```python
import torch

def _softmax(x, axis=-1):
    return torch.softmax(x, dim=axis)
def _gelu(x):
    return torch.nn.functional.gelu(x, approximate="tanh")
def _silu(x):
    return torch.nn.functional.silu(x)
def _sigmoid(x):
    return torch.sigmoid(x)
def _layernorm(x, axis=-1, eps=1e-5):
    m = x.mean(dim=axis, keepdim=True)
    v = x.var(dim=axis, keepdim=True, unbiased=False)
    return (x - m) / torch.sqrt(v + eps)
def _scatter_add(tgt, idx, src, axis=0):
    return tgt.clone().index_add_(axis, idx, src)
def _segment_sum(src, seg, n):
    out = torch.zeros((n,) + src.shape[1:], dtype=src.dtype)
    return out.index_add_(0, seg, src)
def _pad(x, pw):
    flat = tuple(v for pair in reversed(pw) for v in pair)
    return torch.nn.functional.pad(x, flat)

kernel_name = 'parallel_sum__linear_attn_block__moe_arch_mod__prompt'

def setup_inputs():

    _w = (lambda a: (lambda t: t.to(torch.bfloat16) if t.is_floating_point() else t)(torch.as_tensor(a)))
    def _A_setup():
        B, S, D = 1, 2048, 1024
        return {
            "x": _w((lambda *s: torch.randn(*s, dtype=torch.bfloat16) * 0.05)(B, S, D)),
            "wqkv": _w((lambda *s: torch.randn(*s, dtype=torch.bfloat16) * 0.4)(D, 3 * D)),
            "wo": _w((lambda *s: torch.randn(*s, dtype=torch.bfloat16) * 0.2)(D, D)),
        }
    _A_in = _A_setup()

    def _B_setup():
        B, S, D, F, C = 1, 2048, 1024, 3584, 8
        return {
            "x": _w((lambda *s: torch.randn(*s, dtype=torch.bfloat16) * 0.05)(B, S, D)),
            "w_r": _w((lambda *s: torch.randn(*s, dtype=torch.bfloat16) * 0.05)(D)),
            "w_gate": _w((lambda *s: torch.randn(*s, dtype=torch.bfloat16) * 0.05)(D, F)),
            "w_up": _w((lambda *s: torch.randn(*s, dtype=torch.bfloat16) * 0.05)(D, F)),
            "w_down": _w((lambda *s: torch.randn(*s, dtype=torch.bfloat16) * 0.05)(F, D)),
        }
    _B_in = _B_setup()

    return {
        "A_x": _A_in["x"],
        "A_wqkv": _A_in["wqkv"],
        "A_wo": _A_in["wo"],
        "B_x": _B_in["x"],
        "B_w_r": _B_in["w_r"],
        "B_w_gate": _B_in["w_gate"],
        "B_w_up": _B_in["w_up"],
        "B_w_down": _B_in["w_down"],
    }

def reference(A_x, A_wqkv, A_wo, B_x, B_w_r, B_w_gate, B_w_up, B_w_down):
    def _A_ref(x, wqkv, wo):
        B, S, D = x.shape
        H = 32; Dh = D // H
        qkv = (lambda x, *d: x.permute(*d))((x @ wqkv).reshape(B, S, 3, H, Dh), 2, 0, 3, 1, 4)
        q, k, v = qkv[0], qkv[1], qkv[2]
        phi = lambda t: torch.where(t > 0, t + 1, torch.exp(t)) + 1e-6
        pq, pk = phi(q), phi(k)
        kv = torch.einsum("bhsd,bhse->bhde", pk, v)
        z = torch.einsum("bhsd->bhd", pk)
        num = torch.einsum("bhqd,bhde->bhqe", pq, kv)
        den = torch.einsum("bhqd,bhd->bhq", pq, z)[..., None] + 1e-6
        o = num / den
        return (lambda x, *d: x.permute(*d))(o, 0, 2, 1, 3).reshape(B, S, D) @ wo

    def _B_ref(x, w_r, w_gate, w_up, w_down):
        B, S, D = x.shape
        C = 8
        r = x @ w_r
        idx = torch.argsort(-r, axis=-1)[:, :C]
        idx_e = (lambda x, n, axis: torch.repeat_interleave(x, n, dim=axis))(idx.reshape(B, C, 1), D, axis=2)
        x_sel = (lambda x, i, axis: torch.take_along_dim(x, i, dim=axis))(x, idx_e, axis=1)
        g = _silu(x_sel @ w_gate)
        u = x_sel @ w_up
        y = (g * u) @ w_down
        r_sel = _sigmoid((lambda x, i, axis: torch.take_along_dim(x, i, dim=axis))(r, idx, axis=1))
        y = y * r_sel.reshape(B, C, 1)
        b_off = (torch.arange(B) * S).reshape(B, 1)
        flat_idx = (idx + b_off).reshape(B * C)
        zero = (x * 0.0).reshape(B * S, D)
        upd = _scatter_add(zero, flat_idx, y.reshape(B * C, D), axis=0)
        return x + upd.reshape(B, S, D)

    x = A_x
    xn = _layernorm(x, axis=-1)
    return x + _A_ref(xn, A_wqkv, A_wo) + _B_ref(xn, B_w_r, B_w_gate, B_w_up, B_w_down)
```

```asm
; @launch grid=(256,1,1) block=(768,1,1) lds=163840
.amdgcn_target "amdgcn-amd-amdhsa--gfx950"
.text
.globl parallel_sum__linear_attn_block__moe_arch_mod__prompt_kernel
.p2align 8
.type parallel_sum__linear_attn_block__moe_arch_mod__prompt_kernel,@function
parallel_sum__linear_attn_block__moe_arch_mod__prompt_kernel:
    s_load_dwordx4 s[4:7], s[0:1], 0
    s_load_dwordx8 s[60:67], s[0:1], 32
    s_load_dwordx2 s[72:73], s[0:1], 80
    s_load_dwordx4 s[68:71], s[0:1], 64
    s_load_dwordx2 s[8:9], s[0:1], 16
    s_cmp_ge_u32 s2, 256
    s_cbranch_scc1 F_end
    v_lshrrev_b32 v1, 6, v0
    v_and_b32 v0, 63, v0
    s_and_b32 s30, s2, 7
    v_readfirstlane_b32 s3, v1
    s_lshr_b32 s31, s2, 3
    s_and_b32 s32, s30, 1
    s_lshl_b32 s32, s32, 3
    s_and_b32 s35, s31, 7
    s_add_u32 s32, s32, s35
    s_lshr_b32 s33, s30, 1
    s_lshl_b32 s33, s33, 2
    s_lshr_b32 s34, s31, 3
    s_add_u32 s33, s33, s34
    s_lshl_b32 s28, s32, 1
    s_bfe_u32 s29, s30, 0x10001
    s_add_u32 s28, s28, s29
    s_lshl_b32 s29, s30, 2
    s_xor_b32 s29, s29, s30
    s_and_b32 s29, s29, 4
    s_add_u32 s29, s29, s34
    s_lshl_b32 s39, s29, 1
    s_xor_b32 s39, s39, 14
    s_add_u32 s10, s33, 4
    s_and_b32 s10, s10, 15
    v_lshlrev_b32 v2, 4, v0
    s_cmp_ge_u32 s3, 8
    s_cbranch_scc1 F_loader
    s_lshl_b32 s77, s32, 4
    s_add_u32 s77, s77, s33
    s_lshl_b32 s77, s77, 3
    s_add_u32 s77, s77, s3
    s_cmp_lg_u32 s3, 7
    s_cbranch_scc1 F_nt
    s_getpc_b64 s[46:47]
F_pc:
    s_sub_u32 s46, s46, F_pc-parallel_sum__linear_attn_block__moe_arch_mod__prompt_kernel
    s_subb_u32 s47, s47, 0
    s_and_b32 s44, s31, 7
    s_lshl_b32 s44, s44, 13
    v_lshlrev_b32 v60, 7, v0
    v_add_u32_e64 v60, s44, v60
    v_min_u32 v60, F_codeend-parallel_sum__linear_attn_block__moe_arch_mod__prompt_kernel-4, v60
    global_load_dword v161, v60, s[46:47]
F_nt:
    s_lshl_b32 s44, s77, 11
    s_waitcnt lgkmcnt(0)

    s_mov_b32 s20, s4
    s_mov_b32 s21, s5
    s_mov_b32 s22, 0x400000
    s_mov_b32 s23, 0x00020000
    buffer_load_dwordx4 v[4:7], v2, s[20:23], s44 offen
    buffer_load_dwordx4 v[8:11], v2, s[20:23], s44 offen offset:1024
    s_mov_b32 s16, s60
    s_mov_b32 s17, s61
    s_mov_b32 s18, 0x800
    s_mov_b32 s19, 0x00020000
    buffer_load_dwordx4 v[12:15], v2, s[16:19], 0 offen
    buffer_load_dwordx4 v[16:19], v2, s[16:19], 0 offen offset:1024
    s_add_u32 s24, s72, 0x800000
    s_addc_u32 s25, s73, 0
    s_mov_b32 s26, 0x100000
    s_mov_b32 s27, 0x00020000
    s_add_u32 s40, s72, 0x900000
    s_addc_u32 s41, s73, 0
    s_mov_b32 s42, 0x18000
    s_mov_b32 s43, 0x00020000
    s_mov_b32 s48, s70
    s_mov_b32 s49, s71
    s_mov_b32 s50, 0x100
    s_mov_b32 s51, 0x00020000
    v_mov_b32 v20, 0
    v_mov_b32 v21, 0
    v_mov_b32 v22, 0
    v_mov_b32 v23, 0
    s_cmp_lg_u32 s3, 5
    s_cbranch_scc1 F_a0
    s_cmp_lg_u32 s33, 0
    s_cbranch_scc1 F_a0
    s_lshl_b32 s44, s32, 8
    s_add_u32 s44, s44, 32768
    s_lshl_b32 s45, s32, 2
    s_mov_b64 exec, 0xffff
    buffer_store_dwordx4 v[20:23], v2, s[40:43], s44 offen sc0 sc1
    s_mov_b64 exec, 1
    s_waitcnt vmcnt(0)
    v_mov_b32 v24, 1
    buffer_store_dword v24, v20, s[48:51], s45 offen sc0 sc1
    s_mov_b64 exec, -1
    s_branch F_a1
F_a0:
    s_waitcnt vmcnt(0)
F_a1:

    v_lshlrev_b32 v24, 16, v4
    v_and_b32 v25, 0xffff0000, v4
    v_lshlrev_b32 v26, 16, v5
    v_and_b32 v27, 0xffff0000, v5
    v_lshlrev_b32 v28, 16, v6
    v_and_b32 v29, 0xffff0000, v6
    v_lshlrev_b32 v30, 16, v7
    v_and_b32 v31, 0xffff0000, v7
    v_lshlrev_b32 v32, 16, v8
    v_and_b32 v33, 0xffff0000, v8
    v_lshlrev_b32 v34, 16, v9
    v_and_b32 v35, 0xffff0000, v9
    v_lshlrev_b32 v36, 16, v10
    v_and_b32 v37, 0xffff0000, v10
    v_lshlrev_b32 v38, 16, v11
    v_and_b32 v39, 0xffff0000, v11
    v_add_f32 v40, v24, v25
    v_add_f32 v41, v26, v27
    v_add_f32 v42, v28, v29
    v_add_f32 v43, v30, v31
    v_add_f32 v44, v32, v33
    v_add_f32 v45, v34, v35
    v_add_f32 v46, v36, v37
    v_add_f32 v47, v38, v39
    v_add_f32 v40, v40, v44
    v_add_f32 v41, v41, v45
    v_add_f32 v42, v42, v46
    v_add_f32 v43, v43, v47
    v_add_f32 v40, v40, v42
    v_add_f32 v41, v41, v43
    v_add_f32 v40, v40, v41
    s_nop 1
    v_add_f32_dpp v40, v40, v40 row_shr:1 row_mask:0xf bank_mask:0xf bound_ctrl:0
    s_nop 1
    v_add_f32_dpp v40, v40, v40 row_shr:2 row_mask:0xf bank_mask:0xf bound_ctrl:0
    s_nop 1
    v_add_f32_dpp v40, v40, v40 row_shr:4 row_mask:0xf bank_mask:0xf bound_ctrl:0
    s_nop 1
    v_add_f32_dpp v40, v40, v40 row_shr:8 row_mask:0xf bank_mask:0xf bound_ctrl:0
    s_nop 1
    v_add_f32_dpp v40, v40, v40 row_bcast:15 row_mask:0xa bank_mask:0xf
    s_nop 1
    v_add_f32_dpp v40, v40, v40 row_bcast:31 row_mask:0xc bank_mask:0xf
    s_nop 0
    v_readlane_b32 s52, v40, 63
    v_mov_b32 v41, 0x3a800000
    s_nop 0
    v_mul_f32 v41, s52, v41
    v_sub_f32 v44, v24, v41
    v_sub_f32 v45, v25, v41
    v_sub_f32 v46, v26, v41
    v_sub_f32 v47, v27, v41
    v_sub_f32 v48, v28, v41
    v_sub_f32 v49, v29, v41
    v_sub_f32 v50, v30, v41
    v_sub_f32 v51, v31, v41
    v_sub_f32 v52, v32, v41
    v_sub_f32 v53, v33, v41
    v_sub_f32 v54, v34, v41
    v_sub_f32 v55, v35, v41
    v_sub_f32 v56, v36, v41
    v_sub_f32 v57, v37, v41
    v_sub_f32 v58, v38, v41
    v_sub_f32 v59, v39, v41
    v_mul_f32 v40, v44, v44
    v_mul_f32 v42, v45, v45
    v_fmac_f32 v40, v46, v46
    v_fmac_f32 v42, v47, v47
    v_fmac_f32 v40, v48, v48
    v_fmac_f32 v42, v49, v49
    v_fmac_f32 v40, v50, v50
    v_fmac_f32 v42, v51, v51
    v_fmac_f32 v40, v52, v52
    v_fmac_f32 v42, v53, v53
    v_fmac_f32 v40, v54, v54
    v_fmac_f32 v42, v55, v55
    v_fmac_f32 v40, v56, v56
    v_fmac_f32 v42, v57, v57
    v_fmac_f32 v40, v58, v58
    v_fmac_f32 v42, v59, v59
    v_add_f32 v40, v40, v42
    s_nop 1
    v_add_f32_dpp v40, v40, v40 row_shr:1 row_mask:0xf bank_mask:0xf bound_ctrl:0
    s_nop 1
    v_add_f32_dpp v40, v40, v40 row_shr:2 row_mask:0xf bank_mask:0xf bound_ctrl:0
    s_nop 1
    v_add_f32_dpp v40, v40, v40 row_shr:4 row_mask:0xf bank_mask:0xf bound_ctrl:0
    s_nop 1
    v_add_f32_dpp v40, v40, v40 row_shr:8 row_mask:0xf bank_mask:0xf bound_ctrl:0
    s_nop 1
    v_add_f32_dpp v40, v40, v40 row_bcast:15 row_mask:0xa bank_mask:0xf
    s_nop 1
    v_add_f32_dpp v40, v40, v40 row_bcast:31 row_mask:0xc bank_mask:0xf
    s_nop 0
    v_readlane_b32 s52, v40, 63
    v_mov_b32 v42, 0x3a800000
    s_nop 0
    v_mul_f32 v42, s52, v42
    v_cvt_pk_bf16_f32 v43, v41, v42
    v_lshlrev_b32 v41, 16, v43
    v_and_b32 v42, 0xffff0000, v43
    v_add_f32 v42, 0x3727c5ac, v42
    v_cvt_pk_bf16_f32 v42, v42, v42
    v_lshlrev_b32 v42, 16, v42
    v_sqrt_f32 v42, v42
    s_nop 0
    v_cvt_pk_bf16_f32 v42, v42, v42
    v_lshlrev_b32 v42, 16, v42
    v_rcp_f32 v42, v42
    v_sub_f32 v24, v24, v41
    v_sub_f32 v25, v25, v41
    v_sub_f32 v26, v26, v41
    v_sub_f32 v27, v27, v41
    v_sub_f32 v28, v28, v41
    v_sub_f32 v29, v29, v41
    v_sub_f32 v30, v30, v41
    v_sub_f32 v31, v31, v41
    v_sub_f32 v32, v32, v41
    v_sub_f32 v33, v33, v41
    v_sub_f32 v34, v34, v41
    v_sub_f32 v35, v35, v41
    v_sub_f32 v36, v36, v41
    v_sub_f32 v37, v37, v41
    v_sub_f32 v38, v38, v41
    v_sub_f32 v39, v39, v41
    v_cvt_pk_bf16_f32 v4, v24, v25
    v_cvt_pk_bf16_f32 v5, v26, v27
    v_cvt_pk_bf16_f32 v6, v28, v29
    v_cvt_pk_bf16_f32 v7, v30, v31
    v_cvt_pk_bf16_f32 v8, v32, v33
    v_cvt_pk_bf16_f32 v9, v34, v35
    v_cvt_pk_bf16_f32 v10, v36, v37
    v_cvt_pk_bf16_f32 v11, v38, v39
    v_lshlrev_b32 v24, 16, v4
    v_and_b32 v25, 0xffff0000, v4
    v_lshlrev_b32 v26, 16, v5
    v_and_b32 v27, 0xffff0000, v5
    v_lshlrev_b32 v28, 16, v6
    v_and_b32 v29, 0xffff0000, v6
    v_lshlrev_b32 v30, 16, v7
    v_and_b32 v31, 0xffff0000, v7
    v_lshlrev_b32 v32, 16, v8
    v_and_b32 v33, 0xffff0000, v8
    v_lshlrev_b32 v34, 16, v9
    v_and_b32 v35, 0xffff0000, v9
    v_lshlrev_b32 v36, 16, v10
    v_and_b32 v37, 0xffff0000, v10
    v_lshlrev_b32 v38, 16, v11
    v_and_b32 v39, 0xffff0000, v11
    v_mul_f32 v24, v24, v42
    v_mul_f32 v25, v25, v42
    v_mul_f32 v26, v26, v42
    v_mul_f32 v27, v27, v42
    v_mul_f32 v28, v28, v42
    v_mul_f32 v29, v29, v42
    v_mul_f32 v30, v30, v42
    v_mul_f32 v31, v31, v42
    v_mul_f32 v32, v32, v42
    v_mul_f32 v33, v33, v42
    v_mul_f32 v34, v34, v42
    v_mul_f32 v35, v35, v42
    v_mul_f32 v36, v36, v42
    v_mul_f32 v37, v37, v42
    v_mul_f32 v38, v38, v42
    v_mul_f32 v39, v39, v42
    v_cvt_pk_bf16_f32 v4, v24, v25
    v_cvt_pk_bf16_f32 v5, v26, v27
    v_cvt_pk_bf16_f32 v6, v28, v29
    v_cvt_pk_bf16_f32 v7, v30, v31
    v_cvt_pk_bf16_f32 v8, v32, v33
    v_cvt_pk_bf16_f32 v9, v34, v35
    v_cvt_pk_bf16_f32 v10, v36, v37
    v_cvt_pk_bf16_f32 v11, v38, v39
    v_mov_b32 v40, 0
    v_mov_b32 v43, 0
    v_dot2_f32_bf16 v40, v4, v12, v40
    v_dot2_f32_bf16 v43, v5, v13, v43
    v_dot2_f32_bf16 v40, v6, v14, v40
    v_dot2_f32_bf16 v43, v7, v15, v43
    v_dot2_f32_bf16 v40, v8, v16, v40
    v_dot2_f32_bf16 v43, v9, v17, v43
    v_dot2_f32_bf16 v40, v10, v18, v40
    v_dot2_f32_bf16 v43, v11, v19, v43
    s_nop 2
    v_add_f32 v40, v40, v43
    s_nop 1
    v_add_f32_dpp v40, v40, v40 row_shr:1 row_mask:0xf bank_mask:0xf bound_ctrl:0
    s_nop 1
    v_add_f32_dpp v40, v40, v40 row_shr:2 row_mask:0xf bank_mask:0xf bound_ctrl:0
    s_nop 1
    v_add_f32_dpp v40, v40, v40 row_shr:4 row_mask:0xf bank_mask:0xf bound_ctrl:0
    s_nop 1
    v_add_f32_dpp v40, v40, v40 row_shr:8 row_mask:0xf bank_mask:0xf bound_ctrl:0
    s_nop 1
    v_add_f32_dpp v40, v40, v40 row_bcast:15 row_mask:0xa bank_mask:0xf
    s_nop 1
    v_add_f32_dpp v40, v40, v40 row_bcast:31 row_mask:0xc bank_mask:0xf
    s_nop 0
    v_readlane_b32 s52, v40, 63
    s_nop 1
    v_mov_b32 v44, s52
    v_cvt_pk_bf16_f32 v44, v44, v44
    v_and_b32 v44, 0xffff0000, v44
    v_ashrrev_i32 v45, 31, v44
    v_or_b32 v45, 0x80000000, v45
    v_xor_b32 v44, v44, v45
    v_and_b32 v44, 0xffff0000, v44
    s_sub_u32 s44, 2047, s77
    v_or_b32 v44, s44, v44
    v_xor_b32 v46, 0x80000000, v41
    v_mov_b32 v47, v42
    v_mul_f32 v48, 0x3fb8aa3b, v42
    s_lshl_b32 s44, s77, 2
    s_lshl_b32 s45, s77, 4
    s_add_u32 s45, s45, 65536
    v_mov_b32 v45, 0
    s_mov_b64 exec, 1
    buffer_store_dword v44, v45, s[40:43], s44 offen sc0 sc1
    buffer_store_dwordx3 v[46:48], v45, s[40:43], s45 offen sc0 sc1
    s_mov_b64 exec, -1

    s_cmp_ge_u32 s3, 4
    s_cbranch_scc1 F_aux
    s_setprio 2
    s_lshr_b32 s36, s3, 1
    s_and_b32 s37, s3, 1
    s_lshl_b32 s38, s36, 13
    s_lshl_b32 s42, s37, 1

    v_and_b32 v1, 15, v0
    v_lshrrev_b32 v2, 4, v0
    v_lshrrev_b32 v3, 1, v1
    v_xor_b32 v3, v3, v2
    v_lshlrev_b32 v3, 4, v3
    v_lshlrev_b32 v1, 7, v1
    v_add3_u32 v4, v1, v3, s38
    v_xor_b32 v5, 64, v4
    v_add_u32 v6, 81920, v4
    v_add_u32 v7, 81920, v5
    v_bfe_u32 v1, v0, 2, 2
    v_lshl_add_u32 v3, v2, 3, v1
    v_lshrrev_b32 v1, 1, v1
    v_and_b32 v2, 1, v2
    v_lshl_add_u32 v1, v2, 1, v1
    v_xor_b32 v1, s42, v1
    v_lshlrev_b32 v1, 5, v1
    v_lshl_add_u32 v1, v3, 7, v1
    v_and_b32 v2, 3, v0
    v_lshl_add_u32 v1, v2, 3, v1

    v_add_u32 v8, 16384, v1
    v_xor_b32 v9, 32, v8
    v_add_u32 v10, 81920, v8
    v_add_u32 v11, 81920, v9
    s_mov_b32 s40, 0x3f800008
    s_mov_b32 s41, s40
    s_mov_b32 s74, 0x358637bd
    s_mov_b32 s75, s74
    s_lshl_b32 s42, s36, 8
    s_add_u32 s42, s42, 24832
    v_and_or_b32 v164, v0, 48, s42
    v_and_b32 v165, 15, v0
    s_lshl_b32 s42, s37, 7
    s_add_u32 s42, s42, 26368
    v_lshl_add_u32 v165, v165, 2, s42
    s_lshl_b32 s42, s3, 12
    s_add_u32 s42, s42, 65536
    v_lshl_add_u32 v1, v0, 4, s42
    s_lshl_b32 s42, s3, 7
    s_add_u32 s42, s42, 27136
    v_and_or_b32 v2, v0, 48, s42
    s_lshl_b32 s42, s3, 2
    s_add_u32 s42, s42, 24640
    v_mov_b32 v3, s42
    s_lshl_b32 s46, s28, 6
    s_lshl_b32 s47, s29, 8
    s_lshl_b32 s42, s3, 6
    s_add_u32 s47, s47, s42
    s_lshl_b32 s42, s46, 11
    s_add_u32 s42, s42, s47
    s_lshl_b32 s78, s10, 1
    s_add_u32 s78, s78, s37
    s_lshl_b32 s79, s32, 18
    s_lshl_b32 s80, s36, 17
    s_add_u32 s79, s79, s80
    s_lshl_b32 s80, s78, 10
    s_add_u32 s79, s79, s80
    s_lshl_b32 s45, s32, 1
    s_add_u32 s45, s45, s36
    s_mul_i32 s45, s45, 8*64
    s_add_u32 s45, s45, 225280
    v_and_b32 v12, 15, v0
    v_bfe_u32 v13, v0, 4, 1
    v_lshlrev_b32 v13, 5, v13
    v_lshrrev_b32_e64 v14, 5, v0
    v_lshl_add_u32 v13, v14, 4, v13
    v_lshl_add_u32 v167, v12, 11, v13
    s_mul_i32 s82, s78, 4224
    s_add_u32 s83, s82, 4096
    s_lshl_b32 s50, s78, 4
    s_and_b32 s44, s32, 4-1
    s_mul_i32 s44, s44, 16/4
    s_add_u32 s50, s50, s44
    s_mul_i32 s50, s50, 64
    s_and_b32 s44, s2, 63
    s_lshl_b32 s44, s44, 7

    s_add_u32 s56, s50, 0x82f000
    s_add_u32 s56, s72, s56
    s_addc_u32 s57, s73, 0
    s_add_u32 s48, s44, 0x82d000
    s_add_u32 s48, s72, s48
    s_addc_u32 s49, s73, 0
    s_add_u32 s16, s72, 0x400000
    s_addc_u32 s17, s73, 0
    s_mov_b32 s18, 0x400000
    s_mov_b32 s19, 0x00020000
    s_mov_b32 s52, s68
    s_mov_b32 s53, s69
    s_mov_b32 s54, 0x400000
    s_mov_b32 s55, 0x00020000
    s_add_u32 s68, s45, 0x800000
    s_add_u32 s68, s72, s68
    s_addc_u32 s69, s73, 0
    s_mov_b32 s76, 1
    s_barrier
    ds_read_b128 v[12:15], v4 offset:0
    ds_read_b128 v[16:19], v4 offset:2048
    ds_read_b128 v[20:23], v4 offset:4096
    ds_read_b128 v[24:27], v4 offset:6144
    ds_read_b64_tr_b16 v[44:45], v8 offset:8192
    ds_read_b64_tr_b16 v[46:47], v8 offset:8704
    ds_read_b64_tr_b16 v[48:49], v9 offset:8192
    ds_read_b64_tr_b16 v[50:51], v9 offset:8704
    ds_read_b64_tr_b16 v[52:53], v8 offset:16384
    ds_read_b64_tr_b16 v[54:55], v8 offset:16896
    ds_read_b64_tr_b16 v[56:57], v9 offset:16384
    ds_read_b64_tr_b16 v[58:59], v9 offset:16896
    ds_read_b64_tr_b16 v[60:61], v8 offset:0
    ds_read_b64_tr_b16 v[62:63], v8 offset:512
    ds_read_b64_tr_b16 v[64:65], v9 offset:0
    s_waitcnt lgkmcnt(8)
    ds_read_b64_tr_b16 v[66:67], v9 offset:512
    s_waitcnt lgkmcnt(10)
    v_mfma_f32_16x16x32_bf16 v[100:103], v[12:15], v[44:47], 0
    v_mfma_f32_16x16x32_bf16 v[104:107], v[16:19], v[44:47], 0
    v_mfma_f32_16x16x32_bf16 v[108:111], v[20:23], v[44:47], 0
    v_mfma_f32_16x16x32_bf16 v[112:115], v[24:27], v[44:47], 0
    s_waitcnt lgkmcnt(8)
    v_mfma_f32_16x16x32_bf16 v[116:119], v[12:15], v[48:51], 0
    ds_read_b64_tr_b16 v[44:45], v8 offset:12288
    v_mfma_f32_16x16x32_bf16 v[120:123], v[16:19], v[48:51], 0
    ds_read_b64_tr_b16 v[46:47], v8 offset:12800
    v_mfma_f32_16x16x32_bf16 v[124:127], v[20:23], v[48:51], 0
    ds_read_b128 v[28:31], v5 offset:0
    v_mfma_f32_16x16x32_bf16 v[128:131], v[24:27], v[48:51], 0
    ds_read_b128 v[32:35], v5 offset:2048
    s_waitcnt lgkmcnt(10)
    v_mfma_f32_16x16x32_bf16 v[132:135], v[12:15], v[52:55], 0
    ds_read_b128 v[36:39], v5 offset:4096
    v_mfma_f32_16x16x32_bf16 v[136:139], v[16:19], v[52:55], 0
    ds_read_b128 v[40:43], v5 offset:6144
    v_mfma_f32_16x16x32_bf16 v[140:143], v[20:23], v[52:55], 0
    ds_read_b64_tr_b16 v[48:49], v9 offset:12288
    v_mfma_f32_16x16x32_bf16 v[144:147], v[24:27], v[52:55], 0
    ds_read_b64_tr_b16 v[50:51], v9 offset:12800
    s_waitcnt lgkmcnt(12)
    v_mfma_f32_16x16x32_bf16 v[148:151], v[12:15], v[56:59], 0
    ds_read_b64_tr_b16 v[52:53], v8 offset:20480
    v_mfma_f32_16x16x32_bf16 v[152:155], v[16:19], v[56:59], 0
    ds_read_b64_tr_b16 v[54:55], v8 offset:20992
    v_mfma_f32_16x16x32_bf16 v[156:159], v[20:23], v[56:59], 0
    v_mfma_f32_16x16x32_bf16 v[160:163], v[24:27], v[56:59], 0
    s_waitcnt lgkmcnt(12)
    v_mfma_f32_16x16x32_bf16 v[68:71], v[60:63], v[12:15], 0
    ds_read_b64_tr_b16 v[56:57], v9 offset:20480
    v_mfma_f32_16x16x32_bf16 v[72:75], v[60:63], v[16:19], 0
    ds_read_b64_tr_b16 v[58:59], v9 offset:20992
    v_mfma_f32_16x16x32_bf16 v[76:79], v[60:63], v[20:23], 0
    v_mfma_f32_16x16x32_bf16 v[80:83], v[60:63], v[24:27], 0
    s_waitcnt lgkmcnt(12)
    v_mfma_f32_16x16x32_bf16 v[84:87], v[64:67], v[12:15], 0
    ds_read_b64_tr_b16 v[60:61], v8 offset:4096
    v_mfma_f32_16x16x32_bf16 v[88:91], v[64:67], v[16:19], 0
    ds_read_b64_tr_b16 v[62:63], v8 offset:4608
    v_mfma_f32_16x16x32_bf16 v[92:95], v[64:67], v[20:23], 0
    v_mfma_f32_16x16x32_bf16 v[96:99], v[64:67], v[24:27], 0
    ds_read_b64_tr_b16 v[64:65], v9 offset:4096
    s_waitcnt lgkmcnt(8)
    ds_read_b64_tr_b16 v[66:67], v9 offset:4608
    s_waitcnt lgkmcnt(13)
    v_mfma_f32_16x16x32_bf16 v[100:103], v[28:31], v[44:47], v[100:103]
    s_waitcnt lgkmcnt(12)
    v_mfma_f32_16x16x32_bf16 v[104:107], v[32:35], v[44:47], v[104:107]
    s_waitcnt lgkmcnt(11)
    v_mfma_f32_16x16x32_bf16 v[108:111], v[36:39], v[44:47], v[108:111]
    s_waitcnt lgkmcnt(10)
    v_mfma_f32_16x16x32_bf16 v[112:115], v[40:43], v[44:47], v[112:115]
    s_waitcnt lgkmcnt(0)
    s_barrier
    v_mfma_f32_16x16x32_bf16 v[116:119], v[28:31], v[48:51], v[116:119]
    ds_read_b64_tr_b16 v[44:45], v8 offset:49152
    v_mfma_f32_16x16x32_bf16 v[120:123], v[32:35], v[48:51], v[120:123]
    ds_read_b64_tr_b16 v[46:47], v8 offset:49664
    v_mfma_f32_16x16x32_bf16 v[124:127], v[36:39], v[48:51], v[124:127]
    ds_read_b128 v[12:15], v4 offset:40960
    v_mfma_f32_16x16x32_bf16 v[128:131], v[40:43], v[48:51], v[128:131]
    ds_read_b128 v[16:19], v4 offset:43008
    v_mfma_f32_16x16x32_bf16 v[132:135], v[28:31], v[52:55], v[132:135]
    ds_read_b128 v[20:23], v4 offset:45056
    v_mfma_f32_16x16x32_bf16 v[136:139], v[32:35], v[52:55], v[136:139]
    ds_read_b128 v[24:27], v4 offset:47104
    v_mfma_f32_16x16x32_bf16 v[140:143], v[36:39], v[52:55], v[140:143]
    ds_read_b64_tr_b16 v[48:49], v9 offset:49152
    v_mfma_f32_16x16x32_bf16 v[144:147], v[40:43], v[52:55], v[144:147]
    ds_read_b64_tr_b16 v[50:51], v9 offset:49664
    v_mfma_f32_16x16x32_bf16 v[148:151], v[28:31], v[56:59], v[148:151]
    ds_read_b64_tr_b16 v[52:53], v8 offset:57344
    v_mfma_f32_16x16x32_bf16 v[152:155], v[32:35], v[56:59], v[152:155]
    ds_read_b64_tr_b16 v[54:55], v8 offset:57856
    v_mfma_f32_16x16x32_bf16 v[156:159], v[36:39], v[56:59], v[156:159]
    v_mfma_f32_16x16x32_bf16 v[160:163], v[40:43], v[56:59], v[160:163]
    v_mfma_f32_16x16x32_bf16 v[68:71], v[60:63], v[28:31], v[68:71]
    ds_read_b64_tr_b16 v[56:57], v9 offset:57344
    v_mfma_f32_16x16x32_bf16 v[72:75], v[60:63], v[32:35], v[72:75]
    ds_read_b64_tr_b16 v[58:59], v9 offset:57856
    v_mfma_f32_16x16x32_bf16 v[76:79], v[60:63], v[36:39], v[76:79]
    v_mfma_f32_16x16x32_bf16 v[80:83], v[60:63], v[40:43], v[80:83]
    v_mfma_f32_16x16x32_bf16 v[84:87], v[64:67], v[28:31], v[84:87]
    ds_read_b64_tr_b16 v[60:61], v8 offset:40960
    v_mfma_f32_16x16x32_bf16 v[88:91], v[64:67], v[32:35], v[88:91]
    ds_read_b64_tr_b16 v[62:63], v8 offset:41472
    v_mfma_f32_16x16x32_bf16 v[92:95], v[64:67], v[36:39], v[92:95]
    v_mfma_f32_16x16x32_bf16 v[96:99], v[64:67], v[40:43], v[96:99]
    ds_read_b64_tr_b16 v[64:65], v9 offset:40960
    s_waitcnt lgkmcnt(8)
    ds_read_b64_tr_b16 v[66:67], v9 offset:41472
    s_waitcnt lgkmcnt(13)
    v_mfma_f32_16x16x32_bf16 v[100:103], v[12:15], v[44:47], v[100:103]
    s_waitcnt lgkmcnt(12)
    v_mfma_f32_16x16x32_bf16 v[104:107], v[16:19], v[44:47], v[104:107]
    s_waitcnt lgkmcnt(11)
    v_mfma_f32_16x16x32_bf16 v[108:111], v[20:23], v[44:47], v[108:111]
    s_waitcnt lgkmcnt(10)
    v_mfma_f32_16x16x32_bf16 v[112:115], v[24:27], v[44:47], v[112:115]
    s_waitcnt lgkmcnt(8)
    v_mfma_f32_16x16x32_bf16 v[116:119], v[12:15], v[48:51], v[116:119]
    ds_read_b64_tr_b16 v[44:45], v8 offset:53248
    v_mfma_f32_16x16x32_bf16 v[120:123], v[16:19], v[48:51], v[120:123]
    ds_read_b64_tr_b16 v[46:47], v8 offset:53760
    v_mfma_f32_16x16x32_bf16 v[124:127], v[20:23], v[48:51], v[124:127]
    ds_read_b128 v[28:31], v5 offset:40960
    v_mfma_f32_16x16x32_bf16 v[128:131], v[24:27], v[48:51], v[128:131]
    ds_read_b128 v[32:35], v5 offset:43008
    s_waitcnt lgkmcnt(10)
    v_mfma_f32_16x16x32_bf16 v[132:135], v[12:15], v[52:55], v[132:135]
    ds_read_b128 v[36:39], v5 offset:45056
    v_mfma_f32_16x16x32_bf16 v[136:139], v[16:19], v[52:55], v[136:139]
    ds_read_b128 v[40:43], v5 offset:47104
    v_mfma_f32_16x16x32_bf16 v[140:143], v[20:23], v[52:55], v[140:143]
    ds_read_b64_tr_b16 v[48:49], v9 offset:53248
    v_mfma_f32_16x16x32_bf16 v[144:147], v[24:27], v[52:55], v[144:147]
    ds_read_b64_tr_b16 v[50:51], v9 offset:53760
    s_waitcnt lgkmcnt(12)
    v_mfma_f32_16x16x32_bf16 v[148:151], v[12:15], v[56:59], v[148:151]
    ds_read_b64_tr_b16 v[52:53], v8 offset:61440
    v_mfma_f32_16x16x32_bf16 v[152:155], v[16:19], v[56:59], v[152:155]
    ds_read_b64_tr_b16 v[54:55], v8 offset:61952
    v_mfma_f32_16x16x32_bf16 v[156:159], v[20:23], v[56:59], v[156:159]
    v_mfma_f32_16x16x32_bf16 v[160:163], v[24:27], v[56:59], v[160:163]
    s_waitcnt lgkmcnt(12)
    v_mfma_f32_16x16x32_bf16 v[68:71], v[60:63], v[12:15], v[68:71]
    ds_read_b64_tr_b16 v[56:57], v9 offset:61440
    v_mfma_f32_16x16x32_bf16 v[72:75], v[60:63], v[16:19], v[72:75]
    ds_read_b64_tr_b16 v[58:59], v9 offset:61952
    v_mfma_f32_16x16x32_bf16 v[76:79], v[60:63], v[20:23], v[76:79]
    v_mfma_f32_16x16x32_bf16 v[80:83], v[60:63], v[24:27], v[80:83]
    s_waitcnt lgkmcnt(12)
    v_mfma_f32_16x16x32_bf16 v[84:87], v[64:67], v[12:15], v[84:87]
    ds_read_b64_tr_b16 v[60:61], v8 offset:45056
    v_mfma_f32_16x16x32_bf16 v[88:91], v[64:67], v[16:19], v[88:91]
    ds_read_b64_tr_b16 v[62:63], v8 offset:45568
    v_mfma_f32_16x16x32_bf16 v[92:95], v[64:67], v[20:23], v[92:95]
    v_mfma_f32_16x16x32_bf16 v[96:99], v[64:67], v[24:27], v[96:99]
    ds_read_b64_tr_b16 v[64:65], v9 offset:45056
    s_waitcnt lgkmcnt(8)
    ds_read_b64_tr_b16 v[66:67], v9 offset:45568
    s_waitcnt lgkmcnt(13)
    v_mfma_f32_16x16x32_bf16 v[100:103], v[28:31], v[44:47], v[100:103]
    s_waitcnt lgkmcnt(12)
    v_mfma_f32_16x16x32_bf16 v[104:107], v[32:35], v[44:47], v[104:107]
    s_waitcnt lgkmcnt(11)
    v_mfma_f32_16x16x32_bf16 v[108:111], v[36:39], v[44:47], v[108:111]
    s_waitcnt lgkmcnt(10)
    v_mfma_f32_16x16x32_bf16 v[112:115], v[40:43], v[44:47], v[112:115]
    s_waitcnt lgkmcnt(0)
    s_waitcnt vmcnt(0)
    s_barrier
    v_mfma_f32_16x16x32_bf16 v[116:119], v[28:31], v[48:51], v[116:119]
    ds_read_b64_tr_b16 v[44:45], v10 offset:8192
    v_mfma_f32_16x16x32_bf16 v[120:123], v[32:35], v[48:51], v[120:123]
    ds_read_b64_tr_b16 v[46:47], v10 offset:8704
    v_mfma_f32_16x16x32_bf16 v[124:127], v[36:39], v[48:51], v[124:127]
    ds_read_b128 v[12:15], v6 offset:0
    v_mfma_f32_16x16x32_bf16 v[128:131], v[40:43], v[48:51], v[128:131]
    ds_read_b128 v[16:19], v6 offset:2048
    v_mfma_f32_16x16x32_bf16 v[132:135], v[28:31], v[52:55], v[132:135]
    ds_read_b128 v[20:23], v6 offset:4096
    v_mfma_f32_16x16x32_bf16 v[136:139], v[32:35], v[52:55], v[136:139]
    ds_read_b128 v[24:27], v6 offset:6144
    v_mfma_f32_16x16x32_bf16 v[140:143], v[36:39], v[52:55], v[140:143]
    ds_read_b64_tr_b16 v[48:49], v11 offset:8192
    v_mfma_f32_16x16x32_bf16 v[144:147], v[40:43], v[52:55], v[144:147]
    ds_read_b64_tr_b16 v[50:51], v11 offset:8704
    v_mfma_f32_16x16x32_bf16 v[148:151], v[28:31], v[56:59], v[148:151]
    ds_read_b64_tr_b16 v[52:53], v10 offset:16384
    v_mfma_f32_16x16x32_bf16 v[152:155], v[32:35], v[56:59], v[152:155]
    ds_read_b64_tr_b16 v[54:55], v10 offset:16896
    v_mfma_f32_16x16x32_bf16 v[156:159], v[36:39], v[56:59], v[156:159]
    v_mfma_f32_16x16x32_bf16 v[160:163], v[40:43], v[56:59], v[160:163]
    v_mfma_f32_16x16x32_bf16 v[68:71], v[60:63], v[28:31], v[68:71]
    ds_read_b64_tr_b16 v[56:57], v11 offset:16384
    v_mfma_f32_16x16x32_bf16 v[72:75], v[60:63], v[32:35], v[72:75]
    ds_read_b64_tr_b16 v[58:59], v11 offset:16896
    v_mfma_f32_16x16x32_bf16 v[76:79], v[60:63], v[36:39], v[76:79]
    v_mfma_f32_16x16x32_bf16 v[80:83], v[60:63], v[40:43], v[80:83]
    v_mfma_f32_16x16x32_bf16 v[84:87], v[64:67], v[28:31], v[84:87]
    ds_read_b64_tr_b16 v[60:61], v10 offset:0
    v_mfma_f32_16x16x32_bf16 v[88:91], v[64:67], v[32:35], v[88:91]
    ds_read_b64_tr_b16 v[62:63], v10 offset:512
    v_mfma_f32_16x16x32_bf16 v[92:95], v[64:67], v[36:39], v[92:95]
    v_mfma_f32_16x16x32_bf16 v[96:99], v[64:67], v[40:43], v[96:99]
    ds_read_b64_tr_b16 v[64:65], v11 offset:0
    s_waitcnt lgkmcnt(8)
    ds_read_b64_tr_b16 v[66:67], v11 offset:512
    v_swap_b32 v4, v6
    v_swap_b32 v5, v7
    v_swap_b32 v8, v10
    v_swap_b32 v9, v11
    s_mov_b32 s81, 5
F_p1:
    s_waitcnt lgkmcnt(13)
    v_mfma_f32_16x16x32_bf16 v[100:103], v[12:15], v[44:47], v[100:103]
    s_waitcnt lgkmcnt(12)
    v_mfma_f32_16x16x32_bf16 v[104:107], v[16:19], v[44:47], v[104:107]
    s_waitcnt lgkmcnt(11)
    v_mfma_f32_16x16x32_bf16 v[108:111], v[20:23], v[44:47], v[108:111]
    s_waitcnt lgkmcnt(10)
    v_mfma_f32_16x16x32_bf16 v[112:115], v[24:27], v[44:47], v[112:115]
    s_waitcnt lgkmcnt(8)
    v_mfma_f32_16x16x32_bf16 v[116:119], v[12:15], v[48:51], v[116:119]
    ds_read_b64_tr_b16 v[44:45], v8 offset:12288
    v_mfma_f32_16x16x32_bf16 v[120:123], v[16:19], v[48:51], v[120:123]
    ds_read_b64_tr_b16 v[46:47], v8 offset:12800
    v_mfma_f32_16x16x32_bf16 v[124:127], v[20:23], v[48:51], v[124:127]
    ds_read_b128 v[28:31], v5 offset:0
    v_mfma_f32_16x16x32_bf16 v[128:131], v[24:27], v[48:51], v[128:131]
    ds_read_b128 v[32:35], v5 offset:2048
    s_waitcnt lgkmcnt(10)
    v_mfma_f32_16x16x32_bf16 v[132:135], v[12:15], v[52:55], v[132:135]
    ds_read_b128 v[36:39], v5 offset:4096
    v_mfma_f32_16x16x32_bf16 v[136:139], v[16:19], v[52:55], v[136:139]
    ds_read_b128 v[40:43], v5 offset:6144
    v_mfma_f32_16x16x32_bf16 v[140:143], v[20:23], v[52:55], v[140:143]
    ds_read_b64_tr_b16 v[48:49], v9 offset:12288
    v_mfma_f32_16x16x32_bf16 v[144:147], v[24:27], v[52:55], v[144:147]
    ds_read_b64_tr_b16 v[50:51], v9 offset:12800
    s_waitcnt lgkmcnt(12)
    v_mfma_f32_16x16x32_bf16 v[148:151], v[12:15], v[56:59], v[148:151]
    ds_read_b64_tr_b16 v[52:53], v8 offset:20480
    v_mfma_f32_16x16x32_bf16 v[152:155], v[16:19], v[56:59], v[152:155]
    ds_read_b64_tr_b16 v[54:55], v8 offset:20992
    v_mfma_f32_16x16x32_bf16 v[156:159], v[20:23], v[56:59], v[156:159]
    v_mfma_f32_16x16x32_bf16 v[160:163], v[24:27], v[56:59], v[160:163]
    s_waitcnt lgkmcnt(12)
    v_mfma_f32_16x16x32_bf16 v[68:71], v[60:63], v[12:15], v[68:71]
    ds_read_b64_tr_b16 v[56:57], v9 offset:20480
    v_mfma_f32_16x16x32_bf16 v[72:75], v[60:63], v[16:19], v[72:75]
    ds_read_b64_tr_b16 v[58:59], v9 offset:20992
    v_mfma_f32_16x16x32_bf16 v[76:79], v[60:63], v[20:23], v[76:79]
    v_mfma_f32_16x16x32_bf16 v[80:83], v[60:63], v[24:27], v[80:83]
    s_waitcnt lgkmcnt(12)
    v_mfma_f32_16x16x32_bf16 v[84:87], v[64:67], v[12:15], v[84:87]
    ds_read_b64_tr_b16 v[60:61], v8 offset:4096
    v_mfma_f32_16x16x32_bf16 v[88:91], v[64:67], v[16:19], v[88:91]
    ds_read_b64_tr_b16 v[62:63], v8 offset:4608
    v_mfma_f32_16x16x32_bf16 v[92:95], v[64:67], v[20:23], v[92:95]
    v_mfma_f32_16x16x32_bf16 v[96:99], v[64:67], v[24:27], v[96:99]
    ds_read_b64_tr_b16 v[64:65], v9 offset:4096
    s_waitcnt lgkmcnt(8)
    ds_read_b64_tr_b16 v[66:67], v9 offset:4608
    s_waitcnt lgkmcnt(13)
    v_mfma_f32_16x16x32_bf16 v[100:103], v[28:31], v[44:47], v[100:103]
    s_waitcnt lgkmcnt(12)
    v_mfma_f32_16x16x32_bf16 v[104:107], v[32:35], v[44:47], v[104:107]
    s_waitcnt lgkmcnt(11)
    v_mfma_f32_16x16x32_bf16 v[108:111], v[36:39], v[44:47], v[108:111]
    s_waitcnt lgkmcnt(10)
    v_mfma_f32_16x16x32_bf16 v[112:115], v[40:43], v[44:47], v[112:115]
    s_waitcnt lgkmcnt(0)
    s_barrier
    v_mfma_f32_16x16x32_bf16 v[116:119], v[28:31], v[48:51], v[116:119]
    ds_read_b64_tr_b16 v[44:45], v8 offset:49152
    v_mfma_f32_16x16x32_bf16 v[120:123], v[32:35], v[48:51], v[120:123]
    ds_read_b64_tr_b16 v[46:47], v8 offset:49664
    v_mfma_f32_16x16x32_bf16 v[124:127], v[36:39], v[48:51], v[124:127]
    ds_read_b128 v[12:15], v4 offset:40960
    v_mfma_f32_16x16x32_bf16 v[128:131], v[40:43], v[48:51], v[128:131]
    ds_read_b128 v[16:19], v4 offset:43008
    v_mfma_f32_16x16x32_bf16 v[132:135], v[28:31], v[52:55], v[132:135]
    ds_read_b128 v[20:23], v4 offset:45056
    v_mfma_f32_16x16x32_bf16 v[136:139], v[32:35], v[52:55], v[136:139]
    ds_read_b128 v[24:27], v4 offset:47104
    v_mfma_f32_16x16x32_bf16 v[140:143], v[36:39], v[52:55], v[140:143]
    ds_read_b64_tr_b16 v[48:49], v9 offset:49152
    v_mfma_f32_16x16x32_bf16 v[144:147], v[40:43], v[52:55], v[144:147]
    ds_read_b64_tr_b16 v[50:51], v9 offset:49664
    v_mfma_f32_16x16x32_bf16 v[148:151], v[28:31], v[56:59], v[148:151]
    ds_read_b64_tr_b16 v[52:53], v8 offset:57344
    v_mfma_f32_16x16x32_bf16 v[152:155], v[32:35], v[56:59], v[152:155]
    ds_read_b64_tr_b16 v[54:55], v8 offset:57856
    v_mfma_f32_16x16x32_bf16 v[156:159], v[36:39], v[56:59], v[156:159]
    v_mfma_f32_16x16x32_bf16 v[160:163], v[40:43], v[56:59], v[160:163]
    v_mfma_f32_16x16x32_bf16 v[68:71], v[60:63], v[28:31], v[68:71]
    ds_read_b64_tr_b16 v[56:57], v9 offset:57344
    v_mfma_f32_16x16x32_bf16 v[72:75], v[60:63], v[32:35], v[72:75]
    ds_read_b64_tr_b16 v[58:59], v9 offset:57856
    v_mfma_f32_16x16x32_bf16 v[76:79], v[60:63], v[36:39], v[76:79]
    v_mfma_f32_16x16x32_bf16 v[80:83], v[60:63], v[40:43], v[80:83]
    v_mfma_f32_16x16x32_bf16 v[84:87], v[64:67], v[28:31], v[84:87]
    ds_read_b64_tr_b16 v[60:61], v8 offset:40960
    v_mfma_f32_16x16x32_bf16 v[88:91], v[64:67], v[32:35], v[88:91]
    ds_read_b64_tr_b16 v[62:63], v8 offset:41472
    v_mfma_f32_16x16x32_bf16 v[92:95], v[64:67], v[36:39], v[92:95]
    v_mfma_f32_16x16x32_bf16 v[96:99], v[64:67], v[40:43], v[96:99]
    ds_read_b64_tr_b16 v[64:65], v9 offset:40960
    s_waitcnt lgkmcnt(8)
    ds_read_b64_tr_b16 v[66:67], v9 offset:41472
    s_waitcnt lgkmcnt(13)
    v_mfma_f32_16x16x32_bf16 v[100:103], v[12:15], v[44:47], v[100:103]
    s_waitcnt lgkmcnt(12)
    v_mfma_f32_16x16x32_bf16 v[104:107], v[16:19], v[44:47], v[104:107]
    s_waitcnt lgkmcnt(11)
    v_mfma_f32_16x16x32_bf16 v[108:111], v[20:23], v[44:47], v[108:111]
    s_waitcnt lgkmcnt(10)
    v_mfma_f32_16x16x32_bf16 v[112:115], v[24:27], v[44:47], v[112:115]
    s_waitcnt lgkmcnt(8)
    v_mfma_f32_16x16x32_bf16 v[116:119], v[12:15], v[48:51], v[116:119]
    ds_read_b64_tr_b16 v[44:45], v8 offset:53248
    v_mfma_f32_16x16x32_bf16 v[120:123], v[16:19], v[48:51], v[120:123]
    ds_read_b64_tr_b16 v[46:47], v8 offset:53760
    v_mfma_f32_16x16x32_bf16 v[124:127], v[20:23], v[48:51], v[124:127]
    ds_read_b128 v[28:31], v5 offset:40960
    v_mfma_f32_16x16x32_bf16 v[128:131], v[24:27], v[48:51], v[128:131]
    ds_read_b128 v[32:35], v5 offset:43008
    s_waitcnt lgkmcnt(10)
    v_mfma_f32_16x16x32_bf16 v[132:135], v[12:15], v[52:55], v[132:135]
    ds_read_b128 v[36:39], v5 offset:45056
    v_mfma_f32_16x16x32_bf16 v[136:139], v[16:19], v[52:55], v[136:139]
    ds_read_b128 v[40:43], v5 offset:47104
    v_mfma_f32_16x16x32_bf16 v[140:143], v[20:23], v[52:55], v[140:143]
    ds_read_b64_tr_b16 v[48:49], v9 offset:53248
    v_mfma_f32_16x16x32_bf16 v[144:147], v[24:27], v[52:55], v[144:147]
    ds_read_b64_tr_b16 v[50:51], v9 offset:53760
    s_waitcnt lgkmcnt(12)
    v_mfma_f32_16x16x32_bf16 v[148:151], v[12:15], v[56:59], v[148:151]
    ds_read_b64_tr_b16 v[52:53], v8 offset:61440
    v_mfma_f32_16x16x32_bf16 v[152:155], v[16:19], v[56:59], v[152:155]
    ds_read_b64_tr_b16 v[54:55], v8 offset:61952
    v_mfma_f32_16x16x32_bf16 v[156:159], v[20:23], v[56:59], v[156:159]
    v_mfma_f32_16x16x32_bf16 v[160:163], v[24:27], v[56:59], v[160:163]
    s_waitcnt lgkmcnt(12)
    v_mfma_f32_16x16x32_bf16 v[68:71], v[60:63], v[12:15], v[68:71]
    ds_read_b64_tr_b16 v[56:57], v9 offset:61440
    v_mfma_f32_16x16x32_bf16 v[72:75], v[60:63], v[16:19], v[72:75]
    ds_read_b64_tr_b16 v[58:59], v9 offset:61952
    v_mfma_f32_16x16x32_bf16 v[76:79], v[60:63], v[20:23], v[76:79]
    v_mfma_f32_16x16x32_bf16 v[80:83], v[60:63], v[24:27], v[80:83]
    s_waitcnt lgkmcnt(12)
    v_mfma_f32_16x16x32_bf16 v[84:87], v[64:67], v[12:15], v[84:87]
    ds_read_b64_tr_b16 v[60:61], v8 offset:45056
    v_mfma_f32_16x16x32_bf16 v[88:91], v[64:67], v[16:19], v[88:91]
    ds_read_b64_tr_b16 v[62:63], v8 offset:45568
    v_mfma_f32_16x16x32_bf16 v[92:95], v[64:67], v[20:23], v[92:95]
    v_mfma_f32_16x16x32_bf16 v[96:99], v[64:67], v[24:27], v[96:99]
    ds_read_b64_tr_b16 v[64:65], v9 offset:45056
    s_waitcnt lgkmcnt(8)
    ds_read_b64_tr_b16 v[66:67], v9 offset:45568
    s_waitcnt lgkmcnt(13)
    v_mfma_f32_16x16x32_bf16 v[100:103], v[28:31], v[44:47], v[100:103]
    s_waitcnt lgkmcnt(12)
    v_mfma_f32_16x16x32_bf16 v[104:107], v[32:35], v[44:47], v[104:107]
    s_waitcnt lgkmcnt(11)
    v_mfma_f32_16x16x32_bf16 v[108:111], v[36:39], v[44:47], v[108:111]
    s_waitcnt lgkmcnt(10)
    v_mfma_f32_16x16x32_bf16 v[112:115], v[40:43], v[44:47], v[112:115]
    s_waitcnt lgkmcnt(0)
    s_barrier
    v_mfma_f32_16x16x32_bf16 v[116:119], v[28:31], v[48:51], v[116:119]
    ds_read_b64_tr_b16 v[44:45], v10 offset:8192
    v_mfma_f32_16x16x32_bf16 v[120:123], v[32:35], v[48:51], v[120:123]
    ds_read_b64_tr_b16 v[46:47], v10 offset:8704
    v_mfma_f32_16x16x32_bf16 v[124:127], v[36:39], v[48:51], v[124:127]
    ds_read_b128 v[12:15], v6 offset:0
    v_mfma_f32_16x16x32_bf16 v[128:131], v[40:43], v[48:51], v[128:131]
    ds_read_b128 v[16:19], v6 offset:2048
    v_mfma_f32_16x16x32_bf16 v[132:135], v[28:31], v[52:55], v[132:135]
    ds_read_b128 v[20:23], v6 offset:4096
    v_mfma_f32_16x16x32_bf16 v[136:139], v[32:35], v[52:55], v[136:139]
    ds_read_b128 v[24:27], v6 offset:6144
    v_mfma_f32_16x16x32_bf16 v[140:143], v[36:39], v[52:55], v[140:143]
    ds_read_b64_tr_b16 v[48:49], v11 offset:8192
    v_mfma_f32_16x16x32_bf16 v[144:147], v[40:43], v[52:55], v[144:147]
    ds_read_b64_tr_b16 v[50:51], v11 offset:8704
    v_mfma_f32_16x16x32_bf16 v[148:151], v[28:31], v[56:59], v[148:151]
    ds_read_b64_tr_b16 v[52:53], v10 offset:16384
    v_mfma_f32_16x16x32_bf16 v[152:155], v[32:35], v[56:59], v[152:155]
    ds_read_b64_tr_b16 v[54:55], v10 offset:16896
    v_mfma_f32_16x16x32_bf16 v[156:159], v[36:39], v[56:59], v[156:159]
    v_mfma_f32_16x16x32_bf16 v[160:163], v[40:43], v[56:59], v[160:163]
    v_mfma_f32_16x16x32_bf16 v[68:71], v[60:63], v[28:31], v[68:71]
    ds_read_b64_tr_b16 v[56:57], v11 offset:16384
    v_mfma_f32_16x16x32_bf16 v[72:75], v[60:63], v[32:35], v[72:75]
    ds_read_b64_tr_b16 v[58:59], v11 offset:16896
    v_mfma_f32_16x16x32_bf16 v[76:79], v[60:63], v[36:39], v[76:79]
    v_mfma_f32_16x16x32_bf16 v[80:83], v[60:63], v[40:43], v[80:83]
    v_mfma_f32_16x16x32_bf16 v[84:87], v[64:67], v[28:31], v[84:87]
    ds_read_b64_tr_b16 v[60:61], v10 offset:0
    v_mfma_f32_16x16x32_bf16 v[88:91], v[64:67], v[32:35], v[88:91]
    ds_read_b64_tr_b16 v[62:63], v10 offset:512
    v_mfma_f32_16x16x32_bf16 v[92:95], v[64:67], v[36:39], v[92:95]
    v_mfma_f32_16x16x32_bf16 v[96:99], v[64:67], v[40:43], v[96:99]
    ds_read_b64_tr_b16 v[64:65], v11 offset:0
    s_waitcnt lgkmcnt(8)
    ds_read_b64_tr_b16 v[66:67], v11 offset:512
    v_swap_b32 v4, v6
    v_swap_b32 v5, v7
    v_swap_b32 v8, v10
    v_swap_b32 v9, v11
    s_sub_u32 s81, s81, 1
    s_cmp_lg_u32 s81, 0
    s_cbranch_scc1 F_p1
    s_waitcnt lgkmcnt(13)
    v_mfma_f32_16x16x32_bf16 v[100:103], v[12:15], v[44:47], v[100:103]
    s_waitcnt lgkmcnt(12)
    v_mfma_f32_16x16x32_bf16 v[104:107], v[16:19], v[44:47], v[104:107]
    s_waitcnt lgkmcnt(11)
    v_mfma_f32_16x16x32_bf16 v[108:111], v[20:23], v[44:47], v[108:111]
    s_waitcnt lgkmcnt(10)
    v_mfma_f32_16x16x32_bf16 v[112:115], v[24:27], v[44:47], v[112:115]
    s_waitcnt lgkmcnt(8)
    v_mfma_f32_16x16x32_bf16 v[116:119], v[12:15], v[48:51], v[116:119]
    ds_read_b64_tr_b16 v[44:45], v8 offset:12288
    v_mfma_f32_16x16x32_bf16 v[120:123], v[16:19], v[48:51], v[120:123]
    ds_read_b64_tr_b16 v[46:47], v8 offset:12800
    v_mfma_f32_16x16x32_bf16 v[124:127], v[20:23], v[48:51], v[124:127]
    ds_read_b128 v[28:31], v5 offset:0
    v_mfma_f32_16x16x32_bf16 v[128:131], v[24:27], v[48:51], v[128:131]
    ds_read_b128 v[32:35], v5 offset:2048
    s_waitcnt lgkmcnt(10)
    v_mfma_f32_16x16x32_bf16 v[132:135], v[12:15], v[52:55], v[132:135]
    ds_read_b128 v[36:39], v5 offset:4096
    v_mfma_f32_16x16x32_bf16 v[136:139], v[16:19], v[52:55], v[136:139]
    ds_read_b128 v[40:43], v5 offset:6144
    v_mfma_f32_16x16x32_bf16 v[140:143], v[20:23], v[52:55], v[140:143]
    ds_read_b64_tr_b16 v[48:49], v9 offset:12288
    v_mfma_f32_16x16x32_bf16 v[144:147], v[24:27], v[52:55], v[144:147]
    ds_read_b64_tr_b16 v[50:51], v9 offset:12800
    s_waitcnt lgkmcnt(12)
    v_mfma_f32_16x16x32_bf16 v[148:151], v[12:15], v[56:59], v[148:151]
    ds_read_b64_tr_b16 v[52:53], v8 offset:20480
    v_mfma_f32_16x16x32_bf16 v[152:155], v[16:19], v[56:59], v[152:155]
    ds_read_b64_tr_b16 v[54:55], v8 offset:20992
    v_mfma_f32_16x16x32_bf16 v[156:159], v[20:23], v[56:59], v[156:159]
    v_mfma_f32_16x16x32_bf16 v[160:163], v[24:27], v[56:59], v[160:163]
    ds_read_b64_tr_b16 v[56:57], v9 offset:20480
    s_waitcnt lgkmcnt(8)
    ds_read_b64_tr_b16 v[58:59], v9 offset:20992
    s_waitcnt lgkmcnt(9)
    v_mfma_f32_16x16x32_bf16 v[100:103], v[28:31], v[44:47], v[100:103]
    s_waitcnt lgkmcnt(8)
    v_mfma_f32_16x16x32_bf16 v[104:107], v[32:35], v[44:47], v[104:107]
    s_waitcnt lgkmcnt(7)
    v_mfma_f32_16x16x32_bf16 v[108:111], v[36:39], v[44:47], v[108:111]
    s_waitcnt lgkmcnt(6)
    v_mfma_f32_16x16x32_bf16 v[112:115], v[40:43], v[44:47], v[112:115]
    s_waitcnt lgkmcnt(0)
    s_barrier
    v_mfma_f32_16x16x32_bf16 v[116:119], v[28:31], v[48:51], v[116:119]
    ds_read_b64_tr_b16 v[44:45], v8 offset:49152
    v_mfma_f32_16x16x32_bf16 v[120:123], v[32:35], v[48:51], v[120:123]
    ds_read_b64_tr_b16 v[46:47], v8 offset:49664
    v_mfma_f32_16x16x32_bf16 v[124:127], v[36:39], v[48:51], v[124:127]
    ds_read_b128 v[12:15], v4 offset:40960
    v_mfma_f32_16x16x32_bf16 v[128:131], v[40:43], v[48:51], v[128:131]
    ds_read_b128 v[16:19], v4 offset:43008
    v_mfma_f32_16x16x32_bf16 v[132:135], v[28:31], v[52:55], v[132:135]
    ds_read_b128 v[20:23], v4 offset:45056
    v_mfma_f32_16x16x32_bf16 v[136:139], v[32:35], v[52:55], v[136:139]
    ds_read_b128 v[24:27], v4 offset:47104
    v_mfma_f32_16x16x32_bf16 v[140:143], v[36:39], v[52:55], v[140:143]
    ds_read_b64_tr_b16 v[48:49], v9 offset:49152
    v_mfma_f32_16x16x32_bf16 v[144:147], v[40:43], v[52:55], v[144:147]
    ds_read_b64_tr_b16 v[50:51], v9 offset:49664
    v_mfma_f32_16x16x32_bf16 v[148:151], v[28:31], v[56:59], v[148:151]
    ds_read_b64_tr_b16 v[52:53], v8 offset:57344
    v_mfma_f32_16x16x32_bf16 v[152:155], v[32:35], v[56:59], v[152:155]
    ds_read_b64_tr_b16 v[54:55], v8 offset:57856
    v_mfma_f32_16x16x32_bf16 v[156:159], v[36:39], v[56:59], v[156:159]
    v_mfma_f32_16x16x32_bf16 v[160:163], v[40:43], v[56:59], v[160:163]
    ds_read_b64_tr_b16 v[56:57], v9 offset:57344
    ds_read_b64_tr_b16 v[58:59], v9 offset:57856
    s_waitcnt lgkmcnt(9)
    v_mfma_f32_16x16x32_bf16 v[100:103], v[12:15], v[44:47], v[100:103]
    s_waitcnt lgkmcnt(8)
    v_mfma_f32_16x16x32_bf16 v[104:107], v[16:19], v[44:47], v[104:107]
    s_waitcnt lgkmcnt(7)
    v_mfma_f32_16x16x32_bf16 v[108:111], v[20:23], v[44:47], v[108:111]
    s_waitcnt lgkmcnt(6)
    v_mfma_f32_16x16x32_bf16 v[112:115], v[24:27], v[44:47], v[112:115]
    s_waitcnt lgkmcnt(4)
    v_mfma_f32_16x16x32_bf16 v[116:119], v[12:15], v[48:51], v[116:119]
    ds_read_b64_tr_b16 v[44:45], v8 offset:53248
    v_mfma_f32_16x16x32_bf16 v[120:123], v[16:19], v[48:51], v[120:123]
    ds_read_b64_tr_b16 v[46:47], v8 offset:53760
    v_mfma_f32_16x16x32_bf16 v[124:127], v[20:23], v[48:51], v[124:127]
    ds_read_b128 v[28:31], v5 offset:40960
    v_mfma_f32_16x16x32_bf16 v[128:131], v[24:27], v[48:51], v[128:131]
    ds_read_b128 v[32:35], v5 offset:43008
    s_waitcnt lgkmcnt(6)
    v_mfma_f32_16x16x32_bf16 v[132:135], v[12:15], v[52:55], v[132:135]
    ds_read_b128 v[36:39], v5 offset:45056
    v_mfma_f32_16x16x32_bf16 v[136:139], v[16:19], v[52:55], v[136:139]
    ds_read_b128 v[40:43], v5 offset:47104
    v_mfma_f32_16x16x32_bf16 v[140:143], v[20:23], v[52:55], v[140:143]
    ds_read_b64_tr_b16 v[48:49], v9 offset:53248
    v_mfma_f32_16x16x32_bf16 v[144:147], v[24:27], v[52:55], v[144:147]
    ds_read_b64_tr_b16 v[50:51], v9 offset:53760
    s_waitcnt lgkmcnt(8)
    v_mfma_f32_16x16x32_bf16 v[148:151], v[12:15], v[56:59], v[148:151]
    ds_read_b64_tr_b16 v[52:53], v8 offset:61440
    v_mfma_f32_16x16x32_bf16 v[152:155], v[16:19], v[56:59], v[152:155]
    ds_read_b64_tr_b16 v[54:55], v8 offset:61952
    v_mfma_f32_16x16x32_bf16 v[156:159], v[20:23], v[56:59], v[156:159]
    v_mfma_f32_16x16x32_bf16 v[160:163], v[24:27], v[56:59], v[160:163]
    ds_read_b64_tr_b16 v[56:57], v9 offset:61440
    ds_read_b64_tr_b16 v[58:59], v9 offset:61952
    s_waitcnt lgkmcnt(9)
    v_mfma_f32_16x16x32_bf16 v[100:103], v[28:31], v[44:47], v[100:103]
    s_waitcnt lgkmcnt(8)
    v_mfma_f32_16x16x32_bf16 v[104:107], v[32:35], v[44:47], v[104:107]
    s_waitcnt lgkmcnt(7)
    v_mfma_f32_16x16x32_bf16 v[108:111], v[36:39], v[44:47], v[108:111]
    s_waitcnt lgkmcnt(6)
    v_mfma_f32_16x16x32_bf16 v[112:115], v[40:43], v[44:47], v[112:115]
    s_waitcnt lgkmcnt(0)
    s_barrier
    v_mfma_f32_16x16x32_bf16 v[116:119], v[28:31], v[48:51], v[116:119]
    ds_read_b64_tr_b16 v[44:45], v10 offset:8192
    v_mfma_f32_16x16x32_bf16 v[120:123], v[32:35], v[48:51], v[120:123]
    ds_read_b64_tr_b16 v[46:47], v10 offset:8704
    v_mfma_f32_16x16x32_bf16 v[124:127], v[36:39], v[48:51], v[124:127]
    ds_read_b128 v[12:15], v6 offset:0
    v_mfma_f32_16x16x32_bf16 v[128:131], v[40:43], v[48:51], v[128:131]
    ds_read_b128 v[16:19], v6 offset:2048
    v_mfma_f32_16x16x32_bf16 v[132:135], v[28:31], v[52:55], v[132:135]
    ds_read_b128 v[20:23], v6 offset:4096
    v_mfma_f32_16x16x32_bf16 v[136:139], v[32:35], v[52:55], v[136:139]
    ds_read_b128 v[24:27], v6 offset:6144
    v_mfma_f32_16x16x32_bf16 v[140:143], v[36:39], v[52:55], v[140:143]
    ds_read_b64_tr_b16 v[48:49], v11 offset:8192
    v_mfma_f32_16x16x32_bf16 v[144:147], v[40:43], v[52:55], v[144:147]
    ds_read_b64_tr_b16 v[50:51], v11 offset:8704
    v_mfma_f32_16x16x32_bf16 v[148:151], v[28:31], v[56:59], v[148:151]
    ds_read_b64_tr_b16 v[52:53], v10 offset:16384
    v_mfma_f32_16x16x32_bf16 v[152:155], v[32:35], v[56:59], v[152:155]
    ds_read_b64_tr_b16 v[54:55], v10 offset:16896
    v_mfma_f32_16x16x32_bf16 v[156:159], v[36:39], v[56:59], v[156:159]
    v_mfma_f32_16x16x32_bf16 v[160:163], v[40:43], v[56:59], v[160:163]
    ds_read_b64_tr_b16 v[56:57], v11 offset:16384
    ds_read_b64_tr_b16 v[58:59], v11 offset:16896
    s_waitcnt lgkmcnt(9)
    v_mfma_f32_16x16x32_bf16 v[100:103], v[12:15], v[44:47], v[100:103]
    s_waitcnt lgkmcnt(8)
    v_mfma_f32_16x16x32_bf16 v[104:107], v[16:19], v[44:47], v[104:107]
    s_waitcnt lgkmcnt(7)
    v_mfma_f32_16x16x32_bf16 v[108:111], v[20:23], v[44:47], v[108:111]
    s_waitcnt lgkmcnt(6)
    v_mfma_f32_16x16x32_bf16 v[112:115], v[24:27], v[44:47], v[112:115]
    s_waitcnt lgkmcnt(4)
    v_mfma_f32_16x16x32_bf16 v[116:119], v[12:15], v[48:51], v[116:119]
    ds_read_b64_tr_b16 v[44:45], v10 offset:12288
    v_mfma_f32_16x16x32_bf16 v[120:123], v[16:19], v[48:51], v[120:123]
    ds_read_b64_tr_b16 v[46:47], v10 offset:12800
    v_mfma_f32_16x16x32_bf16 v[124:127], v[20:23], v[48:51], v[124:127]
    ds_read_b128 v[28:31], v7 offset:0
    v_mfma_f32_16x16x32_bf16 v[128:131], v[24:27], v[48:51], v[128:131]
    ds_read_b128 v[32:35], v7 offset:2048
    s_waitcnt lgkmcnt(6)
    v_mfma_f32_16x16x32_bf16 v[132:135], v[12:15], v[52:55], v[132:135]
    ds_read_b128 v[36:39], v7 offset:4096
    v_mfma_f32_16x16x32_bf16 v[136:139], v[16:19], v[52:55], v[136:139]
    ds_read_b128 v[40:43], v7 offset:6144
    v_mfma_f32_16x16x32_bf16 v[140:143], v[20:23], v[52:55], v[140:143]
    ds_read_b64_tr_b16 v[48:49], v11 offset:12288
    v_mfma_f32_16x16x32_bf16 v[144:147], v[24:27], v[52:55], v[144:147]
    ds_read_b64_tr_b16 v[50:51], v11 offset:12800
    s_waitcnt lgkmcnt(8)
    v_mfma_f32_16x16x32_bf16 v[148:151], v[12:15], v[56:59], v[148:151]
    ds_read_b64_tr_b16 v[52:53], v10 offset:20480
    v_mfma_f32_16x16x32_bf16 v[152:155], v[16:19], v[56:59], v[152:155]
    ds_read_b64_tr_b16 v[54:55], v10 offset:20992
    v_mfma_f32_16x16x32_bf16 v[156:159], v[20:23], v[56:59], v[156:159]
    v_mfma_f32_16x16x32_bf16 v[160:163], v[24:27], v[56:59], v[160:163]
    ds_read_b64_tr_b16 v[56:57], v11 offset:20480
    ds_read_b64_tr_b16 v[58:59], v11 offset:20992
    s_waitcnt lgkmcnt(9)
    v_mfma_f32_16x16x32_bf16 v[100:103], v[28:31], v[44:47], v[100:103]
    s_waitcnt lgkmcnt(8)
    v_mfma_f32_16x16x32_bf16 v[104:107], v[32:35], v[44:47], v[104:107]
    s_waitcnt lgkmcnt(7)
    v_mfma_f32_16x16x32_bf16 v[108:111], v[36:39], v[44:47], v[108:111]
    s_waitcnt lgkmcnt(6)
    v_mfma_f32_16x16x32_bf16 v[112:115], v[40:43], v[44:47], v[112:115]
    s_waitcnt lgkmcnt(0)
    s_barrier
    v_mfma_f32_16x16x32_bf16 v[116:119], v[28:31], v[48:51], v[116:119]
    ds_read_b64_tr_b16 v[44:45], v10 offset:49152
    v_mfma_f32_16x16x32_bf16 v[120:123], v[32:35], v[48:51], v[120:123]
    ds_read_b64_tr_b16 v[46:47], v10 offset:49664
    v_mfma_f32_16x16x32_bf16 v[124:127], v[36:39], v[48:51], v[124:127]
    ds_read_b128 v[12:15], v6 offset:40960
    v_mfma_f32_16x16x32_bf16 v[128:131], v[40:43], v[48:51], v[128:131]
    ds_read_b128 v[16:19], v6 offset:43008
    v_mfma_f32_16x16x32_bf16 v[132:135], v[28:31], v[52:55], v[132:135]
    ds_read_b128 v[20:23], v6 offset:45056
    v_mfma_f32_16x16x32_bf16 v[136:139], v[32:35], v[52:55], v[136:139]
    ds_read_b128 v[24:27], v6 offset:47104
    v_mfma_f32_16x16x32_bf16 v[140:143], v[36:39], v[52:55], v[140:143]
    ds_read_b64_tr_b16 v[48:49], v11 offset:49152
    v_mfma_f32_16x16x32_bf16 v[144:147], v[40:43], v[52:55], v[144:147]
    ds_read_b64_tr_b16 v[50:51], v11 offset:49664
    v_mfma_f32_16x16x32_bf16 v[148:151], v[28:31], v[56:59], v[148:151]
    ds_read_b64_tr_b16 v[52:53], v10 offset:57344
    v_mfma_f32_16x16x32_bf16 v[152:155], v[32:35], v[56:59], v[152:155]
    ds_read_b64_tr_b16 v[54:55], v10 offset:57856
    v_mfma_f32_16x16x32_bf16 v[156:159], v[36:39], v[56:59], v[156:159]
    v_mfma_f32_16x16x32_bf16 v[160:163], v[40:43], v[56:59], v[160:163]
    ds_read_b64_tr_b16 v[56:57], v11 offset:57344
    ds_read_b64_tr_b16 v[58:59], v11 offset:57856
    s_waitcnt lgkmcnt(9)
    v_mfma_f32_16x16x32_bf16 v[100:103], v[12:15], v[44:47], v[100:103]
    s_waitcnt lgkmcnt(8)
    v_mfma_f32_16x16x32_bf16 v[104:107], v[16:19], v[44:47], v[104:107]
    s_waitcnt lgkmcnt(7)
    v_mfma_f32_16x16x32_bf16 v[108:111], v[20:23], v[44:47], v[108:111]
    s_waitcnt lgkmcnt(6)
    v_mfma_f32_16x16x32_bf16 v[112:115], v[24:27], v[44:47], v[112:115]
    s_waitcnt lgkmcnt(4)
    v_mfma_f32_16x16x32_bf16 v[116:119], v[12:15], v[48:51], v[116:119]
    ds_read_b64_tr_b16 v[44:45], v10 offset:53248
    v_mfma_f32_16x16x32_bf16 v[120:123], v[16:19], v[48:51], v[120:123]
    ds_read_b64_tr_b16 v[46:47], v10 offset:53760
    v_mfma_f32_16x16x32_bf16 v[124:127], v[20:23], v[48:51], v[124:127]
    ds_read_b128 v[28:31], v7 offset:40960
    v_mfma_f32_16x16x32_bf16 v[128:131], v[24:27], v[48:51], v[128:131]
    ds_read_b128 v[32:35], v7 offset:43008
    s_waitcnt lgkmcnt(6)
    v_mfma_f32_16x16x32_bf16 v[132:135], v[12:15], v[52:55], v[132:135]
    ds_read_b128 v[36:39], v7 offset:45056
    v_mfma_f32_16x16x32_bf16 v[136:139], v[16:19], v[52:55], v[136:139]
    ds_read_b128 v[40:43], v7 offset:47104
    v_mfma_f32_16x16x32_bf16 v[140:143], v[20:23], v[52:55], v[140:143]
    ds_read_b64_tr_b16 v[48:49], v11 offset:53248
    v_mfma_f32_16x16x32_bf16 v[144:147], v[24:27], v[52:55], v[144:147]
    ds_read_b64_tr_b16 v[50:51], v11 offset:53760
    s_waitcnt lgkmcnt(8)
    v_mfma_f32_16x16x32_bf16 v[148:151], v[12:15], v[56:59], v[148:151]
    ds_read_b64_tr_b16 v[52:53], v10 offset:61440
    v_mfma_f32_16x16x32_bf16 v[152:155], v[16:19], v[56:59], v[152:155]
    ds_read_b64_tr_b16 v[54:55], v10 offset:61952
    v_mfma_f32_16x16x32_bf16 v[156:159], v[20:23], v[56:59], v[156:159]
    v_mfma_f32_16x16x32_bf16 v[160:163], v[24:27], v[56:59], v[160:163]
    ds_read_b64_tr_b16 v[56:57], v11 offset:61440
    ds_read_b64_tr_b16 v[58:59], v11 offset:61952
    s_waitcnt lgkmcnt(9)
    v_mfma_f32_16x16x32_bf16 v[100:103], v[28:31], v[44:47], v[100:103]
    ds_read_b128 v[12:15], v164 offset:0
    s_waitcnt lgkmcnt(9)
    v_mfma_f32_16x16x32_bf16 v[104:107], v[32:35], v[44:47], v[104:107]
    ds_read_b128 v[16:19], v164 offset:64
    s_waitcnt lgkmcnt(9)
    v_mfma_f32_16x16x32_bf16 v[108:111], v[36:39], v[44:47], v[108:111]
    ds_read_b128 v[20:23], v164 offset:512
    s_waitcnt lgkmcnt(9)
    v_mfma_f32_16x16x32_bf16 v[112:115], v[40:43], v[44:47], v[112:115]
    ds_read_b128 v[24:27], v164 offset:576
    s_waitcnt lgkmcnt(8)
    v_mfma_f32_16x16x32_bf16 v[116:119], v[28:31], v[48:51], v[116:119]
    ds_read_b128 v[60:63], v164 offset:1024
    v_mfma_f32_16x16x32_bf16 v[120:123], v[32:35], v[48:51], v[120:123]
    ds_read_b128 v[64:67], v164 offset:1088
    v_mfma_f32_16x16x32_bf16 v[124:127], v[36:39], v[48:51], v[124:127]
    ds_read2_b32 v[44:45], v165 offset0:64 offset1:64
    v_mfma_f32_16x16x32_bf16 v[128:131], v[40:43], v[48:51], v[128:131]
    ds_read2_b32 v[46:47], v165 offset0:80 offset1:80
    s_waitcnt lgkmcnt(10)
    v_mfma_f32_16x16x32_bf16 v[132:135], v[28:31], v[52:55], v[132:135]
    ds_read2_b32 v[48:49], v165 offset0:128 offset1:128
    v_mfma_f32_16x16x32_bf16 v[136:139], v[32:35], v[52:55], v[136:139]
    ds_read2_b32 v[50:51], v165 offset0:144 offset1:144
    v_mfma_f32_16x16x32_bf16 v[140:143], v[36:39], v[52:55], v[140:143]
    v_mfma_f32_16x16x32_bf16 v[144:147], v[40:43], v[52:55], v[144:147]
    s_waitcnt lgkmcnt(10)
    v_mfma_f32_16x16x32_bf16 v[148:151], v[28:31], v[56:59], v[148:151]
    v_mfma_f32_16x16x32_bf16 v[152:155], v[32:35], v[56:59], v[152:155]
    v_mfma_f32_16x16x32_bf16 v[156:159], v[36:39], v[56:59], v[156:159]
    v_mfma_f32_16x16x32_bf16 v[160:163], v[40:43], v[56:59], v[160:163]
    ds_read_b128 v[36:39], v164 offset:128
    ds_read_b128 v[40:43], v164 offset:192
    ds_read_b128 v[52:55], v164 offset:640
    ds_read_b128 v[56:59], v164 offset:704
    s_waitcnt lgkmcnt(7)
    v_pk_fma_f32 v[100:101], v[12:13], v[44:45], v[100:101]
    v_pk_fma_f32 v[102:103], v[14:15], v[44:45], v[102:103]
    v_pk_fma_f32 v[104:105], v[16:17], v[44:45], v[104:105]
    v_pk_fma_f32 v[106:107], v[18:19], v[44:45], v[106:107]
    v_pk_mul_f32 v[28:29], v[100:101], v[60:61]
    v_pk_mul_f32 v[30:31], v[102:103], v[62:63]
    v_pk_mul_f32 v[32:33], v[104:105], v[64:65]
    v_pk_mul_f32 v[34:35], v[106:107], v[66:67]
    v_pk_fma_f32 v[100:101], v[100:101], v[20:21], s[40:41]
    v_pk_fma_f32 v[102:103], v[102:103], v[22:23], s[40:41]
    v_pk_fma_f32 v[104:105], v[104:105], v[24:25], s[40:41]
    v_pk_fma_f32 v[106:107], v[106:107], v[26:27], s[40:41]
    v_exp_f32 v28, v28 clamp
    v_exp_f32 v29, v29 clamp
    v_exp_f32 v30, v30 clamp
    v_exp_f32 v31, v31 clamp
    v_exp_f32 v32, v32 clamp
    v_exp_f32 v33, v33 clamp
    v_exp_f32 v34, v34 clamp
    v_exp_f32 v35, v35 clamp
    v_pk_add_f32 v[28:29], v[28:29], s[74:75]
    v_pk_add_f32 v[30:31], v[30:31], s[74:75]
    v_pk_add_f32 v[32:33], v[32:33], s[74:75]
    v_pk_add_f32 v[34:35], v[34:35], s[74:75]
    v_max_f32 v100, v100, v28
    v_max_f32 v101, v101, v29
    v_max_f32 v102, v102, v30
    v_max_f32 v103, v103, v31
    v_max_f32 v104, v104, v32
    v_max_f32 v105, v105, v33
    v_max_f32 v106, v106, v34
    v_max_f32_e64 v107, v107, v35
    v_cvt_pk_bf16_f32 v100, v100, v101
    v_cvt_pk_bf16_f32 v101, v102, v103
    v_cvt_pk_bf16_f32 v102, v104, v105
    v_cvt_pk_bf16_f32 v103, v106, v107
    s_waitcnt lgkmcnt(6)
    v_pk_fma_f32 v[116:117], v[12:13], v[46:47], v[116:117]
    v_pk_fma_f32 v[118:119], v[14:15], v[46:47], v[118:119]
    v_pk_fma_f32 v[120:121], v[16:17], v[46:47], v[120:121]
    v_pk_fma_f32 v[122:123], v[18:19], v[46:47], v[122:123]
    v_pk_mul_f32 v[28:29], v[116:117], v[60:61]
    v_pk_mul_f32 v[30:31], v[118:119], v[62:63]
    v_pk_mul_f32 v[32:33], v[120:121], v[64:65]
    v_pk_mul_f32 v[34:35], v[122:123], v[66:67]
    v_pk_fma_f32 v[116:117], v[116:117], v[20:21], s[40:41]
    v_pk_fma_f32 v[118:119], v[118:119], v[22:23], s[40:41]
    v_pk_fma_f32 v[120:121], v[120:121], v[24:25], s[40:41]
    v_pk_fma_f32 v[122:123], v[122:123], v[26:27], s[40:41]
    ds_read_b128 v[60:63], v164 offset:1152
    ds_read_b128 v[64:67], v164 offset:1216
    v_exp_f32 v28, v28 clamp
    v_exp_f32 v29, v29 clamp
    v_exp_f32 v30, v30 clamp
    v_exp_f32 v31, v31 clamp
    v_exp_f32 v32, v32 clamp
    v_exp_f32 v33, v33 clamp
    v_exp_f32 v34, v34 clamp
    v_exp_f32 v35, v35 clamp
    v_pk_add_f32 v[28:29], v[28:29], s[74:75]
    v_pk_add_f32 v[30:31], v[30:31], s[74:75]
    v_pk_add_f32 v[32:33], v[32:33], s[74:75]
    v_pk_add_f32 v[34:35], v[34:35], s[74:75]
    v_max_f32 v116, v116, v28
    v_max_f32 v117, v117, v29
    v_max_f32 v118, v118, v30
    v_max_f32 v119, v119, v31
    v_max_f32 v120, v120, v32
    v_max_f32 v121, v121, v33
    v_max_f32 v122, v122, v34
    v_max_f32_e64 v123, v123, v35
    v_cvt_pk_bf16_f32 v116, v116, v117
    v_cvt_pk_bf16_f32 v117, v118, v119
    v_cvt_pk_bf16_f32 v118, v120, v121
    v_cvt_pk_bf16_f32 v119, v122, v123
    s_waitcnt lgkmcnt(7)
    v_pk_fma_f32 v[132:133], v[12:13], v[48:49], v[132:133]
    v_pk_fma_f32 v[134:135], v[14:15], v[48:49], v[134:135]
    v_pk_fma_f32 v[136:137], v[16:17], v[48:49], v[136:137]
    v_pk_fma_f32 v[138:139], v[18:19], v[48:49], v[138:139]
    v_pk_mul_f32 v[132:133], v[132:133], v[20:21]
    v_pk_mul_f32 v[134:135], v[134:135], v[22:23]
    v_pk_mul_f32 v[136:137], v[136:137], v[24:25]
    v_pk_mul_f32 v[138:139], v[138:139], v[26:27]
    v_cvt_pk_bf16_f32 v132, v132, v133
    v_cvt_pk_bf16_f32 v133, v134, v135
    v_cvt_pk_bf16_f32 v134, v136, v137
    v_cvt_pk_bf16_f32 v135, v138, v139
    s_waitcnt lgkmcnt(6)
    s_nop 0
    v_pk_fma_f32 v[148:149], v[12:13], v[50:51], v[148:149]
    v_pk_fma_f32 v[150:151], v[14:15], v[50:51], v[150:151]
    v_pk_fma_f32 v[152:153], v[16:17], v[50:51], v[152:153]
    v_pk_fma_f32 v[154:155], v[18:19], v[50:51], v[154:155]
    v_pk_mul_f32 v[148:149], v[148:149], v[20:21]
    v_pk_mul_f32 v[150:151], v[150:151], v[22:23]
    v_pk_mul_f32 v[152:153], v[152:153], v[24:25]
    v_pk_mul_f32 v[154:155], v[154:155], v[26:27]
    v_cvt_pk_bf16_f32 v148, v148, v149
    v_cvt_pk_bf16_f32 v149, v150, v151
    v_cvt_pk_bf16_f32 v150, v152, v153
    v_cvt_pk_bf16_f32 v151, v154, v155
    v_mov_b32 v12, 0x3f803f80
    v_mov_b32 v13, 0x3f803f80
    v_mov_b32 v14, 0x3f803f80
    v_mov_b32 v15, 0x3f803f80
    s_waitcnt lgkmcnt(5)
    v_pk_fma_f32 v[140:141], v[36:37], v[48:49], v[140:141]
    v_pk_fma_f32 v[142:143], v[38:39], v[48:49], v[142:143]
    s_waitcnt lgkmcnt(4)
    v_pk_fma_f32 v[144:145], v[40:41], v[48:49], v[144:145]
    v_pk_fma_f32 v[146:147], v[42:43], v[48:49], v[146:147]
    s_waitcnt lgkmcnt(3)
    v_pk_mul_f32 v[140:141], v[140:141], v[52:53]
    v_pk_mul_f32 v[142:143], v[142:143], v[54:55]
    s_waitcnt lgkmcnt(2)
    v_pk_mul_f32 v[144:145], v[144:145], v[56:57]
    v_pk_mul_f32 v[146:147], v[146:147], v[58:59]
    v_cvt_pk_bf16_f32 v140, v140, v141
    v_cvt_pk_bf16_f32 v141, v142, v143
    v_cvt_pk_bf16_f32 v142, v144, v145
    v_cvt_pk_bf16_f32 v143, v146, v147
    v_pk_fma_f32 v[156:157], v[36:37], v[50:51], v[156:157]
    v_pk_fma_f32 v[158:159], v[38:39], v[50:51], v[158:159]
    v_pk_fma_f32 v[160:161], v[40:41], v[50:51], v[160:161]
    v_pk_fma_f32 v[162:163], v[42:43], v[50:51], v[162:163]
    v_pk_mul_f32 v[156:157], v[156:157], v[52:53]
    v_pk_mul_f32 v[158:159], v[158:159], v[54:55]
    v_pk_mul_f32 v[160:161], v[160:161], v[56:57]
    v_pk_mul_f32 v[162:163], v[162:163], v[58:59]
    v_cvt_pk_bf16_f32 v156, v156, v157
    v_cvt_pk_bf16_f32 v157, v158, v159
    v_cvt_pk_bf16_f32 v158, v160, v161
    v_cvt_pk_bf16_f32 v159, v162, v163
    v_pk_fma_f32 v[108:109], v[36:37], v[44:45], v[108:109]
    v_pk_fma_f32 v[110:111], v[38:39], v[44:45], v[110:111]
    v_pk_fma_f32 v[112:113], v[40:41], v[44:45], v[112:113]
    v_pk_fma_f32 v[114:115], v[42:43], v[44:45], v[114:115]
    s_waitcnt lgkmcnt(1)
    v_pk_mul_f32 v[28:29], v[108:109], v[60:61]
    v_pk_mul_f32 v[30:31], v[110:111], v[62:63]
    s_waitcnt lgkmcnt(0)
    v_pk_mul_f32 v[32:33], v[112:113], v[64:65]
    v_pk_mul_f32 v[34:35], v[114:115], v[66:67]
    v_pk_fma_f32 v[108:109], v[108:109], v[52:53], s[40:41]
    v_pk_fma_f32 v[110:111], v[110:111], v[54:55], s[40:41]
    v_pk_fma_f32 v[112:113], v[112:113], v[56:57], s[40:41]
    v_pk_fma_f32 v[114:115], v[114:115], v[58:59], s[40:41]
    v_mfma_f32_16x16x32_bf16 v[104:107], v[100:103], v[132:135], 0
    v_exp_f32 v28, v28 clamp
    v_mfma_f32_16x16x32_bf16 v[136:139], v[100:103], v[148:151], 0
    v_exp_f32 v29, v29 clamp
    v_mfma_f32_16x16x32_bf16 v[120:123], v[116:119], v[132:135], 0
    v_exp_f32 v30, v30 clamp
    v_mfma_f32_16x16x32_bf16 v[152:155], v[116:119], v[148:151], 0
    v_exp_f32 v31, v31 clamp
    v_mfma_f32_16x16x32_bf16 v[144:147], v[100:103], v[12:15], 0
    v_exp_f32 v32, v32 clamp
    v_mfma_f32_16x16x32_bf16 v[160:163], v[116:119], v[12:15], 0
    v_exp_f32 v33, v33 clamp
    v_exp_f32 v34, v34 clamp
    v_exp_f32 v35, v35 clamp
    v_pk_add_f32 v[28:29], v[28:29], s[74:75]
    v_pk_add_f32 v[30:31], v[30:31], s[74:75]
    v_pk_add_f32 v[32:33], v[32:33], s[74:75]
    v_pk_add_f32 v[34:35], v[34:35], s[74:75]
    v_max_f32 v108, v108, v28
    v_max_f32 v109, v109, v29
    v_max_f32 v110, v110, v30
    v_max_f32 v111, v111, v31
    v_max_f32 v112, v112, v32
    v_max_f32 v113, v113, v33
    v_max_f32 v114, v114, v34
    v_max_f32 v115, v115, v35
    v_cvt_pk_bf16_f32 v108, v108, v109
    v_cvt_pk_bf16_f32 v109, v110, v111
    v_cvt_pk_bf16_f32 v110, v112, v113
    v_cvt_pk_bf16_f32 v111, v114, v115
    v_pk_fma_f32 v[124:125], v[36:37], v[46:47], v[124:125]
    v_pk_fma_f32 v[126:127], v[38:39], v[46:47], v[126:127]
    v_pk_fma_f32 v[128:129], v[40:41], v[46:47], v[128:129]
    v_pk_fma_f32 v[130:131], v[42:43], v[46:47], v[130:131]
    v_pk_mul_f32 v[28:29], v[124:125], v[60:61]
    v_pk_mul_f32 v[30:31], v[126:127], v[62:63]
    v_pk_mul_f32 v[32:33], v[128:129], v[64:65]
    v_pk_mul_f32 v[34:35], v[130:131], v[66:67]
    v_pk_fma_f32 v[124:125], v[124:125], v[52:53], s[40:41]
    v_pk_fma_f32 v[126:127], v[126:127], v[54:55], s[40:41]
    v_pk_fma_f32 v[128:129], v[128:129], v[56:57], s[40:41]
    v_pk_fma_f32 v[130:131], v[130:131], v[58:59], s[40:41]
    v_mfma_f32_16x16x32_bf16 v[104:107], v[108:111], v[140:143], v[104:107]
    v_exp_f32 v28, v28 clamp
    v_mfma_f32_16x16x32_bf16 v[136:139], v[108:111], v[156:159], v[136:139]
    v_exp_f32 v29, v29 clamp
    v_mfma_f32_16x16x32_bf16 v[144:147], v[108:111], v[12:15], v[144:147]
    v_exp_f32 v30, v30 clamp
    v_exp_f32 v31, v31 clamp
    v_exp_f32 v32, v32 clamp
    v_exp_f32 v33, v33 clamp
    v_exp_f32 v34, v34 clamp
    v_exp_f32 v35, v35 clamp
    v_pk_add_f32 v[28:29], v[28:29], s[74:75]
    v_pk_add_f32 v[30:31], v[30:31], s[74:75]
    v_pk_add_f32 v[32:33], v[32:33], s[74:75]
    v_pk_add_f32 v[34:35], v[34:35], s[74:75]
    v_max_f32 v124, v124, v28
    v_max_f32 v125, v125, v29
    v_max_f32 v126, v126, v30
    v_max_f32 v127, v127, v31
    v_max_f32 v128, v128, v32
    v_max_f32 v129, v129, v33
    v_max_f32 v130, v130, v34
    v_max_f32 v131, v131, v35
    v_cvt_pk_bf16_f32 v124, v124, v125
    v_cvt_pk_bf16_f32 v125, v126, v127
    v_cvt_pk_bf16_f32 v126, v128, v129
    v_cvt_pk_bf16_f32 v127, v130, v131
    s_nop 1
    v_mfma_f32_16x16x32_bf16 v[120:123], v[124:127], v[140:143], v[120:123]
    v_mfma_f32_16x16x32_bf16 v[152:155], v[124:127], v[156:159], v[152:155]
    v_mfma_f32_16x16x32_bf16 v[160:163], v[124:127], v[12:15], v[160:163]
    ds_write_b128 v1, v[104:107]
    ds_write_b128 v1, v[136:139] offset:2048
    v_mov_b32_e64 v16, 1
    s_nop 2
    ds_write_b128 v1, v[120:123] offset:1024
    ds_write_b128 v1, v[152:155] offset:3072
    s_mov_b32 exec_lo, 0x10001
    s_mov_b32 exec_hi, 0x10001
    ds_write_b128 v2, v[144:147]
    ds_write_b128 v2, v[160:163] offset:64
    s_mov_b64 exec, 1
    ds_write_b32 v3, v16
    s_mov_b64 exec, -1
    ds_read_b128 v[28:31], v4 offset:0
    ds_read_b64_tr_b16 v[44:45], v8 offset:0
    ds_read_b64_tr_b16 v[46:47], v8 offset:512
    ds_read_b128 v[32:35], v4 offset:2048
    ds_read_b128 v[36:39], v4 offset:4096
    ds_read_b128 v[40:43], v4 offset:6144
    ds_read_b64_tr_b16 v[48:49], v9 offset:0
    ds_read_b64_tr_b16 v[50:51], v9 offset:512
    s_setprio 0
    v_and_b32 v132, 15, v0
    s_lshl_b32 s44, s36, 8
    s_add_u32 s44, s44, 24832
    v_lshl_add_u32 v132, v132, 2, s44
    v_add_u32 v133, 1024, v132
    s_lshl_b32 s44, s37, 7
    s_add_u32 s44, s44, 26368
    v_and_or_b32 v134, v0, 48, s44
    s_lshl_b32 s44, s35, 2
    s_and_b32 s47, s3, 2
    s_add_u32 s44, s44, s47
    s_lshr_b32 s44, 0xeee7eece, s44
    s_and_b32 s44, s44, 3
    s_mul_i32 s44, s44, 40960
    s_and_b32 s47, s28, 1
    s_lshl_b32 s47, s47, 13
    s_add_u32 s44, s44, s47
    s_lshl_b32 s47, s37, 6
    v_and_b32 v140, 0x30, v167
    v_xor_b32 v140, s47, v140
    v_and_b32 v141, 14, v0
    v_lshlrev_b32 v141, 3, v141
    v_xor_b32 v140, v140, v141
    v_and_b32 v141, 15, v0
    v_lshlrev_b32 v141, 7, v141
    v_add3_u32 v140, v140, v141, s44

    s_waitcnt lgkmcnt(5)
    v_mfma_f32_16x16x32_bf16 v[68:71], v[44:47], v[28:31], v[68:71]
    ds_read_b128 v[12:15], v5 offset:0
    ds_read_b64_tr_b16 v[52:53], v8 offset:4096
    s_waitcnt lgkmcnt(6)
    v_mfma_f32_16x16x32_bf16 v[72:75], v[44:47], v[32:35], v[72:75]
    ds_read_b64_tr_b16 v[54:55], v8 offset:4608
    ds_read_b128 v[16:19], v5 offset:2048
    s_waitcnt lgkmcnt(7)
    v_mfma_f32_16x16x32_bf16 v[76:79], v[44:47], v[36:39], v[76:79]
    ds_read_b128 v[20:23], v5 offset:4096
    ds_read_b128 v[24:27], v5 offset:6144
    s_waitcnt lgkmcnt(8)
    v_mfma_f32_16x16x32_bf16 v[80:83], v[44:47], v[40:43], v[80:83]
    ds_read_b64_tr_b16 v[56:57], v9 offset:4096
    ds_read_b64_tr_b16 v[58:59], v9 offset:4608
    s_waitcnt lgkmcnt(8)
    v_mfma_f32_16x16x32_bf16 v[84:87], v[48:51], v[28:31], v[84:87]
    v_mfma_f32_16x16x32_bf16 v[88:91], v[48:51], v[32:35], v[88:91]
    v_mfma_f32_16x16x32_bf16 v[92:95], v[48:51], v[36:39], v[92:95]
    v_mfma_f32_16x16x32_bf16 v[96:99], v[48:51], v[40:43], v[96:99]
    s_waitcnt lgkmcnt(5)
    v_mfma_f32_16x16x32_bf16 v[68:71], v[52:55], v[12:15], v[68:71]
    ds_read_b128 v[28:31], v4 offset:40960
    ds_read_b64_tr_b16 v[44:45], v8 offset:40960
    s_waitcnt lgkmcnt(6)
    v_mfma_f32_16x16x32_bf16 v[72:75], v[52:55], v[16:19], v[72:75]
    ds_read_b64_tr_b16 v[46:47], v8 offset:41472
    ds_read_b128 v[32:35], v4 offset:43008
    s_waitcnt lgkmcnt(7)
    v_mfma_f32_16x16x32_bf16 v[76:79], v[52:55], v[20:23], v[76:79]
    ds_read_b128 v[36:39], v4 offset:45056
    ds_read_b128 v[40:43], v4 offset:47104
    s_waitcnt lgkmcnt(8)
    v_mfma_f32_16x16x32_bf16 v[80:83], v[52:55], v[24:27], v[80:83]
    ds_read_b64_tr_b16 v[48:49], v9 offset:40960
    ds_read_b64_tr_b16 v[50:51], v9 offset:41472
    s_waitcnt lgkmcnt(8)
    v_mfma_f32_16x16x32_bf16 v[84:87], v[56:59], v[12:15], v[84:87]
    v_mfma_f32_16x16x32_bf16 v[88:91], v[56:59], v[16:19], v[88:91]
    v_mfma_f32_16x16x32_bf16 v[92:95], v[56:59], v[20:23], v[92:95]
    v_mfma_f32_16x16x32_bf16 v[96:99], v[56:59], v[24:27], v[96:99]
    s_waitcnt lgkmcnt(5)
    v_mfma_f32_16x16x32_bf16 v[68:71], v[44:47], v[28:31], v[68:71]
    ds_read_b128 v[12:15], v5 offset:40960
    ds_read_b64_tr_b16 v[52:53], v8 offset:45056
    s_waitcnt lgkmcnt(6)
    v_mfma_f32_16x16x32_bf16 v[72:75], v[44:47], v[32:35], v[72:75]
    ds_read_b64_tr_b16 v[54:55], v8 offset:45568
    ds_read_b128 v[16:19], v5 offset:43008
    s_waitcnt lgkmcnt(7)
    v_mfma_f32_16x16x32_bf16 v[76:79], v[44:47], v[36:39], v[76:79]
    ds_read_b128 v[20:23], v5 offset:45056
    ds_read_b128 v[24:27], v5 offset:47104
    s_waitcnt lgkmcnt(8)
    v_mfma_f32_16x16x32_bf16 v[80:83], v[44:47], v[40:43], v[80:83]
    ds_read_b64_tr_b16 v[56:57], v9 offset:45056
    ds_read_b64_tr_b16 v[58:59], v9 offset:45568
    s_waitcnt lgkmcnt(8)
    v_mfma_f32_16x16x32_bf16 v[84:87], v[48:51], v[28:31], v[84:87]
    ds_read_b128 v[148:151], v140 offset:0
    ds_read_b128 v[152:155], v140 offset:2048
    v_mfma_f32_16x16x32_bf16 v[88:91], v[48:51], v[32:35], v[88:91]
    ds_read_b128 v[156:159], v140 offset:4096
    ds_read_b128 v[160:163], v140 offset:6144
    v_mfma_f32_16x16x32_bf16 v[92:95], v[48:51], v[36:39], v[92:95]
    v_mfma_f32_16x16x32_bf16 v[96:99], v[48:51], v[40:43], v[96:99]
    s_waitcnt lgkmcnt(9)
    v_mfma_f32_16x16x32_bf16 v[68:71], v[52:55], v[12:15], v[68:71]
    ds_read_b128 v[28:31], v6 offset:0
    ds_read_b64_tr_b16 v[44:45], v10 offset:0
    s_waitcnt lgkmcnt(10)
    v_mfma_f32_16x16x32_bf16 v[72:75], v[52:55], v[16:19], v[72:75]
    ds_read_b64_tr_b16 v[46:47], v10 offset:512
    ds_read_b128 v[32:35], v6 offset:2048
    s_waitcnt lgkmcnt(11)
    v_mfma_f32_16x16x32_bf16 v[76:79], v[52:55], v[20:23], v[76:79]
    ds_read_b128 v[36:39], v6 offset:4096
    ds_read_b128 v[40:43], v6 offset:6144
    s_waitcnt lgkmcnt(12)
    v_mfma_f32_16x16x32_bf16 v[80:83], v[52:55], v[24:27], v[80:83]
    ds_read_b64_tr_b16 v[48:49], v11 offset:0
    ds_read_b64_tr_b16 v[50:51], v11 offset:512
    s_waitcnt lgkmcnt(12)
    v_mfma_f32_16x16x32_bf16 v[84:87], v[56:59], v[12:15], v[84:87]
    v_mfma_f32_16x16x32_bf16 v[88:91], v[56:59], v[16:19], v[88:91]
    v_mfma_f32_16x16x32_bf16 v[92:95], v[56:59], v[20:23], v[92:95]
    v_mfma_f32_16x16x32_bf16 v[96:99], v[56:59], v[24:27], v[96:99]
    s_waitcnt lgkmcnt(5)
    v_mfma_f32_16x16x32_bf16 v[68:71], v[44:47], v[28:31], v[68:71]
    ds_read_b128 v[12:15], v7 offset:0
    ds_read_b64_tr_b16 v[52:53], v10 offset:4096
    s_waitcnt lgkmcnt(6)
    v_mfma_f32_16x16x32_bf16 v[72:75], v[44:47], v[32:35], v[72:75]
    ds_read_b64_tr_b16 v[54:55], v10 offset:4608
    ds_read_b128 v[16:19], v7 offset:2048
    s_waitcnt lgkmcnt(7)
    v_mfma_f32_16x16x32_bf16 v[76:79], v[44:47], v[36:39], v[76:79]
    ds_read_b128 v[20:23], v7 offset:4096
    ds_read_b128 v[24:27], v7 offset:6144
    s_waitcnt lgkmcnt(8)
    v_mfma_f32_16x16x32_bf16 v[80:83], v[44:47], v[40:43], v[80:83]
    ds_read_b64_tr_b16 v[56:57], v11 offset:4096
    ds_read_b64_tr_b16 v[58:59], v11 offset:4608
    s_waitcnt lgkmcnt(8)
    v_mfma_f32_16x16x32_bf16 v[84:87], v[48:51], v[28:31], v[84:87]
    v_mfma_f32_16x16x32_bf16 v[88:91], v[48:51], v[32:35], v[88:91]
    v_mfma_f32_16x16x32_bf16 v[92:95], v[48:51], v[36:39], v[92:95]
    v_mfma_f32_16x16x32_bf16 v[96:99], v[48:51], v[40:43], v[96:99]
    s_waitcnt lgkmcnt(5)
    v_mfma_f32_16x16x32_bf16 v[68:71], v[52:55], v[12:15], v[68:71]
    ds_read_b128 v[28:31], v6 offset:40960
    ds_read_b64_tr_b16 v[44:45], v10 offset:40960
    s_waitcnt lgkmcnt(6)
    v_mfma_f32_16x16x32_bf16 v[72:75], v[52:55], v[16:19], v[72:75]
    ds_read_b64_tr_b16 v[46:47], v10 offset:41472
    ds_read_b128 v[32:35], v6 offset:43008
    s_waitcnt lgkmcnt(7)
    v_mfma_f32_16x16x32_bf16 v[76:79], v[52:55], v[20:23], v[76:79]
    ds_read_b128 v[36:39], v6 offset:45056
    ds_read_b128 v[40:43], v6 offset:47104
    s_waitcnt lgkmcnt(8)
    v_mfma_f32_16x16x32_bf16 v[80:83], v[52:55], v[24:27], v[80:83]
    ds_read_b64_tr_b16 v[48:49], v11 offset:40960
    ds_read_b64_tr_b16 v[50:51], v11 offset:41472
    s_waitcnt lgkmcnt(8)
    v_mfma_f32_16x16x32_bf16 v[84:87], v[56:59], v[12:15], v[84:87]
    v_mfma_f32_16x16x32_bf16 v[88:91], v[56:59], v[16:19], v[88:91]
    v_mfma_f32_16x16x32_bf16 v[92:95], v[56:59], v[20:23], v[92:95]
    v_mfma_f32_16x16x32_bf16 v[96:99], v[56:59], v[24:27], v[96:99]
    s_waitcnt lgkmcnt(5)
    v_mfma_f32_16x16x32_bf16 v[68:71], v[44:47], v[28:31], v[68:71]
    ds_read_b128 v[12:15], v7 offset:40960
    ds_read_b64_tr_b16 v[52:53], v10 offset:45056
    s_waitcnt lgkmcnt(6)
    v_mfma_f32_16x16x32_bf16 v[72:75], v[44:47], v[32:35], v[72:75]
    ds_read_b64_tr_b16 v[54:55], v10 offset:45568
    ds_read_b128 v[16:19], v7 offset:43008
    s_waitcnt lgkmcnt(7)
    v_mfma_f32_16x16x32_bf16 v[76:79], v[44:47], v[36:39], v[76:79]
    ds_read_b128 v[20:23], v7 offset:45056
    ds_read_b128 v[24:27], v7 offset:47104
    s_waitcnt lgkmcnt(8)
    v_mfma_f32_16x16x32_bf16 v[80:83], v[44:47], v[40:43], v[80:83]
    ds_read_b64_tr_b16 v[56:57], v11 offset:45056
    ds_read_b64_tr_b16 v[58:59], v11 offset:45568
    s_waitcnt lgkmcnt(8)
    v_mfma_f32_16x16x32_bf16 v[84:87], v[48:51], v[28:31], v[84:87]
    v_mfma_f32_16x16x32_bf16 v[88:91], v[48:51], v[32:35], v[88:91]
    v_mfma_f32_16x16x32_bf16 v[92:95], v[48:51], v[36:39], v[92:95]
    v_mfma_f32_16x16x32_bf16 v[96:99], v[48:51], v[40:43], v[96:99]
    s_waitcnt lgkmcnt(5)
    v_mfma_f32_16x16x32_bf16 v[68:71], v[52:55], v[12:15], v[68:71]
    v_mov_b32 v135, 2
    s_mov_b64 exec, 1
    ds_write_b32 v3, v135 offset:0
    s_mov_b64 exec, -1
    ds_read_b128 v[100:103], v134 offset:0
    ds_read_b128 v[104:107], v134 offset:64
    s_waitcnt lgkmcnt(7)
    v_mfma_f32_16x16x32_bf16 v[72:75], v[52:55], v[16:19], v[72:75]
    ds_read2_b32 v[108:109], v132 offset0:0 offset1:0
    ds_read2_b32 v[110:111], v132 offset0:16 offset1:16
    s_waitcnt lgkmcnt(8)
    v_mfma_f32_16x16x32_bf16 v[76:79], v[52:55], v[20:23], v[76:79]
    ds_read2_b32 v[112:113], v132 offset0:32 offset1:32
    ds_read2_b32 v[114:115], v132 offset0:48 offset1:48
    s_waitcnt lgkmcnt(9)
    v_mfma_f32_16x16x32_bf16 v[80:83], v[52:55], v[24:27], v[80:83]
    ds_read2_b32 v[124:125], v133 offset0:0 offset1:0
    ds_read2_b32 v[126:127], v133 offset0:16 offset1:16
    s_waitcnt lgkmcnt(9)
    v_mfma_f32_16x16x32_bf16 v[84:87], v[56:59], v[12:15], v[84:87]
    ds_read2_b32 v[128:129], v133 offset0:32 offset1:32
    ds_read2_b32 v[130:131], v133 offset0:48 offset1:48
    v_mfma_f32_16x16x32_bf16 v[88:91], v[56:59], v[16:19], v[88:91]
    ds_read2_b32 v[116:117], v132 offset0:128 offset1:128
    ds_read2_b32 v[118:119], v132 offset0:144 offset1:144
    v_mfma_f32_16x16x32_bf16 v[92:95], v[56:59], v[20:23], v[92:95]
    ds_read2_b32 v[120:121], v132 offset0:160 offset1:160
    ds_read2_b32 v[122:123], v132 offset0:176 offset1:176
    v_mfma_f32_16x16x32_bf16 v[96:99], v[56:59], v[24:27], v[96:99]
    s_waitcnt lgkmcnt(11)
    v_pk_fma_f32 v[68:69], v[100:101], v[108:109], v[68:69]
    v_pk_fma_f32 v[70:71], v[102:103], v[108:109], v[70:71]
    v_pk_fma_f32 v[84:85], v[104:105], v[108:109], v[84:85]
    v_pk_fma_f32 v[86:87], v[106:107], v[108:109], v[86:87]
    s_waitcnt lgkmcnt(10)
    v_pk_fma_f32 v[72:73], v[100:101], v[110:111], v[72:73]
    v_pk_fma_f32 v[74:75], v[102:103], v[110:111], v[74:75]
    v_pk_fma_f32 v[88:89], v[104:105], v[110:111], v[88:89]
    v_pk_fma_f32 v[90:91], v[106:107], v[110:111], v[90:91]
    s_waitcnt lgkmcnt(9)
    v_pk_fma_f32 v[76:77], v[100:101], v[112:113], v[76:77]
    v_pk_fma_f32 v[78:79], v[102:103], v[112:113], v[78:79]
    v_pk_fma_f32 v[92:93], v[104:105], v[112:113], v[92:93]
    v_pk_fma_f32 v[94:95], v[106:107], v[112:113], v[94:95]
    s_waitcnt lgkmcnt(8)
    v_pk_fma_f32 v[80:81], v[100:101], v[114:115], v[80:81]
    v_pk_fma_f32 v[82:83], v[102:103], v[114:115], v[82:83]
    v_pk_fma_f32 v[96:97], v[104:105], v[114:115], v[96:97]
    v_pk_fma_f32 v[98:99], v[106:107], v[114:115], v[98:99]
    s_waitcnt lgkmcnt(7)
    v_pk_mul_f32 v[12:13], v[68:69], v[124:125]
    v_pk_mul_f32 v[14:15], v[70:71], v[124:125]
    v_pk_mul_f32 v[16:17], v[84:85], v[124:125]
    v_pk_mul_f32 v[18:19], v[86:87], v[124:125]
    s_waitcnt lgkmcnt(6)
    v_pk_mul_f32 v[20:21], v[72:73], v[126:127]
    v_pk_mul_f32 v[22:23], v[74:75], v[126:127]
    v_pk_mul_f32 v[24:25], v[88:89], v[126:127]
    v_pk_mul_f32 v[26:27], v[90:91], v[126:127]
    s_waitcnt lgkmcnt(5)
    v_pk_mul_f32 v[28:29], v[76:77], v[128:129]
    v_pk_mul_f32 v[30:31], v[78:79], v[128:129]
    v_pk_mul_f32 v[32:33], v[92:93], v[128:129]
    v_pk_mul_f32 v[34:35], v[94:95], v[128:129]
    s_waitcnt lgkmcnt(4)
    v_pk_mul_f32 v[36:37], v[80:81], v[130:131]
    v_pk_mul_f32 v[38:39], v[82:83], v[130:131]
    v_pk_mul_f32 v[40:41], v[96:97], v[130:131]
    v_pk_mul_f32 v[42:43], v[98:99], v[130:131]
    s_waitcnt lgkmcnt(3)
    v_pk_fma_f32 v[68:69], v[68:69], v[116:117], s[40:41]
    v_pk_fma_f32 v[70:71], v[70:71], v[116:117], s[40:41]
    v_pk_fma_f32 v[84:85], v[84:85], v[116:117], s[40:41]
    v_pk_fma_f32 v[86:87], v[86:87], v[116:117], s[40:41]
    s_waitcnt lgkmcnt(2)
    v_pk_fma_f32 v[72:73], v[72:73], v[118:119], s[40:41]
    v_pk_fma_f32 v[74:75], v[74:75], v[118:119], s[40:41]
    v_pk_fma_f32 v[88:89], v[88:89], v[118:119], s[40:41]
    v_pk_fma_f32 v[90:91], v[90:91], v[118:119], s[40:41]
    s_waitcnt lgkmcnt(1)
    v_pk_fma_f32 v[76:77], v[76:77], v[120:121], s[40:41]
    v_pk_fma_f32 v[78:79], v[78:79], v[120:121], s[40:41]
    v_pk_fma_f32 v[92:93], v[92:93], v[120:121], s[40:41]
    v_pk_fma_f32 v[94:95], v[94:95], v[120:121], s[40:41]
    s_waitcnt lgkmcnt(0)
    v_pk_fma_f32 v[80:81], v[80:81], v[122:123], s[40:41]
    v_pk_fma_f32 v[82:83], v[82:83], v[122:123], s[40:41]
    v_pk_fma_f32 v[96:97], v[96:97], v[122:123], s[40:41]
    v_pk_fma_f32 v[98:99], v[98:99], v[122:123], s[40:41]
    v_exp_f32 v12, v12 clamp
    v_exp_f32 v13, v13 clamp
    v_exp_f32 v14, v14 clamp
    v_exp_f32 v15, v15 clamp
    v_exp_f32 v16, v16 clamp
    v_exp_f32 v17, v17 clamp
    v_exp_f32 v18, v18 clamp
    v_exp_f32 v19, v19 clamp
    v_exp_f32 v20, v20 clamp
    v_exp_f32 v21, v21 clamp
    v_exp_f32 v22, v22 clamp
    v_exp_f32 v23, v23 clamp
    v_exp_f32 v24, v24 clamp
    v_exp_f32 v25, v25 clamp
    v_exp_f32 v26, v26 clamp
    v_exp_f32 v27, v27 clamp
    v_exp_f32 v28, v28 clamp
    v_exp_f32 v29, v29 clamp
    v_exp_f32 v30, v30 clamp
    v_exp_f32 v31, v31 clamp
    v_exp_f32 v32, v32 clamp
    v_exp_f32 v33, v33 clamp
    v_exp_f32 v34, v34 clamp
    v_exp_f32 v35, v35 clamp
    v_exp_f32 v36, v36 clamp
    v_exp_f32 v37, v37 clamp
    v_exp_f32 v38, v38 clamp
    v_exp_f32 v39, v39 clamp
    v_exp_f32 v40, v40 clamp
    v_exp_f32 v41, v41 clamp
    v_exp_f32 v42, v42 clamp
    v_exp_f32 v43, v43 clamp
    v_pk_add_f32 v[12:13], v[12:13], s[74:75]
    v_pk_add_f32 v[14:15], v[14:15], s[74:75]
    v_pk_add_f32 v[16:17], v[16:17], s[74:75]
    v_pk_add_f32 v[18:19], v[18:19], s[74:75]
    v_pk_add_f32 v[20:21], v[20:21], s[74:75]
    v_pk_add_f32 v[22:23], v[22:23], s[74:75]
    v_pk_add_f32 v[24:25], v[24:25], s[74:75]
    v_pk_add_f32 v[26:27], v[26:27], s[74:75]
    v_pk_add_f32 v[28:29], v[28:29], s[74:75]
    v_pk_add_f32 v[30:31], v[30:31], s[74:75]
    v_pk_add_f32 v[32:33], v[32:33], s[74:75]
    v_pk_add_f32 v[34:35], v[34:35], s[74:75]
    v_pk_add_f32 v[36:37], v[36:37], s[74:75]
    v_pk_add_f32 v[38:39], v[38:39], s[74:75]
    v_pk_add_f32 v[40:41], v[40:41], s[74:75]
    v_pk_add_f32 v[42:43], v[42:43], s[74:75]
    v_max_f32 v68, v68, v12
    v_max_f32 v69, v69, v13
    v_max_f32 v70, v70, v14
    v_max_f32 v71, v71, v15
    v_max_f32 v84, v84, v16
    v_max_f32 v85, v85, v17
    v_max_f32 v86, v86, v18
    v_max_f32 v87, v87, v19
    v_max_f32 v72, v72, v20
    v_max_f32 v73, v73, v21
    v_max_f32 v74, v74, v22
    v_max_f32 v75, v75, v23
    v_max_f32 v88, v88, v24
    v_max_f32 v89, v89, v25
    v_max_f32 v90, v90, v26
    v_max_f32 v91, v91, v27
    v_max_f32 v76, v76, v28
    v_max_f32 v77, v77, v29
    v_max_f32 v78, v78, v30
    v_max_f32 v79, v79, v31
    v_max_f32 v92, v92, v32
    v_max_f32 v93, v93, v33
    v_max_f32 v94, v94, v34
    v_max_f32 v95, v95, v35
    v_max_f32 v80, v80, v36
    v_max_f32 v81, v81, v37
    v_max_f32 v82, v82, v38
    v_max_f32 v83, v83, v39
    v_max_f32 v96, v96, v40
    v_max_f32 v97, v97, v41
    v_max_f32 v98, v98, v42
    v_max_f32 v99, v99, v43
    v_cvt_pk_bf16_f32 v44, v68, v69
    v_cvt_pk_bf16_f32 v45, v70, v71
    v_cvt_pk_bf16_f32 v46, v84, v85
    v_cvt_pk_bf16_f32 v47, v86, v87
    v_cvt_pk_bf16_f32 v48, v72, v73
    v_cvt_pk_bf16_f32 v49, v74, v75
    v_cvt_pk_bf16_f32 v50, v88, v89
    v_cvt_pk_bf16_f32 v51, v90, v91
    v_cvt_pk_bf16_f32 v52, v76, v77
    v_cvt_pk_bf16_f32 v53, v78, v79
    v_cvt_pk_bf16_f32 v54, v92, v93
    v_cvt_pk_bf16_f32 v55, v94, v95
    v_cvt_pk_bf16_f32 v56, v80, v81
    v_cvt_pk_bf16_f32 v57, v82, v83
    v_cvt_pk_bf16_f32 v58, v96, v97
    v_cvt_pk_bf16_f32 v59, v98, v99
    s_load_dwordx8 s[60:67], s[48:49], 0 glc
    s_and_b32 s44, s46, 127
    s_lshl_b32 s44, s44, 2
    s_add_u32 s44, s44, 24832
    v_and_b32 v1, 15, v0
    v_lshl_add_u32 v63, v1, 2, s44

    ds_read2_b32 v[4:5], v63 offset0:0 offset1:0
    ds_read2_b32 v[6:7], v63 offset0:16 offset1:16
    ds_read2_b32 v[8:9], v63 offset0:32 offset1:32
    ds_read2_b32 v[10:11], v63 offset0:48 offset1:48
    ds_read2_b32 v[12:13], v63 offset0:128 offset1:128
    ds_read2_b32 v[14:15], v63 offset0:144 offset1:144
    ds_read2_b32 v[16:17], v63 offset0:160 offset1:160
    ds_read2_b32 v[18:19], v63 offset0:176 offset1:176
    v_lshlrev_b32 v60, 4, v0
    v_and_b32 v61, 48, v0
    s_setprio 2
SP_1:
    s_load_dword s58, s[56:57], 0 glc
    s_waitcnt lgkmcnt(0)
    s_cmp_ge_u32 s58, 32
    s_cbranch_scc1 SD_2
    s_sleep 1
    s_branch SP_1
SD_2:
F_kp:
    buffer_load_dwordx4 v[36:39], v61, s[24:27], s83 offen offset:0 sc0 sc1
    buffer_load_dwordx4 v[40:43], v61, s[24:27], s83 offen offset:64 sc0 sc1
    buffer_load_dwordx4 v[20:23], v60, s[24:27], s82 offen offset:0 sc0 sc1
    buffer_load_dwordx4 v[24:27], v60, s[24:27], s82 offen offset:1024 sc0 sc1
    buffer_load_dwordx4 v[28:31], v60, s[24:27], s82 offen offset:2048 sc0 sc1
    buffer_load_dwordx4 v[32:35], v60, s[24:27], s82 offen offset:3072 sc0 sc1
    v_mov_b32 v62, 3
    s_mov_b64 exec, 1
    ds_write_b32 v3, v62 offset:0
    s_mov_b64 exec, -1
    s_waitcnt vmcnt(4)
    v_cvt_pk_bf16_f32 v124, v36, v37
    v_cvt_pk_bf16_f32 v125, v38, v39
    v_cvt_pk_bf16_f32 v126, v40, v41
    v_cvt_pk_bf16_f32 v127, v42, v43
    s_nop 1
    v_mfma_f32_16x16x32_bf16 v[76:79], v[124:127], v[44:47], 0
    v_mfma_f32_16x16x32_bf16 v[88:91], v[124:127], v[48:51], 0
    v_mfma_f32_16x16x32_bf16 v[100:103], v[124:127], v[52:55], 0
    v_mfma_f32_16x16x32_bf16 v[112:115], v[124:127], v[56:59], 0
    s_waitcnt vmcnt(2)
    v_cvt_pk_bf16_f32 v116, v20, v21
    v_cvt_pk_bf16_f32 v117, v22, v23
    v_cvt_pk_bf16_f32 v118, v24, v25
    v_cvt_pk_bf16_f32 v119, v26, v27
    s_nop 1
    v_mfma_f32_16x16x32_bf16 v[68:71], v[116:119], v[44:47], 0
    v_mfma_f32_16x16x32_bf16 v[80:83], v[116:119], v[48:51], 0
    v_mfma_f32_16x16x32_bf16 v[92:95], v[116:119], v[52:55], 0
    v_mfma_f32_16x16x32_bf16 v[104:107], v[116:119], v[56:59], 0
    v_add_f32 v76, s74, v76
    v_rcp_f32 v76, v76
    s_nop 0
    v_mov_b32 v77, v76
    v_add_f32 v88, s74, v88
    v_rcp_f32 v88, v88
    s_nop 0
    v_mov_b32 v89, v88
    v_add_f32 v100, s74, v100
    v_rcp_f32 v100, v100
    s_nop 0
    v_mov_b32 v101, v100
    v_add_f32 v112, s74, v112
    v_rcp_f32 v112, v112
    s_nop 0
    v_mov_b32_e64 v113, v112
    s_waitcnt vmcnt(0)
    v_cvt_pk_bf16_f32 v120, v28, v29
    v_cvt_pk_bf16_f32 v121, v30, v31
    v_cvt_pk_bf16_f32 v122, v32, v33
    v_cvt_pk_bf16_f32 v123, v34, v35
    s_nop 1
    v_mfma_f32_16x16x32_bf16 v[72:75], v[120:123], v[44:47], 0
    v_mfma_f32_16x16x32_bf16 v[84:87], v[120:123], v[48:51], 0
    v_mfma_f32_16x16x32_bf16 v[96:99], v[120:123], v[52:55], 0
    v_mfma_f32_16x16x32_bf16 v[108:111], v[120:123], v[56:59], 0
    s_add_u32 s80, s79, 0
    v_pk_mul_f32 v[68:69], v[68:69], v[76:77]
    v_pk_mul_f32 v[70:71], v[70:71], v[76:77]
    s_nop 1
    v_pk_mul_f32 v[72:73], v[72:73], v[76:77]
    v_pk_mul_f32 v[74:75], v[74:75], v[76:77]
    v_cvt_pk_bf16_f32 v28, v68, v69
    v_cvt_pk_bf16_f32 v29, v70, v71
    v_cvt_pk_bf16_f32 v30, v72, v73
    v_cvt_pk_bf16_f32 v31, v74, v75
    buffer_store_dwordx4 v[28:31], v60, s[16:19], s80 offen sc0 sc1
    s_add_u32 s80, s79, 32768
    v_pk_mul_f32 v[80:81], v[80:81], v[88:89]
    v_pk_mul_f32 v[82:83], v[82:83], v[88:89]
    v_pk_mul_f32 v[84:85], v[84:85], v[88:89]
    v_pk_mul_f32 v[86:87], v[86:87], v[88:89]
    v_cvt_pk_bf16_f32 v32, v80, v81
    v_cvt_pk_bf16_f32 v33, v82, v83
    v_cvt_pk_bf16_f32 v34, v84, v85
    v_cvt_pk_bf16_f32 v35, v86, v87
    buffer_store_dwordx4 v[32:35], v60, s[16:19], s80 offen sc0 sc1
    s_add_u32 s80, s79, 65536
    v_pk_mul_f32 v[92:93], v[92:93], v[100:101]
    v_pk_mul_f32 v[94:95], v[94:95], v[100:101]
    v_pk_mul_f32 v[96:97], v[96:97], v[100:101]
    v_pk_mul_f32 v[98:99], v[98:99], v[100:101]
    v_cvt_pk_bf16_f32 v36, v92, v93
    v_cvt_pk_bf16_f32 v37, v94, v95
    v_cvt_pk_bf16_f32 v38, v96, v97
    v_cvt_pk_bf16_f32 v39, v98, v99
    buffer_store_dwordx4 v[36:39], v60, s[16:19], s80 offen sc0 sc1
    s_add_u32 s80, s79, 98304
    v_pk_mul_f32 v[104:105], v[104:105], v[112:113]
    v_pk_mul_f32 v[106:107], v[106:107], v[112:113]
    v_pk_mul_f32 v[108:109], v[108:109], v[112:113]
    v_pk_mul_f32 v[110:111], v[110:111], v[112:113]
    v_cvt_pk_bf16_f32 v40, v104, v105
    v_cvt_pk_bf16_f32 v41, v106, v107
    v_cvt_pk_bf16_f32 v42, v108, v109
    v_cvt_pk_bf16_f32 v43, v110, v111
    buffer_store_dwordx4 v[40:43], v60, s[16:19], s80 offen sc0 sc1
    s_waitcnt vmcnt(0)
    s_atomic_add s76, s[68:69], 0
    s_atomic_add s76, s[68:69], 128
    s_atomic_add s76, s[68:69], 256
    s_atomic_add s76, s[68:69], 384
    v_mov_b32 v62, 4
    s_mov_b64 exec, 1
    ds_write_b32 v3, v62 offset:0
    s_mov_b64 exec, -1
    s_setprio 0
    v_lshlrev_b32 v132, 16, v148
    v_and_b32 v133, 0xffff0000, v148
    v_lshlrev_b32 v134, 16, v149
    v_and_b32 v135, 0xffff0000, v149
    v_lshlrev_b32 v136, 16, v150
    v_and_b32 v137, 0xffff0000, v150
    v_lshlrev_b32_e64 v138, 16, v151
    v_and_b32 v139, 0xffff0000, v151
    v_pk_add_f32 v[36:37], v[132:133], v[4:5]
    v_pk_add_f32 v[38:39], v[134:135], v[4:5]
    v_pk_add_f32 v[40:41], v[136:137], v[4:5]
    v_pk_add_f32 v[42:43], v[138:139], v[4:5]
    v_cvt_pk_bf16_f32 v24, v36, v37
    v_cvt_pk_bf16_f32 v25, v38, v39
    v_cvt_pk_bf16_f32 v26, v40, v41
    v_cvt_pk_bf16_f32 v27, v42, v43
    v_lshlrev_b32 v36, 16, v24
    v_and_b32 v37, 0xffff0000, v24
    v_lshlrev_b32 v38, 16, v25
    v_and_b32 v39, 0xffff0000, v25
    v_lshlrev_b32 v40, 16, v26
    v_and_b32 v41, 0xffff0000, v26
    v_lshlrev_b32 v42, 16, v27
    v_and_b32 v43, 0xffff0000, v27
    v_pk_mul_f32 v[36:37], v[36:37], v[12:13]
    v_pk_mul_f32 v[38:39], v[38:39], v[12:13]
    v_pk_mul_f32 v[40:41], v[40:41], v[12:13]
    v_pk_mul_f32 v[42:43], v[42:43], v[12:13]
    v_cvt_pk_bf16_f32 v24, v36, v37
    v_cvt_pk_bf16_f32 v25, v38, v39
    v_cvt_pk_bf16_f32 v26, v40, v41
    v_cvt_pk_bf16_f32 v27, v42, v43
    v_lshlrev_b32 v36, 16, v24
    v_and_b32 v37, 0xffff0000, v24
    v_lshlrev_b32 v38, 16, v25
    v_and_b32 v39, 0xffff0000, v25
    v_lshlrev_b32 v40, 16, v26
    v_and_b32 v41, 0xffff0000, v26
    v_lshlrev_b32 v42, 16, v27
    v_and_b32 v43, 0xffff0000, v27
    v_pk_add_f32 v[132:133], v[132:133], v[36:37]
    v_pk_add_f32 v[134:135], v[134:135], v[38:39]
    v_pk_add_f32 v[136:137], v[136:137], v[40:41]
    v_pk_add_f32 v[138:139], v[138:139], v[42:43]
    v_lshlrev_b32 v140, 16, v152
    v_and_b32 v141, 0xffff0000, v152
    v_lshlrev_b32 v142, 16, v153
    v_and_b32 v143, 0xffff0000, v153
    v_lshlrev_b32 v144, 16, v154
    v_and_b32 v145, 0xffff0000, v154
    v_lshlrev_b32 v146, 16, v155
    v_and_b32 v147, 0xffff0000, v155
    v_pk_add_f32 v[36:37], v[140:141], v[6:7]
    v_pk_add_f32 v[38:39], v[142:143], v[6:7]
    v_pk_add_f32 v[40:41], v[144:145], v[6:7]
    v_pk_add_f32 v[42:43], v[146:147], v[6:7]
    v_cvt_pk_bf16_f32 v24, v36, v37
    v_cvt_pk_bf16_f32 v25, v38, v39
    v_cvt_pk_bf16_f32 v26, v40, v41
    v_cvt_pk_bf16_f32 v27, v42, v43
    v_lshlrev_b32 v36, 16, v24
    v_and_b32 v37, 0xffff0000, v24
    v_lshlrev_b32 v38, 16, v25
    v_and_b32 v39, 0xffff0000, v25
    v_lshlrev_b32 v40, 16, v26
    v_and_b32 v41, 0xffff0000, v26
    v_lshlrev_b32 v42, 16, v27
    v_and_b32 v43, 0xffff0000, v27
    v_pk_mul_f32 v[36:37], v[36:37], v[14:15]
    v_pk_mul_f32 v[38:39], v[38:39], v[14:15]
    v_pk_mul_f32 v[40:41], v[40:41], v[14:15]
    v_pk_mul_f32 v[42:43], v[42:43], v[14:15]
    v_cvt_pk_bf16_f32 v24, v36, v37
    v_cvt_pk_bf16_f32 v25, v38, v39
    v_cvt_pk_bf16_f32 v26, v40, v41
    v_cvt_pk_bf16_f32 v27, v42, v43
    v_lshlrev_b32 v36, 16, v24
    v_and_b32 v37, 0xffff0000, v24
    v_lshlrev_b32 v38, 16, v25
    v_and_b32 v39, 0xffff0000, v25
    v_lshlrev_b32 v40, 16, v26
    v_and_b32 v41, 0xffff0000, v26
    v_lshlrev_b32 v42, 16, v27
    v_and_b32 v43, 0xffff0000, v27
    v_pk_add_f32 v[140:141], v[140:141], v[36:37]
    v_pk_add_f32 v[142:143], v[142:143], v[38:39]
    v_pk_add_f32 v[144:145], v[144:145], v[40:41]
    v_pk_add_f32 v[146:147], v[146:147], v[42:43]
    v_lshlrev_b32 v148, 16, v156
    v_and_b32 v149, 0xffff0000, v156
    v_lshlrev_b32 v150, 16, v157
    v_and_b32 v151, 0xffff0000, v157
    v_lshlrev_b32 v152, 16, v158
    v_and_b32 v153, 0xffff0000, v158
    v_lshlrev_b32 v154, 16, v159
    v_and_b32 v155, 0xffff0000, v159
    v_pk_add_f32 v[36:37], v[148:149], v[8:9]
    v_pk_add_f32 v[38:39], v[150:151], v[8:9]
    v_pk_add_f32 v[40:41], v[152:153], v[8:9]
    v_pk_add_f32 v[42:43], v[154:155], v[8:9]
    v_cvt_pk_bf16_f32 v24, v36, v37
    v_cvt_pk_bf16_f32 v25, v38, v39
    v_cvt_pk_bf16_f32 v26, v40, v41
    v_cvt_pk_bf16_f32 v27, v42, v43
    v_lshlrev_b32 v36, 16, v24
    v_and_b32 v37, 0xffff0000, v24
    v_lshlrev_b32 v38, 16, v25
    v_and_b32 v39, 0xffff0000, v25
    v_lshlrev_b32 v40, 16, v26
    v_and_b32 v41, 0xffff0000, v26
    v_lshlrev_b32 v42, 16, v27
    v_and_b32 v43, 0xffff0000, v27
    v_pk_mul_f32 v[36:37], v[36:37], v[16:17]
    v_pk_mul_f32 v[38:39], v[38:39], v[16:17]
    v_pk_mul_f32 v[40:41], v[40:41], v[16:17]
    v_pk_mul_f32 v[42:43], v[42:43], v[16:17]
    v_cvt_pk_bf16_f32 v24, v36, v37
    v_cvt_pk_bf16_f32 v25, v38, v39
    v_cvt_pk_bf16_f32 v26, v40, v41
    v_cvt_pk_bf16_f32 v27, v42, v43
    v_lshlrev_b32 v36, 16, v24
    v_and_b32 v37, 0xffff0000, v24
    v_lshlrev_b32 v38, 16, v25
    v_and_b32 v39, 0xffff0000, v25
    v_lshlrev_b32 v40, 16, v26
    v_and_b32 v41, 0xffff0000, v26
    v_lshlrev_b32 v42, 16, v27
    v_and_b32 v43, 0xffff0000, v27
    v_pk_add_f32 v[148:149], v[148:149], v[36:37]
    v_pk_add_f32 v[150:151], v[150:151], v[38:39]
    v_pk_add_f32 v[152:153], v[152:153], v[40:41]
    v_pk_add_f32 v[154:155], v[154:155], v[42:43]
    v_lshlrev_b32 v156, 16, v160
    v_and_b32 v157, 0xffff0000, v160
    v_lshlrev_b32 v158, 16, v161
    v_and_b32 v159, 0xffff0000, v161
    v_lshlrev_b32 v160, 16, v162
    v_and_b32 v161, 0xffff0000, v162
    v_lshlrev_b32 v162, 16, v163
    v_and_b32 v163, 0xffff0000, v163
    v_pk_add_f32 v[36:37], v[156:157], v[10:11]
    v_pk_add_f32 v[38:39], v[158:159], v[10:11]
    v_pk_add_f32 v[40:41], v[160:161], v[10:11]
    v_pk_add_f32 v[42:43], v[162:163], v[10:11]
    v_cvt_pk_bf16_f32 v24, v36, v37
    v_cvt_pk_bf16_f32 v25, v38, v39
    v_cvt_pk_bf16_f32 v26, v40, v41
    v_cvt_pk_bf16_f32 v27, v42, v43
    v_lshlrev_b32 v36, 16, v24
    v_and_b32 v37, 0xffff0000, v24
    v_lshlrev_b32 v38, 16, v25
    v_and_b32 v39, 0xffff0000, v25
    v_lshlrev_b32 v40, 16, v26
    v_and_b32 v41, 0xffff0000, v26
    v_lshlrev_b32 v42, 16, v27
    v_and_b32 v43, 0xffff0000, v27
    v_pk_mul_f32 v[36:37], v[36:37], v[18:19]
    v_pk_mul_f32 v[38:39], v[38:39], v[18:19]
    v_pk_mul_f32 v[40:41], v[40:41], v[18:19]
    v_pk_mul_f32 v[42:43], v[42:43], v[18:19]
    v_cvt_pk_bf16_f32 v24, v36, v37
    v_cvt_pk_bf16_f32 v25, v38, v39
    v_cvt_pk_bf16_f32 v26, v40, v41
    v_cvt_pk_bf16_f32 v27, v42, v43
    v_lshlrev_b32 v36, 16, v24
    v_and_b32 v37, 0xffff0000, v24
    v_lshlrev_b32 v38, 16, v25
    v_and_b32 v39, 0xffff0000, v25
    v_lshlrev_b32 v40, 16, v26
    v_and_b32 v41, 0xffff0000, v26
    v_lshlrev_b32 v42, 16, v27
    v_and_b32 v43, 0xffff0000, v27
    v_pk_add_f32 v[156:157], v[156:157], v[36:37]
    v_pk_add_f32 v[158:159], v[158:159], v[38:39]
    v_pk_add_f32 v[160:161], v[160:161], v[40:41]
    v_pk_add_f32 v[162:163], v[162:163], v[42:43]
    v_permlane16_swap_b32 v132, v136
    v_permlane16_swap_b32 v133, v137
    v_permlane16_swap_b32 v134, v138
    v_permlane16_swap_b32 v135, v139
    v_permlane16_swap_b32 v140, v144
    v_permlane16_swap_b32 v141, v145
    v_permlane16_swap_b32 v142, v146
    v_permlane16_swap_b32 v143, v147
    v_permlane16_swap_b32 v148, v152
    v_permlane16_swap_b32 v149, v153
    v_permlane16_swap_b32 v150, v154
    v_permlane16_swap_b32 v151, v155
    v_permlane16_swap_b32 v156, v160
    v_permlane16_swap_b32 v157, v161
    v_permlane16_swap_b32 v158, v162
    v_permlane16_swap_b32 v159, v163
    v_lshrrev_b32 v2, 4, v0
    v_lshlrev_b32 v4, 4, v0
    v_add_u32 v5, 98304, v4
    v_add_u32 v4, 16384, v4
    v_bfe_u32 v1, v0, 2, 2
    v_lshl_add_u32 v1, v2, 2, v1
    v_and_b32 v63, 7, v1
    s_lshl_b32 s44, s3, 1
    v_xor_b32 v63, s44, v63
    v_lshlrev_b32 v63, 5, v63
    v_lshl_add_u32 v63, v1, 8, v63
    v_and_b32 v1, 3, v0
    v_lshl_add_u32 v8, v1, 3, v63
    v_xor_b32 v9, 32, v8
    v_add_u32 v10, 65536, v8
    v_add_u32 v11, 65536, v9
    v_add_u32 v12, 122880, v8
    v_add_u32 v13, 122880, v9
    v_and_b32 v1, 15, v0

    v_mov_b32 v128, 0
    v_mov_b32 v129, 0
    v_mov_b32 v130, 0
    v_mov_b32 v131, 0
    s_mov_b32 s77, 0
F_km:
    s_and_b64 s[50:51], s[60:61], s[62:63]
    s_and_b64 s[50:51], s[50:51], s[64:65]
    s_and_b64 s[50:51], s[50:51], s[66:67]
    s_and_b32 s50, s50, s51
    s_bitcmp1_b32 s50, 15
    s_cbranch_scc1 F_km1
    s_load_dwordx8 s[60:67], s[48:49], 0 glc
    s_waitcnt lgkmcnt(0)
    s_branch F_km
F_km1:
    s_sub_u32 s59, 2047, s46

    s_and_b32 s44, s60, 0x7ff
    s_sub_u32 s44, s59, s44
    s_cmp_ge_u32 s44, 64
    s_cbranch_scc1 SD_3
    s_mov_b32 s77, 1
    s_or_b32 s47, s60, 0x4000
    v_mov_b32 v63, s47
    v_cmp_eq_u32 vcc, s44, v1
    s_sub_u32 s44, s44, 16
    s_nop 0
    v_cndmask_b32 v128, v128, v63, vcc
    v_cmp_eq_u32 vcc, s44, v1
    s_sub_u32 s44, s44, 16
    s_nop 0
    v_cndmask_b32 v129, v129, v63, vcc
    v_cmp_eq_u32 vcc, s44, v1
    s_sub_u32 s44, s44, 16
    s_nop 0
    v_cndmask_b32 v130, v130, v63, vcc
    v_cmp_eq_u32 vcc, s44, v1
    s_sub_u32 s44, s44, 16
    s_nop 0
    v_cndmask_b32 v131, v131, v63, vcc
SD_3:
    s_and_b32 s44, s61, 0x7ff
    s_sub_u32 s44, s59, s44
    s_cmp_ge_u32 s44, 64
    s_cbranch_scc1 SD_4
    s_mov_b32 s77, 1
    s_or_b32 s47, s61, 0x4800
    v_mov_b32 v63, s47
    v_cmp_eq_u32 vcc, s44, v1
    s_sub_u32 s44, s44, 16
    s_nop 0
    v_cndmask_b32 v128, v128, v63, vcc
    v_cmp_eq_u32 vcc, s44, v1
    s_sub_u32 s44, s44, 16
    s_nop 0
    v_cndmask_b32 v129, v129, v63, vcc
    v_cmp_eq_u32 vcc, s44, v1
    s_sub_u32 s44, s44, 16
    s_nop 0
    v_cndmask_b32 v130, v130, v63, vcc
    v_cmp_eq_u32 vcc, s44, v1
    s_sub_u32 s44, s44, 16
    s_nop 0
    v_cndmask_b32 v131, v131, v63, vcc
SD_4:
    s_and_b32 s44, s62, 0x7ff
    s_sub_u32 s44, s59, s44
    s_cmp_ge_u32 s44, 64
    s_cbranch_scc1 SD_5
    s_mov_b32 s77, 1
    s_or_b32 s47, s62, 0x5000
    v_mov_b32 v63, s47
    v_cmp_eq_u32 vcc, s44, v1
    s_sub_u32 s44, s44, 16
    s_nop 0
    v_cndmask_b32 v128, v128, v63, vcc
    v_cmp_eq_u32 vcc, s44, v1
    s_sub_u32 s44, s44, 16
    s_nop 0
    v_cndmask_b32 v129, v129, v63, vcc
    v_cmp_eq_u32 vcc, s44, v1
    s_sub_u32 s44, s44, 16
    s_nop 0
    v_cndmask_b32 v130, v130, v63, vcc
    v_cmp_eq_u32 vcc, s44, v1
    s_sub_u32 s44, s44, 16
    s_nop 0
    v_cndmask_b32 v131, v131, v63, vcc
SD_5:
    s_and_b32 s44, s63, 0x7ff
    s_sub_u32 s44, s59, s44
    s_cmp_ge_u32 s44, 64
    s_cbranch_scc1 SD_6
    s_mov_b32 s77, 1
    s_or_b32 s47, s63, 0x5800
    v_mov_b32 v63, s47
    v_cmp_eq_u32 vcc, s44, v1
    s_sub_u32 s44, s44, 16
    s_nop 0
    v_cndmask_b32 v128, v128, v63, vcc
    v_cmp_eq_u32 vcc, s44, v1
    s_sub_u32 s44, s44, 16
    s_nop 0
    v_cndmask_b32 v129, v129, v63, vcc
    v_cmp_eq_u32 vcc, s44, v1
    s_sub_u32 s44, s44, 16
    s_nop 0
    v_cndmask_b32 v130, v130, v63, vcc
    v_cmp_eq_u32 vcc, s44, v1
    s_sub_u32 s44, s44, 16
    s_nop 0
    v_cndmask_b32 v131, v131, v63, vcc
SD_6:
    s_and_b32 s44, s64, 0x7ff
    s_sub_u32 s44, s59, s44
    s_cmp_ge_u32 s44, 64
    s_cbranch_scc1 SD_7
    s_mov_b32 s77, 1
    s_or_b32 s47, s64, 0x6000
    v_mov_b32 v63, s47
    v_cmp_eq_u32 vcc, s44, v1
    s_sub_u32 s44, s44, 16
    s_nop 0
    v_cndmask_b32 v128, v128, v63, vcc
    v_cmp_eq_u32 vcc, s44, v1
    s_sub_u32 s44, s44, 16
    s_nop 0
    v_cndmask_b32 v129, v129, v63, vcc
    v_cmp_eq_u32 vcc, s44, v1
    s_sub_u32 s44, s44, 16
    s_nop 0
    v_cndmask_b32 v130, v130, v63, vcc
    v_cmp_eq_u32 vcc, s44, v1
    s_sub_u32 s44, s44, 16
    s_nop 0
    v_cndmask_b32 v131, v131, v63, vcc
SD_7:
    s_and_b32 s44, s65, 0x7ff
    s_sub_u32 s44, s59, s44
    s_cmp_ge_u32 s44, 64
    s_cbranch_scc1 SD_8
    s_mov_b32 s77, 1
    s_or_b32 s47, s65, 0x6800
    v_mov_b32 v63, s47
    v_cmp_eq_u32 vcc, s44, v1
    s_sub_u32 s44, s44, 16
    s_nop 0
    v_cndmask_b32 v128, v128, v63, vcc
    v_cmp_eq_u32 vcc, s44, v1
    s_sub_u32 s44, s44, 16
    s_nop 0
    v_cndmask_b32 v129, v129, v63, vcc
    v_cmp_eq_u32 vcc, s44, v1
    s_sub_u32 s44, s44, 16
    s_nop 0
    v_cndmask_b32 v130, v130, v63, vcc
    v_cmp_eq_u32 vcc, s44, v1
    s_sub_u32 s44, s44, 16
    s_nop 0
    v_cndmask_b32 v131, v131, v63, vcc
SD_8:
    s_and_b32 s44, s66, 0x7ff
    s_sub_u32 s44, s59, s44
    s_cmp_ge_u32 s44, 64
    s_cbranch_scc1 SD_9
    s_mov_b32 s77, 1
    s_or_b32 s47, s66, 0x7000
    v_mov_b32 v63, s47
    v_cmp_eq_u32 vcc, s44, v1
    s_sub_u32 s44, s44, 16
    s_nop 0
    v_cndmask_b32 v128, v128, v63, vcc
    v_cmp_eq_u32 vcc, s44, v1
    s_sub_u32 s44, s44, 16
    s_nop 0
    v_cndmask_b32 v129, v129, v63, vcc
    v_cmp_eq_u32 vcc, s44, v1
    s_sub_u32 s44, s44, 16
    s_nop 0
    v_cndmask_b32 v130, v130, v63, vcc
    v_cmp_eq_u32 vcc, s44, v1
    s_sub_u32 s44, s44, 16
    s_nop 0
    v_cndmask_b32 v131, v131, v63, vcc
SD_9:
    s_and_b32 s44, s67, 0x7ff
    s_sub_u32 s44, s59, s44
    s_cmp_ge_u32 s44, 64
    s_cbranch_scc1 SD_10
    s_mov_b32 s77, 1
    s_or_b32 s47, s67, 0x7800
    v_mov_b32 v63, s47
    v_cmp_eq_u32 vcc, s44, v1
    s_sub_u32 s44, s44, 16
    s_nop 0
    v_cndmask_b32 v128, v128, v63, vcc
    v_cmp_eq_u32 vcc, s44, v1
    s_sub_u32 s44, s44, 16
    s_nop 0
    v_cndmask_b32 v129, v129, v63, vcc
    v_cmp_eq_u32 vcc, s44, v1
    s_sub_u32 s44, s44, 16
    s_nop 0
    v_cndmask_b32 v130, v130, v63, vcc
    v_cmp_eq_u32_e64 vcc, s44, v1
    s_sub_u32 s44, s44, 16
    s_nop 0
    v_cndmask_b32 v131, v131, v63, vcc
SD_10:
    s_cmp_lg_u32 s77, 0
    s_cbranch_scc1 F_ys
F_ys1:
    s_setprio 2
    s_waitcnt lgkmcnt(0)
    s_barrier
    ds_read_b64_tr_b16 v[40:41], v12 offset:24576
    ds_read_b64_tr_b16 v[42:43], v12 offset:28672
    ds_read_b128 v[24:27], v4 offset:0
    ds_read_b64_tr_b16 v[44:45], v13 offset:24576
    ds_read_b64_tr_b16 v[46:47], v13 offset:28672
    ds_read_b128 v[28:31], v4 offset:2048
    ds_read_b128 v[32:35], v4 offset:4096
    ds_read_b128 v[36:39], v4 offset:6144
    ds_read_b64_tr_b16 v[64:65], v12 offset:32768
    ds_read_b64_tr_b16 v[66:67], v12 offset:36864
    ds_read_b128 v[48:51], v4 offset:1024
    ds_read_b64_tr_b16 v[68:69], v13 offset:32768
    ds_read_b64_tr_b16 v[70:71], v13 offset:36864
    ds_read_b128 v[52:55], v4 offset:3072
    ds_read_b128 v[56:59], v4 offset:5120
    s_waitcnt lgkmcnt(8)
    ds_read_b128 v[60:63], v4 offset:7168
    s_waitcnt lgkmcnt(13)
    v_mfma_f32_16x16x32_bf16 v[132:135], v[40:43], v[24:27], v[132:135]
    s_waitcnt lgkmcnt(11)
    v_mfma_f32_16x16x32_bf16 v[136:139], v[44:47], v[24:27], v[136:139]
    s_waitcnt lgkmcnt(0)
    s_barrier
    ds_read_b64_tr_b16 v[88:89], v10 offset:0
    ds_read_b64_tr_b16 v[90:91], v10 offset:4096
    v_mfma_f32_16x16x32_bf16 v[140:143], v[40:43], v[28:31], v[140:143]
    ds_read_b128 v[72:75], v5 offset:0
    ds_read_b64_tr_b16 v[92:93], v11 offset:0
    v_mfma_f32_16x16x32_bf16 v[144:147], v[44:47], v[28:31], v[144:147]
    ds_read_b64_tr_b16 v[94:95], v11 offset:4096
    ds_read_b128 v[76:79], v5 offset:2048
    v_mfma_f32_16x16x32_bf16 v[148:151], v[40:43], v[32:35], v[148:151]
    ds_read_b128 v[80:83], v5 offset:4096
    ds_read_b128 v[84:87], v5 offset:6144
    v_mfma_f32_16x16x32_bf16 v[152:155], v[44:47], v[32:35], v[152:155]
    v_mfma_f32_16x16x32_bf16 v[156:159], v[40:43], v[36:39], v[156:159]
    v_mfma_f32_16x16x32_bf16 v[160:163], v[44:47], v[36:39], v[160:163]
    v_mfma_f32_16x16x32_bf16 v[132:135], v[64:67], v[48:51], v[132:135]
    ds_read_b64_tr_b16 v[40:41], v10 offset:8192
    ds_read_b64_tr_b16 v[42:43], v10 offset:12288
    v_mfma_f32_16x16x32_bf16 v[136:139], v[68:71], v[48:51], v[136:139]
    ds_read_b128 v[24:27], v5 offset:1024
    ds_read_b64_tr_b16 v[44:45], v11 offset:8192
    v_mfma_f32_16x16x32_bf16 v[140:143], v[64:67], v[52:55], v[140:143]
    ds_read_b64_tr_b16 v[46:47], v11 offset:12288
    ds_read_b128 v[28:31], v5 offset:3072
    v_mfma_f32_16x16x32_bf16 v[144:147], v[68:71], v[52:55], v[144:147]
    ds_read_b128 v[32:35], v5 offset:5120
    s_waitcnt lgkmcnt(8)
    ds_read_b128 v[36:39], v5 offset:7168
    v_mfma_f32_16x16x32_bf16 v[148:151], v[64:67], v[56:59], v[148:151]
    v_mfma_f32_16x16x32_bf16 v[152:155], v[68:71], v[56:59], v[152:155]
    v_mfma_f32_16x16x32_bf16 v[156:159], v[64:67], v[60:63], v[156:159]
    v_mfma_f32_16x16x32_bf16 v[160:163], v[68:71], v[60:63], v[160:163]
    s_waitcnt lgkmcnt(8)
    v_mfma_f32_16x16x32_bf16 v[132:135], v[88:91], v[72:75], v[132:135]
    v_mfma_f32_16x16x32_bf16 v[136:139], v[92:95], v[72:75], v[136:139]
    s_waitcnt lgkmcnt(0)
    s_barrier
    ds_read_b64_tr_b16 v[64:65], v8 offset:0
    ds_read_b64_tr_b16 v[66:67], v8 offset:4096
    v_mfma_f32_16x16x32_bf16 v[140:143], v[88:91], v[76:79], v[140:143]
    ds_read_b128 v[48:51], v5 offset:40960
    ds_read_b64_tr_b16 v[68:69], v9 offset:0
    v_mfma_f32_16x16x32_bf16 v[144:147], v[92:95], v[76:79], v[144:147]
    ds_read_b64_tr_b16 v[70:71], v9 offset:4096
    ds_read_b128 v[52:55], v5 offset:43008
    v_mfma_f32_16x16x32_bf16 v[148:151], v[88:91], v[80:83], v[148:151]
    ds_read_b128 v[56:59], v5 offset:45056
    ds_read_b128 v[60:63], v5 offset:47104
    v_mfma_f32_16x16x32_bf16 v[152:155], v[92:95], v[80:83], v[152:155]
    v_mfma_f32_16x16x32_bf16 v[156:159], v[88:91], v[84:87], v[156:159]
    v_mfma_f32_16x16x32_bf16 v[160:163], v[92:95], v[84:87], v[160:163]
    v_mfma_f32_16x16x32_bf16 v[132:135], v[40:43], v[24:27], v[132:135]
    ds_read_b64_tr_b16 v[88:89], v8 offset:8192
    ds_read_b64_tr_b16 v[90:91], v8 offset:12288
    v_mfma_f32_16x16x32_bf16 v[136:139], v[44:47], v[24:27], v[136:139]
    ds_read_b128 v[72:75], v5 offset:41984
    ds_read_b64_tr_b16 v[92:93], v9 offset:8192
    v_mfma_f32_16x16x32_bf16 v[140:143], v[40:43], v[28:31], v[140:143]
    ds_read_b64_tr_b16 v[94:95], v9 offset:12288
    ds_read_b128 v[76:79], v5 offset:44032
    v_mfma_f32_16x16x32_bf16 v[144:147], v[44:47], v[28:31], v[144:147]
    ds_read_b128 v[80:83], v5 offset:46080
    s_waitcnt lgkmcnt(8)
    ds_read_b128 v[84:87], v5 offset:48128
    v_mfma_f32_16x16x32_bf16 v[148:151], v[40:43], v[32:35], v[148:151]
    v_mfma_f32_16x16x32_bf16 v[152:155], v[44:47], v[32:35], v[152:155]
    v_mfma_f32_16x16x32_bf16 v[156:159], v[40:43], v[36:39], v[156:159]
    v_mfma_f32_16x16x32_bf16 v[160:163], v[44:47], v[36:39], v[160:163]
    s_waitcnt lgkmcnt(8)
    v_mfma_f32_16x16x32_bf16 v[132:135], v[64:67], v[48:51], v[132:135]
    v_mfma_f32_16x16x32_bf16 v[136:139], v[68:71], v[48:51], v[136:139]
    s_waitcnt lgkmcnt(0)
    s_barrier
    ds_read_b64_tr_b16 v[40:41], v8 offset:40960
    ds_read_b64_tr_b16 v[42:43], v8 offset:45056
    v_mfma_f32_16x16x32_bf16 v[140:143], v[64:67], v[52:55], v[140:143]
    ds_read_b128 v[24:27], v4 offset:40960
    ds_read_b64_tr_b16 v[44:45], v9 offset:40960
    v_mfma_f32_16x16x32_bf16 v[144:147], v[68:71], v[52:55], v[144:147]
    ds_read_b64_tr_b16 v[46:47], v9 offset:45056
    ds_read_b128 v[28:31], v4 offset:43008
    v_mfma_f32_16x16x32_bf16 v[148:151], v[64:67], v[56:59], v[148:151]
    ds_read_b128 v[32:35], v4 offset:45056
    ds_read_b128 v[36:39], v4 offset:47104
    v_mfma_f32_16x16x32_bf16 v[152:155], v[68:71], v[56:59], v[152:155]
    v_mfma_f32_16x16x32_bf16 v[156:159], v[64:67], v[60:63], v[156:159]
    v_mfma_f32_16x16x32_bf16 v[160:163], v[68:71], v[60:63], v[160:163]
    v_mfma_f32_16x16x32_bf16 v[132:135], v[88:91], v[72:75], v[132:135]
    ds_read_b64_tr_b16 v[64:65], v8 offset:49152
    ds_read_b64_tr_b16 v[66:67], v8 offset:53248
    v_mfma_f32_16x16x32_bf16 v[136:139], v[92:95], v[72:75], v[136:139]
    ds_read_b128 v[48:51], v4 offset:41984
    ds_read_b64_tr_b16 v[68:69], v9 offset:49152
    v_mfma_f32_16x16x32_bf16 v[140:143], v[88:91], v[76:79], v[140:143]
    ds_read_b64_tr_b16 v[70:71], v9 offset:53248
    ds_read_b128 v[52:55], v4 offset:44032
    v_mfma_f32_16x16x32_bf16 v[144:147], v[92:95], v[76:79], v[144:147]
    ds_read_b128 v[56:59], v4 offset:46080
    s_waitcnt lgkmcnt(8)
    ds_read_b128 v[60:63], v4 offset:48128
    v_mfma_f32_16x16x32_bf16 v[148:151], v[88:91], v[80:83], v[148:151]
    v_mfma_f32_16x16x32_bf16 v[152:155], v[92:95], v[80:83], v[152:155]
    v_mfma_f32_16x16x32_bf16 v[156:159], v[88:91], v[84:87], v[156:159]
    v_mfma_f32_16x16x32_bf16 v[160:163], v[92:95], v[84:87], v[160:163]
    s_waitcnt lgkmcnt(8)
    v_mfma_f32_16x16x32_bf16 v[132:135], v[40:43], v[24:27], v[132:135]
    v_mfma_f32_16x16x32_bf16 v[136:139], v[44:47], v[24:27], v[136:139]
    s_waitcnt lgkmcnt(0)
    s_barrier
    ds_read_b64_tr_b16 v[88:89], v10 offset:16384
    ds_read_b64_tr_b16 v[90:91], v10 offset:20480
    v_mfma_f32_16x16x32_bf16 v[140:143], v[40:43], v[28:31], v[140:143]
    ds_read_b128 v[72:75], v4 offset:0
    ds_read_b64_tr_b16 v[92:93], v11 offset:16384
    v_mfma_f32_16x16x32_bf16 v[144:147], v[44:47], v[28:31], v[144:147]
    ds_read_b64_tr_b16 v[94:95], v11 offset:20480
    ds_read_b128 v[76:79], v4 offset:2048
    v_mfma_f32_16x16x32_bf16 v[148:151], v[40:43], v[32:35], v[148:151]
    ds_read_b128 v[80:83], v4 offset:4096
    ds_read_b128 v[84:87], v4 offset:6144
    v_mfma_f32_16x16x32_bf16 v[152:155], v[44:47], v[32:35], v[152:155]
    v_mfma_f32_16x16x32_bf16 v[156:159], v[40:43], v[36:39], v[156:159]
    v_mfma_f32_16x16x32_bf16 v[160:163], v[44:47], v[36:39], v[160:163]
    v_mfma_f32_16x16x32_bf16 v[132:135], v[64:67], v[48:51], v[132:135]
    ds_read_b64_tr_b16 v[40:41], v10 offset:24576
    ds_read_b64_tr_b16 v[42:43], v10 offset:28672
    v_mfma_f32_16x16x32_bf16 v[136:139], v[68:71], v[48:51], v[136:139]
    ds_read_b128 v[24:27], v4 offset:1024
    ds_read_b64_tr_b16 v[44:45], v11 offset:24576
    v_mfma_f32_16x16x32_bf16 v[140:143], v[64:67], v[52:55], v[140:143]
    ds_read_b64_tr_b16 v[46:47], v11 offset:28672
    ds_read_b128 v[28:31], v4 offset:3072
    v_mfma_f32_16x16x32_bf16 v[144:147], v[68:71], v[52:55], v[144:147]
    ds_read_b128 v[32:35], v4 offset:5120
    s_waitcnt lgkmcnt(8)
    ds_read_b128 v[36:39], v4 offset:7168
    v_mfma_f32_16x16x32_bf16 v[148:151], v[64:67], v[56:59], v[148:151]
    v_mfma_f32_16x16x32_bf16 v[152:155], v[68:71], v[56:59], v[152:155]
    v_mfma_f32_16x16x32_bf16 v[156:159], v[64:67], v[60:63], v[156:159]
    v_mfma_f32_16x16x32_bf16 v[160:163], v[68:71], v[60:63], v[160:163]
    s_waitcnt lgkmcnt(8)
    v_mfma_f32_16x16x32_bf16 v[132:135], v[88:91], v[72:75], v[132:135]
    v_mfma_f32_16x16x32_bf16 v[136:139], v[92:95], v[72:75], v[136:139]
    s_waitcnt lgkmcnt(0)
    s_barrier
    ds_read_b64_tr_b16 v[64:65], v12 offset:0
    ds_read_b64_tr_b16 v[66:67], v12 offset:4096
    v_mfma_f32_16x16x32_bf16 v[140:143], v[88:91], v[76:79], v[140:143]
    ds_read_b128 v[48:51], v5 offset:0
    ds_read_b64_tr_b16 v[68:69], v13 offset:0
    v_mfma_f32_16x16x32_bf16 v[144:147], v[92:95], v[76:79], v[144:147]
    ds_read_b64_tr_b16 v[70:71], v13 offset:4096
    ds_read_b128 v[52:55], v5 offset:2048
    v_mfma_f32_16x16x32_bf16 v[148:151], v[88:91], v[80:83], v[148:151]
    ds_read_b128 v[56:59], v5 offset:4096
    ds_read_b128 v[60:63], v5 offset:6144
    v_mfma_f32_16x16x32_bf16 v[152:155], v[92:95], v[80:83], v[152:155]
    v_mfma_f32_16x16x32_bf16 v[156:159], v[88:91], v[84:87], v[156:159]
    v_mfma_f32_16x16x32_bf16 v[160:163], v[92:95], v[84:87], v[160:163]
    v_mfma_f32_16x16x32_bf16 v[132:135], v[40:43], v[24:27], v[132:135]
    ds_read_b64_tr_b16 v[88:89], v12 offset:8192
    ds_read_b64_tr_b16 v[90:91], v12 offset:12288
    v_mfma_f32_16x16x32_bf16 v[136:139], v[44:47], v[24:27], v[136:139]
    ds_read_b128 v[72:75], v5 offset:1024
    ds_read_b64_tr_b16 v[92:93], v13 offset:8192
    v_mfma_f32_16x16x32_bf16 v[140:143], v[40:43], v[28:31], v[140:143]
    ds_read_b64_tr_b16 v[94:95], v13 offset:12288
    ds_read_b128 v[76:79], v5 offset:3072
    v_mfma_f32_16x16x32_bf16 v[144:147], v[44:47], v[28:31], v[144:147]
    ds_read_b128 v[80:83], v5 offset:5120
    s_waitcnt lgkmcnt(8)
    ds_read_b128 v[84:87], v5 offset:7168
    v_mfma_f32_16x16x32_bf16 v[148:151], v[40:43], v[32:35], v[148:151]
    v_mfma_f32_16x16x32_bf16 v[152:155], v[44:47], v[32:35], v[152:155]
    v_mfma_f32_16x16x32_bf16 v[156:159], v[40:43], v[36:39], v[156:159]
    v_mfma_f32_16x16x32_bf16 v[160:163], v[44:47], v[36:39], v[160:163]
    s_waitcnt lgkmcnt(8)
    v_mfma_f32_16x16x32_bf16 v[132:135], v[64:67], v[48:51], v[132:135]
    v_mfma_f32_16x16x32_bf16 v[136:139], v[68:71], v[48:51], v[136:139]
    s_waitcnt lgkmcnt(0)
    s_barrier
    ds_read_b64_tr_b16 v[40:41], v10 offset:40960
    ds_read_b64_tr_b16 v[42:43], v10 offset:45056
    v_mfma_f32_16x16x32_bf16 v[140:143], v[64:67], v[52:55], v[140:143]
    ds_read_b128 v[24:27], v5 offset:40960
    ds_read_b64_tr_b16 v[44:45], v11 offset:40960
    v_mfma_f32_16x16x32_bf16 v[144:147], v[68:71], v[52:55], v[144:147]
    ds_read_b64_tr_b16 v[46:47], v11 offset:45056
    ds_read_b128 v[28:31], v5 offset:43008
    v_mfma_f32_16x16x32_bf16 v[148:151], v[64:67], v[56:59], v[148:151]
    ds_read_b128 v[32:35], v5 offset:45056
    ds_read_b128 v[36:39], v5 offset:47104
    v_mfma_f32_16x16x32_bf16 v[152:155], v[68:71], v[56:59], v[152:155]
    v_mfma_f32_16x16x32_bf16 v[156:159], v[64:67], v[60:63], v[156:159]
    v_mfma_f32_16x16x32_bf16 v[160:163], v[68:71], v[60:63], v[160:163]
    v_mfma_f32_16x16x32_bf16 v[132:135], v[88:91], v[72:75], v[132:135]
    ds_read_b64_tr_b16 v[64:65], v10 offset:49152
    ds_read_b64_tr_b16 v[66:67], v10 offset:53248
    v_mfma_f32_16x16x32_bf16 v[136:139], v[92:95], v[72:75], v[136:139]
    ds_read_b128 v[48:51], v5 offset:41984
    ds_read_b64_tr_b16 v[68:69], v11 offset:49152
    v_mfma_f32_16x16x32_bf16 v[140:143], v[88:91], v[76:79], v[140:143]
    ds_read_b64_tr_b16 v[70:71], v11 offset:53248
    ds_read_b128 v[52:55], v5 offset:44032
    v_mfma_f32_16x16x32_bf16 v[144:147], v[92:95], v[76:79], v[144:147]
    ds_read_b128 v[56:59], v5 offset:46080
    s_waitcnt lgkmcnt(8)
    ds_read_b128 v[60:63], v5 offset:48128
    v_mfma_f32_16x16x32_bf16 v[148:151], v[88:91], v[80:83], v[148:151]
    v_mfma_f32_16x16x32_bf16 v[152:155], v[92:95], v[80:83], v[152:155]
    v_mfma_f32_16x16x32_bf16 v[156:159], v[88:91], v[84:87], v[156:159]
    v_mfma_f32_16x16x32_bf16 v[160:163], v[92:95], v[84:87], v[160:163]
    s_waitcnt lgkmcnt(8)
    v_mfma_f32_16x16x32_bf16 v[132:135], v[40:43], v[24:27], v[132:135]
    v_mfma_f32_16x16x32_bf16 v[136:139], v[44:47], v[24:27], v[136:139]
    s_waitcnt lgkmcnt(0)
    s_barrier
    ds_read_b64_tr_b16 v[88:89], v12 offset:24576
    ds_read_b64_tr_b16 v[90:91], v12 offset:28672
    v_mfma_f32_16x16x32_bf16 v[140:143], v[40:43], v[28:31], v[140:143]
    ds_read_b128 v[72:75], v4 offset:40960
    ds_read_b64_tr_b16 v[92:93], v13 offset:24576
    v_mfma_f32_16x16x32_bf16 v[144:147], v[44:47], v[28:31], v[144:147]
    ds_read_b64_tr_b16 v[94:95], v13 offset:28672
    ds_read_b128 v[76:79], v4 offset:43008
    v_mfma_f32_16x16x32_bf16 v[148:151], v[40:43], v[32:35], v[148:151]
    ds_read_b128 v[80:83], v4 offset:45056
    ds_read_b128 v[84:87], v4 offset:47104
    v_mfma_f32_16x16x32_bf16 v[152:155], v[44:47], v[32:35], v[152:155]
    v_mfma_f32_16x16x32_bf16 v[156:159], v[40:43], v[36:39], v[156:159]
    v_mfma_f32_16x16x32_bf16 v[160:163], v[44:47], v[36:39], v[160:163]
    v_mfma_f32_16x16x32_bf16 v[132:135], v[64:67], v[48:51], v[132:135]
    ds_read_b64_tr_b16 v[40:41], v12 offset:32768
    ds_read_b64_tr_b16 v[42:43], v12 offset:36864
    v_mfma_f32_16x16x32_bf16 v[136:139], v[68:71], v[48:51], v[136:139]
    ds_read_b128 v[24:27], v4 offset:41984
    ds_read_b64_tr_b16 v[44:45], v13 offset:32768
    v_mfma_f32_16x16x32_bf16 v[140:143], v[64:67], v[52:55], v[140:143]
    ds_read_b64_tr_b16 v[46:47], v13 offset:36864
    ds_read_b128 v[28:31], v4 offset:44032
    v_mfma_f32_16x16x32_bf16 v[144:147], v[68:71], v[52:55], v[144:147]
    ds_read_b128 v[32:35], v4 offset:46080
    s_waitcnt lgkmcnt(8)
    ds_read_b128 v[36:39], v4 offset:48128
    v_mfma_f32_16x16x32_bf16 v[148:151], v[64:67], v[56:59], v[148:151]
    v_mfma_f32_16x16x32_bf16 v[152:155], v[68:71], v[56:59], v[152:155]
    v_mfma_f32_16x16x32_bf16 v[156:159], v[64:67], v[60:63], v[156:159]
    v_mfma_f32_16x16x32_bf16 v[160:163], v[68:71], v[60:63], v[160:163]
    s_waitcnt lgkmcnt(8)
    v_mfma_f32_16x16x32_bf16 v[132:135], v[88:91], v[72:75], v[132:135]
    v_mfma_f32_16x16x32_bf16 v[136:139], v[92:95], v[72:75], v[136:139]
    s_waitcnt lgkmcnt(0)
    s_barrier
    ds_read_b64_tr_b16 v[64:65], v10 offset:0
    ds_read_b64_tr_b16 v[66:67], v10 offset:4096
    v_mfma_f32_16x16x32_bf16 v[140:143], v[88:91], v[76:79], v[140:143]
    ds_read_b128 v[48:51], v4 offset:0
    ds_read_b64_tr_b16 v[68:69], v11 offset:0
    v_mfma_f32_16x16x32_bf16 v[144:147], v[92:95], v[76:79], v[144:147]
    ds_read_b64_tr_b16 v[70:71], v11 offset:4096
    ds_read_b128 v[52:55], v4 offset:2048
    v_mfma_f32_16x16x32_bf16 v[148:151], v[88:91], v[80:83], v[148:151]
    ds_read_b128 v[56:59], v4 offset:4096
    ds_read_b128 v[60:63], v4 offset:6144
    v_mfma_f32_16x16x32_bf16 v[152:155], v[92:95], v[80:83], v[152:155]
    v_mfma_f32_16x16x32_bf16 v[156:159], v[88:91], v[84:87], v[156:159]
    v_mfma_f32_16x16x32_bf16 v[160:163], v[92:95], v[84:87], v[160:163]
    v_mfma_f32_16x16x32_bf16 v[132:135], v[40:43], v[24:27], v[132:135]
    ds_read_b64_tr_b16 v[88:89], v10 offset:8192
    ds_read_b64_tr_b16 v[90:91], v10 offset:12288
    v_mfma_f32_16x16x32_bf16 v[136:139], v[44:47], v[24:27], v[136:139]
    ds_read_b128 v[72:75], v4 offset:1024
    ds_read_b64_tr_b16 v[92:93], v11 offset:8192
    v_mfma_f32_16x16x32_bf16 v[140:143], v[40:43], v[28:31], v[140:143]
    ds_read_b64_tr_b16 v[94:95], v11 offset:12288
    ds_read_b128 v[76:79], v4 offset:3072
    v_mfma_f32_16x16x32_bf16 v[144:147], v[44:47], v[28:31], v[144:147]
    ds_read_b128 v[80:83], v4 offset:5120
    s_waitcnt lgkmcnt(8)
    ds_read_b128 v[84:87], v4 offset:7168
    v_mfma_f32_16x16x32_bf16 v[148:151], v[40:43], v[32:35], v[148:151]
    v_mfma_f32_16x16x32_bf16 v[152:155], v[44:47], v[32:35], v[152:155]
    v_mfma_f32_16x16x32_bf16 v[156:159], v[40:43], v[36:39], v[156:159]
    v_mfma_f32_16x16x32_bf16 v[160:163], v[44:47], v[36:39], v[160:163]
    s_waitcnt lgkmcnt(8)
    v_mfma_f32_16x16x32_bf16 v[132:135], v[64:67], v[48:51], v[132:135]
    v_mfma_f32_16x16x32_bf16 v[136:139], v[68:71], v[48:51], v[136:139]
    s_waitcnt lgkmcnt(0)
    s_barrier
    ds_read_b64_tr_b16 v[40:41], v8 offset:0
    ds_read_b64_tr_b16 v[42:43], v8 offset:4096
    v_mfma_f32_16x16x32_bf16 v[140:143], v[64:67], v[52:55], v[140:143]
    ds_read_b128 v[24:27], v5 offset:0
    ds_read_b64_tr_b16 v[44:45], v9 offset:0
    v_mfma_f32_16x16x32_bf16 v[144:147], v[68:71], v[52:55], v[144:147]
    ds_read_b64_tr_b16 v[46:47], v9 offset:4096
    ds_read_b128 v[28:31], v5 offset:2048
    v_mfma_f32_16x16x32_bf16 v[148:151], v[64:67], v[56:59], v[148:151]
    ds_read_b128 v[32:35], v5 offset:4096
    ds_read_b128 v[36:39], v5 offset:6144
    v_mfma_f32_16x16x32_bf16 v[152:155], v[68:71], v[56:59], v[152:155]
    v_mfma_f32_16x16x32_bf16 v[156:159], v[64:67], v[60:63], v[156:159]
    v_mfma_f32_16x16x32_bf16 v[160:163], v[68:71], v[60:63], v[160:163]
    v_mfma_f32_16x16x32_bf16 v[132:135], v[88:91], v[72:75], v[132:135]
    ds_read_b64_tr_b16 v[64:65], v8 offset:8192
    ds_read_b64_tr_b16 v[66:67], v8 offset:12288
    v_mfma_f32_16x16x32_bf16 v[136:139], v[92:95], v[72:75], v[136:139]
    ds_read_b128 v[48:51], v5 offset:1024
    ds_read_b64_tr_b16 v[68:69], v9 offset:8192
    v_mfma_f32_16x16x32_bf16 v[140:143], v[88:91], v[76:79], v[140:143]
    ds_read_b64_tr_b16 v[70:71], v9 offset:12288
    ds_read_b128 v[52:55], v5 offset:3072
    v_mfma_f32_16x16x32_bf16 v[144:147], v[92:95], v[76:79], v[144:147]
    ds_read_b128 v[56:59], v5 offset:5120
    s_waitcnt lgkmcnt(8)
    ds_read_b128 v[60:63], v5 offset:7168
    v_mfma_f32_16x16x32_bf16 v[148:151], v[88:91], v[80:83], v[148:151]
    v_mfma_f32_16x16x32_bf16 v[152:155], v[92:95], v[80:83], v[152:155]
    v_mfma_f32_16x16x32_bf16 v[156:159], v[88:91], v[84:87], v[156:159]
    v_mfma_f32_16x16x32_bf16 v[160:163], v[92:95], v[84:87], v[160:163]
    s_waitcnt lgkmcnt(8)
    v_mfma_f32_16x16x32_bf16 v[132:135], v[40:43], v[24:27], v[132:135]
    v_mfma_f32_16x16x32_bf16 v[136:139], v[44:47], v[24:27], v[136:139]
    s_waitcnt lgkmcnt(0)
    s_barrier
    ds_read_b64_tr_b16 v[88:89], v8 offset:40960
    ds_read_b64_tr_b16 v[90:91], v8 offset:45056
    v_mfma_f32_16x16x32_bf16 v[140:143], v[40:43], v[28:31], v[140:143]
    ds_read_b128 v[72:75], v5 offset:40960
    ds_read_b64_tr_b16 v[92:93], v9 offset:40960
    v_mfma_f32_16x16x32_bf16 v[144:147], v[44:47], v[28:31], v[144:147]
    ds_read_b64_tr_b16 v[94:95], v9 offset:45056
    ds_read_b128 v[76:79], v5 offset:43008
    v_mfma_f32_16x16x32_bf16 v[148:151], v[40:43], v[32:35], v[148:151]
    ds_read_b128 v[80:83], v5 offset:45056
    ds_read_b128 v[84:87], v5 offset:47104
    v_mfma_f32_16x16x32_bf16 v[152:155], v[44:47], v[32:35], v[152:155]
    v_mfma_f32_16x16x32_bf16 v[156:159], v[40:43], v[36:39], v[156:159]
    v_mfma_f32_16x16x32_bf16 v[160:163], v[44:47], v[36:39], v[160:163]
    v_mfma_f32_16x16x32_bf16 v[132:135], v[64:67], v[48:51], v[132:135]
    ds_read_b64_tr_b16 v[40:41], v8 offset:49152
    ds_read_b64_tr_b16 v[42:43], v8 offset:53248
    v_mfma_f32_16x16x32_bf16 v[136:139], v[68:71], v[48:51], v[136:139]
    ds_read_b128 v[24:27], v5 offset:41984
    ds_read_b64_tr_b16 v[44:45], v9 offset:49152
    v_mfma_f32_16x16x32_bf16 v[140:143], v[64:67], v[52:55], v[140:143]
    ds_read_b64_tr_b16 v[46:47], v9 offset:53248
    ds_read_b128 v[28:31], v5 offset:44032
    v_mfma_f32_16x16x32_bf16 v[144:147], v[68:71], v[52:55], v[144:147]
    ds_read_b128 v[32:35], v5 offset:46080
    s_waitcnt lgkmcnt(8)
    ds_read_b128 v[36:39], v5 offset:48128
    v_mfma_f32_16x16x32_bf16 v[148:151], v[64:67], v[56:59], v[148:151]
    v_mfma_f32_16x16x32_bf16 v[152:155], v[68:71], v[56:59], v[152:155]
    v_mfma_f32_16x16x32_bf16 v[156:159], v[64:67], v[60:63], v[156:159]
    v_mfma_f32_16x16x32_bf16 v[160:163], v[68:71], v[60:63], v[160:163]
    s_waitcnt lgkmcnt(8)
    v_mfma_f32_16x16x32_bf16 v[132:135], v[88:91], v[72:75], v[132:135]
    v_mfma_f32_16x16x32_bf16 v[136:139], v[92:95], v[72:75], v[136:139]
    s_waitcnt lgkmcnt(0)
    s_barrier
    ds_read_b64_tr_b16 v[64:65], v10 offset:16384
    ds_read_b64_tr_b16 v[66:67], v10 offset:20480
    v_mfma_f32_16x16x32_bf16 v[140:143], v[88:91], v[76:79], v[140:143]
    ds_read_b128 v[48:51], v4 offset:40960
    ds_read_b64_tr_b16 v[68:69], v11 offset:16384
    v_mfma_f32_16x16x32_bf16 v[144:147], v[92:95], v[76:79], v[144:147]
    ds_read_b64_tr_b16 v[70:71], v11 offset:20480
    ds_read_b128 v[52:55], v4 offset:43008
    v_mfma_f32_16x16x32_bf16 v[148:151], v[88:91], v[80:83], v[148:151]
    ds_read_b128 v[56:59], v4 offset:45056
    ds_read_b128 v[60:63], v4 offset:47104
    v_mfma_f32_16x16x32_bf16 v[152:155], v[92:95], v[80:83], v[152:155]
    v_mfma_f32_16x16x32_bf16 v[156:159], v[88:91], v[84:87], v[156:159]
    v_mfma_f32_16x16x32_bf16 v[160:163], v[92:95], v[84:87], v[160:163]
    v_mfma_f32_16x16x32_bf16 v[132:135], v[40:43], v[24:27], v[132:135]
    ds_read_b64_tr_b16 v[88:89], v10 offset:24576
    ds_read_b64_tr_b16 v[90:91], v10 offset:28672
    v_mfma_f32_16x16x32_bf16 v[136:139], v[44:47], v[24:27], v[136:139]
    ds_read_b128 v[72:75], v4 offset:41984
    ds_read_b64_tr_b16 v[92:93], v11 offset:24576
    v_mfma_f32_16x16x32_bf16 v[140:143], v[40:43], v[28:31], v[140:143]
    ds_read_b64_tr_b16 v[94:95], v11 offset:28672
    ds_read_b128 v[76:79], v4 offset:44032
    v_mfma_f32_16x16x32_bf16 v[144:147], v[44:47], v[28:31], v[144:147]
    ds_read_b128 v[80:83], v4 offset:46080
    s_waitcnt lgkmcnt(8)
    ds_read_b128 v[84:87], v4 offset:48128
    v_mfma_f32_16x16x32_bf16 v[148:151], v[40:43], v[32:35], v[148:151]
    v_mfma_f32_16x16x32_bf16 v[152:155], v[44:47], v[32:35], v[152:155]
    v_mfma_f32_16x16x32_bf16 v[156:159], v[40:43], v[36:39], v[156:159]
    v_mfma_f32_16x16x32_bf16 v[160:163], v[44:47], v[36:39], v[160:163]
    s_waitcnt lgkmcnt(8)
    v_mfma_f32_16x16x32_bf16 v[132:135], v[64:67], v[48:51], v[132:135]
    v_mfma_f32_16x16x32_bf16 v[136:139], v[68:71], v[48:51], v[136:139]
    s_waitcnt lgkmcnt(0)
    s_barrier
    ds_read_b64_tr_b16 v[40:41], v12 offset:0
    ds_read_b64_tr_b16 v[42:43], v12 offset:4096
    v_mfma_f32_16x16x32_bf16 v[140:143], v[64:67], v[52:55], v[140:143]
    ds_read_b128 v[24:27], v4 offset:0
    ds_read_b64_tr_b16 v[44:45], v13 offset:0
    v_mfma_f32_16x16x32_bf16 v[144:147], v[68:71], v[52:55], v[144:147]
    ds_read_b64_tr_b16 v[46:47], v13 offset:4096
    ds_read_b128 v[28:31], v4 offset:2048
    v_mfma_f32_16x16x32_bf16 v[148:151], v[64:67], v[56:59], v[148:151]
    ds_read_b128 v[32:35], v4 offset:4096
    ds_read_b128 v[36:39], v4 offset:6144
    v_mfma_f32_16x16x32_bf16 v[152:155], v[68:71], v[56:59], v[152:155]
    v_mfma_f32_16x16x32_bf16 v[156:159], v[64:67], v[60:63], v[156:159]
    v_mfma_f32_16x16x32_bf16 v[160:163], v[68:71], v[60:63], v[160:163]
    v_mfma_f32_16x16x32_bf16 v[132:135], v[88:91], v[72:75], v[132:135]
    ds_read_b64_tr_b16 v[64:65], v12 offset:8192
    ds_read_b64_tr_b16 v[66:67], v12 offset:12288
    v_mfma_f32_16x16x32_bf16 v[136:139], v[92:95], v[72:75], v[136:139]
    ds_read_b128 v[48:51], v4 offset:1024
    ds_read_b64_tr_b16 v[68:69], v13 offset:8192
    v_mfma_f32_16x16x32_bf16 v[140:143], v[88:91], v[76:79], v[140:143]
    ds_read_b64_tr_b16 v[70:71], v13 offset:12288
    ds_read_b128 v[52:55], v4 offset:3072
    v_mfma_f32_16x16x32_bf16 v[144:147], v[92:95], v[76:79], v[144:147]
    ds_read_b128 v[56:59], v4 offset:5120
    s_waitcnt lgkmcnt(8)
    ds_read_b128 v[60:63], v4 offset:7168
    v_mfma_f32_16x16x32_bf16 v[148:151], v[88:91], v[80:83], v[148:151]
    v_mfma_f32_16x16x32_bf16 v[152:155], v[92:95], v[80:83], v[152:155]
    v_mfma_f32_16x16x32_bf16 v[156:159], v[88:91], v[84:87], v[156:159]
    v_mfma_f32_16x16x32_bf16 v[160:163], v[92:95], v[84:87], v[160:163]
    s_waitcnt lgkmcnt(8)
    v_mfma_f32_16x16x32_bf16 v[132:135], v[40:43], v[24:27], v[132:135]
    v_mfma_f32_16x16x32_bf16 v[136:139], v[44:47], v[24:27], v[136:139]
    s_waitcnt lgkmcnt(0)
    s_barrier
    ds_read_b64_tr_b16 v[88:89], v10 offset:40960
    ds_read_b64_tr_b16 v[90:91], v10 offset:45056
    v_mfma_f32_16x16x32_bf16 v[140:143], v[40:43], v[28:31], v[140:143]
    ds_read_b128 v[72:75], v5 offset:0
    ds_read_b64_tr_b16 v[92:93], v11 offset:40960
    v_mfma_f32_16x16x32_bf16 v[144:147], v[44:47], v[28:31], v[144:147]
    ds_read_b64_tr_b16 v[94:95], v11 offset:45056
    ds_read_b128 v[76:79], v5 offset:2048
    v_mfma_f32_16x16x32_bf16 v[148:151], v[40:43], v[32:35], v[148:151]
    ds_read_b128 v[80:83], v5 offset:4096
    ds_read_b128 v[84:87], v5 offset:6144
    v_mfma_f32_16x16x32_bf16 v[152:155], v[44:47], v[32:35], v[152:155]
    v_mfma_f32_16x16x32_bf16 v[156:159], v[40:43], v[36:39], v[156:159]
    v_mfma_f32_16x16x32_bf16 v[160:163], v[44:47], v[36:39], v[160:163]
    v_mfma_f32_16x16x32_bf16 v[132:135], v[64:67], v[48:51], v[132:135]
    ds_read_b64_tr_b16 v[40:41], v10 offset:49152
    ds_read_b64_tr_b16 v[42:43], v10 offset:53248
    v_mfma_f32_16x16x32_bf16 v[136:139], v[68:71], v[48:51], v[136:139]
    ds_read_b128 v[24:27], v5 offset:1024
    ds_read_b64_tr_b16 v[44:45], v11 offset:49152
    v_mfma_f32_16x16x32_bf16 v[140:143], v[64:67], v[52:55], v[140:143]
    ds_read_b64_tr_b16 v[46:47], v11 offset:53248
    ds_read_b128 v[28:31], v5 offset:3072
    v_mfma_f32_16x16x32_bf16 v[144:147], v[68:71], v[52:55], v[144:147]
    ds_read_b128 v[32:35], v5 offset:5120
    s_waitcnt lgkmcnt(8)
    ds_read_b128 v[36:39], v5 offset:7168
    v_mfma_f32_16x16x32_bf16 v[148:151], v[64:67], v[56:59], v[148:151]
    v_mfma_f32_16x16x32_bf16 v[152:155], v[68:71], v[56:59], v[152:155]
    v_mfma_f32_16x16x32_bf16 v[156:159], v[64:67], v[60:63], v[156:159]
    v_mfma_f32_16x16x32_bf16 v[160:163], v[68:71], v[60:63], v[160:163]
    s_waitcnt lgkmcnt(8)
    v_mfma_f32_16x16x32_bf16 v[132:135], v[88:91], v[72:75], v[132:135]
    v_mfma_f32_16x16x32_bf16 v[136:139], v[92:95], v[72:75], v[136:139]
    s_waitcnt lgkmcnt(0)
    s_barrier
    ds_read_b64_tr_b16 v[64:65], v12 offset:24576
    ds_read_b64_tr_b16 v[66:67], v12 offset:28672
    v_mfma_f32_16x16x32_bf16 v[140:143], v[88:91], v[76:79], v[140:143]
    ds_read_b128 v[48:51], v5 offset:40960
    ds_read_b64_tr_b16 v[68:69], v13 offset:24576
    v_mfma_f32_16x16x32_bf16 v[144:147], v[92:95], v[76:79], v[144:147]
    ds_read_b64_tr_b16 v[70:71], v13 offset:28672
    ds_read_b128 v[52:55], v5 offset:43008
    v_mfma_f32_16x16x32_bf16 v[148:151], v[88:91], v[80:83], v[148:151]
    ds_read_b128 v[56:59], v5 offset:45056
    ds_read_b128 v[60:63], v5 offset:47104
    v_mfma_f32_16x16x32_bf16 v[152:155], v[92:95], v[80:83], v[152:155]
    v_mfma_f32_16x16x32_bf16 v[156:159], v[88:91], v[84:87], v[156:159]
    v_mfma_f32_16x16x32_bf16 v[160:163], v[92:95], v[84:87], v[160:163]
    v_mfma_f32_16x16x32_bf16 v[132:135], v[40:43], v[24:27], v[132:135]
    ds_read_b64_tr_b16 v[88:89], v12 offset:32768
    ds_read_b64_tr_b16 v[90:91], v12 offset:36864
    v_mfma_f32_16x16x32_bf16 v[136:139], v[44:47], v[24:27], v[136:139]
    ds_read_b128 v[72:75], v5 offset:41984
    ds_read_b64_tr_b16 v[92:93], v13 offset:32768
    v_mfma_f32_16x16x32_bf16 v[140:143], v[40:43], v[28:31], v[140:143]
    ds_read_b64_tr_b16 v[94:95], v13 offset:36864
    ds_read_b128 v[76:79], v5 offset:44032
    v_mfma_f32_16x16x32_bf16 v[144:147], v[44:47], v[28:31], v[144:147]
    ds_read_b128 v[80:83], v5 offset:46080
    s_waitcnt lgkmcnt(8)
    ds_read_b128 v[84:87], v5 offset:48128
    v_mfma_f32_16x16x32_bf16 v[148:151], v[40:43], v[32:35], v[148:151]
    v_mfma_f32_16x16x32_bf16 v[152:155], v[44:47], v[32:35], v[152:155]
    v_mfma_f32_16x16x32_bf16 v[156:159], v[40:43], v[36:39], v[156:159]
    v_mfma_f32_16x16x32_bf16 v[160:163], v[44:47], v[36:39], v[160:163]
    s_waitcnt lgkmcnt(8)
    v_mfma_f32_16x16x32_bf16 v[132:135], v[64:67], v[48:51], v[132:135]
    v_mfma_f32_16x16x32_bf16 v[136:139], v[68:71], v[48:51], v[136:139]
    s_waitcnt lgkmcnt(0)
    s_barrier
    ds_read_b64_tr_b16 v[40:41], v10 offset:0
    ds_read_b64_tr_b16 v[42:43], v10 offset:4096
    v_mfma_f32_16x16x32_bf16 v[140:143], v[64:67], v[52:55], v[140:143]
    ds_read_b128 v[24:27], v4 offset:40960
    ds_read_b64_tr_b16 v[44:45], v11 offset:0
    v_mfma_f32_16x16x32_bf16 v[144:147], v[68:71], v[52:55], v[144:147]
    ds_read_b64_tr_b16 v[46:47], v11 offset:4096
    ds_read_b128 v[28:31], v4 offset:43008
    v_mfma_f32_16x16x32_bf16 v[148:151], v[64:67], v[56:59], v[148:151]
    ds_read_b128 v[32:35], v4 offset:45056
    ds_read_b128 v[36:39], v4 offset:47104
    v_mfma_f32_16x16x32_bf16 v[152:155], v[68:71], v[56:59], v[152:155]
    v_mfma_f32_16x16x32_bf16 v[156:159], v[64:67], v[60:63], v[156:159]
    v_mfma_f32_16x16x32_bf16 v[160:163], v[68:71], v[60:63], v[160:163]
    v_mfma_f32_16x16x32_bf16 v[132:135], v[88:91], v[72:75], v[132:135]
    ds_read_b64_tr_b16 v[64:65], v10 offset:8192
    ds_read_b64_tr_b16 v[66:67], v10 offset:12288
    v_mfma_f32_16x16x32_bf16 v[136:139], v[92:95], v[72:75], v[136:139]
    ds_read_b128 v[48:51], v4 offset:41984
    ds_read_b64_tr_b16 v[68:69], v11 offset:8192
    v_mfma_f32_16x16x32_bf16 v[140:143], v[88:91], v[76:79], v[140:143]
    ds_read_b64_tr_b16 v[70:71], v11 offset:12288
    ds_read_b128 v[52:55], v4 offset:44032
    v_mfma_f32_16x16x32_bf16 v[144:147], v[92:95], v[76:79], v[144:147]
    ds_read_b128 v[56:59], v4 offset:46080
    s_waitcnt lgkmcnt(8)
    ds_read_b128 v[60:63], v4 offset:48128
    v_mfma_f32_16x16x32_bf16 v[148:151], v[88:91], v[80:83], v[148:151]
    v_mfma_f32_16x16x32_bf16 v[152:155], v[92:95], v[80:83], v[152:155]
    v_mfma_f32_16x16x32_bf16 v[156:159], v[88:91], v[84:87], v[156:159]
    v_mfma_f32_16x16x32_bf16 v[160:163], v[92:95], v[84:87], v[160:163]
    s_waitcnt lgkmcnt(0)
    s_cmp_eq_u32 s77, 0
    s_cbranch_scc0 F_y
F_fin:
    v_mfma_f32_16x16x32_bf16 v[132:135], v[40:43], v[24:27], v[132:135]
    v_mfma_f32_16x16x32_bf16 v[136:139], v[44:47], v[24:27], v[136:139]
    v_mfma_f32_16x16x32_bf16 v[132:135], v[64:67], v[48:51], v[132:135]
    v_mfma_f32_16x16x32_bf16 v[136:139], v[68:71], v[48:51], v[136:139]
    v_mfma_f32_16x16x32_bf16 v[140:143], v[40:43], v[28:31], v[140:143]
    v_mfma_f32_16x16x32_bf16 v[144:147], v[44:47], v[28:31], v[144:147]
    s_nop 5
    v_permlane16_swap_b32 v132, v136
    v_permlane16_swap_b32 v133, v137
    v_permlane16_swap_b32 v134, v138
    v_mfma_f32_16x16x32_bf16 v[140:143], v[64:67], v[52:55], v[140:143]
    v_permlane16_swap_b32 v135, v139
    v_cvt_pk_bf16_f32 v96, v132, v133
    v_cvt_pk_bf16_f32 v97, v134, v135
    v_mfma_f32_16x16x32_bf16 v[144:147], v[68:71], v[52:55], v[144:147]
    v_cvt_pk_bf16_f32 v98, v136, v137
    v_cvt_pk_bf16_f32 v99, v138, v139
    s_add_u32 s44, s42, 0
    buffer_store_dwordx4 v[96:99], v167, s[52:55], s44 offen sc1
    v_mfma_f32_16x16x32_bf16 v[148:151], v[40:43], v[32:35], v[148:151]
    v_mfma_f32_16x16x32_bf16 v[152:155], v[44:47], v[32:35], v[152:155]
    s_nop 1
    v_permlane16_swap_b32 v140, v144
    v_permlane16_swap_b32 v141, v145
    v_permlane16_swap_b32 v142, v146
    v_mfma_f32_16x16x32_bf16 v[148:151], v[64:67], v[56:59], v[148:151]
    v_permlane16_swap_b32 v143, v147
    v_cvt_pk_bf16_f32 v100, v140, v141
    v_cvt_pk_bf16_f32 v101, v142, v143
    v_mfma_f32_16x16x32_bf16 v[152:155], v[68:71], v[56:59], v[152:155]
    v_cvt_pk_bf16_f32 v102, v144, v145
    v_cvt_pk_bf16_f32 v103, v146, v147
    s_add_u32 s44, s42, 32768
    buffer_store_dwordx4 v[100:103], v167, s[52:55], s44 offen sc1
    v_mfma_f32_16x16x32_bf16 v[156:159], v[40:43], v[36:39], v[156:159]
    v_mfma_f32_16x16x32_bf16 v[160:163], v[44:47], v[36:39], v[160:163]
    s_nop 1
    v_permlane16_swap_b32 v148, v152
    v_permlane16_swap_b32 v149, v153
    v_permlane16_swap_b32 v150, v154
    v_mfma_f32_16x16x32_bf16 v[156:159], v[64:67], v[60:63], v[156:159]
    v_permlane16_swap_b32 v151, v155
    v_cvt_pk_bf16_f32 v104, v148, v149
    v_cvt_pk_bf16_f32 v105, v150, v151
    v_mfma_f32_16x16x32_bf16 v[160:163], v[68:71], v[60:63], v[160:163]
    v_cvt_pk_bf16_f32 v106, v152, v153
    v_cvt_pk_bf16_f32 v107, v154, v155
    s_add_u32 s44, s42, 65536
    buffer_store_dwordx4 v[104:107], v167, s[52:55], s44 offen sc1
    s_nop 3
    v_permlane16_swap_b32 v156, v160
    v_permlane16_swap_b32 v157, v161
    v_permlane16_swap_b32 v158, v162
    v_permlane16_swap_b32 v159, v163
    v_cvt_pk_bf16_f32 v108, v156, v157
    v_cvt_pk_bf16_f32 v109, v158, v159
    v_cvt_pk_bf16_f32 v110, v160, v161
    v_cvt_pk_bf16_f32 v111, v162, v163
    s_add_u32 s44, s42, 98304
    buffer_store_dwordx4 v[108:111], v167, s[52:55], s44 offen sc1
F_end:
    s_endpgm
F_y:
    s_nop 0
    ds_read_b32 v7, v6
    ds_read_b128 v[72:75], v128 offset:0
    ds_read_b128 v[76:79], v128 offset:64
    ds_read_b128 v[80:83], v129 offset:0
    ds_read_b128 v[84:87], v129 offset:64
    ds_read_b128 v[88:91], v130 offset:0
    ds_read_b128 v[92:95], v130 offset:64
    ds_read_b128 v[96:99], v131 offset:0
    ds_read_b128 v[100:103], v131 offset:64
    s_waitcnt lgkmcnt(8)
    v_cmp_gt_u32 vcc, 9, v7
    s_waitcnt lgkmcnt(0)
    s_cbranch_vccnz F_y
    s_mov_b64 exec, s[60:61]
    v_fmac_f32 v132, v72, v14
    v_fmac_f32 v133, v73, v14
    v_fmac_f32 v134, v74, v14
    v_fmac_f32 v135, v75, v14
    v_fmac_f32 v136, v76, v14
    v_fmac_f32 v137, v77, v14
    v_fmac_f32 v138, v78, v14
    v_fmac_f32 v139, v79, v14
    s_mov_b64 exec, s[62:63]
    v_fmac_f32 v140, v80, v15
    v_fmac_f32 v141, v81, v15
    v_fmac_f32 v142, v82, v15
    v_fmac_f32 v143, v83, v15
    v_fmac_f32 v144, v84, v15
    v_fmac_f32 v145, v85, v15
    v_fmac_f32 v146, v86, v15
    v_fmac_f32 v147, v87, v15
    s_mov_b64 exec, s[64:65]
    v_fmac_f32 v148, v88, v16
    v_fmac_f32 v149, v89, v16
    v_fmac_f32 v150, v90, v16
    v_fmac_f32 v151, v91, v16
    v_fmac_f32 v152, v92, v16
    v_fmac_f32 v153, v93, v16
    v_fmac_f32 v154, v94, v16
    v_fmac_f32 v155, v95, v16
    s_mov_b64 exec, s[66:67]
    v_fmac_f32 v156, v96, v17
    v_fmac_f32 v157, v97, v17
    v_fmac_f32 v158, v98, v17
    v_fmac_f32 v159, v99, v17
    v_fmac_f32 v160, v100, v17
    v_fmac_f32 v161, v101, v17
    v_fmac_f32 v162, v102, v17
    v_fmac_f32 v163, v103, v17
    s_mov_b64 exec, -1
    s_nop 1
    s_branch F_fin
F_ys:
    s_mov_b32 s48, 0xbfb8aa3b
    s_lshl_b32 s44, s3, 7
    s_add_u32 s44, s44, 27648
    v_and_or_b32 v63, v0, 48, s44
    v_mov_b32 v6, 24736

    v_cmp_ne_u32 s[60:61], 0, v128
    v_and_b32 v14, 0xffff0000, v128
    v_ashrrev_i32 v7, 31, v14
    v_not_b32 v7, v7
    v_or_b32 v7, 0x80000000, v7
    v_xor_b32 v14, v14, v7
    v_and_b32 v14, 0xffff0000, v14
    v_mul_f32 v14, s48, v14
    v_exp_f32 v14, v14
    s_nop 0
    v_add_f32 v14, 1.0, v14
    v_rcp_f32 v14, v14
    s_nop 0
    v_cvt_pk_bf16_f32 v14, v14, v14
    v_lshlrev_b32 v14, 16, v14
    v_bfe_u32 v128, v128, 11, 3
    v_lshl_add_u32 v128, v128, 9, v63
    v_cmp_ne_u32 s[62:63], 0, v129
    v_and_b32 v15, 0xffff0000, v129
    v_ashrrev_i32 v7, 31, v15
    v_not_b32 v7, v7
    v_or_b32 v7, 0x80000000, v7
    v_xor_b32 v15, v15, v7
    v_and_b32 v15, 0xffff0000, v15
    v_mul_f32 v15, s48, v15
    v_exp_f32 v15, v15
    s_nop 0
    v_add_f32 v15, 1.0, v15
    v_rcp_f32 v15, v15
    s_nop 0
    v_cvt_pk_bf16_f32 v15, v15, v15
    v_lshlrev_b32 v15, 16, v15
    v_bfe_u32 v129, v129, 11, 3
    v_lshl_add_u32 v129, v129, 9, v63
    v_cmp_ne_u32 s[64:65], 0, v130
    v_and_b32 v16, 0xffff0000, v130
    v_ashrrev_i32 v7, 31, v16
    v_not_b32 v7, v7
    v_or_b32 v7, 0x80000000, v7
    v_xor_b32 v16, v16, v7
    v_and_b32 v16, 0xffff0000, v16
    v_mul_f32 v16, s48, v16
    v_exp_f32 v16, v16
    s_nop 0
    v_add_f32 v16, 1.0, v16
    v_rcp_f32 v16, v16
    s_nop 0
    v_cvt_pk_bf16_f32 v16, v16, v16
    v_lshlrev_b32 v16, 16, v16
    v_bfe_u32 v130, v130, 11, 3
    v_lshl_add_u32 v130, v130, 9, v63
    v_cmp_ne_u32 s[66:67], 0, v131
    v_and_b32 v17, 0xffff0000, v131
    v_ashrrev_i32 v7, 31, v17
    v_not_b32 v7, v7
    v_or_b32 v7, 0x80000000, v7
    v_xor_b32 v17, v17, v7
    v_and_b32 v17, 0xffff0000, v17
    v_mul_f32 v17, s48, v17
    v_exp_f32 v17, v17
    s_nop 0
    v_add_f32 v17, 1.0, v17
    v_rcp_f32 v17, v17
    s_nop 0
    v_cvt_pk_bf16_f32 v17, v17, v17
    v_lshlrev_b32 v17, 16, v17
    v_bfe_u32 v131, v131, 11, 3
    v_lshl_add_u32 v131, v131, 9, v63
    s_branch F_ys1
F_loader:
    s_mov_b32 s48, 0x76542130
    s_mov_b32 s49, 0xfedca9b8
    s_cmp_eq_u32 s35, 1
    s_cselect_b32 s48, 0x75463021, s48
    s_cselect_b32 s49, 0xfdceba98, s49
    s_cmp_eq_u32 s35, 2
    s_cselect_b32 s48, 0x96543102, s48
    s_cselect_b32 s49, 0xfedcba87, s49
    s_cmp_eq_u32 s35, 3
    s_cselect_b32 s48, 0x76532410, s48
    s_cselect_b32 s49, 0xfedbac98, s49
    s_cmp_eq_u32 s35, 4
    s_cselect_b32 s48, 0x65743021, s48
    s_cselect_b32 s49, 0xedfcba98, s49
    s_cmp_eq_u32 s35, 5
    s_cselect_b32 s48, 0x76543102, s48
    s_cselect_b32 s49, 0xfedcb98a, s49
    s_cmp_eq_u32 s35, 6
    s_cselect_b32 s48, 0x76435210, s48
    s_cselect_b32 s49, 0xfecbda98, s49
    s_cmp_eq_u32 s35, 7
    s_cselect_b32 s48, 0x68543021, s48
    s_cselect_b32 s49, 0xfedcba97, s49
    s_setprio 0
    s_sub_u32 s3, s3, 8
    v_lshrrev_b32 v2, 3, v0
    v_and_b32 v3, 7, v0
    v_lshrrev_b32 v4, 1, v2
    v_xor_b32 v5, v3, v4
    v_xor_b32 v6, 4, v5
    v_lshlrev_b32 v5, 4, v5
    v_lshlrev_b32 v6, 4, v6
    v_lshlrev_b32 v7, 11, v2
    v_add_u32 v12, v5, v7
    v_add_u32 v13, v6, v7
    v_and_b32 v4, 1, v4
    v_lshlrev_b32 v4, 1, v4
    v_xor_b32 v8, v3, v4
    v_xor_b32 v9, 4, v8
    v_lshlrev_b32 v8, 4, v8
    v_lshlrev_b32 v9, 4, v9
    v_mul_u32_u24 v7, 6144, v2
    v_add_u32 v14, v8, v7
    v_add_u32_e64 v15, v9, v7
    s_lshl_b32 s36, s32, 18
    s_lshl_b32 s37, s3, 16
    s_add_u32 s36, s36, s37
    s_lshl_b32 s38, s33, 7
    s_mul_i32 s37, s3, 98304
    s_add_u32 s38, s38, s37
    s_sub_u32 s47, s10, s33
    s_lshl_b32 s47, s47, 7
    s_and_b32 s42, s39, 8
    s_and_b32 s43, s30, 6
    s_or_b32 s42, s42, s43
    s_lshl_b32 s44, s3, 12
    s_lshl_b32 s45, s3, 11
    s_waitcnt lgkmcnt(0)
    s_mov_b32 s12, s4
    s_mov_b32 s13, s5
    s_mov_b32 s14, 0x400000
    s_mov_b32 s15, 0x00020000
    s_mov_b32 s16, s6
    s_mov_b32 s17, s7
    s_mov_b32 s18, 0x600000
    s_mov_b32 s19, 0x00020000
    s_bfe_u32 s40, s48, 0x40000
    s_bitcmp1_b32 s40, 3
    s_cselect_b32 s41, s39, s42
    s_xor_b32 s40, s40, s41
    s_mul_i32 s41, s40, 393216
    s_add_u32 s41, s41, s38
    s_lshl_b32 s40, s40, 7
    s_add_u32 s40, s40, s36
    s_add_u32 m0, s44, 0
    s_add_u32 s46, s40, 0
    buffer_load_dwordx4 v12, s[12:15], s46 offen lds
    s_add_u32 m0, s44, 1024
    s_add_u32 s46, s40, 16384
    buffer_load_dwordx4 v13, s[12:15], s46 offen lds
    s_add_u32 m0, s44, 2048
    s_add_u32 s46, s40, 32768
    buffer_load_dwordx4 v12, s[12:15], s46 offen lds
    s_add_u32 m0, s44, 3072
    s_add_u32 s46, s40, 49152
    buffer_load_dwordx4 v13, s[12:15], s46 offen lds
    s_add_u32 m0, s45, 16384
    s_add_u32 s46, s41, 0
    s_add_u32 s46, s46, s47
    buffer_load_dwordx4 v14, s[16:19], s46 offen lds
    s_add_u32 m0, s45, 17408
    s_add_u32 s46, s41, 49152
    s_add_u32 s46, s46, s47
    s_nop 0
    buffer_load_dwordx4 v15, s[16:19], s46 offen lds
    s_add_u32 m0, s45, 24576
    s_add_u32 s46, s41, 2048
    buffer_load_dwordx4 v14, s[16:19], s46 offen lds
    s_add_u32 m0, s45, 25600
    s_add_u32 s46, s41, 51200
    buffer_load_dwordx4 v15, s[16:19], s46 offen lds
    s_add_u32 m0, s45, 32768
    s_add_u32 s46, s41, 4096
    buffer_load_dwordx4 v14, s[16:19], s46 offen lds
    s_add_u32 m0, s45, 33792
    s_add_u32 s46, s41, 53248
    buffer_load_dwordx4 v15, s[16:19], s46 offen lds
    s_bfe_u32 s40, s48, 0x40004
    s_bitcmp1_b32 s40, 3
    s_cselect_b32 s41, s39, s42
    s_xor_b32 s40, s40, s41
    s_mul_i32 s41, s40, 393216
    s_add_u32 s41, s41, s38
    s_lshl_b32 s40, s40, 7
    s_add_u32 s40, s40, s36
    s_add_u32 m0, s44, 40960
    s_add_u32 s46, s40, 0
    s_nop 0
    buffer_load_dwordx4 v12, s[12:15], s46 offen lds
    s_add_u32 m0, s44, 41984
    s_add_u32 s46, s40, 16384
    buffer_load_dwordx4 v13, s[12:15], s46 offen lds
    s_add_u32 m0, s44, 43008
    s_add_u32 s46, s40, 32768
    buffer_load_dwordx4 v12, s[12:15], s46 offen lds
    s_add_u32 m0, s44, 44032
    s_add_u32 s46, s40, 49152
    buffer_load_dwordx4 v13, s[12:15], s46 offen lds
    s_add_u32 m0, s45, 57344
    s_add_u32 s46, s41, 0
    s_add_u32 s46, s46, s47
    buffer_load_dwordx4 v14, s[16:19], s46 offen lds
    s_add_u32 m0, s45, 58368
    s_add_u32 s46, s41, 49152
    s_add_u32 s46, s46, s47
    s_nop 0
    buffer_load_dwordx4 v15, s[16:19], s46 offen lds
    s_add_u32 m0, s45, 65536
    s_add_u32 s46, s41, 2048
    buffer_load_dwordx4 v14, s[16:19], s46 offen lds
    s_add_u32 m0, s45, 66560
    s_add_u32 s46, s41, 51200
    buffer_load_dwordx4 v15, s[16:19], s46 offen lds
    s_waitcnt vmcnt(8)
    s_barrier
    s_add_u32 m0, s45, 73728
    s_add_u32 s46, s41, 4096
    buffer_load_dwordx4 v14, s[16:19], s46 offen lds
    s_add_u32 m0, s45, 74752
    s_add_u32 s46, s41, 53248
    buffer_load_dwordx4 v15, s[16:19], s46 offen lds
    s_bfe_u32 s40, s48, 0x40008
    s_bitcmp1_b32 s40, 3
    s_cselect_b32 s41, s39, s42
    s_xor_b32 s40, s40, s41
    s_mul_i32 s41, s40, 393216
    s_add_u32 s41, s41, s38
    s_lshl_b32 s40, s40, 7
    s_add_u32 s40, s40, s36
    s_add_u32 m0, s44, 81920
    s_add_u32 s46, s40, 0
    s_nop 0
    buffer_load_dwordx4 v12, s[12:15], s46 offen lds
    s_add_u32 m0, s44, 82944
    s_add_u32 s46, s40, 16384
    buffer_load_dwordx4 v13, s[12:15], s46 offen lds
    s_add_u32 m0, s44, 83968
    s_add_u32 s46, s40, 32768
    buffer_load_dwordx4 v12, s[12:15], s46 offen lds
    s_add_u32 m0, s44, 84992
    s_add_u32 s46, s40, 49152
    buffer_load_dwordx4 v13, s[12:15], s46 offen lds
    s_add_u32 m0, s45, 98304
    s_add_u32 s46, s41, 0
    s_add_u32 s46, s46, s47
    buffer_load_dwordx4 v14, s[16:19], s46 offen lds
    s_add_u32 m0, s45, 99328
    s_add_u32 s46, s41, 49152
    s_add_u32 s46, s46, s47
    s_nop 0
    buffer_load_dwordx4 v15, s[16:19], s46 offen lds
    s_add_u32 m0, s45, 106496
    s_add_u32 s46, s41, 2048
    buffer_load_dwordx4 v14, s[16:19], s46 offen lds
    s_add_u32 m0, s45, 107520
    s_add_u32 s46, s41, 51200
    buffer_load_dwordx4 v15, s[16:19], s46 offen lds
    s_add_u32 m0, s45, 114688
    s_add_u32 s46, s41, 4096
    buffer_load_dwordx4 v14, s[16:19], s46 offen lds
    s_add_u32 m0, s45, 115712
    s_add_u32 s46, s41, 53248
    buffer_load_dwordx4 v15, s[16:19], s46 offen lds
    s_waitcnt vmcnt(10)
    s_barrier
    s_bfe_u32 s40, s48, 0x4000c
    s_bitcmp1_b32 s40, 3
    s_cselect_b32 s41, s39, s42
    s_xor_b32 s40, s40, s41
    s_mul_i32 s41, s40, 393216
    s_add_u32 s41, s41, s38
    s_lshl_b32 s40, s40, 7
    s_add_u32 s40, s40, s36
    s_add_u32 m0, s44, 122880
    s_add_u32 s46, s40, 0
    s_nop 0
    buffer_load_dwordx4 v12, s[12:15], s46 offen lds
    s_add_u32 m0, s44, 123904
    s_add_u32 s46, s40, 16384
    buffer_load_dwordx4 v13, s[12:15], s46 offen lds
    s_add_u32 m0, s44, 124928
    s_add_u32 s46, s40, 32768
    buffer_load_dwordx4 v12, s[12:15], s46 offen lds
    s_add_u32 m0, s44, 125952
    s_add_u32 s46, s40, 49152
    buffer_load_dwordx4 v13, s[12:15], s46 offen lds
    s_add_u32 m0, s45, 139264
    s_add_u32 s46, s41, 0
    s_add_u32 s46, s46, s47
    buffer_load_dwordx4 v14, s[16:19], s46 offen lds
    s_add_u32 m0, s45, 140288
    s_add_u32 s46, s41, 49152
    s_add_u32 s46, s46, s47
    s_nop 0
    buffer_load_dwordx4 v15, s[16:19], s46 offen lds
    s_add_u32 m0, s45, 147456
    s_add_u32 s46, s41, 2048
    buffer_load_dwordx4 v14, s[16:19], s46 offen lds
    s_add_u32 m0, s45, 148480
    s_add_u32 s46, s41, 51200
    buffer_load_dwordx4 v15, s[16:19], s46 offen lds
    s_add_u32 m0, s45, 155648
    s_add_u32 s46, s41, 4096
    buffer_load_dwordx4 v14, s[16:19], s46 offen lds
    s_add_u32 m0, s45, 156672
    s_add_u32 s46, s41, 53248
    buffer_load_dwordx4 v15, s[16:19], s46 offen lds
    s_bfe_u32 s40, s48, 0x40010
    s_bitcmp1_b32 s40, 3
    s_cselect_b32 s41, s39, s42
    s_xor_b32 s40, s40, s41
    s_mul_i32 s41, s40, 393216
    s_add_u32 s41, s41, s38
    s_lshl_b32 s40, s40, 7
    s_add_u32 s40, s40, s36
    s_add_u32 m0, s44, 0
    s_add_u32 s46, s40, 0
    buffer_load_dwordx4 v12, s[12:15], s46 offen lds
    s_add_u32 m0, s44, 1024
    s_add_u32 s46, s40, 16384
    buffer_load_dwordx4 v13, s[12:15], s46 offen lds
    s_waitcnt vmcnt(12)
    s_barrier
    s_add_u32 m0, s44, 2048
    s_add_u32 s46, s40, 32768
    buffer_load_dwordx4 v12, s[12:15], s46 offen lds
    s_add_u32 m0, s44, 3072
    s_add_u32 s46, s40, 49152
    buffer_load_dwordx4 v13, s[12:15], s46 offen lds
    s_add_u32 m0, s45, 16384
    s_add_u32 s46, s41, 0
    s_add_u32 s46, s46, s47
    buffer_load_dwordx4 v14, s[16:19], s46 offen lds
    s_add_u32 m0, s45, 17408
    s_add_u32 s46, s41, 49152
    s_add_u32 s46, s46, s47
    s_nop 0
    buffer_load_dwordx4 v15, s[16:19], s46 offen lds
    s_add_u32 m0, s45, 24576
    s_add_u32 s46, s41, 2048
    buffer_load_dwordx4 v14, s[16:19], s46 offen lds
    s_add_u32 m0, s45, 25600
    s_add_u32 s46, s41, 51200
    buffer_load_dwordx4 v15, s[16:19], s46 offen lds
    s_add_u32 m0, s45, 32768
    s_add_u32 s46, s41, 4096
    buffer_load_dwordx4 v14, s[16:19], s46 offen lds
    s_add_u32 m0, s45, 33792
    s_add_u32 s46, s41, 53248
    buffer_load_dwordx4 v15, s[16:19], s46 offen lds
    s_bfe_u32 s40, s48, 0x40014
    s_bitcmp1_b32 s40, 3
    s_cselect_b32 s41, s39, s42
    s_xor_b32 s40, s40, s41
    s_mul_i32 s41, s40, 393216
    s_add_u32 s41, s41, s38
    s_lshl_b32 s40, s40, 7
    s_add_u32 s40, s40, s36
    s_add_u32 m0, s44, 40960
    s_add_u32 s46, s40, 0
    s_nop 0
    buffer_load_dwordx4 v12, s[12:15], s46 offen lds
    s_add_u32 m0, s44, 41984
    s_add_u32 s46, s40, 16384
    buffer_load_dwordx4 v13, s[12:15], s46 offen lds
    s_add_u32 m0, s44, 43008
    s_add_u32 s46, s40, 32768
    buffer_load_dwordx4 v12, s[12:15], s46 offen lds
    s_add_u32 m0, s44, 44032
    s_add_u32 s46, s40, 49152
    buffer_load_dwordx4 v13, s[12:15], s46 offen lds
    s_waitcnt vmcnt(14)
    s_barrier
    s_add_u32 m0, s45, 57344
    s_add_u32 s46, s41, 0
    s_add_u32 s46, s46, s47
    buffer_load_dwordx4 v14, s[16:19], s46 offen lds
    s_add_u32 m0, s45, 58368
    s_add_u32 s46, s41, 49152
    s_add_u32 s46, s46, s47
    s_nop 0
    buffer_load_dwordx4 v15, s[16:19], s46 offen lds
    s_add_u32 m0, s45, 65536
    s_add_u32 s46, s41, 2048
    buffer_load_dwordx4 v14, s[16:19], s46 offen lds
    s_add_u32 m0, s45, 66560
    s_add_u32 s46, s41, 51200
    buffer_load_dwordx4 v15, s[16:19], s46 offen lds
    s_add_u32 m0, s45, 73728
    s_add_u32 s46, s41, 4096
    buffer_load_dwordx4 v14, s[16:19], s46 offen lds
    s_add_u32 m0, s45, 74752
    s_add_u32 s46, s41, 53248
    buffer_load_dwordx4 v15, s[16:19], s46 offen lds
    s_bfe_u32 s40, s48, 0x40018
    s_bitcmp1_b32 s40, 3
    s_cselect_b32 s41, s39, s42
    s_xor_b32 s40, s40, s41
    s_mul_i32 s41, s40, 393216
    s_add_u32 s41, s41, s38
    s_lshl_b32 s40, s40, 7
    s_add_u32 s40, s40, s36
    s_add_u32 m0, s44, 81920
    s_add_u32 s46, s40, 0
    s_nop 0
    buffer_load_dwordx4 v12, s[12:15], s46 offen lds
    s_add_u32 m0, s44, 82944
    s_add_u32 s46, s40, 16384
    buffer_load_dwordx4 v13, s[12:15], s46 offen lds
    s_add_u32 m0, s44, 83968
    s_add_u32 s46, s40, 32768
    buffer_load_dwordx4 v12, s[12:15], s46 offen lds
    s_add_u32 m0, s44, 84992
    s_add_u32 s46, s40, 49152
    buffer_load_dwordx4 v13, s[12:15], s46 offen lds
    s_add_u32 m0, s45, 98304
    s_add_u32 s46, s41, 0
    s_add_u32 s46, s46, s47
    buffer_load_dwordx4 v14, s[16:19], s46 offen lds
    s_add_u32 m0, s45, 99328
    s_add_u32 s46, s41, 49152
    s_add_u32 s46, s46, s47
    buffer_load_dwordx4 v15, s[16:19], s46 offen lds
    s_waitcnt vmcnt(16)
    s_barrier
    s_nop 0
    s_add_u32 m0, s45, 106496
    s_add_u32 s46, s41, 2048
    buffer_load_dwordx4 v14, s[16:19], s46 offen lds
    s_add_u32 m0, s45, 107520
    s_add_u32 s46, s41, 51200
    buffer_load_dwordx4 v15, s[16:19], s46 offen lds
    s_add_u32 m0, s45, 114688
    s_add_u32 s46, s41, 4096
    buffer_load_dwordx4 v14, s[16:19], s46 offen lds
    s_add_u32 m0, s45, 115712
    s_add_u32 s46, s41, 53248
    buffer_load_dwordx4 v15, s[16:19], s46 offen lds
    s_bfe_u32 s40, s48, 0x4001c
    s_bitcmp1_b32 s40, 3
    s_cselect_b32 s41, s39, s42
    s_xor_b32 s40, s40, s41
    s_mul_i32 s41, s40, 393216
    s_add_u32 s41, s41, s38
    s_lshl_b32 s40, s40, 7
    s_add_u32 s40, s40, s36
    s_add_u32 m0, s44, 122880
    s_add_u32 s46, s40, 0
    s_nop 0
    buffer_load_dwordx4 v12, s[12:15], s46 offen lds
    s_add_u32 m0, s44, 123904
    s_add_u32 s46, s40, 16384
    buffer_load_dwordx4 v13, s[12:15], s46 offen lds
    s_add_u32 m0, s44, 124928
    s_add_u32 s46, s40, 32768
    buffer_load_dwordx4 v12, s[12:15], s46 offen lds
    s_add_u32 m0, s44, 125952
    s_add_u32 s46, s40, 49152
    buffer_load_dwordx4 v13, s[12:15], s46 offen lds
    s_add_u32 m0, s45, 139264
    s_add_u32 s46, s41, 0
    s_add_u32 s46, s46, s47
    buffer_load_dwordx4 v14, s[16:19], s46 offen lds
    s_add_u32 m0, s45, 140288
    s_add_u32 s46, s41, 49152
    s_add_u32 s46, s46, s47
    s_nop 0
    buffer_load_dwordx4 v15, s[16:19], s46 offen lds
    s_add_u32 m0, s45, 147456
    s_add_u32 s46, s41, 2048
    buffer_load_dwordx4 v14, s[16:19], s46 offen lds
    s_add_u32 m0, s45, 148480
    s_add_u32 s46, s41, 51200
    buffer_load_dwordx4 v15, s[16:19], s46 offen lds
    s_waitcnt vmcnt(18)
    s_barrier
    s_add_u32 m0, s45, 155648
    s_add_u32 s46, s41, 4096
    buffer_load_dwordx4 v14, s[16:19], s46 offen lds
    s_add_u32 m0, s45, 156672
    s_add_u32 s46, s41, 53248
    buffer_load_dwordx4 v15, s[16:19], s46 offen lds
    s_bfe_u32 s40, s49, 0x40000
    s_bitcmp1_b32 s40, 3
    s_cselect_b32 s41, s39, s42
    s_xor_b32 s40, s40, s41
    s_mul_i32 s41, s40, 393216
    s_add_u32 s41, s41, s38
    s_lshl_b32 s40, s40, 7
    s_add_u32 s40, s40, s36
    s_add_u32 m0, s44, 0
    s_add_u32 s46, s40, 0
    buffer_load_dwordx4 v12, s[12:15], s46 offen lds
    s_add_u32 m0, s44, 1024
    s_add_u32 s46, s40, 16384
    buffer_load_dwordx4 v13, s[12:15], s46 offen lds
    s_add_u32 m0, s44, 2048
    s_add_u32 s46, s40, 32768
    buffer_load_dwordx4 v12, s[12:15], s46 offen lds
    s_add_u32 m0, s44, 3072
    s_add_u32 s46, s40, 49152
    buffer_load_dwordx4 v13, s[12:15], s46 offen lds
    s_add_u32 m0, s45, 16384
    s_add_u32 s46, s41, 0
    s_add_u32 s46, s46, s47
    buffer_load_dwordx4 v14, s[16:19], s46 offen lds
    s_add_u32 m0, s45, 17408
    s_add_u32 s46, s41, 49152
    s_add_u32 s46, s46, s47
    s_nop 0
    buffer_load_dwordx4 v15, s[16:19], s46 offen lds
    s_add_u32 m0, s45, 24576
    s_add_u32 s46, s41, 2048
    buffer_load_dwordx4 v14, s[16:19], s46 offen lds
    s_add_u32 m0, s45, 25600
    s_add_u32 s46, s41, 51200
    buffer_load_dwordx4 v15, s[16:19], s46 offen lds
    s_add_u32 m0, s45, 32768
    s_add_u32 s46, s41, 4096
    buffer_load_dwordx4 v14, s[16:19], s46 offen lds
    s_add_u32 m0, s45, 33792
    s_add_u32 s46, s41, 53248
    buffer_load_dwordx4 v15, s[16:19], s46 offen lds
    s_waitcnt vmcnt(20)
    s_barrier
    s_bfe_u32 s40, s49, 0x40004
    s_bitcmp1_b32 s40, 3
    s_cselect_b32 s41, s39, s42
    s_xor_b32 s40, s40, s41
    s_mul_i32 s41, s40, 393216
    s_add_u32 s41, s41, s38
    s_lshl_b32 s40, s40, 7
    s_add_u32 s40, s40, s36
    s_add_u32 m0, s44, 40960
    s_add_u32 s46, s40, 0
    s_nop 0
    buffer_load_dwordx4 v12, s[12:15], s46 offen lds
    s_add_u32 m0, s44, 41984
    s_add_u32 s46, s40, 16384
    buffer_load_dwordx4 v13, s[12:15], s46 offen lds
    s_add_u32 m0, s44, 43008
    s_add_u32 s46, s40, 32768
    buffer_load_dwordx4 v12, s[12:15], s46 offen lds
    s_add_u32 m0, s44, 44032
    s_add_u32 s46, s40, 49152
    buffer_load_dwordx4 v13, s[12:15], s46 offen lds
    s_add_u32 m0, s45, 57344
    s_add_u32 s46, s41, 0
    s_add_u32 s46, s46, s47
    buffer_load_dwordx4 v14, s[16:19], s46 offen lds
    s_add_u32 m0, s45, 58368
    s_add_u32 s46, s41, 49152
    s_add_u32 s46, s46, s47
    s_nop 0
    buffer_load_dwordx4 v15, s[16:19], s46 offen lds
    s_add_u32 m0, s45, 65536
    s_add_u32 s46, s41, 2048
    buffer_load_dwordx4 v14, s[16:19], s46 offen lds
    s_add_u32 m0, s45, 66560
    s_add_u32 s46, s41, 51200
    buffer_load_dwordx4 v15, s[16:19], s46 offen lds
    s_add_u32 m0, s45, 73728
    s_add_u32 s46, s41, 4096
    buffer_load_dwordx4 v14, s[16:19], s46 offen lds
    s_add_u32 m0, s45, 74752
    s_add_u32 s46, s41, 53248
    buffer_load_dwordx4 v15, s[16:19], s46 offen lds
    s_mov_b32 s20, s8
    s_mov_b32 s21, s9
    s_mov_b32 s22, 0x200000
    s_mov_b32 s23, 0x00020000
    s_lshl_b32 s50, s2, 13
    s_lshl_b32 s51, s3, 11
    s_add_u32 s50, s50, s51
    v_lshlrev_b32 v104, 7, v0
    s_mov_b64 exec, 0xffff
    buffer_load_dword v112, v104, s[20:23], s50 offen
    s_mov_b64 exec, -1

    s_waitcnt vmcnt(21)
    s_barrier
    s_bfe_u32 s40, s49, 0x40008
    s_bitcmp1_b32 s40, 3
    s_cselect_b32 s41, s39, s42
    s_xor_b32 s40, s40, s41
    s_mul_i32 s41, s40, 393216
    s_add_u32 s41, s41, s38
    s_lshl_b32 s40, s40, 7
    s_add_u32 s40, s40, s36
    s_add_u32 m0, s44, 81920
    s_add_u32 s46, s40, 0
    buffer_load_dwordx4 v12, s[12:15], s46 offen lds
    s_add_u32 m0, s44, 82944
    s_add_u32 s46, s40, 16384
    buffer_load_dwordx4 v13, s[12:15], s46 offen lds
    s_add_u32 m0, s44, 83968
    s_add_u32 s46, s40, 32768
    buffer_load_dwordx4 v12, s[12:15], s46 offen lds
    s_add_u32 m0, s44, 84992
    s_add_u32 s46, s40, 49152
    buffer_load_dwordx4 v13, s[12:15], s46 offen lds
    s_add_u32 m0, s45, 98304
    s_add_u32 s46, s41, 0
    s_add_u32 s46, s46, s47
    buffer_load_dwordx4 v14, s[16:19], s46 offen lds
    s_add_u32 m0, s45, 99328
    s_add_u32 s46, s41, 49152
    s_add_u32 s46, s46, s47
    s_nop 0
    buffer_load_dwordx4 v15, s[16:19], s46 offen lds
    s_add_u32 m0, s45, 106496
    s_add_u32 s46, s41, 2048
    buffer_load_dwordx4 v14, s[16:19], s46 offen lds
    s_add_u32 m0, s45, 107520
    s_add_u32 s46, s41, 51200
    buffer_load_dwordx4 v15, s[16:19], s46 offen lds
    s_add_u32 m0, s45, 114688
    s_add_u32 s46, s41, 4096
    buffer_load_dwordx4 v14, s[16:19], s46 offen lds
    s_add_u32 m0, s45, 115712
    s_add_u32 s46, s41, 53248
    buffer_load_dwordx4 v15, s[16:19], s46 offen lds
    s_waitcnt vmcnt(21)
    s_barrier
    s_bfe_u32 s40, s49, 0x4000c
    s_bitcmp1_b32 s40, 3
    s_cselect_b32 s41, s39, s42
    s_xor_b32 s40, s40, s41
    s_mul_i32 s41, s40, 393216
    s_add_u32 s41, s41, s38
    s_lshl_b32 s40, s40, 7
    s_add_u32 s40, s40, s36
    s_add_u32 m0, s44, 122880
    s_add_u32 s46, s40, 0
    s_nop 0
    buffer_load_dwordx4 v12, s[12:15], s46 offen lds
    s_add_u32 m0, s44, 123904
    s_add_u32 s46, s40, 16384
    buffer_load_dwordx4 v13, s[12:15], s46 offen lds
    s_add_u32 m0, s44, 124928
    s_add_u32 s46, s40, 32768
    buffer_load_dwordx4 v12, s[12:15], s46 offen lds
    s_add_u32 m0, s44, 125952
    s_add_u32 s46, s40, 49152
    buffer_load_dwordx4 v13, s[12:15], s46 offen lds
    s_add_u32 m0, s45, 139264
    s_add_u32 s46, s41, 0
    s_add_u32 s46, s46, s47
    buffer_load_dwordx4 v14, s[16:19], s46 offen lds
    s_add_u32 m0, s45, 140288
    s_add_u32 s46, s41, 49152
    s_add_u32 s46, s46, s47
    s_nop 0
    buffer_load_dwordx4 v15, s[16:19], s46 offen lds
    s_add_u32 m0, s45, 147456
    s_add_u32 s46, s41, 2048
    buffer_load_dwordx4 v14, s[16:19], s46 offen lds
    s_add_u32 m0, s45, 148480
    s_add_u32 s46, s41, 51200
    buffer_load_dwordx4 v15, s[16:19], s46 offen lds
    s_add_u32 m0, s45, 155648
    s_add_u32 s46, s41, 4096
    buffer_load_dwordx4 v14, s[16:19], s46 offen lds
    s_add_u32 m0, s45, 156672
    s_add_u32 s46, s41, 53248
    buffer_load_dwordx4 v15, s[16:19], s46 offen lds
    s_waitcnt vmcnt(21)
    s_barrier
    s_bfe_u32 s40, s49, 0x40010
    s_bitcmp1_b32 s40, 3
    s_cselect_b32 s41, s39, s42
    s_xor_b32 s40, s40, s41
    s_mul_i32 s41, s40, 393216
    s_add_u32 s41, s41, s38
    s_lshl_b32 s40, s40, 7
    s_add_u32 s40, s40, s36
    s_add_u32 m0, s44, 0
    s_add_u32 s46, s40, 0
    buffer_load_dwordx4 v12, s[12:15], s46 offen lds
    s_add_u32 m0, s44, 1024
    s_add_u32 s46, s40, 16384
    buffer_load_dwordx4 v13, s[12:15], s46 offen lds
    s_add_u32 m0, s44, 2048
    s_add_u32 s46, s40, 32768
    buffer_load_dwordx4 v12, s[12:15], s46 offen lds
    s_add_u32 m0, s44, 3072
    s_add_u32 s46, s40, 49152
    buffer_load_dwordx4 v13, s[12:15], s46 offen lds
    s_add_u32 m0, s45, 16384
    s_add_u32 s46, s41, 0
    s_add_u32 s46, s46, s47
    buffer_load_dwordx4 v14, s[16:19], s46 offen lds
    s_add_u32 m0, s45, 17408
    s_add_u32 s46, s41, 49152
    s_add_u32 s46, s46, s47
    s_nop 0
    buffer_load_dwordx4 v15, s[16:19], s46 offen lds
    s_add_u32 m0, s45, 24576
    s_add_u32 s46, s41, 2048
    buffer_load_dwordx4 v14, s[16:19], s46 offen lds
    s_add_u32 m0, s45, 25600
    s_add_u32 s46, s41, 51200
    buffer_load_dwordx4 v15, s[16:19], s46 offen lds
    s_add_u32 m0, s45, 32768
    s_add_u32 s46, s41, 4096
    buffer_load_dwordx4 v14, s[16:19], s46 offen lds
    s_add_u32 m0, s45, 33792
    s_add_u32 s46, s41, 53248
    buffer_load_dwordx4 v15, s[16:19], s46 offen lds
    s_waitcnt vmcnt(20)
    s_barrier
    s_bfe_u32 s40, s49, 0x40014
    s_bitcmp1_b32 s40, 3
    s_cselect_b32 s41, s39, s42
    s_xor_b32 s40, s40, s41
    s_mul_i32 s41, s40, 393216
    s_add_u32 s41, s41, s38
    s_lshl_b32 s40, s40, 7
    s_add_u32 s40, s40, s36
    s_add_u32 m0, s44, 40960
    s_add_u32 s46, s40, 0
    s_nop 0
    buffer_load_dwordx4 v12, s[12:15], s46 offen lds
    s_add_u32 m0, s44, 41984
    s_add_u32 s46, s40, 16384
    buffer_load_dwordx4 v13, s[12:15], s46 offen lds
    s_add_u32 m0, s44, 43008
    s_add_u32 s46, s40, 32768
    buffer_load_dwordx4 v12, s[12:15], s46 offen lds
    s_add_u32 m0, s44, 44032
    s_add_u32 s46, s40, 49152
    buffer_load_dwordx4 v13, s[12:15], s46 offen lds
    s_add_u32 m0, s45, 57344
    s_add_u32 s46, s41, 0
    s_add_u32 s46, s46, s47
    buffer_load_dwordx4 v14, s[16:19], s46 offen lds
    s_add_u32 m0, s45, 58368
    s_add_u32 s46, s41, 49152
    s_add_u32 s46, s46, s47
    s_nop 0
    buffer_load_dwordx4 v15, s[16:19], s46 offen lds
    s_add_u32 m0, s45, 65536
    s_add_u32 s46, s41, 2048
    buffer_load_dwordx4 v14, s[16:19], s46 offen lds
    s_add_u32 m0, s45, 66560
    s_add_u32 s46, s41, 51200
    buffer_load_dwordx4 v15, s[16:19], s46 offen lds
    s_add_u32 m0, s45, 73728
    s_add_u32 s46, s41, 4096
    buffer_load_dwordx4 v14, s[16:19], s46 offen lds
    s_add_u32 m0, s45, 74752
    s_add_u32 s46, s41, 53248
    buffer_load_dwordx4 v15, s[16:19], s46 offen lds
    s_waitcnt vmcnt(20)
    s_barrier
    s_bfe_u32 s40, s49, 0x40018
    s_bitcmp1_b32 s40, 3
    s_cselect_b32 s41, s39, s42
    s_xor_b32 s40, s40, s41
    s_mul_i32 s41, s40, 393216
    s_add_u32 s41, s41, s38
    s_lshl_b32 s40, s40, 7
    s_add_u32 s40, s40, s36
    s_add_u32 m0, s44, 81920
    s_add_u32 s46, s40, 0
    s_nop 0
    buffer_load_dwordx4 v12, s[12:15], s46 offen lds
    s_add_u32 m0, s44, 82944
    s_add_u32 s46, s40, 16384
    buffer_load_dwordx4 v13, s[12:15], s46 offen lds
    s_add_u32 m0, s44, 83968
    s_add_u32 s46, s40, 32768
    buffer_load_dwordx4 v12, s[12:15], s46 offen lds
    s_add_u32 m0, s44, 84992
    s_add_u32 s46, s40, 49152
    buffer_load_dwordx4 v13, s[12:15], s46 offen lds
    s_add_u32 m0, s45, 98304
    s_add_u32 s46, s41, 0
    s_add_u32 s46, s46, s47
    buffer_load_dwordx4 v14, s[16:19], s46 offen lds
    s_add_u32 m0, s45, 99328
    s_add_u32 s46, s41, 49152
    s_add_u32 s46, s46, s47
    s_nop 0
    buffer_load_dwordx4 v15, s[16:19], s46 offen lds
    s_add_u32 m0, s45, 106496
    s_add_u32 s46, s41, 2048
    buffer_load_dwordx4 v14, s[16:19], s46 offen lds
    s_add_u32 m0, s45, 107520
    s_add_u32 s46, s41, 51200
    buffer_load_dwordx4 v15, s[16:19], s46 offen lds
    s_add_u32 m0, s45, 114688
    s_add_u32 s46, s41, 4096
    buffer_load_dwordx4 v14, s[16:19], s46 offen lds
    s_add_u32 m0, s45, 115712
    s_add_u32 s46, s41, 53248
    buffer_load_dwordx4 v15, s[16:19], s46 offen lds
    s_add_u32 s84, s72, 0xb00000
    s_addc_u32 s85, s73, 0
    s_mov_b32 s86, 0x30000
    s_mov_b32 s87, 0x00020000
    v_bfe_u32 v113, v0, 2, 2
    v_min_u32 v113, 2, v113
    v_lshlrev_b32 v114, 8, v113
    v_lshlrev_b32 v113, 12, v113
    v_and_b32 v112, 3, v0
    v_lshl_add_u32 v113, v112, 4, v113
    v_lshl_add_u32 v114, v112, 4, v114
    v_lshrrev_b32 v112, 4, v0
    v_mul_u32_u24 v112, 12288, v112
    v_add_u32 v113, v113, v112
    s_lshl_b32 s76, s3, 6
    s_lshl_b32 s53, s33, 8
    s_add_u32 s53, s53, s76
    s_add_u32 s76, s76, 26368
    v_add_u32 v114, s76, v114

    s_waitcnt vmcnt(20)
    s_barrier
    s_bfe_u32 s40, s49, 0x4001c
    s_bitcmp1_b32 s40, 3
    s_cselect_b32 s41, s39, s42
    s_xor_b32 s40, s40, s41
    s_mul_i32 s41, s40, 393216
    s_add_u32 s41, s41, s38
    s_lshl_b32 s40, s40, 7
    s_add_u32 s40, s40, s36
    s_add_u32 m0, s44, 122880
    s_add_u32 s46, s40, 0
    buffer_load_dwordx4 v12, s[12:15], s46 offen lds
    s_add_u32 m0, s44, 123904
    s_add_u32 s46, s40, 16384
    buffer_load_dwordx4 v13, s[12:15], s46 offen lds
    s_add_u32 m0, s44, 124928
    s_add_u32 s46, s40, 32768
    buffer_load_dwordx4 v12, s[12:15], s46 offen lds
    s_add_u32 m0, s44, 125952
    s_add_u32 s46, s40, 49152
    buffer_load_dwordx4 v13, s[12:15], s46 offen lds
    s_add_u32 m0, s45, 139264
    s_add_u32 s46, s41, 0
    s_add_u32 s46, s46, s47
    buffer_load_dwordx4 v14, s[16:19], s46 offen lds
    s_add_u32 m0, s45, 140288
    s_add_u32 s46, s41, 49152
    s_add_u32 s46, s46, s47
    s_nop 0
    buffer_load_dwordx4 v15, s[16:19], s46 offen lds
    s_add_u32 m0, s45, 147456
    s_add_u32 s46, s41, 2048
    buffer_load_dwordx4 v14, s[16:19], s46 offen lds
    s_add_u32 m0, s45, 148480
    s_add_u32 s46, s41, 51200
    buffer_load_dwordx4 v15, s[16:19], s46 offen lds
    s_add_u32 m0, s45, 155648
    s_add_u32 s46, s41, 4096
    buffer_load_dwordx4 v14, s[16:19], s46 offen lds
    s_add_u32 m0, s45, 156672
    s_add_u32 s46, s41, 53248
    buffer_load_dwordx4 v15, s[16:19], s46 offen lds
    s_add_u32 s76, s53, 0
    s_nop 0
    buffer_load_dwordx4 v[72:75], v113, s[84:87], s76 offen sc0 sc1
    s_add_u32 s76, s53, 49152
    buffer_load_dwordx4 v[76:79], v113, s[84:87], s76 offen sc0 sc1
    s_add_u32 s76, s53, 98304
    buffer_load_dwordx4 v[80:83], v113, s[84:87], s76 offen sc0 sc1
    s_add_u32 s76, s53, 147456
    buffer_load_dwordx4 v[84:87], v113, s[84:87], s76 offen sc0 sc1
    v_lshlrev_b32 v10, 4, v0
    s_add_u32 s68, s72, 0x900000
    s_addc_u32 s69, s73, 0
    s_mov_b32 s70, 0x18000
    s_mov_b32 s71, 0x00020000
    s_lshl_b32 s52, s32, 11
    s_add_u32 s52, s52, 65536
    s_lshl_b32 s76, s3, 2
    s_add_u32 s52, s52, s76
    s_lshl_b32 s76, s3, 9
    s_add_u32 m0, s76, 24832
    s_setprio 3

    s_waitcnt vmcnt(22)
    s_barrier
    s_cmp_eq_u32 s3, 3
    s_cbranch_scc1 F_d0
    buffer_load_dword v10, s[68:71], s52 offen sc0 sc1 lds
    s_add_u32 m0, m0, 256
    s_add_u32 s52, s52, 1024
    buffer_load_dword v10, s[68:71], s52 offen sc0 sc1 lds
    s_branch F_d1
F_d0:
    s_mov_b32 m0, 24576
    s_mov_b32 s52, 0x7ff00000
    s_mov_b64 exec, 0xfff
    buffer_load_dwordx4 v10, s[84:87], s52 offen lds
    buffer_load_dwordx4 v10, s[84:87], s52 offen lds
    s_mov_b64 exec, -1
F_d1:

    s_setprio 0
    s_waitcnt vmcnt(16)
    s_barrier
    s_waitcnt vmcnt(2)
F_cs0:
    v_min3_u32 v96, v72, v76, v80
    v_min_u32 v96, v96, v84
    v_cmp_eq_u32 vcc, 0, v96
    s_cbranch_vccz F_cs1
    s_sleep 8

    s_add_u32 s76, s53, 0
    buffer_load_dwordx4 v[72:75], v113, s[84:87], s76 offen sc0 sc1
    s_add_u32 s76, s53, 49152
    buffer_load_dwordx4 v[76:79], v113, s[84:87], s76 offen sc0 sc1
    s_add_u32 s76, s53, 98304
    buffer_load_dwordx4 v[80:83], v113, s[84:87], s76 offen sc0 sc1
    s_add_u32 s76, s53, 147456
    buffer_load_dwordx4 v[84:87], v113, s[84:87], s76 offen sc0 sc1
    s_waitcnt vmcnt(0)
    s_branch F_cs0
F_cs1:
    v_add_f32 v72, v72, v76
    v_add_f32 v80, v80, v84
    v_add_f32 v73, v73, v77
    v_add_f32 v81, v81, v85
    v_add_f32 v74, v74, v78
    v_add_f32 v82, v82, v86
    v_add_f32 v75, v75, v79
    v_add_f32 v83, v83, v87
    v_add_f32 v72, v72, v80
    v_add_f32 v73, v73, v81
    v_add_f32 v74, v74, v82
    v_add_f32 v75, v75, v83
    v_mov_b32 v76, v72
    v_mov_b32 v77, v73
    v_mov_b32 v78, v74
    v_mov_b32 v79, v75
    v_permlane32_swap_b32 v72, v76
    v_permlane32_swap_b32 v73, v77
    v_permlane32_swap_b32 v74, v78
    v_permlane32_swap_b32 v75, v79
    v_add_f32 v72, v72, v76
    v_add_f32 v73, v73, v77
    v_add_f32 v74, v74, v78
    v_add_f32 v75, v75, v79
    v_mov_b32 v76, v72
    v_mov_b32 v77, v73
    v_mov_b32 v78, v74
    v_mov_b32 v79, v75
    v_permlane16_swap_b32 v72, v76
    v_permlane16_swap_b32 v73, v77
    v_permlane16_swap_b32 v74, v78
    v_permlane16_swap_b32 v75, v79
    v_add_f32 v72, v72, v76
    v_add_f32 v73, v73, v77
    v_add_f32 v74, v74, v78
    v_add_f32 v75, v75, v79
    s_mov_b64 exec, 0xfff
    ds_write_b128 v114, v[72:75]
    s_mov_b64 exec, -1
    s_waitcnt lgkmcnt(0)

    s_waitcnt vmcnt(0)
    s_barrier
    s_add_u32 s24, s72, 0x800000
    s_addc_u32 s25, s73, 0
    s_mov_b32 s26, 0x100000
    s_mov_b32 s27, 0x00020000
    s_add_u32 s12, s72, 0x400000
    s_addc_u32 s13, s73, 0
    s_mov_b32 s14, 0x400000
    s_mov_b32 s15, 0x00020000
    s_mov_b32 s16, s8
    s_mov_b32 s17, s9
    s_mov_b32 s18, 0x200000
    s_mov_b32 s19, 0x00020000
    v_lshrrev_b32 v4, 4, v0
    v_and_b32 v3, 15, v0
    v_lshlrev_b32 v6, 1, v4
    v_xor_b32 v8, v3, v6
    v_xor_b32 v9, 8, v8
    v_lshlrev_b32 v8, 4, v8
    v_lshlrev_b32 v9, 4, v9
    v_lshl_add_u32 v8, v4, 11, v8
    v_lshl_add_u32 v9, v4, 11, v9
    s_lshl_b32 s38, s29, 8
    s_lshl_b32 s45, s3, 15
    s_add_u32 s38, s38, s45
    s_lshl_b32 s45, s3, 12
    s_mul_i32 s39, s35, 2
    s_mul_i32 s40, s34, 1
    s_add_u32 s39, s39, s40
    s_and_b32 s59, s34, 0

    s_lshr_b32 s36, s3, 1
    s_and_b32 s37, s3, 1
    s_lshl_b32 s43, s36, 6
    s_lshl_b32 s42, s33, 1
    s_add_u32 s42, s42, s37
    s_mul_i32 s82, s42, 4224
    s_add_u32 s83, s82, 4096
    s_add_u32 s83, s83, s43
    s_lshl_b32 s44, s36, 11
    s_add_u32 s82, s82, s44
    s_mul_i32 s51, s42, 16*64
    s_add_u32 s51, s51, 192512
    s_lshl_b32 s42, s10, 1
    s_add_u32 s42, s42, s37
    s_lshl_b32 s50, s42, 4
    s_add_u32 s50, s50, s32
    s_lshl_b32 s50, s50, 6
    v_lshlrev_b32 v10, 4, v0
    v_lshlrev_b32 v11, 2, v0
    s_lshl_b32 s42, s3, 2
    s_add_u32 s42, s42, 24640
    v_mov_b32 v1, s42
    v_and_b32 v2, 3, v0
    v_lshlrev_b32 v2, 2, v2
    v_add_u32 v2, 24640, v2
    v_and_b32 v105, 1, v0
    v_lshlrev_b32 v105, 3, v105
    s_lshl_b32 s42, s37, 2
    s_add_u32 s42, s42, 24640
    v_add_u32 v105, s42, v105
    s_lshl_b32 s42, s37, 12
    s_add_u32 s42, s42, s44
    s_add_u32 s42, s42, 65536
    v_add_u32 v106, s42, v11
    s_lshl_b32 s42, s37, 7
    s_add_u32 s42, s42, s43
    s_add_u32 s42, s42, 27136
    v_add_u32 v107, s42, v11
    v_mul_u32_u24 v108, 64*16/4, v0
    v_mov_b32 v109, 1
    s_mov_b32 s60, 0
    s_mov_b32 s62, 0xa001024
    s_mov_b32 s63, 0x1a1e14
    s_lshl_b32 s36, s28, 2
    s_add_u32 s36, s36, s3
    s_lshl_b32 s36, s36, 15
    s_lshl_b32 s44, s3, 11
    s_lshl_b32 s50, s28, 3
    s_and_b32 s76, s29, 4-1
    s_mul_i32 s76, s76, 8/4
    s_add_u32 s50, s50, s76
    s_mul_i32 s50, s50, 64
    s_add_u32 s78, s50, 0x837000
    s_add_u32 s78, s72, s78
    s_addc_u32 s79, s73, 0
    s_setprio 3
    s_sleep 16
    ds_read_b32 v114, v105
FW_11:
    s_waitcnt lgkmcnt(0)
    v_cmp_gt_u32 vcc, 1, v114
    s_cbranch_vccz FO_12
    s_sleep 1
    ds_read_b32 v114, v105
    s_branch FW_11
FO_12:
    ds_read2st64_b32 v[12:13], v106 offset0:0 offset1:1
    ds_read2st64_b32 v[20:21], v106 offset0:32 offset1:33
    ds_read2st64_b32 v[14:15], v106 offset0:2 offset1:3
    ds_read2st64_b32 v[22:23], v106 offset0:34 offset1:35
    ds_read2st64_b32 v[16:17], v106 offset0:4 offset1:5
    ds_read2st64_b32 v[24:25], v106 offset0:36 offset1:37
    ds_read2st64_b32 v[18:19], v106 offset0:6 offset1:7
    ds_read2st64_b32 v[26:27], v106 offset0:38 offset1:39
    ds_read2st64_b32 v[28:29], v107 offset0:0 offset1:1
    s_waitcnt lgkmcnt(7)
    v_add_f32 v12, v12, v20
    buffer_atomic_add_f32 v12, v11, s[24:27], s82 offen offset:0
    v_add_f32 v13, v13, v21
    buffer_atomic_add_f32 v13, v11, s[24:27], s82 offen offset:256
    s_waitcnt lgkmcnt(5)
    v_add_f32 v14, v14, v22
    buffer_atomic_add_f32 v14, v11, s[24:27], s82 offen offset:512
    v_add_f32 v15, v15, v23
    buffer_atomic_add_f32 v15, v11, s[24:27], s82 offen offset:768
    s_waitcnt lgkmcnt(3)
    v_add_f32 v16, v16, v24
    buffer_atomic_add_f32 v16, v11, s[24:27], s82 offen offset:1024
    v_add_f32 v17, v17, v25
    buffer_atomic_add_f32 v17, v11, s[24:27], s82 offen offset:1280
    s_waitcnt lgkmcnt(1)
    v_add_f32 v18, v18, v26
    buffer_atomic_add_f32 v18, v11, s[24:27], s82 offen offset:1536
    v_add_f32 v19, v19, v27
    buffer_atomic_add_f32 v19, v11, s[24:27], s82 offen offset:1792
    s_waitcnt lgkmcnt(0)
    v_add_f32 v28, v28, v29
    s_mov_b64 exec, 0xffff
    buffer_atomic_add_f32 v28, v11, s[24:27], s83 offen
    s_mov_b64 exec, -1
    v_mov_b32 v113, 1
    s_mov_b64 exec, 1
    ds_write_b32 v1, v113 offset:32
    s_mov_b64 exec, -1
    s_add_u32 s54, s51, 0x800000
    s_add_u32 s54, s72, s54
    s_addc_u32 s55, s73, 0
    s_mov_b32 s57, 1
    s_waitcnt vmcnt(4)
    ds_read2_b32 v[102:103], v2 offset0:0 offset1:8
    ds_read_b32 v104, v2 offset:16
    s_waitcnt lgkmcnt(0)
    v_cmp_ne_u32 vcc, 2, v102
    v_cmp_eq_u32 s[42:43], 0, v103
    s_nop 0
    s_or_b64 vcc, vcc, s[42:43]
    v_cmp_gt_u32 s[42:43], 2, v104
    s_nop 0
    s_or_b64 vcc, vcc, s[42:43]
    s_waitcnt vmcnt(0)
    s_atomic_add s57, s[54:55], 0
    s_atomic_add s57, s[54:55], 256
    s_atomic_add s57, s[54:55], 512
    s_atomic_add s57, s[54:55], 768
    s_cbranch_vccnz F_pe
    s_add_u32 s41, s39, 0
    s_and_b32 s41, s41, 15
    s_xor_b32 s41, s41, s59
    s_lshl_b32 s41, s41, 17
    s_add_u32 s41, s41, s38
    s_add_u32 m0, s45, 147456
    s_add_u32 s76, s41, 0
    buffer_load_dwordx4 v8, s[16:19], s76 offen lds
    s_add_u32 m0, s45, 148480
    s_add_u32 s76, s41, 8192
    buffer_load_dwordx4 v9, s[16:19], s76 offen lds
    s_add_u32 m0, s45, 149504
    s_add_u32 s76, s41, 16384
    buffer_load_dwordx4 v8, s[16:19], s76 offen lds
    s_add_u32 m0, s45, 150528
    s_add_u32 s76, s41, 24576
    buffer_load_dwordx4 v9, s[16:19], s76 offen lds
    s_add_u32 s41, s39, 1
    s_and_b32 s41, s41, 15
    s_xor_b32 s41, s41, s59
    s_lshl_b32 s41, s41, 17
    s_add_u32 s41, s41, s38
    s_add_u32 m0, s45, 65536
    s_add_u32 s76, s41, 0
    buffer_load_dwordx4 v8, s[16:19], s76 offen lds
    s_add_u32 m0, s45, 66560
    s_add_u32 s76, s41, 8192
    buffer_load_dwordx4 v9, s[16:19], s76 offen lds
    s_add_u32 m0, s45, 67584
    s_add_u32 s76, s41, 16384
    buffer_load_dwordx4 v8, s[16:19], s76 offen lds
    s_add_u32 m0, s45, 68608
    s_add_u32 s76, s41, 24576
    buffer_load_dwordx4 v9, s[16:19], s76 offen lds
    s_add_u32 s41, s39, 2
    s_and_b32 s41, s41, 15
    s_xor_b32 s41, s41, s59
    s_lshl_b32 s41, s41, 17
    s_add_u32 s41, s41, s38
    s_add_u32 m0, s45, 0
    s_add_u32 s76, s41, 0
    s_nop 0
    buffer_load_dwordx4 v8, s[16:19], s76 offen lds
    s_add_u32 m0, s45, 1024
    s_add_u32 s76, s41, 8192
    buffer_load_dwordx4 v9, s[16:19], s76 offen lds
    s_add_u32 m0, s45, 2048
    s_add_u32 s76, s41, 16384
    buffer_load_dwordx4 v8, s[16:19], s76 offen lds
    s_add_u32 m0, s45, 3072
    s_add_u32 s76, s41, 24576
    buffer_load_dwordx4 v9, s[16:19], s76 offen lds
    s_mov_b32 s60, 3
F_pe:
    s_setprio 1
F_pr0:
    s_waitcnt vmcnt(8)
    ds_read2_b32 v[102:103], v2 offset0:0 offset1:8
    s_cmp_lt_u32 s60, 2
    s_cselect_b32 s61, 1, 2
    s_waitcnt lgkmcnt(0)
    v_cmp_le_u32 vcc, 3, v102
    s_cbranch_vccz F_pr3
    s_mov_b32 s61, 4
F_pr3:
    v_cmp_gt_u32 vcc, s61, v102
    v_cmp_gt_u32 s[42:43], 1, v103
    s_nop 0
    s_or_b64 vcc, vcc, s[42:43]
    s_cbranch_vccz F_pr2
    s_sleep 2
    s_branch F_pr0
F_pr2:
    s_cmp_lt_u32 s60, 6
    s_cbranch_scc1 F_pr4
    ds_read_b32 v102, v2 offset:16
    s_waitcnt lgkmcnt(0)
    v_cmp_gt_u32 vcc, 2, v102
    s_cbranch_vccz F_pr4
    s_sleep 2
    s_branch F_pr0
F_pr4:
    s_add_u32 s41, s39, s60
    s_and_b32 s41, s41, 15
    s_xor_b32 s41, s41, s59
    s_lshl_b32 s41, s41, 17
    s_add_u32 s41, s41, s38
    s_lshl_b32 s76, s60, 3
    s_lshr_b64 s[42:43], s[62:63], s76
    s_and_b32 s42, s42, 0xff
    s_lshl_b32 s42, s42, 12
    s_add_u32 m0, s42, s45
    s_add_u32 s60, s60, 1
    buffer_load_dwordx4 v8, s[16:19], s41 offen lds
    s_add_u32 m0, m0, 1024
    s_add_u32 s41, s41, 8192
    buffer_load_dwordx4 v9, s[16:19], s41 offen lds
    s_add_u32 m0, m0, 1024
    s_add_u32 s41, s41, 8192
    buffer_load_dwordx4 v8, s[16:19], s41 offen lds
    s_add_u32 m0, m0, 1024
    s_add_u32 s41, s41, 8192
    buffer_load_dwordx4 v9, s[16:19], s41 offen lds
    s_cmp_ge_u32 s60, 7
    s_cbranch_scc1 F_pr1
    s_cmp_eq_u32 s61, 4
    s_cbranch_scc1 F_pr2
    s_branch F_pr0
F_pr1:
    s_cmp_lg_u32 s3, 0
    s_cbranch_scc1 F_l4
SP_13:
    s_load_dword s58, s[78:79], 0 glc
    s_waitcnt lgkmcnt(0)
    s_cmp_ge_u32 s58, 32
    s_cbranch_scc1 SD_14
    s_sleep 1
    s_branch SP_13
SD_14:
    v_mov_b32 v113, 3
    s_mov_b64 exec, 1
    ds_write_b32 v1, v113 offset:112
    s_mov_b64 exec, -1
    s_branch F_l5
F_l4:
    v_mov_b32 v4, 24752
    ds_read_b32 v13, v4
FW_15:
    s_waitcnt lgkmcnt(0)
    v_cmp_gt_u32_e64 vcc, 3, v13
    s_cbranch_vccz FO_16
    s_sleep 1
    ds_read_b32 v13, v4
    s_branch FW_15
FO_16:
F_l5:
    s_add_u32 s40, s39, 0
    s_and_b32 s40, s40, 15
    s_xor_b32 s40, s40, s59
    s_lshl_b32 s40, s40, 11
    s_add_u32 s40, s40, s36
    s_add_u32 m0, s44, 16384
    s_nop 0
    buffer_load_dwordx4 v10, s[12:15], s40 offen offset:0 sc1 lds
    s_add_u32 m0, s44, 16384
    s_nop 0
    buffer_load_dwordx4 v10, s[12:15], s40 offen offset:1024 sc1 lds
    s_add_u32 s40, s39, 1
    s_and_b32 s40, s40, 15
    s_xor_b32 s40, s40, s59
    s_lshl_b32 s40, s40, 11
    s_add_u32 s40, s40, s36
    s_add_u32 m0, s44, 98304
    s_nop 0
    buffer_load_dwordx4 v10, s[12:15], s40 offen offset:0 sc1 lds
    s_add_u32 m0, s44, 98304
    s_nop 0
    buffer_load_dwordx4 v10, s[12:15], s40 offen offset:1024 sc1 lds
    s_add_u32 s40, s39, 2
    s_and_b32 s40, s40, 15
    s_xor_b32 s40, s40, s59
    s_lshl_b32 s40, s40, 11
    s_add_u32 s40, s40, s36
    s_add_u32 m0, s44, 139264
    s_nop 0
    buffer_load_dwordx4 v10, s[12:15], s40 offen offset:0 sc1 lds
    s_add_u32 m0, s44, 139264
    s_nop 0
    buffer_load_dwordx4 v10, s[12:15], s40 offen offset:1024 sc1 lds
    s_waitcnt vmcnt(4)
    s_barrier
    s_add_u32 s40, s39, 3
    s_and_b32 s40, s40, 15
    s_xor_b32 s40, s40, s59
    s_lshl_b32 s40, s40, 11
    s_add_u32 s40, s40, s36
    s_add_u32 m0, s44, 57344
    s_nop 0
    buffer_load_dwordx4 v10, s[12:15], s40 offen offset:0 sc1 lds
    s_add_u32 m0, s44, 57344
    s_nop 0
    buffer_load_dwordx4 v10, s[12:15], s40 offen offset:1024 sc1 lds
    s_setprio 0
    s_waitcnt vmcnt(4)
    s_barrier
    s_add_u32 s40, s39, 4
    s_and_b32 s40, s40, 15
    s_xor_b32 s40, s40, s59
    s_lshl_b32 s40, s40, 11
    s_add_u32 s40, s40, s36
    s_add_u32 m0, s44, 16384
    s_nop 0
    buffer_load_dwordx4 v10, s[12:15], s40 offen offset:0 sc1 lds
    s_add_u32 m0, s44, 16384
    s_nop 0
    buffer_load_dwordx4 v10, s[12:15], s40 offen offset:1024 sc1 lds
    s_add_u32 s41, s39, 7
    s_and_b32 s41, s41, 15
    s_xor_b32 s41, s41, s59
    s_lshl_b32 s41, s41, 17
    s_add_u32 s41, s41, s38
    s_add_u32 m0, s45, 147456
    s_add_u32 s76, s41, 0
    buffer_load_dwordx4 v8, s[16:19], s76 offen lds
    s_add_u32 m0, s45, 148480
    s_add_u32 s76, s41, 8192
    buffer_load_dwordx4 v9, s[16:19], s76 offen lds
    s_add_u32 m0, s45, 149504
    s_add_u32 s76, s41, 16384
    buffer_load_dwordx4 v8, s[16:19], s76 offen lds
    s_add_u32 m0, s45, 150528
    s_add_u32 s76, s41, 24576
    buffer_load_dwordx4 v9, s[16:19], s76 offen lds
    s_waitcnt vmcnt(8)
    s_barrier
    s_add_u32 s40, s39, 5
    s_and_b32 s40, s40, 15
    s_xor_b32 s40, s40, s59
    s_lshl_b32 s40, s40, 11
    s_add_u32 s40, s40, s36
    s_add_u32 m0, s44, 98304
    s_nop 0
    buffer_load_dwordx4 v10, s[12:15], s40 offen offset:0 sc1 lds
    s_add_u32 m0, s44, 98304
    s_nop 0
    buffer_load_dwordx4 v10, s[12:15], s40 offen offset:1024 sc1 lds
    s_add_u32 s41, s39, 8
    s_and_b32 s41, s41, 15
    s_xor_b32 s41, s41, s59
    s_lshl_b32 s41, s41, 17
    s_add_u32 s41, s41, s38
    s_add_u32 m0, s45, 65536
    s_add_u32 s76, s41, 0
    s_nop 0
    buffer_load_dwordx4 v8, s[16:19], s76 offen lds
    s_add_u32 m0, s45, 66560
    s_add_u32 s76, s41, 8192
    buffer_load_dwordx4 v9, s[16:19], s76 offen lds
    s_add_u32 m0, s45, 67584
    s_add_u32 s76, s41, 16384
    buffer_load_dwordx4 v8, s[16:19], s76 offen lds
    s_add_u32 m0, s45, 68608
    s_add_u32 s76, s41, 24576
    buffer_load_dwordx4 v9, s[16:19], s76 offen lds
    s_waitcnt vmcnt(12)
    s_barrier
    s_add_u32 s40, s39, 6
    s_and_b32 s40, s40, 15
    s_xor_b32 s40, s40, s59
    s_lshl_b32 s40, s40, 11
    s_add_u32 s40, s40, s36
    s_add_u32 m0, s44, 139264
    s_nop 0
    buffer_load_dwordx4 v10, s[12:15], s40 offen offset:0 sc1 lds
    s_add_u32 m0, s44, 139264
    s_nop 0
    buffer_load_dwordx4 v10, s[12:15], s40 offen offset:1024 sc1 lds
    s_add_u32 s41, s39, 9
    s_and_b32 s41, s41, 15
    s_xor_b32 s41, s41, s59
    s_lshl_b32 s41, s41, 17
    s_add_u32 s41, s41, s38
    s_add_u32 m0, s45, 0
    s_add_u32 s76, s41, 0
    buffer_load_dwordx4 v8, s[16:19], s76 offen lds
    s_add_u32 m0, s45, 1024
    s_add_u32 s76, s41, 8192
    buffer_load_dwordx4 v9, s[16:19], s76 offen lds
    s_add_u32 m0, s45, 2048
    s_add_u32 s76, s41, 16384
    buffer_load_dwordx4 v8, s[16:19], s76 offen lds
    s_add_u32 m0, s45, 3072
    s_add_u32 s76, s41, 24576
    buffer_load_dwordx4 v9, s[16:19], s76 offen lds
    s_waitcnt vmcnt(16)
    s_barrier
    s_add_u32 s40, s39, 7
    s_and_b32 s40, s40, 15
    s_xor_b32 s40, s40, s59
    s_lshl_b32 s40, s40, 11
    s_add_u32 s40, s40, s36
    s_add_u32 m0, s44, 57344
    s_nop 0
    buffer_load_dwordx4 v10, s[12:15], s40 offen offset:0 sc1 lds
    s_add_u32 m0, s44, 57344
    s_nop 0
    buffer_load_dwordx4 v10, s[12:15], s40 offen offset:1024 sc1 lds
    s_add_u32 s41, s39, 10
    s_and_b32 s41, s41, 15
    s_xor_b32 s41, s41, s59
    s_lshl_b32 s41, s41, 17
    s_add_u32 s41, s41, s38
    s_add_u32 m0, s45, 40960
    s_add_u32 s76, s41, 0
    s_nop 0
    buffer_load_dwordx4 v8, s[16:19], s76 offen lds
    s_add_u32 m0, s45, 41984
    s_add_u32 s76, s41, 8192
    buffer_load_dwordx4 v9, s[16:19], s76 offen lds
    s_add_u32 m0, s45, 43008
    s_add_u32 s76, s41, 16384
    buffer_load_dwordx4 v8, s[16:19], s76 offen lds
    s_add_u32 m0, s45, 44032
    s_add_u32 s76, s41, 24576
    buffer_load_dwordx4 v9, s[16:19], s76 offen lds
    s_waitcnt vmcnt(16)
    s_barrier
    s_add_u32 s40, s39, 8
    s_and_b32 s40, s40, 15
    s_xor_b32 s40, s40, s59
    s_lshl_b32 s40, s40, 11
    s_add_u32 s40, s40, s36
    s_add_u32 m0, s44, 16384
    s_nop 0
    buffer_load_dwordx4 v10, s[12:15], s40 offen offset:0 sc1 lds
    s_add_u32 m0, s44, 16384
    s_nop 0
    buffer_load_dwordx4 v10, s[12:15], s40 offen offset:1024 sc1 lds
    s_add_u32 s41, s39, 11
    s_and_b32 s41, s41, 15
    s_xor_b32 s41, s41, s59
    s_lshl_b32 s41, s41, 17
    s_add_u32 s41, s41, s38
    s_add_u32 m0, s45, 81920
    s_add_u32 s76, s41, 0
    s_nop 0
    buffer_load_dwordx4 v8, s[16:19], s76 offen lds
    s_add_u32 m0, s45, 82944
    s_add_u32 s76, s41, 8192
    buffer_load_dwordx4 v9, s[16:19], s76 offen lds
    s_add_u32 m0, s45, 83968
    s_add_u32 s76, s41, 16384
    buffer_load_dwordx4 v8, s[16:19], s76 offen lds
    s_add_u32 m0, s45, 84992
    s_add_u32 s76, s41, 24576
    buffer_load_dwordx4 v9, s[16:19], s76 offen lds
    s_waitcnt vmcnt(16)
    s_barrier
    s_add_u32 s40, s39, 9
    s_and_b32 s40, s40, 15
    s_xor_b32 s40, s40, s59
    s_lshl_b32 s40, s40, 11
    s_add_u32 s40, s40, s36
    s_add_u32 m0, s44, 98304
    s_nop 0
    buffer_load_dwordx4 v10, s[12:15], s40 offen offset:0 sc1 lds
    s_add_u32 m0, s44, 98304
    s_nop 0
    buffer_load_dwordx4 v10, s[12:15], s40 offen offset:1024 sc1 lds
    s_add_u32 s41, s39, 12
    s_and_b32 s41, s41, 15
    s_xor_b32 s41, s41, s59
    s_lshl_b32 s41, s41, 17
    s_add_u32 s41, s41, s38
    s_add_u32 m0, s45, 122880
    s_add_u32 s76, s41, 0
    s_nop 0
    buffer_load_dwordx4 v8, s[16:19], s76 offen lds
    s_add_u32 m0, s45, 123904
    s_add_u32 s76, s41, 8192
    buffer_load_dwordx4 v9, s[16:19], s76 offen lds
    s_add_u32 m0, s45, 124928
    s_add_u32 s76, s41, 16384
    buffer_load_dwordx4 v8, s[16:19], s76 offen lds
    s_add_u32 m0, s45, 125952
    s_add_u32 s76, s41, 24576
    buffer_load_dwordx4 v9, s[16:19], s76 offen lds
    s_waitcnt vmcnt(16)
    s_barrier
    s_add_u32 s40, s39, 10
    s_and_b32 s40, s40, 15
    s_xor_b32 s40, s40, s59
    s_lshl_b32 s40, s40, 11
    s_add_u32 s40, s40, s36
    s_add_u32 m0, s44, 139264
    s_nop 0
    buffer_load_dwordx4 v10, s[12:15], s40 offen offset:0 sc1 lds
    s_add_u32 m0, s44, 139264
    s_nop 0
    buffer_load_dwordx4 v10, s[12:15], s40 offen offset:1024 sc1 lds
    s_add_u32 s41, s39, 13
    s_and_b32 s41, s41, 15
    s_xor_b32 s41, s41, s59
    s_lshl_b32 s41, s41, 17
    s_add_u32 s41, s41, s38
    s_add_u32 m0, s45, 106496
    s_add_u32 s76, s41, 0
    s_nop 0
    buffer_load_dwordx4 v8, s[16:19], s76 offen lds
    s_add_u32 m0, s45, 107520
    s_add_u32 s76, s41, 8192
    buffer_load_dwordx4 v9, s[16:19], s76 offen lds
    s_add_u32 m0, s45, 108544
    s_add_u32 s76, s41, 16384
    buffer_load_dwordx4 v8, s[16:19], s76 offen lds
    s_add_u32 m0, s45, 109568
    s_add_u32 s76, s41, 24576
    buffer_load_dwordx4 v9, s[16:19], s76 offen lds
    s_waitcnt vmcnt(16)
    s_barrier
    s_add_u32 s40, s39, 11
    s_and_b32 s40, s40, 15
    s_xor_b32 s40, s40, s59
    s_lshl_b32 s40, s40, 11
    s_add_u32 s40, s40, s36
    s_add_u32 m0, s44, 57344
    s_nop 0
    buffer_load_dwordx4 v10, s[12:15], s40 offen offset:0 sc1 lds
    s_add_u32 m0, s44, 57344
    s_nop 0
    buffer_load_dwordx4 v10, s[12:15], s40 offen offset:1024 sc1 lds
    s_add_u32 s41, s39, 14
    s_and_b32 s41, s41, 15
    s_xor_b32 s41, s41, s59
    s_lshl_b32 s41, s41, 17
    s_add_u32 s41, s41, s38
    s_add_u32 m0, s45, 147456
    s_add_u32 s76, s41, 0
    s_nop 0
    buffer_load_dwordx4 v8, s[16:19], s76 offen lds
    s_add_u32 m0, s45, 148480
    s_add_u32 s76, s41, 8192
    buffer_load_dwordx4 v9, s[16:19], s76 offen lds
    s_add_u32 m0, s45, 149504
    s_add_u32 s76, s41, 16384
    buffer_load_dwordx4 v8, s[16:19], s76 offen lds
    s_add_u32 m0, s45, 150528
    s_add_u32 s76, s41, 24576
    buffer_load_dwordx4 v9, s[16:19], s76 offen lds
    s_waitcnt vmcnt(16)
    s_barrier
    s_add_u32 s40, s39, 12
    s_and_b32 s40, s40, 15
    s_xor_b32 s40, s40, s59
    s_lshl_b32 s40, s40, 11
    s_add_u32 s40, s40, s36
    s_add_u32 m0, s44, 16384
    s_nop 0
    buffer_load_dwordx4 v10, s[12:15], s40 offen offset:0 sc1 lds
    s_add_u32 m0, s44, 16384
    s_nop 0
    buffer_load_dwordx4 v10, s[12:15], s40 offen offset:1024 sc1 lds
    s_add_u32 s41, s39, 15
    s_and_b32 s41, s41, 15
    s_xor_b32 s41, s41, s59
    s_lshl_b32 s41, s41, 17
    s_add_u32 s41, s41, s38
    s_add_u32 m0, s45, 65536
    s_add_u32 s76, s41, 0
    s_nop 0
    buffer_load_dwordx4 v8, s[16:19], s76 offen lds
    s_add_u32 m0, s45, 66560
    s_add_u32 s76, s41, 8192
    buffer_load_dwordx4 v9, s[16:19], s76 offen lds
    s_add_u32 m0, s45, 67584
    s_add_u32 s76, s41, 16384
    buffer_load_dwordx4 v8, s[16:19], s76 offen lds
    s_add_u32 m0, s45, 68608
    s_add_u32 s76, s41, 24576
    buffer_load_dwordx4 v9, s[16:19], s76 offen lds
    s_waitcnt vmcnt(16)
    s_barrier
    s_add_u32 s40, s39, 13
    s_and_b32 s40, s40, 15
    s_xor_b32 s40, s40, s59
    s_lshl_b32 s40, s40, 11
    s_add_u32 s40, s40, s36
    s_add_u32 m0, s44, 98304
    s_nop 0
    buffer_load_dwordx4 v10, s[12:15], s40 offen offset:0 sc1 lds
    s_add_u32 m0, s44, 98304
    s_nop 0
    buffer_load_dwordx4 v10, s[12:15], s40 offen offset:1024 sc1 lds
    s_waitcnt vmcnt(12)
    s_barrier
    s_add_u32 s40, s39, 14
    s_and_b32 s40, s40, 15
    s_xor_b32 s40, s40, s59
    s_lshl_b32 s40, s40, 11
    s_add_u32 s40, s40, s36
    s_add_u32 m0, s44, 139264
    s_nop 0
    buffer_load_dwordx4 v10, s[12:15], s40 offen offset:0 sc1 lds
    s_add_u32 m0, s44, 139264
    s_nop 0
    buffer_load_dwordx4 v10, s[12:15], s40 offen offset:1024 sc1 lds
    s_waitcnt vmcnt(8)
    s_barrier
    s_add_u32 s40, s39, 15
    s_and_b32 s40, s40, 15
    s_xor_b32 s40, s40, s59
    s_lshl_b32 s40, s40, 11
    s_add_u32 s40, s40, s36
    s_add_u32 m0, s44, 57344
    s_nop 0
    buffer_load_dwordx4 v10, s[12:15], s40 offen offset:0 sc1 lds
    s_add_u32 m0, s44, 57344
    s_nop 0
    buffer_load_dwordx4 v10, s[12:15], s40 offen offset:1024 sc1 lds
    s_waitcnt vmcnt(4)
    s_barrier
    s_waitcnt vmcnt(2)
    s_barrier
    s_waitcnt vmcnt(0)
    s_barrier
    s_endpgm
F_aux:
    s_barrier
    s_setprio 0
    s_sub_u32 s3, s3, 4
    s_and_b32 s36, s2, 3
    s_bfe_u32 s37, s2, 0x10002
    s_lshr_b32 s38, s2, 3
    v_lshlrev_b32 v3, 2, v0
    s_lshl_b32 s77, s36, 1
    s_add_u32 s77, s77, s37
    s_mul_i32 s77, s77, 114688
    s_lshl_b32 s46, s38, 12
    s_add_u32 s77, s77, s46
    s_lshl_b32 s46, s3, 10
    s_add_u32 s77, s77, s46
    s_cmp_ge_u32 s2, 224
    s_cselect_b32 s77, 0x7ff00000, s77
    v_mov_b32 v140, 0
    v_mov_b32 v141, 0
    v_mov_b32 v142, 0
    v_mov_b32 v143, 0
    s_add_u32 s12, s72, 0xa00000
    s_addc_u32 s13, s73, 0
    s_mov_b32 s14, 0xe0000
    s_mov_b32 s15, 0x00020000
    buffer_store_dwordx4 v[140:143], v2, s[12:15], s77 offen sc0 sc1
    s_add_u32 s12, s72, 0xb00000
    s_addc_u32 s13, s73, 0
    s_mov_b32 s14, 0x30000
    s_mov_b32 s15, 0x00020000
    s_lshl_b32 s47, s32, 8
    s_add_u32 s56, s47, 0x908000
    s_add_u32 s56, s72, s56
    s_addc_u32 s57, s73, 0
    s_cmp_eq_u32 s37, 0
    s_cselect_b32 s16, s62, s64
    s_cselect_b32 s17, s63, s65
    s_mov_b32 s18, 7340032
    s_mov_b32 s19, 0x00020000
    s_lshl_b32 s44, s3, 2
    s_add_u32 s44, s44, 24640
    v_mov_b32 v10, s44
    v_lshrrev_b32 v5, 4, v0
    v_mul_u32_u24 v6, 57344, v5
    v_and_b32 v7, 15, v0
    v_lshl_add_u32 v6, v7, 4, v6
    s_lshl_b32 s44, s36, 2
    s_add_u32 s44, s44, s3
    s_mul_i32 s54, s44, 458752
    s_lshl_b32 s45, s38, 8
    s_add_u32 s54, s54, s45
    s_cmp_ge_u32 s2, 224
    s_cselect_b32 s54, 0x70000000, s54
    s_lshl_b32 s55, s44, 7
    v_mov_b32 v8, 0
    s_mov_b32 s80, s66
    s_mov_b32 s81, s67
    s_mov_b32 s82, 0x700000
    s_mov_b32 s83, 0x00020000
    v_bfe_u32 v21, v0, 2, 2
    v_lshl_add_u32 v22, v5, 3, v21
    v_lshrrev_b32 v21, 1, v21
    v_and_b32 v20, 1, v5
    v_lshl_add_u32 v21, v20, 1, v21
    v_xor_b32 v21, s3, v21
    v_lshlrev_b32 v21, 5, v21
    v_lshl_add_u32 v21, v22, 7, v21
    v_and_b32 v20, 3, v0
    v_lshl_add_u32 v21, v20, 3, v21
    s_mov_b32 s44, 0x23453342
    s_lshl_b32 s89, s35, 2
    s_lshr_b32 s89, s44, s89
    s_and_b32 s89, s89, 15
    s_and_b32 s44, s89, 3
    s_mul_i32 s44, s44, 40960
    s_add_u32 s44, s44, 16384
    v_add_u32 v112, s44, v21
    v_lshlrev_b32_e64 v113, 2, v7
    v_lshl_add_u32 v113, v5, 12, v113
    s_lshl_b32 s91, s33, 8
    s_lshl_b32 s45, s3, 6
    s_add_u32 s91, s91, s45
    s_mul_i32 s88, s32, 12288
    s_add_u32 s88, s88, s91
    s_mov_b32 exec_hi, 0xffff
    buffer_store_dword v8, v113, s[12:15], s88 offen sc0 sc1
    s_mov_b64 exec, -1
    s_getpc_b64 s[64:65]
F_cp:
    s_add_u32 s64, s64, F_co-F_cp
    s_addc_u32 s65, s65, 0
    s_branch F_cx
F_co:
    ds_read_b64_tr_b16 v[72:73], v112 offset:0
    ds_read_b64_tr_b16 v[74:75], v112 offset:512
    ds_read_b64_tr_b16 v[76:77], v112 offset:4096
    ds_read_b64_tr_b16 v[78:79], v112 offset:4608
    ds_read_b64_tr_b16 v[80:81], v112 offset:8192
    ds_read_b64_tr_b16 v[82:83], v112 offset:8704
    ds_read_b64_tr_b16 v[84:85], v112 offset:12288
    ds_read_b64_tr_b16 v[86:87], v112 offset:12800
    ds_read_b64_tr_b16 v[88:89], v112 offset:16384
    ds_read_b64_tr_b16 v[90:91], v112 offset:16896
    ds_read_b64_tr_b16 v[92:93], v112 offset:20480
    ds_read_b64_tr_b16 v[94:95], v112 offset:20992
    v_mov_b32 v108, 0x3f803f80
    v_mov_b32 v109, 0x3f803f80
    v_mov_b32 v110, 0x3f803f80
    v_mov_b32 v111, 0x3f803f80
    s_waitcnt lgkmcnt(0)
    s_swappc_b64 s[64:65], s[66:67]
    s_setprio 3
    v_mfma_f32_16x16x32_bf16 v[96:99], v[108:111], v[72:75], 0
    v_mfma_f32_16x16x32_bf16 v[100:103], v[108:111], v[80:83], 0
    v_mfma_f32_16x16x32_bf16 v[104:107], v[108:111], v[88:91], 0
    v_mfma_f32_16x16x32_bf16 v[96:99], v[108:111], v[76:79], v[96:99]
    v_mfma_f32_16x16x32_bf16 v[100:103], v[108:111], v[84:87], v[100:103]
    v_mfma_f32_16x16x32_bf16 v[104:107], v[108:111], v[92:95], v[104:107]
    s_setprio 0
    v_cmp_eq_u32 vcc, 1, v5
    s_nop 4
    v_cndmask_b32 v96, v96, v100, vcc
    v_cmp_eq_u32 vcc, 2, v5
    s_nop 1
    v_cndmask_b32 v96, v96, v104, vcc
    v_max_u32 v96, 1, v96
    s_sleep 4
    s_mov_b32 exec_hi, 0xffff
    buffer_store_dword v96, v113, s[12:15], s88 offen sc0 sc1
    s_mov_b64 exec, -1
    s_setpc_b64 s[66:67]
F_cx:
    s_cmp_eq_u32 s3, 0
    s_cbranch_scc1 F_ax0
    s_cmp_eq_u32 s3, 2
    s_cbranch_scc1 F_ax2
    s_barrier
    s_waitcnt vmcnt(0)
    s_barrier
    s_sub_u32 s45, 2, s89
    s_cmp_gt_u32 s45, 1
    s_cbranch_scc1 CB_17
    s_swappc_b64 s[66:67], s[64:65]
CB_17:
    s_barrier
    s_sub_u32 s45, 3, s89
    s_cmp_gt_u32 s45, 1
    s_cbranch_scc1 CB_18
    s_swappc_b64 s[66:67], s[64:65]
CB_18:
    s_barrier
    s_sub_u32 s45, 4, s89
    s_cmp_gt_u32 s45, 1
    s_cbranch_scc1 CB_19
    s_swappc_b64 s[66:67], s[64:65]
CB_19:
    s_barrier
    s_sub_u32 s45, 5, s89
    s_cmp_gt_u32 s45, 1
    s_cbranch_scc1 CB_20
    s_swappc_b64 s[66:67], s[64:65]
CB_20:
    s_barrier
    s_sub_u32 s45, 6, s89
    s_cmp_gt_u32 s45, 1
    s_cbranch_scc1 CB_21
    s_swappc_b64 s[66:67], s[64:65]
CB_21:
    s_barrier
    s_barrier
    s_barrier
    s_barrier
    s_barrier
    s_branch F_aj
F_ax0:
    s_lshl_b32 s44, s32, 2
    buffer_load_dword v9, v8, s[48:51], s44 offen sc0 sc1
    s_barrier
    s_waitcnt vmcnt(0)
    v_cmp_eq_u32 vcc, 0, v9
    s_cbranch_vccz F_ax0r
PL_22:
    buffer_load_dword v9, v8, s[48:51], s44 offen sc0 sc1
    s_waitcnt vmcnt(0)
    v_cmp_gt_u32 vcc, 1, v9
    s_cbranch_vccz PD_23
    s_sleep 1
    s_branch PL_22
PD_23:
F_ax0r:
    s_barrier
    s_mov_b32 s76, 1
    s_atomic_add s76, s[56:57], 0 glc
    s_sub_u32 s45, 2, s89
    s_cmp_gt_u32 s45, 1
    s_cbranch_scc1 CB_24
    s_swappc_b64 s[66:67], s[64:65]
CB_24:
    s_barrier
    s_mov_b32 s75, 0
    s_waitcnt lgkmcnt(0)
    s_cmp_lg_u32 s76, 15
    s_cbranch_scc1 F_ax0c
    s_mov_b32 s75, 1
    s_atomic_add s75, s[70:71], 64 glc
F_ax0c:
    s_sub_u32 s45, 3, s89
    s_cmp_gt_u32 s45, 1
    s_cbranch_scc1 CB_25
    s_swappc_b64 s[66:67], s[64:65]
CB_25:
    s_barrier
    s_sub_u32 s45, 4, s89
    s_cmp_gt_u32 s45, 1
    s_cbranch_scc1 CB_26
    s_swappc_b64 s[66:67], s[64:65]
CB_26:
    s_waitcnt lgkmcnt(0)
    s_cmp_lg_u32 s75, 15
    s_cbranch_scc1 F_ax0d
    v_lshlrev_b32 v9, 8, v0
    v_mov_b32 v11, 1000
    s_mov_b32 s44, 32768
    s_mov_b64 exec, 0xffff
    buffer_store_dword v11, v9, s[40:43], s44 offen sc0 sc1
    s_mov_b64 exec, -1
F_ax0d:
    s_barrier
    s_sub_u32 s45, 5, s89
    s_cmp_gt_u32 s45, 1
    s_cbranch_scc1 CB_27
    s_swappc_b64 s[66:67], s[64:65]
CB_27:
    s_barrier
    s_sub_u32 s45, 6, s89
    s_cmp_gt_u32 s45, 1
    s_cbranch_scc1 CB_28
    s_swappc_b64 s[66:67], s[64:65]
CB_28:
    s_barrier
    s_barrier
    s_barrier
    s_barrier
    s_barrier
    s_branch F_aj
F_ax2:
    s_lshl_b32 s44, s2, 10
    buffer_store_dwordx4 v[140:143], v2, s[24:27], s44 offen sc0 sc1
    s_mov_b64 exec, -1
    s_barrier
    s_waitcnt vmcnt(0)
    s_cmp_lg_u32 s2, 2
    s_cbranch_scc1 F_ax2n
    s_barrier
    s_sub_u32 s45, 2, s89
    s_cmp_gt_u32 s45, 1
    s_cbranch_scc1 CB_29
    s_swappc_b64 s[66:67], s[64:65]
CB_29:
    s_barrier
    s_sub_u32 s45, 3, s89
    s_cmp_gt_u32 s45, 1
    s_cbranch_scc1 CB_30
    s_swappc_b64 s[66:67], s[64:65]
CB_30:
    s_barrier
    s_sub_u32 s45, 4, s89
    s_cmp_gt_u32 s45, 1
    s_cbranch_scc1 CB_31
    s_swappc_b64 s[66:67], s[64:65]
CB_31:
    s_barrier
    s_sub_u32 s45, 5, s89
    s_cmp_gt_u32 s45, 1
    s_cbranch_scc1 CB_32
    s_swappc_b64 s[66:67], s[64:65]
CB_32:
    s_barrier
    s_sub_u32 s45, 6, s89
    s_cmp_gt_u32 s45, 1
    s_cbranch_scc1 CB_33
    s_swappc_b64 s[66:67], s[64:65]
CB_33:
    s_load_dword s76, s[56:57], 0 glc
    s_barrier
    s_waitcnt lgkmcnt(0)
    s_cmp_ge_u32 s76, 1000
    s_cbranch_scc1 F_ax2g
SP_34:
    s_load_dword s76, s[56:57], 0 glc
    s_waitcnt lgkmcnt(0)
    s_cmp_ge_u32 s76, 1000
    s_cbranch_scc1 SD_35
    s_sleep 2
    s_branch SP_34
SD_35:
F_ax2g:
    s_movk_i32 s44, 0
    buffer_load_dwordx4 v[16:19], v2, s[40:43], s44 offen sc0 sc1
    s_movk_i32 s44, 1024
    buffer_load_dwordx4 v[20:23], v2, s[40:43], s44 offen sc0 sc1
    s_movk_i32 s44, 2048
    buffer_load_dwordx4 v[24:27], v2, s[40:43], s44 offen sc0 sc1
    s_movk_i32 s44, 3072
    buffer_load_dwordx4 v[28:31], v2, s[40:43], s44 offen sc0 sc1
    s_movk_i32 s44, 4096
    buffer_load_dwordx4 v[32:35], v2, s[40:43], s44 offen sc0 sc1
    s_movk_i32 s44, 5120
    buffer_load_dwordx4 v[36:39], v2, s[40:43], s44 offen sc0 sc1
    s_movk_i32 s44, 6144
    buffer_load_dwordx4 v[40:43], v2, s[40:43], s44 offen sc0 sc1
    s_movk_i32 s44, 7168
    buffer_load_dwordx4 v[44:47], v2, s[40:43], s44 offen sc0 sc1
    s_mov_b32 s53, 0
    v_and_b32 v13, 7, v0
    v_lshlrev_b32 v13, 2, v13
    v_lshrrev_b32 v9, 3, v0
    v_lshl_add_u32 v13, v9, 7, v13
    s_barrier
    s_waitcnt vmcnt(0)
    s_mov_b32 s58, 0x01010101
    s_mov_b32 s59, s58
    v_max3_u32 v48, v16, v17, v18
    v_med3_u32 v49, v16, v17, v18
    v_min3_u32 v50, v16, v17, v18
    v_med3_u32 v50, v49, v50, v19
    v_med3_u32 v49, v48, v49, v19
    v_max_u32 v48, v48, v19
    v_med3_u32 v50, v49, v50, v20
    v_med3_u32 v49, v48, v49, v20
    v_max_u32 v48, v48, v20
    v_med3_u32 v50, v49, v50, v21
    v_med3_u32 v49, v48, v49, v21
    v_max_u32 v48, v48, v21
    v_med3_u32 v50, v49, v50, v22
    v_med3_u32 v49, v48, v49, v22
    v_max_u32 v48, v48, v22
    v_med3_u32 v50, v49, v50, v23
    v_med3_u32 v49, v48, v49, v23
    v_max_u32 v48, v48, v23
    v_med3_u32 v50, v49, v50, v24
    v_med3_u32 v49, v48, v49, v24
    v_max_u32 v48, v48, v24
    v_med3_u32 v50, v49, v50, v25
    v_med3_u32 v49, v48, v49, v25
    v_max_u32 v48, v48, v25
    v_med3_u32 v50, v49, v50, v26
    v_med3_u32 v49, v48, v49, v26
    v_max_u32 v48, v48, v26
    v_med3_u32 v50, v49, v50, v27
    v_med3_u32 v49, v48, v49, v27
    v_max_u32 v48, v48, v27
    v_med3_u32 v50, v49, v50, v28
    v_med3_u32 v49, v48, v49, v28
    v_max_u32 v48, v48, v28
    v_med3_u32 v50, v49, v50, v29
    v_med3_u32 v49, v48, v49, v29
    v_max_u32 v48, v48, v29
    v_med3_u32 v50, v49, v50, v30
    v_med3_u32 v49, v48, v49, v30
    v_max_u32 v48, v48, v30
    v_med3_u32 v50, v49, v50, v31
    v_med3_u32 v49, v48, v49, v31
    v_max_u32 v48, v48, v31
    v_med3_u32 v50, v49, v50, v32
    v_med3_u32 v49, v48, v49, v32
    v_max_u32 v48, v48, v32
    s_barrier
    v_med3_u32 v50, v49, v50, v33
    v_med3_u32 v49, v48, v49, v33
    v_max_u32 v48, v48, v33
    v_med3_u32 v50, v49, v50, v34
    v_med3_u32 v49, v48, v49, v34
    v_max_u32 v48, v48, v34
    v_med3_u32 v50, v49, v50, v35
    v_med3_u32 v49, v48, v49, v35
    v_max_u32 v48, v48, v35
    v_med3_u32 v50, v49, v50, v36
    v_med3_u32 v49, v48, v49, v36
    v_max_u32 v48, v48, v36
    v_med3_u32 v50, v49, v50, v37
    v_med3_u32 v49, v48, v49, v37
    v_max_u32 v48, v48, v37
    v_med3_u32 v50, v49, v50, v38
    v_med3_u32 v49, v48, v49, v38
    v_max_u32 v48, v48, v38
    v_med3_u32 v50, v49, v50, v39
    v_med3_u32 v49, v48, v49, v39
    v_max_u32 v48, v48, v39
    v_med3_u32 v50, v49, v50, v40
    v_med3_u32 v49, v48, v49, v40
    v_max_u32 v48, v48, v40
    v_med3_u32 v50, v49, v50, v41
    v_med3_u32 v49, v48, v49, v41
    v_max_u32 v48, v48, v41
    v_med3_u32 v50, v49, v50, v42
    v_med3_u32 v49, v48, v49, v42
    v_max_u32 v48, v48, v42
    v_med3_u32 v50, v49, v50, v43
    v_med3_u32 v49, v48, v49, v43
    v_max_u32 v48, v48, v43
    v_med3_u32 v50, v49, v50, v44
    v_med3_u32 v49, v48, v49, v44
    v_max_u32 v48, v48, v44
    v_med3_u32 v50, v49, v50, v45
    v_med3_u32 v49, v48, v49, v45
    v_max_u32 v48, v48, v45
    v_med3_u32 v50, v49, v50, v46
    v_med3_u32 v49, v48, v49, v46
    v_max_u32 v48, v48, v46
    v_med3_u32 v50, v49, v50, v47
    v_med3_u32 v49, v48, v49, v47
    v_max_u32 v48, v48, v47
    v_mov_b32 v4, v48
    s_nop 1
    v_max_u32_dpp v4, v4, v4 row_shr:1 row_mask:0xf bank_mask:0xf bound_ctrl:0
    s_nop 1
    v_max_u32_dpp v4, v4, v4 row_shr:2 row_mask:0xf bank_mask:0xf bound_ctrl:0
    s_nop 1
    v_max_u32_dpp v4, v4, v4 row_shr:4 row_mask:0xf bank_mask:0xf bound_ctrl:0
    s_nop 1
    v_max_u32_dpp v4, v4, v4 row_shr:8 row_mask:0xf bank_mask:0xf bound_ctrl:0
    s_nop 1
    v_max_u32_dpp v4, v4, v4 row_bcast:15 row_mask:0xa bank_mask:0xf
    s_nop 1
    v_max_u32_dpp v4, v4, v4 row_bcast:31 row_mask:0xc bank_mask:0xf
    s_nop 0
    v_readlane_b32 s52, v4, 63
    s_lshl_b64 exec, s[58:59], 0
    s_nop 0
    v_mov_b32 v12, s52
    s_mov_b64 exec, -1
    v_cmp_eq_u32 vcc, s52, v48
    s_nop 1
    v_cndmask_b32 v48, v48, v49, vcc
    v_cndmask_b32 v49, v49, v50, vcc
    v_cndmask_b32 v50, v50, 0, vcc
    s_barrier
    v_mov_b32 v4, v48
    s_nop 1
    v_max_u32_dpp v4, v4, v4 row_shr:1 row_mask:0xf bank_mask:0xf bound_ctrl:0
    s_nop 1
    v_max_u32_dpp v4, v4, v4 row_shr:2 row_mask:0xf bank_mask:0xf bound_ctrl:0
    s_nop 1
    v_max_u32_dpp v4, v4, v4 row_shr:4 row_mask:0xf bank_mask:0xf bound_ctrl:0
    s_nop 1
    v_max_u32_dpp v4, v4, v4 row_shr:8 row_mask:0xf bank_mask:0xf bound_ctrl:0
    s_nop 1
    v_max_u32_dpp v4, v4, v4 row_bcast:15 row_mask:0xa bank_mask:0xf
    s_nop 1
    v_max_u32_dpp v4, v4, v4 row_bcast:31 row_mask:0xc bank_mask:0xf
    s_nop 0
    v_readlane_b32 s52, v4, 63
    s_lshl_b64 exec, s[58:59], 1
    s_nop 0
    v_mov_b32 v12, s52
    s_mov_b64 exec, -1
    v_cmp_eq_u32 vcc, s52, v48
    s_nop 1
    v_cndmask_b32 v48, v48, v49, vcc
    v_cndmask_b32 v49, v49, v50, vcc
    v_cndmask_b32 v50, v50, 0, vcc
    v_mov_b32 v4, v48
    s_nop 1
    v_max_u32_dpp v4, v4, v4 row_shr:1 row_mask:0xf bank_mask:0xf bound_ctrl:0
    s_nop 1
    v_max_u32_dpp v4, v4, v4 row_shr:2 row_mask:0xf bank_mask:0xf bound_ctrl:0
    s_nop 1
    v_max_u32_dpp v4, v4, v4 row_shr:4 row_mask:0xf bank_mask:0xf bound_ctrl:0
    s_nop 1
    v_max_u32_dpp v4, v4, v4 row_shr:8 row_mask:0xf bank_mask:0xf bound_ctrl:0
    s_nop 1
    v_max_u32_dpp v4, v4, v4 row_bcast:15 row_mask:0xa bank_mask:0xf
    s_nop 1
    v_max_u32_dpp v4, v4, v4 row_bcast:31 row_mask:0xc bank_mask:0xf
    s_nop 0
    v_readlane_b32 s52, v4, 63
    s_lshl_b64 exec, s[58:59], 2
    s_nop 0
    v_mov_b32 v12, s52
    s_mov_b64 exec, -1
    v_cmp_eq_u32 vcc, s52, v48
    s_nop 1
    v_cndmask_b32 v48, v48, v49, vcc
    v_cndmask_b32 v49, v49, v50, vcc
    v_cndmask_b32 v50, v50, 0, vcc
    v_mov_b32 v4, v48
    s_nop 1
    v_max_u32_dpp v4, v4, v4 row_shr:1 row_mask:0xf bank_mask:0xf bound_ctrl:0
    s_nop 1
    v_max_u32_dpp v4, v4, v4 row_shr:2 row_mask:0xf bank_mask:0xf bound_ctrl:0
    s_nop 1
    v_max_u32_dpp v4, v4, v4 row_shr:4 row_mask:0xf bank_mask:0xf bound_ctrl:0
    s_nop 1
    v_max_u32_dpp v4, v4, v4 row_shr:8 row_mask:0xf bank_mask:0xf bound_ctrl:0
    s_nop 1
    v_max_u32_dpp v4, v4, v4 row_bcast:15 row_mask:0xa bank_mask:0xf
    s_nop 1
    v_max_u32_dpp v4, v4, v4 row_bcast:31 row_mask:0xc bank_mask:0xf
    s_nop 0
    v_readlane_b32 s52, v4, 63
    s_lshl_b64 exec, s[58:59], 3
    s_nop 0
    v_mov_b32 v12, s52
    s_mov_b64 exec, -1
    v_cmp_eq_u32 vcc, s52, v48
    s_nop 1
    v_cndmask_b32 v48, v48, v49, vcc
    v_cndmask_b32 v49, v49, v50, vcc
    v_cndmask_b32 v50, v50, 0, vcc
    v_mov_b32 v4, v48
    s_nop 1
    v_max_u32_dpp v4, v4, v4 row_shr:1 row_mask:0xf bank_mask:0xf bound_ctrl:0
    s_nop 1
    v_max_u32_dpp v4, v4, v4 row_shr:2 row_mask:0xf bank_mask:0xf bound_ctrl:0
    s_nop 1
    v_max_u32_dpp v4, v4, v4 row_shr:4 row_mask:0xf bank_mask:0xf bound_ctrl:0
    s_nop 1
    v_max_u32_dpp v4, v4, v4 row_shr:8 row_mask:0xf bank_mask:0xf bound_ctrl:0
    s_nop 1
    v_max_u32_dpp v4, v4, v4 row_bcast:15 row_mask:0xa bank_mask:0xf
    s_nop 1
    v_max_u32_dpp v4, v4, v4 row_bcast:31 row_mask:0xc bank_mask:0xf
    s_nop 0
    v_readlane_b32 s52, v4, 63
    s_lshl_b64 exec, s[58:59], 4
    s_nop 0
    v_mov_b32 v12, s52
    s_mov_b64 exec, -1
    v_cmp_eq_u32 vcc, s52, v48
    s_nop 1
    v_cndmask_b32 v48, v48, v49, vcc
    v_cndmask_b32 v49, v49, v50, vcc
    v_cndmask_b32 v50, v50, 0, vcc
    s_barrier
    v_mov_b32 v4, v48
    s_nop 1
    v_max_u32_dpp v4, v4, v4 row_shr:1 row_mask:0xf bank_mask:0xf bound_ctrl:0
    s_nop 1
    v_max_u32_dpp v4, v4, v4 row_shr:2 row_mask:0xf bank_mask:0xf bound_ctrl:0
    s_nop 1
    v_max_u32_dpp v4, v4, v4 row_shr:4 row_mask:0xf bank_mask:0xf bound_ctrl:0
    s_nop 1
    v_max_u32_dpp v4, v4, v4 row_shr:8 row_mask:0xf bank_mask:0xf bound_ctrl:0
    s_nop 1
    v_max_u32_dpp v4, v4, v4 row_bcast:15 row_mask:0xa bank_mask:0xf
    s_nop 1
    v_max_u32_dpp v4, v4, v4 row_bcast:31 row_mask:0xc bank_mask:0xf
    s_nop 0
    v_readlane_b32 s52, v4, 63
    s_lshl_b64 exec, s[58:59], 5
    s_nop 0
    v_mov_b32 v12, s52
    s_mov_b64 exec, -1
    v_cmp_eq_u32 vcc, s52, v48
    s_nop 1
    v_cndmask_b32 v48, v48, v49, vcc
    v_cndmask_b32 v49, v49, v50, vcc
    v_cndmask_b32 v50, v50, 0, vcc
    v_mov_b32 v4, v48
    s_nop 1
    v_max_u32_dpp v4, v4, v4 row_shr:1 row_mask:0xf bank_mask:0xf bound_ctrl:0
    s_nop 1
    v_max_u32_dpp v4, v4, v4 row_shr:2 row_mask:0xf bank_mask:0xf bound_ctrl:0
    s_nop 1
    v_max_u32_dpp v4, v4, v4 row_shr:4 row_mask:0xf bank_mask:0xf bound_ctrl:0
    s_nop 1
    v_max_u32_dpp v4, v4, v4 row_shr:8 row_mask:0xf bank_mask:0xf bound_ctrl:0
    s_nop 1
    v_max_u32_dpp v4, v4, v4 row_bcast:15 row_mask:0xa bank_mask:0xf
    s_nop 1
    v_max_u32_dpp v4, v4, v4 row_bcast:31 row_mask:0xc bank_mask:0xf
    s_nop 0
    v_readlane_b32 s52, v4, 63
    s_lshl_b64 exec, s[58:59], 6
    s_nop 0
    v_mov_b32 v12, s52
    s_mov_b64 exec, -1
    v_cmp_eq_u32 vcc, s52, v48
    s_nop 1
    v_cndmask_b32 v48, v48, v49, vcc
    v_cndmask_b32 v49, v49, v50, vcc
    v_cndmask_b32 v50, v50, 0, vcc
    v_mov_b32 v4, v48
    s_nop 1
    v_max_u32_dpp v4, v4, v4 row_shr:1 row_mask:0xf bank_mask:0xf bound_ctrl:0
    s_nop 1
    v_max_u32_dpp v4, v4, v4 row_shr:2 row_mask:0xf bank_mask:0xf bound_ctrl:0
    s_nop 1
    v_max_u32_dpp v4, v4, v4 row_shr:4 row_mask:0xf bank_mask:0xf bound_ctrl:0
    s_nop 1
    v_max_u32_dpp v4, v4, v4 row_shr:8 row_mask:0xf bank_mask:0xf bound_ctrl:0
    s_nop 1
    v_max_u32_dpp v4, v4, v4 row_bcast:15 row_mask:0xa bank_mask:0xf
    s_nop 1
    v_max_u32_dpp v4, v4, v4 row_bcast:31 row_mask:0xc bank_mask:0xf
    s_nop 0
    v_readlane_b32 s52, v4, 63
    s_lshl_b64 exec, s[58:59], 7
    s_nop 0
    v_mov_b32 v12, s52
    s_mov_b64 exec, -1
    v_cmp_eq_u32 vcc, 0, v48
    s_cbranch_vccz F_tk2
    s_mov_b32 s52, 0
    s_mov_b32 s45, 0
F_tk1:
    v_subrev_u32 v16, s52, v16
    v_subrev_u32 v17, s52, v17
    v_subrev_u32 v18, s52, v18
    v_subrev_u32 v19, s52, v19
    v_subrev_u32 v20, s52, v20
    v_subrev_u32 v21, s52, v21
    v_subrev_u32 v22, s52, v22
    v_subrev_u32 v23, s52, v23
    v_subrev_u32 v24, s52, v24
    v_subrev_u32 v25, s52, v25
    v_subrev_u32 v26, s52, v26
    v_subrev_u32 v27, s52, v27
    v_subrev_u32 v28, s52, v28
    v_subrev_u32 v29, s52, v29
    v_subrev_u32 v30, s52, v30
    v_subrev_u32 v31, s52, v31
    v_subrev_u32 v32, s52, v32
    v_subrev_u32 v33, s52, v33
    v_subrev_u32 v34, s52, v34
    v_subrev_u32 v35, s52, v35
    v_subrev_u32 v36, s52, v36
    v_subrev_u32 v37, s52, v37
    v_subrev_u32 v38, s52, v38
    v_subrev_u32 v39, s52, v39
    v_subrev_u32 v40, s52, v40
    v_subrev_u32 v41, s52, v41
    v_subrev_u32 v42, s52, v42
    v_subrev_u32 v43, s52, v43
    v_subrev_u32 v44, s52, v44
    v_subrev_u32 v45, s52, v45
    v_subrev_u32 v46, s52, v46
    v_subrev_u32 v47, s52, v47
    v_max3_u32 v4, v16, v17, v18
    v_max3_u32 v4, v4, v19, v20
    v_max3_u32 v4, v4, v21, v22
    v_max3_u32 v4, v4, v23, v24
    v_max3_u32 v4, v4, v25, v26
    v_max3_u32 v4, v4, v27, v28
    v_max3_u32 v4, v4, v29, v30
    v_max3_u32 v4, v4, v31, v32
    v_max3_u32 v4, v4, v33, v34
    v_max3_u32 v4, v4, v35, v36
    v_max3_u32 v4, v4, v37, v38
    v_max3_u32 v4, v4, v39, v40
    v_max3_u32 v4, v4, v41, v42
    v_max3_u32 v4, v4, v43, v44
    v_max3_u32 v4, v4, v45, v46
    v_max_u32 v4, v4, v47
    s_nop 1
    v_max_u32_dpp v4, v4, v4 row_shr:1 row_mask:0xf bank_mask:0xf bound_ctrl:0
    s_nop 1
    v_max_u32_dpp v4, v4, v4 row_shr:2 row_mask:0xf bank_mask:0xf bound_ctrl:0
    s_nop 1
    v_max_u32_dpp v4, v4, v4 row_shr:4 row_mask:0xf bank_mask:0xf bound_ctrl:0
    s_nop 1
    v_max_u32_dpp v4, v4, v4 row_shr:8 row_mask:0xf bank_mask:0xf bound_ctrl:0
    s_nop 1
    v_max_u32_dpp v4, v4, v4 row_bcast:15 row_mask:0xa bank_mask:0xf
    s_nop 1
    v_max_u32_dpp v4, v4, v4 row_bcast:31 row_mask:0xc bank_mask:0xf
    s_nop 0
    v_readlane_b32 s52, v4, 63
    s_nop 0
    s_add_u32 s53, s53, s52
    s_lshl_b64 exec, s[58:59], s45
    v_mov_b32 v12, s53
    s_mov_b64 exec, -1
    s_add_u32 s45, s45, 1
    s_cmp_lt_u32 s45, 8
    s_cbranch_scc1 F_tk1
F_tk2:
    v_or_b32 v12, 0x8000, v12
    s_mov_b32 s44, 184320
    buffer_store_dword v12, v13, s[24:27], s44 offen offset:0 sc0 sc1
    buffer_store_dword v12, v13, s[24:27], s44 offen offset:1024 sc0 sc1
    buffer_store_dword v12, v13, s[24:27], s44 offen offset:2048 sc0 sc1
    buffer_store_dword v12, v13, s[24:27], s44 offen offset:3072 sc0 sc1
    s_mov_b32 s44, 188416
    buffer_store_dword v12, v13, s[24:27], s44 offen offset:0 sc0 sc1
    buffer_store_dword v12, v13, s[24:27], s44 offen offset:1024 sc0 sc1
    buffer_store_dword v12, v13, s[24:27], s44 offen offset:2048 sc0 sc1
    buffer_store_dword v12, v13, s[24:27], s44 offen offset:3072 sc0 sc1
    s_branch F_aj
F_ax2n:
    s_barrier
    s_sub_u32 s45, 2, s89
    s_cmp_gt_u32 s45, 1
    s_cbranch_scc1 CB_36
    s_swappc_b64 s[66:67], s[64:65]
CB_36:
    s_barrier
    s_sub_u32 s45, 3, s89
    s_cmp_gt_u32 s45, 1
    s_cbranch_scc1 CB_37
    s_swappc_b64 s[66:67], s[64:65]
CB_37:
    s_barrier
    s_sub_u32 s45, 4, s89
    s_cmp_gt_u32 s45, 1
    s_cbranch_scc1 CB_38
    s_swappc_b64 s[66:67], s[64:65]
CB_38:
    s_barrier
    s_sub_u32 s45, 5, s89
    s_cmp_gt_u32 s45, 1
    s_cbranch_scc1 CB_39
    s_swappc_b64 s[66:67], s[64:65]
CB_39:
    s_barrier
    s_sub_u32 s45, 6, s89
    s_cmp_gt_u32 s45, 1
    s_cbranch_scc1 CB_40
    s_swappc_b64 s[66:67], s[64:65]
CB_40:
    s_barrier
    s_load_dword s76, s[56:57], 0 glc
    s_barrier
    s_waitcnt lgkmcnt(0)
    s_cmp_ge_u32 s76, 1000
    s_cbranch_scc1 F_ax2h
SP_41:
    s_load_dword s76, s[56:57], 0 glc
    s_waitcnt lgkmcnt(0)
    s_cmp_ge_u32 s76, 1000
    s_cbranch_scc1 SD_42
    s_sleep 8
    s_branch SP_41
SD_42:
F_ax2h:
    s_barrier
    s_barrier
    s_barrier
F_aj:
    s_add_u32 s12, s72, 0xa00000
    s_addc_u32 s13, s73, 0
    s_mov_b32 s14, 0xe0000
    s_mov_b32 s15, 0x00020000
    s_and_b32 s46, s2, 63
    s_lshl_b32 s46, s46, 7
    s_add_u32 s56, s46, 0x82d000
    s_add_u32 s56, s72, s56
    s_addc_u32 s57, s73, 0
    s_mov_b32 s58, 0x01010101
    s_mov_b32 s59, s58
    s_mov_b32 s52, 0x05040100
    s_mov_b32 s53, 0x07060302
    v_and_b32 v13, 3, v0
    v_lshlrev_b32 v13, 2, v13
    v_add_u32 v13, 24656, v13
    s_mul_i32 s78, s28, 112
    s_mul_i32 s79, s3, 28
    s_add_u32 s78, s78, s79
    s_lshl_b32 s78, s78, 11
    s_lshl_b32 s79, s29, 8
    s_add_u32 s78, s78, s79

    v_mul_u32_u24 v160, 14336, v5
    v_lshl_add_u32 v160, v7, 4, v160
    s_and_b32 s88, s3, 1
    s_lshl_b32 s88, s88, 12
    s_lshr_b32 s45, s3, 1
    s_mul_i32 s45, s45, 24576
    s_add_u32 s88, s88, s45
    v_subrev_u32 v163, 16, v13
    v_lshrrev_b32 v164, 1, v5
    v_lshlrev_b32 v164, 2, v164
    v_and_b32 v165, 7, v7
    v_xor_b32 v164, v164, v165
    v_lshlrev_b32 v164, 5, v164
    v_lshl_add_u32 v164, v7, 8, v164
    v_and_b32 v165, 1, v5
    v_lshl_add_u32 v164, v165, 4, v164
    s_lshl_b32 s45, s3, 12
    s_add_u32 s45, s45, 106496
    v_add_u32 v164, s45, v164
    s_lshl_b32 s45, s3, 2
    v_add_u32 v165, s45, v5
    v_and_b32 v165, 7, v165
    v_lshlrev_b32 v165, 5, v165
    v_xor_b32 v165, v165, v2
    s_lshl_b32 s45, s3, 10
    s_add_u32 s45, s45, 106496
    v_add_u32 v165, s45, v165
    v_add_u32_e64 v162, 16, v13
    s_barrier
    s_barrier
    s_sleep 2
    s_add_u32 s45, s54, 0
    buffer_load_dwordx4 v[72:75], v6, s[16:19], s45 offen nt
    s_add_u32 s45, s54, 7168
    buffer_load_dwordx4 v[76:79], v6, s[16:19], s45 offen nt
    s_add_u32 s45, s54, 14336
    buffer_load_dwordx4 v[80:83], v6, s[16:19], s45 offen nt
    s_add_u32 s45, s54, 21504
    buffer_load_dwordx4 v[84:87], v6, s[16:19], s45 offen nt
    s_barrier
    s_nop 0
    s_load_dwordx8 s[60:67], s[56:57], 0 glc
    s_add_u32 s45, s54, 28672
    buffer_load_dwordx4 v[88:91], v6, s[16:19], s45 offen nt
    s_add_u32 s45, s54, 35840
    buffer_load_dwordx4 v[92:95], v6, s[16:19], s45 offen nt
    s_add_u32 s45, s54, 43008
    buffer_load_dwordx4 v[96:99], v6, s[16:19], s45 offen nt
    s_add_u32 s45, s54, 50176
    buffer_load_dwordx4 v[100:103], v6, s[16:19], s45 offen nt
    s_barrier
    s_setprio 1
F_sc:
    s_waitcnt lgkmcnt(0)
    s_and_b64 s[74:75], s[60:61], s[62:63]
    s_and_b64 s[74:75], s[74:75], s[64:65]
    s_and_b64 s[74:75], s[74:75], s[66:67]
    s_and_b32 s74, s74, s75
    s_bitcmp1_b32 s74, 15
    s_cbranch_scc1 F_sd
    s_sleep 4
    s_load_dwordx8 s[60:67], s[56:57], 0 glc
    s_branch F_sc
F_sd:

    s_lshl_b64 exec, s[58:59], 0
    v_mov_b32 v4, s60
    s_lshl_b64 exec, s[58:59], 1
    v_mov_b32 v4, s61
    s_lshl_b64 exec, s[58:59], 2
    v_mov_b32 v4, s62
    s_lshl_b64 exec, s[58:59], 3
    v_mov_b32 v4, s63
    s_lshl_b64 exec, s[58:59], 4
    v_mov_b32 v4, s64
    s_lshl_b64 exec, s[58:59], 5
    v_mov_b32 v4, s65
    s_lshl_b64 exec, s[58:59], 6
    v_mov_b32 v4, s66
    s_lshl_b64 exec, s[58:59], 7
    v_mov_b32 v4, s67
    s_mov_b64 exec, -1
    s_mov_b32 s46, 65536
    v_and_b32 v4, 0x7ff, v4
    v_sub_u32 v4, 2047, v4
    v_lshlrev_b32 v9, 4, v4
    v_lshlrev_b32 v4, 11, v4
    v_lshl_add_u32 v4, v5, 4, v4

    buffer_load_dwordx4 v[64:67], v4, s[20:23], s55 offen
    buffer_load_dwordx4 v[68:71], v4, s[20:23], s55 offen offset:64
    buffer_load_dwordx2 v[14:15], v9, s[40:43], s46 offen sc0 sc1
    s_cmp_lt_u32 s2, 224
    s_cbranch_scc1 F_ag
    s_add_u32 s79, s78, 0
    buffer_load_dwordx4 v[16:19], v160, s[80:83], s79 offen nt
    s_add_u32 s79, s78, 2048
    buffer_load_dwordx4 v[20:23], v160, s[80:83], s79 offen nt
    s_add_u32 s79, s78, 4096
    buffer_load_dwordx4 v[24:27], v160, s[80:83], s79 offen nt
    s_add_u32 s79, s78, 6144
    buffer_load_dwordx4 v[28:31], v160, s[80:83], s79 offen nt
    s_add_u32 s79, s78, 8192
    buffer_load_dwordx4 v[144:147], v160, s[80:83], s79 offen nt
    s_add_u32 s79, s78, 10240
    buffer_load_dwordx4 v[148:151], v160, s[80:83], s79 offen nt
    s_add_u32 s79, s78, 12288
    buffer_load_dwordx4 v[152:155], v160, s[80:83], s79 offen nt
    s_sleep 32
    s_branch F_adown
F_ag:
    s_add_u32 s45, s54, 229376
    buffer_load_dwordx4 v[104:107], v6, s[16:19], s45 offen nt
    s_add_u32 s45, s54, 236544
    buffer_load_dwordx4 v[108:111], v6, s[16:19], s45 offen nt
    s_add_u32 s45, s54, 243712
    buffer_load_dwordx4 v[112:115], v6, s[16:19], s45 offen nt
    s_add_u32 s45, s54, 250880
    buffer_load_dwordx4 v[116:119], v6, s[16:19], s45 offen nt
    s_add_u32 s45, s54, 258048
    buffer_load_dwordx4 v[120:123], v6, s[16:19], s45 offen nt
    s_add_u32 s45, s54, 265216
    buffer_load_dwordx4 v[124:127], v6, s[16:19], s45 offen nt
    s_add_u32 s45, s54, 272384
    buffer_load_dwordx4 v[128:131], v6, s[16:19], s45 offen nt
    s_add_u32 s45, s54, 279552
    buffer_load_dwordx4 v[132:135], v6, s[16:19], s45 offen nt
    s_waitcnt vmcnt(8)
    v_lshlrev_b32 v34, 16, v64
    v_and_b32 v35, 0xffff0000, v64
    v_lshlrev_b32 v36, 16, v65
    v_and_b32 v37, 0xffff0000, v65
    v_lshlrev_b32 v38, 16, v66
    v_and_b32 v39, 0xffff0000, v66
    v_lshlrev_b32 v40, 16, v67
    v_and_b32 v41, 0xffff0000, v67
    v_lshlrev_b32 v42, 16, v68
    v_and_b32 v43, 0xffff0000, v68
    v_lshlrev_b32 v44, 16, v69
    v_and_b32 v45, 0xffff0000, v69
    v_lshlrev_b32 v46, 16, v70
    v_and_b32 v47, 0xffff0000, v70
    v_lshlrev_b32 v48, 16, v71
    v_and_b32 v49, 0xffff0000, v71
    v_add_f32 v34, v34, v14
    v_add_f32 v35, v35, v14
    v_add_f32 v36, v36, v14
    v_add_f32 v37, v37, v14
    v_add_f32 v38, v38, v14
    v_add_f32 v39, v39, v14
    v_add_f32 v40, v40, v14
    v_add_f32 v41, v41, v14
    v_add_f32 v42, v42, v14
    v_add_f32 v43, v43, v14
    v_add_f32 v44, v44, v14
    v_add_f32 v45, v45, v14
    v_add_f32 v46, v46, v14
    v_add_f32 v47, v47, v14
    v_add_f32 v48, v48, v14
    v_add_f32_e64 v49, v49, v14
    v_cvt_pk_bf16_f32 v64, v34, v35
    v_cvt_pk_bf16_f32 v65, v36, v37
    v_cvt_pk_bf16_f32 v66, v38, v39
    v_cvt_pk_bf16_f32 v67, v40, v41
    v_cvt_pk_bf16_f32 v68, v42, v43
    v_cvt_pk_bf16_f32 v69, v44, v45
    v_cvt_pk_bf16_f32 v70, v46, v47
    v_cvt_pk_bf16_f32 v71, v48, v49
    v_lshlrev_b32 v34, 16, v64
    v_and_b32 v35, 0xffff0000, v64
    v_lshlrev_b32 v36, 16, v65
    v_and_b32 v37, 0xffff0000, v65
    v_lshlrev_b32 v38, 16, v66
    v_and_b32 v39, 0xffff0000, v66
    v_lshlrev_b32 v40, 16, v67
    v_and_b32 v41, 0xffff0000, v67
    v_lshlrev_b32 v42, 16, v68
    v_and_b32 v43, 0xffff0000, v68
    v_lshlrev_b32 v44, 16, v69
    v_and_b32 v45, 0xffff0000, v69
    v_lshlrev_b32 v46, 16, v70
    v_and_b32 v47, 0xffff0000, v70
    v_lshlrev_b32 v48, 16, v71
    v_and_b32 v49, 0xffff0000, v71
    v_mul_f32 v34, v34, v15
    v_mul_f32 v35, v35, v15
    v_mul_f32 v36, v36, v15
    v_mul_f32 v37, v37, v15
    v_mul_f32 v38, v38, v15
    v_mul_f32 v39, v39, v15
    v_mul_f32 v40, v40, v15
    v_mul_f32 v41, v41, v15
    v_mul_f32 v42, v42, v15
    v_mul_f32 v43, v43, v15
    v_mul_f32 v44, v44, v15
    v_mul_f32 v45, v45, v15
    v_mul_f32 v46, v46, v15
    v_mul_f32 v47, v47, v15
    v_mul_f32 v48, v48, v15
    v_mul_f32 v49, v49, v15
    v_cvt_pk_bf16_f32 v64, v34, v35
    v_cvt_pk_bf16_f32 v65, v36, v37
    v_cvt_pk_bf16_f32 v66, v38, v39
    v_cvt_pk_bf16_f32 v67, v40, v41
    v_cvt_pk_bf16_f32 v68, v42, v43
    v_cvt_pk_bf16_f32 v69, v44, v45
    v_cvt_pk_bf16_f32 v70, v46, v47
    v_cvt_pk_bf16_f32 v71, v48, v49
    s_waitcnt vmcnt(8)
    v_perm_b32 v136, v76, v72, s52
    v_perm_b32 v137, v84, v80, s52
    v_perm_b32 v138, v92, v88, s52
    v_perm_b32 v139, v100, v96, s52
    s_nop 1
    v_mfma_f32_16x16x32_bf16 v[32:35], v[64:67], v[136:139], 0
    v_perm_b32 v140, v76, v72, s53
    v_perm_b32 v141, v84, v80, s53
    v_perm_b32 v142, v92, v88, s53
    v_perm_b32 v143, v100, v96, s53
    s_nop 1
    v_mfma_f32_16x16x32_bf16 v[36:39], v[64:67], v[140:143], 0
    v_perm_b32 v136, v77, v73, s52
    v_perm_b32 v137, v85, v81, s52
    v_perm_b32 v138, v93, v89, s52
    v_perm_b32 v139, v101, v97, s52
    s_nop 1
    v_mfma_f32_16x16x32_bf16 v[40:43], v[64:67], v[136:139], 0
    v_perm_b32 v140, v77, v73, s53
    v_perm_b32 v141, v85, v81, s53
    v_perm_b32 v142, v93, v89, s53
    v_perm_b32 v143, v101, v97, s53
    s_nop 1
    v_mfma_f32_16x16x32_bf16 v[44:47], v[64:67], v[140:143], 0
    v_perm_b32 v136, v78, v74, s52
    v_perm_b32 v137, v86, v82, s52
    v_perm_b32 v138, v94, v90, s52
    v_perm_b32 v139, v102, v98, s52
    s_nop 1
    v_mfma_f32_16x16x32_bf16 v[48:51], v[64:67], v[136:139], 0
    v_perm_b32 v140, v78, v74, s53
    v_perm_b32 v141, v86, v82, s53
    v_perm_b32 v142, v94, v90, s53
    v_perm_b32 v143, v102, v98, s53
    s_nop 1
    v_mfma_f32_16x16x32_bf16 v[52:55], v[64:67], v[140:143], 0
    v_perm_b32 v136, v79, v75, s52
    v_perm_b32 v137, v87, v83, s52
    v_perm_b32 v138, v95, v91, s52
    v_perm_b32 v139, v103, v99, s52
    s_nop 1
    v_mfma_f32_16x16x32_bf16 v[56:59], v[64:67], v[136:139], 0
    v_perm_b32 v140, v79, v75, s53
    v_perm_b32 v141, v87, v83, s53
    v_perm_b32 v142, v95, v91, s53
    v_perm_b32 v143, v103, v99, s53
    s_nop 1
    v_mfma_f32_16x16x32_bf16 v[60:63], v[64:67], v[140:143], 0
    s_waitcnt vmcnt(0)
    s_add_u32 s79, s78, 0
    s_nop 0
    buffer_load_dwordx4 v[16:19], v160, s[80:83], s79 offen nt
    s_add_u32 s79, s78, 2048
    buffer_load_dwordx4 v[20:23], v160, s[80:83], s79 offen nt
    s_add_u32 s79, s78, 4096
    buffer_load_dwordx4 v[24:27], v160, s[80:83], s79 offen nt
    s_add_u32 s79, s78, 6144
    buffer_load_dwordx4 v[28:31], v160, s[80:83], s79 offen nt
    s_add_u32 s79, s78, 8192
    buffer_load_dwordx4 v[144:147], v160, s[80:83], s79 offen nt
    s_add_u32 s79, s78, 10240
    buffer_load_dwordx4 v[148:151], v160, s[80:83], s79 offen nt
    s_add_u32 s79, s78, 12288
    buffer_load_dwordx4 v[152:155], v160, s[80:83], s79 offen nt
    v_perm_b32 v136, v108, v104, s52
    v_perm_b32 v137, v116, v112, s52
    v_perm_b32 v138, v124, v120, s52
    v_perm_b32 v139, v132, v128, s52
    s_nop 1
    v_mfma_f32_16x16x32_bf16 v[32:35], v[68:71], v[136:139], v[32:35]
    v_perm_b32 v140, v108, v104, s53
    v_perm_b32 v141, v116, v112, s53
    v_perm_b32 v142, v124, v120, s53
    v_perm_b32 v143, v132, v128, s53
    s_nop 1
    v_mfma_f32_16x16x32_bf16 v[36:39], v[68:71], v[140:143], v[36:39]
    v_perm_b32 v136, v109, v105, s52
    v_perm_b32 v137, v117, v113, s52
    v_perm_b32 v138, v125, v121, s52
    v_perm_b32 v139, v133, v129, s52
    s_nop 1
    v_mfma_f32_16x16x32_bf16 v[40:43], v[68:71], v[136:139], v[40:43]
    v_perm_b32 v140, v109, v105, s53
    v_perm_b32 v141, v117, v113, s53
    v_perm_b32 v142, v125, v121, s53
    v_perm_b32 v143, v133, v129, s53
    s_nop 1
    v_mfma_f32_16x16x32_bf16 v[44:47], v[68:71], v[140:143], v[44:47]
    v_perm_b32 v136, v110, v106, s52
    v_perm_b32 v137, v118, v114, s52
    v_perm_b32 v138, v126, v122, s52
    v_perm_b32 v139, v134, v130, s52
    s_nop 1
    v_mfma_f32_16x16x32_bf16 v[48:51], v[68:71], v[136:139], v[48:51]
    v_perm_b32 v140, v110, v106, s53
    v_perm_b32 v141, v118, v114, s53
    v_perm_b32 v142, v126, v122, s53
    v_perm_b32 v143, v134, v130, s53
    s_nop 1
    v_mfma_f32_16x16x32_bf16 v[52:55], v[68:71], v[140:143], v[52:55]
    v_perm_b32 v136, v111, v107, s52
    v_perm_b32 v137, v119, v115, s52
    v_perm_b32 v138, v127, v123, s52
    v_perm_b32 v139, v135, v131, s52
    s_nop 1
    v_mfma_f32_16x16x32_bf16 v[56:59], v[68:71], v[136:139], v[56:59]
    v_perm_b32 v140, v111, v107, s53
    v_perm_b32 v141, v119, v115, s53
    v_perm_b32 v142, v127, v123, s53
    v_perm_b32 v143, v135, v131, s53
    s_nop 1
    v_mfma_f32_16x16x32_bf16 v[60:63], v[68:71], v[140:143], v[60:63]
    v_cmp_gt_u32 vcc, 32, v0
    s_nop 1
    v_cndmask_b32 v32, v48, v32, vcc
    v_cndmask_b32 v33, v49, v33, vcc
    v_cndmask_b32 v34, v50, v34, vcc
    v_cndmask_b32 v35, v51, v35, vcc
    ds_write_b128 v164, v[32:35]
    v_cndmask_b32 v36, v52, v36, vcc
    v_cndmask_b32 v37, v53, v37, vcc
    v_cndmask_b32 v38, v54, v38, vcc
    v_cndmask_b32 v39, v55, v39, vcc
    v_xor_b32 v4, 32, v164
    ds_write_b128 v4, v[36:39]
    v_cndmask_b32 v40, v56, v40, vcc
    v_cndmask_b32 v41, v57, v41, vcc
    v_cndmask_b32 v42, v58, v42, vcc
    v_cndmask_b32 v43, v59, v43, vcc
    v_xor_b32 v4, 64, v164
    ds_write_b128 v4, v[40:43]
    v_cndmask_b32 v44, v60, v44, vcc
    v_cndmask_b32 v45, v61, v45, vcc
    v_cndmask_b32 v46, v62, v46, vcc
    v_cndmask_b32 v47, v63, v47, vcc
    v_xor_b32 v4, 96, v164
    ds_write_b128 v4, v[44:47]
    v_mov_b32 v4, 1
    s_mov_b64 exec, 1
    ds_write_b32 v10, v4 offset:16
    s_mov_b64 exec, -1
    ds_read_b32 v12, v13
FW_43:
    s_waitcnt lgkmcnt(0)
    v_cmp_gt_u32 vcc, 1, v12
    s_cbranch_vccz FO_44
    s_sleep 1
    ds_read_b32 v12, v13
    s_branch FW_43
FO_44:
    ds_read_b128 v[72:75], v165 offset:0
    ds_read_b128 v[76:79], v165 offset:4096
    ds_read_b128 v[80:83], v165 offset:8192
    ds_read_b128 v[84:87], v165 offset:12288
    s_waitcnt lgkmcnt(0)
    v_add_f32 v72, v72, v76
    v_add_f32 v80, v80, v84
    v_add_f32 v73, v73, v77
    v_add_f32 v81, v81, v85
    v_add_f32 v74, v74, v78
    v_add_f32 v82, v82, v86
    v_add_f32 v75, v75, v79
    v_add_f32 v83, v83, v87
    v_add_f32 v72, v72, v80
    v_add_f32 v73, v73, v81
    v_add_f32 v74, v74, v82
    v_add_f32 v75, v75, v83
    v_max_u32 v72, 1, v72
    v_max_u32 v74, 1, v74
    buffer_store_dwordx4 v[72:75], v2, s[12:15], s77 offen sc0 sc1
    s_lshl_b32 s44, s38, 2
    s_add_u32 s44, s44, s3
    s_mul_i32 s44, s44, 64
    s_add_u32 s44, s44, 241664
    v_mov_b32 v4, 1
    s_mov_b64 exec, 1
    buffer_atomic_add v4, v8, s[24:27], s44 offen
    s_mov_b64 exec, -1
F_adown:
    v_mov_b32 v4, 2
    s_mov_b64 exec, 1
    ds_write_b32 v10, v4 offset:16
    s_mov_b64 exec, -1
    s_mul_i32 s36, s28, 112
    s_mul_i32 s37, s3, 28
    s_add_u32 s36, s36, s37
    v_min_u32 v4, 55, v0
    v_lshlrev_b32 v4, 4, v4
    s_lshl_b32 s38, s36, 5
    s_lshr_b32 s44, s36, 5
    s_mul_i32 s44, s44, 64
    s_add_u32 s45, s36, 27
    s_lshr_b32 s45, s45, 5
    s_mul_i32 s45, s45, 64
    s_add_u32 s56, s44, 0x83b000
    s_add_u32 s56, s72, s56
    s_addc_u32 s57, s73, 0
    s_add_u32 s58, s45, 0x83b000
    s_add_u32 s58, s72, s58
    s_addc_u32 s59, s73, 0
    v_mov_b32 v156, 0
    v_mov_b32 v157, 0
    v_mov_b32 v158, 0
    v_mov_b32 v159, 0
    s_mov_b32 s48, 0xbfb8aa3b
    ds_read_b32 v12, v163
FW_45:
    s_waitcnt lgkmcnt(0)
    v_cmp_gt_u32 vcc, 2, v12
    s_cbranch_vccz FO_46
    s_sleep 2
    ds_read_b32 v12, v163
    s_branch FW_45
FO_46:
    s_add_u32 s44, s88, 32768
    v_lshlrev_b32 v9, 3, v0
    v_add_u32 v9, s44, v9
    ds_write_b64 v9, v[156:157]
    v_lshrrev_b32 v11, 1, v0
    v_mul_u32_u24 v9, 37, v11
    v_lshrrev_b32 v9, 8, v9
    v_add_u32 v11, v11, v9
    v_lshlrev_b32 v11, 1, v11
    v_and_b32 v9, 1, v0
    v_lshl_add_u32 v11, v9, 8, v11
    v_add_u32 v11, s44, v11
    v_and_b32 v9, 7, v0
    v_lshlrev_b32 v9, 6, v9
    v_lshl_add_u32 v9, v5, 4, v9
    v_add_u32 v9, s44, v9
    s_waitcnt vmcnt(2)
    s_cmp_lt_u32 s2, 224
    s_cbranch_scc1 F_dp
    s_waitcnt vmcnt(0)
F_dp:
    v_perm_b32 v72, v20, v16, s52
    v_perm_b32 v73, v28, v24, s52
    v_perm_b32 v74, v148, v144, s52
    v_perm_b32 v75, v156, v152, s52
    v_perm_b32 v76, v20, v16, s53
    v_perm_b32 v77, v28, v24, s53
    v_perm_b32 v78, v148, v144, s53
    v_perm_b32 v79, v156, v152, s53
    v_perm_b32 v80, v21, v17, s52
    v_perm_b32 v81, v29, v25, s52
    v_perm_b32 v82, v149, v145, s52
    v_perm_b32 v83, v157, v153, s52
    v_perm_b32 v84, v21, v17, s53
    v_perm_b32 v85, v29, v25, s53
    v_perm_b32 v86, v149, v145, s53
    v_perm_b32 v87, v157, v153, s53
    v_perm_b32 v88, v22, v18, s52
    v_perm_b32 v89, v30, v26, s52
    v_perm_b32 v90, v150, v146, s52
    v_perm_b32 v91, v158, v154, s52
    v_perm_b32 v92, v22, v18, s53
    v_perm_b32 v93, v30, v26, s53
    v_perm_b32 v94, v150, v146, s53
    v_perm_b32 v95, v158, v154, s53
    v_perm_b32 v96, v23, v19, s52
    v_perm_b32 v97, v31, v27, s52
    v_perm_b32 v98, v151, v147, s52
    v_perm_b32 v99, v159, v155, s52
    v_perm_b32 v100, v23, v19, s53
    v_perm_b32 v101, v31, v27, s53
    v_perm_b32 v102, v151, v147, s53
    v_perm_b32 v103, v159, v155, s53
    v_and_b32 v14, 1, v5
    v_lshlrev_b32 v14, 11, v14
    v_lshl_add_u32 v14, v7, 5, v14
    v_lshrrev_b32 v15, 1, v5
    v_lshl_add_u32 v14, v15, 4, v14
    v_add_u32 v14, s44, v14
    s_lshl_b32 s45, s3, 10
    s_add_u32 s45, s45, 32768
    v_add_u32 v15, s45, v3
    v_add_u32 v13, 48, v13
    v_and_b32 v17, 31, v0
    v_lshlrev_b32 v17, 4, v17
SP_47:
    s_load_dword s74, s[56:57], 0 glc
    s_load_dword s75, s[58:59], 0 glc
    s_waitcnt lgkmcnt(0)
    s_min_u32 s74, s74, s75
    s_cmp_ge_u32 s74, 8
    s_cbranch_scc1 SD_48
    s_sleep 16
    s_branch SP_47
SD_48:
F_dl:
    s_add_u32 s45, s38, 0
    buffer_load_dwordx4 v[32:35], v4, s[12:15], s45 offen sc0 sc1
    s_add_u32 s45, s38, 114688
    buffer_load_dwordx4 v[36:39], v4, s[12:15], s45 offen sc0 sc1
    s_add_u32 s45, s38, 229376
    buffer_load_dwordx4 v[40:43], v4, s[12:15], s45 offen sc0 sc1
    s_add_u32 s45, s38, 344064
    buffer_load_dwordx4 v[44:47], v4, s[12:15], s45 offen sc0 sc1
    s_add_u32 s45, s38, 458752
    buffer_load_dwordx4 v[48:51], v4, s[12:15], s45 offen sc0 sc1
    s_add_u32 s45, s38, 573440
    buffer_load_dwordx4 v[52:55], v4, s[12:15], s45 offen sc0 sc1
    s_add_u32 s45, s38, 688128
    buffer_load_dwordx4 v[56:59], v4, s[12:15], s45 offen sc0 sc1
    s_add_u32 s45, s38, 802816
    buffer_load_dwordx4 v[60:63], v4, s[12:15], s45 offen sc0 sc1
    s_waitcnt vmcnt(0)
    s_nop 0
    v_min3_u32 v12, v32, v34, v36
    v_min3_u32 v12, v12, v38, v40
    v_min3_u32 v12, v12, v42, v44
    v_min3_u32 v12, v12, v46, v48
    v_min3_u32 v12, v12, v50, v52
    v_min3_u32 v12, v12, v54, v56
    v_min3_u32 v12, v12, v58, v60
    v_min_u32 v12, v12, v62
    v_cmp_eq_u32 vcc, 0, v12
    s_cbranch_vccz F_dm
    s_sleep 6
    s_branch F_dl
F_dm:
    v_add_f32 v32, v32, v40
    v_add_f32 v48, v48, v56
    v_add_f32 v33, v33, v41
    v_add_f32 v49, v49, v57
    v_add_f32 v34, v34, v42
    v_add_f32 v50, v50, v58
    v_add_f32 v35, v35, v43
    v_add_f32 v51, v51, v59
    v_add_f32 v32, v32, v48
    v_add_f32 v33, v33, v49
    v_add_f32 v34, v34, v50
    v_add_f32 v35, v35, v51
    v_add_f32 v36, v36, v44
    v_add_f32 v52, v52, v60
    v_add_f32 v37, v37, v45
    v_add_f32 v53, v53, v61
    v_add_f32 v38, v38, v46
    v_add_f32 v54, v54, v62
    v_add_f32 v39, v39, v47
    v_add_f32 v55, v55, v63
    v_add_f32 v36, v36, v52
    v_add_f32 v37, v37, v53
    v_add_f32 v38, v38, v54
    v_add_f32 v39, v39, v55
    v_cvt_pk_bf16_f32 v40, v32, v36
    v_cvt_pk_bf16_f32 v41, v33, v37
    v_cvt_pk_bf16_f32 v42, v34, v38
    v_cvt_pk_bf16_f32 v43, v35, v39
    v_lshlrev_b32 v32, 16, v40
    v_and_b32 v36, 0xffff0000, v40
    v_lshlrev_b32 v33, 16, v41
    v_and_b32 v37, 0xffff0000, v41
    v_lshlrev_b32 v34, 16, v42
    v_and_b32 v38, 0xffff0000, v42
    v_lshlrev_b32 v35, 16, v43
    v_and_b32 v39, 0xffff0000, v43
    v_mul_f32 v40, s48, v32
    v_mul_f32 v41, s48, v33
    v_mul_f32 v42, s48, v34
    v_mul_f32 v43, s48, v35
    v_exp_f32 v40, v40
    v_exp_f32 v41, v41
    v_exp_f32 v42, v42
    v_exp_f32 v43, v43
    v_add_f32 v40, 1.0, v40
    v_add_f32 v41, 1.0, v41
    v_add_f32 v42, 1.0, v42
    v_add_f32 v43, 1.0, v43
    v_rcp_f32 v40, v40
    v_rcp_f32 v41, v41
    v_rcp_f32 v42, v42
    v_rcp_f32 v43, v43
    v_mul_f32 v32, v32, v40
    v_mul_f32 v33, v33, v41
    v_mul_f32 v34, v34, v42
    v_mul_f32 v35, v35, v43
    v_cvt_pk_bf16_f32 v32, v32, v32
    v_cvt_pk_bf16_f32 v33, v33, v33
    v_cvt_pk_bf16_f32 v34, v34, v34
    v_cvt_pk_bf16_f32 v35, v35, v35
    v_lshlrev_b32 v32, 16, v32
    v_lshlrev_b32 v33, 16, v33
    v_lshlrev_b32 v34, 16, v34
    v_lshlrev_b32 v35, 16, v35
    v_mul_f32 v32, v32, v36
    v_mul_f32 v33, v33, v37
    v_mul_f32 v34, v34, v38
    v_mul_f32 v35, v35, v39
    v_cvt_pk_bf16_f32 v32, v32, v32
    v_cvt_pk_bf16_f32 v33, v33, v33
    v_cvt_pk_bf16_f32 v34, v34, v34
    v_cvt_pk_bf16_f32 v35, v35, v35
    v_cmp_gt_u32 vcc, 56, v0
    s_nop 0
    s_and_saveexec_b64 s[50:51], vcc
    ds_write_b16 v11, v32 offset:0
    ds_write_b16 v11, v33 offset:64
    ds_write_b16 v11, v34 offset:128
    ds_write_b16 v11, v35 offset:192
    s_mov_b64 exec, s[50:51]
    ds_read_b128 v[64:67], v9
    s_waitcnt lgkmcnt(0)
    v_mfma_f32_16x16x32_bf16 v[104:107], v[64:67], v[72:75], 0
    v_mfma_f32_16x16x32_bf16 v[108:111], v[64:67], v[76:79], 0
    v_mfma_f32_16x16x32_bf16 v[112:115], v[64:67], v[80:83], 0
    v_mfma_f32_16x16x32_bf16 v[116:119], v[64:67], v[84:87], 0
    v_mfma_f32_16x16x32_bf16 v[120:123], v[64:67], v[88:91], 0
    v_mfma_f32_16x16x32_bf16 v[124:127], v[64:67], v[92:95], 0
    v_mfma_f32_16x16x32_bf16 v[128:131], v[64:67], v[96:99], 0
    v_mfma_f32_16x16x32_bf16 v[132:135], v[64:67], v[100:103], 0
    v_cmp_gt_u32 vcc, 32, v0
    s_nop 3
    v_cndmask_b32 v32, v120, v104, vcc
    v_cndmask_b32 v33, v124, v108, vcc
    v_cndmask_b32 v34, v128, v112, vcc
    v_cndmask_b32 v35, v132, v116, vcc
    ds_write_b128 v14, v[32:35] offset:0
    v_cndmask_b32 v36, v121, v105, vcc
    v_cndmask_b32 v37, v125, v109, vcc
    v_cndmask_b32 v38, v129, v113, vcc
    v_cndmask_b32 v39, v133, v117, vcc
    ds_write_b128 v14, v[36:39] offset:512
    v_cndmask_b32 v40, v122, v106, vcc
    v_cndmask_b32 v41, v126, v110, vcc
    v_cndmask_b32 v42, v130, v114, vcc
    v_cndmask_b32 v43, v134, v118, vcc
    ds_write_b128 v14, v[40:43] offset:1024
    v_cndmask_b32 v44, v123, v107, vcc
    v_cndmask_b32 v45, v127, v111, vcc
    v_cndmask_b32 v46, v131, v115, vcc
    v_cndmask_b32 v47, v135, v119, vcc
    ds_write_b128 v14, v[44:47] offset:1536
    v_mov_b32 v4, 1
    s_mov_b64 exec, 1
    ds_write_b32 v10, v4 offset:64
    s_mov_b64 exec, -1
    s_lshl_b32 s45, s29, 7
    s_add_u32 s56, s45, 0x82a000
    s_add_u32 s56, s72, s56
    s_addc_u32 s57, s73, 0
    s_lshl_b32 s44, s3, 13
    s_lshl_b32 s50, s29, 9
    s_add_u32 s50, s50, 135168
    s_add_u32 s44, s44, s50
    s_add_u32 s45, s44, 4096
    ds_read_b32 v12, v13
FW_49:
    s_waitcnt lgkmcnt(0)
    v_cmp_gt_u32 vcc, 1, v12
    s_cbranch_vccz FO_50
    s_sleep 1
    ds_read_b32 v12, v13
    s_branch FW_49
FO_50:
    ds_read2st64_b32 v[48:49], v15 offset0:0 offset1:1
    ds_read2st64_b32 v[52:53], v15 offset0:16 offset1:17
    ds_read2st64_b32 v[56:57], v15 offset0:96 offset1:97
    ds_read2st64_b32 v[60:61], v15 offset0:112 offset1:113
    ds_read2st64_b32 v[50:51], v15 offset0:2 offset1:3
    ds_read2st64_b32 v[54:55], v15 offset0:18 offset1:19
    ds_read2st64_b32 v[58:59], v15 offset0:98 offset1:99
    ds_read2st64_b32 v[62:63], v15 offset0:114 offset1:115
    s_waitcnt lgkmcnt(4)
    v_add_f32 v48, v48, v52
    v_add_f32 v56, v56, v60
    v_add_f32 v48, v48, v56
    buffer_atomic_add_f32 v48, v3, s[24:27], s44 offen offset:0
    v_add_f32 v49, v49, v53
    v_add_f32 v57, v57, v61
    v_add_f32 v49, v49, v57
    buffer_atomic_add_f32 v49, v3, s[24:27], s44 offen offset:256
    s_waitcnt lgkmcnt(0)
    v_add_f32 v50, v50, v54
    v_add_f32 v58, v58, v62
    v_add_f32 v50, v50, v58
    buffer_atomic_add_f32 v50, v3, s[24:27], s45 offen offset:0
    v_add_f32 v51, v51, v55
    v_add_f32 v59, v59, v63
    v_add_f32 v51, v51, v59
    buffer_atomic_add_f32 v51, v3, s[24:27], s45 offen offset:256
    s_barrier
    s_barrier
    s_barrier
    s_barrier
    s_waitcnt vmcnt(0)
    s_barrier
    s_mov_b32 s47, 5
    s_cmp_lg_u32 s3, 0
    s_cbranch_scc1 F_end
    s_mov_b32 s76, 1
    s_atomic_add s76, s[56:57], 0
    s_lshl_b32 s44, s28, 6
    s_sub_u32 s44, 2047, s44
    s_movk_i32 s46, 0x7fff
    s_and_b32 s45, s60, 0x7ff
    s_sub_u32 s45, s44, s45
    s_min_u32 s46, s46, s45
    s_and_b32 s45, s61, 0x7ff
    s_sub_u32 s45, s44, s45
    s_min_u32 s46, s46, s45
    s_and_b32 s45, s62, 0x7ff
    s_sub_u32 s45, s44, s45
    s_min_u32 s46, s46, s45
    s_and_b32 s45, s63, 0x7ff
    s_sub_u32 s45, s44, s45
    s_min_u32 s46, s46, s45
    s_and_b32 s45, s64, 0x7ff
    s_sub_u32 s45, s44, s45
    s_min_u32 s46, s46, s45
    s_and_b32 s45, s65, 0x7ff
    s_sub_u32 s45, s44, s45
    s_min_u32 s46, s46, s45
    s_and_b32 s45, s66, 0x7ff
    s_sub_u32 s45, s44, s45
    s_min_u32 s46, s46, s45
    s_and_b32 s45, s67, 0x7ff
    s_sub_u32 s45, s44, s45
    s_min_u32 s46, s46, s45
    v_lshrrev_b32 v4, 5, v0
    v_lshl_add_u32 v4, v4, 12, v17
    s_barrier
    s_barrier
    s_barrier
    s_barrier
    s_barrier
    s_mov_b32 s47, 10
    s_cmp_ge_u32 s46, 64
    s_cbranch_scc1 F_end
F_y3:
    s_load_dword s58, s[56:57], 0 glc
    s_cmp_ge_u32 s47, 16
    s_cbranch_scc1 YB_51
    s_barrier
    s_add_u32 s47, s47, 1
YB_51:
    s_cmp_ge_u32 s47, 16
    s_cbranch_scc1 YB_52
    s_barrier
    s_add_u32 s47, s47, 1
YB_52:
    s_waitcnt lgkmcnt(0)
    s_cmp_lt_u32 s58, 32
    s_cbranch_scc1 F_y3
    s_mov_b32 m0, 27648
    s_nop 0
    buffer_load_dwordx4 v4, s[24:27], s50 offen sc0 sc1 lds
    s_add_u32 s50, s50, 8192
    s_add_u32 m0, m0, 1024
    s_nop 0
    buffer_load_dwordx4 v4, s[24:27], s50 offen sc0 sc1 lds
    s_add_u32 s50, s50, 8192
    s_add_u32 m0, m0, 1024
    s_nop 0
    buffer_load_dwordx4 v4, s[24:27], s50 offen sc0 sc1 lds
    s_add_u32 s50, s50, 8192
    s_add_u32 m0, m0, 1024
    s_nop 0
    buffer_load_dwordx4 v4, s[24:27], s50 offen sc0 sc1 lds
    s_add_u32 s50, s50, 8192
    s_add_u32 m0, m0, 1024
    s_cmp_ge_u32 s47, 16
    s_cbranch_scc1 YB_53
    s_barrier
    s_add_u32 s47, s47, 1
YB_53:
    s_cmp_ge_u32 s47, 16
    s_cbranch_scc1 YB_54
    s_barrier
    s_add_u32 s47, s47, 1
YB_54:
    s_cmp_ge_u32 s47, 16
    s_cbranch_scc1 YB_55
    s_barrier
    s_add_u32 s47, s47, 1
YB_55:
    s_waitcnt vmcnt(0)
    v_mov_b32 v4, 9
    s_mov_b64 exec, 1
    ds_write_b32 v10, v4 offset:96
    s_mov_b64 exec, -1
    s_endpgm
F_codeend:
.section .rodata,"a"
.p2align 6
.amdhsa_kernel parallel_sum__linear_attn_block__moe_arch_mod__prompt_kernel
  .amdhsa_next_free_vgpr 168
  .amdhsa_next_free_sgpr 96
  .amdhsa_accum_offset 168
  .amdhsa_group_segment_fixed_size 0
  .amdhsa_kernarg_size 88
  .amdhsa_user_sgpr_count 2
  .amdhsa_user_sgpr_kernarg_segment_ptr 1
  .amdhsa_system_sgpr_workgroup_id_x 1
  .amdhsa_float_denorm_mode_32 3
  .amdhsa_float_denorm_mode_16_64 3
.end_amdhsa_kernel
```

```asm
; @launch grid=(256,1,1) block=(768,1,1) lds=163840
.amdgcn_target "amdgcn-amd-amdhsa--gfx950"
.text
.globl parallel_sum__linear_attn_block__moe_arch_mod__prompt_kernel
.p2align 8
.type parallel_sum__linear_attn_block__moe_arch_mod__prompt_kernel,@function
parallel_sum__linear_attn_block__moe_arch_mod__prompt_kernel:
    s_load_dwordx4 s[4:7], s[0:1], 0
    s_load_dwordx8 s[60:67], s[0:1], 32
    s_load_dwordx2 s[72:73], s[0:1], 80
    s_load_dwordx4 s[68:71], s[0:1], 64
    s_load_dwordx2 s[8:9], s[0:1], 16
    s_cmp_ge_u32 s2, 256
    s_cbranch_scc1 F_end
    v_lshrrev_b32 v1, 6, v0
    v_and_b32 v0, 63, v0
    s_and_b32 s30, s2, 7
    v_readfirstlane_b32 s3, v1
    s_lshr_b32 s31, s2, 3
    s_and_b32 s32, s30, 1
    s_lshl_b32 s32, s32, 3
    s_and_b32 s35, s31, 7
    s_add_u32 s32, s32, s35
    s_lshr_b32 s33, s30, 1
    s_lshl_b32 s33, s33, 2
    s_lshr_b32 s34, s31, 3
    s_add_u32 s33, s33, s34
    s_lshl_b32 s28, s32, 1
    s_bfe_u32 s29, s30, 0x10001
    s_add_u32 s28, s28, s29
    s_lshl_b32 s29, s30, 2
    s_xor_b32 s29, s29, s30
    s_and_b32 s29, s29, 4
    s_add_u32 s29, s29, s34
    s_lshl_b32 s39, s29, 1
    s_xor_b32 s39, s39, 14
    s_add_u32 s10, s33, 4
    s_and_b32 s10, s10, 15
    v_lshlrev_b32 v2, 4, v0
    s_cmp_ge_u32 s3, 8
    s_cbranch_scc1 F_loader
    s_lshl_b32 s77, s32, 4
    s_add_u32 s77, s77, s33
    s_lshl_b32 s77, s77, 3
    s_add_u32 s77, s77, s3
    s_cmp_lg_u32 s3, 7
    s_cbranch_scc1 F_nt
    s_getpc_b64 s[46:47]
F_pc:
    s_sub_u32 s46, s46, F_pc-parallel_sum__linear_attn_block__moe_arch_mod__prompt_kernel
    s_subb_u32 s47, s47, 0
    s_and_b32 s44, s31, 7
    s_lshl_b32 s44, s44, 13
    v_min_u32 v60, 63, v0
    v_lshlrev_b32 v60, 7, v60
    v_add_u32 v60, s44, v60
    v_min_u32 v60, F_codeend-parallel_sum__linear_attn_block__moe_arch_mod__prompt_kernel-4, v60
    global_load_dword v161, v60, s[46:47]
F_nt:
    s_lshl_b32 s44, s77, 11
    s_waitcnt lgkmcnt(0)

    s_mov_b32 s20, s4
    s_mov_b32 s21, s5
    s_mov_b32 s22, 0x400000
    s_mov_b32 s23, 0x00020000
    buffer_load_dwordx4 v[4:7], v2, s[20:23], s44 offen
    buffer_load_dwordx4 v[8:11], v2, s[20:23], s44 offen offset:1024
    s_mov_b32 s16, s60
    s_mov_b32 s17, s61
    s_mov_b32 s18, 0x800
    s_mov_b32 s19, 0x00020000
    buffer_load_dwordx4 v[12:15], v2, s[16:19], 0 offen
    buffer_load_dwordx4 v[16:19], v2, s[16:19], 0 offen offset:1024
    s_add_u32 s24, s72, 0x800000
    s_addc_u32 s25, s73, 0
    s_mov_b32 s26, 0x100000
    s_mov_b32 s27, 0x00020000
    s_add_u32 s40, s72, 0x900000
    s_addc_u32 s41, s73, 0
    s_mov_b32 s42, 0x18000
    s_mov_b32 s43, 0x00020000
    s_mov_b32 s48, s70
    s_mov_b32 s49, s71
    s_mov_b32 s50, 0x100
    s_mov_b32 s51, 0x00020000
    v_mov_b32 v20, 0
    v_mov_b32 v21, 0
    v_mov_b32 v22, 0
    v_mov_b32 v23, 0
    s_cmp_lg_u32 s3, 5
    s_cbranch_scc1 F_a0
    s_cmp_lg_u32 s33, 0
    s_cbranch_scc1 F_a0
    s_lshl_b32 s44, s32, 8
    s_add_u32 s44, s44, 32768
    s_lshl_b32 s45, s32, 2
    s_mov_b64 exec, 0xffff
    buffer_store_dwordx4 v[20:23], v2, s[40:43], s44 offen sc0 sc1
    s_mov_b64 exec, 1
    s_waitcnt vmcnt(0)
    v_mov_b32 v24, 1
    buffer_store_dword v24, v20, s[48:51], s45 offen sc0 sc1
    s_mov_b64 exec, -1
    s_branch F_a1
F_a0:
    s_waitcnt vmcnt(0)
F_a1:

    v_lshlrev_b32 v24, 16, v4
    v_and_b32 v25, 0xffff0000, v4
    v_lshlrev_b32 v26, 16, v5
    v_and_b32 v27, 0xffff0000, v5
    v_lshlrev_b32 v28, 16, v6
    v_and_b32 v29, 0xffff0000, v6
    v_lshlrev_b32 v30, 16, v7
    v_and_b32 v31, 0xffff0000, v7
    v_lshlrev_b32 v32, 16, v8
    v_and_b32 v33, 0xffff0000, v8
    v_lshlrev_b32 v34, 16, v9
    v_and_b32 v35, 0xffff0000, v9
    v_lshlrev_b32 v36, 16, v10
    v_and_b32 v37, 0xffff0000, v10
    v_lshlrev_b32 v38, 16, v11
    v_and_b32 v39, 0xffff0000, v11
    v_add_f32 v40, v24, v25
    v_add_f32 v41, v26, v27
    v_add_f32 v42, v28, v29
    v_add_f32 v43, v30, v31
    v_add_f32 v44, v32, v33
    v_add_f32 v45, v34, v35
    v_add_f32 v46, v36, v37
    v_add_f32 v47, v38, v39
    v_add_f32 v40, v40, v44
    v_add_f32 v41, v41, v45
    v_add_f32 v42, v42, v46
    v_add_f32 v43, v43, v47
    v_add_f32 v40, v40, v42
    v_add_f32 v41, v41, v43
    v_add_f32 v40, v40, v41
    s_nop 1
    v_add_f32_dpp v40, v40, v40 row_shr:1 row_mask:0xf bank_mask:0xf bound_ctrl:0
    s_nop 1
    v_add_f32_dpp v40, v40, v40 row_shr:2 row_mask:0xf bank_mask:0xf bound_ctrl:0
    s_nop 1
    v_add_f32_dpp v40, v40, v40 row_shr:4 row_mask:0xf bank_mask:0xf bound_ctrl:0
    s_nop 1
    v_add_f32_dpp v40, v40, v40 row_shr:8 row_mask:0xf bank_mask:0xf bound_ctrl:0
    s_nop 1
    v_add_f32_dpp v40, v40, v40 row_bcast:15 row_mask:0xa bank_mask:0xf
    s_nop 1
    v_add_f32_dpp v40, v40, v40 row_bcast:31 row_mask:0xc bank_mask:0xf
    s_nop 0
    v_readlane_b32 s52, v40, 63
    v_mov_b32 v41, 0x3a800000
    s_nop 0
    v_mul_f32 v41, s52, v41
    v_sub_f32 v44, v24, v41
    v_sub_f32 v45, v25, v41
    v_sub_f32 v46, v26, v41
    v_sub_f32 v47, v27, v41
    v_sub_f32 v48, v28, v41
    v_sub_f32 v49, v29, v41
    v_sub_f32 v50, v30, v41
    v_sub_f32 v51, v31, v41
    v_sub_f32 v52, v32, v41
    v_sub_f32 v53, v33, v41
    v_sub_f32 v54, v34, v41
    v_sub_f32 v55, v35, v41
    v_sub_f32 v56, v36, v41
    v_sub_f32 v57, v37, v41
    v_sub_f32 v58, v38, v41
    v_sub_f32 v59, v39, v41
    v_mul_f32 v40, v44, v44
    v_mul_f32 v42, v45, v45
    v_fmac_f32 v40, v46, v46
    v_fmac_f32 v42, v47, v47
    v_fmac_f32 v40, v48, v48
    v_fmac_f32 v42, v49, v49
    v_fmac_f32 v40, v50, v50
    v_fmac_f32 v42, v51, v51
    v_fmac_f32 v40, v52, v52
    v_fmac_f32 v42, v53, v53
    v_fmac_f32 v40, v54, v54
    v_fmac_f32 v42, v55, v55
    v_fmac_f32 v40, v56, v56
    v_fmac_f32 v42, v57, v57
    v_fmac_f32 v40, v58, v58
    v_fmac_f32 v42, v59, v59
    v_add_f32 v40, v40, v42
    s_nop 1
    v_add_f32_dpp v40, v40, v40 row_shr:1 row_mask:0xf bank_mask:0xf bound_ctrl:0
    s_nop 1
    v_add_f32_dpp v40, v40, v40 row_shr:2 row_mask:0xf bank_mask:0xf bound_ctrl:0
    s_nop 1
    v_add_f32_dpp v40, v40, v40 row_shr:4 row_mask:0xf bank_mask:0xf bound_ctrl:0
    s_nop 1
    v_add_f32_dpp v40, v40, v40 row_shr:8 row_mask:0xf bank_mask:0xf bound_ctrl:0
    s_nop 1
    v_add_f32_dpp v40, v40, v40 row_bcast:15 row_mask:0xa bank_mask:0xf
    s_nop 1
    v_add_f32_dpp v40, v40, v40 row_bcast:31 row_mask:0xc bank_mask:0xf
    s_nop 0
    v_readlane_b32 s52, v40, 63
    v_mov_b32 v42, 0x3a800000
    s_nop 0
    v_mul_f32 v42, s52, v42
    v_cvt_pk_bf16_f32 v43, v41, v42
    v_lshlrev_b32 v41, 16, v43
    v_and_b32 v42, 0xffff0000, v43
    v_add_f32 v42, 0x3727c5ac, v42
    v_cvt_pk_bf16_f32 v42, v42, v42
    v_lshlrev_b32 v42, 16, v42
    v_sqrt_f32 v42, v42
    s_nop 0
    v_cvt_pk_bf16_f32 v42, v42, v42
    v_lshlrev_b32 v42, 16, v42
    v_rcp_f32 v42, v42
    v_sub_f32 v24, v24, v41
    v_sub_f32 v25, v25, v41
    v_sub_f32 v26, v26, v41
    v_sub_f32 v27, v27, v41
    v_sub_f32 v28, v28, v41
    v_sub_f32 v29, v29, v41
    v_sub_f32 v30, v30, v41
    v_sub_f32 v31, v31, v41
    v_sub_f32 v32, v32, v41
    v_sub_f32 v33, v33, v41
    v_sub_f32 v34, v34, v41
    v_sub_f32 v35, v35, v41
    v_sub_f32 v36, v36, v41
    v_sub_f32 v37, v37, v41
    v_sub_f32 v38, v38, v41
    v_sub_f32 v39, v39, v41
    v_cvt_pk_bf16_f32 v4, v24, v25
    v_cvt_pk_bf16_f32 v5, v26, v27
    v_cvt_pk_bf16_f32 v6, v28, v29
    v_cvt_pk_bf16_f32 v7, v30, v31
    v_cvt_pk_bf16_f32 v8, v32, v33
    v_cvt_pk_bf16_f32 v9, v34, v35
    v_cvt_pk_bf16_f32 v10, v36, v37
    v_cvt_pk_bf16_f32 v11, v38, v39
    v_lshlrev_b32 v24, 16, v4
    v_and_b32 v25, 0xffff0000, v4
    v_lshlrev_b32 v26, 16, v5
    v_and_b32 v27, 0xffff0000, v5
    v_lshlrev_b32 v28, 16, v6
    v_and_b32 v29, 0xffff0000, v6
    v_lshlrev_b32 v30, 16, v7
    v_and_b32 v31, 0xffff0000, v7
    v_lshlrev_b32 v32, 16, v8
    v_and_b32 v33, 0xffff0000, v8
    v_lshlrev_b32 v34, 16, v9
    v_and_b32 v35, 0xffff0000, v9
    v_lshlrev_b32 v36, 16, v10
    v_and_b32 v37, 0xffff0000, v10
    v_lshlrev_b32 v38, 16, v11
    v_and_b32 v39, 0xffff0000, v11
    v_mul_f32 v24, v24, v42
    v_mul_f32 v25, v25, v42
    v_mul_f32 v26, v26, v42
    v_mul_f32 v27, v27, v42
    v_mul_f32 v28, v28, v42
    v_mul_f32 v29, v29, v42
    v_mul_f32 v30, v30, v42
    v_mul_f32 v31, v31, v42
    v_mul_f32 v32, v32, v42
    v_mul_f32 v33, v33, v42
    v_mul_f32 v34, v34, v42
    v_mul_f32 v35, v35, v42
    v_mul_f32 v36, v36, v42
    v_mul_f32 v37, v37, v42
    v_mul_f32 v38, v38, v42
    v_mul_f32 v39, v39, v42
    v_cvt_pk_bf16_f32 v4, v24, v25
    v_cvt_pk_bf16_f32 v5, v26, v27
    v_cvt_pk_bf16_f32 v6, v28, v29
    v_cvt_pk_bf16_f32 v7, v30, v31
    v_cvt_pk_bf16_f32 v8, v32, v33
    v_cvt_pk_bf16_f32 v9, v34, v35
    v_cvt_pk_bf16_f32 v10, v36, v37
    v_cvt_pk_bf16_f32 v11, v38, v39
    v_mov_b32 v40, 0
    v_mov_b32 v43, 0
    v_dot2_f32_bf16 v40, v4, v12, v40
    v_dot2_f32_bf16 v43, v5, v13, v43
    v_dot2_f32_bf16 v40, v6, v14, v40
    v_dot2_f32_bf16 v43, v7, v15, v43
    v_dot2_f32_bf16 v40, v8, v16, v40
    v_dot2_f32_bf16 v43, v9, v17, v43
    v_dot2_f32_bf16 v40, v10, v18, v40
    v_dot2_f32_bf16 v43, v11, v19, v43
    s_nop 2
    v_add_f32 v40, v40, v43
    s_nop 1
    v_add_f32_dpp v40, v40, v40 row_shr:1 row_mask:0xf bank_mask:0xf bound_ctrl:0
    s_nop 1
    v_add_f32_dpp v40, v40, v40 row_shr:2 row_mask:0xf bank_mask:0xf bound_ctrl:0
    s_nop 1
    v_add_f32_dpp v40, v40, v40 row_shr:4 row_mask:0xf bank_mask:0xf bound_ctrl:0
    s_nop 1
    v_add_f32_dpp v40, v40, v40 row_shr:8 row_mask:0xf bank_mask:0xf bound_ctrl:0
    s_nop 1
    v_add_f32_dpp v40, v40, v40 row_bcast:15 row_mask:0xa bank_mask:0xf
    s_nop 1
    v_add_f32_dpp v40, v40, v40 row_bcast:31 row_mask:0xc bank_mask:0xf
    s_nop 0
    v_readlane_b32 s52, v40, 63
    s_nop 1
    v_mov_b32 v44, s52
    v_cvt_pk_bf16_f32 v44, v44, v44
    v_and_b32 v44, 0xffff0000, v44
    v_ashrrev_i32 v45, 31, v44
    v_or_b32 v45, 0x80000000, v45
    v_xor_b32 v44, v44, v45
    v_and_b32 v44, 0xffff0000, v44
    s_sub_u32 s44, 2047, s77
    v_or_b32 v44, s44, v44
    v_xor_b32 v46, 0x80000000, v41
    v_mov_b32 v47, v42
    v_mul_f32 v48, 0x3fb8aa3b, v42
    s_lshl_b32 s44, s77, 2
    s_lshl_b32 s45, s77, 4
    s_add_u32 s45, s45, 65536
    v_mov_b32 v45, 0
    s_mov_b64 exec, 1
    buffer_store_dword v44, v45, s[40:43], s44 offen sc0 sc1
    buffer_store_dwordx3 v[46:48], v45, s[40:43], s45 offen sc0 sc1
    s_mov_b64 exec, -1

    s_cmp_ge_u32 s3, 4
    s_cbranch_scc1 F_aux
    s_setprio 2
    s_lshr_b32 s36, s3, 1
    s_and_b32 s37, s3, 1
    s_lshl_b32 s38, s36, 13
    s_lshl_b32 s42, s37, 1

    v_and_b32 v1, 15, v0
    v_lshrrev_b32 v2, 4, v0
    v_lshrrev_b32 v3, 1, v1
    v_xor_b32 v3, v3, v2
    v_lshlrev_b32 v3, 4, v3
    v_lshlrev_b32 v1, 7, v1
    v_add3_u32 v4, v1, v3, s38
    v_xor_b32 v5, 64, v4
    v_add_u32 v6, 81920, v4
    v_add_u32 v7, 81920, v5
    v_bfe_u32 v1, v0, 2, 2
    v_lshl_add_u32 v3, v2, 3, v1
    v_lshrrev_b32 v1, 1, v1
    v_and_b32 v2, 1, v2
    v_lshl_add_u32 v1, v2, 1, v1
    v_xor_b32 v1, s42, v1
    v_lshlrev_b32 v1, 5, v1
    v_lshl_add_u32 v1, v3, 7, v1
    v_and_b32 v2, 3, v0
    v_lshl_add_u32 v1, v2, 3, v1

    v_add_u32 v8, 16384, v1
    v_xor_b32 v9, 32, v8
    v_add_u32 v10, 81920, v8
    v_add_u32 v11, 81920, v9
    s_mov_b32 s40, 0x3f800008
    s_mov_b32 s41, s40
    s_mov_b32 s74, 0x358637bd
    s_mov_b32 s75, s74
    s_lshl_b32 s42, s36, 8
    s_add_u32 s42, s42, 24832
    v_and_or_b32 v164, v0, 48, s42
    v_and_b32 v165, 15, v0
    s_lshl_b32 s42, s37, 7
    s_add_u32 s42, s42, 26368
    v_lshl_add_u32 v165, v165, 2, s42
    s_lshl_b32 s42, s3, 12
    s_add_u32 s42, s42, 65536
    v_lshl_add_u32 v1, v0, 4, s42
    s_lshl_b32 s42, s3, 7
    s_add_u32 s42, s42, 27136
    v_and_or_b32 v2, v0, 48, s42
    s_lshl_b32 s42, s3, 2
    s_add_u32 s42, s42, 24640
    v_mov_b32 v3, s42
    s_lshl_b32 s46, s28, 6
    s_lshl_b32 s47, s29, 8
    s_lshl_b32 s42, s3, 6
    s_add_u32 s47, s47, s42
    s_lshl_b32 s42, s46, 11
    s_add_u32 s42, s42, s47
    s_lshl_b32 s78, s10, 1
    s_add_u32 s78, s78, s37
    s_lshl_b32 s79, s32, 18
    s_lshl_b32 s80, s36, 17
    s_add_u32 s79, s79, s80
    s_lshl_b32 s80, s78, 10
    s_add_u32 s79, s79, s80
    s_lshl_b32 s45, s32, 1
    s_add_u32 s45, s45, s36
    s_mul_i32 s45, s45, 8*64
    s_add_u32 s45, s45, 225280
    v_and_b32 v12, 15, v0
    v_bfe_u32 v13, v0, 4, 1
    v_lshlrev_b32 v13, 5, v13
    v_lshrrev_b32_e64 v14, 5, v0
    v_lshl_add_u32 v13, v14, 4, v13
    v_lshl_add_u32 v167, v12, 11, v13
    s_mul_i32 s82, s78, 4224
    s_add_u32 s83, s82, 4096
    s_lshl_b32 s50, s78, 4
    s_and_b32 s44, s32, 4-1
    s_mul_i32 s44, s44, 16/4
    s_add_u32 s50, s50, s44
    s_mul_i32 s50, s50, 64
    s_and_b32 s44, s2, 63
    s_lshl_b32 s44, s44, 7

    s_add_u32 s56, s50, 0x82f000
    s_add_u32 s56, s72, s56
    s_addc_u32 s57, s73, 0
    s_add_u32 s48, s44, 0x82d000
    s_add_u32 s48, s72, s48
    s_addc_u32 s49, s73, 0
    s_add_u32 s16, s72, 0x400000
    s_addc_u32 s17, s73, 0
    s_mov_b32 s18, 0x400000
    s_mov_b32 s19, 0x00020000
    s_mov_b32 s52, s68
    s_mov_b32 s53, s69
    s_mov_b32 s54, 0x400000
    s_mov_b32 s55, 0x00020000
    s_add_u32 s68, s45, 0x800000
    s_add_u32 s68, s72, s68
    s_addc_u32 s69, s73, 0
    s_mov_b32 s76, 1
    s_barrier
    ds_read_b128 v[12:15], v4 offset:0
    ds_read_b128 v[16:19], v4 offset:2048
    ds_read_b128 v[20:23], v4 offset:4096
    ds_read_b128 v[24:27], v4 offset:6144
    ds_read_b64_tr_b16 v[44:45], v8 offset:8192
    ds_read_b64_tr_b16 v[46:47], v8 offset:8704
    ds_read_b64_tr_b16 v[48:49], v9 offset:8192
    ds_read_b64_tr_b16 v[50:51], v9 offset:8704
    ds_read_b64_tr_b16 v[52:53], v8 offset:16384
    ds_read_b64_tr_b16 v[54:55], v8 offset:16896
    ds_read_b64_tr_b16 v[56:57], v9 offset:16384
    ds_read_b64_tr_b16 v[58:59], v9 offset:16896
    ds_read_b64_tr_b16 v[60:61], v8 offset:0
    ds_read_b64_tr_b16 v[62:63], v8 offset:512
    ds_read_b64_tr_b16 v[64:65], v9 offset:0
    s_waitcnt lgkmcnt(8)
    ds_read_b64_tr_b16 v[66:67], v9 offset:512
    s_waitcnt lgkmcnt(10)
    v_mfma_f32_16x16x32_bf16 v[100:103], v[12:15], v[44:47], 0
    v_mfma_f32_16x16x32_bf16 v[104:107], v[16:19], v[44:47], 0
    v_mfma_f32_16x16x32_bf16 v[108:111], v[20:23], v[44:47], 0
    v_mfma_f32_16x16x32_bf16 v[112:115], v[24:27], v[44:47], 0
    s_waitcnt lgkmcnt(8)
    v_mfma_f32_16x16x32_bf16 v[116:119], v[12:15], v[48:51], 0
    ds_read_b64_tr_b16 v[44:45], v8 offset:12288
    v_mfma_f32_16x16x32_bf16 v[120:123], v[16:19], v[48:51], 0
    ds_read_b64_tr_b16 v[46:47], v8 offset:12800
    v_mfma_f32_16x16x32_bf16 v[124:127], v[20:23], v[48:51], 0
    ds_read_b128 v[28:31], v5 offset:0
    v_mfma_f32_16x16x32_bf16 v[128:131], v[24:27], v[48:51], 0
    ds_read_b128 v[32:35], v5 offset:2048
    s_waitcnt lgkmcnt(10)
    v_mfma_f32_16x16x32_bf16 v[132:135], v[12:15], v[52:55], 0
    ds_read_b128 v[36:39], v5 offset:4096
    v_mfma_f32_16x16x32_bf16 v[136:139], v[16:19], v[52:55], 0
    ds_read_b128 v[40:43], v5 offset:6144
    v_mfma_f32_16x16x32_bf16 v[140:143], v[20:23], v[52:55], 0
    ds_read_b64_tr_b16 v[48:49], v9 offset:12288
    v_mfma_f32_16x16x32_bf16 v[144:147], v[24:27], v[52:55], 0
    ds_read_b64_tr_b16 v[50:51], v9 offset:12800
    s_waitcnt lgkmcnt(12)
    v_mfma_f32_16x16x32_bf16 v[148:151], v[12:15], v[56:59], 0
    ds_read_b64_tr_b16 v[52:53], v8 offset:20480
    v_mfma_f32_16x16x32_bf16 v[152:155], v[16:19], v[56:59], 0
    ds_read_b64_tr_b16 v[54:55], v8 offset:20992
    v_mfma_f32_16x16x32_bf16 v[156:159], v[20:23], v[56:59], 0
    v_mfma_f32_16x16x32_bf16 v[160:163], v[24:27], v[56:59], 0
    s_waitcnt lgkmcnt(12)
    v_mfma_f32_16x16x32_bf16 v[68:71], v[60:63], v[12:15], 0
    ds_read_b64_tr_b16 v[56:57], v9 offset:20480
    v_mfma_f32_16x16x32_bf16 v[72:75], v[60:63], v[16:19], 0
    ds_read_b64_tr_b16 v[58:59], v9 offset:20992
    v_mfma_f32_16x16x32_bf16 v[76:79], v[60:63], v[20:23], 0
    v_mfma_f32_16x16x32_bf16 v[80:83], v[60:63], v[24:27], 0
    s_waitcnt lgkmcnt(12)
    v_mfma_f32_16x16x32_bf16 v[84:87], v[64:67], v[12:15], 0
    ds_read_b64_tr_b16 v[60:61], v8 offset:4096
    v_mfma_f32_16x16x32_bf16 v[88:91], v[64:67], v[16:19], 0
    ds_read_b64_tr_b16 v[62:63], v8 offset:4608
    v_mfma_f32_16x16x32_bf16 v[92:95], v[64:67], v[20:23], 0
    v_mfma_f32_16x16x32_bf16 v[96:99], v[64:67], v[24:27], 0
    ds_read_b64_tr_b16 v[64:65], v9 offset:4096
    s_waitcnt lgkmcnt(8)
    ds_read_b64_tr_b16 v[66:67], v9 offset:4608
    s_waitcnt lgkmcnt(13)
    v_mfma_f32_16x16x32_bf16 v[100:103], v[28:31], v[44:47], v[100:103]
    s_waitcnt lgkmcnt(12)
    v_mfma_f32_16x16x32_bf16 v[104:107], v[32:35], v[44:47], v[104:107]
    s_waitcnt lgkmcnt(11)
    v_mfma_f32_16x16x32_bf16 v[108:111], v[36:39], v[44:47], v[108:111]
    s_waitcnt lgkmcnt(10)
    v_mfma_f32_16x16x32_bf16 v[112:115], v[40:43], v[44:47], v[112:115]
    s_waitcnt lgkmcnt(0)
    s_barrier
    v_mfma_f32_16x16x32_bf16 v[116:119], v[28:31], v[48:51], v[116:119]
    ds_read_b64_tr_b16 v[44:45], v8 offset:49152
    v_mfma_f32_16x16x32_bf16 v[120:123], v[32:35], v[48:51], v[120:123]
    ds_read_b64_tr_b16 v[46:47], v8 offset:49664
    v_mfma_f32_16x16x32_bf16 v[124:127], v[36:39], v[48:51], v[124:127]
    ds_read_b128 v[12:15], v4 offset:40960
    v_mfma_f32_16x16x32_bf16 v[128:131], v[40:43], v[48:51], v[128:131]
    ds_read_b128 v[16:19], v4 offset:43008
    v_mfma_f32_16x16x32_bf16 v[132:135], v[28:31], v[52:55], v[132:135]
    ds_read_b128 v[20:23], v4 offset:45056
    v_mfma_f32_16x16x32_bf16 v[136:139], v[32:35], v[52:55], v[136:139]
    ds_read_b128 v[24:27], v4 offset:47104
    v_mfma_f32_16x16x32_bf16 v[140:143], v[36:39], v[52:55], v[140:143]
    ds_read_b64_tr_b16 v[48:49], v9 offset:49152
    v_mfma_f32_16x16x32_bf16 v[144:147], v[40:43], v[52:55], v[144:147]
    ds_read_b64_tr_b16 v[50:51], v9 offset:49664
    v_mfma_f32_16x16x32_bf16 v[148:151], v[28:31], v[56:59], v[148:151]
    ds_read_b64_tr_b16 v[52:53], v8 offset:57344
    v_mfma_f32_16x16x32_bf16 v[152:155], v[32:35], v[56:59], v[152:155]
    ds_read_b64_tr_b16 v[54:55], v8 offset:57856
    v_mfma_f32_16x16x32_bf16 v[156:159], v[36:39], v[56:59], v[156:159]
    v_mfma_f32_16x16x32_bf16 v[160:163], v[40:43], v[56:59], v[160:163]
    v_mfma_f32_16x16x32_bf16 v[68:71], v[60:63], v[28:31], v[68:71]
    ds_read_b64_tr_b16 v[56:57], v9 offset:57344
    v_mfma_f32_16x16x32_bf16 v[72:75], v[60:63], v[32:35], v[72:75]
    ds_read_b64_tr_b16 v[58:59], v9 offset:57856
    v_mfma_f32_16x16x32_bf16 v[76:79], v[60:63], v[36:39], v[76:79]
    v_mfma_f32_16x16x32_bf16 v[80:83], v[60:63], v[40:43], v[80:83]
    v_mfma_f32_16x16x32_bf16 v[84:87], v[64:67], v[28:31], v[84:87]
    ds_read_b64_tr_b16 v[60:61], v8 offset:40960
    v_mfma_f32_16x16x32_bf16 v[88:91], v[64:67], v[32:35], v[88:91]
    ds_read_b64_tr_b16 v[62:63], v8 offset:41472
    v_mfma_f32_16x16x32_bf16 v[92:95], v[64:67], v[36:39], v[92:95]
    v_mfma_f32_16x16x32_bf16 v[96:99], v[64:67], v[40:43], v[96:99]
    ds_read_b64_tr_b16 v[64:65], v9 offset:40960
    s_waitcnt lgkmcnt(8)
    ds_read_b64_tr_b16 v[66:67], v9 offset:41472
    s_waitcnt lgkmcnt(13)
    v_mfma_f32_16x16x32_bf16 v[100:103], v[12:15], v[44:47], v[100:103]
    s_waitcnt lgkmcnt(12)
    v_mfma_f32_16x16x32_bf16 v[104:107], v[16:19], v[44:47], v[104:107]
    s_waitcnt lgkmcnt(11)
    v_mfma_f32_16x16x32_bf16 v[108:111], v[20:23], v[44:47], v[108:111]
    s_waitcnt lgkmcnt(10)
    v_mfma_f32_16x16x32_bf16 v[112:115], v[24:27], v[44:47], v[112:115]
    s_waitcnt lgkmcnt(8)
    v_mfma_f32_16x16x32_bf16 v[116:119], v[12:15], v[48:51], v[116:119]
    ds_read_b64_tr_b16 v[44:45], v8 offset:53248
    v_mfma_f32_16x16x32_bf16 v[120:123], v[16:19], v[48:51], v[120:123]
    ds_read_b64_tr_b16 v[46:47], v8 offset:53760
    v_mfma_f32_16x16x32_bf16 v[124:127], v[20:23], v[48:51], v[124:127]
    ds_read_b128 v[28:31], v5 offset:40960
    v_mfma_f32_16x16x32_bf16 v[128:131], v[24:27], v[48:51], v[128:131]
    ds_read_b128 v[32:35], v5 offset:43008
    s_waitcnt lgkmcnt(10)
    v_mfma_f32_16x16x32_bf16 v[132:135], v[12:15], v[52:55], v[132:135]
    ds_read_b128 v[36:39], v5 offset:45056
    v_mfma_f32_16x16x32_bf16 v[136:139], v[16:19], v[52:55], v[136:139]
    ds_read_b128 v[40:43], v5 offset:47104
    v_mfma_f32_16x16x32_bf16 v[140:143], v[20:23], v[52:55], v[140:143]
    ds_read_b64_tr_b16 v[48:49], v9 offset:53248
    v_mfma_f32_16x16x32_bf16 v[144:147], v[24:27], v[52:55], v[144:147]
    ds_read_b64_tr_b16 v[50:51], v9 offset:53760
    s_waitcnt lgkmcnt(12)
    v_mfma_f32_16x16x32_bf16 v[148:151], v[12:15], v[56:59], v[148:151]
    ds_read_b64_tr_b16 v[52:53], v8 offset:61440
    v_mfma_f32_16x16x32_bf16 v[152:155], v[16:19], v[56:59], v[152:155]
    ds_read_b64_tr_b16 v[54:55], v8 offset:61952
    v_mfma_f32_16x16x32_bf16 v[156:159], v[20:23], v[56:59], v[156:159]
    v_mfma_f32_16x16x32_bf16 v[160:163], v[24:27], v[56:59], v[160:163]
    s_waitcnt lgkmcnt(12)
    v_mfma_f32_16x16x32_bf16 v[68:71], v[60:63], v[12:15], v[68:71]
    ds_read_b64_tr_b16 v[56:57], v9 offset:61440
    v_mfma_f32_16x16x32_bf16 v[72:75], v[60:63], v[16:19], v[72:75]
    ds_read_b64_tr_b16 v[58:59], v9 offset:61952
    v_mfma_f32_16x16x32_bf16 v[76:79], v[60:63], v[20:23], v[76:79]
    v_mfma_f32_16x16x32_bf16 v[80:83], v[60:63], v[24:27], v[80:83]
    s_waitcnt lgkmcnt(12)
    v_mfma_f32_16x16x32_bf16 v[84:87], v[64:67], v[12:15], v[84:87]
    ds_read_b64_tr_b16 v[60:61], v8 offset:45056
    v_mfma_f32_16x16x32_bf16 v[88:91], v[64:67], v[16:19], v[88:91]
    ds_read_b64_tr_b16 v[62:63], v8 offset:45568
    v_mfma_f32_16x16x32_bf16 v[92:95], v[64:67], v[20:23], v[92:95]
    v_mfma_f32_16x16x32_bf16 v[96:99], v[64:67], v[24:27], v[96:99]
    ds_read_b64_tr_b16 v[64:65], v9 offset:45056
    s_waitcnt lgkmcnt(8)
    ds_read_b64_tr_b16 v[66:67], v9 offset:45568
    s_waitcnt lgkmcnt(13)
    v_mfma_f32_16x16x32_bf16 v[100:103], v[28:31], v[44:47], v[100:103]
    s_waitcnt lgkmcnt(12)
    v_mfma_f32_16x16x32_bf16 v[104:107], v[32:35], v[44:47], v[104:107]
    s_waitcnt lgkmcnt(11)
    v_mfma_f32_16x16x32_bf16 v[108:111], v[36:39], v[44:47], v[108:111]
    s_waitcnt lgkmcnt(10)
    v_mfma_f32_16x16x32_bf16 v[112:115], v[40:43], v[44:47], v[112:115]
    s_waitcnt lgkmcnt(0)
    s_waitcnt vmcnt(0)
    s_barrier
    v_mfma_f32_16x16x32_bf16 v[116:119], v[28:31], v[48:51], v[116:119]
    ds_read_b64_tr_b16 v[44:45], v10 offset:8192
    v_mfma_f32_16x16x32_bf16 v[120:123], v[32:35], v[48:51], v[120:123]
    ds_read_b64_tr_b16 v[46:47], v10 offset:8704
    v_mfma_f32_16x16x32_bf16 v[124:127], v[36:39], v[48:51], v[124:127]
    ds_read_b128 v[12:15], v6 offset:0
    v_mfma_f32_16x16x32_bf16 v[128:131], v[40:43], v[48:51], v[128:131]
    ds_read_b128 v[16:19], v6 offset:2048
    v_mfma_f32_16x16x32_bf16 v[132:135], v[28:31], v[52:55], v[132:135]
    ds_read_b128 v[20:23], v6 offset:4096
    v_mfma_f32_16x16x32_bf16 v[136:139], v[32:35], v[52:55], v[136:139]
    ds_read_b128 v[24:27], v6 offset:6144
    v_mfma_f32_16x16x32_bf16 v[140:143], v[36:39], v[52:55], v[140:143]
    ds_read_b64_tr_b16 v[48:49], v11 offset:8192
    v_mfma_f32_16x16x32_bf16 v[144:147], v[40:43], v[52:55], v[144:147]
    ds_read_b64_tr_b16 v[50:51], v11 offset:8704
    v_mfma_f32_16x16x32_bf16 v[148:151], v[28:31], v[56:59], v[148:151]
    ds_read_b64_tr_b16 v[52:53], v10 offset:16384
    v_mfma_f32_16x16x32_bf16 v[152:155], v[32:35], v[56:59], v[152:155]
    ds_read_b64_tr_b16 v[54:55], v10 offset:16896
    v_mfma_f32_16x16x32_bf16 v[156:159], v[36:39], v[56:59], v[156:159]
    v_mfma_f32_16x16x32_bf16 v[160:163], v[40:43], v[56:59], v[160:163]
    v_mfma_f32_16x16x32_bf16 v[68:71], v[60:63], v[28:31], v[68:71]
    ds_read_b64_tr_b16 v[56:57], v11 offset:16384
    v_mfma_f32_16x16x32_bf16 v[72:75], v[60:63], v[32:35], v[72:75]
    ds_read_b64_tr_b16 v[58:59], v11 offset:16896
    v_mfma_f32_16x16x32_bf16 v[76:79], v[60:63], v[36:39], v[76:79]
    v_mfma_f32_16x16x32_bf16 v[80:83], v[60:63], v[40:43], v[80:83]
    v_mfma_f32_16x16x32_bf16 v[84:87], v[64:67], v[28:31], v[84:87]
    ds_read_b64_tr_b16 v[60:61], v10 offset:0
    v_mfma_f32_16x16x32_bf16 v[88:91], v[64:67], v[32:35], v[88:91]
    ds_read_b64_tr_b16 v[62:63], v10 offset:512
    v_mfma_f32_16x16x32_bf16 v[92:95], v[64:67], v[36:39], v[92:95]
    v_mfma_f32_16x16x32_bf16 v[96:99], v[64:67], v[40:43], v[96:99]
    ds_read_b64_tr_b16 v[64:65], v11 offset:0
    s_waitcnt lgkmcnt(8)
    ds_read_b64_tr_b16 v[66:67], v11 offset:512
    v_swap_b32 v4, v6
    v_swap_b32 v5, v7
    v_swap_b32 v8, v10
    v_swap_b32 v9, v11
    s_mov_b32 s81, 5
F_p1:
    s_waitcnt lgkmcnt(13)
    v_mfma_f32_16x16x32_bf16 v[100:103], v[12:15], v[44:47], v[100:103]
    s_waitcnt lgkmcnt(12)
    v_mfma_f32_16x16x32_bf16 v[104:107], v[16:19], v[44:47], v[104:107]
    s_waitcnt lgkmcnt(11)
    v_mfma_f32_16x16x32_bf16 v[108:111], v[20:23], v[44:47], v[108:111]
    s_waitcnt lgkmcnt(10)
    v_mfma_f32_16x16x32_bf16 v[112:115], v[24:27], v[44:47], v[112:115]
    s_waitcnt lgkmcnt(8)
    v_mfma_f32_16x16x32_bf16 v[116:119], v[12:15], v[48:51], v[116:119]
    ds_read_b64_tr_b16 v[44:45], v8 offset:12288
    v_mfma_f32_16x16x32_bf16 v[120:123], v[16:19], v[48:51], v[120:123]
    ds_read_b64_tr_b16 v[46:47], v8 offset:12800
    v_mfma_f32_16x16x32_bf16 v[124:127], v[20:23], v[48:51], v[124:127]
    ds_read_b128 v[28:31], v5 offset:0
    v_mfma_f32_16x16x32_bf16 v[128:131], v[24:27], v[48:51], v[128:131]
    ds_read_b128 v[32:35], v5 offset:2048
    s_waitcnt lgkmcnt(10)
    v_mfma_f32_16x16x32_bf16 v[132:135], v[12:15], v[52:55], v[132:135]
    ds_read_b128 v[36:39], v5 offset:4096
    v_mfma_f32_16x16x32_bf16 v[136:139], v[16:19], v[52:55], v[136:139]
    ds_read_b128 v[40:43], v5 offset:6144
    v_mfma_f32_16x16x32_bf16 v[140:143], v[20:23], v[52:55], v[140:143]
    ds_read_b64_tr_b16 v[48:49], v9 offset:12288
    v_mfma_f32_16x16x32_bf16 v[144:147], v[24:27], v[52:55], v[144:147]
    ds_read_b64_tr_b16 v[50:51], v9 offset:12800
    s_waitcnt lgkmcnt(12)
    v_mfma_f32_16x16x32_bf16 v[148:151], v[12:15], v[56:59], v[148:151]
    ds_read_b64_tr_b16 v[52:53], v8 offset:20480
    v_mfma_f32_16x16x32_bf16 v[152:155], v[16:19], v[56:59], v[152:155]
    ds_read_b64_tr_b16 v[54:55], v8 offset:20992
    v_mfma_f32_16x16x32_bf16 v[156:159], v[20:23], v[56:59], v[156:159]
    v_mfma_f32_16x16x32_bf16 v[160:163], v[24:27], v[56:59], v[160:163]
    s_waitcnt lgkmcnt(12)
    v_mfma_f32_16x16x32_bf16 v[68:71], v[60:63], v[12:15], v[68:71]
    ds_read_b64_tr_b16 v[56:57], v9 offset:20480
    v_mfma_f32_16x16x32_bf16 v[72:75], v[60:63], v[16:19], v[72:75]
    ds_read_b64_tr_b16 v[58:59], v9 offset:20992
    v_mfma_f32_16x16x32_bf16 v[76:79], v[60:63], v[20:23], v[76:79]
    v_mfma_f32_16x16x32_bf16 v[80:83], v[60:63], v[24:27], v[80:83]
    s_waitcnt lgkmcnt(12)
    v_mfma_f32_16x16x32_bf16 v[84:87], v[64:67], v[12:15], v[84:87]
    ds_read_b64_tr_b16 v[60:61], v8 offset:4096
    v_mfma_f32_16x16x32_bf16 v[88:91], v[64:67], v[16:19], v[88:91]
    ds_read_b64_tr_b16 v[62:63], v8 offset:4608
    v_mfma_f32_16x16x32_bf16 v[92:95], v[64:67], v[20:23], v[92:95]
    v_mfma_f32_16x16x32_bf16 v[96:99], v[64:67], v[24:27], v[96:99]
    ds_read_b64_tr_b16 v[64:65], v9 offset:4096
    s_waitcnt lgkmcnt(8)
    ds_read_b64_tr_b16 v[66:67], v9 offset:4608
    s_waitcnt lgkmcnt(13)
    v_mfma_f32_16x16x32_bf16 v[100:103], v[28:31], v[44:47], v[100:103]
    s_waitcnt lgkmcnt(12)
    v_mfma_f32_16x16x32_bf16 v[104:107], v[32:35], v[44:47], v[104:107]
    s_waitcnt lgkmcnt(11)
    v_mfma_f32_16x16x32_bf16 v[108:111], v[36:39], v[44:47], v[108:111]
    s_waitcnt lgkmcnt(10)
    v_mfma_f32_16x16x32_bf16 v[112:115], v[40:43], v[44:47], v[112:115]
    s_waitcnt lgkmcnt(0)
    s_barrier
    v_mfma_f32_16x16x32_bf16 v[116:119], v[28:31], v[48:51], v[116:119]
    ds_read_b64_tr_b16 v[44:45], v8 offset:49152
    v_mfma_f32_16x16x32_bf16 v[120:123], v[32:35], v[48:51], v[120:123]
    ds_read_b64_tr_b16 v[46:47], v8 offset:49664
    v_mfma_f32_16x16x32_bf16 v[124:127], v[36:39], v[48:51], v[124:127]
    ds_read_b128 v[12:15], v4 offset:40960
    v_mfma_f32_16x16x32_bf16 v[128:131], v[40:43], v[48:51], v[128:131]
    ds_read_b128 v[16:19], v4 offset:43008
    v_mfma_f32_16x16x32_bf16 v[132:135], v[28:31], v[52:55], v[132:135]
    ds_read_b128 v[20:23], v4 offset:45056
    v_mfma_f32_16x16x32_bf16 v[136:139], v[32:35], v[52:55], v[136:139]
    ds_read_b128 v[24:27], v4 offset:47104
    v_mfma_f32_16x16x32_bf16 v[140:143], v[36:39], v[52:55], v[140:143]
    ds_read_b64_tr_b16 v[48:49], v9 offset:49152
    v_mfma_f32_16x16x32_bf16 v[144:147], v[40:43], v[52:55], v[144:147]
    ds_read_b64_tr_b16 v[50:51], v9 offset:49664
    v_mfma_f32_16x16x32_bf16 v[148:151], v[28:31], v[56:59], v[148:151]
    ds_read_b64_tr_b16 v[52:53], v8 offset:57344
    v_mfma_f32_16x16x32_bf16 v[152:155], v[32:35], v[56:59], v[152:155]
    ds_read_b64_tr_b16 v[54:55], v8 offset:57856
    v_mfma_f32_16x16x32_bf16 v[156:159], v[36:39], v[56:59], v[156:159]
    v_mfma_f32_16x16x32_bf16 v[160:163], v[40:43], v[56:59], v[160:163]
    v_mfma_f32_16x16x32_bf16 v[68:71], v[60:63], v[28:31], v[68:71]
    ds_read_b64_tr_b16 v[56:57], v9 offset:57344
    v_mfma_f32_16x16x32_bf16 v[72:75], v[60:63], v[32:35], v[72:75]
    ds_read_b64_tr_b16 v[58:59], v9 offset:57856
    v_mfma_f32_16x16x32_bf16 v[76:79], v[60:63], v[36:39], v[76:79]
    v_mfma_f32_16x16x32_bf16 v[80:83], v[60:63], v[40:43], v[80:83]
    v_mfma_f32_16x16x32_bf16 v[84:87], v[64:67], v[28:31], v[84:87]
    ds_read_b64_tr_b16 v[60:61], v8 offset:40960
    v_mfma_f32_16x16x32_bf16 v[88:91], v[64:67], v[32:35], v[88:91]
    ds_read_b64_tr_b16 v[62:63], v8 offset:41472
    v_mfma_f32_16x16x32_bf16 v[92:95], v[64:67], v[36:39], v[92:95]
    v_mfma_f32_16x16x32_bf16 v[96:99], v[64:67], v[40:43], v[96:99]
    ds_read_b64_tr_b16 v[64:65], v9 offset:40960
    s_waitcnt lgkmcnt(8)
    ds_read_b64_tr_b16 v[66:67], v9 offset:41472
    s_waitcnt lgkmcnt(13)
    v_mfma_f32_16x16x32_bf16 v[100:103], v[12:15], v[44:47], v[100:103]
    s_waitcnt lgkmcnt(12)
    v_mfma_f32_16x16x32_bf16 v[104:107], v[16:19], v[44:47], v[104:107]
    s_waitcnt lgkmcnt(11)
    v_mfma_f32_16x16x32_bf16 v[108:111], v[20:23], v[44:47], v[108:111]
    s_waitcnt lgkmcnt(10)
    v_mfma_f32_16x16x32_bf16 v[112:115], v[24:27], v[44:47], v[112:115]
    s_waitcnt lgkmcnt(8)
    v_mfma_f32_16x16x32_bf16 v[116:119], v[12:15], v[48:51], v[116:119]
    ds_read_b64_tr_b16 v[44:45], v8 offset:53248
    v_mfma_f32_16x16x32_bf16 v[120:123], v[16:19], v[48:51], v[120:123]
    ds_read_b64_tr_b16 v[46:47], v8 offset:53760
    v_mfma_f32_16x16x32_bf16 v[124:127], v[20:23], v[48:51], v[124:127]
    ds_read_b128 v[28:31], v5 offset:40960
    v_mfma_f32_16x16x32_bf16 v[128:131], v[24:27], v[48:51], v[128:131]
    ds_read_b128 v[32:35], v5 offset:43008
    s_waitcnt lgkmcnt(10)
    v_mfma_f32_16x16x32_bf16 v[132:135], v[12:15], v[52:55], v[132:135]
    ds_read_b128 v[36:39], v5 offset:45056
    v_mfma_f32_16x16x32_bf16 v[136:139], v[16:19], v[52:55], v[136:139]
    ds_read_b128 v[40:43], v5 offset:47104
    v_mfma_f32_16x16x32_bf16 v[140:143], v[20:23], v[52:55], v[140:143]
    ds_read_b64_tr_b16 v[48:49], v9 offset:53248
    v_mfma_f32_16x16x32_bf16 v[144:147], v[24:27], v[52:55], v[144:147]
    ds_read_b64_tr_b16 v[50:51], v9 offset:53760
    s_waitcnt lgkmcnt(12)
    v_mfma_f32_16x16x32_bf16 v[148:151], v[12:15], v[56:59], v[148:151]
    ds_read_b64_tr_b16 v[52:53], v8 offset:61440
    v_mfma_f32_16x16x32_bf16 v[152:155], v[16:19], v[56:59], v[152:155]
    ds_read_b64_tr_b16 v[54:55], v8 offset:61952
    v_mfma_f32_16x16x32_bf16 v[156:159], v[20:23], v[56:59], v[156:159]
    v_mfma_f32_16x16x32_bf16 v[160:163], v[24:27], v[56:59], v[160:163]
    s_waitcnt lgkmcnt(12)
    v_mfma_f32_16x16x32_bf16 v[68:71], v[60:63], v[12:15], v[68:71]
    ds_read_b64_tr_b16 v[56:57], v9 offset:61440
    v_mfma_f32_16x16x32_bf16 v[72:75], v[60:63], v[16:19], v[72:75]
    ds_read_b64_tr_b16 v[58:59], v9 offset:61952
    v_mfma_f32_16x16x32_bf16 v[76:79], v[60:63], v[20:23], v[76:79]
    v_mfma_f32_16x16x32_bf16 v[80:83], v[60:63], v[24:27], v[80:83]
    s_waitcnt lgkmcnt(12)
    v_mfma_f32_16x16x32_bf16 v[84:87], v[64:67], v[12:15], v[84:87]
    ds_read_b64_tr_b16 v[60:61], v8 offset:45056
    v_mfma_f32_16x16x32_bf16 v[88:91], v[64:67], v[16:19], v[88:91]
    ds_read_b64_tr_b16 v[62:63], v8 offset:45568
    v_mfma_f32_16x16x32_bf16 v[92:95], v[64:67], v[20:23], v[92:95]
    v_mfma_f32_16x16x32_bf16 v[96:99], v[64:67], v[24:27], v[96:99]
    ds_read_b64_tr_b16 v[64:65], v9 offset:45056
    s_waitcnt lgkmcnt(8)
    ds_read_b64_tr_b16 v[66:67], v9 offset:45568
    s_waitcnt lgkmcnt(13)
    v_mfma_f32_16x16x32_bf16 v[100:103], v[28:31], v[44:47], v[100:103]
    s_waitcnt lgkmcnt(12)
    v_mfma_f32_16x16x32_bf16 v[104:107], v[32:35], v[44:47], v[104:107]
    s_waitcnt lgkmcnt(11)
    v_mfma_f32_16x16x32_bf16 v[108:111], v[36:39], v[44:47], v[108:111]
    s_waitcnt lgkmcnt(10)
    v_mfma_f32_16x16x32_bf16 v[112:115], v[40:43], v[44:47], v[112:115]
    s_waitcnt lgkmcnt(0)
    s_barrier
    v_mfma_f32_16x16x32_bf16 v[116:119], v[28:31], v[48:51], v[116:119]
    ds_read_b64_tr_b16 v[44:45], v10 offset:8192
    v_mfma_f32_16x16x32_bf16 v[120:123], v[32:35], v[48:51], v[120:123]
    ds_read_b64_tr_b16 v[46:47], v10 offset:8704
    v_mfma_f32_16x16x32_bf16 v[124:127], v[36:39], v[48:51], v[124:127]
    ds_read_b128 v[12:15], v6 offset:0
    v_mfma_f32_16x16x32_bf16 v[128:131], v[40:43], v[48:51], v[128:131]
    ds_read_b128 v[16:19], v6 offset:2048
    v_mfma_f32_16x16x32_bf16 v[132:135], v[28:31], v[52:55], v[132:135]
    ds_read_b128 v[20:23], v6 offset:4096
    v_mfma_f32_16x16x32_bf16 v[136:139], v[32:35], v[52:55], v[136:139]
    ds_read_b128 v[24:27], v6 offset:6144
    v_mfma_f32_16x16x32_bf16 v[140:143], v[36:39], v[52:55], v[140:143]
    ds_read_b64_tr_b16 v[48:49], v11 offset:8192
    v_mfma_f32_16x16x32_bf16 v[144:147], v[40:43], v[52:55], v[144:147]
    ds_read_b64_tr_b16 v[50:51], v11 offset:8704
    v_mfma_f32_16x16x32_bf16 v[148:151], v[28:31], v[56:59], v[148:151]
    ds_read_b64_tr_b16 v[52:53], v10 offset:16384
    v_mfma_f32_16x16x32_bf16 v[152:155], v[32:35], v[56:59], v[152:155]
    ds_read_b64_tr_b16 v[54:55], v10 offset:16896
    v_mfma_f32_16x16x32_bf16 v[156:159], v[36:39], v[56:59], v[156:159]
    v_mfma_f32_16x16x32_bf16 v[160:163], v[40:43], v[56:59], v[160:163]
    v_mfma_f32_16x16x32_bf16 v[68:71], v[60:63], v[28:31], v[68:71]
    ds_read_b64_tr_b16 v[56:57], v11 offset:16384
    v_mfma_f32_16x16x32_bf16 v[72:75], v[60:63], v[32:35], v[72:75]
    ds_read_b64_tr_b16 v[58:59], v11 offset:16896
    v_mfma_f32_16x16x32_bf16 v[76:79], v[60:63], v[36:39], v[76:79]
    v_mfma_f32_16x16x32_bf16 v[80:83], v[60:63], v[40:43], v[80:83]
    v_mfma_f32_16x16x32_bf16 v[84:87], v[64:67], v[28:31], v[84:87]
    ds_read_b64_tr_b16 v[60:61], v10 offset:0
    v_mfma_f32_16x16x32_bf16 v[88:91], v[64:67], v[32:35], v[88:91]
    ds_read_b64_tr_b16 v[62:63], v10 offset:512
    v_mfma_f32_16x16x32_bf16 v[92:95], v[64:67], v[36:39], v[92:95]
    v_mfma_f32_16x16x32_bf16 v[96:99], v[64:67], v[40:43], v[96:99]
    ds_read_b64_tr_b16 v[64:65], v11 offset:0
    s_waitcnt lgkmcnt(8)
    ds_read_b64_tr_b16 v[66:67], v11 offset:512
    v_swap_b32 v4, v6
    v_swap_b32 v5, v7
    v_swap_b32 v8, v10
    v_swap_b32 v9, v11
    s_sub_u32 s81, s81, 1
    s_cmp_lg_u32 s81, 0
    s_cbranch_scc1 F_p1
    s_waitcnt lgkmcnt(13)
    v_mfma_f32_16x16x32_bf16 v[100:103], v[12:15], v[44:47], v[100:103]
    s_waitcnt lgkmcnt(12)
    v_mfma_f32_16x16x32_bf16 v[104:107], v[16:19], v[44:47], v[104:107]
    s_waitcnt lgkmcnt(11)
    v_mfma_f32_16x16x32_bf16 v[108:111], v[20:23], v[44:47], v[108:111]
    s_waitcnt lgkmcnt(10)
    v_mfma_f32_16x16x32_bf16 v[112:115], v[24:27], v[44:47], v[112:115]
    s_waitcnt lgkmcnt(8)
    v_mfma_f32_16x16x32_bf16 v[116:119], v[12:15], v[48:51], v[116:119]
    ds_read_b64_tr_b16 v[44:45], v8 offset:12288
    v_mfma_f32_16x16x32_bf16 v[120:123], v[16:19], v[48:51], v[120:123]
    ds_read_b64_tr_b16 v[46:47], v8 offset:12800
    v_mfma_f32_16x16x32_bf16 v[124:127], v[20:23], v[48:51], v[124:127]
    ds_read_b128 v[28:31], v5 offset:0
    v_mfma_f32_16x16x32_bf16 v[128:131], v[24:27], v[48:51], v[128:131]
    ds_read_b128 v[32:35], v5 offset:2048
    s_waitcnt lgkmcnt(10)
    v_mfma_f32_16x16x32_bf16 v[132:135], v[12:15], v[52:55], v[132:135]
    ds_read_b128 v[36:39], v5 offset:4096
    v_mfma_f32_16x16x32_bf16 v[136:139], v[16:19], v[52:55], v[136:139]
    ds_read_b128 v[40:43], v5 offset:6144
    v_mfma_f32_16x16x32_bf16 v[140:143], v[20:23], v[52:55], v[140:143]
    ds_read_b64_tr_b16 v[48:49], v9 offset:12288
    v_mfma_f32_16x16x32_bf16 v[144:147], v[24:27], v[52:55], v[144:147]
    ds_read_b64_tr_b16 v[50:51], v9 offset:12800
    s_waitcnt lgkmcnt(12)
    v_mfma_f32_16x16x32_bf16 v[148:151], v[12:15], v[56:59], v[148:151]
    ds_read_b64_tr_b16 v[52:53], v8 offset:20480
    v_mfma_f32_16x16x32_bf16 v[152:155], v[16:19], v[56:59], v[152:155]
    ds_read_b64_tr_b16 v[54:55], v8 offset:20992
    v_mfma_f32_16x16x32_bf16 v[156:159], v[20:23], v[56:59], v[156:159]
    v_mfma_f32_16x16x32_bf16 v[160:163], v[24:27], v[56:59], v[160:163]
    ds_read_b64_tr_b16 v[56:57], v9 offset:20480
    s_waitcnt lgkmcnt(8)
    ds_read_b64_tr_b16 v[58:59], v9 offset:20992
    s_waitcnt lgkmcnt(9)
    v_mfma_f32_16x16x32_bf16 v[100:103], v[28:31], v[44:47], v[100:103]
    s_waitcnt lgkmcnt(8)
    v_mfma_f32_16x16x32_bf16 v[104:107], v[32:35], v[44:47], v[104:107]
    s_waitcnt lgkmcnt(7)
    v_mfma_f32_16x16x32_bf16 v[108:111], v[36:39], v[44:47], v[108:111]
    s_waitcnt lgkmcnt(6)
    v_mfma_f32_16x16x32_bf16 v[112:115], v[40:43], v[44:47], v[112:115]
    s_waitcnt lgkmcnt(0)
    s_barrier
    v_mfma_f32_16x16x32_bf16 v[116:119], v[28:31], v[48:51], v[116:119]
    ds_read_b64_tr_b16 v[44:45], v8 offset:49152
    v_mfma_f32_16x16x32_bf16 v[120:123], v[32:35], v[48:51], v[120:123]
    ds_read_b64_tr_b16 v[46:47], v8 offset:49664
    v_mfma_f32_16x16x32_bf16 v[124:127], v[36:39], v[48:51], v[124:127]
    ds_read_b128 v[12:15], v4 offset:40960
    v_mfma_f32_16x16x32_bf16 v[128:131], v[40:43], v[48:51], v[128:131]
    ds_read_b128 v[16:19], v4 offset:43008
    v_mfma_f32_16x16x32_bf16 v[132:135], v[28:31], v[52:55], v[132:135]
    ds_read_b128 v[20:23], v4 offset:45056
    v_mfma_f32_16x16x32_bf16 v[136:139], v[32:35], v[52:55], v[136:139]
    ds_read_b128 v[24:27], v4 offset:47104
    v_mfma_f32_16x16x32_bf16 v[140:143], v[36:39], v[52:55], v[140:143]
    ds_read_b64_tr_b16 v[48:49], v9 offset:49152
    v_mfma_f32_16x16x32_bf16 v[144:147], v[40:43], v[52:55], v[144:147]
    ds_read_b64_tr_b16 v[50:51], v9 offset:49664
    v_mfma_f32_16x16x32_bf16 v[148:151], v[28:31], v[56:59], v[148:151]
    ds_read_b64_tr_b16 v[52:53], v8 offset:57344
    v_mfma_f32_16x16x32_bf16 v[152:155], v[32:35], v[56:59], v[152:155]
    ds_read_b64_tr_b16 v[54:55], v8 offset:57856
    v_mfma_f32_16x16x32_bf16 v[156:159], v[36:39], v[56:59], v[156:159]
    v_mfma_f32_16x16x32_bf16 v[160:163], v[40:43], v[56:59], v[160:163]
    ds_read_b64_tr_b16 v[56:57], v9 offset:57344
    ds_read_b64_tr_b16 v[58:59], v9 offset:57856
    s_waitcnt lgkmcnt(9)
    v_mfma_f32_16x16x32_bf16 v[100:103], v[12:15], v[44:47], v[100:103]
    s_waitcnt lgkmcnt(8)
    v_mfma_f32_16x16x32_bf16 v[104:107], v[16:19], v[44:47], v[104:107]
    s_waitcnt lgkmcnt(7)
    v_mfma_f32_16x16x32_bf16 v[108:111], v[20:23], v[44:47], v[108:111]
    s_waitcnt lgkmcnt(6)
    v_mfma_f32_16x16x32_bf16 v[112:115], v[24:27], v[44:47], v[112:115]
    s_waitcnt lgkmcnt(4)
    v_mfma_f32_16x16x32_bf16 v[116:119], v[12:15], v[48:51], v[116:119]
    ds_read_b64_tr_b16 v[44:45], v8 offset:53248
    v_mfma_f32_16x16x32_bf16 v[120:123], v[16:19], v[48:51], v[120:123]
    ds_read_b64_tr_b16 v[46:47], v8 offset:53760
    v_mfma_f32_16x16x32_bf16 v[124:127], v[20:23], v[48:51], v[124:127]
    ds_read_b128 v[28:31], v5 offset:40960
    v_mfma_f32_16x16x32_bf16 v[128:131], v[24:27], v[48:51], v[128:131]
    ds_read_b128 v[32:35], v5 offset:43008
    s_waitcnt lgkmcnt(6)
    v_mfma_f32_16x16x32_bf16 v[132:135], v[12:15], v[52:55], v[132:135]
    ds_read_b128 v[36:39], v5 offset:45056
    v_mfma_f32_16x16x32_bf16 v[136:139], v[16:19], v[52:55], v[136:139]
    ds_read_b128 v[40:43], v5 offset:47104
    v_mfma_f32_16x16x32_bf16 v[140:143], v[20:23], v[52:55], v[140:143]
    ds_read_b64_tr_b16 v[48:49], v9 offset:53248
    v_mfma_f32_16x16x32_bf16 v[144:147], v[24:27], v[52:55], v[144:147]
    ds_read_b64_tr_b16 v[50:51], v9 offset:53760
    s_waitcnt lgkmcnt(8)
    v_mfma_f32_16x16x32_bf16 v[148:151], v[12:15], v[56:59], v[148:151]
    ds_read_b64_tr_b16 v[52:53], v8 offset:61440
    v_mfma_f32_16x16x32_bf16 v[152:155], v[16:19], v[56:59], v[152:155]
    ds_read_b64_tr_b16 v[54:55], v8 offset:61952
    v_mfma_f32_16x16x32_bf16 v[156:159], v[20:23], v[56:59], v[156:159]
    v_mfma_f32_16x16x32_bf16 v[160:163], v[24:27], v[56:59], v[160:163]
    ds_read_b64_tr_b16 v[56:57], v9 offset:61440
    ds_read_b64_tr_b16 v[58:59], v9 offset:61952
    s_waitcnt lgkmcnt(9)
    v_mfma_f32_16x16x32_bf16 v[100:103], v[28:31], v[44:47], v[100:103]
    s_waitcnt lgkmcnt(8)
    v_mfma_f32_16x16x32_bf16 v[104:107], v[32:35], v[44:47], v[104:107]
    s_waitcnt lgkmcnt(7)
    v_mfma_f32_16x16x32_bf16 v[108:111], v[36:39], v[44:47], v[108:111]
    s_waitcnt lgkmcnt(6)
    v_mfma_f32_16x16x32_bf16 v[112:115], v[40:43], v[44:47], v[112:115]
    s_waitcnt lgkmcnt(0)
    s_barrier
    v_mfma_f32_16x16x32_bf16 v[116:119], v[28:31], v[48:51], v[116:119]
    ds_read_b64_tr_b16 v[44:45], v10 offset:8192
    v_mfma_f32_16x16x32_bf16 v[120:123], v[32:35], v[48:51], v[120:123]
    ds_read_b64_tr_b16 v[46:47], v10 offset:8704
    v_mfma_f32_16x16x32_bf16 v[124:127], v[36:39], v[48:51], v[124:127]
    ds_read_b128 v[12:15], v6 offset:0
    v_mfma_f32_16x16x32_bf16 v[128:131], v[40:43], v[48:51], v[128:131]
    ds_read_b128 v[16:19], v6 offset:2048
    v_mfma_f32_16x16x32_bf16 v[132:135], v[28:31], v[52:55], v[132:135]
    ds_read_b128 v[20:23], v6 offset:4096
    v_mfma_f32_16x16x32_bf16 v[136:139], v[32:35], v[52:55], v[136:139]
    ds_read_b128 v[24:27], v6 offset:6144
    v_mfma_f32_16x16x32_bf16 v[140:143], v[36:39], v[52:55], v[140:143]
    ds_read_b64_tr_b16 v[48:49], v11 offset:8192
    v_mfma_f32_16x16x32_bf16 v[144:147], v[40:43], v[52:55], v[144:147]
    ds_read_b64_tr_b16 v[50:51], v11 offset:8704
    v_mfma_f32_16x16x32_bf16 v[148:151], v[28:31], v[56:59], v[148:151]
    ds_read_b64_tr_b16 v[52:53], v10 offset:16384
    v_mfma_f32_16x16x32_bf16 v[152:155], v[32:35], v[56:59], v[152:155]
    ds_read_b64_tr_b16 v[54:55], v10 offset:16896
    v_mfma_f32_16x16x32_bf16 v[156:159], v[36:39], v[56:59], v[156:159]
    v_mfma_f32_16x16x32_bf16 v[160:163], v[40:43], v[56:59], v[160:163]
    ds_read_b64_tr_b16 v[56:57], v11 offset:16384
    ds_read_b64_tr_b16 v[58:59], v11 offset:16896
    s_waitcnt lgkmcnt(9)
    v_mfma_f32_16x16x32_bf16 v[100:103], v[12:15], v[44:47], v[100:103]
    s_waitcnt lgkmcnt(8)
    v_mfma_f32_16x16x32_bf16 v[104:107], v[16:19], v[44:47], v[104:107]
    s_waitcnt lgkmcnt(7)
    v_mfma_f32_16x16x32_bf16 v[108:111], v[20:23], v[44:47], v[108:111]
    s_waitcnt lgkmcnt(6)
    v_mfma_f32_16x16x32_bf16 v[112:115], v[24:27], v[44:47], v[112:115]
    s_waitcnt lgkmcnt(4)
    v_mfma_f32_16x16x32_bf16 v[116:119], v[12:15], v[48:51], v[116:119]
    ds_read_b64_tr_b16 v[44:45], v10 offset:12288
    v_mfma_f32_16x16x32_bf16 v[120:123], v[16:19], v[48:51], v[120:123]
    ds_read_b64_tr_b16 v[46:47], v10 offset:12800
    v_mfma_f32_16x16x32_bf16 v[124:127], v[20:23], v[48:51], v[124:127]
    ds_read_b128 v[28:31], v7 offset:0
    v_mfma_f32_16x16x32_bf16 v[128:131], v[24:27], v[48:51], v[128:131]
    ds_read_b128 v[32:35], v7 offset:2048
    s_waitcnt lgkmcnt(6)
    v_mfma_f32_16x16x32_bf16 v[132:135], v[12:15], v[52:55], v[132:135]
    ds_read_b128 v[36:39], v7 offset:4096
    v_mfma_f32_16x16x32_bf16 v[136:139], v[16:19], v[52:55], v[136:139]
    ds_read_b128 v[40:43], v7 offset:6144
    v_mfma_f32_16x16x32_bf16 v[140:143], v[20:23], v[52:55], v[140:143]
    ds_read_b64_tr_b16 v[48:49], v11 offset:12288
    v_mfma_f32_16x16x32_bf16 v[144:147], v[24:27], v[52:55], v[144:147]
    ds_read_b64_tr_b16 v[50:51], v11 offset:12800
    s_waitcnt lgkmcnt(8)
    v_mfma_f32_16x16x32_bf16 v[148:151], v[12:15], v[56:59], v[148:151]
    ds_read_b64_tr_b16 v[52:53], v10 offset:20480
    v_mfma_f32_16x16x32_bf16 v[152:155], v[16:19], v[56:59], v[152:155]
    ds_read_b64_tr_b16 v[54:55], v10 offset:20992
    v_mfma_f32_16x16x32_bf16 v[156:159], v[20:23], v[56:59], v[156:159]
    v_mfma_f32_16x16x32_bf16 v[160:163], v[24:27], v[56:59], v[160:163]
    ds_read_b64_tr_b16 v[56:57], v11 offset:20480
    ds_read_b64_tr_b16 v[58:59], v11 offset:20992
    s_waitcnt lgkmcnt(9)
    v_mfma_f32_16x16x32_bf16 v[100:103], v[28:31], v[44:47], v[100:103]
    s_waitcnt lgkmcnt(8)
    v_mfma_f32_16x16x32_bf16 v[104:107], v[32:35], v[44:47], v[104:107]
    s_waitcnt lgkmcnt(7)
    v_mfma_f32_16x16x32_bf16 v[108:111], v[36:39], v[44:47], v[108:111]
    s_waitcnt lgkmcnt(6)
    v_mfma_f32_16x16x32_bf16 v[112:115], v[40:43], v[44:47], v[112:115]
    s_waitcnt lgkmcnt(0)
    s_barrier
    v_mfma_f32_16x16x32_bf16 v[116:119], v[28:31], v[48:51], v[116:119]
    ds_read_b64_tr_b16 v[44:45], v10 offset:49152
    v_mfma_f32_16x16x32_bf16 v[120:123], v[32:35], v[48:51], v[120:123]
    ds_read_b64_tr_b16 v[46:47], v10 offset:49664
    v_mfma_f32_16x16x32_bf16 v[124:127], v[36:39], v[48:51], v[124:127]
    ds_read_b128 v[12:15], v6 offset:40960
    v_mfma_f32_16x16x32_bf16 v[128:131], v[40:43], v[48:51], v[128:131]
    ds_read_b128 v[16:19], v6 offset:43008
    v_mfma_f32_16x16x32_bf16 v[132:135], v[28:31], v[52:55], v[132:135]
    ds_read_b128 v[20:23], v6 offset:45056
    v_mfma_f32_16x16x32_bf16 v[136:139], v[32:35], v[52:55], v[136:139]
    ds_read_b128 v[24:27], v6 offset:47104
    v_mfma_f32_16x16x32_bf16 v[140:143], v[36:39], v[52:55], v[140:143]
    ds_read_b64_tr_b16 v[48:49], v11 offset:49152
    v_mfma_f32_16x16x32_bf16 v[144:147], v[40:43], v[52:55], v[144:147]
    ds_read_b64_tr_b16 v[50:51], v11 offset:49664
    v_mfma_f32_16x16x32_bf16 v[148:151], v[28:31], v[56:59], v[148:151]
    ds_read_b64_tr_b16 v[52:53], v10 offset:57344
    v_mfma_f32_16x16x32_bf16 v[152:155], v[32:35], v[56:59], v[152:155]
    ds_read_b64_tr_b16 v[54:55], v10 offset:57856
    v_mfma_f32_16x16x32_bf16 v[156:159], v[36:39], v[56:59], v[156:159]
    v_mfma_f32_16x16x32_bf16 v[160:163], v[40:43], v[56:59], v[160:163]
    ds_read_b64_tr_b16 v[56:57], v11 offset:57344
    ds_read_b64_tr_b16 v[58:59], v11 offset:57856
    s_waitcnt lgkmcnt(9)
    v_mfma_f32_16x16x32_bf16 v[100:103], v[12:15], v[44:47], v[100:103]
    s_waitcnt lgkmcnt(8)
    v_mfma_f32_16x16x32_bf16 v[104:107], v[16:19], v[44:47], v[104:107]
    s_waitcnt lgkmcnt(7)
    v_mfma_f32_16x16x32_bf16 v[108:111], v[20:23], v[44:47], v[108:111]
    s_waitcnt lgkmcnt(6)
    v_mfma_f32_16x16x32_bf16 v[112:115], v[24:27], v[44:47], v[112:115]
    s_waitcnt lgkmcnt(4)
    v_mfma_f32_16x16x32_bf16 v[116:119], v[12:15], v[48:51], v[116:119]
    ds_read_b64_tr_b16 v[44:45], v10 offset:53248
    v_mfma_f32_16x16x32_bf16 v[120:123], v[16:19], v[48:51], v[120:123]
    ds_read_b64_tr_b16 v[46:47], v10 offset:53760
    v_mfma_f32_16x16x32_bf16 v[124:127], v[20:23], v[48:51], v[124:127]
    ds_read_b128 v[28:31], v7 offset:40960
    v_mfma_f32_16x16x32_bf16 v[128:131], v[24:27], v[48:51], v[128:131]
    ds_read_b128 v[32:35], v7 offset:43008
    s_waitcnt lgkmcnt(6)
    v_mfma_f32_16x16x32_bf16 v[132:135], v[12:15], v[52:55], v[132:135]
    ds_read_b128 v[36:39], v7 offset:45056
    v_mfma_f32_16x16x32_bf16 v[136:139], v[16:19], v[52:55], v[136:139]
    ds_read_b128 v[40:43], v7 offset:47104
    v_mfma_f32_16x16x32_bf16 v[140:143], v[20:23], v[52:55], v[140:143]
    ds_read_b64_tr_b16 v[48:49], v11 offset:53248
    v_mfma_f32_16x16x32_bf16 v[144:147], v[24:27], v[52:55], v[144:147]
    ds_read_b64_tr_b16 v[50:51], v11 offset:53760
    s_waitcnt lgkmcnt(8)
    v_mfma_f32_16x16x32_bf16 v[148:151], v[12:15], v[56:59], v[148:151]
    ds_read_b64_tr_b16 v[52:53], v10 offset:61440
    v_mfma_f32_16x16x32_bf16 v[152:155], v[16:19], v[56:59], v[152:155]
    ds_read_b64_tr_b16 v[54:55], v10 offset:61952
    v_mfma_f32_16x16x32_bf16 v[156:159], v[20:23], v[56:59], v[156:159]
    v_mfma_f32_16x16x32_bf16 v[160:163], v[24:27], v[56:59], v[160:163]
    ds_read_b64_tr_b16 v[56:57], v11 offset:61440
    ds_read_b64_tr_b16 v[58:59], v11 offset:61952
    s_waitcnt lgkmcnt(9)
    v_mfma_f32_16x16x32_bf16 v[100:103], v[28:31], v[44:47], v[100:103]
    ds_read_b128 v[12:15], v164 offset:0
    s_waitcnt lgkmcnt(9)
    v_mfma_f32_16x16x32_bf16 v[104:107], v[32:35], v[44:47], v[104:107]
    ds_read_b128 v[16:19], v164 offset:64
    s_waitcnt lgkmcnt(9)
    v_mfma_f32_16x16x32_bf16 v[108:111], v[36:39], v[44:47], v[108:111]
    ds_read_b128 v[20:23], v164 offset:512
    s_waitcnt lgkmcnt(9)
    v_mfma_f32_16x16x32_bf16 v[112:115], v[40:43], v[44:47], v[112:115]
    ds_read_b128 v[24:27], v164 offset:576
    s_waitcnt lgkmcnt(8)
    v_mfma_f32_16x16x32_bf16 v[116:119], v[28:31], v[48:51], v[116:119]
    ds_read_b128 v[60:63], v164 offset:1024
    v_mfma_f32_16x16x32_bf16 v[120:123], v[32:35], v[48:51], v[120:123]
    ds_read_b128 v[64:67], v164 offset:1088
    v_mfma_f32_16x16x32_bf16 v[124:127], v[36:39], v[48:51], v[124:127]
    ds_read2_b32 v[44:45], v165 offset0:64 offset1:64
    v_mfma_f32_16x16x32_bf16 v[128:131], v[40:43], v[48:51], v[128:131]
    ds_read2_b32 v[46:47], v165 offset0:80 offset1:80
    s_waitcnt lgkmcnt(10)
    v_mfma_f32_16x16x32_bf16 v[132:135], v[28:31], v[52:55], v[132:135]
    ds_read2_b32 v[48:49], v165 offset0:128 offset1:128
    v_mfma_f32_16x16x32_bf16 v[136:139], v[32:35], v[52:55], v[136:139]
    ds_read2_b32 v[50:51], v165 offset0:144 offset1:144
    v_mfma_f32_16x16x32_bf16 v[140:143], v[36:39], v[52:55], v[140:143]
    v_mfma_f32_16x16x32_bf16 v[144:147], v[40:43], v[52:55], v[144:147]
    s_waitcnt lgkmcnt(10)
    v_mfma_f32_16x16x32_bf16 v[148:151], v[28:31], v[56:59], v[148:151]
    v_mfma_f32_16x16x32_bf16 v[152:155], v[32:35], v[56:59], v[152:155]
    v_mfma_f32_16x16x32_bf16 v[156:159], v[36:39], v[56:59], v[156:159]
    v_mfma_f32_16x16x32_bf16 v[160:163], v[40:43], v[56:59], v[160:163]
    s_mov_b32 s50, 0x10001
    s_mov_b32 s51, s50
    ds_read_b128 v[36:39], v164 offset:128
    ds_read_b128 v[40:43], v164 offset:192
    ds_read_b128 v[52:55], v164 offset:640
    ds_read_b128 v[56:59], v164 offset:704
    s_waitcnt lgkmcnt(7)
    s_nop 0
    v_pk_fma_f32 v[100:101], v[12:13], v[44:45], v[100:101]
    v_pk_fma_f32 v[102:103], v[14:15], v[44:45], v[102:103]
    v_pk_fma_f32 v[104:105], v[16:17], v[44:45], v[104:105]
    v_pk_fma_f32 v[106:107], v[18:19], v[44:45], v[106:107]
    v_pk_mul_f32 v[28:29], v[100:101], v[60:61]
    v_pk_mul_f32 v[30:31], v[102:103], v[62:63]
    v_pk_mul_f32 v[32:33], v[104:105], v[64:65]
    v_pk_mul_f32 v[34:35], v[106:107], v[66:67]
    v_pk_fma_f32 v[100:101], v[100:101], v[20:21], s[40:41]
    v_pk_fma_f32 v[102:103], v[102:103], v[22:23], s[40:41]
    v_pk_fma_f32 v[104:105], v[104:105], v[24:25], s[40:41]
    v_pk_fma_f32 v[106:107], v[106:107], v[26:27], s[40:41]
    v_exp_f32 v28, v28 clamp
    v_exp_f32 v29, v29 clamp
    v_exp_f32 v30, v30 clamp
    v_exp_f32 v31, v31 clamp
    v_exp_f32 v32, v32 clamp
    v_exp_f32 v33, v33 clamp
    v_exp_f32 v34, v34 clamp
    v_exp_f32 v35, v35 clamp
    v_pk_add_f32 v[28:29], v[28:29], s[74:75]
    v_pk_add_f32 v[30:31], v[30:31], s[74:75]
    v_pk_add_f32 v[32:33], v[32:33], s[74:75]
    v_pk_add_f32 v[34:35], v[34:35], s[74:75]
    v_max_f32 v100, v100, v28
    v_max_f32 v101, v101, v29
    v_max_f32 v102, v102, v30
    v_max_f32 v103, v103, v31
    v_max_f32 v104, v104, v32
    v_max_f32 v105, v105, v33
    v_max_f32 v106, v106, v34
    v_max_f32 v107, v107, v35
    v_cvt_pk_bf16_f32 v100, v100, v101
    v_cvt_pk_bf16_f32 v101, v102, v103
    v_cvt_pk_bf16_f32 v102, v104, v105
    v_cvt_pk_bf16_f32 v103, v106, v107
    s_waitcnt lgkmcnt(3)
    v_pk_fma_f32 v[140:141], v[36:37], v[48:49], v[140:141]
    v_pk_fma_f32 v[142:143], v[38:39], v[48:49], v[142:143]
    s_waitcnt lgkmcnt(2)
    v_pk_fma_f32 v[144:145], v[40:41], v[48:49], v[144:145]
    v_pk_fma_f32 v[146:147], v[42:43], v[48:49], v[146:147]
    s_waitcnt lgkmcnt(1)
    v_pk_mul_f32 v[140:141], v[140:141], v[52:53]
    v_pk_mul_f32 v[142:143], v[142:143], v[54:55]
    s_waitcnt lgkmcnt(0)
    v_pk_mul_f32 v[144:145], v[144:145], v[56:57]
    v_pk_mul_f32 v[146:147], v[146:147], v[58:59]
    v_cvt_pk_bf16_f32 v140, v140, v141
    v_cvt_pk_bf16_f32 v141, v142, v143
    v_cvt_pk_bf16_f32 v142, v144, v145
    v_cvt_pk_bf16_f32 v143, v146, v147
    v_pk_fma_f32 v[156:157], v[36:37], v[50:51], v[156:157]
    v_pk_fma_f32 v[158:159], v[38:39], v[50:51], v[158:159]
    v_pk_fma_f32 v[160:161], v[40:41], v[50:51], v[160:161]
    v_pk_fma_f32 v[162:163], v[42:43], v[50:51], v[162:163]
    v_pk_mul_f32 v[156:157], v[156:157], v[52:53]
    v_pk_mul_f32 v[158:159], v[158:159], v[54:55]
    v_pk_mul_f32 v[160:161], v[160:161], v[56:57]
    v_pk_mul_f32 v[162:163], v[162:163], v[58:59]
    v_cvt_pk_bf16_f32 v156, v156, v157
    v_cvt_pk_bf16_f32 v157, v158, v159
    v_cvt_pk_bf16_f32 v158, v160, v161
    v_cvt_pk_bf16_f32 v159, v162, v163
    ds_read_b128 v[144:147], v164 offset:1152
    ds_read_b128 v[160:163], v164 offset:1216
    v_pk_fma_f32 v[132:133], v[12:13], v[48:49], v[132:133]
    v_pk_fma_f32 v[134:135], v[14:15], v[48:49], v[134:135]
    v_pk_fma_f32 v[136:137], v[16:17], v[48:49], v[136:137]
    v_pk_fma_f32 v[138:139], v[18:19], v[48:49], v[138:139]
    v_pk_mul_f32 v[132:133], v[132:133], v[20:21]
    v_pk_mul_f32 v[134:135], v[134:135], v[22:23]
    v_pk_mul_f32 v[136:137], v[136:137], v[24:25]
    v_pk_mul_f32 v[138:139], v[138:139], v[26:27]
    v_cvt_pk_bf16_f32 v132, v132, v133
    v_cvt_pk_bf16_f32 v133, v134, v135
    v_cvt_pk_bf16_f32 v134, v136, v137
    v_cvt_pk_bf16_f32 v135, v138, v139
    v_pk_fma_f32 v[148:149], v[12:13], v[50:51], v[148:149]
    v_pk_fma_f32 v[150:151], v[14:15], v[50:51], v[150:151]
    v_pk_fma_f32 v[152:153], v[16:17], v[50:51], v[152:153]
    v_pk_fma_f32 v[154:155], v[18:19], v[50:51], v[154:155]
    v_pk_mul_f32 v[148:149], v[148:149], v[20:21]
    v_pk_mul_f32 v[150:151], v[150:151], v[22:23]
    v_pk_mul_f32 v[152:153], v[152:153], v[24:25]
    v_pk_mul_f32 v[154:155], v[154:155], v[26:27]
    v_cvt_pk_bf16_f32 v148, v148, v149
    v_cvt_pk_bf16_f32 v149, v150, v151
    v_cvt_pk_bf16_f32 v150, v152, v153
    v_cvt_pk_bf16_f32 v151, v154, v155
    v_mov_b32 v48, 0x3f803f80
    v_mov_b32 v49, 0x3f803f80
    v_mov_b32 v50, 0x3f803f80
    v_mov_b32 v51, 0x3f803f80
    v_mov_b32 v164, 1
    v_mov_b32 v165, 2
    v_pk_fma_f32 v[108:109], v[36:37], v[44:45], v[108:109]
    v_pk_fma_f32 v[110:111], v[38:39], v[44:45], v[110:111]
    v_pk_fma_f32 v[112:113], v[40:41], v[44:45], v[112:113]
    v_pk_fma_f32 v[114:115], v[42:43], v[44:45], v[114:115]
    s_waitcnt lgkmcnt(1)
    v_pk_mul_f32 v[28:29], v[108:109], v[144:145]
    v_pk_mul_f32 v[30:31], v[110:111], v[146:147]
    s_waitcnt lgkmcnt(0)
    v_pk_mul_f32 v[32:33], v[112:113], v[160:161]
    v_pk_mul_f32 v[34:35], v[114:115], v[162:163]
    v_pk_fma_f32 v[108:109], v[108:109], v[52:53], s[40:41]
    v_pk_fma_f32 v[110:111], v[110:111], v[54:55], s[40:41]
    v_pk_fma_f32 v[112:113], v[112:113], v[56:57], s[40:41]
    v_pk_fma_f32 v[114:115], v[114:115], v[58:59], s[40:41]
    v_mfma_f32_16x16x32_bf16 v[136:139], v[100:103], v[132:135], 0
    v_exp_f32 v28, v28 clamp
    v_mfma_f32_16x16x32_bf16 v[152:155], v[100:103], v[148:151], 0
    v_exp_f32 v29, v29 clamp
    v_mfma_f32_16x16x32_bf16 v[104:107], v[100:103], v[48:51], 0
    v_exp_f32 v30, v30 clamp
    v_exp_f32 v31, v31 clamp
    v_exp_f32 v32, v32 clamp
    v_exp_f32 v33, v33 clamp
    v_exp_f32 v34, v34 clamp
    v_exp_f32 v35, v35 clamp
    v_pk_add_f32 v[28:29], v[28:29], s[74:75]
    v_pk_add_f32 v[30:31], v[30:31], s[74:75]
    v_pk_add_f32 v[32:33], v[32:33], s[74:75]
    v_pk_add_f32 v[34:35], v[34:35], s[74:75]
    v_max_f32 v108, v108, v28
    v_max_f32 v109, v109, v29
    v_max_f32 v110, v110, v30
    v_max_f32 v111, v111, v31
    v_max_f32 v112, v112, v32
    v_max_f32 v113, v113, v33
    v_max_f32 v114, v114, v34
    v_max_f32 v115, v115, v35
    v_cvt_pk_bf16_f32 v108, v108, v109
    v_cvt_pk_bf16_f32 v109, v110, v111
    v_cvt_pk_bf16_f32 v110, v112, v113
    v_cvt_pk_bf16_f32 v111, v114, v115
    v_pk_fma_f32 v[116:117], v[12:13], v[46:47], v[116:117]
    v_pk_fma_f32 v[118:119], v[14:15], v[46:47], v[118:119]
    v_pk_fma_f32 v[120:121], v[16:17], v[46:47], v[120:121]
    v_pk_fma_f32 v[122:123], v[18:19], v[46:47], v[122:123]
    v_pk_mul_f32 v[28:29], v[116:117], v[60:61]
    v_pk_mul_f32 v[30:31], v[118:119], v[62:63]
    v_pk_mul_f32 v[32:33], v[120:121], v[64:65]
    v_pk_mul_f32 v[34:35], v[122:123], v[66:67]
    v_pk_fma_f32 v[116:117], v[116:117], v[20:21], s[40:41]
    v_pk_fma_f32 v[118:119], v[118:119], v[22:23], s[40:41]
    v_pk_fma_f32 v[120:121], v[120:121], v[24:25], s[40:41]
    v_pk_fma_f32 v[122:123], v[122:123], v[26:27], s[40:41]
    v_mfma_f32_16x16x32_bf16 v[136:139], v[108:111], v[140:143], v[136:139]
    v_exp_f32 v28, v28 clamp
    v_mfma_f32_16x16x32_bf16 v[152:155], v[108:111], v[156:159], v[152:155]
    v_exp_f32 v29, v29 clamp
    v_mfma_f32_16x16x32_bf16 v[104:107], v[108:111], v[48:51], v[104:107]
    v_exp_f32 v30, v30 clamp
    v_exp_f32 v31, v31 clamp
    v_exp_f32 v32, v32 clamp
    v_exp_f32 v33, v33 clamp
    v_exp_f32 v34, v34 clamp
    v_exp_f32 v35, v35 clamp
    v_pk_add_f32 v[28:29], v[28:29], s[74:75]
    v_pk_add_f32 v[30:31], v[30:31], s[74:75]
    v_pk_add_f32 v[32:33], v[32:33], s[74:75]
    v_pk_add_f32 v[34:35], v[34:35], s[74:75]
    ds_write_b128 v1, v[136:139] offset:0
    ds_write_b128 v1, v[152:155] offset:1024
    s_mov_b64 exec, s[50:51]
    ds_write_b128 v2, v[104:107] offset:0
    s_mov_b64 exec, 1
    ds_write_b32 v3, v164
    s_mov_b64 exec, -1
    v_max_f32 v116, v116, v28
    v_max_f32 v117, v117, v29
    v_max_f32 v118, v118, v30
    v_max_f32 v119, v119, v31
    v_max_f32 v120, v120, v32
    v_max_f32 v121, v121, v33
    v_max_f32 v122, v122, v34
    v_max_f32_e64 v123, v123, v35
    v_cvt_pk_bf16_f32 v116, v116, v117
    v_cvt_pk_bf16_f32 v117, v118, v119
    v_cvt_pk_bf16_f32 v118, v120, v121
    v_cvt_pk_bf16_f32 v119, v122, v123
    v_pk_fma_f32 v[124:125], v[36:37], v[46:47], v[124:125]
    v_pk_fma_f32 v[126:127], v[38:39], v[46:47], v[126:127]
    v_pk_fma_f32 v[128:129], v[40:41], v[46:47], v[128:129]
    v_pk_fma_f32 v[130:131], v[42:43], v[46:47], v[130:131]
    v_pk_mul_f32 v[28:29], v[124:125], v[144:145]
    v_pk_mul_f32 v[30:31], v[126:127], v[146:147]
    v_pk_mul_f32 v[32:33], v[128:129], v[160:161]
    v_pk_mul_f32 v[34:35], v[130:131], v[162:163]
    v_pk_fma_f32 v[124:125], v[124:125], v[52:53], s[40:41]
    v_pk_fma_f32 v[126:127], v[126:127], v[54:55], s[40:41]
    v_pk_fma_f32 v[128:129], v[128:129], v[56:57], s[40:41]
    v_pk_fma_f32 v[130:131], v[130:131], v[58:59], s[40:41]
    v_mfma_f32_16x16x32_bf16 v[112:115], v[116:119], v[132:135], 0
    v_exp_f32 v28, v28 clamp
    v_mfma_f32_16x16x32_bf16 v[120:123], v[116:119], v[148:151], 0
    v_exp_f32 v29, v29 clamp
    v_mfma_f32_16x16x32_bf16 v[100:103], v[116:119], v[48:51], 0
    v_exp_f32 v30, v30 clamp
    v_exp_f32 v31, v31 clamp
    v_exp_f32 v32, v32 clamp
    v_exp_f32 v33, v33 clamp
    v_exp_f32 v34, v34 clamp
    v_exp_f32 v35, v35 clamp
    v_pk_add_f32 v[28:29], v[28:29], s[74:75]
    v_pk_add_f32 v[30:31], v[30:31], s[74:75]
    v_pk_add_f32 v[32:33], v[32:33], s[74:75]
    v_pk_add_f32 v[34:35], v[34:35], s[74:75]
    v_max_f32 v124, v124, v28
    v_max_f32 v125, v125, v29
    v_max_f32 v126, v126, v30
    v_max_f32 v127, v127, v31
    v_max_f32 v128, v128, v32
    v_max_f32 v129, v129, v33
    v_max_f32 v130, v130, v34
    v_max_f32 v131, v131, v35
    v_cvt_pk_bf16_f32 v124, v124, v125
    v_cvt_pk_bf16_f32 v125, v126, v127
    v_cvt_pk_bf16_f32 v126, v128, v129
    v_cvt_pk_bf16_f32 v127, v130, v131
    s_nop 1
    v_mfma_f32_16x16x32_bf16 v[112:115], v[124:127], v[140:143], v[112:115]
    v_mfma_f32_16x16x32_bf16 v[120:123], v[124:127], v[156:159], v[120:123]
    v_mfma_f32_16x16x32_bf16 v[100:103], v[124:127], v[48:51], v[100:103]
    ds_read_b128 v[28:31], v4 offset:0
    ds_read_b64_tr_b16 v[44:45], v8 offset:0
    ds_read_b64_tr_b16 v[46:47], v8 offset:512
    ds_read_b128 v[32:35], v4 offset:2048
    ds_read_b128 v[36:39], v4 offset:4096
    ds_read_b128 v[40:43], v4 offset:6144
    ds_write_b128 v1, v[112:115] offset:2048
    ds_write_b128 v1, v[120:123] offset:3072
    s_mov_b64 exec, s[50:51]
    ds_write_b128 v2, v[100:103] offset:64
    s_mov_b64 exec, 1
    ds_write_b32 v3, v165
    s_mov_b64 exec, -1
    ds_read_b64_tr_b16 v[48:49], v9 offset:0
    s_waitcnt lgkmcnt(8)
    ds_read_b64_tr_b16 v[50:51], v9 offset:512
    s_setprio 0
    v_and_b32 v132, 15, v0
    s_lshl_b32 s44, s36, 8
    s_add_u32 s44, s44, 24832
    v_lshl_add_u32 v132, v132, 2, s44
    v_add_u32 v133, 1024, v132
    s_lshl_b32 s44, s37, 7
    s_add_u32 s44, s44, 26368
    v_and_or_b32 v134, v0, 48, s44
    s_lshl_b32 s44, s35, 2
    s_and_b32 s47, s3, 2
    s_add_u32 s44, s44, s47
    s_lshr_b32 s44, 0xeee7eece, s44
    s_and_b32 s44, s44, 3
    s_mul_i32 s44, s44, 40960
    s_and_b32 s47, s28, 1
    s_lshl_b32 s47, s47, 13
    s_add_u32 s44, s44, s47
    s_lshl_b32 s47, s37, 6
    v_and_b32 v140, 0x30, v167
    v_xor_b32 v140, s47, v140
    v_and_b32 v141, 14, v0
    v_lshlrev_b32 v141, 3, v141
    v_xor_b32 v140, v140, v141
    v_and_b32 v141, 15, v0
    v_lshlrev_b32 v141, 7, v141
    v_add3_u32 v140, v140, v141, s44

    s_waitcnt lgkmcnt(9)
    v_mfma_f32_16x16x32_bf16 v[68:71], v[44:47], v[28:31], v[68:71]
    ds_read_b128 v[12:15], v5 offset:0
    ds_read_b64_tr_b16 v[52:53], v8 offset:4096
    s_waitcnt lgkmcnt(10)
    v_mfma_f32_16x16x32_bf16 v[72:75], v[44:47], v[32:35], v[72:75]
    ds_read_b64_tr_b16 v[54:55], v8 offset:4608
    ds_read_b128 v[16:19], v5 offset:2048
    s_waitcnt lgkmcnt(11)
    v_mfma_f32_16x16x32_bf16 v[76:79], v[44:47], v[36:39], v[76:79]
    ds_read_b128 v[20:23], v5 offset:4096
    ds_read_b128 v[24:27], v5 offset:6144
    s_waitcnt lgkmcnt(12)
    v_mfma_f32_16x16x32_bf16 v[80:83], v[44:47], v[40:43], v[80:83]
    ds_read_b64_tr_b16 v[56:57], v9 offset:4096
    ds_read_b64_tr_b16 v[58:59], v9 offset:4608
    s_waitcnt lgkmcnt(8)
    v_mfma_f32_16x16x32_bf16 v[84:87], v[48:51], v[28:31], v[84:87]
    v_mfma_f32_16x16x32_bf16 v[88:91], v[48:51], v[32:35], v[88:91]
    v_mfma_f32_16x16x32_bf16 v[92:95], v[48:51], v[36:39], v[92:95]
    v_mfma_f32_16x16x32_bf16 v[96:99], v[48:51], v[40:43], v[96:99]
    s_waitcnt lgkmcnt(5)
    v_mfma_f32_16x16x32_bf16 v[68:71], v[52:55], v[12:15], v[68:71]
    ds_read_b128 v[28:31], v4 offset:40960
    ds_read_b64_tr_b16 v[44:45], v8 offset:40960
    s_waitcnt lgkmcnt(6)
    v_mfma_f32_16x16x32_bf16 v[72:75], v[52:55], v[16:19], v[72:75]
    ds_read_b64_tr_b16 v[46:47], v8 offset:41472
    ds_read_b128 v[32:35], v4 offset:43008
    s_waitcnt lgkmcnt(7)
    v_mfma_f32_16x16x32_bf16 v[76:79], v[52:55], v[20:23], v[76:79]
    ds_read_b128 v[36:39], v4 offset:45056
    ds_read_b128 v[40:43], v4 offset:47104
    s_waitcnt lgkmcnt(8)
    v_mfma_f32_16x16x32_bf16 v[80:83], v[52:55], v[24:27], v[80:83]
    ds_read_b64_tr_b16 v[48:49], v9 offset:40960
    ds_read_b64_tr_b16 v[50:51], v9 offset:41472
    s_waitcnt lgkmcnt(8)
    v_mfma_f32_16x16x32_bf16 v[84:87], v[56:59], v[12:15], v[84:87]
    v_mfma_f32_16x16x32_bf16 v[88:91], v[56:59], v[16:19], v[88:91]
    v_mfma_f32_16x16x32_bf16 v[92:95], v[56:59], v[20:23], v[92:95]
    v_mfma_f32_16x16x32_bf16 v[96:99], v[56:59], v[24:27], v[96:99]
    s_waitcnt lgkmcnt(5)
    v_mfma_f32_16x16x32_bf16 v[68:71], v[44:47], v[28:31], v[68:71]
    ds_read_b128 v[12:15], v5 offset:40960
    ds_read_b64_tr_b16 v[52:53], v8 offset:45056
    s_waitcnt lgkmcnt(6)
    v_mfma_f32_16x16x32_bf16 v[72:75], v[44:47], v[32:35], v[72:75]
    ds_read_b64_tr_b16 v[54:55], v8 offset:45568
    ds_read_b128 v[16:19], v5 offset:43008
    s_waitcnt lgkmcnt(7)
    v_mfma_f32_16x16x32_bf16 v[76:79], v[44:47], v[36:39], v[76:79]
    ds_read_b128 v[20:23], v5 offset:45056
    ds_read_b128 v[24:27], v5 offset:47104
    s_waitcnt lgkmcnt(8)
    v_mfma_f32_16x16x32_bf16 v[80:83], v[44:47], v[40:43], v[80:83]
    ds_read_b64_tr_b16 v[56:57], v9 offset:45056
    ds_read_b64_tr_b16 v[58:59], v9 offset:45568
    s_waitcnt lgkmcnt(8)
    v_mfma_f32_16x16x32_bf16 v[84:87], v[48:51], v[28:31], v[84:87]
    ds_read_b128 v[148:151], v140 offset:0
    ds_read_b128 v[152:155], v140 offset:2048
    v_mfma_f32_16x16x32_bf16 v[88:91], v[48:51], v[32:35], v[88:91]
    ds_read_b128 v[156:159], v140 offset:4096
    ds_read_b128 v[160:163], v140 offset:6144
    v_mfma_f32_16x16x32_bf16 v[92:95], v[48:51], v[36:39], v[92:95]
    v_mfma_f32_16x16x32_bf16 v[96:99], v[48:51], v[40:43], v[96:99]
    s_waitcnt lgkmcnt(9)
    v_mfma_f32_16x16x32_bf16 v[68:71], v[52:55], v[12:15], v[68:71]
    ds_read_b128 v[28:31], v6 offset:0
    ds_read_b64_tr_b16 v[44:45], v10 offset:0
    s_waitcnt lgkmcnt(10)
    v_mfma_f32_16x16x32_bf16 v[72:75], v[52:55], v[16:19], v[72:75]
    ds_read_b64_tr_b16 v[46:47], v10 offset:512
    ds_read_b128 v[32:35], v6 offset:2048
    s_waitcnt lgkmcnt(11)
    v_mfma_f32_16x16x32_bf16 v[76:79], v[52:55], v[20:23], v[76:79]
    ds_read_b128 v[36:39], v6 offset:4096
    ds_read_b128 v[40:43], v6 offset:6144
    s_waitcnt lgkmcnt(12)
    v_mfma_f32_16x16x32_bf16 v[80:83], v[52:55], v[24:27], v[80:83]
    ds_read_b64_tr_b16 v[48:49], v11 offset:0
    ds_read_b64_tr_b16 v[50:51], v11 offset:512
    s_waitcnt lgkmcnt(12)
    v_mfma_f32_16x16x32_bf16 v[84:87], v[56:59], v[12:15], v[84:87]
    v_mfma_f32_16x16x32_bf16 v[88:91], v[56:59], v[16:19], v[88:91]
    v_mfma_f32_16x16x32_bf16 v[92:95], v[56:59], v[20:23], v[92:95]
    v_mfma_f32_16x16x32_bf16 v[96:99], v[56:59], v[24:27], v[96:99]
    s_waitcnt lgkmcnt(5)
    v_mfma_f32_16x16x32_bf16 v[68:71], v[44:47], v[28:31], v[68:71]
    ds_read_b128 v[12:15], v7 offset:0
    ds_read_b64_tr_b16 v[52:53], v10 offset:4096
    s_waitcnt lgkmcnt(6)
    v_mfma_f32_16x16x32_bf16 v[72:75], v[44:47], v[32:35], v[72:75]
    ds_read_b64_tr_b16 v[54:55], v10 offset:4608
    ds_read_b128 v[16:19], v7 offset:2048
    s_waitcnt lgkmcnt(7)
    v_mfma_f32_16x16x32_bf16 v[76:79], v[44:47], v[36:39], v[76:79]
    ds_read_b128 v[20:23], v7 offset:4096
    ds_read_b128 v[24:27], v7 offset:6144
    s_waitcnt lgkmcnt(8)
    v_mfma_f32_16x16x32_bf16 v[80:83], v[44:47], v[40:43], v[80:83]
    ds_read_b64_tr_b16 v[56:57], v11 offset:4096
    ds_read_b64_tr_b16 v[58:59], v11 offset:4608
    s_waitcnt lgkmcnt(8)
    v_mfma_f32_16x16x32_bf16 v[84:87], v[48:51], v[28:31], v[84:87]
    v_mfma_f32_16x16x32_bf16 v[88:91], v[48:51], v[32:35], v[88:91]
    v_mfma_f32_16x16x32_bf16 v[92:95], v[48:51], v[36:39], v[92:95]
    v_mfma_f32_16x16x32_bf16 v[96:99], v[48:51], v[40:43], v[96:99]
    s_waitcnt lgkmcnt(5)
    v_mfma_f32_16x16x32_bf16 v[68:71], v[52:55], v[12:15], v[68:71]
    ds_read_b128 v[28:31], v6 offset:40960
    ds_read_b64_tr_b16 v[44:45], v10 offset:40960
    s_waitcnt lgkmcnt(6)
    v_mfma_f32_16x16x32_bf16 v[72:75], v[52:55], v[16:19], v[72:75]
    ds_read_b64_tr_b16 v[46:47], v10 offset:41472
    ds_read_b128 v[32:35], v6 offset:43008
    s_waitcnt lgkmcnt(7)
    v_mfma_f32_16x16x32_bf16 v[76:79], v[52:55], v[20:23], v[76:79]
    ds_read_b128 v[36:39], v6 offset:45056
    ds_read_b128 v[40:43], v6 offset:47104
    s_waitcnt lgkmcnt(8)
    v_mfma_f32_16x16x32_bf16 v[80:83], v[52:55], v[24:27], v[80:83]
    ds_read_b64_tr_b16 v[48:49], v11 offset:40960
    ds_read_b64_tr_b16 v[50:51], v11 offset:41472
    s_waitcnt lgkmcnt(8)
    v_mfma_f32_16x16x32_bf16 v[84:87], v[56:59], v[12:15], v[84:87]
    v_mfma_f32_16x16x32_bf16 v[88:91], v[56:59], v[16:19], v[88:91]
    v_mfma_f32_16x16x32_bf16 v[92:95], v[56:59], v[20:23], v[92:95]
    v_mfma_f32_16x16x32_bf16 v[96:99], v[56:59], v[24:27], v[96:99]
    s_waitcnt lgkmcnt(5)
    v_mfma_f32_16x16x32_bf16 v[68:71], v[44:47], v[28:31], v[68:71]
    ds_read_b128 v[12:15], v7 offset:40960
    ds_read_b64_tr_b16 v[52:53], v10 offset:45056
    s_waitcnt lgkmcnt(6)
    v_mfma_f32_16x16x32_bf16 v[72:75], v[44:47], v[32:35], v[72:75]
    ds_read_b64_tr_b16 v[54:55], v10 offset:45568
    ds_read_b128 v[16:19], v7 offset:43008
    s_waitcnt lgkmcnt(7)
    v_mfma_f32_16x16x32_bf16 v[76:79], v[44:47], v[36:39], v[76:79]
    ds_read_b128 v[20:23], v7 offset:45056
    ds_read_b128 v[24:27], v7 offset:47104
    s_waitcnt lgkmcnt(8)
    v_mfma_f32_16x16x32_bf16 v[80:83], v[44:47], v[40:43], v[80:83]
    ds_read_b64_tr_b16 v[56:57], v11 offset:45056
    ds_read_b64_tr_b16 v[58:59], v11 offset:45568
    s_waitcnt lgkmcnt(8)
    v_mfma_f32_16x16x32_bf16 v[84:87], v[48:51], v[28:31], v[84:87]
    v_mfma_f32_16x16x32_bf16 v[88:91], v[48:51], v[32:35], v[88:91]
    v_mfma_f32_16x16x32_bf16 v[92:95], v[48:51], v[36:39], v[92:95]
    v_mfma_f32_16x16x32_bf16 v[96:99], v[48:51], v[40:43], v[96:99]
    s_waitcnt lgkmcnt(5)
    v_mfma_f32_16x16x32_bf16 v[68:71], v[52:55], v[12:15], v[68:71]
    v_mov_b32_e64 v135, 3
    s_mov_b64 exec, 1
    ds_write_b32 v3, v135 offset:0
    s_mov_b64 exec, -1
    ds_read_b128 v[100:103], v134 offset:0
    ds_read_b128 v[104:107], v134 offset:64
    s_waitcnt lgkmcnt(7)
    v_mfma_f32_16x16x32_bf16 v[72:75], v[52:55], v[16:19], v[72:75]
    ds_read2_b32 v[108:109], v132 offset0:0 offset1:0
    ds_read2_b32 v[110:111], v132 offset0:16 offset1:16
    s_waitcnt lgkmcnt(8)
    v_mfma_f32_16x16x32_bf16 v[76:79], v[52:55], v[20:23], v[76:79]
    ds_read2_b32 v[112:113], v132 offset0:32 offset1:32
    ds_read2_b32 v[114:115], v132 offset0:48 offset1:48
    s_waitcnt lgkmcnt(9)
    v_mfma_f32_16x16x32_bf16 v[80:83], v[52:55], v[24:27], v[80:83]
    ds_read2_b32 v[124:125], v133 offset0:0 offset1:0
    ds_read2_b32 v[126:127], v133 offset0:16 offset1:16
    s_waitcnt lgkmcnt(9)
    v_mfma_f32_16x16x32_bf16 v[84:87], v[56:59], v[12:15], v[84:87]
    ds_read2_b32 v[128:129], v133 offset0:32 offset1:32
    ds_read2_b32 v[130:131], v133 offset0:48 offset1:48
    v_mfma_f32_16x16x32_bf16 v[88:91], v[56:59], v[16:19], v[88:91]
    ds_read2_b32 v[116:117], v132 offset0:128 offset1:128
    ds_read2_b32 v[118:119], v132 offset0:144 offset1:144
    v_mfma_f32_16x16x32_bf16 v[92:95], v[56:59], v[20:23], v[92:95]
    ds_read2_b32 v[120:121], v132 offset0:160 offset1:160
    ds_read2_b32 v[122:123], v132 offset0:176 offset1:176
    v_mfma_f32_16x16x32_bf16 v[96:99], v[56:59], v[24:27], v[96:99]
    s_waitcnt lgkmcnt(11)
    v_pk_fma_f32 v[68:69], v[100:101], v[108:109], v[68:69]
    v_pk_fma_f32 v[70:71], v[102:103], v[108:109], v[70:71]
    v_pk_fma_f32 v[84:85], v[104:105], v[108:109], v[84:85]
    v_pk_fma_f32 v[86:87], v[106:107], v[108:109], v[86:87]
    s_waitcnt lgkmcnt(10)
    v_pk_fma_f32 v[72:73], v[100:101], v[110:111], v[72:73]
    v_pk_fma_f32 v[74:75], v[102:103], v[110:111], v[74:75]
    v_pk_fma_f32 v[88:89], v[104:105], v[110:111], v[88:89]
    v_pk_fma_f32 v[90:91], v[106:107], v[110:111], v[90:91]
    s_waitcnt lgkmcnt(9)
    v_pk_fma_f32 v[76:77], v[100:101], v[112:113], v[76:77]
    v_pk_fma_f32 v[78:79], v[102:103], v[112:113], v[78:79]
    v_pk_fma_f32 v[92:93], v[104:105], v[112:113], v[92:93]
    v_pk_fma_f32 v[94:95], v[106:107], v[112:113], v[94:95]
    s_waitcnt lgkmcnt(8)
    v_pk_fma_f32 v[80:81], v[100:101], v[114:115], v[80:81]
    v_pk_fma_f32 v[82:83], v[102:103], v[114:115], v[82:83]
    v_pk_fma_f32 v[96:97], v[104:105], v[114:115], v[96:97]
    v_pk_fma_f32 v[98:99], v[106:107], v[114:115], v[98:99]
    s_waitcnt lgkmcnt(7)
    v_pk_mul_f32 v[12:13], v[68:69], v[124:125]
    v_pk_mul_f32 v[14:15], v[70:71], v[124:125]
    v_pk_mul_f32 v[16:17], v[84:85], v[124:125]
    v_pk_mul_f32 v[18:19], v[86:87], v[124:125]
    s_waitcnt lgkmcnt(6)
    v_pk_mul_f32 v[20:21], v[72:73], v[126:127]
    v_pk_mul_f32 v[22:23], v[74:75], v[126:127]
    v_pk_mul_f32 v[24:25], v[88:89], v[126:127]
    v_pk_mul_f32 v[26:27], v[90:91], v[126:127]
    s_waitcnt lgkmcnt(5)
    v_pk_mul_f32 v[28:29], v[76:77], v[128:129]
    v_pk_mul_f32 v[30:31], v[78:79], v[128:129]
    v_pk_mul_f32 v[32:33], v[92:93], v[128:129]
    v_pk_mul_f32 v[34:35], v[94:95], v[128:129]
    s_waitcnt lgkmcnt(4)
    v_pk_mul_f32 v[36:37], v[80:81], v[130:131]
    v_pk_mul_f32 v[38:39], v[82:83], v[130:131]
    v_pk_mul_f32 v[40:41], v[96:97], v[130:131]
    v_pk_mul_f32 v[42:43], v[98:99], v[130:131]
    s_waitcnt lgkmcnt(3)
    v_pk_fma_f32 v[68:69], v[68:69], v[116:117], s[40:41]
    v_pk_fma_f32 v[70:71], v[70:71], v[116:117], s[40:41]
    v_pk_fma_f32 v[84:85], v[84:85], v[116:117], s[40:41]
    v_pk_fma_f32 v[86:87], v[86:87], v[116:117], s[40:41]
    s_waitcnt lgkmcnt(2)
    v_pk_fma_f32 v[72:73], v[72:73], v[118:119], s[40:41]
    v_pk_fma_f32 v[74:75], v[74:75], v[118:119], s[40:41]
    v_pk_fma_f32 v[88:89], v[88:89], v[118:119], s[40:41]
    v_pk_fma_f32 v[90:91], v[90:91], v[118:119], s[40:41]
    s_waitcnt lgkmcnt(1)
    v_pk_fma_f32 v[76:77], v[76:77], v[120:121], s[40:41]
    v_pk_fma_f32 v[78:79], v[78:79], v[120:121], s[40:41]
    v_pk_fma_f32 v[92:93], v[92:93], v[120:121], s[40:41]
    v_pk_fma_f32 v[94:95], v[94:95], v[120:121], s[40:41]
    s_waitcnt lgkmcnt(0)
    v_pk_fma_f32 v[80:81], v[80:81], v[122:123], s[40:41]
    v_pk_fma_f32 v[82:83], v[82:83], v[122:123], s[40:41]
    v_pk_fma_f32 v[96:97], v[96:97], v[122:123], s[40:41]
    v_pk_fma_f32 v[98:99], v[98:99], v[122:123], s[40:41]
    v_exp_f32 v12, v12 clamp
    v_exp_f32 v13, v13 clamp
    v_exp_f32 v14, v14 clamp
    v_exp_f32 v15, v15 clamp
    v_exp_f32 v16, v16 clamp
    v_exp_f32 v17, v17 clamp
    v_exp_f32 v18, v18 clamp
    v_exp_f32 v19, v19 clamp
    v_exp_f32 v20, v20 clamp
    v_exp_f32 v21, v21 clamp
    v_exp_f32 v22, v22 clamp
    v_exp_f32 v23, v23 clamp
    v_exp_f32 v24, v24 clamp
    v_exp_f32 v25, v25 clamp
    v_exp_f32 v26, v26 clamp
    v_exp_f32 v27, v27 clamp
    v_exp_f32 v28, v28 clamp
    v_exp_f32 v29, v29 clamp
    v_exp_f32 v30, v30 clamp
    v_exp_f32 v31, v31 clamp
    v_exp_f32 v32, v32 clamp
    v_exp_f32 v33, v33 clamp
    v_exp_f32 v34, v34 clamp
    v_exp_f32 v35, v35 clamp
    v_exp_f32 v36, v36 clamp
    v_exp_f32 v37, v37 clamp
    v_exp_f32 v38, v38 clamp
    v_exp_f32 v39, v39 clamp
    v_exp_f32 v40, v40 clamp
    v_exp_f32 v41, v41 clamp
    v_exp_f32 v42, v42 clamp
    v_exp_f32 v43, v43 clamp
    v_pk_add_f32 v[12:13], v[12:13], s[74:75]
    v_pk_add_f32 v[14:15], v[14:15], s[74:75]
    v_pk_add_f32 v[16:17], v[16:17], s[74:75]
    v_pk_add_f32 v[18:19], v[18:19], s[74:75]
    v_pk_add_f32 v[20:21], v[20:21], s[74:75]
    v_pk_add_f32 v[22:23], v[22:23], s[74:75]
    v_pk_add_f32 v[24:25], v[24:25], s[74:75]
    v_pk_add_f32 v[26:27], v[26:27], s[74:75]
    v_pk_add_f32 v[28:29], v[28:29], s[74:75]
    v_pk_add_f32 v[30:31], v[30:31], s[74:75]
    v_pk_add_f32 v[32:33], v[32:33], s[74:75]
    v_pk_add_f32 v[34:35], v[34:35], s[74:75]
    v_pk_add_f32 v[36:37], v[36:37], s[74:75]
    v_pk_add_f32 v[38:39], v[38:39], s[74:75]
    v_pk_add_f32 v[40:41], v[40:41], s[74:75]
    v_pk_add_f32 v[42:43], v[42:43], s[74:75]
    v_max_f32 v68, v68, v12
    v_max_f32 v69, v69, v13
    v_max_f32 v70, v70, v14
    v_max_f32 v71, v71, v15
    v_max_f32 v84, v84, v16
    v_max_f32 v85, v85, v17
    v_max_f32 v86, v86, v18
    v_max_f32 v87, v87, v19
    v_max_f32 v72, v72, v20
    v_max_f32 v73, v73, v21
    v_max_f32 v74, v74, v22
    v_max_f32 v75, v75, v23
    v_max_f32 v88, v88, v24
    v_max_f32 v89, v89, v25
    v_max_f32 v90, v90, v26
    v_max_f32 v91, v91, v27
    v_max_f32 v76, v76, v28
    v_max_f32 v77, v77, v29
    v_max_f32 v78, v78, v30
    v_max_f32 v79, v79, v31
    v_max_f32 v92, v92, v32
    v_max_f32 v93, v93, v33
    v_max_f32 v94, v94, v34
    v_max_f32 v95, v95, v35
    v_max_f32 v80, v80, v36
    v_max_f32 v81, v81, v37
    v_max_f32 v82, v82, v38
    v_max_f32 v83, v83, v39
    v_max_f32 v96, v96, v40
    v_max_f32 v97, v97, v41
    v_max_f32 v98, v98, v42
    v_max_f32 v99, v99, v43
    v_cvt_pk_bf16_f32 v44, v68, v69
    v_cvt_pk_bf16_f32 v45, v70, v71
    v_cvt_pk_bf16_f32 v46, v84, v85
    v_cvt_pk_bf16_f32 v47, v86, v87
    v_cvt_pk_bf16_f32 v48, v72, v73
    v_cvt_pk_bf16_f32 v49, v74, v75
    v_cvt_pk_bf16_f32 v50, v88, v89
    v_cvt_pk_bf16_f32 v51, v90, v91
    v_cvt_pk_bf16_f32 v52, v76, v77
    v_cvt_pk_bf16_f32 v53, v78, v79
    v_cvt_pk_bf16_f32 v54, v92, v93
    v_cvt_pk_bf16_f32 v55, v94, v95
    v_cvt_pk_bf16_f32 v56, v80, v81
    v_cvt_pk_bf16_f32 v57, v82, v83
    v_cvt_pk_bf16_f32 v58, v96, v97
    v_cvt_pk_bf16_f32 v59, v98, v99
    s_load_dwordx8 s[60:67], s[48:49], 0 glc
    s_and_b32 s44, s46, 127
    s_lshl_b32 s44, s44, 2
    s_add_u32 s44, s44, 24832
    v_and_b32 v1, 15, v0
    v_lshl_add_u32 v63, v1, 2, s44

    ds_read2_b32 v[4:5], v63 offset0:0 offset1:0
    ds_read2_b32 v[6:7], v63 offset0:16 offset1:16
    ds_read2_b32 v[8:9], v63 offset0:32 offset1:32
    ds_read2_b32 v[10:11], v63 offset0:48 offset1:48
    ds_read2_b32 v[12:13], v63 offset0:128 offset1:128
    ds_read2_b32 v[14:15], v63 offset0:144 offset1:144
    ds_read2_b32 v[16:17], v63 offset0:160 offset1:160
    ds_read2_b32 v[18:19], v63 offset0:176 offset1:176
    v_lshlrev_b32 v60, 4, v0
    v_and_b32 v61, 48, v0
    s_setprio 2
SP_1:
    s_load_dword s58, s[56:57], 0 glc
    s_waitcnt lgkmcnt(0)
    s_cmp_ge_u32 s58, 32
    s_cbranch_scc1 SD_2
    s_sleep 1
    s_branch SP_1
SD_2:
F_kp:
    buffer_load_dwordx4 v[36:39], v61, s[24:27], s83 offen offset:0 sc0 sc1
    buffer_load_dwordx4 v[40:43], v61, s[24:27], s83 offen offset:64 sc0 sc1
    buffer_load_dwordx4 v[20:23], v60, s[24:27], s82 offen offset:0 sc0 sc1
    buffer_load_dwordx4 v[24:27], v60, s[24:27], s82 offen offset:2048 sc0 sc1
    buffer_load_dwordx4 v[28:31], v60, s[24:27], s82 offen offset:1024 sc0 sc1
    buffer_load_dwordx4 v[32:35], v60, s[24:27], s82 offen offset:3072 sc0 sc1
    v_mov_b32 v62, 4
    s_mov_b64 exec, 1
    ds_write_b32 v3, v62 offset:0
    s_mov_b64 exec, -1
    s_waitcnt vmcnt(4)
    v_cvt_pk_bf16_f32 v124, v36, v37
    v_cvt_pk_bf16_f32 v125, v38, v39
    v_cvt_pk_bf16_f32 v126, v40, v41
    v_cvt_pk_bf16_f32 v127, v42, v43
    s_nop 1
    v_mfma_f32_16x16x32_bf16 v[76:79], v[124:127], v[44:47], 0
    v_mfma_f32_16x16x32_bf16 v[88:91], v[124:127], v[48:51], 0
    v_mfma_f32_16x16x32_bf16 v[100:103], v[124:127], v[52:55], 0
    v_mfma_f32_16x16x32_bf16 v[112:115], v[124:127], v[56:59], 0
    s_waitcnt vmcnt(2)
    v_cvt_pk_bf16_f32 v116, v20, v21
    v_cvt_pk_bf16_f32 v117, v22, v23
    v_cvt_pk_bf16_f32 v118, v24, v25
    v_cvt_pk_bf16_f32 v119, v26, v27
    s_nop 1
    v_mfma_f32_16x16x32_bf16 v[68:71], v[116:119], v[44:47], 0
    v_mfma_f32_16x16x32_bf16 v[80:83], v[116:119], v[48:51], 0
    v_mfma_f32_16x16x32_bf16 v[92:95], v[116:119], v[52:55], 0
    v_mfma_f32_16x16x32_bf16 v[104:107], v[116:119], v[56:59], 0
    v_add_f32 v76, s74, v76
    v_rcp_f32 v76, v76
    s_nop 0
    v_mov_b32 v77, v76
    v_add_f32 v88, s74, v88
    v_rcp_f32 v88, v88
    s_nop 0
    v_mov_b32 v89, v88
    v_add_f32 v100, s74, v100
    v_rcp_f32 v100, v100
    s_nop 0
    v_mov_b32 v101, v100
    v_add_f32 v112, s74, v112
    v_rcp_f32 v112, v112
    s_nop 0
    v_mov_b32_e64 v113, v112
    s_waitcnt vmcnt(0)
    v_cvt_pk_bf16_f32 v120, v28, v29
    v_cvt_pk_bf16_f32 v121, v30, v31
    v_cvt_pk_bf16_f32 v122, v32, v33
    v_cvt_pk_bf16_f32 v123, v34, v35
    s_nop 1
    v_mfma_f32_16x16x32_bf16 v[72:75], v[120:123], v[44:47], 0
    v_mfma_f32_16x16x32_bf16 v[84:87], v[120:123], v[48:51], 0
    v_mfma_f32_16x16x32_bf16 v[96:99], v[120:123], v[52:55], 0
    v_mfma_f32_16x16x32_bf16 v[108:111], v[120:123], v[56:59], 0
    s_add_u32 s80, s79, 0
    v_pk_mul_f32 v[68:69], v[68:69], v[76:77]
    v_pk_mul_f32 v[70:71], v[70:71], v[76:77]
    s_nop 1
    v_pk_mul_f32 v[72:73], v[72:73], v[76:77]
    v_pk_mul_f32 v[74:75], v[74:75], v[76:77]
    v_cvt_pk_bf16_f32 v28, v68, v69
    v_cvt_pk_bf16_f32 v29, v70, v71
    v_cvt_pk_bf16_f32 v30, v72, v73
    v_cvt_pk_bf16_f32 v31, v74, v75
    buffer_store_dwordx4 v[28:31], v60, s[16:19], s80 offen sc0 sc1
    s_add_u32 s80, s79, 32768
    v_pk_mul_f32 v[80:81], v[80:81], v[88:89]
    v_pk_mul_f32 v[82:83], v[82:83], v[88:89]
    v_pk_mul_f32 v[84:85], v[84:85], v[88:89]
    v_pk_mul_f32 v[86:87], v[86:87], v[88:89]
    v_cvt_pk_bf16_f32 v32, v80, v81
    v_cvt_pk_bf16_f32 v33, v82, v83
    v_cvt_pk_bf16_f32 v34, v84, v85
    v_cvt_pk_bf16_f32 v35, v86, v87
    buffer_store_dwordx4 v[32:35], v60, s[16:19], s80 offen sc0 sc1
    s_add_u32 s80, s79, 65536
    v_pk_mul_f32 v[92:93], v[92:93], v[100:101]
    v_pk_mul_f32 v[94:95], v[94:95], v[100:101]
    v_pk_mul_f32 v[96:97], v[96:97], v[100:101]
    v_pk_mul_f32 v[98:99], v[98:99], v[100:101]
    v_cvt_pk_bf16_f32 v36, v92, v93
    v_cvt_pk_bf16_f32 v37, v94, v95
    v_cvt_pk_bf16_f32 v38, v96, v97
    v_cvt_pk_bf16_f32 v39, v98, v99
    buffer_store_dwordx4 v[36:39], v60, s[16:19], s80 offen sc0 sc1
    s_add_u32 s80, s79, 98304
    v_pk_mul_f32 v[104:105], v[104:105], v[112:113]
    v_pk_mul_f32 v[106:107], v[106:107], v[112:113]
    v_pk_mul_f32 v[108:109], v[108:109], v[112:113]
    v_pk_mul_f32 v[110:111], v[110:111], v[112:113]
    v_cvt_pk_bf16_f32 v40, v104, v105
    v_cvt_pk_bf16_f32 v41, v106, v107
    v_cvt_pk_bf16_f32 v42, v108, v109
    v_cvt_pk_bf16_f32 v43, v110, v111
    buffer_store_dwordx4 v[40:43], v60, s[16:19], s80 offen sc0 sc1
    v_lshlrev_b32 v132, 16, v148
    v_and_b32 v133, 0xffff0000, v148
    v_lshlrev_b32 v134, 16, v149
    v_and_b32 v135, 0xffff0000, v149
    v_lshlrev_b32 v136, 16, v150
    v_and_b32 v137, 0xffff0000, v150
    v_lshlrev_b32 v138, 16, v151
    v_and_b32 v139, 0xffff0000, v151
    v_pk_add_f32 v[72:73], v[132:133], v[4:5]
    v_pk_add_f32 v[74:75], v[134:135], v[4:5]
    v_pk_add_f32 v[76:77], v[136:137], v[4:5]
    v_pk_add_f32 v[78:79], v[138:139], v[4:5]
    v_cvt_pk_bf16_f32 v68, v72, v73
    v_cvt_pk_bf16_f32 v69, v74, v75
    v_cvt_pk_bf16_f32 v70, v76, v77
    v_cvt_pk_bf16_f32 v71, v78, v79
    v_lshlrev_b32 v72, 16, v68
    v_and_b32 v73, 0xffff0000, v68
    v_lshlrev_b32 v74, 16, v69
    v_and_b32 v75, 0xffff0000, v69
    v_lshlrev_b32 v76, 16, v70
    v_and_b32 v77, 0xffff0000, v70
    v_lshlrev_b32 v78, 16, v71
    v_and_b32 v79, 0xffff0000, v71
    v_pk_mul_f32 v[72:73], v[72:73], v[12:13]
    v_pk_mul_f32 v[74:75], v[74:75], v[12:13]
    v_pk_mul_f32 v[76:77], v[76:77], v[12:13]
    v_pk_mul_f32 v[78:79], v[78:79], v[12:13]
    v_cvt_pk_bf16_f32 v68, v72, v73
    v_cvt_pk_bf16_f32 v69, v74, v75
    v_cvt_pk_bf16_f32 v70, v76, v77
    v_cvt_pk_bf16_f32 v71, v78, v79
    v_lshlrev_b32 v72, 16, v68
    v_and_b32 v73, 0xffff0000, v68
    v_lshlrev_b32 v74, 16, v69
    v_and_b32 v75, 0xffff0000, v69
    v_lshlrev_b32 v76, 16, v70
    v_and_b32 v77, 0xffff0000, v70
    v_lshlrev_b32 v78, 16, v71
    v_and_b32 v79, 0xffff0000, v71
    v_pk_add_f32 v[132:133], v[132:133], v[72:73]
    v_pk_add_f32 v[134:135], v[134:135], v[74:75]
    v_pk_add_f32 v[136:137], v[136:137], v[76:77]
    v_pk_add_f32 v[138:139], v[138:139], v[78:79]
    v_lshlrev_b32 v140, 16, v152
    v_and_b32 v141, 0xffff0000, v152
    v_lshlrev_b32 v142, 16, v153
    v_and_b32 v143, 0xffff0000, v153
    v_lshlrev_b32 v144, 16, v154
    v_and_b32 v145, 0xffff0000, v154
    v_lshlrev_b32 v146, 16, v155
    v_and_b32 v147, 0xffff0000, v155
    v_pk_add_f32 v[72:73], v[140:141], v[6:7]
    v_pk_add_f32 v[74:75], v[142:143], v[6:7]
    v_pk_add_f32 v[76:77], v[144:145], v[6:7]
    v_pk_add_f32 v[78:79], v[146:147], v[6:7]
    v_cvt_pk_bf16_f32 v68, v72, v73
    v_cvt_pk_bf16_f32 v69, v74, v75
    v_cvt_pk_bf16_f32 v70, v76, v77
    v_cvt_pk_bf16_f32 v71, v78, v79
    v_lshlrev_b32 v72, 16, v68
    v_and_b32 v73, 0xffff0000, v68
    v_lshlrev_b32 v74, 16, v69
    v_and_b32 v75, 0xffff0000, v69
    v_lshlrev_b32 v76, 16, v70
    v_and_b32 v77, 0xffff0000, v70
    v_lshlrev_b32 v78, 16, v71
    v_and_b32 v79, 0xffff0000, v71
    v_pk_mul_f32 v[72:73], v[72:73], v[14:15]
    v_pk_mul_f32 v[74:75], v[74:75], v[14:15]
    v_pk_mul_f32 v[76:77], v[76:77], v[14:15]
    v_pk_mul_f32 v[78:79], v[78:79], v[14:15]
    v_cvt_pk_bf16_f32 v68, v72, v73
    v_cvt_pk_bf16_f32 v69, v74, v75
    v_cvt_pk_bf16_f32 v70, v76, v77
    v_cvt_pk_bf16_f32 v71, v78, v79
    v_lshlrev_b32 v72, 16, v68
    v_and_b32 v73, 0xffff0000, v68
    v_lshlrev_b32 v74, 16, v69
    v_and_b32 v75, 0xffff0000, v69
    v_lshlrev_b32 v76, 16, v70
    v_and_b32 v77, 0xffff0000, v70
    v_lshlrev_b32 v78, 16, v71
    v_and_b32 v79, 0xffff0000, v71
    v_pk_add_f32 v[140:141], v[140:141], v[72:73]
    v_pk_add_f32 v[142:143], v[142:143], v[74:75]
    v_pk_add_f32 v[144:145], v[144:145], v[76:77]
    v_pk_add_f32 v[146:147], v[146:147], v[78:79]
    v_permlane16_swap_b32 v132, v136
    v_permlane16_swap_b32 v133, v137
    v_permlane16_swap_b32 v134, v138
    v_permlane16_swap_b32 v135, v139
    v_permlane16_swap_b32 v140, v144
    v_permlane16_swap_b32 v141, v145
    v_permlane16_swap_b32 v142, v146
    v_permlane16_swap_b32 v143, v147
    s_waitcnt vmcnt(0)
    s_atomic_add s76, s[68:69], 0
    s_atomic_add s76, s[68:69], 128
    s_atomic_add s76, s[68:69], 256
    s_atomic_add s76, s[68:69], 384
    v_mov_b32 v62, 5
    s_mov_b64 exec, 1
    ds_write_b32 v3, v62 offset:0
    s_mov_b64 exec, -1
    s_setprio 0
    v_lshlrev_b32 v148, 16, v156
    v_and_b32 v149, 0xffff0000, v156
    v_lshlrev_b32 v150, 16, v157
    v_and_b32 v151, 0xffff0000, v157
    v_lshlrev_b32 v152, 16, v158
    v_and_b32 v153, 0xffff0000, v158
    v_lshlrev_b32_e64 v154, 16, v159
    v_and_b32 v155, 0xffff0000, v159
    v_pk_add_f32 v[72:73], v[148:149], v[8:9]
    v_pk_add_f32 v[74:75], v[150:151], v[8:9]
    v_pk_add_f32 v[76:77], v[152:153], v[8:9]
    v_pk_add_f32 v[78:79], v[154:155], v[8:9]
    v_cvt_pk_bf16_f32 v68, v72, v73
    v_cvt_pk_bf16_f32 v69, v74, v75
    v_cvt_pk_bf16_f32 v70, v76, v77
    v_cvt_pk_bf16_f32 v71, v78, v79
    v_lshlrev_b32 v72, 16, v68
    v_and_b32 v73, 0xffff0000, v68
    v_lshlrev_b32 v74, 16, v69
    v_and_b32 v75, 0xffff0000, v69
    v_lshlrev_b32 v76, 16, v70
    v_and_b32 v77, 0xffff0000, v70
    v_lshlrev_b32 v78, 16, v71
    v_and_b32 v79, 0xffff0000, v71
    v_pk_mul_f32 v[72:73], v[72:73], v[16:17]
    v_pk_mul_f32 v[74:75], v[74:75], v[16:17]
    v_pk_mul_f32 v[76:77], v[76:77], v[16:17]
    v_pk_mul_f32 v[78:79], v[78:79], v[16:17]
    v_cvt_pk_bf16_f32 v68, v72, v73
    v_cvt_pk_bf16_f32 v69, v74, v75
    v_cvt_pk_bf16_f32 v70, v76, v77
    v_cvt_pk_bf16_f32 v71, v78, v79
    v_lshlrev_b32 v72, 16, v68
    v_and_b32 v73, 0xffff0000, v68
    v_lshlrev_b32 v74, 16, v69
    v_and_b32 v75, 0xffff0000, v69
    v_lshlrev_b32 v76, 16, v70
    v_and_b32 v77, 0xffff0000, v70
    v_lshlrev_b32 v78, 16, v71
    v_and_b32 v79, 0xffff0000, v71
    v_pk_add_f32 v[148:149], v[148:149], v[72:73]
    v_pk_add_f32 v[150:151], v[150:151], v[74:75]
    v_pk_add_f32 v[152:153], v[152:153], v[76:77]
    v_pk_add_f32 v[154:155], v[154:155], v[78:79]
    v_lshlrev_b32 v156, 16, v160
    v_and_b32 v157, 0xffff0000, v160
    v_lshlrev_b32 v158, 16, v161
    v_and_b32 v159, 0xffff0000, v161
    v_lshlrev_b32 v160, 16, v162
    v_and_b32 v161, 0xffff0000, v162
    v_lshlrev_b32 v162, 16, v163
    v_and_b32 v163, 0xffff0000, v163
    v_pk_add_f32 v[72:73], v[156:157], v[10:11]
    v_pk_add_f32 v[74:75], v[158:159], v[10:11]
    v_pk_add_f32 v[76:77], v[160:161], v[10:11]
    v_pk_add_f32 v[78:79], v[162:163], v[10:11]
    v_cvt_pk_bf16_f32 v68, v72, v73
    v_cvt_pk_bf16_f32 v69, v74, v75
    v_cvt_pk_bf16_f32 v70, v76, v77
    v_cvt_pk_bf16_f32 v71, v78, v79
    v_lshlrev_b32 v72, 16, v68
    v_and_b32 v73, 0xffff0000, v68
    v_lshlrev_b32 v74, 16, v69
    v_and_b32 v75, 0xffff0000, v69
    v_lshlrev_b32 v76, 16, v70
    v_and_b32 v77, 0xffff0000, v70
    v_lshlrev_b32 v78, 16, v71
    v_and_b32 v79, 0xffff0000, v71
    v_pk_mul_f32 v[72:73], v[72:73], v[18:19]
    v_pk_mul_f32 v[74:75], v[74:75], v[18:19]
    v_pk_mul_f32 v[76:77], v[76:77], v[18:19]
    v_pk_mul_f32 v[78:79], v[78:79], v[18:19]
    v_cvt_pk_bf16_f32 v68, v72, v73
    v_cvt_pk_bf16_f32 v69, v74, v75
    v_cvt_pk_bf16_f32 v70, v76, v77
    v_cvt_pk_bf16_f32 v71, v78, v79
    v_lshlrev_b32 v72, 16, v68
    v_and_b32 v73, 0xffff0000, v68
    v_lshlrev_b32 v74, 16, v69
    v_and_b32 v75, 0xffff0000, v69
    v_lshlrev_b32 v76, 16, v70
    v_and_b32 v77, 0xffff0000, v70
    v_lshlrev_b32 v78, 16, v71
    v_and_b32 v79, 0xffff0000, v71
    v_pk_add_f32 v[156:157], v[156:157], v[72:73]
    v_pk_add_f32 v[158:159], v[158:159], v[74:75]
    v_pk_add_f32 v[160:161], v[160:161], v[76:77]
    v_pk_add_f32 v[162:163], v[162:163], v[78:79]
    v_permlane16_swap_b32 v148, v152
    v_permlane16_swap_b32 v149, v153
    v_permlane16_swap_b32 v150, v154
    v_permlane16_swap_b32 v151, v155
    v_permlane16_swap_b32 v156, v160
    v_permlane16_swap_b32 v157, v161
    v_permlane16_swap_b32 v158, v162
    v_permlane16_swap_b32 v159, v163
    v_lshrrev_b32 v2, 4, v0
    v_lshlrev_b32 v4, 4, v0
    v_add_u32 v5, 98304, v4
    v_add_u32 v4, 16384, v4
    v_bfe_u32 v1, v0, 2, 2
    v_lshl_add_u32 v1, v2, 2, v1
    v_and_b32 v63, 7, v1
    s_lshl_b32 s44, s3, 1
    v_xor_b32 v63, s44, v63
    v_lshlrev_b32 v63, 5, v63
    v_lshl_add_u32 v63, v1, 8, v63
    v_and_b32 v1, 3, v0
    v_lshl_add_u32 v8, v1, 3, v63
    v_xor_b32 v9, 32, v8
    v_add_u32 v10, 65536, v8
    v_add_u32 v11, 65536, v9
    v_add_u32 v12, 122880, v8
    v_add_u32 v13, 122880, v9
    v_and_b32 v1, 15, v0

    v_mov_b32 v128, 0
    v_mov_b32 v129, 0
    v_mov_b32 v130, 0
    v_mov_b32 v131, 0
    s_mov_b32 s77, 0
F_km:
    s_and_b64 s[50:51], s[60:61], s[62:63]
    s_and_b64 s[50:51], s[50:51], s[64:65]
    s_and_b64 s[50:51], s[50:51], s[66:67]
    s_and_b32 s50, s50, s51
    s_bitcmp1_b32 s50, 15
    s_cbranch_scc1 F_km1
    s_load_dwordx8 s[60:67], s[48:49], 0 glc
    s_waitcnt lgkmcnt(0)
    s_branch F_km
F_km1:
    s_sub_u32 s59, 2047, s46

    s_and_b32 s44, s60, 0x7ff
    s_sub_u32 s44, s59, s44
    s_cmp_ge_u32 s44, 64
    s_cbranch_scc1 SD_3
    s_mov_b32 s77, 1
    s_or_b32 s47, s60, 0x4000
    v_mov_b32 v63, s47
    v_cmp_eq_u32 vcc, s44, v1
    s_sub_u32 s44, s44, 16
    s_nop 0
    v_cndmask_b32 v128, v128, v63, vcc
    v_cmp_eq_u32 vcc, s44, v1
    s_sub_u32 s44, s44, 16
    s_nop 0
    v_cndmask_b32 v129, v129, v63, vcc
    v_cmp_eq_u32 vcc, s44, v1
    s_sub_u32 s44, s44, 16
    s_nop 0
    v_cndmask_b32 v130, v130, v63, vcc
    v_cmp_eq_u32 vcc, s44, v1
    s_sub_u32 s44, s44, 16
    s_nop 0
    v_cndmask_b32 v131, v131, v63, vcc
SD_3:
    s_and_b32 s44, s61, 0x7ff
    s_sub_u32 s44, s59, s44
    s_cmp_ge_u32 s44, 64
    s_cbranch_scc1 SD_4
    s_mov_b32 s77, 1
    s_or_b32 s47, s61, 0x4800
    v_mov_b32 v63, s47
    v_cmp_eq_u32 vcc, s44, v1
    s_sub_u32 s44, s44, 16
    s_nop 0
    v_cndmask_b32 v128, v128, v63, vcc
    v_cmp_eq_u32 vcc, s44, v1
    s_sub_u32 s44, s44, 16
    s_nop 0
    v_cndmask_b32 v129, v129, v63, vcc
    v_cmp_eq_u32 vcc, s44, v1
    s_sub_u32 s44, s44, 16
    s_nop 0
    v_cndmask_b32 v130, v130, v63, vcc
    v_cmp_eq_u32 vcc, s44, v1
    s_sub_u32 s44, s44, 16
    s_nop 0
    v_cndmask_b32 v131, v131, v63, vcc
SD_4:
    s_and_b32 s44, s62, 0x7ff
    s_sub_u32 s44, s59, s44
    s_cmp_ge_u32 s44, 64
    s_cbranch_scc1 SD_5
    s_mov_b32 s77, 1
    s_or_b32 s47, s62, 0x5000
    v_mov_b32 v63, s47
    v_cmp_eq_u32 vcc, s44, v1
    s_sub_u32 s44, s44, 16
    s_nop 0
    v_cndmask_b32 v128, v128, v63, vcc
    v_cmp_eq_u32 vcc, s44, v1
    s_sub_u32 s44, s44, 16
    s_nop 0
    v_cndmask_b32 v129, v129, v63, vcc
    v_cmp_eq_u32 vcc, s44, v1
    s_sub_u32 s44, s44, 16
    s_nop 0
    v_cndmask_b32 v130, v130, v63, vcc
    v_cmp_eq_u32 vcc, s44, v1
    s_sub_u32 s44, s44, 16
    s_nop 0
    v_cndmask_b32 v131, v131, v63, vcc
SD_5:
    s_and_b32 s44, s63, 0x7ff
    s_sub_u32 s44, s59, s44
    s_cmp_ge_u32 s44, 64
    s_cbranch_scc1 SD_6
    s_mov_b32 s77, 1
    s_or_b32 s47, s63, 0x5800
    v_mov_b32 v63, s47
    v_cmp_eq_u32 vcc, s44, v1
    s_sub_u32 s44, s44, 16
    s_nop 0
    v_cndmask_b32 v128, v128, v63, vcc
    v_cmp_eq_u32 vcc, s44, v1
    s_sub_u32 s44, s44, 16
    s_nop 0
    v_cndmask_b32 v129, v129, v63, vcc
    v_cmp_eq_u32 vcc, s44, v1
    s_sub_u32 s44, s44, 16
    s_nop 0
    v_cndmask_b32 v130, v130, v63, vcc
    v_cmp_eq_u32 vcc, s44, v1
    s_sub_u32 s44, s44, 16
    s_nop 0
    v_cndmask_b32 v131, v131, v63, vcc
SD_6:
    s_and_b32 s44, s64, 0x7ff
    s_sub_u32 s44, s59, s44
    s_cmp_ge_u32 s44, 64
    s_cbranch_scc1 SD_7
    s_mov_b32 s77, 1
    s_or_b32 s47, s64, 0x6000
    v_mov_b32 v63, s47
    v_cmp_eq_u32 vcc, s44, v1
    s_sub_u32 s44, s44, 16
    s_nop 0
    v_cndmask_b32 v128, v128, v63, vcc
    v_cmp_eq_u32 vcc, s44, v1
    s_sub_u32 s44, s44, 16
    s_nop 0
    v_cndmask_b32 v129, v129, v63, vcc
    v_cmp_eq_u32 vcc, s44, v1
    s_sub_u32 s44, s44, 16
    s_nop 0
    v_cndmask_b32 v130, v130, v63, vcc
    v_cmp_eq_u32 vcc, s44, v1
    s_sub_u32 s44, s44, 16
    s_nop 0
    v_cndmask_b32 v131, v131, v63, vcc
SD_7:
    s_and_b32 s44, s65, 0x7ff
    s_sub_u32 s44, s59, s44
    s_cmp_ge_u32 s44, 64
    s_cbranch_scc1 SD_8
    s_mov_b32 s77, 1
    s_or_b32 s47, s65, 0x6800
    v_mov_b32 v63, s47
    v_cmp_eq_u32 vcc, s44, v1
    s_sub_u32 s44, s44, 16
    s_nop 0
    v_cndmask_b32 v128, v128, v63, vcc
    v_cmp_eq_u32 vcc, s44, v1
    s_sub_u32 s44, s44, 16
    s_nop 0
    v_cndmask_b32 v129, v129, v63, vcc
    v_cmp_eq_u32 vcc, s44, v1
    s_sub_u32 s44, s44, 16
    s_nop 0
    v_cndmask_b32 v130, v130, v63, vcc
    v_cmp_eq_u32 vcc, s44, v1
    s_sub_u32 s44, s44, 16
    s_nop 0
    v_cndmask_b32 v131, v131, v63, vcc
SD_8:
    s_and_b32 s44, s66, 0x7ff
    s_sub_u32 s44, s59, s44
    s_cmp_ge_u32 s44, 64
    s_cbranch_scc1 SD_9
    s_mov_b32 s77, 1
    s_or_b32 s47, s66, 0x7000
    v_mov_b32 v63, s47
    v_cmp_eq_u32 vcc, s44, v1
    s_sub_u32 s44, s44, 16
    s_nop 0
    v_cndmask_b32 v128, v128, v63, vcc
    v_cmp_eq_u32 vcc, s44, v1
    s_sub_u32 s44, s44, 16
    s_nop 0
    v_cndmask_b32 v129, v129, v63, vcc
    v_cmp_eq_u32 vcc, s44, v1
    s_sub_u32 s44, s44, 16
    s_nop 0
    v_cndmask_b32 v130, v130, v63, vcc
    v_cmp_eq_u32 vcc, s44, v1
    s_sub_u32 s44, s44, 16
    s_nop 0
    v_cndmask_b32 v131, v131, v63, vcc
SD_9:
    s_and_b32 s44, s67, 0x7ff
    s_sub_u32 s44, s59, s44
    s_cmp_ge_u32 s44, 64
    s_cbranch_scc1 SD_10
    s_mov_b32 s77, 1
    s_or_b32 s47, s67, 0x7800
    v_mov_b32 v63, s47
    v_cmp_eq_u32 vcc, s44, v1
    s_sub_u32 s44, s44, 16
    s_nop 0
    v_cndmask_b32 v128, v128, v63, vcc
    v_cmp_eq_u32 vcc, s44, v1
    s_sub_u32 s44, s44, 16
    s_nop 0
    v_cndmask_b32 v129, v129, v63, vcc
    v_cmp_eq_u32 vcc, s44, v1
    s_sub_u32 s44, s44, 16
    s_nop 0
    v_cndmask_b32 v130, v130, v63, vcc
    v_cmp_eq_u32_e64 vcc, s44, v1
    s_sub_u32 s44, s44, 16
    s_nop 0
    v_cndmask_b32 v131, v131, v63, vcc
SD_10:
    s_cmp_lg_u32 s77, 0
    s_cbranch_scc1 F_ys
F_ys1:
    s_setprio 2
    s_waitcnt lgkmcnt(0)
    s_barrier
    ds_read_b64_tr_b16 v[40:41], v12 offset:24576
    ds_read_b64_tr_b16 v[42:43], v12 offset:28672
    ds_read_b128 v[24:27], v4 offset:0
    ds_read_b64_tr_b16 v[44:45], v13 offset:24576
    ds_read_b64_tr_b16 v[46:47], v13 offset:28672
    ds_read_b128 v[28:31], v4 offset:2048
    ds_read_b128 v[32:35], v4 offset:4096
    ds_read_b128 v[36:39], v4 offset:6144
    ds_read_b64_tr_b16 v[64:65], v12 offset:32768
    ds_read_b64_tr_b16 v[66:67], v12 offset:36864
    ds_read_b128 v[48:51], v4 offset:1024
    ds_read_b64_tr_b16 v[68:69], v13 offset:32768
    ds_read_b64_tr_b16 v[70:71], v13 offset:36864
    ds_read_b128 v[52:55], v4 offset:3072
    ds_read_b128 v[56:59], v4 offset:5120
    s_waitcnt lgkmcnt(8)
    ds_read_b128 v[60:63], v4 offset:7168
    s_waitcnt lgkmcnt(13)
    v_mfma_f32_16x16x32_bf16 v[132:135], v[40:43], v[24:27], v[132:135]
    s_waitcnt lgkmcnt(11)
    v_mfma_f32_16x16x32_bf16 v[136:139], v[44:47], v[24:27], v[136:139]
    s_waitcnt lgkmcnt(0)
    s_barrier
    ds_read_b64_tr_b16 v[88:89], v10 offset:0
    ds_read_b64_tr_b16 v[90:91], v10 offset:4096
    v_mfma_f32_16x16x32_bf16 v[140:143], v[40:43], v[28:31], v[140:143]
    ds_read_b128 v[72:75], v5 offset:0
    ds_read_b64_tr_b16 v[92:93], v11 offset:0
    v_mfma_f32_16x16x32_bf16 v[144:147], v[44:47], v[28:31], v[144:147]
    ds_read_b64_tr_b16 v[94:95], v11 offset:4096
    ds_read_b128 v[76:79], v5 offset:2048
    v_mfma_f32_16x16x32_bf16 v[148:151], v[40:43], v[32:35], v[148:151]
    ds_read_b128 v[80:83], v5 offset:4096
    ds_read_b128 v[84:87], v5 offset:6144
    v_mfma_f32_16x16x32_bf16 v[152:155], v[44:47], v[32:35], v[152:155]
    v_mfma_f32_16x16x32_bf16 v[156:159], v[40:43], v[36:39], v[156:159]
    v_mfma_f32_16x16x32_bf16 v[160:163], v[44:47], v[36:39], v[160:163]
    v_mfma_f32_16x16x32_bf16 v[132:135], v[64:67], v[48:51], v[132:135]
    ds_read_b64_tr_b16 v[40:41], v10 offset:8192
    ds_read_b64_tr_b16 v[42:43], v10 offset:12288
    v_mfma_f32_16x16x32_bf16 v[136:139], v[68:71], v[48:51], v[136:139]
    ds_read_b128 v[24:27], v5 offset:1024
    ds_read_b64_tr_b16 v[44:45], v11 offset:8192
    v_mfma_f32_16x16x32_bf16 v[140:143], v[64:67], v[52:55], v[140:143]
    ds_read_b64_tr_b16 v[46:47], v11 offset:12288
    ds_read_b128 v[28:31], v5 offset:3072
    v_mfma_f32_16x16x32_bf16 v[144:147], v[68:71], v[52:55], v[144:147]
    ds_read_b128 v[32:35], v5 offset:5120
    s_waitcnt lgkmcnt(8)
    ds_read_b128 v[36:39], v5 offset:7168
    v_mfma_f32_16x16x32_bf16 v[148:151], v[64:67], v[56:59], v[148:151]
    v_mfma_f32_16x16x32_bf16 v[152:155], v[68:71], v[56:59], v[152:155]
    v_mfma_f32_16x16x32_bf16 v[156:159], v[64:67], v[60:63], v[156:159]
    v_mfma_f32_16x16x32_bf16 v[160:163], v[68:71], v[60:63], v[160:163]
    s_waitcnt lgkmcnt(8)
    v_mfma_f32_16x16x32_bf16 v[132:135], v[88:91], v[72:75], v[132:135]
    v_mfma_f32_16x16x32_bf16 v[136:139], v[92:95], v[72:75], v[136:139]
    s_waitcnt lgkmcnt(0)
    s_barrier
    ds_read_b64_tr_b16 v[64:65], v8 offset:0
    ds_read_b64_tr_b16 v[66:67], v8 offset:4096
    v_mfma_f32_16x16x32_bf16 v[140:143], v[88:91], v[76:79], v[140:143]
    ds_read_b128 v[48:51], v5 offset:40960
    ds_read_b64_tr_b16 v[68:69], v9 offset:0
    v_mfma_f32_16x16x32_bf16 v[144:147], v[92:95], v[76:79], v[144:147]
    ds_read_b64_tr_b16 v[70:71], v9 offset:4096
    ds_read_b128 v[52:55], v5 offset:43008
    v_mfma_f32_16x16x32_bf16 v[148:151], v[88:91], v[80:83], v[148:151]
    ds_read_b128 v[56:59], v5 offset:45056
    ds_read_b128 v[60:63], v5 offset:47104
    v_mfma_f32_16x16x32_bf16 v[152:155], v[92:95], v[80:83], v[152:155]
    v_mfma_f32_16x16x32_bf16 v[156:159], v[88:91], v[84:87], v[156:159]
    v_mfma_f32_16x16x32_bf16 v[160:163], v[92:95], v[84:87], v[160:163]
    v_mfma_f32_16x16x32_bf16 v[132:135], v[40:43], v[24:27], v[132:135]
    ds_read_b64_tr_b16 v[88:89], v8 offset:8192
    ds_read_b64_tr_b16 v[90:91], v8 offset:12288
    v_mfma_f32_16x16x32_bf16 v[136:139], v[44:47], v[24:27], v[136:139]
    ds_read_b128 v[72:75], v5 offset:41984
    ds_read_b64_tr_b16 v[92:93], v9 offset:8192
    v_mfma_f32_16x16x32_bf16 v[140:143], v[40:43], v[28:31], v[140:143]
    ds_read_b64_tr_b16 v[94:95], v9 offset:12288
    ds_read_b128 v[76:79], v5 offset:44032
    v_mfma_f32_16x16x32_bf16 v[144:147], v[44:47], v[28:31], v[144:147]
    ds_read_b128 v[80:83], v5 offset:46080
    s_waitcnt lgkmcnt(8)
    ds_read_b128 v[84:87], v5 offset:48128
    v_mfma_f32_16x16x32_bf16 v[148:151], v[40:43], v[32:35], v[148:151]
    v_mfma_f32_16x16x32_bf16 v[152:155], v[44:47], v[32:35], v[152:155]
    v_mfma_f32_16x16x32_bf16 v[156:159], v[40:43], v[36:39], v[156:159]
    v_mfma_f32_16x16x32_bf16 v[160:163], v[44:47], v[36:39], v[160:163]
    s_waitcnt lgkmcnt(8)
    v_mfma_f32_16x16x32_bf16 v[132:135], v[64:67], v[48:51], v[132:135]
    v_mfma_f32_16x16x32_bf16 v[136:139], v[68:71], v[48:51], v[136:139]
    s_waitcnt lgkmcnt(0)
    s_barrier
    ds_read_b64_tr_b16 v[40:41], v8 offset:40960
    ds_read_b64_tr_b16 v[42:43], v8 offset:45056
    v_mfma_f32_16x16x32_bf16 v[140:143], v[64:67], v[52:55], v[140:143]
    ds_read_b128 v[24:27], v4 offset:40960
    ds_read_b64_tr_b16 v[44:45], v9 offset:40960
    v_mfma_f32_16x16x32_bf16 v[144:147], v[68:71], v[52:55], v[144:147]
    ds_read_b64_tr_b16 v[46:47], v9 offset:45056
    ds_read_b128 v[28:31], v4 offset:43008
    v_mfma_f32_16x16x32_bf16 v[148:151], v[64:67], v[56:59], v[148:151]
    ds_read_b128 v[32:35], v4 offset:45056
    ds_read_b128 v[36:39], v4 offset:47104
    v_mfma_f32_16x16x32_bf16 v[152:155], v[68:71], v[56:59], v[152:155]
    v_mfma_f32_16x16x32_bf16 v[156:159], v[64:67], v[60:63], v[156:159]
    v_mfma_f32_16x16x32_bf16 v[160:163], v[68:71], v[60:63], v[160:163]
    v_mfma_f32_16x16x32_bf16 v[132:135], v[88:91], v[72:75], v[132:135]
    ds_read_b64_tr_b16 v[64:65], v8 offset:49152
    ds_read_b64_tr_b16 v[66:67], v8 offset:53248
    v_mfma_f32_16x16x32_bf16 v[136:139], v[92:95], v[72:75], v[136:139]
    ds_read_b128 v[48:51], v4 offset:41984
    ds_read_b64_tr_b16 v[68:69], v9 offset:49152
    v_mfma_f32_16x16x32_bf16 v[140:143], v[88:91], v[76:79], v[140:143]
    ds_read_b64_tr_b16 v[70:71], v9 offset:53248
    ds_read_b128 v[52:55], v4 offset:44032
    v_mfma_f32_16x16x32_bf16 v[144:147], v[92:95], v[76:79], v[144:147]
    ds_read_b128 v[56:59], v4 offset:46080
    s_waitcnt lgkmcnt(8)
    ds_read_b128 v[60:63], v4 offset:48128
    v_mfma_f32_16x16x32_bf16 v[148:151], v[88:91], v[80:83], v[148:151]
    v_mfma_f32_16x16x32_bf16 v[152:155], v[92:95], v[80:83], v[152:155]
    v_mfma_f32_16x16x32_bf16 v[156:159], v[88:91], v[84:87], v[156:159]
    v_mfma_f32_16x16x32_bf16 v[160:163], v[92:95], v[84:87], v[160:163]
    s_waitcnt lgkmcnt(8)
    v_mfma_f32_16x16x32_bf16 v[132:135], v[40:43], v[24:27], v[132:135]
    v_mfma_f32_16x16x32_bf16 v[136:139], v[44:47], v[24:27], v[136:139]
    s_waitcnt lgkmcnt(0)
    s_barrier
    ds_read_b64_tr_b16 v[88:89], v10 offset:16384
    ds_read_b64_tr_b16 v[90:91], v10 offset:20480
    v_mfma_f32_16x16x32_bf16 v[140:143], v[40:43], v[28:31], v[140:143]
    ds_read_b128 v[72:75], v4 offset:0
    ds_read_b64_tr_b16 v[92:93], v11 offset:16384
    v_mfma_f32_16x16x32_bf16 v[144:147], v[44:47], v[28:31], v[144:147]
    ds_read_b64_tr_b16 v[94:95], v11 offset:20480
    ds_read_b128 v[76:79], v4 offset:2048
    v_mfma_f32_16x16x32_bf16 v[148:151], v[40:43], v[32:35], v[148:151]
    ds_read_b128 v[80:83], v4 offset:4096
    ds_read_b128 v[84:87], v4 offset:6144
    v_mfma_f32_16x16x32_bf16 v[152:155], v[44:47], v[32:35], v[152:155]
    v_mfma_f32_16x16x32_bf16 v[156:159], v[40:43], v[36:39], v[156:159]
    v_mfma_f32_16x16x32_bf16 v[160:163], v[44:47], v[36:39], v[160:163]
    v_mfma_f32_16x16x32_bf16 v[132:135], v[64:67], v[48:51], v[132:135]
    ds_read_b64_tr_b16 v[40:41], v10 offset:24576
    ds_read_b64_tr_b16 v[42:43], v10 offset:28672
    v_mfma_f32_16x16x32_bf16 v[136:139], v[68:71], v[48:51], v[136:139]
    ds_read_b128 v[24:27], v4 offset:1024
    ds_read_b64_tr_b16 v[44:45], v11 offset:24576
    v_mfma_f32_16x16x32_bf16 v[140:143], v[64:67], v[52:55], v[140:143]
    ds_read_b64_tr_b16 v[46:47], v11 offset:28672
    ds_read_b128 v[28:31], v4 offset:3072
    v_mfma_f32_16x16x32_bf16 v[144:147], v[68:71], v[52:55], v[144:147]
    ds_read_b128 v[32:35], v4 offset:5120
    s_waitcnt lgkmcnt(8)
    ds_read_b128 v[36:39], v4 offset:7168
    v_mfma_f32_16x16x32_bf16 v[148:151], v[64:67], v[56:59], v[148:151]
    v_mfma_f32_16x16x32_bf16 v[152:155], v[68:71], v[56:59], v[152:155]
    v_mfma_f32_16x16x32_bf16 v[156:159], v[64:67], v[60:63], v[156:159]
    v_mfma_f32_16x16x32_bf16 v[160:163], v[68:71], v[60:63], v[160:163]
    s_waitcnt lgkmcnt(8)
    v_mfma_f32_16x16x32_bf16 v[132:135], v[88:91], v[72:75], v[132:135]
    v_mfma_f32_16x16x32_bf16 v[136:139], v[92:95], v[72:75], v[136:139]
    s_waitcnt lgkmcnt(0)
    s_barrier
    ds_read_b64_tr_b16 v[64:65], v12 offset:0
    ds_read_b64_tr_b16 v[66:67], v12 offset:4096
    v_mfma_f32_16x16x32_bf16 v[140:143], v[88:91], v[76:79], v[140:143]
    ds_read_b128 v[48:51], v5 offset:0
    ds_read_b64_tr_b16 v[68:69], v13 offset:0
    v_mfma_f32_16x16x32_bf16 v[144:147], v[92:95], v[76:79], v[144:147]
    ds_read_b64_tr_b16 v[70:71], v13 offset:4096
    ds_read_b128 v[52:55], v5 offset:2048
    v_mfma_f32_16x16x32_bf16 v[148:151], v[88:91], v[80:83], v[148:151]
    ds_read_b128 v[56:59], v5 offset:4096
    ds_read_b128 v[60:63], v5 offset:6144
    v_mfma_f32_16x16x32_bf16 v[152:155], v[92:95], v[80:83], v[152:155]
    v_mfma_f32_16x16x32_bf16 v[156:159], v[88:91], v[84:87], v[156:159]
    v_mfma_f32_16x16x32_bf16 v[160:163], v[92:95], v[84:87], v[160:163]
    v_mfma_f32_16x16x32_bf16 v[132:135], v[40:43], v[24:27], v[132:135]
    ds_read_b64_tr_b16 v[88:89], v12 offset:8192
    ds_read_b64_tr_b16 v[90:91], v12 offset:12288
    v_mfma_f32_16x16x32_bf16 v[136:139], v[44:47], v[24:27], v[136:139]
    ds_read_b128 v[72:75], v5 offset:1024
    ds_read_b64_tr_b16 v[92:93], v13 offset:8192
    v_mfma_f32_16x16x32_bf16 v[140:143], v[40:43], v[28:31], v[140:143]
    ds_read_b64_tr_b16 v[94:95], v13 offset:12288
    ds_read_b128 v[76:79], v5 offset:3072
    v_mfma_f32_16x16x32_bf16 v[144:147], v[44:47], v[28:31], v[144:147]
    ds_read_b128 v[80:83], v5 offset:5120
    s_waitcnt lgkmcnt(8)
    ds_read_b128 v[84:87], v5 offset:7168
    v_mfma_f32_16x16x32_bf16 v[148:151], v[40:43], v[32:35], v[148:151]
    v_mfma_f32_16x16x32_bf16 v[152:155], v[44:47], v[32:35], v[152:155]
    v_mfma_f32_16x16x32_bf16 v[156:159], v[40:43], v[36:39], v[156:159]
    v_mfma_f32_16x16x32_bf16 v[160:163], v[44:47], v[36:39], v[160:163]
    s_waitcnt lgkmcnt(8)
    v_mfma_f32_16x16x32_bf16 v[132:135], v[64:67], v[48:51], v[132:135]
    v_mfma_f32_16x16x32_bf16 v[136:139], v[68:71], v[48:51], v[136:139]
    s_waitcnt lgkmcnt(0)
    s_barrier
    ds_read_b64_tr_b16 v[40:41], v10 offset:40960
    ds_read_b64_tr_b16 v[42:43], v10 offset:45056
    v_mfma_f32_16x16x32_bf16 v[140:143], v[64:67], v[52:55], v[140:143]
    ds_read_b128 v[24:27], v5 offset:40960
    ds_read_b64_tr_b16 v[44:45], v11 offset:40960
    v_mfma_f32_16x16x32_bf16 v[144:147], v[68:71], v[52:55], v[144:147]
    ds_read_b64_tr_b16 v[46:47], v11 offset:45056
    ds_read_b128 v[28:31], v5 offset:43008
    v_mfma_f32_16x16x32_bf16 v[148:151], v[64:67], v[56:59], v[148:151]
    ds_read_b128 v[32:35], v5 offset:45056
    ds_read_b128 v[36:39], v5 offset:47104
    v_mfma_f32_16x16x32_bf16 v[152:155], v[68:71], v[56:59], v[152:155]
    v_mfma_f32_16x16x32_bf16 v[156:159], v[64:67], v[60:63], v[156:159]
    v_mfma_f32_16x16x32_bf16 v[160:163], v[68:71], v[60:63], v[160:163]
    v_mfma_f32_16x16x32_bf16 v[132:135], v[88:91], v[72:75], v[132:135]
    ds_read_b64_tr_b16 v[64:65], v10 offset:49152
    ds_read_b64_tr_b16 v[66:67], v10 offset:53248
    v_mfma_f32_16x16x32_bf16 v[136:139], v[92:95], v[72:75], v[136:139]
    ds_read_b128 v[48:51], v5 offset:41984
    ds_read_b64_tr_b16 v[68:69], v11 offset:49152
    v_mfma_f32_16x16x32_bf16 v[140:143], v[88:91], v[76:79], v[140:143]
    ds_read_b64_tr_b16 v[70:71], v11 offset:53248
    ds_read_b128 v[52:55], v5 offset:44032
    v_mfma_f32_16x16x32_bf16 v[144:147], v[92:95], v[76:79], v[144:147]
    ds_read_b128 v[56:59], v5 offset:46080
    s_waitcnt lgkmcnt(8)
    ds_read_b128 v[60:63], v5 offset:48128
    v_mfma_f32_16x16x32_bf16 v[148:151], v[88:91], v[80:83], v[148:151]
    v_mfma_f32_16x16x32_bf16 v[152:155], v[92:95], v[80:83], v[152:155]
    v_mfma_f32_16x16x32_bf16 v[156:159], v[88:91], v[84:87], v[156:159]
    v_mfma_f32_16x16x32_bf16 v[160:163], v[92:95], v[84:87], v[160:163]
    s_waitcnt lgkmcnt(8)
    v_mfma_f32_16x16x32_bf16 v[132:135], v[40:43], v[24:27], v[132:135]
    v_mfma_f32_16x16x32_bf16 v[136:139], v[44:47], v[24:27], v[136:139]
    s_waitcnt lgkmcnt(0)
    s_barrier
    ds_read_b64_tr_b16 v[88:89], v12 offset:24576
    ds_read_b64_tr_b16 v[90:91], v12 offset:28672
    v_mfma_f32_16x16x32_bf16 v[140:143], v[40:43], v[28:31], v[140:143]
    ds_read_b128 v[72:75], v4 offset:40960
    ds_read_b64_tr_b16 v[92:93], v13 offset:24576
    v_mfma_f32_16x16x32_bf16 v[144:147], v[44:47], v[28:31], v[144:147]
    ds_read_b64_tr_b16 v[94:95], v13 offset:28672
    ds_read_b128 v[76:79], v4 offset:43008
    v_mfma_f32_16x16x32_bf16 v[148:151], v[40:43], v[32:35], v[148:151]
    ds_read_b128 v[80:83], v4 offset:45056
    ds_read_b128 v[84:87], v4 offset:47104
    v_mfma_f32_16x16x32_bf16 v[152:155], v[44:47], v[32:35], v[152:155]
    v_mfma_f32_16x16x32_bf16 v[156:159], v[40:43], v[36:39], v[156:159]
    v_mfma_f32_16x16x32_bf16 v[160:163], v[44:47], v[36:39], v[160:163]
    v_mfma_f32_16x16x32_bf16 v[132:135], v[64:67], v[48:51], v[132:135]
    ds_read_b64_tr_b16 v[40:41], v12 offset:32768
    ds_read_b64_tr_b16 v[42:43], v12 offset:36864
    v_mfma_f32_16x16x32_bf16 v[136:139], v[68:71], v[48:51], v[136:139]
    ds_read_b128 v[24:27], v4 offset:41984
    ds_read_b64_tr_b16 v[44:45], v13 offset:32768
    v_mfma_f32_16x16x32_bf16 v[140:143], v[64:67], v[52:55], v[140:143]
    ds_read_b64_tr_b16 v[46:47], v13 offset:36864
    ds_read_b128 v[28:31], v4 offset:44032
    v_mfma_f32_16x16x32_bf16 v[144:147], v[68:71], v[52:55], v[144:147]
    ds_read_b128 v[32:35], v4 offset:46080
    s_waitcnt lgkmcnt(8)
    ds_read_b128 v[36:39], v4 offset:48128
    v_mfma_f32_16x16x32_bf16 v[148:151], v[64:67], v[56:59], v[148:151]
    v_mfma_f32_16x16x32_bf16 v[152:155], v[68:71], v[56:59], v[152:155]
    v_mfma_f32_16x16x32_bf16 v[156:159], v[64:67], v[60:63], v[156:159]
    v_mfma_f32_16x16x32_bf16 v[160:163], v[68:71], v[60:63], v[160:163]
    s_waitcnt lgkmcnt(8)
    v_mfma_f32_16x16x32_bf16 v[132:135], v[88:91], v[72:75], v[132:135]
    v_mfma_f32_16x16x32_bf16 v[136:139], v[92:95], v[72:75], v[136:139]
    s_waitcnt lgkmcnt(0)
    s_barrier
    ds_read_b64_tr_b16 v[64:65], v10 offset:0
    ds_read_b64_tr_b16 v[66:67], v10 offset:4096
    v_mfma_f32_16x16x32_bf16 v[140:143], v[88:91], v[76:79], v[140:143]
    ds_read_b128 v[48:51], v4 offset:0
    ds_read_b64_tr_b16 v[68:69], v11 offset:0
    v_mfma_f32_16x16x32_bf16 v[144:147], v[92:95], v[76:79], v[144:147]
    ds_read_b64_tr_b16 v[70:71], v11 offset:4096
    ds_read_b128 v[52:55], v4 offset:2048
    v_mfma_f32_16x16x32_bf16 v[148:151], v[88:91], v[80:83], v[148:151]
    ds_read_b128 v[56:59], v4 offset:4096
    ds_read_b128 v[60:63], v4 offset:6144
    v_mfma_f32_16x16x32_bf16 v[152:155], v[92:95], v[80:83], v[152:155]
    v_mfma_f32_16x16x32_bf16 v[156:159], v[88:91], v[84:87], v[156:159]
    v_mfma_f32_16x16x32_bf16 v[160:163], v[92:95], v[84:87], v[160:163]
    v_mfma_f32_16x16x32_bf16 v[132:135], v[40:43], v[24:27], v[132:135]
    ds_read_b64_tr_b16 v[88:89], v10 offset:8192
    ds_read_b64_tr_b16 v[90:91], v10 offset:12288
    v_mfma_f32_16x16x32_bf16 v[136:139], v[44:47], v[24:27], v[136:139]
    ds_read_b128 v[72:75], v4 offset:1024
    ds_read_b64_tr_b16 v[92:93], v11 offset:8192
    v_mfma_f32_16x16x32_bf16 v[140:143], v[40:43], v[28:31], v[140:143]
    ds_read_b64_tr_b16 v[94:95], v11 offset:12288
    ds_read_b128 v[76:79], v4 offset:3072
    v_mfma_f32_16x16x32_bf16 v[144:147], v[44:47], v[28:31], v[144:147]
    ds_read_b128 v[80:83], v4 offset:5120
    s_waitcnt lgkmcnt(8)
    ds_read_b128 v[84:87], v4 offset:7168
    v_mfma_f32_16x16x32_bf16 v[148:151], v[40:43], v[32:35], v[148:151]
    v_mfma_f32_16x16x32_bf16 v[152:155], v[44:47], v[32:35], v[152:155]
    v_mfma_f32_16x16x32_bf16 v[156:159], v[40:43], v[36:39], v[156:159]
    v_mfma_f32_16x16x32_bf16 v[160:163], v[44:47], v[36:39], v[160:163]
    s_waitcnt lgkmcnt(8)
    v_mfma_f32_16x16x32_bf16 v[132:135], v[64:67], v[48:51], v[132:135]
    v_mfma_f32_16x16x32_bf16 v[136:139], v[68:71], v[48:51], v[136:139]
    s_waitcnt lgkmcnt(0)
    s_barrier
    ds_read_b64_tr_b16 v[40:41], v8 offset:0
    ds_read_b64_tr_b16 v[42:43], v8 offset:4096
    v_mfma_f32_16x16x32_bf16 v[140:143], v[64:67], v[52:55], v[140:143]
    ds_read_b128 v[24:27], v5 offset:0
    ds_read_b64_tr_b16 v[44:45], v9 offset:0
    v_mfma_f32_16x16x32_bf16 v[144:147], v[68:71], v[52:55], v[144:147]
    ds_read_b64_tr_b16 v[46:47], v9 offset:4096
    ds_read_b128 v[28:31], v5 offset:2048
    v_mfma_f32_16x16x32_bf16 v[148:151], v[64:67], v[56:59], v[148:151]
    ds_read_b128 v[32:35], v5 offset:4096
    ds_read_b128 v[36:39], v5 offset:6144
    v_mfma_f32_16x16x32_bf16 v[152:155], v[68:71], v[56:59], v[152:155]
    v_mfma_f32_16x16x32_bf16 v[156:159], v[64:67], v[60:63], v[156:159]
    v_mfma_f32_16x16x32_bf16 v[160:163], v[68:71], v[60:63], v[160:163]
    v_mfma_f32_16x16x32_bf16 v[132:135], v[88:91], v[72:75], v[132:135]
    ds_read_b64_tr_b16 v[64:65], v8 offset:8192
    ds_read_b64_tr_b16 v[66:67], v8 offset:12288
    v_mfma_f32_16x16x32_bf16 v[136:139], v[92:95], v[72:75], v[136:139]
    ds_read_b128 v[48:51], v5 offset:1024
    ds_read_b64_tr_b16 v[68:69], v9 offset:8192
    v_mfma_f32_16x16x32_bf16 v[140:143], v[88:91], v[76:79], v[140:143]
    ds_read_b64_tr_b16 v[70:71], v9 offset:12288
    ds_read_b128 v[52:55], v5 offset:3072
    v_mfma_f32_16x16x32_bf16 v[144:147], v[92:95], v[76:79], v[144:147]
    ds_read_b128 v[56:59], v5 offset:5120
    s_waitcnt lgkmcnt(8)
    ds_read_b128 v[60:63], v5 offset:7168
    v_mfma_f32_16x16x32_bf16 v[148:151], v[88:91], v[80:83], v[148:151]
    v_mfma_f32_16x16x32_bf16 v[152:155], v[92:95], v[80:83], v[152:155]
    v_mfma_f32_16x16x32_bf16 v[156:159], v[88:91], v[84:87], v[156:159]
    v_mfma_f32_16x16x32_bf16 v[160:163], v[92:95], v[84:87], v[160:163]
    s_waitcnt lgkmcnt(8)
    v_mfma_f32_16x16x32_bf16 v[132:135], v[40:43], v[24:27], v[132:135]
    v_mfma_f32_16x16x32_bf16 v[136:139], v[44:47], v[24:27], v[136:139]
    s_waitcnt lgkmcnt(0)
    s_barrier
    ds_read_b64_tr_b16 v[88:89], v8 offset:40960
    ds_read_b64_tr_b16 v[90:91], v8 offset:45056
    v_mfma_f32_16x16x32_bf16 v[140:143], v[40:43], v[28:31], v[140:143]
    ds_read_b128 v[72:75], v5 offset:40960
    ds_read_b64_tr_b16 v[92:93], v9 offset:40960
    v_mfma_f32_16x16x32_bf16 v[144:147], v[44:47], v[28:31], v[144:147]
    ds_read_b64_tr_b16 v[94:95], v9 offset:45056
    ds_read_b128 v[76:79], v5 offset:43008
    v_mfma_f32_16x16x32_bf16 v[148:151], v[40:43], v[32:35], v[148:151]
    ds_read_b128 v[80:83], v5 offset:45056
    ds_read_b128 v[84:87], v5 offset:47104
    v_mfma_f32_16x16x32_bf16 v[152:155], v[44:47], v[32:35], v[152:155]
    v_mfma_f32_16x16x32_bf16 v[156:159], v[40:43], v[36:39], v[156:159]
    v_mfma_f32_16x16x32_bf16 v[160:163], v[44:47], v[36:39], v[160:163]
    v_mfma_f32_16x16x32_bf16 v[132:135], v[64:67], v[48:51], v[132:135]
    ds_read_b64_tr_b16 v[40:41], v8 offset:49152
    ds_read_b64_tr_b16 v[42:43], v8 offset:53248
    v_mfma_f32_16x16x32_bf16 v[136:139], v[68:71], v[48:51], v[136:139]
    ds_read_b128 v[24:27], v5 offset:41984
    ds_read_b64_tr_b16 v[44:45], v9 offset:49152
    v_mfma_f32_16x16x32_bf16 v[140:143], v[64:67], v[52:55], v[140:143]
    ds_read_b64_tr_b16 v[46:47], v9 offset:53248
    ds_read_b128 v[28:31], v5 offset:44032
    v_mfma_f32_16x16x32_bf16 v[144:147], v[68:71], v[52:55], v[144:147]
    ds_read_b128 v[32:35], v5 offset:46080
    s_waitcnt lgkmcnt(8)
    ds_read_b128 v[36:39], v5 offset:48128
    v_mfma_f32_16x16x32_bf16 v[148:151], v[64:67], v[56:59], v[148:151]
    v_mfma_f32_16x16x32_bf16 v[152:155], v[68:71], v[56:59], v[152:155]
    v_mfma_f32_16x16x32_bf16 v[156:159], v[64:67], v[60:63], v[156:159]
    v_mfma_f32_16x16x32_bf16 v[160:163], v[68:71], v[60:63], v[160:163]
    s_waitcnt lgkmcnt(8)
    v_mfma_f32_16x16x32_bf16 v[132:135], v[88:91], v[72:75], v[132:135]
    v_mfma_f32_16x16x32_bf16 v[136:139], v[92:95], v[72:75], v[136:139]
    s_waitcnt lgkmcnt(0)
    s_barrier
    ds_read_b64_tr_b16 v[64:65], v10 offset:16384
    ds_read_b64_tr_b16 v[66:67], v10 offset:20480
    v_mfma_f32_16x16x32_bf16 v[140:143], v[88:91], v[76:79], v[140:143]
    ds_read_b128 v[48:51], v4 offset:40960
    ds_read_b64_tr_b16 v[68:69], v11 offset:16384
    v_mfma_f32_16x16x32_bf16 v[144:147], v[92:95], v[76:79], v[144:147]
    ds_read_b64_tr_b16 v[70:71], v11 offset:20480
    ds_read_b128 v[52:55], v4 offset:43008
    v_mfma_f32_16x16x32_bf16 v[148:151], v[88:91], v[80:83], v[148:151]
    ds_read_b128 v[56:59], v4 offset:45056
    ds_read_b128 v[60:63], v4 offset:47104
    v_mfma_f32_16x16x32_bf16 v[152:155], v[92:95], v[80:83], v[152:155]
    v_mfma_f32_16x16x32_bf16 v[156:159], v[88:91], v[84:87], v[156:159]
    v_mfma_f32_16x16x32_bf16 v[160:163], v[92:95], v[84:87], v[160:163]
    v_mfma_f32_16x16x32_bf16 v[132:135], v[40:43], v[24:27], v[132:135]
    ds_read_b64_tr_b16 v[88:89], v10 offset:24576
    ds_read_b64_tr_b16 v[90:91], v10 offset:28672
    v_mfma_f32_16x16x32_bf16 v[136:139], v[44:47], v[24:27], v[136:139]
    ds_read_b128 v[72:75], v4 offset:41984
    ds_read_b64_tr_b16 v[92:93], v11 offset:24576
    v_mfma_f32_16x16x32_bf16 v[140:143], v[40:43], v[28:31], v[140:143]
    ds_read_b64_tr_b16 v[94:95], v11 offset:28672
    ds_read_b128 v[76:79], v4 offset:44032
    v_mfma_f32_16x16x32_bf16 v[144:147], v[44:47], v[28:31], v[144:147]
    ds_read_b128 v[80:83], v4 offset:46080
    s_waitcnt lgkmcnt(8)
    ds_read_b128 v[84:87], v4 offset:48128
    v_mfma_f32_16x16x32_bf16 v[148:151], v[40:43], v[32:35], v[148:151]
    v_mfma_f32_16x16x32_bf16 v[152:155], v[44:47], v[32:35], v[152:155]
    v_mfma_f32_16x16x32_bf16 v[156:159], v[40:43], v[36:39], v[156:159]
    v_mfma_f32_16x16x32_bf16 v[160:163], v[44:47], v[36:39], v[160:163]
    s_waitcnt lgkmcnt(8)
    v_mfma_f32_16x16x32_bf16 v[132:135], v[64:67], v[48:51], v[132:135]
    v_mfma_f32_16x16x32_bf16 v[136:139], v[68:71], v[48:51], v[136:139]
    s_waitcnt lgkmcnt(0)
    s_barrier
    ds_read_b64_tr_b16 v[40:41], v12 offset:0
    ds_read_b64_tr_b16 v[42:43], v12 offset:4096
    v_mfma_f32_16x16x32_bf16 v[140:143], v[64:67], v[52:55], v[140:143]
    ds_read_b128 v[24:27], v4 offset:0
    ds_read_b64_tr_b16 v[44:45], v13 offset:0
    v_mfma_f32_16x16x32_bf16 v[144:147], v[68:71], v[52:55], v[144:147]
    ds_read_b64_tr_b16 v[46:47], v13 offset:4096
    ds_read_b128 v[28:31], v4 offset:2048
    v_mfma_f32_16x16x32_bf16 v[148:151], v[64:67], v[56:59], v[148:151]
    ds_read_b128 v[32:35], v4 offset:4096
    ds_read_b128 v[36:39], v4 offset:6144
    v_mfma_f32_16x16x32_bf16 v[152:155], v[68:71], v[56:59], v[152:155]
    v_mfma_f32_16x16x32_bf16 v[156:159], v[64:67], v[60:63], v[156:159]
    v_mfma_f32_16x16x32_bf16 v[160:163], v[68:71], v[60:63], v[160:163]
    v_mfma_f32_16x16x32_bf16 v[132:135], v[88:91], v[72:75], v[132:135]
    ds_read_b64_tr_b16 v[64:65], v12 offset:8192
    ds_read_b64_tr_b16 v[66:67], v12 offset:12288
    v_mfma_f32_16x16x32_bf16 v[136:139], v[92:95], v[72:75], v[136:139]
    ds_read_b128 v[48:51], v4 offset:1024
    ds_read_b64_tr_b16 v[68:69], v13 offset:8192
    v_mfma_f32_16x16x32_bf16 v[140:143], v[88:91], v[76:79], v[140:143]
    ds_read_b64_tr_b16 v[70:71], v13 offset:12288
    ds_read_b128 v[52:55], v4 offset:3072
    v_mfma_f32_16x16x32_bf16 v[144:147], v[92:95], v[76:79], v[144:147]
    ds_read_b128 v[56:59], v4 offset:5120
    s_waitcnt lgkmcnt(8)
    ds_read_b128 v[60:63], v4 offset:7168
    v_mfma_f32_16x16x32_bf16 v[148:151], v[88:91], v[80:83], v[148:151]
    v_mfma_f32_16x16x32_bf16 v[152:155], v[92:95], v[80:83], v[152:155]
    v_mfma_f32_16x16x32_bf16 v[156:159], v[88:91], v[84:87], v[156:159]
    v_mfma_f32_16x16x32_bf16 v[160:163], v[92:95], v[84:87], v[160:163]
    s_waitcnt lgkmcnt(8)
    v_mfma_f32_16x16x32_bf16 v[132:135], v[40:43], v[24:27], v[132:135]
    v_mfma_f32_16x16x32_bf16 v[136:139], v[44:47], v[24:27], v[136:139]
    s_waitcnt lgkmcnt(0)
    s_barrier
    ds_read_b64_tr_b16 v[88:89], v10 offset:40960
    ds_read_b64_tr_b16 v[90:91], v10 offset:45056
    v_mfma_f32_16x16x32_bf16 v[140:143], v[40:43], v[28:31], v[140:143]
    ds_read_b128 v[72:75], v5 offset:0
    ds_read_b64_tr_b16 v[92:93], v11 offset:40960
    v_mfma_f32_16x16x32_bf16 v[144:147], v[44:47], v[28:31], v[144:147]
    ds_read_b64_tr_b16 v[94:95], v11 offset:45056
    ds_read_b128 v[76:79], v5 offset:2048
    v_mfma_f32_16x16x32_bf16 v[148:151], v[40:43], v[32:35], v[148:151]
    ds_read_b128 v[80:83], v5 offset:4096
    ds_read_b128 v[84:87], v5 offset:6144
    v_mfma_f32_16x16x32_bf16 v[152:155], v[44:47], v[32:35], v[152:155]
    v_mfma_f32_16x16x32_bf16 v[156:159], v[40:43], v[36:39], v[156:159]
    v_mfma_f32_16x16x32_bf16 v[160:163], v[44:47], v[36:39], v[160:163]
    v_mfma_f32_16x16x32_bf16 v[132:135], v[64:67], v[48:51], v[132:135]
    ds_read_b64_tr_b16 v[40:41], v10 offset:49152
    ds_read_b64_tr_b16 v[42:43], v10 offset:53248
    v_mfma_f32_16x16x32_bf16 v[136:139], v[68:71], v[48:51], v[136:139]
    ds_read_b128 v[24:27], v5 offset:1024
    ds_read_b64_tr_b16 v[44:45], v11 offset:49152
    v_mfma_f32_16x16x32_bf16 v[140:143], v[64:67], v[52:55], v[140:143]
    ds_read_b64_tr_b16 v[46:47], v11 offset:53248
    ds_read_b128 v[28:31], v5 offset:3072
    v_mfma_f32_16x16x32_bf16 v[144:147], v[68:71], v[52:55], v[144:147]
    ds_read_b128 v[32:35], v5 offset:5120
    s_waitcnt lgkmcnt(8)
    ds_read_b128 v[36:39], v5 offset:7168
    v_mfma_f32_16x16x32_bf16 v[148:151], v[64:67], v[56:59], v[148:151]
    v_mfma_f32_16x16x32_bf16 v[152:155], v[68:71], v[56:59], v[152:155]
    v_mfma_f32_16x16x32_bf16 v[156:159], v[64:67], v[60:63], v[156:159]
    v_mfma_f32_16x16x32_bf16 v[160:163], v[68:71], v[60:63], v[160:163]
    s_waitcnt lgkmcnt(8)
    v_mfma_f32_16x16x32_bf16 v[132:135], v[88:91], v[72:75], v[132:135]
    v_mfma_f32_16x16x32_bf16 v[136:139], v[92:95], v[72:75], v[136:139]
    s_waitcnt lgkmcnt(0)
    s_barrier
    ds_read_b64_tr_b16 v[64:65], v12 offset:24576
    ds_read_b64_tr_b16 v[66:67], v12 offset:28672
    v_mfma_f32_16x16x32_bf16 v[140:143], v[88:91], v[76:79], v[140:143]
    ds_read_b128 v[48:51], v5 offset:40960
    ds_read_b64_tr_b16 v[68:69], v13 offset:24576
    v_mfma_f32_16x16x32_bf16 v[144:147], v[92:95], v[76:79], v[144:147]
    ds_read_b64_tr_b16 v[70:71], v13 offset:28672
    ds_read_b128 v[52:55], v5 offset:43008
    v_mfma_f32_16x16x32_bf16 v[148:151], v[88:91], v[80:83], v[148:151]
    ds_read_b128 v[56:59], v5 offset:45056
    ds_read_b128 v[60:63], v5 offset:47104
    v_mfma_f32_16x16x32_bf16 v[152:155], v[92:95], v[80:83], v[152:155]
    v_mfma_f32_16x16x32_bf16 v[156:159], v[88:91], v[84:87], v[156:159]
    v_mfma_f32_16x16x32_bf16 v[160:163], v[92:95], v[84:87], v[160:163]
    v_mfma_f32_16x16x32_bf16 v[132:135], v[40:43], v[24:27], v[132:135]
    ds_read_b64_tr_b16 v[88:89], v12 offset:32768
    ds_read_b64_tr_b16 v[90:91], v12 offset:36864
    v_mfma_f32_16x16x32_bf16 v[136:139], v[44:47], v[24:27], v[136:139]
    ds_read_b128 v[72:75], v5 offset:41984
    ds_read_b64_tr_b16 v[92:93], v13 offset:32768
    v_mfma_f32_16x16x32_bf16 v[140:143], v[40:43], v[28:31], v[140:143]
    ds_read_b64_tr_b16 v[94:95], v13 offset:36864
    ds_read_b128 v[76:79], v5 offset:44032
    v_mfma_f32_16x16x32_bf16 v[144:147], v[44:47], v[28:31], v[144:147]
    ds_read_b128 v[80:83], v5 offset:46080
    s_waitcnt lgkmcnt(8)
    ds_read_b128 v[84:87], v5 offset:48128
    v_mfma_f32_16x16x32_bf16 v[148:151], v[40:43], v[32:35], v[148:151]
    v_mfma_f32_16x16x32_bf16 v[152:155], v[44:47], v[32:35], v[152:155]
    v_mfma_f32_16x16x32_bf16 v[156:159], v[40:43], v[36:39], v[156:159]
    v_mfma_f32_16x16x32_bf16 v[160:163], v[44:47], v[36:39], v[160:163]
    s_waitcnt lgkmcnt(8)
    v_mfma_f32_16x16x32_bf16 v[132:135], v[64:67], v[48:51], v[132:135]
    v_mfma_f32_16x16x32_bf16 v[136:139], v[68:71], v[48:51], v[136:139]
    s_waitcnt lgkmcnt(0)
    s_barrier
    ds_read_b64_tr_b16 v[40:41], v10 offset:0
    ds_read_b64_tr_b16 v[42:43], v10 offset:4096
    v_mfma_f32_16x16x32_bf16 v[140:143], v[64:67], v[52:55], v[140:143]
    ds_read_b128 v[24:27], v4 offset:40960
    ds_read_b64_tr_b16 v[44:45], v11 offset:0
    v_mfma_f32_16x16x32_bf16 v[144:147], v[68:71], v[52:55], v[144:147]
    ds_read_b64_tr_b16 v[46:47], v11 offset:4096
    ds_read_b128 v[28:31], v4 offset:43008
    v_mfma_f32_16x16x32_bf16 v[148:151], v[64:67], v[56:59], v[148:151]
    ds_read_b128 v[32:35], v4 offset:45056
    ds_read_b128 v[36:39], v4 offset:47104
    v_mfma_f32_16x16x32_bf16 v[152:155], v[68:71], v[56:59], v[152:155]
    v_mfma_f32_16x16x32_bf16 v[156:159], v[64:67], v[60:63], v[156:159]
    v_mfma_f32_16x16x32_bf16 v[160:163], v[68:71], v[60:63], v[160:163]
    v_mfma_f32_16x16x32_bf16 v[132:135], v[88:91], v[72:75], v[132:135]
    ds_read_b64_tr_b16 v[64:65], v10 offset:8192
    ds_read_b64_tr_b16 v[66:67], v10 offset:12288
    v_mfma_f32_16x16x32_bf16 v[136:139], v[92:95], v[72:75], v[136:139]
    ds_read_b128 v[48:51], v4 offset:41984
    ds_read_b64_tr_b16 v[68:69], v11 offset:8192
    v_mfma_f32_16x16x32_bf16 v[140:143], v[88:91], v[76:79], v[140:143]
    ds_read_b64_tr_b16 v[70:71], v11 offset:12288
    ds_read_b128 v[52:55], v4 offset:44032
    v_mfma_f32_16x16x32_bf16 v[144:147], v[92:95], v[76:79], v[144:147]
    ds_read_b128 v[56:59], v4 offset:46080
    s_waitcnt lgkmcnt(8)
    ds_read_b128 v[60:63], v4 offset:48128
    v_mfma_f32_16x16x32_bf16 v[148:151], v[88:91], v[80:83], v[148:151]
    v_mfma_f32_16x16x32_bf16 v[152:155], v[92:95], v[80:83], v[152:155]
    v_mfma_f32_16x16x32_bf16 v[156:159], v[88:91], v[84:87], v[156:159]
    v_mfma_f32_16x16x32_bf16 v[160:163], v[92:95], v[84:87], v[160:163]
    s_waitcnt lgkmcnt(0)
    s_cmp_eq_u32 s77, 0
    s_cbranch_scc0 F_y
F_fin:
    v_mfma_f32_16x16x32_bf16 v[132:135], v[40:43], v[24:27], v[132:135]
    v_mfma_f32_16x16x32_bf16 v[136:139], v[44:47], v[24:27], v[136:139]
    v_mfma_f32_16x16x32_bf16 v[132:135], v[64:67], v[48:51], v[132:135]
    v_mfma_f32_16x16x32_bf16 v[136:139], v[68:71], v[48:51], v[136:139]
    v_mfma_f32_16x16x32_bf16 v[140:143], v[40:43], v[28:31], v[140:143]
    v_mfma_f32_16x16x32_bf16 v[144:147], v[44:47], v[28:31], v[144:147]
    s_nop 5
    v_permlane16_swap_b32 v132, v136
    v_permlane16_swap_b32 v133, v137
    v_permlane16_swap_b32 v134, v138
    v_mfma_f32_16x16x32_bf16 v[140:143], v[64:67], v[52:55], v[140:143]
    v_permlane16_swap_b32 v135, v139
    v_cvt_pk_bf16_f32 v96, v132, v133
    v_cvt_pk_bf16_f32 v97, v134, v135
    v_mfma_f32_16x16x32_bf16 v[144:147], v[68:71], v[52:55], v[144:147]
    v_cvt_pk_bf16_f32 v98, v136, v137
    v_cvt_pk_bf16_f32 v99, v138, v139
    s_add_u32 s44, s42, 0
    buffer_store_dwordx4 v[96:99], v167, s[52:55], s44 offen sc1
    v_mfma_f32_16x16x32_bf16 v[148:151], v[40:43], v[32:35], v[148:151]
    v_mfma_f32_16x16x32_bf16 v[152:155], v[44:47], v[32:35], v[152:155]
    s_nop 1
    v_permlane16_swap_b32 v140, v144
    v_permlane16_swap_b32 v141, v145
    v_permlane16_swap_b32 v142, v146
    v_mfma_f32_16x16x32_bf16 v[148:151], v[64:67], v[56:59], v[148:151]
    v_permlane16_swap_b32 v143, v147
    v_cvt_pk_bf16_f32 v100, v140, v141
    v_cvt_pk_bf16_f32 v101, v142, v143
    v_mfma_f32_16x16x32_bf16 v[152:155], v[68:71], v[56:59], v[152:155]
    v_cvt_pk_bf16_f32 v102, v144, v145
    v_cvt_pk_bf16_f32 v103, v146, v147
    s_add_u32 s44, s42, 32768
    buffer_store_dwordx4 v[100:103], v167, s[52:55], s44 offen sc1
    v_mfma_f32_16x16x32_bf16 v[156:159], v[40:43], v[36:39], v[156:159]
    v_mfma_f32_16x16x32_bf16 v[160:163], v[44:47], v[36:39], v[160:163]
    s_nop 1
    v_permlane16_swap_b32 v148, v152
    v_permlane16_swap_b32 v149, v153
    v_permlane16_swap_b32 v150, v154
    v_mfma_f32_16x16x32_bf16 v[156:159], v[64:67], v[60:63], v[156:159]
    v_permlane16_swap_b32 v151, v155
    v_cvt_pk_bf16_f32 v104, v148, v149
    v_cvt_pk_bf16_f32 v105, v150, v151
    v_mfma_f32_16x16x32_bf16 v[160:163], v[68:71], v[60:63], v[160:163]
    v_cvt_pk_bf16_f32 v106, v152, v153
    v_cvt_pk_bf16_f32 v107, v154, v155
    s_add_u32 s44, s42, 65536
    buffer_store_dwordx4 v[104:107], v167, s[52:55], s44 offen sc1
    s_nop 3
    v_permlane16_swap_b32 v156, v160
    v_permlane16_swap_b32 v157, v161
    v_permlane16_swap_b32 v158, v162
    v_permlane16_swap_b32 v159, v163
    v_cvt_pk_bf16_f32 v108, v156, v157
    v_cvt_pk_bf16_f32 v109, v158, v159
    v_cvt_pk_bf16_f32 v110, v160, v161
    v_cvt_pk_bf16_f32 v111, v162, v163
    s_add_u32 s44, s42, 98304
    buffer_store_dwordx4 v[108:111], v167, s[52:55], s44 offen sc1
F_end:
    s_endpgm
F_y:
    s_nop 0
    ds_read_b32 v7, v6
    ds_read_b128 v[72:75], v128 offset:0
    ds_read_b128 v[76:79], v128 offset:64
    ds_read_b128 v[80:83], v129 offset:0
    ds_read_b128 v[84:87], v129 offset:64
    ds_read_b128 v[88:91], v130 offset:0
    ds_read_b128 v[92:95], v130 offset:64
    ds_read_b128 v[96:99], v131 offset:0
    ds_read_b128 v[100:103], v131 offset:64
    s_waitcnt lgkmcnt(8)
    v_cmp_gt_u32 vcc, 9, v7
    s_waitcnt lgkmcnt(0)
    s_cbranch_vccnz F_y
    s_mov_b64 exec, s[60:61]
    v_fmac_f32 v132, v72, v14
    v_fmac_f32 v133, v73, v14
    v_fmac_f32 v134, v74, v14
    v_fmac_f32 v135, v75, v14
    v_fmac_f32 v136, v76, v14
    v_fmac_f32 v137, v77, v14
    v_fmac_f32 v138, v78, v14
    v_fmac_f32 v139, v79, v14
    s_mov_b64 exec, s[62:63]
    v_fmac_f32 v140, v80, v15
    v_fmac_f32 v141, v81, v15
    v_fmac_f32 v142, v82, v15
    v_fmac_f32 v143, v83, v15
    v_fmac_f32 v144, v84, v15
    v_fmac_f32 v145, v85, v15
    v_fmac_f32 v146, v86, v15
    v_fmac_f32 v147, v87, v15
    s_mov_b64 exec, s[64:65]
    v_fmac_f32 v148, v88, v16
    v_fmac_f32 v149, v89, v16
    v_fmac_f32 v150, v90, v16
    v_fmac_f32 v151, v91, v16
    v_fmac_f32 v152, v92, v16
    v_fmac_f32 v153, v93, v16
    v_fmac_f32 v154, v94, v16
    v_fmac_f32 v155, v95, v16
    s_mov_b64 exec, s[66:67]
    v_fmac_f32 v156, v96, v17
    v_fmac_f32 v157, v97, v17
    v_fmac_f32 v158, v98, v17
    v_fmac_f32 v159, v99, v17
    v_fmac_f32 v160, v100, v17
    v_fmac_f32 v161, v101, v17
    v_fmac_f32 v162, v102, v17
    v_fmac_f32 v163, v103, v17
    s_mov_b64 exec, -1
    s_nop 1
    s_branch F_fin
F_ys:
    s_mov_b32 s48, 0xbfb8aa3b
    s_lshl_b32 s44, s3, 7
    s_add_u32 s44, s44, 27648
    v_and_or_b32 v63, v0, 48, s44
    v_mov_b32 v6, 24736

    v_cmp_ne_u32 s[60:61], 0, v128
    v_and_b32 v14, 0xffff0000, v128
    v_ashrrev_i32 v7, 31, v14
    v_not_b32 v7, v7
    v_or_b32 v7, 0x80000000, v7
    v_xor_b32 v14, v14, v7
    v_and_b32 v14, 0xffff0000, v14
    v_mul_f32 v14, s48, v14
    v_exp_f32 v14, v14
    s_nop 0
    v_add_f32 v14, 1.0, v14
    v_rcp_f32 v14, v14
    s_nop 0
    v_cvt_pk_bf16_f32 v14, v14, v14
    v_lshlrev_b32 v14, 16, v14
    v_bfe_u32 v128, v128, 11, 3
    v_lshl_add_u32 v128, v128, 9, v63
    v_cmp_ne_u32 s[62:63], 0, v129
    v_and_b32 v15, 0xffff0000, v129
    v_ashrrev_i32 v7, 31, v15
    v_not_b32 v7, v7
    v_or_b32 v7, 0x80000000, v7
    v_xor_b32 v15, v15, v7
    v_and_b32 v15, 0xffff0000, v15
    v_mul_f32 v15, s48, v15
    v_exp_f32 v15, v15
    s_nop 0
    v_add_f32 v15, 1.0, v15
    v_rcp_f32 v15, v15
    s_nop 0
    v_cvt_pk_bf16_f32 v15, v15, v15
    v_lshlrev_b32 v15, 16, v15
    v_bfe_u32 v129, v129, 11, 3
    v_lshl_add_u32 v129, v129, 9, v63
    v_cmp_ne_u32 s[64:65], 0, v130
    v_and_b32 v16, 0xffff0000, v130
    v_ashrrev_i32 v7, 31, v16
    v_not_b32 v7, v7
    v_or_b32 v7, 0x80000000, v7
    v_xor_b32 v16, v16, v7
    v_and_b32 v16, 0xffff0000, v16
    v_mul_f32 v16, s48, v16
    v_exp_f32 v16, v16
    s_nop 0
    v_add_f32 v16, 1.0, v16
    v_rcp_f32 v16, v16
    s_nop 0
    v_cvt_pk_bf16_f32 v16, v16, v16
    v_lshlrev_b32 v16, 16, v16
    v_bfe_u32 v130, v130, 11, 3
    v_lshl_add_u32 v130, v130, 9, v63
    v_cmp_ne_u32 s[66:67], 0, v131
    v_and_b32 v17, 0xffff0000, v131
    v_ashrrev_i32 v7, 31, v17
    v_not_b32 v7, v7
    v_or_b32 v7, 0x80000000, v7
    v_xor_b32 v17, v17, v7
    v_and_b32 v17, 0xffff0000, v17
    v_mul_f32 v17, s48, v17
    v_exp_f32 v17, v17
    s_nop 0
    v_add_f32 v17, 1.0, v17
    v_rcp_f32 v17, v17
    s_nop 0
    v_cvt_pk_bf16_f32 v17, v17, v17
    v_lshlrev_b32 v17, 16, v17
    v_bfe_u32 v131, v131, 11, 3
    v_lshl_add_u32 v131, v131, 9, v63
    s_branch F_ys1
F_loader:
    s_mov_b32 s48, 0x76542130
    s_mov_b32 s49, 0xfedca9b8
    s_cmp_eq_u32 s35, 1
    s_cselect_b32 s48, 0x75463021, s48
    s_cselect_b32 s49, 0xfdceba98, s49
    s_cmp_eq_u32 s35, 2
    s_cselect_b32 s48, 0x96543102, s48
    s_cselect_b32 s49, 0xfedcba87, s49
    s_cmp_eq_u32 s35, 3
    s_cselect_b32 s48, 0x76532410, s48
    s_cselect_b32 s49, 0xfedbac98, s49
    s_cmp_eq_u32 s35, 4
    s_cselect_b32 s48, 0x65743021, s48
    s_cselect_b32 s49, 0xedfcba98, s49
    s_cmp_eq_u32 s35, 5
    s_cselect_b32 s48, 0x76543102, s48
    s_cselect_b32 s49, 0xfedcb98a, s49
    s_cmp_eq_u32 s35, 6
    s_cselect_b32 s48, 0x76435210, s48
    s_cselect_b32 s49, 0xfecbda98, s49
    s_cmp_eq_u32 s35, 7
    s_cselect_b32 s48, 0x68543021, s48
    s_cselect_b32 s49, 0xfedcba97, s49
    s_setprio 0
    s_sub_u32 s3, s3, 8
    v_lshrrev_b32 v2, 3, v0
    v_and_b32 v3, 7, v0
    v_lshrrev_b32 v4, 1, v2
    v_xor_b32 v5, v3, v4
    v_xor_b32 v6, 4, v5
    v_lshlrev_b32 v5, 4, v5
    v_lshlrev_b32 v6, 4, v6
    v_lshlrev_b32 v7, 11, v2
    v_add_u32 v12, v5, v7
    v_add_u32 v13, v6, v7
    v_and_b32 v4, 1, v4
    v_lshlrev_b32 v4, 1, v4
    v_xor_b32 v8, v3, v4
    v_xor_b32 v9, 4, v8
    v_lshlrev_b32 v8, 4, v8
    v_lshlrev_b32 v9, 4, v9
    v_mul_u32_u24 v7, 6144, v2
    v_add_u32 v14, v8, v7
    v_add_u32 v15, v9, v7
    s_lshl_b32 s36, s32, 18
    s_lshl_b32 s37, s3, 16
    s_add_u32 s36, s36, s37
    s_lshl_b32 s38, s33, 7
    s_mul_i32 s37, s3, 98304
    s_add_u32 s38, s38, s37
    s_sub_u32 s47, s10, s33
    s_lshl_b32 s47, s47, 7
    s_and_b32 s42, s39, 8
    s_and_b32 s43, s30, 6
    s_or_b32 s42, s42, s43
    s_and_b32 s43, s34, 0
    s_lshl_b32 s43, s43, 0
    s_xor_b32 s42, s42, s43
    s_lshl_b32 s44, s3, 12
    s_lshl_b32 s45, s3, 11
    s_waitcnt lgkmcnt(0)
    s_mov_b32 s12, s4
    s_mov_b32 s13, s5
    s_mov_b32 s14, 0x400000
    s_mov_b32 s15, 0x00020000
    s_mov_b32 s16, s6
    s_mov_b32 s17, s7
    s_mov_b32 s18, 0x600000
    s_mov_b32 s19, 0x00020000
    s_bfe_u32 s40, s48, 0x40000
    s_bitcmp1_b32 s40, 3
    s_cselect_b32 s41, s39, s42
    s_xor_b32 s40, s40, s41
    s_mul_i32 s41, s40, 393216
    s_add_u32 s41, s41, s38
    s_lshl_b32 s40, s40, 7
    s_add_u32 s40, s40, s36
    s_add_u32 m0, s44, 0
    s_add_u32 s46, s40, 0
    buffer_load_dwordx4 v12, s[12:15], s46 offen lds
    s_add_u32 m0, s45, 24576
    s_add_u32 s46, s41, 2048
    buffer_load_dwordx4 v14, s[16:19], s46 offen lds
    s_add_u32 m0, s45, 25600
    s_add_u32 s46, s41, 51200
    buffer_load_dwordx4 v15, s[16:19], s46 offen lds
    s_add_u32 m0, s45, 16384
    s_add_u32 s46, s41, 0
    s_add_u32 s46, s46, s47
    buffer_load_dwordx4 v14, s[16:19], s46 offen lds
    s_add_u32 m0, s45, 17408
    s_add_u32 s46, s41, 49152
    s_add_u32 s46, s46, s47
    s_nop 0
    buffer_load_dwordx4 v15, s[16:19], s46 offen lds
    s_add_u32 m0, s45, 32768
    s_add_u32 s46, s41, 4096
    buffer_load_dwordx4 v14, s[16:19], s46 offen lds
    s_add_u32 m0, s45, 33792
    s_add_u32 s46, s41, 53248
    buffer_load_dwordx4 v15, s[16:19], s46 offen lds
    s_add_u32 m0, s44, 1024
    s_add_u32 s46, s40, 16384
    buffer_load_dwordx4 v13, s[12:15], s46 offen lds
    s_add_u32 m0, s44, 2048
    s_add_u32 s46, s40, 32768
    buffer_load_dwordx4 v12, s[12:15], s46 offen lds
    s_add_u32 m0, s44, 3072
    s_add_u32 s46, s40, 49152
    buffer_load_dwordx4 v13, s[12:15], s46 offen lds
    s_bfe_u32 s40, s48, 0x40004
    s_bitcmp1_b32 s40, 3
    s_cselect_b32 s41, s39, s42
    s_xor_b32 s40, s40, s41
    s_mul_i32 s41, s40, 393216
    s_add_u32 s41, s41, s38
    s_lshl_b32 s40, s40, 7
    s_add_u32 s40, s40, s36
    s_add_u32 m0, s44, 40960
    s_add_u32 s46, s40, 0
    s_nop 0
    buffer_load_dwordx4 v12, s[12:15], s46 offen lds
    s_add_u32 m0, s45, 65536
    s_add_u32 s46, s41, 2048
    buffer_load_dwordx4 v14, s[16:19], s46 offen lds
    s_add_u32 m0, s45, 66560
    s_add_u32 s46, s41, 51200
    buffer_load_dwordx4 v15, s[16:19], s46 offen lds
    s_add_u32 m0, s45, 57344
    s_add_u32 s46, s41, 0
    s_add_u32 s46, s46, s47
    buffer_load_dwordx4 v14, s[16:19], s46 offen lds
    s_add_u32 m0, s45, 58368
    s_add_u32 s46, s41, 49152
    s_add_u32 s46, s46, s47
    s_nop 0
    buffer_load_dwordx4 v15, s[16:19], s46 offen lds
    s_add_u32 m0, s45, 73728
    s_add_u32 s46, s41, 4096
    buffer_load_dwordx4 v14, s[16:19], s46 offen lds
    s_add_u32 m0, s45, 74752
    s_add_u32 s46, s41, 53248
    buffer_load_dwordx4 v15, s[16:19], s46 offen lds
    s_add_u32 m0, s44, 41984
    s_add_u32 s46, s40, 16384
    buffer_load_dwordx4 v13, s[12:15], s46 offen lds
    s_waitcnt vmcnt(8)
    s_barrier
    s_add_u32 m0, s44, 43008
    s_add_u32 s46, s40, 32768
    buffer_load_dwordx4 v12, s[12:15], s46 offen lds
    s_add_u32 m0, s44, 44032
    s_add_u32 s46, s40, 49152
    buffer_load_dwordx4 v13, s[12:15], s46 offen lds
    s_bfe_u32 s40, s48, 0x40008
    s_bitcmp1_b32 s40, 3
    s_cselect_b32 s41, s39, s42
    s_xor_b32 s40, s40, s41
    s_mul_i32 s41, s40, 393216
    s_add_u32 s41, s41, s38
    s_lshl_b32 s40, s40, 7
    s_add_u32 s40, s40, s36
    s_add_u32 m0, s44, 81920
    s_add_u32 s46, s40, 0
    s_nop 0
    buffer_load_dwordx4 v12, s[12:15], s46 offen lds
    s_add_u32 m0, s45, 106496
    s_add_u32 s46, s41, 2048
    buffer_load_dwordx4 v14, s[16:19], s46 offen lds
    s_add_u32 m0, s45, 107520
    s_add_u32 s46, s41, 51200
    buffer_load_dwordx4 v15, s[16:19], s46 offen lds
    s_add_u32 m0, s45, 98304
    s_add_u32 s46, s41, 0
    s_add_u32 s46, s46, s47
    buffer_load_dwordx4 v14, s[16:19], s46 offen lds
    s_add_u32 m0, s45, 99328
    s_add_u32 s46, s41, 49152
    s_add_u32 s46, s46, s47
    s_nop 0
    buffer_load_dwordx4 v15, s[16:19], s46 offen lds
    s_add_u32 m0, s45, 114688
    s_add_u32 s46, s41, 4096
    buffer_load_dwordx4 v14, s[16:19], s46 offen lds
    s_add_u32 m0, s45, 115712
    s_add_u32 s46, s41, 53248
    buffer_load_dwordx4 v15, s[16:19], s46 offen lds
    s_add_u32 m0, s44, 82944
    s_add_u32 s46, s40, 16384
    buffer_load_dwordx4 v13, s[12:15], s46 offen lds
    s_add_u32 m0, s44, 83968
    s_add_u32 s46, s40, 32768
    buffer_load_dwordx4 v12, s[12:15], s46 offen lds
    s_add_u32 m0, s44, 84992
    s_add_u32 s46, s40, 49152
    buffer_load_dwordx4 v13, s[12:15], s46 offen lds
    s_waitcnt vmcnt(10)
    s_barrier
    s_bfe_u32 s40, s48, 0x4000c
    s_bitcmp1_b32 s40, 3
    s_cselect_b32 s41, s39, s42
    s_xor_b32 s40, s40, s41
    s_mul_i32 s41, s40, 393216
    s_add_u32 s41, s41, s38
    s_lshl_b32 s40, s40, 7
    s_add_u32 s40, s40, s36
    s_add_u32 m0, s44, 122880
    s_add_u32 s46, s40, 0
    s_nop 0
    buffer_load_dwordx4 v12, s[12:15], s46 offen lds
    s_add_u32 m0, s45, 147456
    s_add_u32 s46, s41, 2048
    buffer_load_dwordx4 v14, s[16:19], s46 offen lds
    s_add_u32 m0, s45, 148480
    s_add_u32 s46, s41, 51200
    buffer_load_dwordx4 v15, s[16:19], s46 offen lds
    s_add_u32 m0, s45, 139264
    s_add_u32 s46, s41, 0
    s_add_u32 s46, s46, s47
    buffer_load_dwordx4 v14, s[16:19], s46 offen lds
    s_add_u32 m0, s45, 140288
    s_add_u32 s46, s41, 49152
    s_add_u32 s46, s46, s47
    s_nop 0
    buffer_load_dwordx4 v15, s[16:19], s46 offen lds
    s_add_u32 m0, s45, 155648
    s_add_u32 s46, s41, 4096
    buffer_load_dwordx4 v14, s[16:19], s46 offen lds
    s_add_u32 m0, s45, 156672
    s_add_u32 s46, s41, 53248
    buffer_load_dwordx4 v15, s[16:19], s46 offen lds
    s_add_u32 m0, s44, 123904
    s_add_u32 s46, s40, 16384
    buffer_load_dwordx4 v13, s[12:15], s46 offen lds
    s_add_u32 m0, s44, 124928
    s_add_u32 s46, s40, 32768
    buffer_load_dwordx4 v12, s[12:15], s46 offen lds
    s_add_u32 m0, s44, 125952
    s_add_u32 s46, s40, 49152
    buffer_load_dwordx4 v13, s[12:15], s46 offen lds
    s_bfe_u32 s40, s48, 0x40010
    s_bitcmp1_b32 s40, 3
    s_cselect_b32 s41, s39, s42
    s_xor_b32 s40, s40, s41
    s_mul_i32 s41, s40, 393216
    s_add_u32 s41, s41, s38
    s_lshl_b32 s40, s40, 7
    s_add_u32 s40, s40, s36
    s_add_u32 m0, s44, 0
    s_add_u32 s46, s40, 0
    buffer_load_dwordx4 v12, s[12:15], s46 offen lds
    s_add_u32 m0, s45, 24576
    s_add_u32 s46, s41, 2048
    buffer_load_dwordx4 v14, s[16:19], s46 offen lds
    s_waitcnt vmcnt(12)
    s_barrier
    s_add_u32 m0, s45, 25600
    s_add_u32 s46, s41, 51200
    buffer_load_dwordx4 v15, s[16:19], s46 offen lds
    s_add_u32 m0, s45, 16384
    s_add_u32 s46, s41, 0
    s_add_u32 s46, s46, s47
    buffer_load_dwordx4 v14, s[16:19], s46 offen lds
    s_add_u32 m0, s45, 17408
    s_add_u32 s46, s41, 49152
    s_add_u32 s46, s46, s47
    s_nop 0
    buffer_load_dwordx4 v15, s[16:19], s46 offen lds
    s_add_u32 m0, s45, 32768
    s_add_u32 s46, s41, 4096
    buffer_load_dwordx4 v14, s[16:19], s46 offen lds
    s_add_u32 m0, s45, 33792
    s_add_u32 s46, s41, 53248
    buffer_load_dwordx4 v15, s[16:19], s46 offen lds
    s_add_u32 m0, s44, 1024
    s_add_u32 s46, s40, 16384
    buffer_load_dwordx4 v13, s[12:15], s46 offen lds
    s_add_u32 m0, s44, 2048
    s_add_u32 s46, s40, 32768
    buffer_load_dwordx4 v12, s[12:15], s46 offen lds
    s_add_u32 m0, s44, 3072
    s_add_u32 s46, s40, 49152
    buffer_load_dwordx4 v13, s[12:15], s46 offen lds
    s_bfe_u32 s40, s48, 0x40014
    s_bitcmp1_b32 s40, 3
    s_cselect_b32 s41, s39, s42
    s_xor_b32 s40, s40, s41
    s_mul_i32 s41, s40, 393216
    s_add_u32 s41, s41, s38
    s_lshl_b32 s40, s40, 7
    s_add_u32 s40, s40, s36
    s_add_u32 m0, s44, 40960
    s_add_u32 s46, s40, 0
    s_nop 0
    buffer_load_dwordx4 v12, s[12:15], s46 offen lds
    s_add_u32 m0, s45, 65536
    s_add_u32 s46, s41, 2048
    buffer_load_dwordx4 v14, s[16:19], s46 offen lds
    s_add_u32 m0, s45, 66560
    s_add_u32 s46, s41, 51200
    buffer_load_dwordx4 v15, s[16:19], s46 offen lds
    s_add_u32 m0, s45, 57344
    s_add_u32 s46, s41, 0
    s_add_u32 s46, s46, s47
    buffer_load_dwordx4 v14, s[16:19], s46 offen lds
    s_waitcnt vmcnt(14)
    s_barrier
    s_add_u32 m0, s45, 58368
    s_add_u32 s46, s41, 49152
    s_add_u32 s46, s46, s47
    s_nop 0
    buffer_load_dwordx4 v15, s[16:19], s46 offen lds
    s_add_u32 m0, s45, 73728
    s_add_u32 s46, s41, 4096
    buffer_load_dwordx4 v14, s[16:19], s46 offen lds
    s_add_u32 m0, s45, 74752
    s_add_u32 s46, s41, 53248
    buffer_load_dwordx4 v15, s[16:19], s46 offen lds
    s_add_u32 m0, s44, 41984
    s_add_u32 s46, s40, 16384
    buffer_load_dwordx4 v13, s[12:15], s46 offen lds
    s_add_u32 m0, s44, 43008
    s_add_u32 s46, s40, 32768
    buffer_load_dwordx4 v12, s[12:15], s46 offen lds
    s_add_u32 m0, s44, 44032
    s_add_u32 s46, s40, 49152
    buffer_load_dwordx4 v13, s[12:15], s46 offen lds
    s_bfe_u32 s40, s48, 0x40018
    s_bitcmp1_b32 s40, 3
    s_cselect_b32 s41, s39, s42
    s_xor_b32 s40, s40, s41
    s_mul_i32 s41, s40, 393216
    s_add_u32 s41, s41, s38
    s_lshl_b32 s40, s40, 7
    s_add_u32 s40, s40, s36
    s_add_u32 m0, s44, 81920
    s_add_u32 s46, s40, 0
    s_nop 0
    buffer_load_dwordx4 v12, s[12:15], s46 offen lds
    s_add_u32 m0, s45, 106496
    s_add_u32 s46, s41, 2048
    buffer_load_dwordx4 v14, s[16:19], s46 offen lds
    s_add_u32 m0, s45, 107520
    s_add_u32 s46, s41, 51200
    buffer_load_dwordx4 v15, s[16:19], s46 offen lds
    s_add_u32 m0, s45, 98304
    s_add_u32 s46, s41, 0
    s_add_u32 s46, s46, s47
    buffer_load_dwordx4 v14, s[16:19], s46 offen lds
    s_add_u32 m0, s45, 99328
    s_add_u32 s46, s41, 49152
    s_add_u32 s46, s46, s47
    buffer_load_dwordx4 v15, s[16:19], s46 offen lds
    s_add_u32 m0, s45, 114688
    s_add_u32 s46, s41, 4096
    buffer_load_dwordx4 v14, s[16:19], s46 offen lds
    s_waitcnt vmcnt(16)
    s_barrier
    s_nop 0
    s_add_u32 m0, s45, 115712
    s_add_u32 s46, s41, 53248
    buffer_load_dwordx4 v15, s[16:19], s46 offen lds
    s_add_u32 m0, s44, 82944
    s_add_u32 s46, s40, 16384
    buffer_load_dwordx4 v13, s[12:15], s46 offen lds
    s_add_u32 m0, s44, 83968
    s_add_u32 s46, s40, 32768
    buffer_load_dwordx4 v12, s[12:15], s46 offen lds
    s_add_u32 m0, s44, 84992
    s_add_u32 s46, s40, 49152
    buffer_load_dwordx4 v13, s[12:15], s46 offen lds
    s_bfe_u32 s40, s48, 0x4001c
    s_bitcmp1_b32 s40, 3
    s_cselect_b32 s41, s39, s42
    s_xor_b32 s40, s40, s41
    s_mul_i32 s41, s40, 393216
    s_add_u32 s41, s41, s38
    s_lshl_b32 s40, s40, 7
    s_add_u32 s40, s40, s36
    s_add_u32 m0, s44, 122880
    s_add_u32 s46, s40, 0
    s_nop 0
    buffer_load_dwordx4 v12, s[12:15], s46 offen lds
    s_add_u32 m0, s45, 147456
    s_add_u32 s46, s41, 2048
    buffer_load_dwordx4 v14, s[16:19], s46 offen lds
    s_add_u32 m0, s45, 148480
    s_add_u32 s46, s41, 51200
    buffer_load_dwordx4 v15, s[16:19], s46 offen lds
    s_add_u32 m0, s45, 139264
    s_add_u32 s46, s41, 0
    s_add_u32 s46, s46, s47
    buffer_load_dwordx4 v14, s[16:19], s46 offen lds
    s_add_u32 m0, s45, 140288
    s_add_u32 s46, s41, 49152
    s_add_u32 s46, s46, s47
    s_nop 0
    buffer_load_dwordx4 v15, s[16:19], s46 offen lds
    s_add_u32 m0, s45, 155648
    s_add_u32 s46, s41, 4096
    buffer_load_dwordx4 v14, s[16:19], s46 offen lds
    s_add_u32 m0, s45, 156672
    s_add_u32 s46, s41, 53248
    buffer_load_dwordx4 v15, s[16:19], s46 offen lds
    s_add_u32 m0, s44, 123904
    s_add_u32 s46, s40, 16384
    buffer_load_dwordx4 v13, s[12:15], s46 offen lds
    s_waitcnt vmcnt(18)
    s_barrier
    s_add_u32 m0, s44, 124928
    s_add_u32 s46, s40, 32768
    buffer_load_dwordx4 v12, s[12:15], s46 offen lds
    s_add_u32 m0, s44, 125952
    s_add_u32 s46, s40, 49152
    buffer_load_dwordx4 v13, s[12:15], s46 offen lds
    s_bfe_u32 s40, s49, 0x40000
    s_bitcmp1_b32 s40, 3
    s_cselect_b32 s41, s39, s42
    s_xor_b32 s40, s40, s41
    s_mul_i32 s41, s40, 393216
    s_add_u32 s41, s41, s38
    s_lshl_b32 s40, s40, 7
    s_add_u32 s40, s40, s36
    s_add_u32 m0, s44, 0
    s_add_u32 s46, s40, 0
    buffer_load_dwordx4 v12, s[12:15], s46 offen lds
    s_add_u32 m0, s45, 24576
    s_add_u32 s46, s41, 2048
    buffer_load_dwordx4 v14, s[16:19], s46 offen lds
    s_add_u32 m0, s45, 25600
    s_add_u32 s46, s41, 51200
    buffer_load_dwordx4 v15, s[16:19], s46 offen lds
    s_add_u32 m0, s45, 16384
    s_add_u32 s46, s41, 0
    s_add_u32 s46, s46, s47
    buffer_load_dwordx4 v14, s[16:19], s46 offen lds
    s_add_u32 m0, s45, 17408
    s_add_u32 s46, s41, 49152
    s_add_u32 s46, s46, s47
    s_nop 0
    buffer_load_dwordx4 v15, s[16:19], s46 offen lds
    s_add_u32 m0, s45, 32768
    s_add_u32 s46, s41, 4096
    buffer_load_dwordx4 v14, s[16:19], s46 offen lds
    s_add_u32 m0, s45, 33792
    s_add_u32 s46, s41, 53248
    buffer_load_dwordx4 v15, s[16:19], s46 offen lds
    s_add_u32 m0, s44, 1024
    s_add_u32 s46, s40, 16384
    buffer_load_dwordx4 v13, s[12:15], s46 offen lds
    s_add_u32 m0, s44, 2048
    s_add_u32 s46, s40, 32768
    buffer_load_dwordx4 v12, s[12:15], s46 offen lds
    s_add_u32 m0, s44, 3072
    s_add_u32 s46, s40, 49152
    buffer_load_dwordx4 v13, s[12:15], s46 offen lds
    s_waitcnt vmcnt(20)
    s_barrier
    s_bfe_u32 s40, s49, 0x40004
    s_bitcmp1_b32 s40, 3
    s_cselect_b32 s41, s39, s42
    s_xor_b32 s40, s40, s41
    s_mul_i32 s41, s40, 393216
    s_add_u32 s41, s41, s38
    s_lshl_b32 s40, s40, 7
    s_add_u32 s40, s40, s36
    s_add_u32 m0, s44, 40960
    s_add_u32 s46, s40, 0
    s_nop 0
    buffer_load_dwordx4 v12, s[12:15], s46 offen lds
    s_add_u32 m0, s45, 65536
    s_add_u32 s46, s41, 2048
    buffer_load_dwordx4 v14, s[16:19], s46 offen lds
    s_add_u32 m0, s45, 66560
    s_add_u32 s46, s41, 51200
    buffer_load_dwordx4 v15, s[16:19], s46 offen lds
    s_add_u32 m0, s45, 57344
    s_add_u32 s46, s41, 0
    s_add_u32 s46, s46, s47
    buffer_load_dwordx4 v14, s[16:19], s46 offen lds
    s_add_u32 m0, s45, 58368
    s_add_u32 s46, s41, 49152
    s_add_u32 s46, s46, s47
    s_nop 0
    buffer_load_dwordx4 v15, s[16:19], s46 offen lds
    s_add_u32 m0, s45, 73728
    s_add_u32 s46, s41, 4096
    buffer_load_dwordx4 v14, s[16:19], s46 offen lds
    s_add_u32 m0, s45, 74752
    s_add_u32 s46, s41, 53248
    buffer_load_dwordx4 v15, s[16:19], s46 offen lds
    s_add_u32 m0, s44, 41984
    s_add_u32 s46, s40, 16384
    buffer_load_dwordx4 v13, s[12:15], s46 offen lds
    s_add_u32 m0, s44, 43008
    s_add_u32 s46, s40, 32768
    buffer_load_dwordx4 v12, s[12:15], s46 offen lds
    s_add_u32 m0, s44, 44032
    s_add_u32 s46, s40, 49152
    buffer_load_dwordx4 v13, s[12:15], s46 offen lds
    s_mov_b32 s20, s8
    s_mov_b32 s21, s9
    s_mov_b32 s22, 0x200000
    s_mov_b32 s23, 0x00020000
    s_lshl_b32 s50, s2, 13
    s_lshl_b32 s51, s3, 11
    s_add_u32 s50, s50, s51
    v_lshlrev_b32 v104, 7, v0
    s_mov_b64 exec, 0xffff
    buffer_load_dword v112, v104, s[20:23], s50 offen
    s_mov_b64 exec, -1

    s_waitcnt vmcnt(21)
    s_barrier
    s_bfe_u32 s40, s49, 0x40008
    s_bitcmp1_b32 s40, 3
    s_cselect_b32 s41, s39, s42
    s_xor_b32 s40, s40, s41
    s_mul_i32 s41, s40, 393216
    s_add_u32 s41, s41, s38
    s_lshl_b32 s40, s40, 7
    s_add_u32 s40, s40, s36
    s_add_u32 m0, s44, 81920
    s_add_u32 s46, s40, 0
    buffer_load_dwordx4 v12, s[12:15], s46 offen lds
    s_add_u32 m0, s45, 106496
    s_add_u32 s46, s41, 2048
    buffer_load_dwordx4 v14, s[16:19], s46 offen lds
    s_add_u32 m0, s45, 107520
    s_add_u32 s46, s41, 51200
    buffer_load_dwordx4 v15, s[16:19], s46 offen lds
    s_add_u32 m0, s45, 98304
    s_add_u32 s46, s41, 0
    s_add_u32 s46, s46, s47
    buffer_load_dwordx4 v14, s[16:19], s46 offen lds
    s_add_u32 m0, s45, 99328
    s_add_u32 s46, s41, 49152
    s_add_u32 s46, s46, s47
    s_nop 0
    buffer_load_dwordx4 v15, s[16:19], s46 offen lds
    s_add_u32 m0, s45, 114688
    s_add_u32 s46, s41, 4096
    buffer_load_dwordx4 v14, s[16:19], s46 offen lds
    s_add_u32 m0, s45, 115712
    s_add_u32 s46, s41, 53248
    buffer_load_dwordx4 v15, s[16:19], s46 offen lds
    s_add_u32 m0, s44, 82944
    s_add_u32 s46, s40, 16384
    buffer_load_dwordx4 v13, s[12:15], s46 offen lds
    s_add_u32 m0, s44, 83968
    s_add_u32 s46, s40, 32768
    buffer_load_dwordx4 v12, s[12:15], s46 offen lds
    s_add_u32 m0, s44, 84992
    s_add_u32 s46, s40, 49152
    buffer_load_dwordx4 v13, s[12:15], s46 offen lds
    s_waitcnt vmcnt(21)
    s_barrier
    s_bfe_u32 s40, s49, 0x4000c
    s_bitcmp1_b32 s40, 3
    s_cselect_b32 s41, s39, s42
    s_xor_b32 s40, s40, s41
    s_mul_i32 s41, s40, 393216
    s_add_u32 s41, s41, s38
    s_lshl_b32 s40, s40, 7
    s_add_u32 s40, s40, s36
    s_add_u32 m0, s44, 122880
    s_add_u32 s46, s40, 0
    s_nop 0
    buffer_load_dwordx4 v12, s[12:15], s46 offen lds
    s_add_u32 m0, s45, 147456
    s_add_u32 s46, s41, 2048
    buffer_load_dwordx4 v14, s[16:19], s46 offen lds
    s_add_u32 m0, s45, 148480
    s_add_u32 s46, s41, 51200
    buffer_load_dwordx4 v15, s[16:19], s46 offen lds
    s_add_u32 m0, s45, 139264
    s_add_u32 s46, s41, 0
    s_add_u32 s46, s46, s47
    buffer_load_dwordx4 v14, s[16:19], s46 offen lds
    s_add_u32 m0, s45, 140288
    s_add_u32 s46, s41, 49152
    s_add_u32 s46, s46, s47
    s_nop 0
    buffer_load_dwordx4 v15, s[16:19], s46 offen lds
    s_add_u32 m0, s45, 155648
    s_add_u32 s46, s41, 4096
    buffer_load_dwordx4 v14, s[16:19], s46 offen lds
    s_add_u32 m0, s45, 156672
    s_add_u32 s46, s41, 53248
    buffer_load_dwordx4 v15, s[16:19], s46 offen lds
    s_add_u32 m0, s44, 123904
    s_add_u32 s46, s40, 16384
    buffer_load_dwordx4 v13, s[12:15], s46 offen lds
    s_add_u32 m0, s44, 124928
    s_add_u32 s46, s40, 32768
    buffer_load_dwordx4 v12, s[12:15], s46 offen lds
    s_add_u32 m0, s44, 125952
    s_add_u32 s46, s40, 49152
    buffer_load_dwordx4 v13, s[12:15], s46 offen lds
    s_waitcnt vmcnt(21)
    s_barrier
    s_bfe_u32 s40, s49, 0x40010
    s_bitcmp1_b32 s40, 3
    s_cselect_b32 s41, s39, s42
    s_xor_b32 s40, s40, s41
    s_mul_i32 s41, s40, 393216
    s_add_u32 s41, s41, s38
    s_lshl_b32 s40, s40, 7
    s_add_u32 s40, s40, s36
    s_add_u32 m0, s44, 0
    s_add_u32 s46, s40, 0
    buffer_load_dwordx4 v12, s[12:15], s46 offen lds
    s_add_u32 m0, s45, 24576
    s_add_u32 s46, s41, 2048
    buffer_load_dwordx4 v14, s[16:19], s46 offen lds
    s_add_u32 m0, s45, 25600
    s_add_u32 s46, s41, 51200
    buffer_load_dwordx4 v15, s[16:19], s46 offen lds
    s_add_u32 m0, s45, 16384
    s_add_u32 s46, s41, 0
    s_add_u32 s46, s46, s47
    buffer_load_dwordx4 v14, s[16:19], s46 offen lds
    s_add_u32 m0, s45, 17408
    s_add_u32 s46, s41, 49152
    s_add_u32 s46, s46, s47
    s_nop 0
    buffer_load_dwordx4 v15, s[16:19], s46 offen lds
    s_add_u32 m0, s45, 32768
    s_add_u32 s46, s41, 4096
    buffer_load_dwordx4 v14, s[16:19], s46 offen lds
    s_add_u32 m0, s45, 33792
    s_add_u32 s46, s41, 53248
    buffer_load_dwordx4 v15, s[16:19], s46 offen lds
    s_add_u32 m0, s44, 1024
    s_add_u32 s46, s40, 16384
    buffer_load_dwordx4 v13, s[12:15], s46 offen lds
    s_add_u32 m0, s44, 2048
    s_add_u32 s46, s40, 32768
    buffer_load_dwordx4 v12, s[12:15], s46 offen lds
    s_add_u32 m0, s44, 3072
    s_add_u32 s46, s40, 49152
    buffer_load_dwordx4 v13, s[12:15], s46 offen lds
    s_waitcnt vmcnt(20)
    s_barrier
    s_bfe_u32 s40, s49, 0x40014
    s_bitcmp1_b32 s40, 3
    s_cselect_b32 s41, s39, s42
    s_xor_b32 s40, s40, s41
    s_mul_i32 s41, s40, 393216
    s_add_u32 s41, s41, s38
    s_lshl_b32 s40, s40, 7
    s_add_u32 s40, s40, s36
    s_add_u32 m0, s44, 40960
    s_add_u32 s46, s40, 0
    s_nop 0
    buffer_load_dwordx4 v12, s[12:15], s46 offen lds
    s_add_u32 m0, s45, 65536
    s_add_u32 s46, s41, 2048
    buffer_load_dwordx4 v14, s[16:19], s46 offen lds
    s_add_u32 m0, s45, 66560
    s_add_u32 s46, s41, 51200
    buffer_load_dwordx4 v15, s[16:19], s46 offen lds
    s_add_u32 m0, s45, 57344
    s_add_u32 s46, s41, 0
    s_add_u32 s46, s46, s47
    buffer_load_dwordx4 v14, s[16:19], s46 offen lds
    s_add_u32 m0, s45, 58368
    s_add_u32 s46, s41, 49152
    s_add_u32 s46, s46, s47
    s_nop 0
    buffer_load_dwordx4 v15, s[16:19], s46 offen lds
    s_add_u32 m0, s45, 73728
    s_add_u32 s46, s41, 4096
    buffer_load_dwordx4 v14, s[16:19], s46 offen lds
    s_add_u32 m0, s45, 74752
    s_add_u32 s46, s41, 53248
    buffer_load_dwordx4 v15, s[16:19], s46 offen lds
    s_add_u32 m0, s44, 41984
    s_add_u32 s46, s40, 16384
    buffer_load_dwordx4 v13, s[12:15], s46 offen lds
    s_add_u32 m0, s44, 43008
    s_add_u32 s46, s40, 32768
    buffer_load_dwordx4 v12, s[12:15], s46 offen lds
    s_add_u32 m0, s44, 44032
    s_add_u32 s46, s40, 49152
    buffer_load_dwordx4 v13, s[12:15], s46 offen lds
    s_waitcnt vmcnt(20)
    s_barrier
    s_bfe_u32 s40, s49, 0x40018
    s_bitcmp1_b32 s40, 3
    s_cselect_b32 s41, s39, s42
    s_xor_b32 s40, s40, s41
    s_mul_i32 s41, s40, 393216
    s_add_u32 s41, s41, s38
    s_lshl_b32 s40, s40, 7
    s_add_u32 s40, s40, s36
    s_add_u32 m0, s44, 81920
    s_add_u32 s46, s40, 0
    s_nop 0
    buffer_load_dwordx4 v12, s[12:15], s46 offen lds
    s_add_u32 m0, s45, 106496
    s_add_u32 s46, s41, 2048
    buffer_load_dwordx4 v14, s[16:19], s46 offen lds
    s_add_u32 m0, s45, 107520
    s_add_u32 s46, s41, 51200
    buffer_load_dwordx4 v15, s[16:19], s46 offen lds
    s_add_u32 m0, s45, 98304
    s_add_u32 s46, s41, 0
    s_add_u32 s46, s46, s47
    buffer_load_dwordx4 v14, s[16:19], s46 offen lds
    s_add_u32 m0, s45, 99328
    s_add_u32 s46, s41, 49152
    s_add_u32 s46, s46, s47
    s_nop 0
    buffer_load_dwordx4 v15, s[16:19], s46 offen lds
    s_add_u32 m0, s45, 114688
    s_add_u32 s46, s41, 4096
    buffer_load_dwordx4 v14, s[16:19], s46 offen lds
    s_add_u32 m0, s45, 115712
    s_add_u32 s46, s41, 53248
    buffer_load_dwordx4 v15, s[16:19], s46 offen lds
    s_add_u32 m0, s44, 82944
    s_add_u32 s46, s40, 16384
    buffer_load_dwordx4 v13, s[12:15], s46 offen lds
    s_add_u32 m0, s44, 83968
    s_add_u32 s46, s40, 32768
    buffer_load_dwordx4 v12, s[12:15], s46 offen lds
    s_add_u32 m0, s44, 84992
    s_add_u32 s46, s40, 49152
    buffer_load_dwordx4 v13, s[12:15], s46 offen lds
    s_add_u32 s84, s72, 0xb00000
    s_addc_u32 s85, s73, 0
    s_mov_b32 s86, 0x30000
    s_mov_b32 s87, 0x00020000
    v_bfe_u32 v113, v0, 2, 2
    v_min_u32 v113, 2, v113
    v_lshlrev_b32 v114, 8, v113
    v_lshlrev_b32 v113, 12, v113
    v_and_b32 v112, 3, v0
    v_lshl_add_u32 v113, v112, 4, v113
    v_lshl_add_u32 v114, v112, 4, v114
    v_lshrrev_b32 v112, 4, v0
    v_mul_u32_u24 v112, 12288, v112
    v_add_u32 v113, v113, v112
    s_lshl_b32 s76, s3, 6
    s_lshl_b32 s53, s33, 8
    s_add_u32 s53, s53, s76
    s_add_u32 s76, s76, 26368
    v_add_u32 v114, s76, v114

    s_waitcnt vmcnt(20)
    s_barrier
    s_bfe_u32 s40, s49, 0x4001c
    s_bitcmp1_b32 s40, 3
    s_cselect_b32 s41, s39, s42
    s_xor_b32 s40, s40, s41
    s_mul_i32 s41, s40, 393216
    s_add_u32 s41, s41, s38
    s_lshl_b32 s40, s40, 7
    s_add_u32 s40, s40, s36
    s_add_u32 m0, s44, 122880
    s_add_u32 s46, s40, 0
    buffer_load_dwordx4 v12, s[12:15], s46 offen lds
    s_add_u32 m0, s45, 147456
    s_add_u32 s46, s41, 2048
    buffer_load_dwordx4 v14, s[16:19], s46 offen lds
    s_add_u32 m0, s45, 148480
    s_add_u32 s46, s41, 51200
    buffer_load_dwordx4 v15, s[16:19], s46 offen lds
    s_add_u32 m0, s45, 139264
    s_add_u32 s46, s41, 0
    s_add_u32 s46, s46, s47
    buffer_load_dwordx4 v14, s[16:19], s46 offen lds
    s_add_u32 m0, s45, 140288
    s_add_u32 s46, s41, 49152
    s_add_u32 s46, s46, s47
    s_nop 0
    buffer_load_dwordx4 v15, s[16:19], s46 offen lds
    s_add_u32 m0, s45, 155648
    s_add_u32 s46, s41, 4096
    buffer_load_dwordx4 v14, s[16:19], s46 offen lds
    s_add_u32 m0, s45, 156672
    s_add_u32 s46, s41, 53248
    buffer_load_dwordx4 v15, s[16:19], s46 offen lds
    s_add_u32 m0, s44, 123904
    s_add_u32 s46, s40, 16384
    buffer_load_dwordx4 v13, s[12:15], s46 offen lds
    s_add_u32 m0, s44, 124928
    s_add_u32 s46, s40, 32768
    buffer_load_dwordx4 v12, s[12:15], s46 offen lds
    s_add_u32 m0, s44, 125952
    s_add_u32 s46, s40, 49152
    buffer_load_dwordx4 v13, s[12:15], s46 offen lds
    s_add_u32 s76, s53, 0
    s_nop 0
    buffer_load_dwordx4 v[72:75], v113, s[84:87], s76 offen sc0 sc1
    s_add_u32 s76, s53, 49152
    buffer_load_dwordx4 v[76:79], v113, s[84:87], s76 offen sc0 sc1
    s_add_u32 s76, s53, 98304
    buffer_load_dwordx4 v[80:83], v113, s[84:87], s76 offen sc0 sc1
    s_add_u32 s76, s53, 147456
    buffer_load_dwordx4 v[84:87], v113, s[84:87], s76 offen sc0 sc1
    v_lshlrev_b32 v10, 4, v0
    s_add_u32 s68, s72, 0x900000
    s_addc_u32 s69, s73, 0
    s_mov_b32 s70, 0x18000
    s_mov_b32 s71, 0x00020000
    s_lshl_b32 s52, s32, 11
    s_add_u32 s52, s52, 65536
    s_lshl_b32 s76, s3, 2
    s_add_u32 s52, s52, s76
    s_lshl_b32 s76, s3, 9
    s_add_u32 m0, s76, 24832
    s_setprio 3

    s_waitcnt vmcnt(22)
    s_barrier
    s_cmp_eq_u32 s3, 3
    s_cbranch_scc1 F_d0
    buffer_load_dword v10, s[68:71], s52 offen sc0 sc1 lds
    s_add_u32 m0, m0, 256
    s_add_u32 s52, s52, 1024
    buffer_load_dword v10, s[68:71], s52 offen sc0 sc1 lds
    s_branch F_d1
F_d0:
    s_mov_b32 m0, 24576
    s_mov_b32 s52, 0x7ff00000
    s_mov_b64 exec, 0xfff
    buffer_load_dwordx4 v10, s[84:87], s52 offen lds
    buffer_load_dwordx4 v10, s[84:87], s52 offen lds
    s_mov_b64 exec, -1
F_d1:

    s_setprio 0
    s_waitcnt vmcnt(16)
    s_barrier
    s_waitcnt vmcnt(2)
F_cs0:
    v_min3_u32 v96, v72, v76, v80
    v_min_u32 v96, v96, v84
    v_cmp_eq_u32 vcc, 0, v96
    s_cbranch_vccz F_cs1
    s_sleep 8

    s_add_u32 s76, s53, 0
    buffer_load_dwordx4 v[72:75], v113, s[84:87], s76 offen sc0 sc1
    s_add_u32 s76, s53, 49152
    buffer_load_dwordx4 v[76:79], v113, s[84:87], s76 offen sc0 sc1
    s_add_u32 s76, s53, 98304
    buffer_load_dwordx4 v[80:83], v113, s[84:87], s76 offen sc0 sc1
    s_add_u32 s76, s53, 147456
    buffer_load_dwordx4 v[84:87], v113, s[84:87], s76 offen sc0 sc1
    s_waitcnt vmcnt(0)
    s_branch F_cs0
F_cs1:
    v_add_f32 v72, v72, v76
    v_add_f32 v80, v80, v84
    v_add_f32 v73, v73, v77
    v_add_f32 v81, v81, v85
    v_add_f32 v74, v74, v78
    v_add_f32 v82, v82, v86
    v_add_f32 v75, v75, v79
    v_add_f32 v83, v83, v87
    v_add_f32 v72, v72, v80
    v_add_f32 v73, v73, v81
    v_add_f32 v74, v74, v82
    v_add_f32 v75, v75, v83
    v_mov_b32 v76, v72
    v_mov_b32 v77, v73
    v_mov_b32 v78, v74
    v_mov_b32 v79, v75
    v_permlane32_swap_b32 v72, v76
    v_permlane32_swap_b32 v73, v77
    v_permlane32_swap_b32 v74, v78
    v_permlane32_swap_b32 v75, v79
    v_add_f32 v72, v72, v76
    v_add_f32 v73, v73, v77
    v_add_f32 v74, v74, v78
    v_add_f32 v75, v75, v79
    v_mov_b32 v76, v72
    v_mov_b32 v77, v73
    v_mov_b32 v78, v74
    v_mov_b32 v79, v75
    v_permlane16_swap_b32 v72, v76
    v_permlane16_swap_b32 v73, v77
    v_permlane16_swap_b32 v74, v78
    v_permlane16_swap_b32 v75, v79
    v_add_f32 v72, v72, v76
    v_add_f32 v73, v73, v77
    v_add_f32 v74, v74, v78
    v_add_f32 v75, v75, v79
    s_mov_b64 exec, 0xfff
    ds_write_b128 v114, v[72:75]
    s_mov_b64 exec, -1
    s_waitcnt lgkmcnt(0)

    s_waitcnt vmcnt(0)
    s_barrier
    s_add_u32 s24, s72, 0x800000
    s_addc_u32 s25, s73, 0
    s_mov_b32 s26, 0x100000
    s_mov_b32 s27, 0x00020000
    s_add_u32 s12, s72, 0x400000
    s_addc_u32 s13, s73, 0
    s_mov_b32 s14, 0x400000
    s_mov_b32 s15, 0x00020000
    s_mov_b32 s16, s8
    s_mov_b32 s17, s9
    s_mov_b32 s18, 0x200000
    s_mov_b32 s19, 0x00020000
    v_lshrrev_b32 v4, 4, v0
    v_and_b32 v3, 15, v0
    v_lshlrev_b32 v6, 1, v4
    v_xor_b32 v8, v3, v6
    v_xor_b32 v9, 8, v8
    v_lshlrev_b32 v8, 4, v8
    v_lshlrev_b32 v9, 4, v9
    v_lshl_add_u32 v8, v4, 11, v8
    v_lshl_add_u32 v9, v4, 11, v9
    s_lshl_b32 s38, s29, 8
    s_lshl_b32 s45, s3, 15
    s_add_u32 s38, s38, s45
    s_lshl_b32 s45, s3, 12
    s_mul_i32 s39, s35, 2
    s_mul_i32 s40, s34, 1
    s_add_u32 s39, s39, s40
    s_and_b32 s59, s34, 0

    s_lshr_b32 s36, s3, 1
    s_and_b32 s37, s3, 1
    s_lshl_b32 s43, s36, 6
    s_lshl_b32 s42, s33, 1
    s_add_u32 s42, s42, s37
    s_mul_i32 s82, s42, 4224
    s_add_u32 s83, s82, 4096
    s_add_u32 s83, s83, s43
    s_lshl_b32 s44, s36, 11
    s_add_u32 s82, s82, s44
    s_mul_i32 s51, s42, 16*64
    s_add_u32 s51, s51, 192512
    s_lshl_b32 s42, s10, 1
    s_add_u32 s42, s42, s37
    s_lshl_b32 s50, s42, 4
    s_add_u32 s50, s50, s32
    s_lshl_b32 s50, s50, 6
    v_lshlrev_b32 v10, 4, v0
    v_lshlrev_b32 v11, 2, v0
    s_lshl_b32 s42, s3, 2
    s_add_u32 s42, s42, 24640
    v_mov_b32 v1, s42
    v_and_b32 v2, 3, v0
    v_lshlrev_b32 v2, 2, v2
    v_add_u32 v2, 24640, v2
    v_and_b32 v105, 1, v0
    v_lshlrev_b32 v105, 3, v105
    s_lshl_b32 s42, s37, 2
    s_add_u32 s42, s42, 24640
    v_add_u32 v105, s42, v105
    s_lshl_b32 s42, s37, 12
    s_add_u32 s42, s42, s44
    s_add_u32 s42, s42, 65536
    v_add_u32 v106, s42, v11
    s_lshl_b32 s42, s37, 7
    s_add_u32 s42, s42, s43
    s_add_u32 s42, s42, 27136
    v_add_u32 v107, s42, v11
    v_mul_u32_u24 v108, 64*16/4, v0
    v_mov_b32 v109, 1
    s_mov_b32 s60, 0
    s_mov_b32 s62, 0xa001024
    s_mov_b32 s63, 0x1a1e14
    s_lshl_b32 s36, s28, 2
    s_add_u32 s36, s36, s3
    s_lshl_b32 s36, s36, 15
    s_lshl_b32 s44, s3, 11
    s_lshl_b32 s50, s28, 3
    s_and_b32 s76, s29, 4-1
    s_mul_i32 s76, s76, 8/4
    s_add_u32 s50, s50, s76
    s_mul_i32 s50, s50, 64
    s_add_u32 s78, s50, 0x837000
    s_add_u32 s78, s72, s78
    s_addc_u32 s79, s73, 0
    s_setprio 3
    s_sleep 10
    s_lshr_b32 s56, s3, 1
    s_add_u32 s56, s56, 1
    ds_read_b32 v114, v105
FW_11:
    s_waitcnt lgkmcnt(0)
    v_cmp_gt_u32 vcc, s56, v114
    s_cbranch_vccz FO_12
    s_sleep 1
    ds_read_b32 v114, v105
    s_branch FW_11
FO_12:
    ds_read2st64_b32 v[12:13], v106 offset0:0 offset1:1
    ds_read2st64_b32 v[20:21], v106 offset0:32 offset1:33
    ds_read2st64_b32 v[14:15], v106 offset0:2 offset1:3
    ds_read2st64_b32 v[22:23], v106 offset0:34 offset1:35
    ds_read2st64_b32 v[16:17], v106 offset0:4 offset1:5
    ds_read2st64_b32 v[24:25], v106 offset0:36 offset1:37
    ds_read2st64_b32 v[18:19], v106 offset0:6 offset1:7
    ds_read2st64_b32 v[26:27], v106 offset0:38 offset1:39
    ds_read2st64_b32 v[28:29], v107 offset0:0 offset1:1
    s_waitcnt lgkmcnt(7)
    v_add_f32 v12, v12, v20
    buffer_atomic_add_f32 v12, v11, s[24:27], s82 offen offset:0
    v_add_f32 v13, v13, v21
    buffer_atomic_add_f32 v13, v11, s[24:27], s82 offen offset:256
    s_waitcnt lgkmcnt(5)
    v_add_f32 v14, v14, v22
    buffer_atomic_add_f32 v14, v11, s[24:27], s82 offen offset:512
    v_add_f32 v15, v15, v23
    buffer_atomic_add_f32 v15, v11, s[24:27], s82 offen offset:768
    s_waitcnt lgkmcnt(3)
    v_add_f32 v16, v16, v24
    buffer_atomic_add_f32 v16, v11, s[24:27], s82 offen offset:1024
    v_add_f32 v17, v17, v25
    buffer_atomic_add_f32 v17, v11, s[24:27], s82 offen offset:1280
    s_waitcnt lgkmcnt(1)
    v_add_f32 v18, v18, v26
    buffer_atomic_add_f32 v18, v11, s[24:27], s82 offen offset:1536
    v_add_f32 v19, v19, v27
    buffer_atomic_add_f32 v19, v11, s[24:27], s82 offen offset:1792
    s_waitcnt lgkmcnt(0)
    v_add_f32 v28, v28, v29
    s_mov_b64 exec, 0xffff
    buffer_atomic_add_f32 v28, v11, s[24:27], s83 offen
    s_mov_b64 exec, -1
    v_mov_b32 v113, 1
    s_mov_b64 exec, 1
    ds_write_b32 v1, v113 offset:32
    s_mov_b64 exec, -1
    s_add_u32 s54, s51, 0x800000
    s_add_u32 s54, s72, s54
    s_addc_u32 s55, s73, 0
    s_mov_b32 s57, 1
    s_waitcnt vmcnt(4)
    ds_read2_b32 v[102:103], v2 offset0:0 offset1:8
    ds_read_b32 v104, v2 offset:16
    s_waitcnt lgkmcnt(0)
    v_cmp_ne_u32 vcc, 3, v102
    v_cmp_eq_u32 s[42:43], 0, v103
    s_nop 0
    s_or_b64 vcc, vcc, s[42:43]
    v_cmp_gt_u32 s[42:43], 2, v104
    s_nop 0
    s_or_b64 vcc, vcc, s[42:43]
    s_waitcnt vmcnt(0)
    s_atomic_add s57, s[54:55], 0
    s_atomic_add s57, s[54:55], 256
    s_atomic_add s57, s[54:55], 512
    s_atomic_add s57, s[54:55], 768
    s_cbranch_vccnz F_pe
    s_add_u32 s41, s39, 0
    s_and_b32 s41, s41, 15
    s_xor_b32 s41, s41, s59
    s_lshl_b32 s41, s41, 17
    s_add_u32 s41, s41, s38
    s_add_u32 m0, s45, 147456
    s_add_u32 s76, s41, 0
    buffer_load_dwordx4 v8, s[16:19], s76 offen lds
    s_add_u32 m0, s45, 148480
    s_add_u32 s76, s41, 8192
    buffer_load_dwordx4 v9, s[16:19], s76 offen lds
    s_add_u32 m0, s45, 149504
    s_add_u32 s76, s41, 16384
    buffer_load_dwordx4 v8, s[16:19], s76 offen lds
    s_add_u32 m0, s45, 150528
    s_add_u32 s76, s41, 24576
    buffer_load_dwordx4 v9, s[16:19], s76 offen lds
    s_add_u32 s41, s39, 1
    s_and_b32 s41, s41, 15
    s_xor_b32 s41, s41, s59
    s_lshl_b32 s41, s41, 17
    s_add_u32 s41, s41, s38
    s_add_u32 m0, s45, 65536
    s_add_u32 s76, s41, 0
    buffer_load_dwordx4 v8, s[16:19], s76 offen lds
    s_add_u32 m0, s45, 66560
    s_add_u32 s76, s41, 8192
    buffer_load_dwordx4 v9, s[16:19], s76 offen lds
    s_add_u32 m0, s45, 67584
    s_add_u32 s76, s41, 16384
    buffer_load_dwordx4 v8, s[16:19], s76 offen lds
    s_add_u32 m0, s45, 68608
    s_add_u32 s76, s41, 24576
    buffer_load_dwordx4 v9, s[16:19], s76 offen lds
    s_add_u32 s41, s39, 2
    s_and_b32 s41, s41, 15
    s_xor_b32 s41, s41, s59
    s_lshl_b32 s41, s41, 17
    s_add_u32 s41, s41, s38
    s_add_u32 m0, s45, 0
    s_add_u32 s76, s41, 0
    s_nop 0
    buffer_load_dwordx4 v8, s[16:19], s76 offen lds
    s_add_u32 m0, s45, 1024
    s_add_u32 s76, s41, 8192
    buffer_load_dwordx4 v9, s[16:19], s76 offen lds
    s_add_u32 m0, s45, 2048
    s_add_u32 s76, s41, 16384
    buffer_load_dwordx4 v8, s[16:19], s76 offen lds
    s_add_u32 m0, s45, 3072
    s_add_u32 s76, s41, 24576
    buffer_load_dwordx4 v9, s[16:19], s76 offen lds
    s_mov_b32 s60, 3
F_pe:
    s_setprio 1
F_pr0:
    s_waitcnt vmcnt(8)
    ds_read2_b32 v[102:103], v2 offset0:0 offset1:8
    s_cmp_lt_u32 s60, 2
    s_cselect_b32 s61, 1, 3
    s_waitcnt lgkmcnt(0)
    v_cmp_le_u32 vcc, 4, v102
    s_cbranch_vccz F_pr3
    s_mov_b32 s61, 5
F_pr3:
    v_cmp_gt_u32 vcc, s61, v102
    v_cmp_gt_u32 s[42:43], 1, v103
    s_nop 0
    s_or_b64 vcc, vcc, s[42:43]
    s_cbranch_vccz F_pr2
    s_sleep 2
    s_branch F_pr0
F_pr2:
    s_cmp_lt_u32 s60, 6
    s_cbranch_scc1 F_pr4
    ds_read_b32 v102, v2 offset:16
    s_waitcnt lgkmcnt(0)
    v_cmp_gt_u32 vcc, 2, v102
    s_cbranch_vccz F_pr4
    s_sleep 2
    s_branch F_pr0
F_pr4:
    s_add_u32 s41, s39, s60
    s_and_b32 s41, s41, 15
    s_xor_b32 s41, s41, s59
    s_lshl_b32 s41, s41, 17
    s_add_u32 s41, s41, s38
    s_lshl_b32 s76, s60, 3
    s_lshr_b64 s[42:43], s[62:63], s76
    s_and_b32 s42, s42, 0xff
    s_lshl_b32 s42, s42, 12
    s_add_u32 m0, s42, s45
    s_add_u32 s60, s60, 1
    buffer_load_dwordx4 v8, s[16:19], s41 offen lds
    s_add_u32 m0, m0, 1024
    s_add_u32 s41, s41, 8192
    buffer_load_dwordx4 v9, s[16:19], s41 offen lds
    s_add_u32 m0, m0, 1024
    s_add_u32 s41, s41, 8192
    buffer_load_dwordx4 v8, s[16:19], s41 offen lds
    s_add_u32 m0, m0, 1024
    s_add_u32 s41, s41, 8192
    buffer_load_dwordx4 v9, s[16:19], s41 offen lds
    s_cmp_ge_u32 s60, 7
    s_cbranch_scc1 F_pr1
    s_cmp_eq_u32 s61, 5
    s_cbranch_scc1 F_pr2
    s_branch F_pr0
F_pr1:
    s_cmp_lg_u32 s3, 0
    s_cbranch_scc1 F_l4
SP_13:
    s_load_dword s58, s[78:79], 0 glc
    s_waitcnt lgkmcnt(0)
    s_cmp_ge_u32 s58, 32
    s_cbranch_scc1 SD_14
    s_sleep 1
    s_branch SP_13
SD_14:
    v_mov_b32 v113, 3
    s_mov_b64 exec, 1
    ds_write_b32 v1, v113 offset:112
    s_mov_b64 exec, -1
    s_branch F_l5
F_l4:
    v_mov_b32 v4, 24752
    ds_read_b32 v13, v4
FW_15:
    s_waitcnt lgkmcnt(0)
    v_cmp_gt_u32_e64 vcc, 3, v13
    s_cbranch_vccz FO_16
    s_sleep 1
    ds_read_b32 v13, v4
    s_branch FW_15
FO_16:
F_l5:
    s_add_u32 s40, s39, 0
    s_and_b32 s40, s40, 15
    s_xor_b32 s40, s40, s59
    s_lshl_b32 s40, s40, 11
    s_add_u32 s40, s40, s36
    s_add_u32 m0, s44, 16384
    s_nop 0
    buffer_load_dwordx4 v10, s[12:15], s40 offen offset:0 sc1 lds
    s_add_u32 m0, s44, 16384
    s_nop 0
    buffer_load_dwordx4 v10, s[12:15], s40 offen offset:1024 sc1 lds
    s_add_u32 s40, s39, 1
    s_and_b32 s40, s40, 15
    s_xor_b32 s40, s40, s59
    s_lshl_b32 s40, s40, 11
    s_add_u32 s40, s40, s36
    s_add_u32 m0, s44, 98304
    s_nop 0
    buffer_load_dwordx4 v10, s[12:15], s40 offen offset:0 sc1 lds
    s_add_u32 m0, s44, 98304
    s_nop 0
    buffer_load_dwordx4 v10, s[12:15], s40 offen offset:1024 sc1 lds
    s_add_u32 s40, s39, 2
    s_and_b32 s40, s40, 15
    s_xor_b32 s40, s40, s59
    s_lshl_b32 s40, s40, 11
    s_add_u32 s40, s40, s36
    s_add_u32 m0, s44, 139264
    s_nop 0
    buffer_load_dwordx4 v10, s[12:15], s40 offen offset:0 sc1 lds
    s_add_u32 m0, s44, 139264
    s_nop 0
    buffer_load_dwordx4 v10, s[12:15], s40 offen offset:1024 sc1 lds
    s_waitcnt vmcnt(4)
    s_barrier
    s_add_u32 s40, s39, 3
    s_and_b32 s40, s40, 15
    s_xor_b32 s40, s40, s59
    s_lshl_b32 s40, s40, 11
    s_add_u32 s40, s40, s36
    s_add_u32 m0, s44, 57344
    s_nop 0
    buffer_load_dwordx4 v10, s[12:15], s40 offen offset:0 sc1 lds
    s_add_u32 m0, s44, 57344
    s_nop 0
    buffer_load_dwordx4 v10, s[12:15], s40 offen offset:1024 sc1 lds
    s_setprio 0
    s_waitcnt vmcnt(4)
    s_barrier
    s_add_u32 s40, s39, 4
    s_and_b32 s40, s40, 15
    s_xor_b32 s40, s40, s59
    s_lshl_b32 s40, s40, 11
    s_add_u32 s40, s40, s36
    s_add_u32 m0, s44, 16384
    s_nop 0
    buffer_load_dwordx4 v10, s[12:15], s40 offen offset:0 sc1 lds
    s_add_u32 m0, s44, 16384
    s_nop 0
    buffer_load_dwordx4 v10, s[12:15], s40 offen offset:1024 sc1 lds
    s_add_u32 s41, s39, 7
    s_and_b32 s41, s41, 15
    s_xor_b32 s41, s41, s59
    s_lshl_b32 s41, s41, 17
    s_add_u32 s41, s41, s38
    s_add_u32 m0, s45, 147456
    s_add_u32 s76, s41, 0
    buffer_load_dwordx4 v8, s[16:19], s76 offen lds
    s_add_u32 m0, s45, 148480
    s_add_u32 s76, s41, 8192
    buffer_load_dwordx4 v9, s[16:19], s76 offen lds
    s_add_u32 m0, s45, 149504
    s_add_u32 s76, s41, 16384
    buffer_load_dwordx4 v8, s[16:19], s76 offen lds
    s_add_u32 m0, s45, 150528
    s_add_u32 s76, s41, 24576
    buffer_load_dwordx4 v9, s[16:19], s76 offen lds
    s_waitcnt vmcnt(8)
    s_barrier
    s_add_u32 s40, s39, 5
    s_and_b32 s40, s40, 15
    s_xor_b32 s40, s40, s59
    s_lshl_b32 s40, s40, 11
    s_add_u32 s40, s40, s36
    s_add_u32 m0, s44, 98304
    s_nop 0
    buffer_load_dwordx4 v10, s[12:15], s40 offen offset:0 sc1 lds
    s_add_u32 m0, s44, 98304
    s_nop 0
    buffer_load_dwordx4 v10, s[12:15], s40 offen offset:1024 sc1 lds
    s_add_u32 s41, s39, 8
    s_and_b32 s41, s41, 15
    s_xor_b32 s41, s41, s59
    s_lshl_b32 s41, s41, 17
    s_add_u32 s41, s41, s38
    s_add_u32 m0, s45, 65536
    s_add_u32 s76, s41, 0
    s_nop 0
    buffer_load_dwordx4 v8, s[16:19], s76 offen lds
    s_add_u32 m0, s45, 66560
    s_add_u32 s76, s41, 8192
    buffer_load_dwordx4 v9, s[16:19], s76 offen lds
    s_add_u32 m0, s45, 67584
    s_add_u32 s76, s41, 16384
    buffer_load_dwordx4 v8, s[16:19], s76 offen lds
    s_add_u32 m0, s45, 68608
    s_add_u32 s76, s41, 24576
    buffer_load_dwordx4 v9, s[16:19], s76 offen lds
    s_waitcnt vmcnt(12)
    s_barrier
    s_add_u32 s40, s39, 6
    s_and_b32 s40, s40, 15
    s_xor_b32 s40, s40, s59
    s_lshl_b32 s40, s40, 11
    s_add_u32 s40, s40, s36
    s_add_u32 m0, s44, 139264
    s_nop 0
    buffer_load_dwordx4 v10, s[12:15], s40 offen offset:0 sc1 lds
    s_add_u32 m0, s44, 139264
    s_nop 0
    buffer_load_dwordx4 v10, s[12:15], s40 offen offset:1024 sc1 lds
    s_add_u32 s41, s39, 9
    s_and_b32 s41, s41, 15
    s_xor_b32 s41, s41, s59
    s_lshl_b32 s41, s41, 17
    s_add_u32 s41, s41, s38
    s_add_u32 m0, s45, 0
    s_add_u32 s76, s41, 0
    buffer_load_dwordx4 v8, s[16:19], s76 offen lds
    s_add_u32 m0, s45, 1024
    s_add_u32 s76, s41, 8192
    buffer_load_dwordx4 v9, s[16:19], s76 offen lds
    s_add_u32 m0, s45, 2048
    s_add_u32 s76, s41, 16384
    buffer_load_dwordx4 v8, s[16:19], s76 offen lds
    s_add_u32 m0, s45, 3072
    s_add_u32 s76, s41, 24576
    buffer_load_dwordx4 v9, s[16:19], s76 offen lds
    s_waitcnt vmcnt(16)
    s_barrier
    s_add_u32 s40, s39, 7
    s_and_b32 s40, s40, 15
    s_xor_b32 s40, s40, s59
    s_lshl_b32 s40, s40, 11
    s_add_u32 s40, s40, s36
    s_add_u32 m0, s44, 57344
    s_nop 0
    buffer_load_dwordx4 v10, s[12:15], s40 offen offset:0 sc1 lds
    s_add_u32 m0, s44, 57344
    s_nop 0
    buffer_load_dwordx4 v10, s[12:15], s40 offen offset:1024 sc1 lds
    s_add_u32 s41, s39, 10
    s_and_b32 s41, s41, 15
    s_xor_b32 s41, s41, s59
    s_lshl_b32 s41, s41, 17
    s_add_u32 s41, s41, s38
    s_add_u32 m0, s45, 40960
    s_add_u32 s76, s41, 0
    s_nop 0
    buffer_load_dwordx4 v8, s[16:19], s76 offen lds
    s_add_u32 m0, s45, 41984
    s_add_u32 s76, s41, 8192
    buffer_load_dwordx4 v9, s[16:19], s76 offen lds
    s_add_u32 m0, s45, 43008
    s_add_u32 s76, s41, 16384
    buffer_load_dwordx4 v8, s[16:19], s76 offen lds
    s_add_u32 m0, s45, 44032
    s_add_u32 s76, s41, 24576
    buffer_load_dwordx4 v9, s[16:19], s76 offen lds
    s_waitcnt vmcnt(16)
    s_barrier
    s_add_u32 s40, s39, 8
    s_and_b32 s40, s40, 15
    s_xor_b32 s40, s40, s59
    s_lshl_b32 s40, s40, 11
    s_add_u32 s40, s40, s36
    s_add_u32 m0, s44, 16384
    s_nop 0
    buffer_load_dwordx4 v10, s[12:15], s40 offen offset:0 sc1 lds
    s_add_u32 m0, s44, 16384
    s_nop 0
    buffer_load_dwordx4 v10, s[12:15], s40 offen offset:1024 sc1 lds
    s_add_u32 s41, s39, 11
    s_and_b32 s41, s41, 15
    s_xor_b32 s41, s41, s59
    s_lshl_b32 s41, s41, 17
    s_add_u32 s41, s41, s38
    s_add_u32 m0, s45, 81920
    s_add_u32 s76, s41, 0
    s_nop 0
    buffer_load_dwordx4 v8, s[16:19], s76 offen lds
    s_add_u32 m0, s45, 82944
    s_add_u32 s76, s41, 8192
    buffer_load_dwordx4 v9, s[16:19], s76 offen lds
    s_add_u32 m0, s45, 83968
    s_add_u32 s76, s41, 16384
    buffer_load_dwordx4 v8, s[16:19], s76 offen lds
    s_add_u32 m0, s45, 84992
    s_add_u32 s76, s41, 24576
    buffer_load_dwordx4 v9, s[16:19], s76 offen lds
    s_waitcnt vmcnt(16)
    s_barrier
    s_add_u32 s40, s39, 9
    s_and_b32 s40, s40, 15
    s_xor_b32 s40, s40, s59
    s_lshl_b32 s40, s40, 11
    s_add_u32 s40, s40, s36
    s_add_u32 m0, s44, 98304
    s_nop 0
    buffer_load_dwordx4 v10, s[12:15], s40 offen offset:0 sc1 lds
    s_add_u32 m0, s44, 98304
    s_nop 0
    buffer_load_dwordx4 v10, s[12:15], s40 offen offset:1024 sc1 lds
    s_add_u32 s41, s39, 12
    s_and_b32 s41, s41, 15
    s_xor_b32 s41, s41, s59
    s_lshl_b32 s41, s41, 17
    s_add_u32 s41, s41, s38
    s_add_u32 m0, s45, 122880
    s_add_u32 s76, s41, 0
    s_nop 0
    buffer_load_dwordx4 v8, s[16:19], s76 offen lds
    s_add_u32 m0, s45, 123904
    s_add_u32 s76, s41, 8192
    buffer_load_dwordx4 v9, s[16:19], s76 offen lds
    s_add_u32 m0, s45, 124928
    s_add_u32 s76, s41, 16384
    buffer_load_dwordx4 v8, s[16:19], s76 offen lds
    s_add_u32 m0, s45, 125952
    s_add_u32 s76, s41, 24576
    buffer_load_dwordx4 v9, s[16:19], s76 offen lds
    s_waitcnt vmcnt(16)
    s_barrier
    s_add_u32 s40, s39, 10
    s_and_b32 s40, s40, 15
    s_xor_b32 s40, s40, s59
    s_lshl_b32 s40, s40, 11
    s_add_u32 s40, s40, s36
    s_add_u32 m0, s44, 139264
    s_nop 0
    buffer_load_dwordx4 v10, s[12:15], s40 offen offset:0 sc1 lds
    s_add_u32 m0, s44, 139264
    s_nop 0
    buffer_load_dwordx4 v10, s[12:15], s40 offen offset:1024 sc1 lds
    s_add_u32 s41, s39, 13
    s_and_b32 s41, s41, 15
    s_xor_b32 s41, s41, s59
    s_lshl_b32 s41, s41, 17
    s_add_u32 s41, s41, s38
    s_add_u32 m0, s45, 106496
    s_add_u32 s76, s41, 0
    s_nop 0
    buffer_load_dwordx4 v8, s[16:19], s76 offen lds
    s_add_u32 m0, s45, 107520
    s_add_u32 s76, s41, 8192
    buffer_load_dwordx4 v9, s[16:19], s76 offen lds
    s_add_u32 m0, s45, 108544
    s_add_u32 s76, s41, 16384
    buffer_load_dwordx4 v8, s[16:19], s76 offen lds
    s_add_u32 m0, s45, 109568
    s_add_u32 s76, s41, 24576
    buffer_load_dwordx4 v9, s[16:19], s76 offen lds
    s_waitcnt vmcnt(16)
    s_barrier
    s_add_u32 s40, s39, 11
    s_and_b32 s40, s40, 15
    s_xor_b32 s40, s40, s59
    s_lshl_b32 s40, s40, 11
    s_add_u32 s40, s40, s36
    s_add_u32 m0, s44, 57344
    s_nop 0
    buffer_load_dwordx4 v10, s[12:15], s40 offen offset:0 sc1 lds
    s_add_u32 m0, s44, 57344
    s_nop 0
    buffer_load_dwordx4 v10, s[12:15], s40 offen offset:1024 sc1 lds
    s_add_u32 s41, s39, 14
    s_and_b32 s41, s41, 15
    s_xor_b32 s41, s41, s59
    s_lshl_b32 s41, s41, 17
    s_add_u32 s41, s41, s38
    s_add_u32 m0, s45, 147456
    s_add_u32 s76, s41, 0
    s_nop 0
    buffer_load_dwordx4 v8, s[16:19], s76 offen lds
    s_add_u32 m0, s45, 148480
    s_add_u32 s76, s41, 8192
    buffer_load_dwordx4 v9, s[16:19], s76 offen lds
    s_add_u32 m0, s45, 149504
    s_add_u32 s76, s41, 16384
    buffer_load_dwordx4 v8, s[16:19], s76 offen lds
    s_add_u32 m0, s45, 150528
    s_add_u32 s76, s41, 24576
    buffer_load_dwordx4 v9, s[16:19], s76 offen lds
    s_waitcnt vmcnt(16)
    s_barrier
    s_add_u32 s40, s39, 12
    s_and_b32 s40, s40, 15
    s_xor_b32 s40, s40, s59
    s_lshl_b32 s40, s40, 11
    s_add_u32 s40, s40, s36
    s_add_u32 m0, s44, 16384
    s_nop 0
    buffer_load_dwordx4 v10, s[12:15], s40 offen offset:0 sc1 lds
    s_add_u32 m0, s44, 16384
    s_nop 0
    buffer_load_dwordx4 v10, s[12:15], s40 offen offset:1024 sc1 lds
    s_add_u32 s41, s39, 15
    s_and_b32 s41, s41, 15
    s_xor_b32 s41, s41, s59
    s_lshl_b32 s41, s41, 17
    s_add_u32 s41, s41, s38
    s_add_u32 m0, s45, 65536
    s_add_u32 s76, s41, 0
    s_nop 0
    buffer_load_dwordx4 v8, s[16:19], s76 offen lds
    s_add_u32 m0, s45, 66560
    s_add_u32 s76, s41, 8192
    buffer_load_dwordx4 v9, s[16:19], s76 offen lds
    s_add_u32 m0, s45, 67584
    s_add_u32 s76, s41, 16384
    buffer_load_dwordx4 v8, s[16:19], s76 offen lds
    s_add_u32 m0, s45, 68608
    s_add_u32 s76, s41, 24576
    buffer_load_dwordx4 v9, s[16:19], s76 offen lds
    s_waitcnt vmcnt(16)
    s_barrier
    s_add_u32 s40, s39, 13
    s_and_b32 s40, s40, 15
    s_xor_b32 s40, s40, s59
    s_lshl_b32 s40, s40, 11
    s_add_u32 s40, s40, s36
    s_add_u32 m0, s44, 98304
    s_nop 0
    buffer_load_dwordx4 v10, s[12:15], s40 offen offset:0 sc1 lds
    s_add_u32 m0, s44, 98304
    s_nop 0
    buffer_load_dwordx4 v10, s[12:15], s40 offen offset:1024 sc1 lds
    s_waitcnt vmcnt(12)
    s_barrier
    s_add_u32 s40, s39, 14
    s_and_b32 s40, s40, 15
    s_xor_b32 s40, s40, s59
    s_lshl_b32 s40, s40, 11
    s_add_u32 s40, s40, s36
    s_add_u32 m0, s44, 139264
    s_nop 0
    buffer_load_dwordx4 v10, s[12:15], s40 offen offset:0 sc1 lds
    s_add_u32 m0, s44, 139264
    s_nop 0
    buffer_load_dwordx4 v10, s[12:15], s40 offen offset:1024 sc1 lds
    s_waitcnt vmcnt(8)
    s_barrier
    s_add_u32 s40, s39, 15
    s_and_b32 s40, s40, 15
    s_xor_b32 s40, s40, s59
    s_lshl_b32 s40, s40, 11
    s_add_u32 s40, s40, s36
    s_add_u32 m0, s44, 57344
    s_nop 0
    buffer_load_dwordx4 v10, s[12:15], s40 offen offset:0 sc1 lds
    s_add_u32 m0, s44, 57344
    s_nop 0
    buffer_load_dwordx4 v10, s[12:15], s40 offen offset:1024 sc1 lds
    s_waitcnt vmcnt(4)
    s_barrier
    s_waitcnt vmcnt(2)
    s_barrier
    s_waitcnt vmcnt(0)
    s_barrier
    s_endpgm
F_aux:
    s_barrier
    s_setprio 0
    s_sub_u32 s3, s3, 4
    s_and_b32 s36, s2, 3
    s_bfe_u32 s37, s2, 0x10002
    s_lshr_b32 s38, s2, 3
    v_lshlrev_b32 v3, 2, v0
    s_lshl_b32 s77, s36, 1
    s_add_u32 s77, s77, s37
    s_mul_i32 s77, s77, 114688
    s_lshl_b32 s46, s38, 12
    s_add_u32 s77, s77, s46
    s_lshl_b32 s46, s3, 10
    s_add_u32 s77, s77, s46
    s_cmp_ge_u32 s2, 224
    s_cselect_b32 s77, 0x7ff00000, s77
    v_mov_b32 v140, 0
    v_mov_b32 v141, 0
    v_mov_b32 v142, 0
    v_mov_b32 v143, 0
    s_add_u32 s12, s72, 0xa00000
    s_addc_u32 s13, s73, 0
    s_mov_b32 s14, 0xe0000
    s_mov_b32 s15, 0x00020000
    buffer_store_dwordx4 v[140:143], v2, s[12:15], s77 offen sc0 sc1
    s_add_u32 s12, s72, 0xb00000
    s_addc_u32 s13, s73, 0
    s_mov_b32 s14, 0x30000
    s_mov_b32 s15, 0x00020000
    s_lshl_b32 s47, s32, 8
    s_add_u32 s56, s47, 0x908000
    s_add_u32 s56, s72, s56
    s_addc_u32 s57, s73, 0
    s_cmp_eq_u32 s37, 0
    s_cselect_b32 s16, s62, s64
    s_cselect_b32 s17, s63, s65
    s_mov_b32 s18, 7340032
    s_mov_b32 s19, 0x00020000
    s_lshl_b32 s44, s3, 2
    s_add_u32 s44, s44, 24640
    v_mov_b32 v10, s44
    v_lshrrev_b32 v5, 4, v0
    v_mul_u32_u24 v6, 57344, v5
    v_and_b32 v7, 15, v0
    v_lshl_add_u32 v6, v7, 4, v6
    s_lshl_b32 s44, s36, 2
    s_add_u32 s44, s44, s3
    s_mul_i32 s54, s44, 458752
    s_lshl_b32 s45, s38, 8
    s_add_u32 s54, s54, s45
    s_cmp_ge_u32 s2, 224
    s_cselect_b32 s54, 0x70000000, s54
    s_lshl_b32 s55, s44, 7
    v_mov_b32 v8, 0
    s_mov_b32 s80, s66
    s_mov_b32 s81, s67
    s_mov_b32 s82, 0x700000
    s_mov_b32 s83, 0x00020000
    v_bfe_u32 v21, v0, 2, 2
    v_lshl_add_u32 v22, v5, 3, v21
    v_lshrrev_b32 v21, 1, v21
    v_and_b32 v20, 1, v5
    v_lshl_add_u32 v21, v20, 1, v21
    v_xor_b32 v21, s3, v21
    v_lshlrev_b32 v21, 5, v21
    v_lshl_add_u32 v21, v22, 7, v21
    v_and_b32 v20, 3, v0
    v_lshl_add_u32 v21, v20, 3, v21
    s_mov_b32 s44, 0x23453342
    s_lshl_b32 s89, s35, 2
    s_lshr_b32 s89, s44, s89
    s_and_b32 s89, s89, 15
    s_and_b32 s44, s89, 3
    s_mul_i32 s44, s44, 40960
    s_add_u32 s44, s44, 16384
    v_add_u32 v112, s44, v21
    v_lshlrev_b32_e64 v113, 2, v7
    v_lshl_add_u32 v113, v5, 12, v113
    s_lshl_b32 s91, s33, 8
    s_lshl_b32 s45, s3, 6
    s_add_u32 s91, s91, s45
    s_mul_i32 s88, s32, 12288
    s_add_u32 s88, s88, s91
    s_mov_b32 exec_hi, 0xffff
    buffer_store_dword v8, v113, s[12:15], s88 offen sc0 sc1
    s_mov_b64 exec, -1
    s_getpc_b64 s[64:65]
F_cp:
    s_add_u32 s64, s64, F_co-F_cp
    s_addc_u32 s65, s65, 0
    s_branch F_cx
F_co:
    ds_read_b64_tr_b16 v[72:73], v112 offset:0
    ds_read_b64_tr_b16 v[74:75], v112 offset:512
    ds_read_b64_tr_b16 v[76:77], v112 offset:4096
    ds_read_b64_tr_b16 v[78:79], v112 offset:4608
    ds_read_b64_tr_b16 v[80:81], v112 offset:8192
    ds_read_b64_tr_b16 v[82:83], v112 offset:8704
    ds_read_b64_tr_b16 v[84:85], v112 offset:12288
    ds_read_b64_tr_b16 v[86:87], v112 offset:12800
    ds_read_b64_tr_b16 v[88:89], v112 offset:16384
    ds_read_b64_tr_b16 v[90:91], v112 offset:16896
    ds_read_b64_tr_b16 v[92:93], v112 offset:20480
    ds_read_b64_tr_b16 v[94:95], v112 offset:20992
    v_mov_b32 v108, 0x3f803f80
    v_mov_b32 v109, 0x3f803f80
    v_mov_b32 v110, 0x3f803f80
    v_mov_b32 v111, 0x3f803f80
    s_waitcnt lgkmcnt(0)
    s_swappc_b64 s[64:65], s[66:67]
    s_setprio 3
    v_mfma_f32_16x16x32_bf16 v[96:99], v[108:111], v[72:75], 0
    v_mfma_f32_16x16x32_bf16 v[100:103], v[108:111], v[80:83], 0
    v_mfma_f32_16x16x32_bf16 v[104:107], v[108:111], v[88:91], 0
    v_mfma_f32_16x16x32_bf16 v[96:99], v[108:111], v[76:79], v[96:99]
    v_mfma_f32_16x16x32_bf16 v[100:103], v[108:111], v[84:87], v[100:103]
    v_mfma_f32_16x16x32_bf16 v[104:107], v[108:111], v[92:95], v[104:107]
    s_setprio 0
    v_cmp_eq_u32 vcc, 1, v5
    s_nop 4
    v_cndmask_b32 v96, v96, v100, vcc
    v_cmp_eq_u32 vcc, 2, v5
    s_nop 1
    v_cndmask_b32 v96, v96, v104, vcc
    v_max_u32 v96, 1, v96
    s_sleep 4
    s_mov_b32 exec_hi, 0xffff
    buffer_store_dword v96, v113, s[12:15], s88 offen sc0 sc1
    s_mov_b64 exec, -1
    s_setpc_b64 s[66:67]
F_cx:
    s_cmp_eq_u32 s3, 0
    s_cbranch_scc1 F_ax0
    s_cmp_eq_u32 s3, 2
    s_cbranch_scc1 F_ax2
    s_barrier
    s_waitcnt vmcnt(0)
    s_barrier
    s_sub_u32 s45, 2, s89
    s_cmp_gt_u32 s45, 1
    s_cbranch_scc1 CB_17
    s_swappc_b64 s[66:67], s[64:65]
CB_17:
    s_barrier
    s_sub_u32 s45, 3, s89
    s_cmp_gt_u32 s45, 1
    s_cbranch_scc1 CB_18
    s_swappc_b64 s[66:67], s[64:65]
CB_18:
    s_barrier
    s_sub_u32 s45, 4, s89
    s_cmp_gt_u32 s45, 1
    s_cbranch_scc1 CB_19
    s_swappc_b64 s[66:67], s[64:65]
CB_19:
    s_barrier
    s_sub_u32 s45, 5, s89
    s_cmp_gt_u32 s45, 1
    s_cbranch_scc1 CB_20
    s_swappc_b64 s[66:67], s[64:65]
CB_20:
    s_barrier
    s_sub_u32 s45, 6, s89
    s_cmp_gt_u32 s45, 1
    s_cbranch_scc1 CB_21
    s_swappc_b64 s[66:67], s[64:65]
CB_21:
    s_barrier
    s_barrier
    s_barrier
    s_barrier
    s_barrier
    s_branch F_aj
F_ax0:
    s_lshl_b32 s44, s32, 2
    buffer_load_dword v9, v8, s[48:51], s44 offen sc0 sc1
    s_barrier
    s_waitcnt vmcnt(0)
    v_cmp_eq_u32 vcc, 0, v9
    s_cbranch_vccz F_ax0r
PL_22:
    buffer_load_dword v9, v8, s[48:51], s44 offen sc0 sc1
    s_waitcnt vmcnt(0)
    v_cmp_gt_u32 vcc, 1, v9
    s_cbranch_vccz PD_23
    s_sleep 1
    s_branch PL_22
PD_23:
F_ax0r:
    s_barrier
    s_mov_b32 s76, 1
    s_atomic_add s76, s[56:57], 0 glc
    s_sub_u32 s45, 2, s89
    s_cmp_gt_u32 s45, 1
    s_cbranch_scc1 CB_24
    s_swappc_b64 s[66:67], s[64:65]
CB_24:
    s_barrier
    s_mov_b32 s75, 0
    s_waitcnt lgkmcnt(0)
    s_cmp_lg_u32 s76, 15
    s_cbranch_scc1 F_ax0c
    s_mov_b32 s75, 1
    s_atomic_add s75, s[70:71], 64 glc
F_ax0c:
    s_sub_u32 s45, 3, s89
    s_cmp_gt_u32 s45, 1
    s_cbranch_scc1 CB_25
    s_swappc_b64 s[66:67], s[64:65]
CB_25:
    s_barrier
    s_sub_u32 s45, 4, s89
    s_cmp_gt_u32 s45, 1
    s_cbranch_scc1 CB_26
    s_swappc_b64 s[66:67], s[64:65]
CB_26:
    s_waitcnt lgkmcnt(0)
    s_cmp_lg_u32 s75, 15
    s_cbranch_scc1 F_ax0d
    v_lshlrev_b32 v9, 8, v0
    v_mov_b32 v11, 1000
    s_mov_b32 s44, 32768
    s_mov_b64 exec, 0xffff
    buffer_store_dword v11, v9, s[40:43], s44 offen sc0 sc1
    s_mov_b64 exec, -1
F_ax0d:
    s_barrier
    s_sub_u32 s45, 5, s89
    s_cmp_gt_u32 s45, 1
    s_cbranch_scc1 CB_27
    s_swappc_b64 s[66:67], s[64:65]
CB_27:
    s_barrier
    s_sub_u32 s45, 6, s89
    s_cmp_gt_u32 s45, 1
    s_cbranch_scc1 CB_28
    s_swappc_b64 s[66:67], s[64:65]
CB_28:
    s_barrier
    s_barrier
    s_barrier
    s_barrier
    s_barrier
    s_branch F_aj
F_ax2:
    s_lshl_b32 s44, s2, 10
    buffer_store_dwordx4 v[140:143], v2, s[24:27], s44 offen sc0 sc1
    s_mov_b64 exec, -1
    s_barrier
    s_waitcnt vmcnt(0)
    s_cmp_lg_u32 s2, 2
    s_cbranch_scc1 F_ax2n
    s_barrier
    s_sub_u32 s45, 2, s89
    s_cmp_gt_u32 s45, 1
    s_cbranch_scc1 CB_29
    s_swappc_b64 s[66:67], s[64:65]
CB_29:
    s_barrier
    s_sub_u32 s45, 3, s89
    s_cmp_gt_u32 s45, 1
    s_cbranch_scc1 CB_30
    s_swappc_b64 s[66:67], s[64:65]
CB_30:
    s_barrier
    s_sub_u32 s45, 4, s89
    s_cmp_gt_u32 s45, 1
    s_cbranch_scc1 CB_31
    s_swappc_b64 s[66:67], s[64:65]
CB_31:
    s_barrier
    s_sub_u32 s45, 5, s89
    s_cmp_gt_u32 s45, 1
    s_cbranch_scc1 CB_32
    s_swappc_b64 s[66:67], s[64:65]
CB_32:
    s_barrier
    s_sub_u32 s45, 6, s89
    s_cmp_gt_u32 s45, 1
    s_cbranch_scc1 CB_33
    s_swappc_b64 s[66:67], s[64:65]
CB_33:
    s_load_dword s76, s[56:57], 0 glc
    s_barrier
    s_waitcnt lgkmcnt(0)
    s_cmp_ge_u32 s76, 1000
    s_cbranch_scc1 F_ax2g
SP_34:
    s_load_dword s76, s[56:57], 0 glc
    s_waitcnt lgkmcnt(0)
    s_cmp_ge_u32 s76, 1000
    s_cbranch_scc1 SD_35
    s_sleep 2
    s_branch SP_34
SD_35:
F_ax2g:
    s_movk_i32 s44, 0
    buffer_load_dwordx4 v[16:19], v2, s[40:43], s44 offen sc0 sc1
    s_movk_i32 s44, 1024
    buffer_load_dwordx4 v[20:23], v2, s[40:43], s44 offen sc0 sc1
    s_movk_i32 s44, 2048
    buffer_load_dwordx4 v[24:27], v2, s[40:43], s44 offen sc0 sc1
    s_movk_i32 s44, 3072
    buffer_load_dwordx4 v[28:31], v2, s[40:43], s44 offen sc0 sc1
    s_movk_i32 s44, 4096
    buffer_load_dwordx4 v[32:35], v2, s[40:43], s44 offen sc0 sc1
    s_movk_i32 s44, 5120
    buffer_load_dwordx4 v[36:39], v2, s[40:43], s44 offen sc0 sc1
    s_movk_i32 s44, 6144
    buffer_load_dwordx4 v[40:43], v2, s[40:43], s44 offen sc0 sc1
    s_movk_i32 s44, 7168
    buffer_load_dwordx4 v[44:47], v2, s[40:43], s44 offen sc0 sc1
    s_mov_b32 s53, 0
    v_and_b32 v13, 7, v0
    v_lshlrev_b32 v13, 2, v13
    v_lshrrev_b32 v9, 3, v0
    v_lshl_add_u32 v13, v9, 7, v13
    s_barrier
    s_waitcnt vmcnt(0)
    s_mov_b32 s58, 0x01010101
    s_mov_b32 s59, s58
    v_max3_u32 v48, v16, v17, v18
    v_med3_u32 v49, v16, v17, v18
    v_min3_u32 v50, v16, v17, v18
    v_med3_u32 v50, v49, v50, v19
    v_med3_u32 v49, v48, v49, v19
    v_max_u32 v48, v48, v19
    v_med3_u32 v50, v49, v50, v20
    v_med3_u32 v49, v48, v49, v20
    v_max_u32 v48, v48, v20
    v_med3_u32 v50, v49, v50, v21
    v_med3_u32 v49, v48, v49, v21
    v_max_u32 v48, v48, v21
    v_med3_u32 v50, v49, v50, v22
    v_med3_u32 v49, v48, v49, v22
    v_max_u32 v48, v48, v22
    v_med3_u32 v50, v49, v50, v23
    v_med3_u32 v49, v48, v49, v23
    v_max_u32 v48, v48, v23
    v_med3_u32 v50, v49, v50, v24
    v_med3_u32 v49, v48, v49, v24
    v_max_u32 v48, v48, v24
    v_med3_u32 v50, v49, v50, v25
    v_med3_u32 v49, v48, v49, v25
    v_max_u32 v48, v48, v25
    v_med3_u32 v50, v49, v50, v26
    v_med3_u32 v49, v48, v49, v26
    v_max_u32 v48, v48, v26
    v_med3_u32 v50, v49, v50, v27
    v_med3_u32 v49, v48, v49, v27
    v_max_u32 v48, v48, v27
    v_med3_u32 v50, v49, v50, v28
    v_med3_u32 v49, v48, v49, v28
    v_max_u32 v48, v48, v28
    v_med3_u32 v50, v49, v50, v29
    v_med3_u32 v49, v48, v49, v29
    v_max_u32 v48, v48, v29
    v_med3_u32 v50, v49, v50, v30
    v_med3_u32 v49, v48, v49, v30
    v_max_u32 v48, v48, v30
    v_med3_u32 v50, v49, v50, v31
    v_med3_u32 v49, v48, v49, v31
    v_max_u32 v48, v48, v31
    v_med3_u32 v50, v49, v50, v32
    v_med3_u32 v49, v48, v49, v32
    v_max_u32 v48, v48, v32
    s_barrier
    v_med3_u32 v50, v49, v50, v33
    v_med3_u32 v49, v48, v49, v33
    v_max_u32 v48, v48, v33
    v_med3_u32 v50, v49, v50, v34
    v_med3_u32 v49, v48, v49, v34
    v_max_u32 v48, v48, v34
    v_med3_u32 v50, v49, v50, v35
    v_med3_u32 v49, v48, v49, v35
    v_max_u32 v48, v48, v35
    v_med3_u32 v50, v49, v50, v36
    v_med3_u32 v49, v48, v49, v36
    v_max_u32 v48, v48, v36
    v_med3_u32 v50, v49, v50, v37
    v_med3_u32 v49, v48, v49, v37
    v_max_u32 v48, v48, v37
    v_med3_u32 v50, v49, v50, v38
    v_med3_u32 v49, v48, v49, v38
    v_max_u32 v48, v48, v38
    v_med3_u32 v50, v49, v50, v39
    v_med3_u32 v49, v48, v49, v39
    v_max_u32 v48, v48, v39
    v_med3_u32 v50, v49, v50, v40
    v_med3_u32 v49, v48, v49, v40
    v_max_u32 v48, v48, v40
    v_med3_u32 v50, v49, v50, v41
    v_med3_u32 v49, v48, v49, v41
    v_max_u32 v48, v48, v41
    v_med3_u32 v50, v49, v50, v42
    v_med3_u32 v49, v48, v49, v42
    v_max_u32 v48, v48, v42
    v_med3_u32 v50, v49, v50, v43
    v_med3_u32 v49, v48, v49, v43
    v_max_u32 v48, v48, v43
    v_med3_u32 v50, v49, v50, v44
    v_med3_u32 v49, v48, v49, v44
    v_max_u32 v48, v48, v44
    v_med3_u32 v50, v49, v50, v45
    v_med3_u32 v49, v48, v49, v45
    v_max_u32 v48, v48, v45
    v_med3_u32 v50, v49, v50, v46
    v_med3_u32 v49, v48, v49, v46
    v_max_u32 v48, v48, v46
    v_med3_u32 v50, v49, v50, v47
    v_med3_u32 v49, v48, v49, v47
    v_max_u32 v48, v48, v47
    v_mov_b32 v4, v48
    s_nop 1
    v_max_u32_dpp v4, v4, v4 row_shr:1 row_mask:0xf bank_mask:0xf bound_ctrl:0
    s_nop 1
    v_max_u32_dpp v4, v4, v4 row_shr:2 row_mask:0xf bank_mask:0xf bound_ctrl:0
    s_nop 1
    v_max_u32_dpp v4, v4, v4 row_shr:4 row_mask:0xf bank_mask:0xf bound_ctrl:0
    s_nop 1
    v_max_u32_dpp v4, v4, v4 row_shr:8 row_mask:0xf bank_mask:0xf bound_ctrl:0
    s_nop 1
    v_max_u32_dpp v4, v4, v4 row_bcast:15 row_mask:0xa bank_mask:0xf
    s_nop 1
    v_max_u32_dpp v4, v4, v4 row_bcast:31 row_mask:0xc bank_mask:0xf
    s_nop 0
    v_readlane_b32 s52, v4, 63
    s_lshl_b64 exec, s[58:59], 0
    s_nop 0
    v_mov_b32 v12, s52
    s_mov_b64 exec, -1
    v_cmp_eq_u32 vcc, s52, v48
    s_nop 1
    v_cndmask_b32 v48, v48, v49, vcc
    v_cndmask_b32 v49, v49, v50, vcc
    v_cndmask_b32 v50, v50, 0, vcc
    s_barrier
    v_mov_b32 v4, v48
    s_nop 1
    v_max_u32_dpp v4, v4, v4 row_shr:1 row_mask:0xf bank_mask:0xf bound_ctrl:0
    s_nop 1
    v_max_u32_dpp v4, v4, v4 row_shr:2 row_mask:0xf bank_mask:0xf bound_ctrl:0
    s_nop 1
    v_max_u32_dpp v4, v4, v4 row_shr:4 row_mask:0xf bank_mask:0xf bound_ctrl:0
    s_nop 1
    v_max_u32_dpp v4, v4, v4 row_shr:8 row_mask:0xf bank_mask:0xf bound_ctrl:0
    s_nop 1
    v_max_u32_dpp v4, v4, v4 row_bcast:15 row_mask:0xa bank_mask:0xf
    s_nop 1
    v_max_u32_dpp v4, v4, v4 row_bcast:31 row_mask:0xc bank_mask:0xf
    s_nop 0
    v_readlane_b32 s52, v4, 63
    s_lshl_b64 exec, s[58:59], 1
    s_nop 0
    v_mov_b32 v12, s52
    s_mov_b64 exec, -1
    v_cmp_eq_u32 vcc, s52, v48
    s_nop 1
    v_cndmask_b32 v48, v48, v49, vcc
    v_cndmask_b32 v49, v49, v50, vcc
    v_cndmask_b32 v50, v50, 0, vcc
    v_mov_b32 v4, v48
    s_nop 1
    v_max_u32_dpp v4, v4, v4 row_shr:1 row_mask:0xf bank_mask:0xf bound_ctrl:0
    s_nop 1
    v_max_u32_dpp v4, v4, v4 row_shr:2 row_mask:0xf bank_mask:0xf bound_ctrl:0
    s_nop 1
    v_max_u32_dpp v4, v4, v4 row_shr:4 row_mask:0xf bank_mask:0xf bound_ctrl:0
    s_nop 1
    v_max_u32_dpp v4, v4, v4 row_shr:8 row_mask:0xf bank_mask:0xf bound_ctrl:0
    s_nop 1
    v_max_u32_dpp v4, v4, v4 row_bcast:15 row_mask:0xa bank_mask:0xf
    s_nop 1
    v_max_u32_dpp v4, v4, v4 row_bcast:31 row_mask:0xc bank_mask:0xf
    s_nop 0
    v_readlane_b32 s52, v4, 63
    s_lshl_b64 exec, s[58:59], 2
    s_nop 0
    v_mov_b32 v12, s52
    s_mov_b64 exec, -1
    v_cmp_eq_u32 vcc, s52, v48
    s_nop 1
    v_cndmask_b32 v48, v48, v49, vcc
    v_cndmask_b32 v49, v49, v50, vcc
    v_cndmask_b32 v50, v50, 0, vcc
    v_mov_b32 v4, v48
    s_nop 1
    v_max_u32_dpp v4, v4, v4 row_shr:1 row_mask:0xf bank_mask:0xf bound_ctrl:0
    s_nop 1
    v_max_u32_dpp v4, v4, v4 row_shr:2 row_mask:0xf bank_mask:0xf bound_ctrl:0
    s_nop 1
    v_max_u32_dpp v4, v4, v4 row_shr:4 row_mask:0xf bank_mask:0xf bound_ctrl:0
    s_nop 1
    v_max_u32_dpp v4, v4, v4 row_shr:8 row_mask:0xf bank_mask:0xf bound_ctrl:0
    s_nop 1
    v_max_u32_dpp v4, v4, v4 row_bcast:15 row_mask:0xa bank_mask:0xf
    s_nop 1
    v_max_u32_dpp v4, v4, v4 row_bcast:31 row_mask:0xc bank_mask:0xf
    s_nop 0
    v_readlane_b32 s52, v4, 63
    s_lshl_b64 exec, s[58:59], 3
    s_nop 0
    v_mov_b32 v12, s52
    s_mov_b64 exec, -1
    v_cmp_eq_u32 vcc, s52, v48
    s_nop 1
    v_cndmask_b32 v48, v48, v49, vcc
    v_cndmask_b32 v49, v49, v50, vcc
    v_cndmask_b32 v50, v50, 0, vcc
    v_mov_b32 v4, v48
    s_nop 1
    v_max_u32_dpp v4, v4, v4 row_shr:1 row_mask:0xf bank_mask:0xf bound_ctrl:0
    s_nop 1
    v_max_u32_dpp v4, v4, v4 row_shr:2 row_mask:0xf bank_mask:0xf bound_ctrl:0
    s_nop 1
    v_max_u32_dpp v4, v4, v4 row_shr:4 row_mask:0xf bank_mask:0xf bound_ctrl:0
    s_nop 1
    v_max_u32_dpp v4, v4, v4 row_shr:8 row_mask:0xf bank_mask:0xf bound_ctrl:0
    s_nop 1
    v_max_u32_dpp v4, v4, v4 row_bcast:15 row_mask:0xa bank_mask:0xf
    s_nop 1
    v_max_u32_dpp v4, v4, v4 row_bcast:31 row_mask:0xc bank_mask:0xf
    s_nop 0
    v_readlane_b32 s52, v4, 63
    s_lshl_b64 exec, s[58:59], 4
    s_nop 0
    v_mov_b32 v12, s52
    s_mov_b64 exec, -1
    v_cmp_eq_u32 vcc, s52, v48
    s_nop 1
    v_cndmask_b32 v48, v48, v49, vcc
    v_cndmask_b32 v49, v49, v50, vcc
    v_cndmask_b32 v50, v50, 0, vcc
    s_barrier
    v_mov_b32 v4, v48
    s_nop 1
    v_max_u32_dpp v4, v4, v4 row_shr:1 row_mask:0xf bank_mask:0xf bound_ctrl:0
    s_nop 1
    v_max_u32_dpp v4, v4, v4 row_shr:2 row_mask:0xf bank_mask:0xf bound_ctrl:0
    s_nop 1
    v_max_u32_dpp v4, v4, v4 row_shr:4 row_mask:0xf bank_mask:0xf bound_ctrl:0
    s_nop 1
    v_max_u32_dpp v4, v4, v4 row_shr:8 row_mask:0xf bank_mask:0xf bound_ctrl:0
    s_nop 1
    v_max_u32_dpp v4, v4, v4 row_bcast:15 row_mask:0xa bank_mask:0xf
    s_nop 1
    v_max_u32_dpp v4, v4, v4 row_bcast:31 row_mask:0xc bank_mask:0xf
    s_nop 0
    v_readlane_b32 s52, v4, 63
    s_lshl_b64 exec, s[58:59], 5
    s_nop 0
    v_mov_b32 v12, s52
    s_mov_b64 exec, -1
    v_cmp_eq_u32 vcc, s52, v48
    s_nop 1
    v_cndmask_b32 v48, v48, v49, vcc
    v_cndmask_b32 v49, v49, v50, vcc
    v_cndmask_b32 v50, v50, 0, vcc
    v_mov_b32 v4, v48
    s_nop 1
    v_max_u32_dpp v4, v4, v4 row_shr:1 row_mask:0xf bank_mask:0xf bound_ctrl:0
    s_nop 1
    v_max_u32_dpp v4, v4, v4 row_shr:2 row_mask:0xf bank_mask:0xf bound_ctrl:0
    s_nop 1
    v_max_u32_dpp v4, v4, v4 row_shr:4 row_mask:0xf bank_mask:0xf bound_ctrl:0
    s_nop 1
    v_max_u32_dpp v4, v4, v4 row_shr:8 row_mask:0xf bank_mask:0xf bound_ctrl:0
    s_nop 1
    v_max_u32_dpp v4, v4, v4 row_bcast:15 row_mask:0xa bank_mask:0xf
    s_nop 1
    v_max_u32_dpp v4, v4, v4 row_bcast:31 row_mask:0xc bank_mask:0xf
    s_nop 0
    v_readlane_b32 s52, v4, 63
    s_lshl_b64 exec, s[58:59], 6
    s_nop 0
    v_mov_b32 v12, s52
    s_mov_b64 exec, -1
    v_cmp_eq_u32 vcc, s52, v48
    s_nop 1
    v_cndmask_b32 v48, v48, v49, vcc
    v_cndmask_b32 v49, v49, v50, vcc
    v_cndmask_b32 v50, v50, 0, vcc
    v_mov_b32 v4, v48
    s_nop 1
    v_max_u32_dpp v4, v4, v4 row_shr:1 row_mask:0xf bank_mask:0xf bound_ctrl:0
    s_nop 1
    v_max_u32_dpp v4, v4, v4 row_shr:2 row_mask:0xf bank_mask:0xf bound_ctrl:0
    s_nop 1
    v_max_u32_dpp v4, v4, v4 row_shr:4 row_mask:0xf bank_mask:0xf bound_ctrl:0
    s_nop 1
    v_max_u32_dpp v4, v4, v4 row_shr:8 row_mask:0xf bank_mask:0xf bound_ctrl:0
    s_nop 1
    v_max_u32_dpp v4, v4, v4 row_bcast:15 row_mask:0xa bank_mask:0xf
    s_nop 1
    v_max_u32_dpp v4, v4, v4 row_bcast:31 row_mask:0xc bank_mask:0xf
    s_nop 0
    v_readlane_b32 s52, v4, 63
    s_lshl_b64 exec, s[58:59], 7
    s_nop 0
    v_mov_b32 v12, s52
    s_mov_b64 exec, -1
    v_cmp_eq_u32 vcc, 0, v48
    s_cbranch_vccz F_tk2
    s_mov_b32 s52, 0
    s_mov_b32 s45, 0
F_tk1:
    v_subrev_u32 v16, s52, v16
    v_subrev_u32 v17, s52, v17
    v_subrev_u32 v18, s52, v18
    v_subrev_u32 v19, s52, v19
    v_subrev_u32 v20, s52, v20
    v_subrev_u32 v21, s52, v21
    v_subrev_u32 v22, s52, v22
    v_subrev_u32 v23, s52, v23
    v_subrev_u32 v24, s52, v24
    v_subrev_u32 v25, s52, v25
    v_subrev_u32 v26, s52, v26
    v_subrev_u32 v27, s52, v27
    v_subrev_u32 v28, s52, v28
    v_subrev_u32 v29, s52, v29
    v_subrev_u32 v30, s52, v30
    v_subrev_u32 v31, s52, v31
    v_subrev_u32 v32, s52, v32
    v_subrev_u32 v33, s52, v33
    v_subrev_u32 v34, s52, v34
    v_subrev_u32 v35, s52, v35
    v_subrev_u32 v36, s52, v36
    v_subrev_u32 v37, s52, v37
    v_subrev_u32 v38, s52, v38
    v_subrev_u32 v39, s52, v39
    v_subrev_u32 v40, s52, v40
    v_subrev_u32 v41, s52, v41
    v_subrev_u32 v42, s52, v42
    v_subrev_u32 v43, s52, v43
    v_subrev_u32 v44, s52, v44
    v_subrev_u32 v45, s52, v45
    v_subrev_u32 v46, s52, v46
    v_subrev_u32 v47, s52, v47
    v_max3_u32 v4, v16, v17, v18
    v_max3_u32 v4, v4, v19, v20
    v_max3_u32 v4, v4, v21, v22
    v_max3_u32 v4, v4, v23, v24
    v_max3_u32 v4, v4, v25, v26
    v_max3_u32 v4, v4, v27, v28
    v_max3_u32 v4, v4, v29, v30
    v_max3_u32 v4, v4, v31, v32
    v_max3_u32 v4, v4, v33, v34
    v_max3_u32 v4, v4, v35, v36
    v_max3_u32 v4, v4, v37, v38
    v_max3_u32 v4, v4, v39, v40
    v_max3_u32 v4, v4, v41, v42
    v_max3_u32 v4, v4, v43, v44
    v_max3_u32 v4, v4, v45, v46
    v_max_u32 v4, v4, v47
    s_nop 1
    v_max_u32_dpp v4, v4, v4 row_shr:1 row_mask:0xf bank_mask:0xf bound_ctrl:0
    s_nop 1
    v_max_u32_dpp v4, v4, v4 row_shr:2 row_mask:0xf bank_mask:0xf bound_ctrl:0
    s_nop 1
    v_max_u32_dpp v4, v4, v4 row_shr:4 row_mask:0xf bank_mask:0xf bound_ctrl:0
    s_nop 1
    v_max_u32_dpp v4, v4, v4 row_shr:8 row_mask:0xf bank_mask:0xf bound_ctrl:0
    s_nop 1
    v_max_u32_dpp v4, v4, v4 row_bcast:15 row_mask:0xa bank_mask:0xf
    s_nop 1
    v_max_u32_dpp v4, v4, v4 row_bcast:31 row_mask:0xc bank_mask:0xf
    s_nop 0
    v_readlane_b32 s52, v4, 63
    s_nop 0
    s_add_u32 s53, s53, s52
    s_lshl_b64 exec, s[58:59], s45
    v_mov_b32 v12, s53
    s_mov_b64 exec, -1
    s_add_u32 s45, s45, 1
    s_cmp_lt_u32 s45, 8
    s_cbranch_scc1 F_tk1
F_tk2:
    v_or_b32 v12, 0x8000, v12
    s_mov_b32 s44, 184320
    buffer_store_dword v12, v13, s[24:27], s44 offen offset:0 sc0 sc1
    buffer_store_dword v12, v13, s[24:27], s44 offen offset:1024 sc0 sc1
    buffer_store_dword v12, v13, s[24:27], s44 offen offset:2048 sc0 sc1
    buffer_store_dword v12, v13, s[24:27], s44 offen offset:3072 sc0 sc1
    s_mov_b32 s44, 188416
    buffer_store_dword v12, v13, s[24:27], s44 offen offset:0 sc0 sc1
    buffer_store_dword v12, v13, s[24:27], s44 offen offset:1024 sc0 sc1
    buffer_store_dword v12, v13, s[24:27], s44 offen offset:2048 sc0 sc1
    buffer_store_dword v12, v13, s[24:27], s44 offen offset:3072 sc0 sc1
    s_branch F_aj
F_ax2n:
    s_barrier
    s_sub_u32 s45, 2, s89
    s_cmp_gt_u32 s45, 1
    s_cbranch_scc1 CB_36
    s_swappc_b64 s[66:67], s[64:65]
CB_36:
    s_barrier
    s_sub_u32 s45, 3, s89
    s_cmp_gt_u32 s45, 1
    s_cbranch_scc1 CB_37
    s_swappc_b64 s[66:67], s[64:65]
CB_37:
    s_barrier
    s_sub_u32 s45, 4, s89
    s_cmp_gt_u32 s45, 1
    s_cbranch_scc1 CB_38
    s_swappc_b64 s[66:67], s[64:65]
CB_38:
    s_barrier
    s_sub_u32 s45, 5, s89
    s_cmp_gt_u32 s45, 1
    s_cbranch_scc1 CB_39
    s_swappc_b64 s[66:67], s[64:65]
CB_39:
    s_barrier
    s_sub_u32 s45, 6, s89
    s_cmp_gt_u32 s45, 1
    s_cbranch_scc1 CB_40
    s_swappc_b64 s[66:67], s[64:65]
CB_40:
    s_barrier
    s_load_dword s76, s[56:57], 0 glc
    s_barrier
    s_waitcnt lgkmcnt(0)
    s_cmp_ge_u32 s76, 1000
    s_cbranch_scc1 F_ax2h
SP_41:
    s_load_dword s76, s[56:57], 0 glc
    s_waitcnt lgkmcnt(0)
    s_cmp_ge_u32 s76, 1000
    s_cbranch_scc1 SD_42
    s_sleep 8
    s_branch SP_41
SD_42:
F_ax2h:
    s_barrier
    s_barrier
    s_barrier
F_aj:
    s_add_u32 s12, s72, 0xa00000
    s_addc_u32 s13, s73, 0
    s_mov_b32 s14, 0xe0000
    s_mov_b32 s15, 0x00020000
    s_and_b32 s46, s2, 63
    s_lshl_b32 s46, s46, 7
    s_add_u32 s56, s46, 0x82d000
    s_add_u32 s56, s72, s56
    s_addc_u32 s57, s73, 0
    s_mov_b32 s58, 0x01010101
    s_mov_b32 s59, s58
    s_mov_b32 s52, 0x05040100
    s_mov_b32 s53, 0x07060302
    v_and_b32 v13, 3, v0
    v_lshlrev_b32 v13, 2, v13
    v_add_u32 v13, 24656, v13
    s_mul_i32 s78, s28, 112
    s_mul_i32 s79, s3, 28
    s_add_u32 s78, s78, s79
    s_lshl_b32 s78, s78, 11
    s_lshl_b32 s79, s29, 8
    s_add_u32 s78, s78, s79

    v_mul_u32_u24 v160, 14336, v5
    v_lshl_add_u32 v160, v7, 4, v160
    s_and_b32 s88, s3, 1
    s_lshl_b32 s88, s88, 12
    s_lshr_b32 s45, s3, 1
    s_mul_i32 s45, s45, 24576
    s_add_u32 s88, s88, s45
    v_subrev_u32 v163, 16, v13
    v_lshrrev_b32 v164, 1, v5
    v_lshlrev_b32 v164, 2, v164
    v_and_b32 v165, 7, v7
    v_xor_b32 v164, v164, v165
    v_lshlrev_b32 v164, 5, v164
    v_lshl_add_u32 v164, v7, 8, v164
    v_and_b32 v165, 1, v5
    v_lshl_add_u32 v164, v165, 4, v164
    s_lshl_b32 s45, s3, 12
    s_add_u32 s45, s45, 106496
    v_add_u32 v164, s45, v164
    s_lshl_b32 s45, s3, 2
    v_add_u32 v165, s45, v5
    v_and_b32 v165, 7, v165
    v_lshlrev_b32 v165, 5, v165
    v_xor_b32 v165, v165, v2
    s_lshl_b32 s45, s3, 10
    s_add_u32 s45, s45, 106496
    v_add_u32 v165, s45, v165
    v_add_u32_e64 v162, 16, v13
    s_barrier
    s_barrier
    s_sleep 2
    s_add_u32 s45, s54, 0
    buffer_load_dwordx4 v[72:75], v6, s[16:19], s45 offen nt
    s_add_u32 s45, s54, 7168
    buffer_load_dwordx4 v[76:79], v6, s[16:19], s45 offen nt
    s_add_u32 s45, s54, 14336
    buffer_load_dwordx4 v[80:83], v6, s[16:19], s45 offen nt
    s_add_u32 s45, s54, 21504
    buffer_load_dwordx4 v[84:87], v6, s[16:19], s45 offen nt
    s_barrier
    s_nop 0
    s_load_dwordx8 s[60:67], s[56:57], 0 glc
    s_add_u32 s45, s54, 28672
    buffer_load_dwordx4 v[88:91], v6, s[16:19], s45 offen nt
    s_add_u32 s45, s54, 35840
    buffer_load_dwordx4 v[92:95], v6, s[16:19], s45 offen nt
    s_add_u32 s45, s54, 43008
    buffer_load_dwordx4 v[96:99], v6, s[16:19], s45 offen nt
    s_add_u32 s45, s54, 50176
    buffer_load_dwordx4 v[100:103], v6, s[16:19], s45 offen nt
    s_barrier
    s_setprio 1
F_sc:
    s_waitcnt lgkmcnt(0)
    s_and_b64 s[74:75], s[60:61], s[62:63]
    s_and_b64 s[74:75], s[74:75], s[64:65]
    s_and_b64 s[74:75], s[74:75], s[66:67]
    s_and_b32 s74, s74, s75
    s_bitcmp1_b32 s74, 15
    s_cbranch_scc1 F_sd
    s_sleep 4
    s_load_dwordx8 s[60:67], s[56:57], 0 glc
    s_branch F_sc
F_sd:

    s_lshl_b64 exec, s[58:59], 0
    v_mov_b32 v4, s60
    s_lshl_b64 exec, s[58:59], 1
    v_mov_b32 v4, s61
    s_lshl_b64 exec, s[58:59], 2
    v_mov_b32 v4, s62
    s_lshl_b64 exec, s[58:59], 3
    v_mov_b32 v4, s63
    s_lshl_b64 exec, s[58:59], 4
    v_mov_b32 v4, s64
    s_lshl_b64 exec, s[58:59], 5
    v_mov_b32 v4, s65
    s_lshl_b64 exec, s[58:59], 6
    v_mov_b32 v4, s66
    s_lshl_b64 exec, s[58:59], 7
    v_mov_b32 v4, s67
    s_mov_b64 exec, -1
    s_mov_b32 s46, 65536
    v_and_b32 v4, 0x7ff, v4
    v_sub_u32 v4, 2047, v4
    v_lshlrev_b32 v9, 4, v4
    v_lshlrev_b32 v4, 11, v4
    v_lshl_add_u32 v4, v5, 4, v4

    buffer_load_dwordx4 v[64:67], v4, s[20:23], s55 offen
    buffer_load_dwordx4 v[68:71], v4, s[20:23], s55 offen offset:64
    buffer_load_dwordx2 v[14:15], v9, s[40:43], s46 offen sc0 sc1
    s_cmp_lt_u32 s2, 224
    s_cbranch_scc1 F_ag
    s_add_u32 s79, s78, 0
    buffer_load_dwordx4 v[16:19], v160, s[80:83], s79 offen nt
    s_add_u32 s79, s78, 2048
    buffer_load_dwordx4 v[20:23], v160, s[80:83], s79 offen nt
    s_add_u32 s79, s78, 4096
    buffer_load_dwordx4 v[24:27], v160, s[80:83], s79 offen nt
    s_add_u32 s79, s78, 6144
    buffer_load_dwordx4 v[28:31], v160, s[80:83], s79 offen nt
    s_add_u32 s79, s78, 8192
    buffer_load_dwordx4 v[144:147], v160, s[80:83], s79 offen nt
    s_add_u32 s79, s78, 10240
    buffer_load_dwordx4 v[148:151], v160, s[80:83], s79 offen nt
    s_add_u32 s79, s78, 12288
    buffer_load_dwordx4 v[152:155], v160, s[80:83], s79 offen nt
    s_sleep 32
    s_branch F_adown
F_ag:
    s_add_u32 s45, s54, 229376
    buffer_load_dwordx4 v[104:107], v6, s[16:19], s45 offen nt
    s_add_u32 s45, s54, 236544
    buffer_load_dwordx4 v[108:111], v6, s[16:19], s45 offen nt
    s_add_u32 s45, s54, 243712
    buffer_load_dwordx4 v[112:115], v6, s[16:19], s45 offen nt
    s_add_u32 s45, s54, 250880
    buffer_load_dwordx4 v[116:119], v6, s[16:19], s45 offen nt
    s_add_u32 s45, s54, 258048
    buffer_load_dwordx4 v[120:123], v6, s[16:19], s45 offen nt
    s_add_u32 s45, s54, 265216
    buffer_load_dwordx4 v[124:127], v6, s[16:19], s45 offen nt
    s_add_u32 s45, s54, 272384
    buffer_load_dwordx4 v[128:131], v6, s[16:19], s45 offen nt
    s_add_u32 s45, s54, 279552
    buffer_load_dwordx4 v[132:135], v6, s[16:19], s45 offen nt
    s_waitcnt vmcnt(8)
    v_lshlrev_b32 v34, 16, v64
    v_and_b32 v35, 0xffff0000, v64
    v_lshlrev_b32 v36, 16, v65
    v_and_b32 v37, 0xffff0000, v65
    v_lshlrev_b32 v38, 16, v66
    v_and_b32 v39, 0xffff0000, v66
    v_lshlrev_b32 v40, 16, v67
    v_and_b32 v41, 0xffff0000, v67
    v_lshlrev_b32 v42, 16, v68
    v_and_b32 v43, 0xffff0000, v68
    v_lshlrev_b32 v44, 16, v69
    v_and_b32 v45, 0xffff0000, v69
    v_lshlrev_b32 v46, 16, v70
    v_and_b32 v47, 0xffff0000, v70
    v_lshlrev_b32 v48, 16, v71
    v_and_b32 v49, 0xffff0000, v71
    v_add_f32 v34, v34, v14
    v_add_f32 v35, v35, v14
    v_add_f32 v36, v36, v14
    v_add_f32 v37, v37, v14
    v_add_f32 v38, v38, v14
    v_add_f32 v39, v39, v14
    v_add_f32 v40, v40, v14
    v_add_f32 v41, v41, v14
    v_add_f32 v42, v42, v14
    v_add_f32 v43, v43, v14
    v_add_f32 v44, v44, v14
    v_add_f32 v45, v45, v14
    v_add_f32 v46, v46, v14
    v_add_f32 v47, v47, v14
    v_add_f32 v48, v48, v14
    v_add_f32_e64 v49, v49, v14
    v_cvt_pk_bf16_f32 v64, v34, v35
    v_cvt_pk_bf16_f32 v65, v36, v37
    v_cvt_pk_bf16_f32 v66, v38, v39
    v_cvt_pk_bf16_f32 v67, v40, v41
    v_cvt_pk_bf16_f32 v68, v42, v43
    v_cvt_pk_bf16_f32 v69, v44, v45
    v_cvt_pk_bf16_f32 v70, v46, v47
    v_cvt_pk_bf16_f32 v71, v48, v49
    v_lshlrev_b32 v34, 16, v64
    v_and_b32 v35, 0xffff0000, v64
    v_lshlrev_b32 v36, 16, v65
    v_and_b32 v37, 0xffff0000, v65
    v_lshlrev_b32 v38, 16, v66
    v_and_b32 v39, 0xffff0000, v66
    v_lshlrev_b32 v40, 16, v67
    v_and_b32 v41, 0xffff0000, v67
    v_lshlrev_b32 v42, 16, v68
    v_and_b32 v43, 0xffff0000, v68
    v_lshlrev_b32 v44, 16, v69
    v_and_b32 v45, 0xffff0000, v69
    v_lshlrev_b32 v46, 16, v70
    v_and_b32 v47, 0xffff0000, v70
    v_lshlrev_b32 v48, 16, v71
    v_and_b32 v49, 0xffff0000, v71
    v_mul_f32 v34, v34, v15
    v_mul_f32 v35, v35, v15
    v_mul_f32 v36, v36, v15
    v_mul_f32 v37, v37, v15
    v_mul_f32 v38, v38, v15
    v_mul_f32 v39, v39, v15
    v_mul_f32 v40, v40, v15
    v_mul_f32 v41, v41, v15
    v_mul_f32 v42, v42, v15
    v_mul_f32 v43, v43, v15
    v_mul_f32 v44, v44, v15
    v_mul_f32 v45, v45, v15
    v_mul_f32 v46, v46, v15
    v_mul_f32 v47, v47, v15
    v_mul_f32 v48, v48, v15
    v_mul_f32 v49, v49, v15
    v_cvt_pk_bf16_f32 v64, v34, v35
    v_cvt_pk_bf16_f32 v65, v36, v37
    v_cvt_pk_bf16_f32 v66, v38, v39
    v_cvt_pk_bf16_f32 v67, v40, v41
    v_cvt_pk_bf16_f32 v68, v42, v43
    v_cvt_pk_bf16_f32 v69, v44, v45
    v_cvt_pk_bf16_f32 v70, v46, v47
    v_cvt_pk_bf16_f32 v71, v48, v49
    s_waitcnt vmcnt(8)
    v_perm_b32 v136, v76, v72, s52
    v_perm_b32 v137, v84, v80, s52
    v_perm_b32 v138, v92, v88, s52
    v_perm_b32 v139, v100, v96, s52
    s_nop 1
    v_mfma_f32_16x16x32_bf16 v[32:35], v[64:67], v[136:139], 0
    v_perm_b32 v140, v76, v72, s53
    v_perm_b32 v141, v84, v80, s53
    v_perm_b32 v142, v92, v88, s53
    v_perm_b32 v143, v100, v96, s53
    s_nop 1
    v_mfma_f32_16x16x32_bf16 v[36:39], v[64:67], v[140:143], 0
    v_perm_b32 v136, v77, v73, s52
    v_perm_b32 v137, v85, v81, s52
    v_perm_b32 v138, v93, v89, s52
    v_perm_b32 v139, v101, v97, s52
    s_nop 1
    v_mfma_f32_16x16x32_bf16 v[40:43], v[64:67], v[136:139], 0
    v_perm_b32 v140, v77, v73, s53
    v_perm_b32 v141, v85, v81, s53
    v_perm_b32 v142, v93, v89, s53
    v_perm_b32 v143, v101, v97, s53
    s_nop 1
    v_mfma_f32_16x16x32_bf16 v[44:47], v[64:67], v[140:143], 0
    v_perm_b32 v136, v78, v74, s52
    v_perm_b32 v137, v86, v82, s52
    v_perm_b32 v138, v94, v90, s52
    v_perm_b32 v139, v102, v98, s52
    s_nop 1
    v_mfma_f32_16x16x32_bf16 v[48:51], v[64:67], v[136:139], 0
    v_perm_b32 v140, v78, v74, s53
    v_perm_b32 v141, v86, v82, s53
    v_perm_b32 v142, v94, v90, s53
    v_perm_b32 v143, v102, v98, s53
    s_nop 1
    v_mfma_f32_16x16x32_bf16 v[52:55], v[64:67], v[140:143], 0
    v_perm_b32 v136, v79, v75, s52
    v_perm_b32 v137, v87, v83, s52
    v_perm_b32 v138, v95, v91, s52
    v_perm_b32 v139, v103, v99, s52
    s_nop 1
    v_mfma_f32_16x16x32_bf16 v[56:59], v[64:67], v[136:139], 0
    v_perm_b32 v140, v79, v75, s53
    v_perm_b32 v141, v87, v83, s53
    v_perm_b32 v142, v95, v91, s53
    v_perm_b32 v143, v103, v99, s53
    s_nop 1
    v_mfma_f32_16x16x32_bf16 v[60:63], v[64:67], v[140:143], 0
    s_waitcnt vmcnt(0)
    s_add_u32 s79, s78, 0
    s_nop 0
    buffer_load_dwordx4 v[16:19], v160, s[80:83], s79 offen nt
    s_add_u32 s79, s78, 2048
    buffer_load_dwordx4 v[20:23], v160, s[80:83], s79 offen nt
    s_add_u32 s79, s78, 4096
    buffer_load_dwordx4 v[24:27], v160, s[80:83], s79 offen nt
    s_add_u32 s79, s78, 6144
    buffer_load_dwordx4 v[28:31], v160, s[80:83], s79 offen nt
    s_add_u32 s79, s78, 8192
    buffer_load_dwordx4 v[144:147], v160, s[80:83], s79 offen nt
    s_add_u32 s79, s78, 10240
    buffer_load_dwordx4 v[148:151], v160, s[80:83], s79 offen nt
    s_add_u32 s79, s78, 12288
    buffer_load_dwordx4 v[152:155], v160, s[80:83], s79 offen nt
    v_perm_b32 v136, v108, v104, s52
    v_perm_b32 v137, v116, v112, s52
    v_perm_b32 v138, v124, v120, s52
    v_perm_b32 v139, v132, v128, s52
    s_nop 1
    v_mfma_f32_16x16x32_bf16 v[32:35], v[68:71], v[136:139], v[32:35]
    v_perm_b32 v140, v108, v104, s53
    v_perm_b32 v141, v116, v112, s53
    v_perm_b32 v142, v124, v120, s53
    v_perm_b32 v143, v132, v128, s53
    s_nop 1
    v_mfma_f32_16x16x32_bf16 v[36:39], v[68:71], v[140:143], v[36:39]
    v_perm_b32 v136, v109, v105, s52
    v_perm_b32 v137, v117, v113, s52
    v_perm_b32 v138, v125, v121, s52
    v_perm_b32 v139, v133, v129, s52
    s_nop 1
    v_mfma_f32_16x16x32_bf16 v[40:43], v[68:71], v[136:139], v[40:43]
    v_perm_b32 v140, v109, v105, s53
    v_perm_b32 v141, v117, v113, s53
    v_perm_b32 v142, v125, v121, s53
    v_perm_b32 v143, v133, v129, s53
    s_nop 1
    v_mfma_f32_16x16x32_bf16 v[44:47], v[68:71], v[140:143], v[44:47]
    v_perm_b32 v136, v110, v106, s52
    v_perm_b32 v137, v118, v114, s52
    v_perm_b32 v138, v126, v122, s52
    v_perm_b32 v139, v134, v130, s52
    s_nop 1
    v_mfma_f32_16x16x32_bf16 v[48:51], v[68:71], v[136:139], v[48:51]
    v_perm_b32 v140, v110, v106, s53
    v_perm_b32 v141, v118, v114, s53
    v_perm_b32 v142, v126, v122, s53
    v_perm_b32 v143, v134, v130, s53
    s_nop 1
    v_mfma_f32_16x16x32_bf16 v[52:55], v[68:71], v[140:143], v[52:55]
    v_perm_b32 v136, v111, v107, s52
    v_perm_b32 v137, v119, v115, s52
    v_perm_b32 v138, v127, v123, s52
    v_perm_b32 v139, v135, v131, s52
    s_nop 1
    v_mfma_f32_16x16x32_bf16 v[56:59], v[68:71], v[136:139], v[56:59]
    v_perm_b32 v140, v111, v107, s53
    v_perm_b32 v141, v119, v115, s53
    v_perm_b32 v142, v127, v123, s53
    v_perm_b32 v143, v135, v131, s53
    s_nop 1
    v_mfma_f32_16x16x32_bf16 v[60:63], v[68:71], v[140:143], v[60:63]
    v_cmp_gt_u32 vcc, 32, v0
    s_nop 1
    v_cndmask_b32 v32, v48, v32, vcc
    v_cndmask_b32 v33, v49, v33, vcc
    v_cndmask_b32 v34, v50, v34, vcc
    v_cndmask_b32 v35, v51, v35, vcc
    ds_write_b128 v164, v[32:35]
    v_cndmask_b32 v36, v52, v36, vcc
    v_cndmask_b32 v37, v53, v37, vcc
    v_cndmask_b32 v38, v54, v38, vcc
    v_cndmask_b32 v39, v55, v39, vcc
    v_xor_b32 v4, 32, v164
    ds_write_b128 v4, v[36:39]
    v_cndmask_b32 v40, v56, v40, vcc
    v_cndmask_b32 v41, v57, v41, vcc
    v_cndmask_b32 v42, v58, v42, vcc
    v_cndmask_b32 v43, v59, v43, vcc
    v_xor_b32 v4, 64, v164
    ds_write_b128 v4, v[40:43]
    v_cndmask_b32 v44, v60, v44, vcc
    v_cndmask_b32 v45, v61, v45, vcc
    v_cndmask_b32 v46, v62, v46, vcc
    v_cndmask_b32 v47, v63, v47, vcc
    v_xor_b32 v4, 96, v164
    ds_write_b128 v4, v[44:47]
    v_mov_b32 v4, 1
    s_mov_b64 exec, 1
    ds_write_b32 v10, v4 offset:16
    s_mov_b64 exec, -1
    ds_read_b32 v12, v13
FW_43:
    s_waitcnt lgkmcnt(0)
    v_cmp_gt_u32 vcc, 1, v12
    s_cbranch_vccz FO_44
    s_sleep 1
    ds_read_b32 v12, v13
    s_branch FW_43
FO_44:
    ds_read_b128 v[72:75], v165 offset:0
    ds_read_b128 v[76:79], v165 offset:4096
    ds_read_b128 v[80:83], v165 offset:8192
    ds_read_b128 v[84:87], v165 offset:12288
    s_waitcnt lgkmcnt(0)
    v_add_f32 v72, v72, v76
    v_add_f32 v80, v80, v84
    v_add_f32 v73, v73, v77
    v_add_f32 v81, v81, v85
    v_add_f32 v74, v74, v78
    v_add_f32 v82, v82, v86
    v_add_f32 v75, v75, v79
    v_add_f32 v83, v83, v87
    v_add_f32 v72, v72, v80
    v_add_f32 v73, v73, v81
    v_add_f32 v74, v74, v82
    v_add_f32 v75, v75, v83
    v_max_u32 v72, 1, v72
    v_max_u32 v74, 1, v74
    buffer_store_dwordx4 v[72:75], v2, s[12:15], s77 offen sc0 sc1
    s_lshl_b32 s44, s38, 2
    s_add_u32 s44, s44, s3
    s_mul_i32 s44, s44, 64
    s_add_u32 s44, s44, 241664
    v_mov_b32 v4, 1
    s_mov_b64 exec, 1
    buffer_atomic_add v4, v8, s[24:27], s44 offen
    s_mov_b64 exec, -1
F_adown:
    v_mov_b32 v4, 2
    s_mov_b64 exec, 1
    ds_write_b32 v10, v4 offset:16
    s_mov_b64 exec, -1
    s_mul_i32 s36, s28, 112
    s_mul_i32 s37, s3, 28
    s_add_u32 s36, s36, s37
    v_min_u32 v4, 55, v0
    v_lshlrev_b32 v4, 4, v4
    s_lshl_b32 s38, s36, 5
    s_lshr_b32 s44, s36, 5
    s_mul_i32 s44, s44, 64
    s_add_u32 s45, s36, 27
    s_lshr_b32 s45, s45, 5
    s_mul_i32 s45, s45, 64
    s_add_u32 s56, s44, 0x83b000
    s_add_u32 s56, s72, s56
    s_addc_u32 s57, s73, 0
    s_add_u32 s58, s45, 0x83b000
    s_add_u32 s58, s72, s58
    s_addc_u32 s59, s73, 0
    v_mov_b32 v156, 0
    v_mov_b32 v157, 0
    v_mov_b32 v158, 0
    v_mov_b32 v159, 0
    s_mov_b32 s48, 0xbfb8aa3b
    ds_read_b32 v12, v163
FW_45:
    s_waitcnt lgkmcnt(0)
    v_cmp_gt_u32 vcc, 3, v12
    s_cbranch_vccz FO_46
    s_sleep 2
    ds_read_b32 v12, v163
    s_branch FW_45
FO_46:
    s_add_u32 s44, s88, 32768
    v_lshlrev_b32 v9, 3, v0
    v_add_u32 v9, s44, v9
    ds_write_b64 v9, v[156:157]
    v_lshrrev_b32 v11, 1, v0
    v_mul_u32_u24 v9, 37, v11
    v_lshrrev_b32 v9, 8, v9
    v_add_u32 v11, v11, v9
    v_lshlrev_b32 v11, 1, v11
    v_and_b32 v9, 1, v0
    v_lshl_add_u32 v11, v9, 8, v11
    v_add_u32 v11, s44, v11
    v_and_b32 v9, 7, v0
    v_lshlrev_b32 v9, 6, v9
    v_lshl_add_u32 v9, v5, 4, v9
    v_add_u32 v9, s44, v9
    s_waitcnt vmcnt(2)
    s_cmp_lt_u32 s2, 224
    s_cbranch_scc1 F_dp
    s_waitcnt vmcnt(0)
F_dp:
    v_perm_b32 v72, v20, v16, s52
    v_perm_b32 v73, v28, v24, s52
    v_perm_b32 v74, v148, v144, s52
    v_perm_b32 v75, v156, v152, s52
    v_perm_b32 v76, v20, v16, s53
    v_perm_b32 v77, v28, v24, s53
    v_perm_b32 v78, v148, v144, s53
    v_perm_b32 v79, v156, v152, s53
    v_perm_b32 v80, v21, v17, s52
    v_perm_b32 v81, v29, v25, s52
    v_perm_b32 v82, v149, v145, s52
    v_perm_b32 v83, v157, v153, s52
    v_perm_b32 v84, v21, v17, s53
    v_perm_b32 v85, v29, v25, s53
    v_perm_b32 v86, v149, v145, s53
    v_perm_b32 v87, v157, v153, s53
    v_perm_b32 v88, v22, v18, s52
    v_perm_b32 v89, v30, v26, s52
    v_perm_b32 v90, v150, v146, s52
    v_perm_b32 v91, v158, v154, s52
    v_perm_b32 v92, v22, v18, s53
    v_perm_b32 v93, v30, v26, s53
    v_perm_b32 v94, v150, v146, s53
    v_perm_b32 v95, v158, v154, s53
    v_perm_b32 v96, v23, v19, s52
    v_perm_b32 v97, v31, v27, s52
    v_perm_b32 v98, v151, v147, s52
    v_perm_b32 v99, v159, v155, s52
    v_perm_b32 v100, v23, v19, s53
    v_perm_b32 v101, v31, v27, s53
    v_perm_b32 v102, v151, v147, s53
    v_perm_b32 v103, v159, v155, s53
    v_and_b32 v14, 1, v5
    v_lshlrev_b32 v14, 11, v14
    v_lshl_add_u32 v14, v7, 5, v14
    v_lshrrev_b32 v15, 1, v5
    v_lshl_add_u32 v14, v15, 4, v14
    v_add_u32 v14, s44, v14
    s_lshl_b32 s45, s3, 10
    s_add_u32 s45, s45, 32768
    v_add_u32 v15, s45, v3
    v_add_u32 v13, 48, v13
    v_and_b32 v17, 31, v0
    v_lshlrev_b32 v17, 4, v17
SP_47:
    s_load_dword s74, s[56:57], 0 glc
    s_load_dword s75, s[58:59], 0 glc
    s_waitcnt lgkmcnt(0)
    s_min_u32 s74, s74, s75
    s_cmp_ge_u32 s74, 8
    s_cbranch_scc1 SD_48
    s_sleep 16
    s_branch SP_47
SD_48:
F_dl:
    s_add_u32 s45, s38, 0
    buffer_load_dwordx4 v[32:35], v4, s[12:15], s45 offen sc0 sc1
    s_add_u32 s45, s38, 114688
    buffer_load_dwordx4 v[36:39], v4, s[12:15], s45 offen sc0 sc1
    s_add_u32 s45, s38, 229376
    buffer_load_dwordx4 v[40:43], v4, s[12:15], s45 offen sc0 sc1
    s_add_u32 s45, s38, 344064
    buffer_load_dwordx4 v[44:47], v4, s[12:15], s45 offen sc0 sc1
    s_add_u32 s45, s38, 458752
    buffer_load_dwordx4 v[48:51], v4, s[12:15], s45 offen sc0 sc1
    s_add_u32 s45, s38, 573440
    buffer_load_dwordx4 v[52:55], v4, s[12:15], s45 offen sc0 sc1
    s_add_u32 s45, s38, 688128
    buffer_load_dwordx4 v[56:59], v4, s[12:15], s45 offen sc0 sc1
    s_add_u32 s45, s38, 802816
    buffer_load_dwordx4 v[60:63], v4, s[12:15], s45 offen sc0 sc1
    s_waitcnt vmcnt(0)
    s_nop 0
    v_min3_u32 v12, v32, v34, v36
    v_min3_u32 v12, v12, v38, v40
    v_min3_u32 v12, v12, v42, v44
    v_min3_u32 v12, v12, v46, v48
    v_min3_u32 v12, v12, v50, v52
    v_min3_u32 v12, v12, v54, v56
    v_min3_u32 v12, v12, v58, v60
    v_min_u32 v12, v12, v62
    v_cmp_eq_u32 vcc, 0, v12
    s_cbranch_vccz F_dm
    s_sleep 6
    s_branch F_dl
F_dm:
    v_add_f32 v32, v32, v40
    v_add_f32 v48, v48, v56
    v_add_f32 v33, v33, v41
    v_add_f32 v49, v49, v57
    v_add_f32 v34, v34, v42
    v_add_f32 v50, v50, v58
    v_add_f32 v35, v35, v43
    v_add_f32 v51, v51, v59
    v_add_f32 v32, v32, v48
    v_add_f32 v33, v33, v49
    v_add_f32 v34, v34, v50
    v_add_f32 v35, v35, v51
    v_add_f32 v36, v36, v44
    v_add_f32 v52, v52, v60
    v_add_f32 v37, v37, v45
    v_add_f32 v53, v53, v61
    v_add_f32 v38, v38, v46
    v_add_f32 v54, v54, v62
    v_add_f32 v39, v39, v47
    v_add_f32 v55, v55, v63
    v_add_f32 v36, v36, v52
    v_add_f32 v37, v37, v53
    v_add_f32 v38, v38, v54
    v_add_f32 v39, v39, v55
    v_cvt_pk_bf16_f32 v40, v32, v36
    v_cvt_pk_bf16_f32 v41, v33, v37
    v_cvt_pk_bf16_f32 v42, v34, v38
    v_cvt_pk_bf16_f32 v43, v35, v39
    v_lshlrev_b32 v32, 16, v40
    v_and_b32 v36, 0xffff0000, v40
    v_lshlrev_b32 v33, 16, v41
    v_and_b32 v37, 0xffff0000, v41
    v_lshlrev_b32 v34, 16, v42
    v_and_b32 v38, 0xffff0000, v42
    v_lshlrev_b32 v35, 16, v43
    v_and_b32 v39, 0xffff0000, v43
    v_mul_f32 v40, s48, v32
    v_mul_f32 v41, s48, v33
    v_mul_f32 v42, s48, v34
    v_mul_f32 v43, s48, v35
    v_exp_f32 v40, v40
    v_exp_f32 v41, v41
    v_exp_f32 v42, v42
    v_exp_f32 v43, v43
    v_add_f32 v40, 1.0, v40
    v_add_f32 v41, 1.0, v41
    v_add_f32 v42, 1.0, v42
    v_add_f32 v43, 1.0, v43
    v_rcp_f32 v40, v40
    v_rcp_f32 v41, v41
    v_rcp_f32 v42, v42
    v_rcp_f32 v43, v43
    v_mul_f32 v32, v32, v40
    v_mul_f32 v33, v33, v41
    v_mul_f32 v34, v34, v42
    v_mul_f32 v35, v35, v43
    v_cvt_pk_bf16_f32 v32, v32, v32
    v_cvt_pk_bf16_f32 v33, v33, v33
    v_cvt_pk_bf16_f32 v34, v34, v34
    v_cvt_pk_bf16_f32 v35, v35, v35
    v_lshlrev_b32 v32, 16, v32
    v_lshlrev_b32 v33, 16, v33
    v_lshlrev_b32 v34, 16, v34
    v_lshlrev_b32 v35, 16, v35
    v_mul_f32 v32, v32, v36
    v_mul_f32 v33, v33, v37
    v_mul_f32 v34, v34, v38
    v_mul_f32 v35, v35, v39
    v_cvt_pk_bf16_f32 v32, v32, v32
    v_cvt_pk_bf16_f32 v33, v33, v33
    v_cvt_pk_bf16_f32 v34, v34, v34
    v_cvt_pk_bf16_f32 v35, v35, v35
    v_cmp_gt_u32 vcc, 56, v0
    s_nop 0
    s_and_saveexec_b64 s[50:51], vcc
    ds_write_b16 v11, v32 offset:0
    ds_write_b16 v11, v33 offset:64
    ds_write_b16 v11, v34 offset:128
    ds_write_b16 v11, v35 offset:192
    s_mov_b64 exec, s[50:51]
    ds_read_b128 v[64:67], v9
    s_waitcnt lgkmcnt(0)
    v_mfma_f32_16x16x32_bf16 v[104:107], v[64:67], v[72:75], 0
    v_mfma_f32_16x16x32_bf16 v[108:111], v[64:67], v[76:79], 0
    v_mfma_f32_16x16x32_bf16 v[112:115], v[64:67], v[80:83], 0
    v_mfma_f32_16x16x32_bf16 v[116:119], v[64:67], v[84:87], 0
    v_mfma_f32_16x16x32_bf16 v[120:123], v[64:67], v[88:91], 0
    v_mfma_f32_16x16x32_bf16 v[124:127], v[64:67], v[92:95], 0
    v_mfma_f32_16x16x32_bf16 v[128:131], v[64:67], v[96:99], 0
    v_mfma_f32_16x16x32_bf16 v[132:135], v[64:67], v[100:103], 0
    v_cmp_gt_u32 vcc, 32, v0
    s_nop 3
    v_cndmask_b32 v32, v120, v104, vcc
    v_cndmask_b32 v33, v124, v108, vcc
    v_cndmask_b32 v34, v128, v112, vcc
    v_cndmask_b32 v35, v132, v116, vcc
    ds_write_b128 v14, v[32:35] offset:0
    v_cndmask_b32 v36, v121, v105, vcc
    v_cndmask_b32 v37, v125, v109, vcc
    v_cndmask_b32 v38, v129, v113, vcc
    v_cndmask_b32 v39, v133, v117, vcc
    ds_write_b128 v14, v[36:39] offset:512
    v_cndmask_b32 v40, v122, v106, vcc
    v_cndmask_b32 v41, v126, v110, vcc
    v_cndmask_b32 v42, v130, v114, vcc
    v_cndmask_b32 v43, v134, v118, vcc
    ds_write_b128 v14, v[40:43] offset:1024
    v_cndmask_b32 v44, v123, v107, vcc
    v_cndmask_b32 v45, v127, v111, vcc
    v_cndmask_b32 v46, v131, v115, vcc
    v_cndmask_b32 v47, v135, v119, vcc
    ds_write_b128 v14, v[44:47] offset:1536
    v_mov_b32 v4, 1
    s_mov_b64 exec, 1
    ds_write_b32 v10, v4 offset:64
    s_mov_b64 exec, -1
    s_lshl_b32 s45, s29, 7
    s_add_u32 s56, s45, 0x82a000
    s_add_u32 s56, s72, s56
    s_addc_u32 s57, s73, 0
    s_lshl_b32 s44, s3, 13
    s_lshl_b32 s50, s29, 9
    s_add_u32 s50, s50, 135168
    s_add_u32 s44, s44, s50
    s_add_u32 s45, s44, 4096
    ds_read_b32 v12, v13
FW_49:
    s_waitcnt lgkmcnt(0)
    v_cmp_gt_u32 vcc, 1, v12
    s_cbranch_vccz FO_50
    s_sleep 1
    ds_read_b32 v12, v13
    s_branch FW_49
FO_50:
    ds_read2st64_b32 v[48:49], v15 offset0:0 offset1:1
    ds_read2st64_b32 v[52:53], v15 offset0:16 offset1:17
    ds_read2st64_b32 v[56:57], v15 offset0:96 offset1:97
    ds_read2st64_b32 v[60:61], v15 offset0:112 offset1:113
    ds_read2st64_b32 v[50:51], v15 offset0:2 offset1:3
    ds_read2st64_b32 v[54:55], v15 offset0:18 offset1:19
    ds_read2st64_b32 v[58:59], v15 offset0:98 offset1:99
    ds_read2st64_b32 v[62:63], v15 offset0:114 offset1:115
    s_waitcnt lgkmcnt(4)
    v_add_f32 v48, v48, v52
    v_add_f32 v56, v56, v60
    v_add_f32 v48, v48, v56
    buffer_atomic_add_f32 v48, v3, s[24:27], s44 offen offset:0
    v_add_f32 v49, v49, v53
    v_add_f32 v57, v57, v61
    v_add_f32 v49, v49, v57
    buffer_atomic_add_f32 v49, v3, s[24:27], s44 offen offset:256
    s_waitcnt lgkmcnt(0)
    v_add_f32 v50, v50, v54
    v_add_f32 v58, v58, v62
    v_add_f32 v50, v50, v58
    buffer_atomic_add_f32 v50, v3, s[24:27], s45 offen offset:0
    v_add_f32 v51, v51, v55
    v_add_f32 v59, v59, v63
    v_add_f32 v51, v51, v59
    buffer_atomic_add_f32 v51, v3, s[24:27], s45 offen offset:256
    s_barrier
    s_barrier
    s_barrier
    s_barrier
    s_waitcnt vmcnt(0)
    s_barrier
    s_mov_b32 s47, 5
    s_cmp_lg_u32 s3, 0
    s_cbranch_scc1 F_end
    s_mov_b32 s76, 1
    s_atomic_add s76, s[56:57], 0
    s_lshl_b32 s44, s28, 6
    s_sub_u32 s44, 2047, s44
    s_movk_i32 s46, 0x7fff
    s_and_b32 s45, s60, 0x7ff
    s_sub_u32 s45, s44, s45
    s_min_u32 s46, s46, s45
    s_and_b32 s45, s61, 0x7ff
    s_sub_u32 s45, s44, s45
    s_min_u32 s46, s46, s45
    s_and_b32 s45, s62, 0x7ff
    s_sub_u32 s45, s44, s45
    s_min_u32 s46, s46, s45
    s_and_b32 s45, s63, 0x7ff
    s_sub_u32 s45, s44, s45
    s_min_u32 s46, s46, s45
    s_and_b32 s45, s64, 0x7ff
    s_sub_u32 s45, s44, s45
    s_min_u32 s46, s46, s45
    s_and_b32 s45, s65, 0x7ff
    s_sub_u32 s45, s44, s45
    s_min_u32 s46, s46, s45
    s_and_b32 s45, s66, 0x7ff
    s_sub_u32 s45, s44, s45
    s_min_u32 s46, s46, s45
    s_and_b32 s45, s67, 0x7ff
    s_sub_u32 s45, s44, s45
    s_min_u32 s46, s46, s45
    v_lshrrev_b32 v4, 5, v0
    v_lshl_add_u32 v4, v4, 12, v17
    s_barrier
    s_barrier
    s_barrier
    s_barrier
    s_barrier
    s_mov_b32 s47, 10
    s_cmp_ge_u32 s46, 64
    s_cbranch_scc1 F_end
F_y3:
    s_load_dword s58, s[56:57], 0 glc
    s_cmp_ge_u32 s47, 16
    s_cbranch_scc1 YB_51
    s_barrier
    s_add_u32 s47, s47, 1
YB_51:
    s_cmp_ge_u32 s47, 16
    s_cbranch_scc1 YB_52
    s_barrier
    s_add_u32 s47, s47, 1
YB_52:
    s_waitcnt lgkmcnt(0)
    s_cmp_lt_u32 s58, 32
    s_cbranch_scc1 F_y3
    s_mov_b32 m0, 27648
    s_nop 0
    buffer_load_dwordx4 v4, s[24:27], s50 offen sc0 sc1 lds
    s_add_u32 s50, s50, 8192
    s_add_u32 m0, m0, 1024
    s_nop 0
    buffer_load_dwordx4 v4, s[24:27], s50 offen sc0 sc1 lds
    s_add_u32 s50, s50, 8192
    s_add_u32 m0, m0, 1024
    s_nop 0
    buffer_load_dwordx4 v4, s[24:27], s50 offen sc0 sc1 lds
    s_add_u32 s50, s50, 8192
    s_add_u32 m0, m0, 1024
    s_nop 0
    buffer_load_dwordx4 v4, s[24:27], s50 offen sc0 sc1 lds
    s_add_u32 s50, s50, 8192
    s_add_u32 m0, m0, 1024
    s_cmp_ge_u32 s47, 16
    s_cbranch_scc1 YB_53
    s_barrier
    s_add_u32 s47, s47, 1
YB_53:
    s_cmp_ge_u32 s47, 16
    s_cbranch_scc1 YB_54
    s_barrier
    s_add_u32 s47, s47, 1
YB_54:
    s_cmp_ge_u32 s47, 16
    s_cbranch_scc1 YB_55
    s_barrier
    s_add_u32 s47, s47, 1
YB_55:
    s_waitcnt vmcnt(0)
    v_mov_b32 v4, 9
    s_mov_b64 exec, 1
    ds_write_b32 v10, v4 offset:96
    s_mov_b64 exec, -1
    s_endpgm
F_codeend:
.section .rodata,"a"
.p2align 6
.amdhsa_kernel parallel_sum__linear_attn_block__moe_arch_mod__prompt_kernel
  .amdhsa_next_free_vgpr 168
  .amdhsa_next_free_sgpr 96
  .amdhsa_accum_offset 168
  .amdhsa_group_segment_fixed_size 0
  .amdhsa_kernarg_size 88
  .amdhsa_user_sgpr_count 2
  .amdhsa_user_sgpr_kernarg_segment_ptr 1
  .amdhsa_system_sgpr_workgroup_id_x 1
  .amdhsa_float_denorm_mode_32 3
  .amdhsa_float_denorm_mode_16_64 3
.end_amdhsa_kernel
```

```asm
; @launch grid=(256,1,1) block=(768,1,1) lds=163840
.amdgcn_target "amdgcn-amd-amdhsa--gfx950"
.text
.globl parallel_sum__linear_attn_block__moe_arch_mod__prompt_kernel
.p2align 8
.type parallel_sum__linear_attn_block__moe_arch_mod__prompt_kernel,@function
parallel_sum__linear_attn_block__moe_arch_mod__prompt_kernel:
    s_load_dwordx4 s[4:7], s[0:1], 0
    s_load_dwordx8 s[60:67], s[0:1], 32
    s_load_dwordx2 s[72:73], s[0:1], 80
    s_load_dwordx4 s[68:71], s[0:1], 64
    s_load_dwordx2 s[8:9], s[0:1], 16
    s_cmp_ge_u32 s2, 256
    s_cbranch_scc1 F_end
    v_lshrrev_b32 v1, 6, v0
    v_and_b32 v0, 63, v0
    s_and_b32 s30, s2, 7
    v_readfirstlane_b32 s3, v1
    s_lshr_b32 s31, s2, 3
    s_and_b32 s32, s30, 1
    s_lshl_b32 s32, s32, 3
    s_and_b32 s35, s31, 7
    s_add_u32 s32, s32, s35
    s_lshr_b32 s33, s30, 1
    s_lshl_b32 s33, s33, 2
    s_lshr_b32 s34, s31, 3
    s_add_u32 s33, s33, s34
    s_lshl_b32 s28, s32, 1
    s_bfe_u32 s29, s30, 0x10001
    s_add_u32 s28, s28, s29
    s_lshl_b32 s29, s30, 2
    s_xor_b32 s29, s29, s30
    s_and_b32 s29, s29, 4
    s_add_u32 s29, s29, s34
    s_lshl_b32 s39, s29, 1
    s_xor_b32 s39, s39, 14
    s_add_u32 s10, s33, 4
    s_and_b32 s10, s10, 15
    v_lshlrev_b32 v2, 4, v0
    s_cmp_ge_u32 s3, 8
    s_cbranch_scc1 F_loader
    s_lshl_b32 s77, s32, 4
    s_add_u32 s77, s77, s33
    s_lshl_b32 s77, s77, 3
    s_add_u32 s77, s77, s3
    s_cmp_lg_u32 s3, 7
    s_cbranch_scc1 F_nt
    s_getpc_b64 s[46:47]
F_pc:
    s_sub_u32 s46, s46, F_pc-parallel_sum__linear_attn_block__moe_arch_mod__prompt_kernel
    s_subb_u32 s47, s47, 0
    s_and_b32 s44, s31, 7
    s_lshl_b32 s44, s44, 13
    v_min_u32 v60, 63, v0
    v_lshlrev_b32 v60, 7, v60
    v_add_u32 v60, s44, v60
    v_min_u32 v60, F_codeend-parallel_sum__linear_attn_block__moe_arch_mod__prompt_kernel-4, v60
    global_load_dword v161, v60, s[46:47]
F_nt:
    s_lshl_b32 s44, s77, 11
    s_waitcnt lgkmcnt(0)

    s_mov_b32 s20, s4
    s_mov_b32 s21, s5
    s_mov_b32 s22, 0x400000
    s_mov_b32 s23, 0x00020000
    buffer_load_dwordx4 v[4:7], v2, s[20:23], s44 offen
    buffer_load_dwordx4 v[8:11], v2, s[20:23], s44 offen offset:1024
    s_mov_b32 s16, s60
    s_mov_b32 s17, s61
    s_mov_b32 s18, 0x800
    s_mov_b32 s19, 0x00020000
    buffer_load_dwordx4 v[12:15], v2, s[16:19], 0 offen
    buffer_load_dwordx4 v[16:19], v2, s[16:19], 0 offen offset:1024
    s_add_u32 s24, s72, 0x800000
    s_addc_u32 s25, s73, 0
    s_mov_b32 s26, 0x100000
    s_mov_b32 s27, 0x00020000
    s_add_u32 s40, s72, 0x900000
    s_addc_u32 s41, s73, 0
    s_mov_b32 s42, 0x18000
    s_mov_b32 s43, 0x00020000
    s_mov_b32 s48, s70
    s_mov_b32 s49, s71
    s_mov_b32 s50, 0x100
    s_mov_b32 s51, 0x00020000
    v_mov_b32 v20, 0
    v_mov_b32 v21, 0
    v_mov_b32 v22, 0
    v_mov_b32 v23, 0
    s_cmp_lg_u32 s3, 5
    s_cbranch_scc1 F_a0
    s_cmp_lg_u32 s33, 0
    s_cbranch_scc1 F_a0
    s_lshl_b32 s44, s32, 8
    s_add_u32 s44, s44, 32768
    s_lshl_b32 s45, s32, 2
    s_mov_b64 exec, 0xffff
    buffer_store_dwordx4 v[20:23], v2, s[40:43], s44 offen sc0 sc1
    s_mov_b64 exec, 1
    s_waitcnt vmcnt(0)
    v_mov_b32 v24, 1
    buffer_store_dword v24, v20, s[48:51], s45 offen sc0 sc1
    s_mov_b64 exec, -1
    s_branch F_a1
F_a0:
    s_waitcnt vmcnt(0)
F_a1:

    v_lshlrev_b32 v24, 16, v4
    v_and_b32 v25, 0xffff0000, v4
    v_lshlrev_b32 v26, 16, v5
    v_and_b32 v27, 0xffff0000, v5
    v_lshlrev_b32 v28, 16, v6
    v_and_b32 v29, 0xffff0000, v6
    v_lshlrev_b32 v30, 16, v7
    v_and_b32 v31, 0xffff0000, v7
    v_lshlrev_b32 v32, 16, v8
    v_and_b32 v33, 0xffff0000, v8
    v_lshlrev_b32 v34, 16, v9
    v_and_b32 v35, 0xffff0000, v9
    v_lshlrev_b32 v36, 16, v10
    v_and_b32 v37, 0xffff0000, v10
    v_lshlrev_b32 v38, 16, v11
    v_and_b32 v39, 0xffff0000, v11
    v_add_f32 v40, v24, v25
    v_add_f32 v41, v26, v27
    v_add_f32 v42, v28, v29
    v_add_f32 v43, v30, v31
    v_add_f32 v44, v32, v33
    v_add_f32 v45, v34, v35
    v_add_f32 v46, v36, v37
    v_add_f32 v47, v38, v39
    v_add_f32 v40, v40, v44
    v_add_f32 v41, v41, v45
    v_add_f32 v42, v42, v46
    v_add_f32 v43, v43, v47
    v_add_f32 v40, v40, v42
    v_add_f32 v41, v41, v43
    v_add_f32 v40, v40, v41
    s_nop 1
    v_add_f32_dpp v40, v40, v40 row_shr:1 row_mask:0xf bank_mask:0xf bound_ctrl:0
    s_nop 1
    v_add_f32_dpp v40, v40, v40 row_shr:2 row_mask:0xf bank_mask:0xf bound_ctrl:0
    s_nop 1
    v_add_f32_dpp v40, v40, v40 row_shr:4 row_mask:0xf bank_mask:0xf bound_ctrl:0
    s_nop 1
    v_add_f32_dpp v40, v40, v40 row_shr:8 row_mask:0xf bank_mask:0xf bound_ctrl:0
    s_nop 1
    v_add_f32_dpp v40, v40, v40 row_bcast:15 row_mask:0xa bank_mask:0xf
    s_nop 1
    v_add_f32_dpp v40, v40, v40 row_bcast:31 row_mask:0xc bank_mask:0xf
    s_nop 0
    v_readlane_b32 s52, v40, 63
    v_mov_b32 v41, 0x3a800000
    s_nop 0
    v_mul_f32 v41, s52, v41
    v_sub_f32 v44, v24, v41
    v_sub_f32 v45, v25, v41
    v_sub_f32 v46, v26, v41
    v_sub_f32 v47, v27, v41
    v_sub_f32 v48, v28, v41
    v_sub_f32 v49, v29, v41
    v_sub_f32 v50, v30, v41
    v_sub_f32 v51, v31, v41
    v_sub_f32 v52, v32, v41
    v_sub_f32 v53, v33, v41
    v_sub_f32 v54, v34, v41
    v_sub_f32 v55, v35, v41
    v_sub_f32 v56, v36, v41
    v_sub_f32 v57, v37, v41
    v_sub_f32 v58, v38, v41
    v_sub_f32 v59, v39, v41
    v_mul_f32 v40, v44, v44
    v_mul_f32 v42, v45, v45
    v_fmac_f32 v40, v46, v46
    v_fmac_f32 v42, v47, v47
    v_fmac_f32 v40, v48, v48
    v_fmac_f32 v42, v49, v49
    v_fmac_f32 v40, v50, v50
    v_fmac_f32 v42, v51, v51
    v_fmac_f32 v40, v52, v52
    v_fmac_f32 v42, v53, v53
    v_fmac_f32 v40, v54, v54
    v_fmac_f32 v42, v55, v55
    v_fmac_f32 v40, v56, v56
    v_fmac_f32 v42, v57, v57
    v_fmac_f32 v40, v58, v58
    v_fmac_f32 v42, v59, v59
    v_add_f32 v40, v40, v42
    s_nop 1
    v_add_f32_dpp v40, v40, v40 row_shr:1 row_mask:0xf bank_mask:0xf bound_ctrl:0
    s_nop 1
    v_add_f32_dpp v40, v40, v40 row_shr:2 row_mask:0xf bank_mask:0xf bound_ctrl:0
    s_nop 1
    v_add_f32_dpp v40, v40, v40 row_shr:4 row_mask:0xf bank_mask:0xf bound_ctrl:0
    s_nop 1
    v_add_f32_dpp v40, v40, v40 row_shr:8 row_mask:0xf bank_mask:0xf bound_ctrl:0
    s_nop 1
    v_add_f32_dpp v40, v40, v40 row_bcast:15 row_mask:0xa bank_mask:0xf
    s_nop 1
    v_add_f32_dpp v40, v40, v40 row_bcast:31 row_mask:0xc bank_mask:0xf
    s_nop 0
    v_readlane_b32 s52, v40, 63
    v_mov_b32 v42, 0x3a800000
    s_nop 0
    v_mul_f32 v42, s52, v42
    v_cvt_pk_bf16_f32 v43, v41, v42
    v_lshlrev_b32 v41, 16, v43
    v_and_b32 v42, 0xffff0000, v43
    v_add_f32 v42, 0x3727c5ac, v42
    v_cvt_pk_bf16_f32 v42, v42, v42
    v_lshlrev_b32 v42, 16, v42
    v_sqrt_f32 v42, v42
    s_nop 0
    v_cvt_pk_bf16_f32 v42, v42, v42
    v_lshlrev_b32 v42, 16, v42
    v_rcp_f32 v42, v42
    v_sub_f32 v24, v24, v41
    v_sub_f32 v25, v25, v41
    v_sub_f32 v26, v26, v41
    v_sub_f32 v27, v27, v41
    v_sub_f32 v28, v28, v41
    v_sub_f32 v29, v29, v41
    v_sub_f32 v30, v30, v41
    v_sub_f32 v31, v31, v41
    v_sub_f32 v32, v32, v41
    v_sub_f32 v33, v33, v41
    v_sub_f32 v34, v34, v41
    v_sub_f32 v35, v35, v41
    v_sub_f32 v36, v36, v41
    v_sub_f32 v37, v37, v41
    v_sub_f32 v38, v38, v41
    v_sub_f32 v39, v39, v41
    v_cvt_pk_bf16_f32 v4, v24, v25
    v_cvt_pk_bf16_f32 v5, v26, v27
    v_cvt_pk_bf16_f32 v6, v28, v29
    v_cvt_pk_bf16_f32 v7, v30, v31
    v_cvt_pk_bf16_f32 v8, v32, v33
    v_cvt_pk_bf16_f32 v9, v34, v35
    v_cvt_pk_bf16_f32 v10, v36, v37
    v_cvt_pk_bf16_f32 v11, v38, v39
    v_lshlrev_b32 v24, 16, v4
    v_and_b32 v25, 0xffff0000, v4
    v_lshlrev_b32 v26, 16, v5
    v_and_b32 v27, 0xffff0000, v5
    v_lshlrev_b32 v28, 16, v6
    v_and_b32 v29, 0xffff0000, v6
    v_lshlrev_b32 v30, 16, v7
    v_and_b32 v31, 0xffff0000, v7
    v_lshlrev_b32 v32, 16, v8
    v_and_b32 v33, 0xffff0000, v8
    v_lshlrev_b32 v34, 16, v9
    v_and_b32 v35, 0xffff0000, v9
    v_lshlrev_b32 v36, 16, v10
    v_and_b32 v37, 0xffff0000, v10
    v_lshlrev_b32 v38, 16, v11
    v_and_b32 v39, 0xffff0000, v11
    v_mul_f32 v24, v24, v42
    v_mul_f32 v25, v25, v42
    v_mul_f32 v26, v26, v42
    v_mul_f32 v27, v27, v42
    v_mul_f32 v28, v28, v42
    v_mul_f32 v29, v29, v42
    v_mul_f32 v30, v30, v42
    v_mul_f32 v31, v31, v42
    v_mul_f32 v32, v32, v42
    v_mul_f32 v33, v33, v42
    v_mul_f32 v34, v34, v42
    v_mul_f32 v35, v35, v42
    v_mul_f32 v36, v36, v42
    v_mul_f32 v37, v37, v42
    v_mul_f32 v38, v38, v42
    v_mul_f32 v39, v39, v42
    v_cvt_pk_bf16_f32 v4, v24, v25
    v_cvt_pk_bf16_f32 v5, v26, v27
    v_cvt_pk_bf16_f32 v6, v28, v29
    v_cvt_pk_bf16_f32 v7, v30, v31
    v_cvt_pk_bf16_f32 v8, v32, v33
    v_cvt_pk_bf16_f32 v9, v34, v35
    v_cvt_pk_bf16_f32 v10, v36, v37
    v_cvt_pk_bf16_f32 v11, v38, v39
    v_mov_b32 v40, 0
    v_mov_b32 v43, 0
    v_dot2_f32_bf16 v40, v4, v12, v40
    v_dot2_f32_bf16 v43, v5, v13, v43
    v_dot2_f32_bf16 v40, v6, v14, v40
    v_dot2_f32_bf16 v43, v7, v15, v43
    v_dot2_f32_bf16 v40, v8, v16, v40
    v_dot2_f32_bf16 v43, v9, v17, v43
    v_dot2_f32_bf16 v40, v10, v18, v40
    v_dot2_f32_bf16 v43, v11, v19, v43
    s_nop 2
    v_add_f32 v40, v40, v43
    s_nop 1
    v_add_f32_dpp v40, v40, v40 row_shr:1 row_mask:0xf bank_mask:0xf bound_ctrl:0
    s_nop 1
    v_add_f32_dpp v40, v40, v40 row_shr:2 row_mask:0xf bank_mask:0xf bound_ctrl:0
    s_nop 1
    v_add_f32_dpp v40, v40, v40 row_shr:4 row_mask:0xf bank_mask:0xf bound_ctrl:0
    s_nop 1
    v_add_f32_dpp v40, v40, v40 row_shr:8 row_mask:0xf bank_mask:0xf bound_ctrl:0
    s_nop 1
    v_add_f32_dpp v40, v40, v40 row_bcast:15 row_mask:0xa bank_mask:0xf
    s_nop 1
    v_add_f32_dpp v40, v40, v40 row_bcast:31 row_mask:0xc bank_mask:0xf
    s_nop 0
    v_readlane_b32 s52, v40, 63
    s_nop 1
    v_mov_b32 v44, s52
    v_cvt_pk_bf16_f32 v44, v44, v44
    v_and_b32 v44, 0xffff0000, v44
    v_ashrrev_i32 v45, 31, v44
    v_or_b32 v45, 0x80000000, v45
    v_xor_b32 v44, v44, v45
    v_and_b32 v44, 0xffff0000, v44
    s_sub_u32 s44, 2047, s77
    v_or_b32 v44, s44, v44
    v_xor_b32 v46, 0x80000000, v41
    v_mov_b32 v47, v42
    v_mul_f32 v48, 0x3fb8aa3b, v42
    s_lshl_b32 s44, s77, 2
    s_lshl_b32 s45, s77, 4
    s_add_u32 s45, s45, 65536
    v_mov_b32 v45, 0
    s_mov_b64 exec, 1
    buffer_store_dword v44, v45, s[40:43], s44 offen sc0 sc1
    buffer_store_dwordx3 v[46:48], v45, s[40:43], s45 offen sc0 sc1
    s_mov_b64 exec, -1

    s_cmp_ge_u32 s3, 4
    s_cbranch_scc1 F_aux
    s_setprio 2
    s_lshr_b32 s36, s3, 1
    s_and_b32 s37, s3, 1
    s_lshl_b32 s38, s36, 13
    s_lshl_b32 s42, s37, 1

    v_and_b32 v1, 15, v0
    v_lshrrev_b32 v2, 4, v0
    v_lshrrev_b32 v3, 1, v1
    v_xor_b32 v3, v3, v2
    v_lshlrev_b32 v3, 4, v3
    v_lshlrev_b32 v1, 7, v1
    v_add3_u32 v4, v1, v3, s38
    v_xor_b32 v5, 64, v4
    v_add_u32 v6, 81920, v4
    v_add_u32 v7, 81920, v5
    v_bfe_u32 v1, v0, 2, 2
    v_lshl_add_u32 v3, v2, 3, v1
    v_lshrrev_b32 v1, 1, v1
    v_and_b32 v2, 1, v2
    v_lshl_add_u32 v1, v2, 1, v1
    v_xor_b32 v1, s42, v1
    v_lshlrev_b32 v1, 5, v1
    v_lshl_add_u32 v1, v3, 7, v1
    v_and_b32 v2, 3, v0
    v_lshl_add_u32 v1, v2, 3, v1

    v_add_u32 v8, 16384, v1
    v_xor_b32 v9, 32, v8
    v_add_u32 v10, 81920, v8
    v_add_u32 v11, 81920, v9
    s_mov_b32 s40, 0x3f800008
    s_mov_b32 s41, s40
    s_mov_b32 s74, 0x358637bd
    s_mov_b32 s75, s74
    s_lshl_b32 s42, s36, 8
    s_add_u32 s42, s42, 24832
    v_and_or_b32 v164, v0, 48, s42
    v_and_b32 v165, 15, v0
    s_lshl_b32 s42, s37, 7
    s_add_u32 s42, s42, 26368
    v_lshl_add_u32 v165, v165, 2, s42
    s_lshl_b32 s42, s3, 12
    s_add_u32 s42, s42, 65536
    v_lshl_add_u32 v1, v0, 4, s42
    s_lshl_b32 s42, s3, 7
    s_add_u32 s42, s42, 27136
    v_and_or_b32 v2, v0, 48, s42
    s_lshl_b32 s42, s3, 2
    s_add_u32 s42, s42, 24640
    v_mov_b32 v3, s42
    s_lshl_b32 s46, s28, 6
    s_lshl_b32 s47, s29, 8
    s_lshl_b32 s42, s3, 6
    s_add_u32 s47, s47, s42
    s_lshl_b32 s42, s46, 11
    s_add_u32 s42, s42, s47
    s_lshl_b32 s78, s10, 1
    s_add_u32 s78, s78, s37
    s_lshl_b32 s79, s32, 18
    s_lshl_b32 s80, s36, 17
    s_add_u32 s79, s79, s80
    s_lshl_b32 s80, s78, 10
    s_add_u32 s79, s79, s80
    s_lshl_b32 s45, s32, 1
    s_add_u32 s45, s45, s36
    s_mul_i32 s45, s45, 8*64
    s_add_u32 s45, s45, 225280
    v_and_b32 v12, 15, v0
    v_bfe_u32 v13, v0, 4, 1
    v_lshlrev_b32 v13, 5, v13
    v_lshrrev_b32_e64 v14, 5, v0
    v_lshl_add_u32 v13, v14, 4, v13
    v_lshl_add_u32 v167, v12, 11, v13
    s_mul_i32 s82, s78, 4224
    s_add_u32 s83, s82, 4096
    s_lshl_b32 s50, s78, 4
    s_and_b32 s44, s32, 4-1
    s_mul_i32 s44, s44, 16/4
    s_add_u32 s50, s50, s44
    s_mul_i32 s50, s50, 64
    s_and_b32 s44, s2, 63
    s_lshl_b32 s44, s44, 7

    s_add_u32 s56, s50, 0x82f000
    s_add_u32 s56, s72, s56
    s_addc_u32 s57, s73, 0
    s_add_u32 s48, s44, 0x82d000
    s_add_u32 s48, s72, s48
    s_addc_u32 s49, s73, 0
    s_add_u32 s16, s72, 0x400000
    s_addc_u32 s17, s73, 0
    s_mov_b32 s18, 0x400000
    s_mov_b32 s19, 0x00020000
    s_mov_b32 s52, s68
    s_mov_b32 s53, s69
    s_mov_b32 s54, 0x400000
    s_mov_b32 s55, 0x00020000
    s_add_u32 s68, s45, 0x800000
    s_add_u32 s68, s72, s68
    s_addc_u32 s69, s73, 0
    s_mov_b32 s76, 1
    s_barrier
    ds_read_b128 v[12:15], v4 offset:0
    ds_read_b64_tr_b16 v[44:45], v8 offset:8192
    ds_read_b64_tr_b16 v[46:47], v8 offset:8704
    ds_read_b128 v[28:31], v5 offset:0
    ds_read_b64_tr_b16 v[48:49], v8 offset:12288
    ds_read_b64_tr_b16 v[50:51], v8 offset:12800
    ds_read_b128 v[16:19], v4 offset:2048
    ds_read_b128 v[32:35], v5 offset:2048
    ds_read_b128 v[20:23], v4 offset:4096
    ds_read_b128 v[36:39], v5 offset:4096
    ds_read_b128 v[24:27], v4 offset:6144
    ds_read_b128 v[40:43], v5 offset:6144
    ds_read_b64_tr_b16 v[52:53], v9 offset:8192
    ds_read_b64_tr_b16 v[54:55], v9 offset:8704
    s_waitcnt lgkmcnt(11)
    v_mfma_f32_16x16x32_bf16 v[100:103], v[12:15], v[44:47], 0
    ds_read_b64_tr_b16 v[56:57], v9 offset:12288
    s_waitcnt lgkmcnt(9)
    v_mfma_f32_16x16x32_bf16 v[100:103], v[28:31], v[48:51], v[100:103]
    ds_read_b64_tr_b16 v[58:59], v9 offset:12800
    s_waitcnt lgkmcnt(9)
    v_mfma_f32_16x16x32_bf16 v[104:107], v[16:19], v[44:47], 0
    ds_read_b64_tr_b16 v[60:61], v8 offset:16384
    s_waitcnt lgkmcnt(9)
    v_mfma_f32_16x16x32_bf16 v[104:107], v[32:35], v[48:51], v[104:107]
    ds_read_b64_tr_b16 v[62:63], v8 offset:16896
    s_waitcnt lgkmcnt(9)
    v_mfma_f32_16x16x32_bf16 v[108:111], v[20:23], v[44:47], 0
    ds_read_b64_tr_b16 v[64:65], v8 offset:20480
    s_waitcnt lgkmcnt(9)
    v_mfma_f32_16x16x32_bf16 v[108:111], v[36:39], v[48:51], v[108:111]
    ds_read_b64_tr_b16 v[66:67], v8 offset:20992
    s_waitcnt lgkmcnt(9)
    v_mfma_f32_16x16x32_bf16 v[112:115], v[24:27], v[44:47], 0
    ds_read_b64_tr_b16 v[44:45], v9 offset:16384
    s_waitcnt lgkmcnt(9)
    v_mfma_f32_16x16x32_bf16 v[112:115], v[40:43], v[48:51], v[112:115]
    ds_read_b64_tr_b16 v[46:47], v9 offset:16896
    s_waitcnt lgkmcnt(8)
    v_mfma_f32_16x16x32_bf16 v[116:119], v[12:15], v[52:55], 0
    ds_read_b64_tr_b16 v[48:49], v9 offset:20480
    s_waitcnt lgkmcnt(7)
    v_mfma_f32_16x16x32_bf16 v[116:119], v[28:31], v[56:59], v[116:119]
    ds_read_b64_tr_b16 v[50:51], v9 offset:20992
    v_mfma_f32_16x16x32_bf16 v[120:123], v[16:19], v[52:55], 0
    v_mfma_f32_16x16x32_bf16 v[120:123], v[32:35], v[56:59], v[120:123]
    v_mfma_f32_16x16x32_bf16 v[124:127], v[20:23], v[52:55], 0
    v_mfma_f32_16x16x32_bf16 v[124:127], v[36:39], v[56:59], v[124:127]
    v_mfma_f32_16x16x32_bf16 v[128:131], v[24:27], v[52:55], 0
    ds_read_b64_tr_b16 v[52:53], v8 offset:0
    v_mfma_f32_16x16x32_bf16 v[128:131], v[40:43], v[56:59], v[128:131]
    ds_read_b64_tr_b16 v[54:55], v8 offset:512
    s_waitcnt lgkmcnt(5)
    v_mfma_f32_16x16x32_bf16 v[132:135], v[12:15], v[60:63], 0
    ds_read_b64_tr_b16 v[56:57], v8 offset:4096
    v_mfma_f32_16x16x32_bf16 v[132:135], v[28:31], v[64:67], v[132:135]
    ds_read_b64_tr_b16 v[58:59], v8 offset:4608
    v_mfma_f32_16x16x32_bf16 v[136:139], v[16:19], v[60:63], 0
    v_mfma_f32_16x16x32_bf16 v[136:139], v[32:35], v[64:67], v[136:139]
    v_mfma_f32_16x16x32_bf16 v[140:143], v[20:23], v[60:63], 0
    v_mfma_f32_16x16x32_bf16 v[140:143], v[36:39], v[64:67], v[140:143]
    v_mfma_f32_16x16x32_bf16 v[144:147], v[24:27], v[60:63], 0
    ds_read_b64_tr_b16 v[60:61], v9 offset:0
    v_mfma_f32_16x16x32_bf16 v[144:147], v[40:43], v[64:67], v[144:147]
    ds_read_b64_tr_b16 v[62:63], v9 offset:512
    s_waitcnt lgkmcnt(5)
    v_mfma_f32_16x16x32_bf16 v[148:151], v[12:15], v[44:47], 0
    ds_read_b64_tr_b16 v[64:65], v9 offset:4096
    v_mfma_f32_16x16x32_bf16 v[148:151], v[28:31], v[48:51], v[148:151]
    ds_read_b64_tr_b16 v[66:67], v9 offset:4608
    v_mfma_f32_16x16x32_bf16 v[152:155], v[16:19], v[44:47], 0
    v_mfma_f32_16x16x32_bf16 v[152:155], v[32:35], v[48:51], v[152:155]
    v_mfma_f32_16x16x32_bf16 v[156:159], v[20:23], v[44:47], 0
    v_mfma_f32_16x16x32_bf16 v[156:159], v[36:39], v[48:51], v[156:159]
    s_waitcnt lgkmcnt(0)
    s_barrier
    v_mfma_f32_16x16x32_bf16 v[160:163], v[24:27], v[44:47], 0
    ds_read_b64_tr_b16 v[44:45], v8 offset:49152
    v_mfma_f32_16x16x32_bf16 v[160:163], v[40:43], v[48:51], v[160:163]
    ds_read_b64_tr_b16 v[46:47], v8 offset:49664
    v_mfma_f32_16x16x32_bf16 v[68:71], v[52:55], v[12:15], 0
    ds_read_b64_tr_b16 v[48:49], v8 offset:53248
    v_mfma_f32_16x16x32_bf16 v[68:71], v[56:59], v[28:31], v[68:71]
    ds_read_b64_tr_b16 v[50:51], v8 offset:53760
    v_mfma_f32_16x16x32_bf16 v[84:87], v[60:63], v[12:15], 0
    ds_read_b128 v[12:15], v4 offset:40960
    v_mfma_f32_16x16x32_bf16 v[84:87], v[64:67], v[28:31], v[84:87]
    ds_read_b128 v[28:31], v5 offset:40960
    v_mfma_f32_16x16x32_bf16 v[72:75], v[52:55], v[16:19], 0
    v_mfma_f32_16x16x32_bf16 v[72:75], v[56:59], v[32:35], v[72:75]
    v_mfma_f32_16x16x32_bf16 v[88:91], v[60:63], v[16:19], 0
    ds_read_b128 v[16:19], v4 offset:43008
    v_mfma_f32_16x16x32_bf16 v[88:91], v[64:67], v[32:35], v[88:91]
    ds_read_b128 v[32:35], v5 offset:43008
    v_mfma_f32_16x16x32_bf16 v[76:79], v[52:55], v[20:23], 0
    v_mfma_f32_16x16x32_bf16 v[76:79], v[56:59], v[36:39], v[76:79]
    v_mfma_f32_16x16x32_bf16 v[92:95], v[60:63], v[20:23], 0
    ds_read_b128 v[20:23], v4 offset:45056
    v_mfma_f32_16x16x32_bf16 v[92:95], v[64:67], v[36:39], v[92:95]
    ds_read_b128 v[36:39], v5 offset:45056
    v_mfma_f32_16x16x32_bf16 v[80:83], v[52:55], v[24:27], 0
    ds_read_b64_tr_b16 v[52:53], v9 offset:49152
    v_mfma_f32_16x16x32_bf16 v[80:83], v[56:59], v[40:43], v[80:83]
    ds_read_b64_tr_b16 v[54:55], v9 offset:49664
    v_mfma_f32_16x16x32_bf16 v[96:99], v[60:63], v[24:27], 0
    ds_read_b128 v[24:27], v4 offset:47104
    v_mfma_f32_16x16x32_bf16 v[96:99], v[64:67], v[40:43], v[96:99]
    ds_read_b128 v[40:43], v5 offset:47104
    s_waitcnt lgkmcnt(7)
    v_mfma_f32_16x16x32_bf16 v[100:103], v[12:15], v[44:47], v[100:103]
    ds_read_b64_tr_b16 v[56:57], v9 offset:53248
    v_mfma_f32_16x16x32_bf16 v[100:103], v[28:31], v[48:51], v[100:103]
    ds_read_b64_tr_b16 v[58:59], v9 offset:53760
    v_mfma_f32_16x16x32_bf16 v[104:107], v[16:19], v[44:47], v[104:107]
    ds_read_b64_tr_b16 v[60:61], v8 offset:57344
    s_waitcnt lgkmcnt(9)
    v_mfma_f32_16x16x32_bf16 v[104:107], v[32:35], v[48:51], v[104:107]
    ds_read_b64_tr_b16 v[62:63], v8 offset:57856
    s_waitcnt lgkmcnt(9)
    v_mfma_f32_16x16x32_bf16 v[108:111], v[20:23], v[44:47], v[108:111]
    ds_read_b64_tr_b16 v[64:65], v8 offset:61440
    s_waitcnt lgkmcnt(9)
    v_mfma_f32_16x16x32_bf16 v[108:111], v[36:39], v[48:51], v[108:111]
    ds_read_b64_tr_b16 v[66:67], v8 offset:61952
    s_waitcnt lgkmcnt(7)
    v_mfma_f32_16x16x32_bf16 v[112:115], v[24:27], v[44:47], v[112:115]
    ds_read_b64_tr_b16 v[44:45], v9 offset:57344
    s_waitcnt lgkmcnt(7)
    v_mfma_f32_16x16x32_bf16 v[112:115], v[40:43], v[48:51], v[112:115]
    ds_read_b64_tr_b16 v[46:47], v9 offset:57856
    v_mfma_f32_16x16x32_bf16 v[116:119], v[12:15], v[52:55], v[116:119]
    ds_read_b64_tr_b16 v[48:49], v9 offset:61440
    s_waitcnt lgkmcnt(7)
    v_mfma_f32_16x16x32_bf16 v[116:119], v[28:31], v[56:59], v[116:119]
    ds_read_b64_tr_b16 v[50:51], v9 offset:61952
    v_mfma_f32_16x16x32_bf16 v[120:123], v[16:19], v[52:55], v[120:123]
    v_mfma_f32_16x16x32_bf16 v[120:123], v[32:35], v[56:59], v[120:123]
    v_mfma_f32_16x16x32_bf16 v[124:127], v[20:23], v[52:55], v[124:127]
    v_mfma_f32_16x16x32_bf16 v[124:127], v[36:39], v[56:59], v[124:127]
    v_mfma_f32_16x16x32_bf16 v[128:131], v[24:27], v[52:55], v[128:131]
    ds_read_b64_tr_b16 v[52:53], v8 offset:40960
    v_mfma_f32_16x16x32_bf16 v[128:131], v[40:43], v[56:59], v[128:131]
    ds_read_b64_tr_b16 v[54:55], v8 offset:41472
    s_waitcnt lgkmcnt(5)
    v_mfma_f32_16x16x32_bf16 v[132:135], v[12:15], v[60:63], v[132:135]
    ds_read_b64_tr_b16 v[56:57], v8 offset:45056
    v_mfma_f32_16x16x32_bf16 v[132:135], v[28:31], v[64:67], v[132:135]
    ds_read_b64_tr_b16 v[58:59], v8 offset:45568
    v_mfma_f32_16x16x32_bf16 v[136:139], v[16:19], v[60:63], v[136:139]
    v_mfma_f32_16x16x32_bf16 v[136:139], v[32:35], v[64:67], v[136:139]
    v_mfma_f32_16x16x32_bf16 v[140:143], v[20:23], v[60:63], v[140:143]
    v_mfma_f32_16x16x32_bf16 v[140:143], v[36:39], v[64:67], v[140:143]
    v_mfma_f32_16x16x32_bf16 v[144:147], v[24:27], v[60:63], v[144:147]
    ds_read_b64_tr_b16 v[60:61], v9 offset:40960
    v_mfma_f32_16x16x32_bf16 v[144:147], v[40:43], v[64:67], v[144:147]
    ds_read_b64_tr_b16 v[62:63], v9 offset:41472
    s_waitcnt lgkmcnt(5)
    v_mfma_f32_16x16x32_bf16 v[148:151], v[12:15], v[44:47], v[148:151]
    ds_read_b64_tr_b16 v[64:65], v9 offset:45056
    v_mfma_f32_16x16x32_bf16 v[148:151], v[28:31], v[48:51], v[148:151]
    ds_read_b64_tr_b16 v[66:67], v9 offset:45568
    v_mfma_f32_16x16x32_bf16 v[152:155], v[16:19], v[44:47], v[152:155]
    v_mfma_f32_16x16x32_bf16 v[152:155], v[32:35], v[48:51], v[152:155]
    v_mfma_f32_16x16x32_bf16 v[156:159], v[20:23], v[44:47], v[156:159]
    v_mfma_f32_16x16x32_bf16 v[156:159], v[36:39], v[48:51], v[156:159]
    s_waitcnt lgkmcnt(0)
    s_waitcnt vmcnt(0)
    s_barrier
    v_mfma_f32_16x16x32_bf16 v[160:163], v[24:27], v[44:47], v[160:163]
    ds_read_b64_tr_b16 v[44:45], v10 offset:8192
    v_mfma_f32_16x16x32_bf16 v[160:163], v[40:43], v[48:51], v[160:163]
    ds_read_b64_tr_b16 v[46:47], v10 offset:8704
    v_mfma_f32_16x16x32_bf16 v[68:71], v[52:55], v[12:15], v[68:71]
    ds_read_b64_tr_b16 v[48:49], v10 offset:12288
    v_mfma_f32_16x16x32_bf16 v[68:71], v[56:59], v[28:31], v[68:71]
    ds_read_b64_tr_b16 v[50:51], v10 offset:12800
    v_mfma_f32_16x16x32_bf16 v[84:87], v[60:63], v[12:15], v[84:87]
    ds_read_b128 v[12:15], v6 offset:0
    v_mfma_f32_16x16x32_bf16 v[84:87], v[64:67], v[28:31], v[84:87]
    ds_read_b128 v[28:31], v7 offset:0
    v_mfma_f32_16x16x32_bf16 v[72:75], v[52:55], v[16:19], v[72:75]
    v_mfma_f32_16x16x32_bf16 v[72:75], v[56:59], v[32:35], v[72:75]
    v_mfma_f32_16x16x32_bf16 v[88:91], v[60:63], v[16:19], v[88:91]
    ds_read_b128 v[16:19], v6 offset:2048
    v_mfma_f32_16x16x32_bf16 v[88:91], v[64:67], v[32:35], v[88:91]
    ds_read_b128 v[32:35], v7 offset:2048
    v_mfma_f32_16x16x32_bf16 v[76:79], v[52:55], v[20:23], v[76:79]
    v_mfma_f32_16x16x32_bf16 v[76:79], v[56:59], v[36:39], v[76:79]
    v_mfma_f32_16x16x32_bf16 v[92:95], v[60:63], v[20:23], v[92:95]
    ds_read_b128 v[20:23], v6 offset:4096
    v_mfma_f32_16x16x32_bf16 v[92:95], v[64:67], v[36:39], v[92:95]
    ds_read_b128 v[36:39], v7 offset:4096
    v_mfma_f32_16x16x32_bf16 v[80:83], v[52:55], v[24:27], v[80:83]
    ds_read_b64_tr_b16 v[52:53], v11 offset:8192
    v_mfma_f32_16x16x32_bf16 v[80:83], v[56:59], v[40:43], v[80:83]
    ds_read_b64_tr_b16 v[54:55], v11 offset:8704
    v_mfma_f32_16x16x32_bf16 v[96:99], v[60:63], v[24:27], v[96:99]
    ds_read_b128 v[24:27], v6 offset:6144
    v_mfma_f32_16x16x32_bf16 v[96:99], v[64:67], v[40:43], v[96:99]
    ds_read_b128 v[40:43], v7 offset:6144
    v_swap_b32 v4, v6
    v_swap_b32 v5, v7
    v_swap_b32 v8, v10
    v_swap_b32 v9, v11
    s_mov_b32 s81, 5
F_p1:
    s_waitcnt lgkmcnt(7)
    v_mfma_f32_16x16x32_bf16 v[100:103], v[12:15], v[44:47], v[100:103]
    ds_read_b64_tr_b16 v[56:57], v9 offset:12288
    v_mfma_f32_16x16x32_bf16 v[100:103], v[28:31], v[48:51], v[100:103]
    ds_read_b64_tr_b16 v[58:59], v9 offset:12800
    v_mfma_f32_16x16x32_bf16 v[104:107], v[16:19], v[44:47], v[104:107]
    ds_read_b64_tr_b16 v[60:61], v8 offset:16384
    s_waitcnt lgkmcnt(9)
    v_mfma_f32_16x16x32_bf16 v[104:107], v[32:35], v[48:51], v[104:107]
    ds_read_b64_tr_b16 v[62:63], v8 offset:16896
    s_waitcnt lgkmcnt(9)
    v_mfma_f32_16x16x32_bf16 v[108:111], v[20:23], v[44:47], v[108:111]
    ds_read_b64_tr_b16 v[64:65], v8 offset:20480
    s_waitcnt lgkmcnt(9)
    v_mfma_f32_16x16x32_bf16 v[108:111], v[36:39], v[48:51], v[108:111]
    ds_read_b64_tr_b16 v[66:67], v8 offset:20992
    s_waitcnt lgkmcnt(7)
    v_mfma_f32_16x16x32_bf16 v[112:115], v[24:27], v[44:47], v[112:115]
    ds_read_b64_tr_b16 v[44:45], v9 offset:16384
    s_waitcnt lgkmcnt(7)
    v_mfma_f32_16x16x32_bf16 v[112:115], v[40:43], v[48:51], v[112:115]
    ds_read_b64_tr_b16 v[46:47], v9 offset:16896
    v_mfma_f32_16x16x32_bf16 v[116:119], v[12:15], v[52:55], v[116:119]
    ds_read_b64_tr_b16 v[48:49], v9 offset:20480
    s_waitcnt lgkmcnt(7)
    v_mfma_f32_16x16x32_bf16 v[116:119], v[28:31], v[56:59], v[116:119]
    ds_read_b64_tr_b16 v[50:51], v9 offset:20992
    v_mfma_f32_16x16x32_bf16 v[120:123], v[16:19], v[52:55], v[120:123]
    v_mfma_f32_16x16x32_bf16 v[120:123], v[32:35], v[56:59], v[120:123]
    v_mfma_f32_16x16x32_bf16 v[124:127], v[20:23], v[52:55], v[124:127]
    v_mfma_f32_16x16x32_bf16 v[124:127], v[36:39], v[56:59], v[124:127]
    v_mfma_f32_16x16x32_bf16 v[128:131], v[24:27], v[52:55], v[128:131]
    ds_read_b64_tr_b16 v[52:53], v8 offset:0
    v_mfma_f32_16x16x32_bf16 v[128:131], v[40:43], v[56:59], v[128:131]
    ds_read_b64_tr_b16 v[54:55], v8 offset:512
    s_waitcnt lgkmcnt(5)
    v_mfma_f32_16x16x32_bf16 v[132:135], v[12:15], v[60:63], v[132:135]
    ds_read_b64_tr_b16 v[56:57], v8 offset:4096
    v_mfma_f32_16x16x32_bf16 v[132:135], v[28:31], v[64:67], v[132:135]
    ds_read_b64_tr_b16 v[58:59], v8 offset:4608
    v_mfma_f32_16x16x32_bf16 v[136:139], v[16:19], v[60:63], v[136:139]
    v_mfma_f32_16x16x32_bf16 v[136:139], v[32:35], v[64:67], v[136:139]
    v_mfma_f32_16x16x32_bf16 v[140:143], v[20:23], v[60:63], v[140:143]
    v_mfma_f32_16x16x32_bf16 v[140:143], v[36:39], v[64:67], v[140:143]
    v_mfma_f32_16x16x32_bf16 v[144:147], v[24:27], v[60:63], v[144:147]
    ds_read_b64_tr_b16 v[60:61], v9 offset:0
    v_mfma_f32_16x16x32_bf16 v[144:147], v[40:43], v[64:67], v[144:147]
    ds_read_b64_tr_b16 v[62:63], v9 offset:512
    s_waitcnt lgkmcnt(5)
    v_mfma_f32_16x16x32_bf16 v[148:151], v[12:15], v[44:47], v[148:151]
    ds_read_b64_tr_b16 v[64:65], v9 offset:4096
    v_mfma_f32_16x16x32_bf16 v[148:151], v[28:31], v[48:51], v[148:151]
    ds_read_b64_tr_b16 v[66:67], v9 offset:4608
    v_mfma_f32_16x16x32_bf16 v[152:155], v[16:19], v[44:47], v[152:155]
    v_mfma_f32_16x16x32_bf16 v[152:155], v[32:35], v[48:51], v[152:155]
    v_mfma_f32_16x16x32_bf16 v[156:159], v[20:23], v[44:47], v[156:159]
    v_mfma_f32_16x16x32_bf16 v[156:159], v[36:39], v[48:51], v[156:159]
    s_waitcnt lgkmcnt(0)
    s_barrier
    v_mfma_f32_16x16x32_bf16 v[160:163], v[24:27], v[44:47], v[160:163]
    ds_read_b64_tr_b16 v[44:45], v8 offset:49152
    v_mfma_f32_16x16x32_bf16 v[160:163], v[40:43], v[48:51], v[160:163]
    ds_read_b64_tr_b16 v[46:47], v8 offset:49664
    v_mfma_f32_16x16x32_bf16 v[68:71], v[52:55], v[12:15], v[68:71]
    ds_read_b64_tr_b16 v[48:49], v8 offset:53248
    v_mfma_f32_16x16x32_bf16 v[68:71], v[56:59], v[28:31], v[68:71]
    ds_read_b64_tr_b16 v[50:51], v8 offset:53760
    v_mfma_f32_16x16x32_bf16 v[84:87], v[60:63], v[12:15], v[84:87]
    ds_read_b128 v[12:15], v4 offset:40960
    v_mfma_f32_16x16x32_bf16 v[84:87], v[64:67], v[28:31], v[84:87]
    ds_read_b128 v[28:31], v5 offset:40960
    v_mfma_f32_16x16x32_bf16 v[72:75], v[52:55], v[16:19], v[72:75]
    v_mfma_f32_16x16x32_bf16 v[72:75], v[56:59], v[32:35], v[72:75]
    v_mfma_f32_16x16x32_bf16 v[88:91], v[60:63], v[16:19], v[88:91]
    ds_read_b128 v[16:19], v4 offset:43008
    v_mfma_f32_16x16x32_bf16 v[88:91], v[64:67], v[32:35], v[88:91]
    ds_read_b128 v[32:35], v5 offset:43008
    v_mfma_f32_16x16x32_bf16 v[76:79], v[52:55], v[20:23], v[76:79]
    v_mfma_f32_16x16x32_bf16 v[76:79], v[56:59], v[36:39], v[76:79]
    v_mfma_f32_16x16x32_bf16 v[92:95], v[60:63], v[20:23], v[92:95]
    ds_read_b128 v[20:23], v4 offset:45056
    v_mfma_f32_16x16x32_bf16 v[92:95], v[64:67], v[36:39], v[92:95]
    ds_read_b128 v[36:39], v5 offset:45056
    v_mfma_f32_16x16x32_bf16 v[80:83], v[52:55], v[24:27], v[80:83]
    ds_read_b64_tr_b16 v[52:53], v9 offset:49152
    v_mfma_f32_16x16x32_bf16 v[80:83], v[56:59], v[40:43], v[80:83]
    ds_read_b64_tr_b16 v[54:55], v9 offset:49664
    v_mfma_f32_16x16x32_bf16 v[96:99], v[60:63], v[24:27], v[96:99]
    ds_read_b128 v[24:27], v4 offset:47104
    v_mfma_f32_16x16x32_bf16 v[96:99], v[64:67], v[40:43], v[96:99]
    ds_read_b128 v[40:43], v5 offset:47104
    s_waitcnt lgkmcnt(7)
    v_mfma_f32_16x16x32_bf16 v[100:103], v[12:15], v[44:47], v[100:103]
    ds_read_b64_tr_b16 v[56:57], v9 offset:53248
    v_mfma_f32_16x16x32_bf16 v[100:103], v[28:31], v[48:51], v[100:103]
    ds_read_b64_tr_b16 v[58:59], v9 offset:53760
    v_mfma_f32_16x16x32_bf16 v[104:107], v[16:19], v[44:47], v[104:107]
    ds_read_b64_tr_b16 v[60:61], v8 offset:57344
    s_waitcnt lgkmcnt(9)
    v_mfma_f32_16x16x32_bf16 v[104:107], v[32:35], v[48:51], v[104:107]
    ds_read_b64_tr_b16 v[62:63], v8 offset:57856
    s_waitcnt lgkmcnt(9)
    v_mfma_f32_16x16x32_bf16 v[108:111], v[20:23], v[44:47], v[108:111]
    ds_read_b64_tr_b16 v[64:65], v8 offset:61440
    s_waitcnt lgkmcnt(9)
    v_mfma_f32_16x16x32_bf16 v[108:111], v[36:39], v[48:51], v[108:111]
    ds_read_b64_tr_b16 v[66:67], v8 offset:61952
    s_waitcnt lgkmcnt(7)
    v_mfma_f32_16x16x32_bf16 v[112:115], v[24:27], v[44:47], v[112:115]
    ds_read_b64_tr_b16 v[44:45], v9 offset:57344
    s_waitcnt lgkmcnt(7)
    v_mfma_f32_16x16x32_bf16 v[112:115], v[40:43], v[48:51], v[112:115]
    ds_read_b64_tr_b16 v[46:47], v9 offset:57856
    v_mfma_f32_16x16x32_bf16 v[116:119], v[12:15], v[52:55], v[116:119]
    ds_read_b64_tr_b16 v[48:49], v9 offset:61440
    s_waitcnt lgkmcnt(7)
    v_mfma_f32_16x16x32_bf16 v[116:119], v[28:31], v[56:59], v[116:119]
    ds_read_b64_tr_b16 v[50:51], v9 offset:61952
    v_mfma_f32_16x16x32_bf16 v[120:123], v[16:19], v[52:55], v[120:123]
    v_mfma_f32_16x16x32_bf16 v[120:123], v[32:35], v[56:59], v[120:123]
    v_mfma_f32_16x16x32_bf16 v[124:127], v[20:23], v[52:55], v[124:127]
    v_mfma_f32_16x16x32_bf16 v[124:127], v[36:39], v[56:59], v[124:127]
    v_mfma_f32_16x16x32_bf16 v[128:131], v[24:27], v[52:55], v[128:131]
    ds_read_b64_tr_b16 v[52:53], v8 offset:40960
    v_mfma_f32_16x16x32_bf16 v[128:131], v[40:43], v[56:59], v[128:131]
    ds_read_b64_tr_b16 v[54:55], v8 offset:41472
    s_waitcnt lgkmcnt(5)
    v_mfma_f32_16x16x32_bf16 v[132:135], v[12:15], v[60:63], v[132:135]
    ds_read_b64_tr_b16 v[56:57], v8 offset:45056
    v_mfma_f32_16x16x32_bf16 v[132:135], v[28:31], v[64:67], v[132:135]
    ds_read_b64_tr_b16 v[58:59], v8 offset:45568
    v_mfma_f32_16x16x32_bf16 v[136:139], v[16:19], v[60:63], v[136:139]
    v_mfma_f32_16x16x32_bf16 v[136:139], v[32:35], v[64:67], v[136:139]
    v_mfma_f32_16x16x32_bf16 v[140:143], v[20:23], v[60:63], v[140:143]
    v_mfma_f32_16x16x32_bf16 v[140:143], v[36:39], v[64:67], v[140:143]
    v_mfma_f32_16x16x32_bf16 v[144:147], v[24:27], v[60:63], v[144:147]
    ds_read_b64_tr_b16 v[60:61], v9 offset:40960
    v_mfma_f32_16x16x32_bf16 v[144:147], v[40:43], v[64:67], v[144:147]
    ds_read_b64_tr_b16 v[62:63], v9 offset:41472
    s_waitcnt lgkmcnt(5)
    v_mfma_f32_16x16x32_bf16 v[148:151], v[12:15], v[44:47], v[148:151]
    ds_read_b64_tr_b16 v[64:65], v9 offset:45056
    v_mfma_f32_16x16x32_bf16 v[148:151], v[28:31], v[48:51], v[148:151]
    ds_read_b64_tr_b16 v[66:67], v9 offset:45568
    v_mfma_f32_16x16x32_bf16 v[152:155], v[16:19], v[44:47], v[152:155]
    v_mfma_f32_16x16x32_bf16 v[152:155], v[32:35], v[48:51], v[152:155]
    v_mfma_f32_16x16x32_bf16 v[156:159], v[20:23], v[44:47], v[156:159]
    v_mfma_f32_16x16x32_bf16 v[156:159], v[36:39], v[48:51], v[156:159]
    s_waitcnt lgkmcnt(0)
    s_barrier
    v_mfma_f32_16x16x32_bf16 v[160:163], v[24:27], v[44:47], v[160:163]
    ds_read_b64_tr_b16 v[44:45], v10 offset:8192
    v_mfma_f32_16x16x32_bf16 v[160:163], v[40:43], v[48:51], v[160:163]
    ds_read_b64_tr_b16 v[46:47], v10 offset:8704
    v_mfma_f32_16x16x32_bf16 v[68:71], v[52:55], v[12:15], v[68:71]
    ds_read_b64_tr_b16 v[48:49], v10 offset:12288
    v_mfma_f32_16x16x32_bf16 v[68:71], v[56:59], v[28:31], v[68:71]
    ds_read_b64_tr_b16 v[50:51], v10 offset:12800
    v_mfma_f32_16x16x32_bf16 v[84:87], v[60:63], v[12:15], v[84:87]
    ds_read_b128 v[12:15], v6 offset:0
    v_mfma_f32_16x16x32_bf16 v[84:87], v[64:67], v[28:31], v[84:87]
    ds_read_b128 v[28:31], v7 offset:0
    v_mfma_f32_16x16x32_bf16 v[72:75], v[52:55], v[16:19], v[72:75]
    v_mfma_f32_16x16x32_bf16 v[72:75], v[56:59], v[32:35], v[72:75]
    v_mfma_f32_16x16x32_bf16 v[88:91], v[60:63], v[16:19], v[88:91]
    ds_read_b128 v[16:19], v6 offset:2048
    v_mfma_f32_16x16x32_bf16 v[88:91], v[64:67], v[32:35], v[88:91]
    ds_read_b128 v[32:35], v7 offset:2048
    v_mfma_f32_16x16x32_bf16 v[76:79], v[52:55], v[20:23], v[76:79]
    v_mfma_f32_16x16x32_bf16 v[76:79], v[56:59], v[36:39], v[76:79]
    v_mfma_f32_16x16x32_bf16 v[92:95], v[60:63], v[20:23], v[92:95]
    ds_read_b128 v[20:23], v6 offset:4096
    v_mfma_f32_16x16x32_bf16 v[92:95], v[64:67], v[36:39], v[92:95]
    ds_read_b128 v[36:39], v7 offset:4096
    v_mfma_f32_16x16x32_bf16 v[80:83], v[52:55], v[24:27], v[80:83]
    ds_read_b64_tr_b16 v[52:53], v11 offset:8192
    v_mfma_f32_16x16x32_bf16 v[80:83], v[56:59], v[40:43], v[80:83]
    ds_read_b64_tr_b16 v[54:55], v11 offset:8704
    v_mfma_f32_16x16x32_bf16 v[96:99], v[60:63], v[24:27], v[96:99]
    ds_read_b128 v[24:27], v6 offset:6144
    v_mfma_f32_16x16x32_bf16 v[96:99], v[64:67], v[40:43], v[96:99]
    ds_read_b128 v[40:43], v7 offset:6144
    v_swap_b32 v4, v6
    v_swap_b32 v5, v7
    v_swap_b32 v8, v10
    v_swap_b32 v9, v11
    s_sub_u32 s81, s81, 1
    s_cmp_lg_u32 s81, 0
    s_cbranch_scc1 F_p1
    s_waitcnt lgkmcnt(7)
    v_mfma_f32_16x16x32_bf16 v[100:103], v[12:15], v[44:47], v[100:103]
    ds_read_b64_tr_b16 v[56:57], v9 offset:12288
    v_mfma_f32_16x16x32_bf16 v[100:103], v[28:31], v[48:51], v[100:103]
    ds_read_b64_tr_b16 v[58:59], v9 offset:12800
    v_mfma_f32_16x16x32_bf16 v[104:107], v[16:19], v[44:47], v[104:107]
    ds_read_b64_tr_b16 v[60:61], v8 offset:16384
    s_waitcnt lgkmcnt(9)
    v_mfma_f32_16x16x32_bf16 v[104:107], v[32:35], v[48:51], v[104:107]
    ds_read_b64_tr_b16 v[62:63], v8 offset:16896
    s_waitcnt lgkmcnt(9)
    v_mfma_f32_16x16x32_bf16 v[108:111], v[20:23], v[44:47], v[108:111]
    ds_read_b64_tr_b16 v[64:65], v8 offset:20480
    s_waitcnt lgkmcnt(9)
    v_mfma_f32_16x16x32_bf16 v[108:111], v[36:39], v[48:51], v[108:111]
    ds_read_b64_tr_b16 v[66:67], v8 offset:20992
    s_waitcnt lgkmcnt(7)
    v_mfma_f32_16x16x32_bf16 v[112:115], v[24:27], v[44:47], v[112:115]
    ds_read_b64_tr_b16 v[44:45], v9 offset:16384
    s_waitcnt lgkmcnt(7)
    v_mfma_f32_16x16x32_bf16 v[112:115], v[40:43], v[48:51], v[112:115]
    ds_read_b64_tr_b16 v[46:47], v9 offset:16896
    v_mfma_f32_16x16x32_bf16 v[116:119], v[12:15], v[52:55], v[116:119]
    ds_read_b64_tr_b16 v[48:49], v9 offset:20480
    s_waitcnt lgkmcnt(7)
    v_mfma_f32_16x16x32_bf16 v[116:119], v[28:31], v[56:59], v[116:119]
    ds_read_b64_tr_b16 v[50:51], v9 offset:20992
    v_mfma_f32_16x16x32_bf16 v[120:123], v[16:19], v[52:55], v[120:123]
    v_mfma_f32_16x16x32_bf16 v[120:123], v[32:35], v[56:59], v[120:123]
    v_mfma_f32_16x16x32_bf16 v[124:127], v[20:23], v[52:55], v[124:127]
    v_mfma_f32_16x16x32_bf16 v[124:127], v[36:39], v[56:59], v[124:127]
    s_waitcnt lgkmcnt(0)
    s_barrier
    v_mfma_f32_16x16x32_bf16 v[128:131], v[24:27], v[52:55], v[128:131]
    ds_read_b64_tr_b16 v[52:53], v8 offset:49152
    v_mfma_f32_16x16x32_bf16 v[128:131], v[40:43], v[56:59], v[128:131]
    ds_read_b64_tr_b16 v[54:55], v8 offset:49664
    v_mfma_f32_16x16x32_bf16 v[132:135], v[12:15], v[60:63], v[132:135]
    ds_read_b64_tr_b16 v[56:57], v8 offset:53248
    v_mfma_f32_16x16x32_bf16 v[132:135], v[28:31], v[64:67], v[132:135]
    ds_read_b64_tr_b16 v[58:59], v8 offset:53760
    v_mfma_f32_16x16x32_bf16 v[148:151], v[12:15], v[44:47], v[148:151]
    ds_read_b128 v[12:15], v4 offset:40960
    v_mfma_f32_16x16x32_bf16 v[148:151], v[28:31], v[48:51], v[148:151]
    ds_read_b128 v[28:31], v5 offset:40960
    v_mfma_f32_16x16x32_bf16 v[136:139], v[16:19], v[60:63], v[136:139]
    v_mfma_f32_16x16x32_bf16 v[136:139], v[32:35], v[64:67], v[136:139]
    v_mfma_f32_16x16x32_bf16 v[152:155], v[16:19], v[44:47], v[152:155]
    ds_read_b128 v[16:19], v4 offset:43008
    v_mfma_f32_16x16x32_bf16 v[152:155], v[32:35], v[48:51], v[152:155]
    ds_read_b128 v[32:35], v5 offset:43008
    v_mfma_f32_16x16x32_bf16 v[140:143], v[20:23], v[60:63], v[140:143]
    v_mfma_f32_16x16x32_bf16 v[140:143], v[36:39], v[64:67], v[140:143]
    v_mfma_f32_16x16x32_bf16 v[156:159], v[20:23], v[44:47], v[156:159]
    ds_read_b128 v[20:23], v4 offset:45056
    v_mfma_f32_16x16x32_bf16 v[156:159], v[36:39], v[48:51], v[156:159]
    ds_read_b128 v[36:39], v5 offset:45056
    v_mfma_f32_16x16x32_bf16 v[144:147], v[24:27], v[60:63], v[144:147]
    ds_read_b64_tr_b16 v[60:61], v9 offset:49152
    v_mfma_f32_16x16x32_bf16 v[144:147], v[40:43], v[64:67], v[144:147]
    ds_read_b64_tr_b16 v[62:63], v9 offset:49664
    v_mfma_f32_16x16x32_bf16 v[160:163], v[24:27], v[44:47], v[160:163]
    ds_read_b128 v[24:27], v4 offset:47104
    v_mfma_f32_16x16x32_bf16 v[160:163], v[40:43], v[48:51], v[160:163]
    ds_read_b128 v[40:43], v5 offset:47104
    s_waitcnt lgkmcnt(7)
    v_mfma_f32_16x16x32_bf16 v[100:103], v[12:15], v[52:55], v[100:103]
    ds_read_b64_tr_b16 v[64:65], v9 offset:53248
    v_mfma_f32_16x16x32_bf16 v[100:103], v[28:31], v[56:59], v[100:103]
    ds_read_b64_tr_b16 v[66:67], v9 offset:53760
    v_mfma_f32_16x16x32_bf16 v[104:107], v[16:19], v[52:55], v[104:107]
    ds_read_b64_tr_b16 v[44:45], v8 offset:57344
    s_waitcnt lgkmcnt(9)
    v_mfma_f32_16x16x32_bf16 v[104:107], v[32:35], v[56:59], v[104:107]
    ds_read_b64_tr_b16 v[46:47], v8 offset:57856
    s_waitcnt lgkmcnt(9)
    v_mfma_f32_16x16x32_bf16 v[108:111], v[20:23], v[52:55], v[108:111]
    ds_read_b64_tr_b16 v[48:49], v8 offset:61440
    s_waitcnt lgkmcnt(9)
    v_mfma_f32_16x16x32_bf16 v[108:111], v[36:39], v[56:59], v[108:111]
    ds_read_b64_tr_b16 v[50:51], v8 offset:61952
    s_waitcnt lgkmcnt(7)
    v_mfma_f32_16x16x32_bf16 v[112:115], v[24:27], v[52:55], v[112:115]
    ds_read_b64_tr_b16 v[52:53], v9 offset:57344
    s_waitcnt lgkmcnt(7)
    v_mfma_f32_16x16x32_bf16 v[112:115], v[40:43], v[56:59], v[112:115]
    ds_read_b64_tr_b16 v[54:55], v9 offset:57856
    v_mfma_f32_16x16x32_bf16 v[116:119], v[12:15], v[60:63], v[116:119]
    ds_read_b64_tr_b16 v[56:57], v9 offset:61440
    s_waitcnt lgkmcnt(7)
    v_mfma_f32_16x16x32_bf16 v[116:119], v[28:31], v[64:67], v[116:119]
    ds_read_b64_tr_b16 v[58:59], v9 offset:61952
    v_mfma_f32_16x16x32_bf16 v[120:123], v[16:19], v[60:63], v[120:123]
    v_mfma_f32_16x16x32_bf16 v[120:123], v[32:35], v[64:67], v[120:123]
    v_mfma_f32_16x16x32_bf16 v[124:127], v[20:23], v[60:63], v[124:127]
    v_mfma_f32_16x16x32_bf16 v[124:127], v[36:39], v[64:67], v[124:127]
    s_waitcnt lgkmcnt(0)
    s_barrier
    v_mfma_f32_16x16x32_bf16 v[128:131], v[24:27], v[60:63], v[128:131]
    ds_read_b64_tr_b16 v[60:61], v10 offset:8192
    v_mfma_f32_16x16x32_bf16 v[128:131], v[40:43], v[64:67], v[128:131]
    ds_read_b64_tr_b16 v[62:63], v10 offset:8704
    v_mfma_f32_16x16x32_bf16 v[132:135], v[12:15], v[44:47], v[132:135]
    ds_read_b64_tr_b16 v[64:65], v10 offset:12288
    v_mfma_f32_16x16x32_bf16 v[132:135], v[28:31], v[48:51], v[132:135]
    ds_read_b64_tr_b16 v[66:67], v10 offset:12800
    v_mfma_f32_16x16x32_bf16 v[148:151], v[12:15], v[52:55], v[148:151]
    ds_read_b128 v[12:15], v6 offset:0
    v_mfma_f32_16x16x32_bf16 v[148:151], v[28:31], v[56:59], v[148:151]
    ds_read_b128 v[28:31], v7 offset:0
    v_mfma_f32_16x16x32_bf16 v[136:139], v[16:19], v[44:47], v[136:139]
    v_mfma_f32_16x16x32_bf16 v[136:139], v[32:35], v[48:51], v[136:139]
    v_mfma_f32_16x16x32_bf16 v[152:155], v[16:19], v[52:55], v[152:155]
    ds_read_b128 v[16:19], v6 offset:2048
    v_mfma_f32_16x16x32_bf16 v[152:155], v[32:35], v[56:59], v[152:155]
    ds_read_b128 v[32:35], v7 offset:2048
    v_mfma_f32_16x16x32_bf16 v[140:143], v[20:23], v[44:47], v[140:143]
    v_mfma_f32_16x16x32_bf16 v[140:143], v[36:39], v[48:51], v[140:143]
    v_mfma_f32_16x16x32_bf16 v[156:159], v[20:23], v[52:55], v[156:159]
    ds_read_b128 v[20:23], v6 offset:4096
    v_mfma_f32_16x16x32_bf16 v[156:159], v[36:39], v[56:59], v[156:159]
    ds_read_b128 v[36:39], v7 offset:4096
    v_mfma_f32_16x16x32_bf16 v[144:147], v[24:27], v[44:47], v[144:147]
    ds_read_b64_tr_b16 v[44:45], v11 offset:8192
    v_mfma_f32_16x16x32_bf16 v[144:147], v[40:43], v[48:51], v[144:147]
    ds_read_b64_tr_b16 v[46:47], v11 offset:8704
    v_mfma_f32_16x16x32_bf16 v[160:163], v[24:27], v[52:55], v[160:163]
    ds_read_b128 v[24:27], v6 offset:6144
    v_mfma_f32_16x16x32_bf16 v[160:163], v[40:43], v[56:59], v[160:163]
    ds_read_b128 v[40:43], v7 offset:6144
    s_waitcnt lgkmcnt(7)
    v_mfma_f32_16x16x32_bf16 v[100:103], v[12:15], v[60:63], v[100:103]
    ds_read_b64_tr_b16 v[48:49], v11 offset:12288
    v_mfma_f32_16x16x32_bf16 v[100:103], v[28:31], v[64:67], v[100:103]
    ds_read_b64_tr_b16 v[50:51], v11 offset:12800
    v_mfma_f32_16x16x32_bf16 v[104:107], v[16:19], v[60:63], v[104:107]
    ds_read_b64_tr_b16 v[52:53], v10 offset:16384
    s_waitcnt lgkmcnt(9)
    v_mfma_f32_16x16x32_bf16 v[104:107], v[32:35], v[64:67], v[104:107]
    ds_read_b64_tr_b16 v[54:55], v10 offset:16896
    s_waitcnt lgkmcnt(9)
    v_mfma_f32_16x16x32_bf16 v[108:111], v[20:23], v[60:63], v[108:111]
    ds_read_b64_tr_b16 v[56:57], v10 offset:20480
    s_waitcnt lgkmcnt(9)
    v_mfma_f32_16x16x32_bf16 v[108:111], v[36:39], v[64:67], v[108:111]
    ds_read_b64_tr_b16 v[58:59], v10 offset:20992
    s_waitcnt lgkmcnt(7)
    v_mfma_f32_16x16x32_bf16 v[112:115], v[24:27], v[60:63], v[112:115]
    ds_read_b64_tr_b16 v[60:61], v11 offset:16384
    s_waitcnt lgkmcnt(7)
    v_mfma_f32_16x16x32_bf16 v[112:115], v[40:43], v[64:67], v[112:115]
    ds_read_b64_tr_b16 v[62:63], v11 offset:16896
    v_mfma_f32_16x16x32_bf16 v[116:119], v[12:15], v[44:47], v[116:119]
    ds_read_b64_tr_b16 v[64:65], v11 offset:20480
    s_waitcnt lgkmcnt(7)
    v_mfma_f32_16x16x32_bf16 v[116:119], v[28:31], v[48:51], v[116:119]
    ds_read_b64_tr_b16 v[66:67], v11 offset:20992
    v_mfma_f32_16x16x32_bf16 v[120:123], v[16:19], v[44:47], v[120:123]
    v_mfma_f32_16x16x32_bf16 v[120:123], v[32:35], v[48:51], v[120:123]
    v_mfma_f32_16x16x32_bf16 v[124:127], v[20:23], v[44:47], v[124:127]
    v_mfma_f32_16x16x32_bf16 v[124:127], v[36:39], v[48:51], v[124:127]
    s_waitcnt lgkmcnt(0)
    s_barrier
    v_mfma_f32_16x16x32_bf16 v[128:131], v[24:27], v[44:47], v[128:131]
    ds_read_b64_tr_b16 v[44:45], v10 offset:49152
    v_mfma_f32_16x16x32_bf16 v[128:131], v[40:43], v[48:51], v[128:131]
    ds_read_b64_tr_b16 v[46:47], v10 offset:49664
    v_mfma_f32_16x16x32_bf16 v[132:135], v[12:15], v[52:55], v[132:135]
    ds_read_b64_tr_b16 v[48:49], v10 offset:53248
    v_mfma_f32_16x16x32_bf16 v[132:135], v[28:31], v[56:59], v[132:135]
    ds_read_b64_tr_b16 v[50:51], v10 offset:53760
    v_mfma_f32_16x16x32_bf16 v[148:151], v[12:15], v[60:63], v[148:151]
    ds_read_b128 v[12:15], v6 offset:40960
    v_mfma_f32_16x16x32_bf16 v[148:151], v[28:31], v[64:67], v[148:151]
    ds_read_b128 v[28:31], v7 offset:40960
    v_mfma_f32_16x16x32_bf16 v[136:139], v[16:19], v[52:55], v[136:139]
    v_mfma_f32_16x16x32_bf16 v[136:139], v[32:35], v[56:59], v[136:139]
    v_mfma_f32_16x16x32_bf16 v[152:155], v[16:19], v[60:63], v[152:155]
    ds_read_b128 v[16:19], v6 offset:43008
    v_mfma_f32_16x16x32_bf16 v[152:155], v[32:35], v[64:67], v[152:155]
    ds_read_b128 v[32:35], v7 offset:43008
    v_mfma_f32_16x16x32_bf16 v[140:143], v[20:23], v[52:55], v[140:143]
    v_mfma_f32_16x16x32_bf16 v[140:143], v[36:39], v[56:59], v[140:143]
    v_mfma_f32_16x16x32_bf16 v[156:159], v[20:23], v[60:63], v[156:159]
    ds_read_b128 v[20:23], v6 offset:45056
    v_mfma_f32_16x16x32_bf16 v[156:159], v[36:39], v[64:67], v[156:159]
    ds_read_b128 v[36:39], v7 offset:45056
    v_mfma_f32_16x16x32_bf16 v[144:147], v[24:27], v[52:55], v[144:147]
    ds_read_b64_tr_b16 v[52:53], v11 offset:49152
    v_mfma_f32_16x16x32_bf16 v[144:147], v[40:43], v[56:59], v[144:147]
    ds_read_b64_tr_b16 v[54:55], v11 offset:49664
    v_mfma_f32_16x16x32_bf16 v[160:163], v[24:27], v[60:63], v[160:163]
    ds_read_b128 v[24:27], v6 offset:47104
    v_mfma_f32_16x16x32_bf16 v[160:163], v[40:43], v[64:67], v[160:163]
    ds_read_b128 v[40:43], v7 offset:47104
    s_waitcnt lgkmcnt(7)
    v_mfma_f32_16x16x32_bf16 v[100:103], v[12:15], v[44:47], v[100:103]
    ds_read_b64_tr_b16 v[56:57], v11 offset:53248
    v_mfma_f32_16x16x32_bf16 v[100:103], v[28:31], v[48:51], v[100:103]
    ds_read_b64_tr_b16 v[58:59], v11 offset:53760
    v_mfma_f32_16x16x32_bf16 v[104:107], v[16:19], v[44:47], v[104:107]
    ds_read_b64_tr_b16 v[60:61], v10 offset:57344
    s_waitcnt lgkmcnt(9)
    v_mfma_f32_16x16x32_bf16 v[104:107], v[32:35], v[48:51], v[104:107]
    ds_read_b64_tr_b16 v[62:63], v10 offset:57856
    s_waitcnt lgkmcnt(9)
    v_mfma_f32_16x16x32_bf16 v[108:111], v[20:23], v[44:47], v[108:111]
    ds_read_b64_tr_b16 v[64:65], v10 offset:61440
    s_waitcnt lgkmcnt(9)
    v_mfma_f32_16x16x32_bf16 v[108:111], v[36:39], v[48:51], v[108:111]
    ds_read_b64_tr_b16 v[66:67], v10 offset:61952
    s_waitcnt lgkmcnt(7)
    v_mfma_f32_16x16x32_bf16 v[112:115], v[24:27], v[44:47], v[112:115]
    ds_read_b64_tr_b16 v[44:45], v11 offset:57344
    s_waitcnt lgkmcnt(7)
    v_mfma_f32_16x16x32_bf16 v[112:115], v[40:43], v[48:51], v[112:115]
    ds_read_b64_tr_b16 v[46:47], v11 offset:57856
    v_mfma_f32_16x16x32_bf16 v[116:119], v[12:15], v[52:55], v[116:119]
    ds_read_b64_tr_b16 v[48:49], v11 offset:61440
    s_waitcnt lgkmcnt(7)
    v_mfma_f32_16x16x32_bf16 v[116:119], v[28:31], v[56:59], v[116:119]
    ds_read_b64_tr_b16 v[50:51], v11 offset:61952
    v_mfma_f32_16x16x32_bf16 v[120:123], v[16:19], v[52:55], v[120:123]
    v_mfma_f32_16x16x32_bf16 v[120:123], v[32:35], v[56:59], v[120:123]
    v_mfma_f32_16x16x32_bf16 v[124:127], v[20:23], v[52:55], v[124:127]
    v_mfma_f32_16x16x32_bf16 v[124:127], v[36:39], v[56:59], v[124:127]
    v_mfma_f32_16x16x32_bf16 v[128:131], v[24:27], v[52:55], v[128:131]
    ds_read2_b32 v[52:53], v165 offset0:64 offset1:64
    v_mfma_f32_16x16x32_bf16 v[128:131], v[40:43], v[56:59], v[128:131]
    ds_read2_b32 v[54:55], v165 offset0:80 offset1:80
    s_waitcnt lgkmcnt(5)
    v_mfma_f32_16x16x32_bf16 v[132:135], v[12:15], v[60:63], v[132:135]
    ds_read2_b32 v[56:57], v165 offset0:128 offset1:128
    v_mfma_f32_16x16x32_bf16 v[132:135], v[28:31], v[64:67], v[132:135]
    ds_read2_b32 v[58:59], v165 offset0:144 offset1:144
    s_waitcnt lgkmcnt(5)
    v_mfma_f32_16x16x32_bf16 v[148:151], v[12:15], v[44:47], v[148:151]
    ds_read_b128 v[12:15], v164 offset:0
    s_waitcnt lgkmcnt(5)
    v_mfma_f32_16x16x32_bf16 v[148:151], v[28:31], v[48:51], v[148:151]
    ds_read_b128 v[28:31], v164 offset:512
    v_mfma_f32_16x16x32_bf16 v[136:139], v[16:19], v[60:63], v[136:139]
    v_mfma_f32_16x16x32_bf16 v[136:139], v[32:35], v[64:67], v[136:139]
    v_mfma_f32_16x16x32_bf16 v[152:155], v[16:19], v[44:47], v[152:155]
    ds_read_b128 v[16:19], v164 offset:64
    v_mfma_f32_16x16x32_bf16 v[152:155], v[32:35], v[48:51], v[152:155]
    ds_read_b128 v[32:35], v164 offset:576
    v_mfma_f32_16x16x32_bf16 v[140:143], v[20:23], v[60:63], v[140:143]
    v_mfma_f32_16x16x32_bf16 v[140:143], v[36:39], v[64:67], v[140:143]
    v_mfma_f32_16x16x32_bf16 v[156:159], v[20:23], v[44:47], v[156:159]
    v_mfma_f32_16x16x32_bf16 v[156:159], v[36:39], v[48:51], v[156:159]
    v_mfma_f32_16x16x32_bf16 v[144:147], v[24:27], v[60:63], v[144:147]
    ds_read_b128 v[60:63], v164 offset:1024
    v_mfma_f32_16x16x32_bf16 v[144:147], v[40:43], v[64:67], v[144:147]
    ds_read_b128 v[64:67], v164 offset:1088
    v_mfma_f32_16x16x32_bf16 v[160:163], v[24:27], v[44:47], v[160:163]
    v_mfma_f32_16x16x32_bf16 v[160:163], v[40:43], v[48:51], v[160:163]
    s_mov_b32 s50, 0x10001
    s_mov_b32 s51, s50
    ds_read_b128 v[36:39], v164 offset:128
    ds_read_b128 v[40:43], v164 offset:192
    ds_read_b128 v[44:47], v164 offset:640
    ds_read_b128 v[48:51], v164 offset:704
    s_waitcnt lgkmcnt(9)
    v_pk_fma_f32 v[100:101], v[12:13], v[52:53], v[100:101]
    v_pk_fma_f32 v[102:103], v[14:15], v[52:53], v[102:103]
    s_waitcnt lgkmcnt(7)
    v_pk_fma_f32 v[104:105], v[16:17], v[52:53], v[104:105]
    v_pk_fma_f32 v[106:107], v[18:19], v[52:53], v[106:107]
    s_waitcnt lgkmcnt(5)
    v_pk_mul_f32 v[20:21], v[100:101], v[60:61]
    v_pk_mul_f32 v[22:23], v[102:103], v[62:63]
    s_waitcnt lgkmcnt(4)
    v_pk_mul_f32 v[24:25], v[104:105], v[64:65]
    v_pk_mul_f32 v[26:27], v[106:107], v[66:67]
    v_pk_fma_f32 v[100:101], v[100:101], v[28:29], s[40:41]
    v_pk_fma_f32 v[102:103], v[102:103], v[30:31], s[40:41]
    v_pk_fma_f32 v[104:105], v[104:105], v[32:33], s[40:41]
    v_pk_fma_f32 v[106:107], v[106:107], v[34:35], s[40:41]
    v_exp_f32 v20, v20 clamp
    v_exp_f32 v21, v21 clamp
    v_exp_f32 v22, v22 clamp
    v_exp_f32 v23, v23 clamp
    v_exp_f32 v24, v24 clamp
    v_exp_f32 v25, v25 clamp
    v_exp_f32 v26, v26 clamp
    v_exp_f32 v27, v27 clamp
    v_pk_add_f32 v[20:21], v[20:21], s[74:75]
    v_pk_add_f32 v[22:23], v[22:23], s[74:75]
    v_pk_add_f32 v[24:25], v[24:25], s[74:75]
    v_pk_add_f32 v[26:27], v[26:27], s[74:75]
    v_max_f32 v100, v100, v20
    v_max_f32 v101, v101, v21
    v_max_f32 v102, v102, v22
    v_max_f32 v103, v103, v23
    v_max_f32 v104, v104, v24
    v_max_f32 v105, v105, v25
    v_max_f32 v106, v106, v26
    v_max_f32 v107, v107, v27
    v_cvt_pk_bf16_f32 v100, v100, v101
    v_cvt_pk_bf16_f32 v101, v102, v103
    v_cvt_pk_bf16_f32 v102, v104, v105
    v_cvt_pk_bf16_f32 v103, v106, v107
    s_waitcnt lgkmcnt(3)
    v_pk_fma_f32 v[140:141], v[36:37], v[56:57], v[140:141]
    v_pk_fma_f32 v[142:143], v[38:39], v[56:57], v[142:143]
    s_waitcnt lgkmcnt(2)
    v_pk_fma_f32 v[144:145], v[40:41], v[56:57], v[144:145]
    v_pk_fma_f32 v[146:147], v[42:43], v[56:57], v[146:147]
    s_waitcnt lgkmcnt(1)
    v_pk_mul_f32 v[140:141], v[140:141], v[44:45]
    v_pk_mul_f32 v[142:143], v[142:143], v[46:47]
    s_waitcnt lgkmcnt(0)
    v_pk_mul_f32 v[144:145], v[144:145], v[48:49]
    v_pk_mul_f32 v[146:147], v[146:147], v[50:51]
    v_cvt_pk_bf16_f32 v140, v140, v141
    v_cvt_pk_bf16_f32 v141, v142, v143
    v_cvt_pk_bf16_f32 v142, v144, v145
    v_cvt_pk_bf16_f32 v143, v146, v147
    v_pk_fma_f32 v[156:157], v[36:37], v[58:59], v[156:157]
    v_pk_fma_f32 v[158:159], v[38:39], v[58:59], v[158:159]
    v_pk_fma_f32 v[160:161], v[40:41], v[58:59], v[160:161]
    v_pk_fma_f32 v[162:163], v[42:43], v[58:59], v[162:163]
    v_pk_mul_f32 v[156:157], v[156:157], v[44:45]
    v_pk_mul_f32 v[158:159], v[158:159], v[46:47]
    v_pk_mul_f32 v[160:161], v[160:161], v[48:49]
    v_pk_mul_f32 v[162:163], v[162:163], v[50:51]
    v_cvt_pk_bf16_f32 v156, v156, v157
    v_cvt_pk_bf16_f32 v157, v158, v159
    v_cvt_pk_bf16_f32 v158, v160, v161
    v_cvt_pk_bf16_f32 v159, v162, v163
    ds_read_b128 v[144:147], v164 offset:1152
    ds_read_b128 v[160:163], v164 offset:1216
    v_pk_fma_f32 v[132:133], v[12:13], v[56:57], v[132:133]
    v_pk_fma_f32 v[134:135], v[14:15], v[56:57], v[134:135]
    v_pk_fma_f32 v[136:137], v[16:17], v[56:57], v[136:137]
    v_pk_fma_f32 v[138:139], v[18:19], v[56:57], v[138:139]
    v_pk_mul_f32 v[132:133], v[132:133], v[28:29]
    v_pk_mul_f32 v[134:135], v[134:135], v[30:31]
    v_pk_mul_f32 v[136:137], v[136:137], v[32:33]
    v_pk_mul_f32 v[138:139], v[138:139], v[34:35]
    v_cvt_pk_bf16_f32 v132, v132, v133
    v_cvt_pk_bf16_f32 v133, v134, v135
    v_cvt_pk_bf16_f32 v134, v136, v137
    v_cvt_pk_bf16_f32 v135, v138, v139
    v_pk_fma_f32 v[148:149], v[12:13], v[58:59], v[148:149]
    v_pk_fma_f32 v[150:151], v[14:15], v[58:59], v[150:151]
    v_pk_fma_f32 v[152:153], v[16:17], v[58:59], v[152:153]
    v_pk_fma_f32 v[154:155], v[18:19], v[58:59], v[154:155]
    v_pk_mul_f32 v[148:149], v[148:149], v[28:29]
    v_pk_mul_f32 v[150:151], v[150:151], v[30:31]
    v_pk_mul_f32 v[152:153], v[152:153], v[32:33]
    v_pk_mul_f32 v[154:155], v[154:155], v[34:35]
    v_cvt_pk_bf16_f32 v148, v148, v149
    v_cvt_pk_bf16_f32 v149, v150, v151
    v_cvt_pk_bf16_f32 v150, v152, v153
    v_cvt_pk_bf16_f32 v151, v154, v155
    v_mov_b32 v56, 0x3f803f80
    v_mov_b32 v57, 0x3f803f80
    v_mov_b32 v58, 0x3f803f80
    v_mov_b32 v59, 0x3f803f80
    v_mov_b32 v164, 1
    v_mov_b32 v165, 2
    v_pk_fma_f32 v[108:109], v[36:37], v[52:53], v[108:109]
    v_pk_fma_f32 v[110:111], v[38:39], v[52:53], v[110:111]
    v_pk_fma_f32 v[112:113], v[40:41], v[52:53], v[112:113]
    v_pk_fma_f32 v[114:115], v[42:43], v[52:53], v[114:115]
    s_waitcnt lgkmcnt(1)
    v_pk_mul_f32 v[20:21], v[108:109], v[144:145]
    v_pk_mul_f32 v[22:23], v[110:111], v[146:147]
    s_waitcnt lgkmcnt(0)
    v_pk_mul_f32 v[24:25], v[112:113], v[160:161]
    v_pk_mul_f32 v[26:27], v[114:115], v[162:163]
    v_pk_fma_f32 v[108:109], v[108:109], v[44:45], s[40:41]
    v_pk_fma_f32 v[110:111], v[110:111], v[46:47], s[40:41]
    v_pk_fma_f32 v[112:113], v[112:113], v[48:49], s[40:41]
    v_pk_fma_f32 v[114:115], v[114:115], v[50:51], s[40:41]
    v_mfma_f32_16x16x32_bf16 v[136:139], v[100:103], v[132:135], 0
    v_exp_f32 v20, v20 clamp
    v_mfma_f32_16x16x32_bf16 v[152:155], v[100:103], v[148:151], 0
    v_exp_f32 v21, v21 clamp
    v_mfma_f32_16x16x32_bf16 v[104:107], v[100:103], v[56:59], 0
    v_exp_f32 v22, v22 clamp
    v_exp_f32 v23, v23 clamp
    v_exp_f32 v24, v24 clamp
    v_exp_f32 v25, v25 clamp
    v_exp_f32 v26, v26 clamp
    v_exp_f32 v27, v27 clamp
    v_pk_add_f32 v[20:21], v[20:21], s[74:75]
    v_pk_add_f32 v[22:23], v[22:23], s[74:75]
    v_pk_add_f32 v[24:25], v[24:25], s[74:75]
    v_pk_add_f32 v[26:27], v[26:27], s[74:75]
    v_max_f32 v108, v108, v20
    v_max_f32 v109, v109, v21
    v_max_f32 v110, v110, v22
    v_max_f32 v111, v111, v23
    v_max_f32 v112, v112, v24
    v_max_f32 v113, v113, v25
    v_max_f32 v114, v114, v26
    v_max_f32 v115, v115, v27
    v_cvt_pk_bf16_f32 v108, v108, v109
    v_cvt_pk_bf16_f32 v109, v110, v111
    v_cvt_pk_bf16_f32 v110, v112, v113
    v_cvt_pk_bf16_f32 v111, v114, v115
    v_pk_fma_f32 v[116:117], v[12:13], v[54:55], v[116:117]
    v_pk_fma_f32 v[118:119], v[14:15], v[54:55], v[118:119]
    v_pk_fma_f32 v[120:121], v[16:17], v[54:55], v[120:121]
    v_pk_fma_f32 v[122:123], v[18:19], v[54:55], v[122:123]
    v_pk_mul_f32 v[20:21], v[116:117], v[60:61]
    v_pk_mul_f32 v[22:23], v[118:119], v[62:63]
    v_pk_mul_f32 v[24:25], v[120:121], v[64:65]
    v_pk_mul_f32 v[26:27], v[122:123], v[66:67]
    v_pk_fma_f32 v[116:117], v[116:117], v[28:29], s[40:41]
    v_pk_fma_f32 v[118:119], v[118:119], v[30:31], s[40:41]
    v_pk_fma_f32 v[120:121], v[120:121], v[32:33], s[40:41]
    v_pk_fma_f32 v[122:123], v[122:123], v[34:35], s[40:41]
    v_mfma_f32_16x16x32_bf16 v[136:139], v[108:111], v[140:143], v[136:139]
    v_exp_f32 v20, v20 clamp
    v_mfma_f32_16x16x32_bf16 v[152:155], v[108:111], v[156:159], v[152:155]
    v_exp_f32 v21, v21 clamp
    v_mfma_f32_16x16x32_bf16 v[104:107], v[108:111], v[56:59], v[104:107]
    v_exp_f32 v22, v22 clamp
    v_exp_f32 v23, v23 clamp
    v_exp_f32 v24, v24 clamp
    v_exp_f32 v25, v25 clamp
    v_exp_f32 v26, v26 clamp
    v_exp_f32 v27, v27 clamp
    v_pk_add_f32 v[20:21], v[20:21], s[74:75]
    v_pk_add_f32 v[22:23], v[22:23], s[74:75]
    v_pk_add_f32 v[24:25], v[24:25], s[74:75]
    v_pk_add_f32 v[26:27], v[26:27], s[74:75]
    ds_write_b128 v1, v[136:139] offset:0
    ds_write_b128 v1, v[152:155] offset:1024
    s_mov_b64 exec, s[50:51]
    ds_write_b128 v2, v[104:107] offset:0
    s_mov_b64 exec, 1
    ds_write_b32 v3, v164
    s_mov_b64 exec, -1
    v_max_f32 v116, v116, v20
    v_max_f32 v117, v117, v21
    v_max_f32 v118, v118, v22
    v_max_f32 v119, v119, v23
    v_max_f32 v120, v120, v24
    v_max_f32 v121, v121, v25
    v_max_f32 v122, v122, v26
    v_max_f32_e64 v123, v123, v27
    v_cvt_pk_bf16_f32 v116, v116, v117
    v_cvt_pk_bf16_f32 v117, v118, v119
    v_cvt_pk_bf16_f32 v118, v120, v121
    v_cvt_pk_bf16_f32 v119, v122, v123
    v_pk_fma_f32 v[124:125], v[36:37], v[54:55], v[124:125]
    v_pk_fma_f32 v[126:127], v[38:39], v[54:55], v[126:127]
    v_pk_fma_f32 v[128:129], v[40:41], v[54:55], v[128:129]
    v_pk_fma_f32 v[130:131], v[42:43], v[54:55], v[130:131]
    v_pk_mul_f32 v[20:21], v[124:125], v[144:145]
    v_pk_mul_f32 v[22:23], v[126:127], v[146:147]
    v_pk_mul_f32 v[24:25], v[128:129], v[160:161]
    v_pk_mul_f32 v[26:27], v[130:131], v[162:163]
    v_pk_fma_f32 v[124:125], v[124:125], v[44:45], s[40:41]
    v_pk_fma_f32 v[126:127], v[126:127], v[46:47], s[40:41]
    v_pk_fma_f32 v[128:129], v[128:129], v[48:49], s[40:41]
    v_pk_fma_f32 v[130:131], v[130:131], v[50:51], s[40:41]
    v_mfma_f32_16x16x32_bf16 v[112:115], v[116:119], v[132:135], 0
    v_exp_f32 v20, v20 clamp
    v_mfma_f32_16x16x32_bf16 v[120:123], v[116:119], v[148:151], 0
    v_exp_f32 v21, v21 clamp
    v_mfma_f32_16x16x32_bf16 v[100:103], v[116:119], v[56:59], 0
    v_exp_f32 v22, v22 clamp
    v_exp_f32 v23, v23 clamp
    v_exp_f32 v24, v24 clamp
    v_exp_f32 v25, v25 clamp
    v_exp_f32 v26, v26 clamp
    v_exp_f32 v27, v27 clamp
    v_pk_add_f32 v[20:21], v[20:21], s[74:75]
    v_pk_add_f32 v[22:23], v[22:23], s[74:75]
    v_pk_add_f32 v[24:25], v[24:25], s[74:75]
    v_pk_add_f32 v[26:27], v[26:27], s[74:75]
    v_max_f32 v124, v124, v20
    v_max_f32 v125, v125, v21
    v_max_f32 v126, v126, v22
    v_max_f32 v127, v127, v23
    v_max_f32 v128, v128, v24
    v_max_f32 v129, v129, v25
    v_max_f32 v130, v130, v26
    v_max_f32 v131, v131, v27
    v_cvt_pk_bf16_f32 v124, v124, v125
    v_cvt_pk_bf16_f32 v125, v126, v127
    v_cvt_pk_bf16_f32 v126, v128, v129
    v_cvt_pk_bf16_f32 v127, v130, v131
    s_nop 1
    v_mfma_f32_16x16x32_bf16 v[112:115], v[124:127], v[140:143], v[112:115]
    v_mfma_f32_16x16x32_bf16 v[120:123], v[124:127], v[156:159], v[120:123]
    v_mfma_f32_16x16x32_bf16 v[100:103], v[124:127], v[56:59], v[100:103]
    ds_read_b128 v[28:31], v4 offset:0
    ds_read_b64_tr_b16 v[44:45], v8 offset:0
    ds_read_b64_tr_b16 v[46:47], v8 offset:512
    ds_read_b128 v[32:35], v4 offset:2048
    ds_read_b128 v[36:39], v4 offset:4096
    ds_read_b128 v[40:43], v4 offset:6144
    ds_write_b128 v1, v[112:115] offset:2048
    ds_write_b128 v1, v[120:123] offset:3072
    s_mov_b64 exec, s[50:51]
    ds_write_b128 v2, v[100:103] offset:64
    s_mov_b64 exec, 1
    ds_write_b32 v3, v165
    s_mov_b64 exec, -1
    ds_read_b64_tr_b16 v[48:49], v9 offset:0
    s_waitcnt lgkmcnt(8)
    ds_read_b64_tr_b16 v[50:51], v9 offset:512
    s_setprio 0
    v_and_b32 v132, 15, v0
    s_lshl_b32 s44, s36, 8
    s_add_u32 s44, s44, 24832
    v_lshl_add_u32 v132, v132, 2, s44
    v_add_u32 v133, 1024, v132
    s_lshl_b32 s44, s37, 7
    s_add_u32 s44, s44, 26368
    v_and_or_b32 v134, v0, 48, s44
    s_lshl_b32 s44, s35, 2
    s_and_b32 s47, s3, 2
    s_add_u32 s44, s44, s47
    s_lshr_b32 s44, 0xeee7eece, s44
    s_and_b32 s44, s44, 3
    s_mul_i32 s44, s44, 40960
    s_and_b32 s47, s28, 1
    s_lshl_b32 s47, s47, 13
    s_add_u32 s44, s44, s47
    s_lshl_b32 s47, s37, 6
    v_and_b32 v140, 0x30, v167
    v_xor_b32 v140, s47, v140
    v_and_b32 v141, 14, v0
    v_lshlrev_b32 v141, 3, v141
    v_xor_b32 v140, v140, v141
    v_and_b32 v141, 15, v0
    v_lshlrev_b32 v141, 7, v141
    v_add3_u32 v140, v140, v141, s44

    s_waitcnt lgkmcnt(9)
    v_mfma_f32_16x16x32_bf16 v[68:71], v[44:47], v[28:31], v[68:71]
    ds_read_b128 v[12:15], v5 offset:0
    ds_read_b64_tr_b16 v[52:53], v8 offset:4096
    s_waitcnt lgkmcnt(10)
    v_mfma_f32_16x16x32_bf16 v[72:75], v[44:47], v[32:35], v[72:75]
    ds_read_b64_tr_b16 v[54:55], v8 offset:4608
    ds_read_b128 v[16:19], v5 offset:2048
    s_waitcnt lgkmcnt(11)
    v_mfma_f32_16x16x32_bf16 v[76:79], v[44:47], v[36:39], v[76:79]
    ds_read_b128 v[20:23], v5 offset:4096
    ds_read_b128 v[24:27], v5 offset:6144
    s_waitcnt lgkmcnt(12)
    v_mfma_f32_16x16x32_bf16 v[80:83], v[44:47], v[40:43], v[80:83]
    ds_read_b64_tr_b16 v[56:57], v9 offset:4096
    ds_read_b64_tr_b16 v[58:59], v9 offset:4608
    s_waitcnt lgkmcnt(8)
    v_mfma_f32_16x16x32_bf16 v[84:87], v[48:51], v[28:31], v[84:87]
    v_mfma_f32_16x16x32_bf16 v[88:91], v[48:51], v[32:35], v[88:91]
    v_mfma_f32_16x16x32_bf16 v[92:95], v[48:51], v[36:39], v[92:95]
    v_mfma_f32_16x16x32_bf16 v[96:99], v[48:51], v[40:43], v[96:99]
    s_waitcnt lgkmcnt(5)
    v_mfma_f32_16x16x32_bf16 v[68:71], v[52:55], v[12:15], v[68:71]
    ds_read_b128 v[28:31], v4 offset:40960
    ds_read_b64_tr_b16 v[44:45], v8 offset:40960
    s_waitcnt lgkmcnt(6)
    v_mfma_f32_16x16x32_bf16 v[72:75], v[52:55], v[16:19], v[72:75]
    ds_read_b64_tr_b16 v[46:47], v8 offset:41472
    ds_read_b128 v[32:35], v4 offset:43008
    s_waitcnt lgkmcnt(7)
    v_mfma_f32_16x16x32_bf16 v[76:79], v[52:55], v[20:23], v[76:79]
    ds_read_b128 v[36:39], v4 offset:45056
    ds_read_b128 v[40:43], v4 offset:47104
    s_waitcnt lgkmcnt(8)
    v_mfma_f32_16x16x32_bf16 v[80:83], v[52:55], v[24:27], v[80:83]
    ds_read_b64_tr_b16 v[48:49], v9 offset:40960
    ds_read_b64_tr_b16 v[50:51], v9 offset:41472
    s_waitcnt lgkmcnt(8)
    v_mfma_f32_16x16x32_bf16 v[84:87], v[56:59], v[12:15], v[84:87]
    v_mfma_f32_16x16x32_bf16 v[88:91], v[56:59], v[16:19], v[88:91]
    v_mfma_f32_16x16x32_bf16 v[92:95], v[56:59], v[20:23], v[92:95]
    v_mfma_f32_16x16x32_bf16 v[96:99], v[56:59], v[24:27], v[96:99]
    s_waitcnt lgkmcnt(5)
    v_mfma_f32_16x16x32_bf16 v[68:71], v[44:47], v[28:31], v[68:71]
    ds_read_b128 v[12:15], v5 offset:40960
    ds_read_b64_tr_b16 v[52:53], v8 offset:45056
    s_waitcnt lgkmcnt(6)
    v_mfma_f32_16x16x32_bf16 v[72:75], v[44:47], v[32:35], v[72:75]
    ds_read_b64_tr_b16 v[54:55], v8 offset:45568
    ds_read_b128 v[16:19], v5 offset:43008
    s_waitcnt lgkmcnt(7)
    v_mfma_f32_16x16x32_bf16 v[76:79], v[44:47], v[36:39], v[76:79]
    ds_read_b128 v[20:23], v5 offset:45056
    ds_read_b128 v[24:27], v5 offset:47104
    s_waitcnt lgkmcnt(8)
    v_mfma_f32_16x16x32_bf16 v[80:83], v[44:47], v[40:43], v[80:83]
    ds_read_b64_tr_b16 v[56:57], v9 offset:45056
    ds_read_b64_tr_b16 v[58:59], v9 offset:45568
    s_waitcnt lgkmcnt(8)
    v_mfma_f32_16x16x32_bf16 v[84:87], v[48:51], v[28:31], v[84:87]
    ds_read_b128 v[148:151], v140 offset:0
    ds_read_b128 v[152:155], v140 offset:2048
    v_mfma_f32_16x16x32_bf16 v[88:91], v[48:51], v[32:35], v[88:91]
    ds_read_b128 v[156:159], v140 offset:4096
    ds_read_b128 v[160:163], v140 offset:6144
    v_mfma_f32_16x16x32_bf16 v[92:95], v[48:51], v[36:39], v[92:95]
    v_mfma_f32_16x16x32_bf16 v[96:99], v[48:51], v[40:43], v[96:99]
    s_waitcnt lgkmcnt(9)
    v_mfma_f32_16x16x32_bf16 v[68:71], v[52:55], v[12:15], v[68:71]
    ds_read_b128 v[28:31], v6 offset:0
    ds_read_b64_tr_b16 v[44:45], v10 offset:0
    s_waitcnt lgkmcnt(10)
    v_mfma_f32_16x16x32_bf16 v[72:75], v[52:55], v[16:19], v[72:75]
    ds_read_b64_tr_b16 v[46:47], v10 offset:512
    ds_read_b128 v[32:35], v6 offset:2048
    s_waitcnt lgkmcnt(11)
    v_mfma_f32_16x16x32_bf16 v[76:79], v[52:55], v[20:23], v[76:79]
    ds_read_b128 v[36:39], v6 offset:4096
    ds_read_b128 v[40:43], v6 offset:6144
    s_waitcnt lgkmcnt(12)
    v_mfma_f32_16x16x32_bf16 v[80:83], v[52:55], v[24:27], v[80:83]
    ds_read_b64_tr_b16 v[48:49], v11 offset:0
    ds_read_b64_tr_b16 v[50:51], v11 offset:512
    s_waitcnt lgkmcnt(12)
    v_mfma_f32_16x16x32_bf16 v[84:87], v[56:59], v[12:15], v[84:87]
    v_mfma_f32_16x16x32_bf16 v[88:91], v[56:59], v[16:19], v[88:91]
    v_mfma_f32_16x16x32_bf16 v[92:95], v[56:59], v[20:23], v[92:95]
    v_mfma_f32_16x16x32_bf16 v[96:99], v[56:59], v[24:27], v[96:99]
    s_waitcnt lgkmcnt(5)
    v_mfma_f32_16x16x32_bf16 v[68:71], v[44:47], v[28:31], v[68:71]
    ds_read_b128 v[12:15], v7 offset:0
    ds_read_b64_tr_b16 v[52:53], v10 offset:4096
    s_waitcnt lgkmcnt(6)
    v_mfma_f32_16x16x32_bf16 v[72:75], v[44:47], v[32:35], v[72:75]
    ds_read_b64_tr_b16 v[54:55], v10 offset:4608
    ds_read_b128 v[16:19], v7 offset:2048
    s_waitcnt lgkmcnt(7)
    v_mfma_f32_16x16x32_bf16 v[76:79], v[44:47], v[36:39], v[76:79]
    ds_read_b128 v[20:23], v7 offset:4096
    ds_read_b128 v[24:27], v7 offset:6144
    s_waitcnt lgkmcnt(8)
    v_mfma_f32_16x16x32_bf16 v[80:83], v[44:47], v[40:43], v[80:83]
    ds_read_b64_tr_b16 v[56:57], v11 offset:4096
    ds_read_b64_tr_b16 v[58:59], v11 offset:4608
    s_waitcnt lgkmcnt(8)
    v_mfma_f32_16x16x32_bf16 v[84:87], v[48:51], v[28:31], v[84:87]
    v_mfma_f32_16x16x32_bf16 v[88:91], v[48:51], v[32:35], v[88:91]
    v_mfma_f32_16x16x32_bf16 v[92:95], v[48:51], v[36:39], v[92:95]
    v_mfma_f32_16x16x32_bf16 v[96:99], v[48:51], v[40:43], v[96:99]
    s_waitcnt lgkmcnt(5)
    v_mfma_f32_16x16x32_bf16 v[68:71], v[52:55], v[12:15], v[68:71]
    ds_read_b128 v[28:31], v6 offset:40960
    ds_read_b64_tr_b16 v[44:45], v10 offset:40960
    s_waitcnt lgkmcnt(6)
    v_mfma_f32_16x16x32_bf16 v[72:75], v[52:55], v[16:19], v[72:75]
    ds_read_b64_tr_b16 v[46:47], v10 offset:41472
    ds_read_b128 v[32:35], v6 offset:43008
    s_waitcnt lgkmcnt(7)
    v_mfma_f32_16x16x32_bf16 v[76:79], v[52:55], v[20:23], v[76:79]
    ds_read_b128 v[36:39], v6 offset:45056
    ds_read_b128 v[40:43], v6 offset:47104
    s_waitcnt lgkmcnt(8)
    v_mfma_f32_16x16x32_bf16 v[80:83], v[52:55], v[24:27], v[80:83]
    ds_read_b64_tr_b16 v[48:49], v11 offset:40960
    ds_read_b64_tr_b16 v[50:51], v11 offset:41472
    s_waitcnt lgkmcnt(8)
    v_mfma_f32_16x16x32_bf16 v[84:87], v[56:59], v[12:15], v[84:87]
    v_mfma_f32_16x16x32_bf16 v[88:91], v[56:59], v[16:19], v[88:91]
    v_mfma_f32_16x16x32_bf16 v[92:95], v[56:59], v[20:23], v[92:95]
    v_mfma_f32_16x16x32_bf16 v[96:99], v[56:59], v[24:27], v[96:99]
    s_waitcnt lgkmcnt(5)
    v_mfma_f32_16x16x32_bf16 v[68:71], v[44:47], v[28:31], v[68:71]
    ds_read_b128 v[12:15], v7 offset:40960
    ds_read_b64_tr_b16 v[52:53], v10 offset:45056
    s_waitcnt lgkmcnt(6)
    v_mfma_f32_16x16x32_bf16 v[72:75], v[44:47], v[32:35], v[72:75]
    ds_read_b64_tr_b16 v[54:55], v10 offset:45568
    ds_read_b128 v[16:19], v7 offset:43008
    s_waitcnt lgkmcnt(7)
    v_mfma_f32_16x16x32_bf16 v[76:79], v[44:47], v[36:39], v[76:79]
    ds_read_b128 v[20:23], v7 offset:45056
    ds_read_b128 v[24:27], v7 offset:47104
    s_waitcnt lgkmcnt(8)
    v_mfma_f32_16x16x32_bf16 v[80:83], v[44:47], v[40:43], v[80:83]
    ds_read_b64_tr_b16 v[56:57], v11 offset:45056
    ds_read_b64_tr_b16 v[58:59], v11 offset:45568
    s_waitcnt lgkmcnt(8)
    v_mfma_f32_16x16x32_bf16 v[84:87], v[48:51], v[28:31], v[84:87]
    v_mfma_f32_16x16x32_bf16 v[88:91], v[48:51], v[32:35], v[88:91]
    v_mfma_f32_16x16x32_bf16 v[92:95], v[48:51], v[36:39], v[92:95]
    v_mfma_f32_16x16x32_bf16 v[96:99], v[48:51], v[40:43], v[96:99]
    s_waitcnt lgkmcnt(5)
    v_mfma_f32_16x16x32_bf16 v[68:71], v[52:55], v[12:15], v[68:71]
    v_mov_b32_e64 v135, 3
    s_mov_b64 exec, 1
    ds_write_b32 v3, v135 offset:0
    s_mov_b64 exec, -1
    ds_read_b128 v[100:103], v134 offset:0
    ds_read_b128 v[104:107], v134 offset:64
    s_waitcnt lgkmcnt(7)
    v_mfma_f32_16x16x32_bf16 v[72:75], v[52:55], v[16:19], v[72:75]
    ds_read2_b32 v[108:109], v132 offset0:0 offset1:0
    ds_read2_b32 v[110:111], v132 offset0:16 offset1:16
    s_waitcnt lgkmcnt(8)
    v_mfma_f32_16x16x32_bf16 v[76:79], v[52:55], v[20:23], v[76:79]
    ds_read2_b32 v[112:113], v132 offset0:32 offset1:32
    ds_read2_b32 v[114:115], v132 offset0:48 offset1:48
    s_waitcnt lgkmcnt(9)
    v_mfma_f32_16x16x32_bf16 v[80:83], v[52:55], v[24:27], v[80:83]
    ds_read2_b32 v[124:125], v133 offset0:0 offset1:0
    ds_read2_b32 v[126:127], v133 offset0:16 offset1:16
    s_waitcnt lgkmcnt(9)
    v_mfma_f32_16x16x32_bf16 v[84:87], v[56:59], v[12:15], v[84:87]
    ds_read2_b32 v[128:129], v133 offset0:32 offset1:32
    ds_read2_b32 v[130:131], v133 offset0:48 offset1:48
    v_mfma_f32_16x16x32_bf16 v[88:91], v[56:59], v[16:19], v[88:91]
    ds_read2_b32 v[116:117], v132 offset0:128 offset1:128
    ds_read2_b32 v[118:119], v132 offset0:144 offset1:144
    v_mfma_f32_16x16x32_bf16 v[92:95], v[56:59], v[20:23], v[92:95]
    ds_read2_b32 v[120:121], v132 offset0:160 offset1:160
    ds_read2_b32 v[122:123], v132 offset0:176 offset1:176
    v_mfma_f32_16x16x32_bf16 v[96:99], v[56:59], v[24:27], v[96:99]
    s_waitcnt lgkmcnt(11)
    v_pk_fma_f32 v[68:69], v[100:101], v[108:109], v[68:69]
    v_pk_fma_f32 v[70:71], v[102:103], v[108:109], v[70:71]
    v_pk_fma_f32 v[84:85], v[104:105], v[108:109], v[84:85]
    v_pk_fma_f32 v[86:87], v[106:107], v[108:109], v[86:87]
    s_waitcnt lgkmcnt(10)
    v_pk_fma_f32 v[72:73], v[100:101], v[110:111], v[72:73]
    v_pk_fma_f32 v[74:75], v[102:103], v[110:111], v[74:75]
    v_pk_fma_f32 v[88:89], v[104:105], v[110:111], v[88:89]
    v_pk_fma_f32 v[90:91], v[106:107], v[110:111], v[90:91]
    s_waitcnt lgkmcnt(9)
    v_pk_fma_f32 v[76:77], v[100:101], v[112:113], v[76:77]
    v_pk_fma_f32 v[78:79], v[102:103], v[112:113], v[78:79]
    v_pk_fma_f32 v[92:93], v[104:105], v[112:113], v[92:93]
    v_pk_fma_f32 v[94:95], v[106:107], v[112:113], v[94:95]
    s_waitcnt lgkmcnt(8)
    v_pk_fma_f32 v[80:81], v[100:101], v[114:115], v[80:81]
    v_pk_fma_f32 v[82:83], v[102:103], v[114:115], v[82:83]
    v_pk_fma_f32 v[96:97], v[104:105], v[114:115], v[96:97]
    v_pk_fma_f32 v[98:99], v[106:107], v[114:115], v[98:99]
    s_waitcnt lgkmcnt(7)
    v_pk_mul_f32 v[12:13], v[68:69], v[124:125]
    v_pk_mul_f32 v[14:15], v[70:71], v[124:125]
    v_pk_mul_f32 v[16:17], v[84:85], v[124:125]
    v_pk_mul_f32 v[18:19], v[86:87], v[124:125]
    s_waitcnt lgkmcnt(6)
    v_pk_mul_f32 v[20:21], v[72:73], v[126:127]
    v_pk_mul_f32 v[22:23], v[74:75], v[126:127]
    v_pk_mul_f32 v[24:25], v[88:89], v[126:127]
    v_pk_mul_f32 v[26:27], v[90:91], v[126:127]
    s_waitcnt lgkmcnt(5)
    v_pk_mul_f32 v[28:29], v[76:77], v[128:129]
    v_pk_mul_f32 v[30:31], v[78:79], v[128:129]
    v_pk_mul_f32 v[32:33], v[92:93], v[128:129]
    v_pk_mul_f32 v[34:35], v[94:95], v[128:129]
    s_waitcnt lgkmcnt(4)
    v_pk_mul_f32 v[36:37], v[80:81], v[130:131]
    v_pk_mul_f32 v[38:39], v[82:83], v[130:131]
    v_pk_mul_f32 v[40:41], v[96:97], v[130:131]
    v_pk_mul_f32 v[42:43], v[98:99], v[130:131]
    s_waitcnt lgkmcnt(3)
    v_pk_fma_f32 v[68:69], v[68:69], v[116:117], s[40:41]
    v_pk_fma_f32 v[70:71], v[70:71], v[116:117], s[40:41]
    v_pk_fma_f32 v[84:85], v[84:85], v[116:117], s[40:41]
    v_pk_fma_f32 v[86:87], v[86:87], v[116:117], s[40:41]
    s_waitcnt lgkmcnt(2)
    v_pk_fma_f32 v[72:73], v[72:73], v[118:119], s[40:41]
    v_pk_fma_f32 v[74:75], v[74:75], v[118:119], s[40:41]
    v_pk_fma_f32 v[88:89], v[88:89], v[118:119], s[40:41]
    v_pk_fma_f32 v[90:91], v[90:91], v[118:119], s[40:41]
    s_waitcnt lgkmcnt(1)
    v_pk_fma_f32 v[76:77], v[76:77], v[120:121], s[40:41]
    v_pk_fma_f32 v[78:79], v[78:79], v[120:121], s[40:41]
    v_pk_fma_f32 v[92:93], v[92:93], v[120:121], s[40:41]
    v_pk_fma_f32 v[94:95], v[94:95], v[120:121], s[40:41]
    s_waitcnt lgkmcnt(0)
    v_pk_fma_f32 v[80:81], v[80:81], v[122:123], s[40:41]
    v_pk_fma_f32 v[82:83], v[82:83], v[122:123], s[40:41]
    v_pk_fma_f32 v[96:97], v[96:97], v[122:123], s[40:41]
    v_pk_fma_f32 v[98:99], v[98:99], v[122:123], s[40:41]
    v_exp_f32 v12, v12 clamp
    v_exp_f32 v13, v13 clamp
    v_exp_f32 v14, v14 clamp
    v_exp_f32 v15, v15 clamp
    v_exp_f32 v16, v16 clamp
    v_exp_f32 v17, v17 clamp
    v_exp_f32 v18, v18 clamp
    v_exp_f32 v19, v19 clamp
    v_exp_f32 v20, v20 clamp
    v_exp_f32 v21, v21 clamp
    v_exp_f32 v22, v22 clamp
    v_exp_f32 v23, v23 clamp
    v_exp_f32 v24, v24 clamp
    v_exp_f32 v25, v25 clamp
    v_exp_f32 v26, v26 clamp
    v_exp_f32 v27, v27 clamp
    v_exp_f32 v28, v28 clamp
    v_exp_f32 v29, v29 clamp
    v_exp_f32 v30, v30 clamp
    v_exp_f32 v31, v31 clamp
    v_exp_f32 v32, v32 clamp
    v_exp_f32 v33, v33 clamp
    v_exp_f32 v34, v34 clamp
    v_exp_f32 v35, v35 clamp
    v_exp_f32 v36, v36 clamp
    v_exp_f32 v37, v37 clamp
    v_exp_f32 v38, v38 clamp
    v_exp_f32 v39, v39 clamp
    v_exp_f32 v40, v40 clamp
    v_exp_f32 v41, v41 clamp
    v_exp_f32 v42, v42 clamp
    v_exp_f32 v43, v43 clamp
    v_pk_add_f32 v[12:13], v[12:13], s[74:75]
    v_pk_add_f32 v[14:15], v[14:15], s[74:75]
    v_pk_add_f32 v[16:17], v[16:17], s[74:75]
    v_pk_add_f32 v[18:19], v[18:19], s[74:75]
    v_pk_add_f32 v[20:21], v[20:21], s[74:75]
    v_pk_add_f32 v[22:23], v[22:23], s[74:75]
    v_pk_add_f32 v[24:25], v[24:25], s[74:75]
    v_pk_add_f32 v[26:27], v[26:27], s[74:75]
    v_pk_add_f32 v[28:29], v[28:29], s[74:75]
    v_pk_add_f32 v[30:31], v[30:31], s[74:75]
    v_pk_add_f32 v[32:33], v[32:33], s[74:75]
    v_pk_add_f32 v[34:35], v[34:35], s[74:75]
    v_pk_add_f32 v[36:37], v[36:37], s[74:75]
    v_pk_add_f32 v[38:39], v[38:39], s[74:75]
    v_pk_add_f32 v[40:41], v[40:41], s[74:75]
    v_pk_add_f32 v[42:43], v[42:43], s[74:75]
    v_max_f32 v68, v68, v12
    v_max_f32 v69, v69, v13
    v_max_f32 v70, v70, v14
    v_max_f32 v71, v71, v15
    v_max_f32 v84, v84, v16
    v_max_f32 v85, v85, v17
    v_max_f32 v86, v86, v18
    v_max_f32 v87, v87, v19
    v_max_f32 v72, v72, v20
    v_max_f32 v73, v73, v21
    v_max_f32 v74, v74, v22
    v_max_f32 v75, v75, v23
    v_max_f32 v88, v88, v24
    v_max_f32 v89, v89, v25
    v_max_f32 v90, v90, v26
    v_max_f32 v91, v91, v27
    v_max_f32 v76, v76, v28
    v_max_f32 v77, v77, v29
    v_max_f32 v78, v78, v30
    v_max_f32 v79, v79, v31
    v_max_f32 v92, v92, v32
    v_max_f32 v93, v93, v33
    v_max_f32 v94, v94, v34
    v_max_f32 v95, v95, v35
    v_max_f32 v80, v80, v36
    v_max_f32 v81, v81, v37
    v_max_f32 v82, v82, v38
    v_max_f32 v83, v83, v39
    v_max_f32 v96, v96, v40
    v_max_f32 v97, v97, v41
    v_max_f32 v98, v98, v42
    v_max_f32 v99, v99, v43
    v_cvt_pk_bf16_f32 v44, v68, v69
    v_cvt_pk_bf16_f32 v45, v70, v71
    v_cvt_pk_bf16_f32 v46, v84, v85
    v_cvt_pk_bf16_f32 v47, v86, v87
    v_cvt_pk_bf16_f32 v48, v72, v73
    v_cvt_pk_bf16_f32 v49, v74, v75
    v_cvt_pk_bf16_f32 v50, v88, v89
    v_cvt_pk_bf16_f32 v51, v90, v91
    v_cvt_pk_bf16_f32 v52, v76, v77
    v_cvt_pk_bf16_f32 v53, v78, v79
    v_cvt_pk_bf16_f32 v54, v92, v93
    v_cvt_pk_bf16_f32 v55, v94, v95
    v_cvt_pk_bf16_f32 v56, v80, v81
    v_cvt_pk_bf16_f32 v57, v82, v83
    v_cvt_pk_bf16_f32 v58, v96, v97
    v_cvt_pk_bf16_f32 v59, v98, v99
    s_load_dwordx8 s[60:67], s[48:49], 0 glc
    s_and_b32 s44, s46, 127
    s_lshl_b32 s44, s44, 2
    s_add_u32 s44, s44, 24832
    v_and_b32 v1, 15, v0
    v_lshl_add_u32 v63, v1, 2, s44

    ds_read2_b32 v[4:5], v63 offset0:0 offset1:0
    ds_read2_b32 v[6:7], v63 offset0:16 offset1:16
    ds_read2_b32 v[8:9], v63 offset0:32 offset1:32
    ds_read2_b32 v[10:11], v63 offset0:48 offset1:48
    ds_read2_b32 v[12:13], v63 offset0:128 offset1:128
    ds_read2_b32 v[14:15], v63 offset0:144 offset1:144
    ds_read2_b32 v[16:17], v63 offset0:160 offset1:160
    ds_read2_b32 v[18:19], v63 offset0:176 offset1:176
    v_lshlrev_b32 v60, 4, v0
    v_and_b32 v61, 48, v0
    s_setprio 2
SP_1:
    s_load_dword s58, s[56:57], 0 glc
    s_waitcnt lgkmcnt(0)
    s_cmp_ge_u32 s58, 32
    s_cbranch_scc1 SD_2
    s_sleep 1
    s_branch SP_1
SD_2:
F_kp:
    buffer_load_dwordx4 v[36:39], v61, s[24:27], s83 offen offset:0 sc0 sc1
    buffer_load_dwordx4 v[40:43], v61, s[24:27], s83 offen offset:64 sc0 sc1
    buffer_load_dwordx4 v[20:23], v60, s[24:27], s82 offen offset:0 sc0 sc1
    buffer_load_dwordx4 v[24:27], v60, s[24:27], s82 offen offset:2048 sc0 sc1
    buffer_load_dwordx4 v[28:31], v60, s[24:27], s82 offen offset:1024 sc0 sc1
    buffer_load_dwordx4 v[32:35], v60, s[24:27], s82 offen offset:3072 sc0 sc1
    v_mov_b32 v62, 4
    s_mov_b64 exec, 1
    ds_write_b32 v3, v62 offset:0
    s_mov_b64 exec, -1
    s_waitcnt vmcnt(4)
    v_cvt_pk_bf16_f32 v124, v36, v37
    v_cvt_pk_bf16_f32 v125, v38, v39
    v_cvt_pk_bf16_f32 v126, v40, v41
    v_cvt_pk_bf16_f32 v127, v42, v43
    s_nop 1
    v_mfma_f32_16x16x32_bf16 v[76:79], v[124:127], v[44:47], 0
    v_mfma_f32_16x16x32_bf16 v[88:91], v[124:127], v[48:51], 0
    v_mfma_f32_16x16x32_bf16 v[100:103], v[124:127], v[52:55], 0
    v_mfma_f32_16x16x32_bf16 v[112:115], v[124:127], v[56:59], 0
    s_waitcnt vmcnt(2)
    v_cvt_pk_bf16_f32 v116, v20, v21
    v_cvt_pk_bf16_f32 v117, v22, v23
    v_cvt_pk_bf16_f32 v118, v24, v25
    v_cvt_pk_bf16_f32 v119, v26, v27
    s_nop 1
    v_mfma_f32_16x16x32_bf16 v[68:71], v[116:119], v[44:47], 0
    v_mfma_f32_16x16x32_bf16 v[80:83], v[116:119], v[48:51], 0
    v_mfma_f32_16x16x32_bf16 v[92:95], v[116:119], v[52:55], 0
    v_mfma_f32_16x16x32_bf16 v[104:107], v[116:119], v[56:59], 0
    v_add_f32 v76, s74, v76
    v_rcp_f32 v76, v76
    s_nop 0
    v_mov_b32 v77, v76
    v_add_f32 v88, s74, v88
    v_rcp_f32 v88, v88
    s_nop 0
    v_mov_b32 v89, v88
    v_add_f32 v100, s74, v100
    v_rcp_f32 v100, v100
    s_nop 0
    v_mov_b32 v101, v100
    v_add_f32 v112, s74, v112
    v_rcp_f32 v112, v112
    s_nop 0
    v_mov_b32_e64 v113, v112
    s_waitcnt vmcnt(0)
    v_cvt_pk_bf16_f32 v120, v28, v29
    v_cvt_pk_bf16_f32 v121, v30, v31
    v_cvt_pk_bf16_f32 v122, v32, v33
    v_cvt_pk_bf16_f32 v123, v34, v35
    s_nop 1
    v_mfma_f32_16x16x32_bf16 v[72:75], v[120:123], v[44:47], 0
    v_mfma_f32_16x16x32_bf16 v[84:87], v[120:123], v[48:51], 0
    v_mfma_f32_16x16x32_bf16 v[96:99], v[120:123], v[52:55], 0
    v_mfma_f32_16x16x32_bf16 v[108:111], v[120:123], v[56:59], 0
    s_add_u32 s80, s79, 0
    v_pk_mul_f32 v[68:69], v[68:69], v[76:77]
    v_pk_mul_f32 v[70:71], v[70:71], v[76:77]
    s_nop 1
    v_pk_mul_f32 v[72:73], v[72:73], v[76:77]
    v_pk_mul_f32 v[74:75], v[74:75], v[76:77]
    v_cvt_pk_bf16_f32 v28, v68, v69
    v_cvt_pk_bf16_f32 v29, v70, v71
    v_cvt_pk_bf16_f32 v30, v72, v73
    v_cvt_pk_bf16_f32 v31, v74, v75
    buffer_store_dwordx4 v[28:31], v60, s[16:19], s80 offen sc0 sc1
    s_add_u32 s80, s79, 32768
    v_pk_mul_f32 v[80:81], v[80:81], v[88:89]
    v_pk_mul_f32 v[82:83], v[82:83], v[88:89]
    v_pk_mul_f32 v[84:85], v[84:85], v[88:89]
    v_pk_mul_f32 v[86:87], v[86:87], v[88:89]
    v_cvt_pk_bf16_f32 v32, v80, v81
    v_cvt_pk_bf16_f32 v33, v82, v83
    v_cvt_pk_bf16_f32 v34, v84, v85
    v_cvt_pk_bf16_f32 v35, v86, v87
    buffer_store_dwordx4 v[32:35], v60, s[16:19], s80 offen sc0 sc1
    s_add_u32 s80, s79, 65536
    v_pk_mul_f32 v[92:93], v[92:93], v[100:101]
    v_pk_mul_f32 v[94:95], v[94:95], v[100:101]
    v_pk_mul_f32 v[96:97], v[96:97], v[100:101]
    v_pk_mul_f32 v[98:99], v[98:99], v[100:101]
    v_cvt_pk_bf16_f32 v36, v92, v93
    v_cvt_pk_bf16_f32 v37, v94, v95
    v_cvt_pk_bf16_f32 v38, v96, v97
    v_cvt_pk_bf16_f32 v39, v98, v99
    buffer_store_dwordx4 v[36:39], v60, s[16:19], s80 offen sc0 sc1
    s_add_u32 s80, s79, 98304
    v_pk_mul_f32 v[104:105], v[104:105], v[112:113]
    v_pk_mul_f32 v[106:107], v[106:107], v[112:113]
    v_pk_mul_f32 v[108:109], v[108:109], v[112:113]
    v_pk_mul_f32 v[110:111], v[110:111], v[112:113]
    v_cvt_pk_bf16_f32 v40, v104, v105
    v_cvt_pk_bf16_f32 v41, v106, v107
    v_cvt_pk_bf16_f32 v42, v108, v109
    v_cvt_pk_bf16_f32 v43, v110, v111
    buffer_store_dwordx4 v[40:43], v60, s[16:19], s80 offen sc0 sc1
    v_lshlrev_b32 v132, 16, v148
    v_and_b32 v133, 0xffff0000, v148
    v_lshlrev_b32 v134, 16, v149
    v_and_b32 v135, 0xffff0000, v149
    v_lshlrev_b32 v136, 16, v150
    v_and_b32 v137, 0xffff0000, v150
    v_lshlrev_b32 v138, 16, v151
    v_and_b32 v139, 0xffff0000, v151
    v_pk_add_f32 v[72:73], v[132:133], v[4:5]
    v_pk_add_f32 v[74:75], v[134:135], v[4:5]
    v_pk_add_f32 v[76:77], v[136:137], v[4:5]
    v_pk_add_f32 v[78:79], v[138:139], v[4:5]
    v_cvt_pk_bf16_f32 v68, v72, v73
    v_cvt_pk_bf16_f32 v69, v74, v75
    v_cvt_pk_bf16_f32 v70, v76, v77
    v_cvt_pk_bf16_f32 v71, v78, v79
    v_lshlrev_b32 v72, 16, v68
    v_and_b32 v73, 0xffff0000, v68
    v_lshlrev_b32 v74, 16, v69
    v_and_b32 v75, 0xffff0000, v69
    v_lshlrev_b32 v76, 16, v70
    v_and_b32 v77, 0xffff0000, v70
    v_lshlrev_b32 v78, 16, v71
    v_and_b32 v79, 0xffff0000, v71
    v_pk_mul_f32 v[72:73], v[72:73], v[12:13]
    v_pk_mul_f32 v[74:75], v[74:75], v[12:13]
    v_pk_mul_f32 v[76:77], v[76:77], v[12:13]
    v_pk_mul_f32 v[78:79], v[78:79], v[12:13]
    v_cvt_pk_bf16_f32 v68, v72, v73
    v_cvt_pk_bf16_f32 v69, v74, v75
    v_cvt_pk_bf16_f32 v70, v76, v77
    v_cvt_pk_bf16_f32 v71, v78, v79
    v_lshlrev_b32 v72, 16, v68
    v_and_b32 v73, 0xffff0000, v68
    v_lshlrev_b32 v74, 16, v69
    v_and_b32 v75, 0xffff0000, v69
    v_lshlrev_b32 v76, 16, v70
    v_and_b32 v77, 0xffff0000, v70
    v_lshlrev_b32 v78, 16, v71
    v_and_b32 v79, 0xffff0000, v71
    v_pk_add_f32 v[132:133], v[132:133], v[72:73]
    v_pk_add_f32 v[134:135], v[134:135], v[74:75]
    v_pk_add_f32 v[136:137], v[136:137], v[76:77]
    v_pk_add_f32 v[138:139], v[138:139], v[78:79]
    v_lshlrev_b32 v140, 16, v152
    v_and_b32 v141, 0xffff0000, v152
    v_lshlrev_b32 v142, 16, v153
    v_and_b32 v143, 0xffff0000, v153
    v_lshlrev_b32 v144, 16, v154
    v_and_b32 v145, 0xffff0000, v154
    v_lshlrev_b32 v146, 16, v155
    v_and_b32 v147, 0xffff0000, v155
    v_pk_add_f32 v[72:73], v[140:141], v[6:7]
    v_pk_add_f32 v[74:75], v[142:143], v[6:7]
    v_pk_add_f32 v[76:77], v[144:145], v[6:7]
    v_pk_add_f32 v[78:79], v[146:147], v[6:7]
    v_cvt_pk_bf16_f32 v68, v72, v73
    v_cvt_pk_bf16_f32 v69, v74, v75
    v_cvt_pk_bf16_f32 v70, v76, v77
    v_cvt_pk_bf16_f32 v71, v78, v79
    v_lshlrev_b32 v72, 16, v68
    v_and_b32 v73, 0xffff0000, v68
    v_lshlrev_b32 v74, 16, v69
    v_and_b32 v75, 0xffff0000, v69
    v_lshlrev_b32 v76, 16, v70
    v_and_b32 v77, 0xffff0000, v70
    v_lshlrev_b32 v78, 16, v71
    v_and_b32 v79, 0xffff0000, v71
    v_pk_mul_f32 v[72:73], v[72:73], v[14:15]
    v_pk_mul_f32 v[74:75], v[74:75], v[14:15]
    v_pk_mul_f32 v[76:77], v[76:77], v[14:15]
    v_pk_mul_f32 v[78:79], v[78:79], v[14:15]
    v_cvt_pk_bf16_f32 v68, v72, v73
    v_cvt_pk_bf16_f32 v69, v74, v75
    v_cvt_pk_bf16_f32 v70, v76, v77
    v_cvt_pk_bf16_f32 v71, v78, v79
    v_lshlrev_b32 v72, 16, v68
    v_and_b32 v73, 0xffff0000, v68
    v_lshlrev_b32 v74, 16, v69
    v_and_b32 v75, 0xffff0000, v69
    v_lshlrev_b32 v76, 16, v70
    v_and_b32 v77, 0xffff0000, v70
    v_lshlrev_b32 v78, 16, v71
    v_and_b32 v79, 0xffff0000, v71
    v_pk_add_f32 v[140:141], v[140:141], v[72:73]
    v_pk_add_f32 v[142:143], v[142:143], v[74:75]
    v_pk_add_f32 v[144:145], v[144:145], v[76:77]
    v_pk_add_f32 v[146:147], v[146:147], v[78:79]
    v_permlane16_swap_b32 v132, v136
    v_permlane16_swap_b32 v133, v137
    v_permlane16_swap_b32 v134, v138
    v_permlane16_swap_b32 v135, v139
    v_permlane16_swap_b32 v140, v144
    v_permlane16_swap_b32 v141, v145
    v_permlane16_swap_b32 v142, v146
    v_permlane16_swap_b32 v143, v147
    s_waitcnt vmcnt(0)
    s_atomic_add s76, s[68:69], 0
    s_atomic_add s76, s[68:69], 128
    s_atomic_add s76, s[68:69], 256
    s_atomic_add s76, s[68:69], 384
    v_mov_b32 v62, 5
    s_mov_b64 exec, 1
    ds_write_b32 v3, v62 offset:0
    s_mov_b64 exec, -1
    s_setprio 0
    v_lshlrev_b32 v148, 16, v156
    v_and_b32 v149, 0xffff0000, v156
    v_lshlrev_b32 v150, 16, v157
    v_and_b32 v151, 0xffff0000, v157
    v_lshlrev_b32 v152, 16, v158
    v_and_b32 v153, 0xffff0000, v158
    v_lshlrev_b32_e64 v154, 16, v159
    v_and_b32 v155, 0xffff0000, v159
    v_pk_add_f32 v[72:73], v[148:149], v[8:9]
    v_pk_add_f32 v[74:75], v[150:151], v[8:9]
    v_pk_add_f32 v[76:77], v[152:153], v[8:9]
    v_pk_add_f32 v[78:79], v[154:155], v[8:9]
    v_cvt_pk_bf16_f32 v68, v72, v73
    v_cvt_pk_bf16_f32 v69, v74, v75
    v_cvt_pk_bf16_f32 v70, v76, v77
    v_cvt_pk_bf16_f32 v71, v78, v79
    v_lshlrev_b32 v72, 16, v68
    v_and_b32 v73, 0xffff0000, v68
    v_lshlrev_b32 v74, 16, v69
    v_and_b32 v75, 0xffff0000, v69
    v_lshlrev_b32 v76, 16, v70
    v_and_b32 v77, 0xffff0000, v70
    v_lshlrev_b32 v78, 16, v71
    v_and_b32 v79, 0xffff0000, v71
    v_pk_mul_f32 v[72:73], v[72:73], v[16:17]
    v_pk_mul_f32 v[74:75], v[74:75], v[16:17]
    v_pk_mul_f32 v[76:77], v[76:77], v[16:17]
    v_pk_mul_f32 v[78:79], v[78:79], v[16:17]
    v_cvt_pk_bf16_f32 v68, v72, v73
    v_cvt_pk_bf16_f32 v69, v74, v75
    v_cvt_pk_bf16_f32 v70, v76, v77
    v_cvt_pk_bf16_f32 v71, v78, v79
    v_lshlrev_b32 v72, 16, v68
    v_and_b32 v73, 0xffff0000, v68
    v_lshlrev_b32 v74, 16, v69
    v_and_b32 v75, 0xffff0000, v69
    v_lshlrev_b32 v76, 16, v70
    v_and_b32 v77, 0xffff0000, v70
    v_lshlrev_b32 v78, 16, v71
    v_and_b32 v79, 0xffff0000, v71
    v_pk_add_f32 v[148:149], v[148:149], v[72:73]
    v_pk_add_f32 v[150:151], v[150:151], v[74:75]
    v_pk_add_f32 v[152:153], v[152:153], v[76:77]
    v_pk_add_f32 v[154:155], v[154:155], v[78:79]
    v_lshlrev_b32 v156, 16, v160
    v_and_b32 v157, 0xffff0000, v160
    v_lshlrev_b32 v158, 16, v161
    v_and_b32 v159, 0xffff0000, v161
    v_lshlrev_b32 v160, 16, v162
    v_and_b32 v161, 0xffff0000, v162
    v_lshlrev_b32 v162, 16, v163
    v_and_b32 v163, 0xffff0000, v163
    v_pk_add_f32 v[72:73], v[156:157], v[10:11]
    v_pk_add_f32 v[74:75], v[158:159], v[10:11]
    v_pk_add_f32 v[76:77], v[160:161], v[10:11]
    v_pk_add_f32 v[78:79], v[162:163], v[10:11]
    v_cvt_pk_bf16_f32 v68, v72, v73
    v_cvt_pk_bf16_f32 v69, v74, v75
    v_cvt_pk_bf16_f32 v70, v76, v77
    v_cvt_pk_bf16_f32 v71, v78, v79
    v_lshlrev_b32 v72, 16, v68
    v_and_b32 v73, 0xffff0000, v68
    v_lshlrev_b32 v74, 16, v69
    v_and_b32 v75, 0xffff0000, v69
    v_lshlrev_b32 v76, 16, v70
    v_and_b32 v77, 0xffff0000, v70
    v_lshlrev_b32 v78, 16, v71
    v_and_b32 v79, 0xffff0000, v71
    v_pk_mul_f32 v[72:73], v[72:73], v[18:19]
    v_pk_mul_f32 v[74:75], v[74:75], v[18:19]
    v_pk_mul_f32 v[76:77], v[76:77], v[18:19]
    v_pk_mul_f32 v[78:79], v[78:79], v[18:19]
    v_cvt_pk_bf16_f32 v68, v72, v73
    v_cvt_pk_bf16_f32 v69, v74, v75
    v_cvt_pk_bf16_f32 v70, v76, v77
    v_cvt_pk_bf16_f32 v71, v78, v79
    v_lshlrev_b32 v72, 16, v68
    v_and_b32 v73, 0xffff0000, v68
    v_lshlrev_b32 v74, 16, v69
    v_and_b32 v75, 0xffff0000, v69
    v_lshlrev_b32 v76, 16, v70
    v_and_b32 v77, 0xffff0000, v70
    v_lshlrev_b32 v78, 16, v71
    v_and_b32 v79, 0xffff0000, v71
    v_pk_add_f32 v[156:157], v[156:157], v[72:73]
    v_pk_add_f32 v[158:159], v[158:159], v[74:75]
    v_pk_add_f32 v[160:161], v[160:161], v[76:77]
    v_pk_add_f32 v[162:163], v[162:163], v[78:79]
    v_permlane16_swap_b32 v148, v152
    v_permlane16_swap_b32 v149, v153
    v_permlane16_swap_b32 v150, v154
    v_permlane16_swap_b32 v151, v155
    v_permlane16_swap_b32 v156, v160
    v_permlane16_swap_b32 v157, v161
    v_permlane16_swap_b32 v158, v162
    v_permlane16_swap_b32 v159, v163
    v_lshrrev_b32 v2, 4, v0
    v_lshlrev_b32 v4, 4, v0
    v_add_u32 v5, 98304, v4
    v_add_u32 v4, 16384, v4
    v_bfe_u32 v1, v0, 2, 2
    v_lshl_add_u32 v1, v2, 2, v1
    v_and_b32 v63, 7, v1
    s_lshl_b32 s44, s3, 1
    v_xor_b32 v63, s44, v63
    v_lshlrev_b32 v63, 5, v63
    v_lshl_add_u32 v63, v1, 8, v63
    v_and_b32 v1, 3, v0
    v_lshl_add_u32 v8, v1, 3, v63
    v_xor_b32 v9, 32, v8
    v_add_u32 v10, 65536, v8
    v_add_u32 v11, 65536, v9
    v_add_u32 v12, 122880, v8
    v_add_u32 v13, 122880, v9
    v_and_b32 v1, 15, v0

    v_mov_b32 v128, 0
    v_mov_b32 v129, 0
    v_mov_b32 v130, 0
    v_mov_b32 v131, 0
    s_mov_b32 s77, 0
F_km:
    s_and_b64 s[50:51], s[60:61], s[62:63]
    s_and_b64 s[50:51], s[50:51], s[64:65]
    s_and_b64 s[50:51], s[50:51], s[66:67]
    s_and_b32 s50, s50, s51
    s_bitcmp1_b32 s50, 15
    s_cbranch_scc1 F_km1
    s_load_dwordx8 s[60:67], s[48:49], 0 glc
    s_waitcnt lgkmcnt(0)
    s_branch F_km
F_km1:
    s_sub_u32 s59, 2047, s46

    s_and_b32 s44, s60, 0x7ff
    s_sub_u32 s44, s59, s44
    s_cmp_ge_u32 s44, 64
    s_cbranch_scc1 SD_3
    s_mov_b32 s77, 1
    s_or_b32 s47, s60, 0x4000
    v_mov_b32 v63, s47
    v_cmp_eq_u32 vcc, s44, v1
    s_sub_u32 s44, s44, 16
    s_nop 0
    v_cndmask_b32 v128, v128, v63, vcc
    v_cmp_eq_u32 vcc, s44, v1
    s_sub_u32 s44, s44, 16
    s_nop 0
    v_cndmask_b32 v129, v129, v63, vcc
    v_cmp_eq_u32 vcc, s44, v1
    s_sub_u32 s44, s44, 16
    s_nop 0
    v_cndmask_b32 v130, v130, v63, vcc
    v_cmp_eq_u32 vcc, s44, v1
    s_sub_u32 s44, s44, 16
    s_nop 0
    v_cndmask_b32 v131, v131, v63, vcc
SD_3:
    s_and_b32 s44, s61, 0x7ff
    s_sub_u32 s44, s59, s44
    s_cmp_ge_u32 s44, 64
    s_cbranch_scc1 SD_4
    s_mov_b32 s77, 1
    s_or_b32 s47, s61, 0x4800
    v_mov_b32 v63, s47
    v_cmp_eq_u32 vcc, s44, v1
    s_sub_u32 s44, s44, 16
    s_nop 0
    v_cndmask_b32 v128, v128, v63, vcc
    v_cmp_eq_u32 vcc, s44, v1
    s_sub_u32 s44, s44, 16
    s_nop 0
    v_cndmask_b32 v129, v129, v63, vcc
    v_cmp_eq_u32 vcc, s44, v1
    s_sub_u32 s44, s44, 16
    s_nop 0
    v_cndmask_b32 v130, v130, v63, vcc
    v_cmp_eq_u32 vcc, s44, v1
    s_sub_u32 s44, s44, 16
    s_nop 0
    v_cndmask_b32 v131, v131, v63, vcc
SD_4:
    s_and_b32 s44, s62, 0x7ff
    s_sub_u32 s44, s59, s44
    s_cmp_ge_u32 s44, 64
    s_cbranch_scc1 SD_5
    s_mov_b32 s77, 1
    s_or_b32 s47, s62, 0x5000
    v_mov_b32 v63, s47
    v_cmp_eq_u32 vcc, s44, v1
    s_sub_u32 s44, s44, 16
    s_nop 0
    v_cndmask_b32 v128, v128, v63, vcc
    v_cmp_eq_u32 vcc, s44, v1
    s_sub_u32 s44, s44, 16
    s_nop 0
    v_cndmask_b32 v129, v129, v63, vcc
    v_cmp_eq_u32 vcc, s44, v1
    s_sub_u32 s44, s44, 16
    s_nop 0
    v_cndmask_b32 v130, v130, v63, vcc
    v_cmp_eq_u32 vcc, s44, v1
    s_sub_u32 s44, s44, 16
    s_nop 0
    v_cndmask_b32 v131, v131, v63, vcc
SD_5:
    s_and_b32 s44, s63, 0x7ff
    s_sub_u32 s44, s59, s44
    s_cmp_ge_u32 s44, 64
    s_cbranch_scc1 SD_6
    s_mov_b32 s77, 1
    s_or_b32 s47, s63, 0x5800
    v_mov_b32 v63, s47
    v_cmp_eq_u32 vcc, s44, v1
    s_sub_u32 s44, s44, 16
    s_nop 0
    v_cndmask_b32 v128, v128, v63, vcc
    v_cmp_eq_u32 vcc, s44, v1
    s_sub_u32 s44, s44, 16
    s_nop 0
    v_cndmask_b32 v129, v129, v63, vcc
    v_cmp_eq_u32 vcc, s44, v1
    s_sub_u32 s44, s44, 16
    s_nop 0
    v_cndmask_b32 v130, v130, v63, vcc
    v_cmp_eq_u32 vcc, s44, v1
    s_sub_u32 s44, s44, 16
    s_nop 0
    v_cndmask_b32 v131, v131, v63, vcc
SD_6:
    s_and_b32 s44, s64, 0x7ff
    s_sub_u32 s44, s59, s44
    s_cmp_ge_u32 s44, 64
    s_cbranch_scc1 SD_7
    s_mov_b32 s77, 1
    s_or_b32 s47, s64, 0x6000
    v_mov_b32 v63, s47
    v_cmp_eq_u32 vcc, s44, v1
    s_sub_u32 s44, s44, 16
    s_nop 0
    v_cndmask_b32 v128, v128, v63, vcc
    v_cmp_eq_u32 vcc, s44, v1
    s_sub_u32 s44, s44, 16
    s_nop 0
    v_cndmask_b32 v129, v129, v63, vcc
    v_cmp_eq_u32 vcc, s44, v1
    s_sub_u32 s44, s44, 16
    s_nop 0
    v_cndmask_b32 v130, v130, v63, vcc
    v_cmp_eq_u32 vcc, s44, v1
    s_sub_u32 s44, s44, 16
    s_nop 0
    v_cndmask_b32 v131, v131, v63, vcc
SD_7:
    s_and_b32 s44, s65, 0x7ff
    s_sub_u32 s44, s59, s44
    s_cmp_ge_u32 s44, 64
    s_cbranch_scc1 SD_8
    s_mov_b32 s77, 1
    s_or_b32 s47, s65, 0x6800
    v_mov_b32 v63, s47
    v_cmp_eq_u32 vcc, s44, v1
    s_sub_u32 s44, s44, 16
    s_nop 0
    v_cndmask_b32 v128, v128, v63, vcc
    v_cmp_eq_u32 vcc, s44, v1
    s_sub_u32 s44, s44, 16
    s_nop 0
    v_cndmask_b32 v129, v129, v63, vcc
    v_cmp_eq_u32 vcc, s44, v1
    s_sub_u32 s44, s44, 16
    s_nop 0
    v_cndmask_b32 v130, v130, v63, vcc
    v_cmp_eq_u32 vcc, s44, v1
    s_sub_u32 s44, s44, 16
    s_nop 0
    v_cndmask_b32 v131, v131, v63, vcc
SD_8:
    s_and_b32 s44, s66, 0x7ff
    s_sub_u32 s44, s59, s44
    s_cmp_ge_u32 s44, 64
    s_cbranch_scc1 SD_9
    s_mov_b32 s77, 1
    s_or_b32 s47, s66, 0x7000
    v_mov_b32 v63, s47
    v_cmp_eq_u32 vcc, s44, v1
    s_sub_u32 s44, s44, 16
    s_nop 0
    v_cndmask_b32 v128, v128, v63, vcc
    v_cmp_eq_u32 vcc, s44, v1
    s_sub_u32 s44, s44, 16
    s_nop 0
    v_cndmask_b32 v129, v129, v63, vcc
    v_cmp_eq_u32 vcc, s44, v1
    s_sub_u32 s44, s44, 16
    s_nop 0
    v_cndmask_b32 v130, v130, v63, vcc
    v_cmp_eq_u32 vcc, s44, v1
    s_sub_u32 s44, s44, 16
    s_nop 0
    v_cndmask_b32 v131, v131, v63, vcc
SD_9:
    s_and_b32 s44, s67, 0x7ff
    s_sub_u32 s44, s59, s44
    s_cmp_ge_u32 s44, 64
    s_cbranch_scc1 SD_10
    s_mov_b32 s77, 1
    s_or_b32 s47, s67, 0x7800
    v_mov_b32 v63, s47
    v_cmp_eq_u32 vcc, s44, v1
    s_sub_u32 s44, s44, 16
    s_nop 0
    v_cndmask_b32 v128, v128, v63, vcc
    v_cmp_eq_u32 vcc, s44, v1
    s_sub_u32 s44, s44, 16
    s_nop 0
    v_cndmask_b32 v129, v129, v63, vcc
    v_cmp_eq_u32 vcc, s44, v1
    s_sub_u32 s44, s44, 16
    s_nop 0
    v_cndmask_b32 v130, v130, v63, vcc
    v_cmp_eq_u32_e64 vcc, s44, v1
    s_sub_u32 s44, s44, 16
    s_nop 0
    v_cndmask_b32 v131, v131, v63, vcc
SD_10:
    s_cmp_lg_u32 s77, 0
    s_cbranch_scc1 F_ys
F_ys1:
    s_setprio 2
    s_waitcnt lgkmcnt(0)
    s_barrier
    ds_read_b64_tr_b16 v[40:41], v12 offset:24576
    ds_read_b64_tr_b16 v[42:43], v12 offset:28672
    ds_read_b128 v[24:27], v4 offset:0
    ds_read_b64_tr_b16 v[64:65], v12 offset:32768
    ds_read_b64_tr_b16 v[66:67], v12 offset:36864
    ds_read_b128 v[48:51], v4 offset:1024
    ds_read_b64_tr_b16 v[44:45], v13 offset:24576
    ds_read_b64_tr_b16 v[46:47], v13 offset:28672
    ds_read_b64_tr_b16 v[68:69], v13 offset:32768
    ds_read_b64_tr_b16 v[70:71], v13 offset:36864
    ds_read_b128 v[28:31], v4 offset:2048
    ds_read_b128 v[52:55], v4 offset:3072
    ds_read_b128 v[32:35], v4 offset:4096
    ds_read_b128 v[56:59], v4 offset:5120
    ds_read_b128 v[36:39], v4 offset:6144
    s_waitcnt lgkmcnt(8)
    ds_read_b128 v[60:63], v4 offset:7168
    s_waitcnt lgkmcnt(13)
    v_mfma_f32_16x16x32_bf16 v[132:135], v[40:43], v[24:27], v[132:135]
    s_waitcnt lgkmcnt(10)
    v_mfma_f32_16x16x32_bf16 v[132:135], v[64:67], v[48:51], v[132:135]
    s_waitcnt lgkmcnt(8)
    v_mfma_f32_16x16x32_bf16 v[136:139], v[44:47], v[24:27], v[136:139]
    s_waitcnt lgkmcnt(6)
    v_mfma_f32_16x16x32_bf16 v[136:139], v[68:71], v[48:51], v[136:139]
    s_waitcnt lgkmcnt(5)
    v_mfma_f32_16x16x32_bf16 v[140:143], v[40:43], v[28:31], v[140:143]
    s_waitcnt lgkmcnt(4)
    v_mfma_f32_16x16x32_bf16 v[140:143], v[64:67], v[52:55], v[140:143]
    s_waitcnt lgkmcnt(0)
    s_barrier
    ds_read_b64_tr_b16 v[88:89], v10 offset:0
    ds_read_b64_tr_b16 v[90:91], v10 offset:4096
    v_mfma_f32_16x16x32_bf16 v[144:147], v[44:47], v[28:31], v[144:147]
    ds_read_b128 v[72:75], v5 offset:0
    ds_read_b64_tr_b16 v[112:113], v10 offset:8192
    v_mfma_f32_16x16x32_bf16 v[144:147], v[68:71], v[52:55], v[144:147]
    ds_read_b64_tr_b16 v[114:115], v10 offset:12288
    ds_read_b128 v[96:99], v5 offset:1024
    v_mfma_f32_16x16x32_bf16 v[148:151], v[40:43], v[32:35], v[148:151]
    ds_read_b64_tr_b16 v[92:93], v11 offset:0
    ds_read_b64_tr_b16 v[94:95], v11 offset:4096
    v_mfma_f32_16x16x32_bf16 v[148:151], v[64:67], v[56:59], v[148:151]
    ds_read_b64_tr_b16 v[116:117], v11 offset:8192
    ds_read_b64_tr_b16 v[118:119], v11 offset:12288
    v_mfma_f32_16x16x32_bf16 v[152:155], v[44:47], v[32:35], v[152:155]
    ds_read_b128 v[76:79], v5 offset:2048
    ds_read_b128 v[100:103], v5 offset:3072
    v_mfma_f32_16x16x32_bf16 v[152:155], v[68:71], v[56:59], v[152:155]
    ds_read_b128 v[80:83], v5 offset:4096
    ds_read_b128 v[104:107], v5 offset:5120
    v_mfma_f32_16x16x32_bf16 v[156:159], v[40:43], v[36:39], v[156:159]
    s_waitcnt lgkmcnt(8)
    ds_read_b128 v[84:87], v5 offset:6144
    ds_read_b128 v[108:111], v5 offset:7168
    v_mfma_f32_16x16x32_bf16 v[156:159], v[64:67], v[60:63], v[156:159]
    v_mfma_f32_16x16x32_bf16 v[160:163], v[44:47], v[36:39], v[160:163]
    v_mfma_f32_16x16x32_bf16 v[160:163], v[68:71], v[60:63], v[160:163]
    s_waitcnt lgkmcnt(4)
    v_mfma_f32_16x16x32_bf16 v[132:135], v[88:91], v[72:75], v[132:135]
    v_mfma_f32_16x16x32_bf16 v[132:135], v[112:115], v[96:99], v[132:135]
    s_waitcnt lgkmcnt(0)
    s_barrier
    ds_read_b64_tr_b16 v[40:41], v8 offset:0
    ds_read_b64_tr_b16 v[42:43], v8 offset:4096
    v_mfma_f32_16x16x32_bf16 v[136:139], v[92:95], v[72:75], v[136:139]
    ds_read_b128 v[24:27], v5 offset:40960
    ds_read_b64_tr_b16 v[64:65], v8 offset:8192
    v_mfma_f32_16x16x32_bf16 v[136:139], v[116:119], v[96:99], v[136:139]
    ds_read_b64_tr_b16 v[66:67], v8 offset:12288
    ds_read_b128 v[48:51], v5 offset:41984
    v_mfma_f32_16x16x32_bf16 v[140:143], v[88:91], v[76:79], v[140:143]
    ds_read_b64_tr_b16 v[44:45], v9 offset:0
    ds_read_b64_tr_b16 v[46:47], v9 offset:4096
    v_mfma_f32_16x16x32_bf16 v[140:143], v[112:115], v[100:103], v[140:143]
    ds_read_b64_tr_b16 v[68:69], v9 offset:8192
    v_mfma_f32_16x16x32_bf16 v[144:147], v[92:95], v[76:79], v[144:147]
    ds_read_b64_tr_b16 v[70:71], v9 offset:12288
    v_mfma_f32_16x16x32_bf16 v[144:147], v[116:119], v[100:103], v[144:147]
    ds_read_b128 v[28:31], v5 offset:43008
    v_mfma_f32_16x16x32_bf16 v[148:151], v[88:91], v[80:83], v[148:151]
    ds_read_b128 v[52:55], v5 offset:44032
    v_mfma_f32_16x16x32_bf16 v[148:151], v[112:115], v[104:107], v[148:151]
    ds_read_b128 v[32:35], v5 offset:45056
    v_mfma_f32_16x16x32_bf16 v[152:155], v[92:95], v[80:83], v[152:155]
    ds_read_b128 v[56:59], v5 offset:46080
    v_mfma_f32_16x16x32_bf16 v[152:155], v[116:119], v[104:107], v[152:155]
    s_waitcnt lgkmcnt(8)
    ds_read_b128 v[36:39], v5 offset:47104
    v_mfma_f32_16x16x32_bf16 v[156:159], v[88:91], v[84:87], v[156:159]
    ds_read_b128 v[60:63], v5 offset:48128
    v_mfma_f32_16x16x32_bf16 v[156:159], v[112:115], v[108:111], v[156:159]
    v_mfma_f32_16x16x32_bf16 v[160:163], v[92:95], v[84:87], v[160:163]
    v_mfma_f32_16x16x32_bf16 v[160:163], v[116:119], v[108:111], v[160:163]
    s_waitcnt lgkmcnt(4)
    v_mfma_f32_16x16x32_bf16 v[132:135], v[40:43], v[24:27], v[132:135]
    v_mfma_f32_16x16x32_bf16 v[132:135], v[64:67], v[48:51], v[132:135]
    s_waitcnt lgkmcnt(0)
    s_barrier
    ds_read_b64_tr_b16 v[88:89], v8 offset:40960
    ds_read_b64_tr_b16 v[90:91], v8 offset:45056
    v_mfma_f32_16x16x32_bf16 v[136:139], v[44:47], v[24:27], v[136:139]
    ds_read_b128 v[72:75], v4 offset:40960
    ds_read_b64_tr_b16 v[112:113], v8 offset:49152
    v_mfma_f32_16x16x32_bf16 v[136:139], v[68:71], v[48:51], v[136:139]
    ds_read_b64_tr_b16 v[114:115], v8 offset:53248
    ds_read_b128 v[96:99], v4 offset:41984
    v_mfma_f32_16x16x32_bf16 v[140:143], v[40:43], v[28:31], v[140:143]
    ds_read_b64_tr_b16 v[92:93], v9 offset:40960
    ds_read_b64_tr_b16 v[94:95], v9 offset:45056
    v_mfma_f32_16x16x32_bf16 v[140:143], v[64:67], v[52:55], v[140:143]
    ds_read_b64_tr_b16 v[116:117], v9 offset:49152
    v_mfma_f32_16x16x32_bf16 v[144:147], v[44:47], v[28:31], v[144:147]
    ds_read_b64_tr_b16 v[118:119], v9 offset:53248
    v_mfma_f32_16x16x32_bf16 v[144:147], v[68:71], v[52:55], v[144:147]
    ds_read_b128 v[76:79], v4 offset:43008
    v_mfma_f32_16x16x32_bf16 v[148:151], v[40:43], v[32:35], v[148:151]
    ds_read_b128 v[100:103], v4 offset:44032
    v_mfma_f32_16x16x32_bf16 v[148:151], v[64:67], v[56:59], v[148:151]
    ds_read_b128 v[80:83], v4 offset:45056
    v_mfma_f32_16x16x32_bf16 v[152:155], v[44:47], v[32:35], v[152:155]
    ds_read_b128 v[104:107], v4 offset:46080
    v_mfma_f32_16x16x32_bf16 v[152:155], v[68:71], v[56:59], v[152:155]
    s_waitcnt lgkmcnt(8)
    ds_read_b128 v[84:87], v4 offset:47104
    v_mfma_f32_16x16x32_bf16 v[156:159], v[40:43], v[36:39], v[156:159]
    ds_read_b128 v[108:111], v4 offset:48128
    v_mfma_f32_16x16x32_bf16 v[156:159], v[64:67], v[60:63], v[156:159]
    v_mfma_f32_16x16x32_bf16 v[160:163], v[44:47], v[36:39], v[160:163]
    v_mfma_f32_16x16x32_bf16 v[160:163], v[68:71], v[60:63], v[160:163]
    s_waitcnt lgkmcnt(4)
    v_mfma_f32_16x16x32_bf16 v[132:135], v[88:91], v[72:75], v[132:135]
    v_mfma_f32_16x16x32_bf16 v[132:135], v[112:115], v[96:99], v[132:135]
    s_waitcnt lgkmcnt(0)
    s_barrier
    ds_read_b64_tr_b16 v[40:41], v10 offset:16384
    ds_read_b64_tr_b16 v[42:43], v10 offset:20480
    v_mfma_f32_16x16x32_bf16 v[136:139], v[92:95], v[72:75], v[136:139]
    ds_read_b128 v[24:27], v4 offset:0
    ds_read_b64_tr_b16 v[64:65], v10 offset:24576
    v_mfma_f32_16x16x32_bf16 v[136:139], v[116:119], v[96:99], v[136:139]
    ds_read_b64_tr_b16 v[66:67], v10 offset:28672
    ds_read_b128 v[48:51], v4 offset:1024
    v_mfma_f32_16x16x32_bf16 v[140:143], v[88:91], v[76:79], v[140:143]
    ds_read_b64_tr_b16 v[44:45], v11 offset:16384
    ds_read_b64_tr_b16 v[46:47], v11 offset:20480
    v_mfma_f32_16x16x32_bf16 v[140:143], v[112:115], v[100:103], v[140:143]
    ds_read_b64_tr_b16 v[68:69], v11 offset:24576
    v_mfma_f32_16x16x32_bf16 v[144:147], v[92:95], v[76:79], v[144:147]
    ds_read_b64_tr_b16 v[70:71], v11 offset:28672
    v_mfma_f32_16x16x32_bf16 v[144:147], v[116:119], v[100:103], v[144:147]
    ds_read_b128 v[28:31], v4 offset:2048
    v_mfma_f32_16x16x32_bf16 v[148:151], v[88:91], v[80:83], v[148:151]
    ds_read_b128 v[52:55], v4 offset:3072
    v_mfma_f32_16x16x32_bf16 v[148:151], v[112:115], v[104:107], v[148:151]
    ds_read_b128 v[32:35], v4 offset:4096
    v_mfma_f32_16x16x32_bf16 v[152:155], v[92:95], v[80:83], v[152:155]
    ds_read_b128 v[56:59], v4 offset:5120
    v_mfma_f32_16x16x32_bf16 v[152:155], v[116:119], v[104:107], v[152:155]
    s_waitcnt lgkmcnt(8)
    ds_read_b128 v[36:39], v4 offset:6144
    v_mfma_f32_16x16x32_bf16 v[156:159], v[88:91], v[84:87], v[156:159]
    ds_read_b128 v[60:63], v4 offset:7168
    v_mfma_f32_16x16x32_bf16 v[156:159], v[112:115], v[108:111], v[156:159]
    v_mfma_f32_16x16x32_bf16 v[160:163], v[92:95], v[84:87], v[160:163]
    v_mfma_f32_16x16x32_bf16 v[160:163], v[116:119], v[108:111], v[160:163]
    s_waitcnt lgkmcnt(4)
    v_mfma_f32_16x16x32_bf16 v[132:135], v[40:43], v[24:27], v[132:135]
    v_mfma_f32_16x16x32_bf16 v[132:135], v[64:67], v[48:51], v[132:135]
    s_waitcnt lgkmcnt(0)
    s_barrier
    ds_read_b64_tr_b16 v[88:89], v12 offset:0
    ds_read_b64_tr_b16 v[90:91], v12 offset:4096
    v_mfma_f32_16x16x32_bf16 v[136:139], v[44:47], v[24:27], v[136:139]
    ds_read_b128 v[72:75], v5 offset:0
    ds_read_b64_tr_b16 v[112:113], v12 offset:8192
    v_mfma_f32_16x16x32_bf16 v[136:139], v[68:71], v[48:51], v[136:139]
    ds_read_b64_tr_b16 v[114:115], v12 offset:12288
    ds_read_b128 v[96:99], v5 offset:1024
    v_mfma_f32_16x16x32_bf16 v[140:143], v[40:43], v[28:31], v[140:143]
    ds_read_b64_tr_b16 v[92:93], v13 offset:0
    ds_read_b64_tr_b16 v[94:95], v13 offset:4096
    v_mfma_f32_16x16x32_bf16 v[140:143], v[64:67], v[52:55], v[140:143]
    ds_read_b64_tr_b16 v[116:117], v13 offset:8192
    v_mfma_f32_16x16x32_bf16 v[144:147], v[44:47], v[28:31], v[144:147]
    ds_read_b64_tr_b16 v[118:119], v13 offset:12288
    v_mfma_f32_16x16x32_bf16 v[144:147], v[68:71], v[52:55], v[144:147]
    ds_read_b128 v[76:79], v5 offset:2048
    v_mfma_f32_16x16x32_bf16 v[148:151], v[40:43], v[32:35], v[148:151]
    ds_read_b128 v[100:103], v5 offset:3072
    v_mfma_f32_16x16x32_bf16 v[148:151], v[64:67], v[56:59], v[148:151]
    ds_read_b128 v[80:83], v5 offset:4096
    v_mfma_f32_16x16x32_bf16 v[152:155], v[44:47], v[32:35], v[152:155]
    ds_read_b128 v[104:107], v5 offset:5120
    v_mfma_f32_16x16x32_bf16 v[152:155], v[68:71], v[56:59], v[152:155]
    s_waitcnt lgkmcnt(8)
    ds_read_b128 v[84:87], v5 offset:6144
    v_mfma_f32_16x16x32_bf16 v[156:159], v[40:43], v[36:39], v[156:159]
    ds_read_b128 v[108:111], v5 offset:7168
    v_mfma_f32_16x16x32_bf16 v[156:159], v[64:67], v[60:63], v[156:159]
    v_mfma_f32_16x16x32_bf16 v[160:163], v[44:47], v[36:39], v[160:163]
    v_mfma_f32_16x16x32_bf16 v[160:163], v[68:71], v[60:63], v[160:163]
    s_waitcnt lgkmcnt(4)
    v_mfma_f32_16x16x32_bf16 v[132:135], v[88:91], v[72:75], v[132:135]
    v_mfma_f32_16x16x32_bf16 v[132:135], v[112:115], v[96:99], v[132:135]
    s_waitcnt lgkmcnt(0)
    s_barrier
    ds_read_b64_tr_b16 v[40:41], v10 offset:40960
    ds_read_b64_tr_b16 v[42:43], v10 offset:45056
    v_mfma_f32_16x16x32_bf16 v[136:139], v[92:95], v[72:75], v[136:139]
    ds_read_b128 v[24:27], v5 offset:40960
    ds_read_b64_tr_b16 v[64:65], v10 offset:49152
    v_mfma_f32_16x16x32_bf16 v[136:139], v[116:119], v[96:99], v[136:139]
    ds_read_b64_tr_b16 v[66:67], v10 offset:53248
    ds_read_b128 v[48:51], v5 offset:41984
    v_mfma_f32_16x16x32_bf16 v[140:143], v[88:91], v[76:79], v[140:143]
    ds_read_b64_tr_b16 v[44:45], v11 offset:40960
    ds_read_b64_tr_b16 v[46:47], v11 offset:45056
    v_mfma_f32_16x16x32_bf16 v[140:143], v[112:115], v[100:103], v[140:143]
    ds_read_b64_tr_b16 v[68:69], v11 offset:49152
    v_mfma_f32_16x16x32_bf16 v[144:147], v[92:95], v[76:79], v[144:147]
    ds_read_b64_tr_b16 v[70:71], v11 offset:53248
    v_mfma_f32_16x16x32_bf16 v[144:147], v[116:119], v[100:103], v[144:147]
    ds_read_b128 v[28:31], v5 offset:43008
    v_mfma_f32_16x16x32_bf16 v[148:151], v[88:91], v[80:83], v[148:151]
    ds_read_b128 v[52:55], v5 offset:44032
    v_mfma_f32_16x16x32_bf16 v[148:151], v[112:115], v[104:107], v[148:151]
    ds_read_b128 v[32:35], v5 offset:45056
    v_mfma_f32_16x16x32_bf16 v[152:155], v[92:95], v[80:83], v[152:155]
    ds_read_b128 v[56:59], v5 offset:46080
    v_mfma_f32_16x16x32_bf16 v[152:155], v[116:119], v[104:107], v[152:155]
    s_waitcnt lgkmcnt(8)
    ds_read_b128 v[36:39], v5 offset:47104
    v_mfma_f32_16x16x32_bf16 v[156:159], v[88:91], v[84:87], v[156:159]
    ds_read_b128 v[60:63], v5 offset:48128
    v_mfma_f32_16x16x32_bf16 v[156:159], v[112:115], v[108:111], v[156:159]
    v_mfma_f32_16x16x32_bf16 v[160:163], v[92:95], v[84:87], v[160:163]
    v_mfma_f32_16x16x32_bf16 v[160:163], v[116:119], v[108:111], v[160:163]
    s_waitcnt lgkmcnt(4)
    v_mfma_f32_16x16x32_bf16 v[132:135], v[40:43], v[24:27], v[132:135]
    v_mfma_f32_16x16x32_bf16 v[132:135], v[64:67], v[48:51], v[132:135]
    s_waitcnt lgkmcnt(0)
    s_barrier
    ds_read_b64_tr_b16 v[88:89], v12 offset:24576
    ds_read_b64_tr_b16 v[90:91], v12 offset:28672
    v_mfma_f32_16x16x32_bf16 v[136:139], v[44:47], v[24:27], v[136:139]
    ds_read_b128 v[72:75], v4 offset:40960
    ds_read_b64_tr_b16 v[112:113], v12 offset:32768
    v_mfma_f32_16x16x32_bf16 v[136:139], v[68:71], v[48:51], v[136:139]
    ds_read_b64_tr_b16 v[114:115], v12 offset:36864
    ds_read_b128 v[96:99], v4 offset:41984
    v_mfma_f32_16x16x32_bf16 v[140:143], v[40:43], v[28:31], v[140:143]
    ds_read_b64_tr_b16 v[92:93], v13 offset:24576
    ds_read_b64_tr_b16 v[94:95], v13 offset:28672
    v_mfma_f32_16x16x32_bf16 v[140:143], v[64:67], v[52:55], v[140:143]
    ds_read_b64_tr_b16 v[116:117], v13 offset:32768
    v_mfma_f32_16x16x32_bf16 v[144:147], v[44:47], v[28:31], v[144:147]
    ds_read_b64_tr_b16 v[118:119], v13 offset:36864
    v_mfma_f32_16x16x32_bf16 v[144:147], v[68:71], v[52:55], v[144:147]
    ds_read_b128 v[76:79], v4 offset:43008
    v_mfma_f32_16x16x32_bf16 v[148:151], v[40:43], v[32:35], v[148:151]
    ds_read_b128 v[100:103], v4 offset:44032
    v_mfma_f32_16x16x32_bf16 v[148:151], v[64:67], v[56:59], v[148:151]
    ds_read_b128 v[80:83], v4 offset:45056
    v_mfma_f32_16x16x32_bf16 v[152:155], v[44:47], v[32:35], v[152:155]
    ds_read_b128 v[104:107], v4 offset:46080
    v_mfma_f32_16x16x32_bf16 v[152:155], v[68:71], v[56:59], v[152:155]
    s_waitcnt lgkmcnt(8)
    ds_read_b128 v[84:87], v4 offset:47104
    v_mfma_f32_16x16x32_bf16 v[156:159], v[40:43], v[36:39], v[156:159]
    ds_read_b128 v[108:111], v4 offset:48128
    v_mfma_f32_16x16x32_bf16 v[156:159], v[64:67], v[60:63], v[156:159]
    v_mfma_f32_16x16x32_bf16 v[160:163], v[44:47], v[36:39], v[160:163]
    v_mfma_f32_16x16x32_bf16 v[160:163], v[68:71], v[60:63], v[160:163]
    s_waitcnt lgkmcnt(4)
    v_mfma_f32_16x16x32_bf16 v[132:135], v[88:91], v[72:75], v[132:135]
    v_mfma_f32_16x16x32_bf16 v[132:135], v[112:115], v[96:99], v[132:135]
    s_waitcnt lgkmcnt(0)
    s_barrier
    ds_read_b64_tr_b16 v[40:41], v10 offset:0
    ds_read_b64_tr_b16 v[42:43], v10 offset:4096
    v_mfma_f32_16x16x32_bf16 v[136:139], v[92:95], v[72:75], v[136:139]
    ds_read_b128 v[24:27], v4 offset:0
    ds_read_b64_tr_b16 v[64:65], v10 offset:8192
    v_mfma_f32_16x16x32_bf16 v[136:139], v[116:119], v[96:99], v[136:139]
    ds_read_b64_tr_b16 v[66:67], v10 offset:12288
    ds_read_b128 v[48:51], v4 offset:1024
    v_mfma_f32_16x16x32_bf16 v[140:143], v[88:91], v[76:79], v[140:143]
    ds_read_b64_tr_b16 v[44:45], v11 offset:0
    ds_read_b64_tr_b16 v[46:47], v11 offset:4096
    v_mfma_f32_16x16x32_bf16 v[140:143], v[112:115], v[100:103], v[140:143]
    ds_read_b64_tr_b16 v[68:69], v11 offset:8192
    v_mfma_f32_16x16x32_bf16 v[144:147], v[92:95], v[76:79], v[144:147]
    ds_read_b64_tr_b16 v[70:71], v11 offset:12288
    v_mfma_f32_16x16x32_bf16 v[144:147], v[116:119], v[100:103], v[144:147]
    ds_read_b128 v[28:31], v4 offset:2048
    v_mfma_f32_16x16x32_bf16 v[148:151], v[88:91], v[80:83], v[148:151]
    ds_read_b128 v[52:55], v4 offset:3072
    v_mfma_f32_16x16x32_bf16 v[148:151], v[112:115], v[104:107], v[148:151]
    ds_read_b128 v[32:35], v4 offset:4096
    v_mfma_f32_16x16x32_bf16 v[152:155], v[92:95], v[80:83], v[152:155]
    ds_read_b128 v[56:59], v4 offset:5120
    v_mfma_f32_16x16x32_bf16 v[152:155], v[116:119], v[104:107], v[152:155]
    s_waitcnt lgkmcnt(8)
    ds_read_b128 v[36:39], v4 offset:6144
    v_mfma_f32_16x16x32_bf16 v[156:159], v[88:91], v[84:87], v[156:159]
    ds_read_b128 v[60:63], v4 offset:7168
    v_mfma_f32_16x16x32_bf16 v[156:159], v[112:115], v[108:111], v[156:159]
    v_mfma_f32_16x16x32_bf16 v[160:163], v[92:95], v[84:87], v[160:163]
    v_mfma_f32_16x16x32_bf16 v[160:163], v[116:119], v[108:111], v[160:163]
    s_waitcnt lgkmcnt(4)
    v_mfma_f32_16x16x32_bf16 v[132:135], v[40:43], v[24:27], v[132:135]
    v_mfma_f32_16x16x32_bf16 v[132:135], v[64:67], v[48:51], v[132:135]
    s_waitcnt lgkmcnt(0)
    s_barrier
    ds_read_b64_tr_b16 v[88:89], v8 offset:0
    ds_read_b64_tr_b16 v[90:91], v8 offset:4096
    v_mfma_f32_16x16x32_bf16 v[136:139], v[44:47], v[24:27], v[136:139]
    ds_read_b128 v[72:75], v5 offset:0
    ds_read_b64_tr_b16 v[112:113], v8 offset:8192
    v_mfma_f32_16x16x32_bf16 v[136:139], v[68:71], v[48:51], v[136:139]
    ds_read_b64_tr_b16 v[114:115], v8 offset:12288
    ds_read_b128 v[96:99], v5 offset:1024
    v_mfma_f32_16x16x32_bf16 v[140:143], v[40:43], v[28:31], v[140:143]
    ds_read_b64_tr_b16 v[92:93], v9 offset:0
    ds_read_b64_tr_b16 v[94:95], v9 offset:4096
    v_mfma_f32_16x16x32_bf16 v[140:143], v[64:67], v[52:55], v[140:143]
    ds_read_b64_tr_b16 v[116:117], v9 offset:8192
    v_mfma_f32_16x16x32_bf16 v[144:147], v[44:47], v[28:31], v[144:147]
    ds_read_b64_tr_b16 v[118:119], v9 offset:12288
    v_mfma_f32_16x16x32_bf16 v[144:147], v[68:71], v[52:55], v[144:147]
    ds_read_b128 v[76:79], v5 offset:2048
    v_mfma_f32_16x16x32_bf16 v[148:151], v[40:43], v[32:35], v[148:151]
    ds_read_b128 v[100:103], v5 offset:3072
    v_mfma_f32_16x16x32_bf16 v[148:151], v[64:67], v[56:59], v[148:151]
    ds_read_b128 v[80:83], v5 offset:4096
    v_mfma_f32_16x16x32_bf16 v[152:155], v[44:47], v[32:35], v[152:155]
    ds_read_b128 v[104:107], v5 offset:5120
    v_mfma_f32_16x16x32_bf16 v[152:155], v[68:71], v[56:59], v[152:155]
    s_waitcnt lgkmcnt(8)
    ds_read_b128 v[84:87], v5 offset:6144
    v_mfma_f32_16x16x32_bf16 v[156:159], v[40:43], v[36:39], v[156:159]
    ds_read_b128 v[108:111], v5 offset:7168
    v_mfma_f32_16x16x32_bf16 v[156:159], v[64:67], v[60:63], v[156:159]
    v_mfma_f32_16x16x32_bf16 v[160:163], v[44:47], v[36:39], v[160:163]
    v_mfma_f32_16x16x32_bf16 v[160:163], v[68:71], v[60:63], v[160:163]
    s_waitcnt lgkmcnt(4)
    v_mfma_f32_16x16x32_bf16 v[132:135], v[88:91], v[72:75], v[132:135]
    v_mfma_f32_16x16x32_bf16 v[132:135], v[112:115], v[96:99], v[132:135]
    s_waitcnt lgkmcnt(0)
    s_barrier
    ds_read_b64_tr_b16 v[40:41], v8 offset:40960
    ds_read_b64_tr_b16 v[42:43], v8 offset:45056
    v_mfma_f32_16x16x32_bf16 v[136:139], v[92:95], v[72:75], v[136:139]
    ds_read_b128 v[24:27], v5 offset:40960
    ds_read_b64_tr_b16 v[64:65], v8 offset:49152
    v_mfma_f32_16x16x32_bf16 v[136:139], v[116:119], v[96:99], v[136:139]
    ds_read_b64_tr_b16 v[66:67], v8 offset:53248
    ds_read_b128 v[48:51], v5 offset:41984
    v_mfma_f32_16x16x32_bf16 v[140:143], v[88:91], v[76:79], v[140:143]
    ds_read_b64_tr_b16 v[44:45], v9 offset:40960
    ds_read_b64_tr_b16 v[46:47], v9 offset:45056
    v_mfma_f32_16x16x32_bf16 v[140:143], v[112:115], v[100:103], v[140:143]
    ds_read_b64_tr_b16 v[68:69], v9 offset:49152
    v_mfma_f32_16x16x32_bf16 v[144:147], v[92:95], v[76:79], v[144:147]
    ds_read_b64_tr_b16 v[70:71], v9 offset:53248
    v_mfma_f32_16x16x32_bf16 v[144:147], v[116:119], v[100:103], v[144:147]
    ds_read_b128 v[28:31], v5 offset:43008
    v_mfma_f32_16x16x32_bf16 v[148:151], v[88:91], v[80:83], v[148:151]
    ds_read_b128 v[52:55], v5 offset:44032
    v_mfma_f32_16x16x32_bf16 v[148:151], v[112:115], v[104:107], v[148:151]
    ds_read_b128 v[32:35], v5 offset:45056
    v_mfma_f32_16x16x32_bf16 v[152:155], v[92:95], v[80:83], v[152:155]
    ds_read_b128 v[56:59], v5 offset:46080
    v_mfma_f32_16x16x32_bf16 v[152:155], v[116:119], v[104:107], v[152:155]
    s_waitcnt lgkmcnt(8)
    ds_read_b128 v[36:39], v5 offset:47104
    v_mfma_f32_16x16x32_bf16 v[156:159], v[88:91], v[84:87], v[156:159]
    ds_read_b128 v[60:63], v5 offset:48128
    v_mfma_f32_16x16x32_bf16 v[156:159], v[112:115], v[108:111], v[156:159]
    v_mfma_f32_16x16x32_bf16 v[160:163], v[92:95], v[84:87], v[160:163]
    v_mfma_f32_16x16x32_bf16 v[160:163], v[116:119], v[108:111], v[160:163]
    s_waitcnt lgkmcnt(4)
    v_mfma_f32_16x16x32_bf16 v[132:135], v[40:43], v[24:27], v[132:135]
    v_mfma_f32_16x16x32_bf16 v[132:135], v[64:67], v[48:51], v[132:135]
    s_waitcnt lgkmcnt(0)
    s_barrier
    ds_read_b64_tr_b16 v[88:89], v10 offset:16384
    ds_read_b64_tr_b16 v[90:91], v10 offset:20480
    v_mfma_f32_16x16x32_bf16 v[136:139], v[44:47], v[24:27], v[136:139]
    ds_read_b128 v[72:75], v4 offset:40960
    ds_read_b64_tr_b16 v[112:113], v10 offset:24576
    v_mfma_f32_16x16x32_bf16 v[136:139], v[68:71], v[48:51], v[136:139]
    ds_read_b64_tr_b16 v[114:115], v10 offset:28672
    ds_read_b128 v[96:99], v4 offset:41984
    v_mfma_f32_16x16x32_bf16 v[140:143], v[40:43], v[28:31], v[140:143]
    ds_read_b64_tr_b16 v[92:93], v11 offset:16384
    ds_read_b64_tr_b16 v[94:95], v11 offset:20480
    v_mfma_f32_16x16x32_bf16 v[140:143], v[64:67], v[52:55], v[140:143]
    ds_read_b64_tr_b16 v[116:117], v11 offset:24576
    v_mfma_f32_16x16x32_bf16 v[144:147], v[44:47], v[28:31], v[144:147]
    ds_read_b64_tr_b16 v[118:119], v11 offset:28672
    v_mfma_f32_16x16x32_bf16 v[144:147], v[68:71], v[52:55], v[144:147]
    ds_read_b128 v[76:79], v4 offset:43008
    v_mfma_f32_16x16x32_bf16 v[148:151], v[40:43], v[32:35], v[148:151]
    ds_read_b128 v[100:103], v4 offset:44032
    v_mfma_f32_16x16x32_bf16 v[148:151], v[64:67], v[56:59], v[148:151]
    ds_read_b128 v[80:83], v4 offset:45056
    v_mfma_f32_16x16x32_bf16 v[152:155], v[44:47], v[32:35], v[152:155]
    ds_read_b128 v[104:107], v4 offset:46080
    v_mfma_f32_16x16x32_bf16 v[152:155], v[68:71], v[56:59], v[152:155]
    s_waitcnt lgkmcnt(8)
    ds_read_b128 v[84:87], v4 offset:47104
    v_mfma_f32_16x16x32_bf16 v[156:159], v[40:43], v[36:39], v[156:159]
    ds_read_b128 v[108:111], v4 offset:48128
    v_mfma_f32_16x16x32_bf16 v[156:159], v[64:67], v[60:63], v[156:159]
    v_mfma_f32_16x16x32_bf16 v[160:163], v[44:47], v[36:39], v[160:163]
    v_mfma_f32_16x16x32_bf16 v[160:163], v[68:71], v[60:63], v[160:163]
    s_waitcnt lgkmcnt(4)
    v_mfma_f32_16x16x32_bf16 v[132:135], v[88:91], v[72:75], v[132:135]
    v_mfma_f32_16x16x32_bf16 v[132:135], v[112:115], v[96:99], v[132:135]
    s_waitcnt lgkmcnt(0)
    s_barrier
    ds_read_b64_tr_b16 v[40:41], v12 offset:0
    ds_read_b64_tr_b16 v[42:43], v12 offset:4096
    v_mfma_f32_16x16x32_bf16 v[136:139], v[92:95], v[72:75], v[136:139]
    ds_read_b128 v[24:27], v4 offset:0
    ds_read_b64_tr_b16 v[64:65], v12 offset:8192
    v_mfma_f32_16x16x32_bf16 v[136:139], v[116:119], v[96:99], v[136:139]
    ds_read_b64_tr_b16 v[66:67], v12 offset:12288
    ds_read_b128 v[48:51], v4 offset:1024
    v_mfma_f32_16x16x32_bf16 v[140:143], v[88:91], v[76:79], v[140:143]
    ds_read_b64_tr_b16 v[44:45], v13 offset:0
    ds_read_b64_tr_b16 v[46:47], v13 offset:4096
    v_mfma_f32_16x16x32_bf16 v[140:143], v[112:115], v[100:103], v[140:143]
    ds_read_b64_tr_b16 v[68:69], v13 offset:8192
    v_mfma_f32_16x16x32_bf16 v[144:147], v[92:95], v[76:79], v[144:147]
    ds_read_b64_tr_b16 v[70:71], v13 offset:12288
    v_mfma_f32_16x16x32_bf16 v[144:147], v[116:119], v[100:103], v[144:147]
    ds_read_b128 v[28:31], v4 offset:2048
    v_mfma_f32_16x16x32_bf16 v[148:151], v[88:91], v[80:83], v[148:151]
    ds_read_b128 v[52:55], v4 offset:3072
    v_mfma_f32_16x16x32_bf16 v[148:151], v[112:115], v[104:107], v[148:151]
    ds_read_b128 v[32:35], v4 offset:4096
    v_mfma_f32_16x16x32_bf16 v[152:155], v[92:95], v[80:83], v[152:155]
    ds_read_b128 v[56:59], v4 offset:5120
    v_mfma_f32_16x16x32_bf16 v[152:155], v[116:119], v[104:107], v[152:155]
    s_waitcnt lgkmcnt(8)
    ds_read_b128 v[36:39], v4 offset:6144
    v_mfma_f32_16x16x32_bf16 v[156:159], v[88:91], v[84:87], v[156:159]
    ds_read_b128 v[60:63], v4 offset:7168
    v_mfma_f32_16x16x32_bf16 v[156:159], v[112:115], v[108:111], v[156:159]
    v_mfma_f32_16x16x32_bf16 v[160:163], v[92:95], v[84:87], v[160:163]
    v_mfma_f32_16x16x32_bf16 v[160:163], v[116:119], v[108:111], v[160:163]
    s_waitcnt lgkmcnt(4)
    v_mfma_f32_16x16x32_bf16 v[132:135], v[40:43], v[24:27], v[132:135]
    v_mfma_f32_16x16x32_bf16 v[132:135], v[64:67], v[48:51], v[132:135]
    s_waitcnt lgkmcnt(0)
    s_barrier
    ds_read_b64_tr_b16 v[88:89], v10 offset:40960
    ds_read_b64_tr_b16 v[90:91], v10 offset:45056
    v_mfma_f32_16x16x32_bf16 v[136:139], v[44:47], v[24:27], v[136:139]
    ds_read_b128 v[72:75], v5 offset:0
    ds_read_b64_tr_b16 v[112:113], v10 offset:49152
    v_mfma_f32_16x16x32_bf16 v[136:139], v[68:71], v[48:51], v[136:139]
    ds_read_b64_tr_b16 v[114:115], v10 offset:53248
    ds_read_b128 v[96:99], v5 offset:1024
    v_mfma_f32_16x16x32_bf16 v[140:143], v[40:43], v[28:31], v[140:143]
    ds_read_b64_tr_b16 v[92:93], v11 offset:40960
    ds_read_b64_tr_b16 v[94:95], v11 offset:45056
    v_mfma_f32_16x16x32_bf16 v[140:143], v[64:67], v[52:55], v[140:143]
    ds_read_b64_tr_b16 v[116:117], v11 offset:49152
    v_mfma_f32_16x16x32_bf16 v[144:147], v[44:47], v[28:31], v[144:147]
    ds_read_b64_tr_b16 v[118:119], v11 offset:53248
    v_mfma_f32_16x16x32_bf16 v[144:147], v[68:71], v[52:55], v[144:147]
    ds_read_b128 v[76:79], v5 offset:2048
    v_mfma_f32_16x16x32_bf16 v[148:151], v[40:43], v[32:35], v[148:151]
    ds_read_b128 v[100:103], v5 offset:3072
    v_mfma_f32_16x16x32_bf16 v[148:151], v[64:67], v[56:59], v[148:151]
    ds_read_b128 v[80:83], v5 offset:4096
    v_mfma_f32_16x16x32_bf16 v[152:155], v[44:47], v[32:35], v[152:155]
    ds_read_b128 v[104:107], v5 offset:5120
    v_mfma_f32_16x16x32_bf16 v[152:155], v[68:71], v[56:59], v[152:155]
    s_waitcnt lgkmcnt(8)
    ds_read_b128 v[84:87], v5 offset:6144
    v_mfma_f32_16x16x32_bf16 v[156:159], v[40:43], v[36:39], v[156:159]
    ds_read_b128 v[108:111], v5 offset:7168
    v_mfma_f32_16x16x32_bf16 v[156:159], v[64:67], v[60:63], v[156:159]
    v_mfma_f32_16x16x32_bf16 v[160:163], v[44:47], v[36:39], v[160:163]
    v_mfma_f32_16x16x32_bf16 v[160:163], v[68:71], v[60:63], v[160:163]
    s_waitcnt lgkmcnt(4)
    v_mfma_f32_16x16x32_bf16 v[132:135], v[88:91], v[72:75], v[132:135]
    v_mfma_f32_16x16x32_bf16 v[132:135], v[112:115], v[96:99], v[132:135]
    s_waitcnt lgkmcnt(0)
    s_barrier
    ds_read_b64_tr_b16 v[40:41], v12 offset:24576
    ds_read_b64_tr_b16 v[42:43], v12 offset:28672
    v_mfma_f32_16x16x32_bf16 v[136:139], v[92:95], v[72:75], v[136:139]
    ds_read_b128 v[24:27], v5 offset:40960
    ds_read_b64_tr_b16 v[64:65], v12 offset:32768
    v_mfma_f32_16x16x32_bf16 v[136:139], v[116:119], v[96:99], v[136:139]
    ds_read_b64_tr_b16 v[66:67], v12 offset:36864
    ds_read_b128 v[48:51], v5 offset:41984
    v_mfma_f32_16x16x32_bf16 v[140:143], v[88:91], v[76:79], v[140:143]
    ds_read_b64_tr_b16 v[44:45], v13 offset:24576
    ds_read_b64_tr_b16 v[46:47], v13 offset:28672
    v_mfma_f32_16x16x32_bf16 v[140:143], v[112:115], v[100:103], v[140:143]
    ds_read_b64_tr_b16 v[68:69], v13 offset:32768
    v_mfma_f32_16x16x32_bf16 v[144:147], v[92:95], v[76:79], v[144:147]
    ds_read_b64_tr_b16 v[70:71], v13 offset:36864
    v_mfma_f32_16x16x32_bf16 v[144:147], v[116:119], v[100:103], v[144:147]
    ds_read_b128 v[28:31], v5 offset:43008
    v_mfma_f32_16x16x32_bf16 v[148:151], v[88:91], v[80:83], v[148:151]
    ds_read_b128 v[52:55], v5 offset:44032
    v_mfma_f32_16x16x32_bf16 v[148:151], v[112:115], v[104:107], v[148:151]
    ds_read_b128 v[32:35], v5 offset:45056
    v_mfma_f32_16x16x32_bf16 v[152:155], v[92:95], v[80:83], v[152:155]
    ds_read_b128 v[56:59], v5 offset:46080
    v_mfma_f32_16x16x32_bf16 v[152:155], v[116:119], v[104:107], v[152:155]
    s_waitcnt lgkmcnt(8)
    ds_read_b128 v[36:39], v5 offset:47104
    v_mfma_f32_16x16x32_bf16 v[156:159], v[88:91], v[84:87], v[156:159]
    ds_read_b128 v[60:63], v5 offset:48128
    v_mfma_f32_16x16x32_bf16 v[156:159], v[112:115], v[108:111], v[156:159]
    v_mfma_f32_16x16x32_bf16 v[160:163], v[92:95], v[84:87], v[160:163]
    v_mfma_f32_16x16x32_bf16 v[160:163], v[116:119], v[108:111], v[160:163]
    s_waitcnt lgkmcnt(4)
    v_mfma_f32_16x16x32_bf16 v[132:135], v[40:43], v[24:27], v[132:135]
    v_mfma_f32_16x16x32_bf16 v[132:135], v[64:67], v[48:51], v[132:135]
    s_waitcnt lgkmcnt(0)
    s_barrier
    ds_read_b64_tr_b16 v[88:89], v10 offset:0
    ds_read_b64_tr_b16 v[90:91], v10 offset:4096
    v_mfma_f32_16x16x32_bf16 v[136:139], v[44:47], v[24:27], v[136:139]
    ds_read_b128 v[72:75], v4 offset:40960
    ds_read_b64_tr_b16 v[112:113], v10 offset:8192
    v_mfma_f32_16x16x32_bf16 v[136:139], v[68:71], v[48:51], v[136:139]
    ds_read_b64_tr_b16 v[114:115], v10 offset:12288
    ds_read_b128 v[96:99], v4 offset:41984
    v_mfma_f32_16x16x32_bf16 v[140:143], v[40:43], v[28:31], v[140:143]
    ds_read_b64_tr_b16 v[92:93], v11 offset:0
    ds_read_b64_tr_b16 v[94:95], v11 offset:4096
    v_mfma_f32_16x16x32_bf16 v[140:143], v[64:67], v[52:55], v[140:143]
    ds_read_b64_tr_b16 v[116:117], v11 offset:8192
    v_mfma_f32_16x16x32_bf16 v[144:147], v[44:47], v[28:31], v[144:147]
    ds_read_b64_tr_b16 v[118:119], v11 offset:12288
    v_mfma_f32_16x16x32_bf16 v[144:147], v[68:71], v[52:55], v[144:147]
    ds_read_b128 v[76:79], v4 offset:43008
    v_mfma_f32_16x16x32_bf16 v[148:151], v[40:43], v[32:35], v[148:151]
    ds_read_b128 v[100:103], v4 offset:44032
    v_mfma_f32_16x16x32_bf16 v[148:151], v[64:67], v[56:59], v[148:151]
    ds_read_b128 v[80:83], v4 offset:45056
    v_mfma_f32_16x16x32_bf16 v[152:155], v[44:47], v[32:35], v[152:155]
    ds_read_b128 v[104:107], v4 offset:46080
    v_mfma_f32_16x16x32_bf16 v[152:155], v[68:71], v[56:59], v[152:155]
    s_waitcnt lgkmcnt(8)
    ds_read_b128 v[84:87], v4 offset:47104
    v_mfma_f32_16x16x32_bf16 v[156:159], v[40:43], v[36:39], v[156:159]
    ds_read_b128 v[108:111], v4 offset:48128
    v_mfma_f32_16x16x32_bf16 v[156:159], v[64:67], v[60:63], v[156:159]
    v_mfma_f32_16x16x32_bf16 v[160:163], v[44:47], v[36:39], v[160:163]
    v_mfma_f32_16x16x32_bf16 v[160:163], v[68:71], v[60:63], v[160:163]
    s_waitcnt lgkmcnt(0)
    s_cmp_eq_u32 s77, 0
    s_cbranch_scc0 F_y
F_fin:
    v_mfma_f32_16x16x32_bf16 v[132:135], v[88:91], v[72:75], v[132:135]
    v_mfma_f32_16x16x32_bf16 v[132:135], v[112:115], v[96:99], v[132:135]
    v_mfma_f32_16x16x32_bf16 v[136:139], v[92:95], v[72:75], v[136:139]
    v_mfma_f32_16x16x32_bf16 v[136:139], v[116:119], v[96:99], v[136:139]
    v_mfma_f32_16x16x32_bf16 v[140:143], v[88:91], v[76:79], v[140:143]
    v_mfma_f32_16x16x32_bf16 v[140:143], v[112:115], v[100:103], v[140:143]
    s_nop 5
    v_permlane16_swap_b32 v132, v136
    v_permlane16_swap_b32 v133, v137
    v_permlane16_swap_b32 v134, v138
    v_mfma_f32_16x16x32_bf16 v[144:147], v[92:95], v[76:79], v[144:147]
    v_permlane16_swap_b32 v135, v139
    v_cvt_pk_bf16_f32 v56, v132, v133
    v_cvt_pk_bf16_f32 v57, v134, v135
    v_mfma_f32_16x16x32_bf16 v[144:147], v[116:119], v[100:103], v[144:147]
    v_cvt_pk_bf16_f32 v58, v136, v137
    v_cvt_pk_bf16_f32 v59, v138, v139
    s_add_u32 s44, s42, 0
    buffer_store_dwordx4 v[56:59], v167, s[52:55], s44 offen sc1
    v_mfma_f32_16x16x32_bf16 v[148:151], v[88:91], v[80:83], v[148:151]
    v_mfma_f32_16x16x32_bf16 v[148:151], v[112:115], v[104:107], v[148:151]
    s_nop 1
    v_permlane16_swap_b32 v140, v144
    v_permlane16_swap_b32 v141, v145
    v_permlane16_swap_b32 v142, v146
    v_mfma_f32_16x16x32_bf16 v[152:155], v[92:95], v[80:83], v[152:155]
    v_permlane16_swap_b32 v143, v147
    v_cvt_pk_bf16_f32 v60, v140, v141
    v_cvt_pk_bf16_f32 v61, v142, v143
    v_mfma_f32_16x16x32_bf16 v[152:155], v[116:119], v[104:107], v[152:155]
    v_cvt_pk_bf16_f32 v62, v144, v145
    v_cvt_pk_bf16_f32 v63, v146, v147
    s_add_u32 s44, s42, 32768
    buffer_store_dwordx4 v[60:63], v167, s[52:55], s44 offen sc1
    v_mfma_f32_16x16x32_bf16 v[156:159], v[88:91], v[84:87], v[156:159]
    v_mfma_f32_16x16x32_bf16 v[156:159], v[112:115], v[108:111], v[156:159]
    s_nop 1
    v_permlane16_swap_b32 v148, v152
    v_permlane16_swap_b32 v149, v153
    v_permlane16_swap_b32 v150, v154
    v_mfma_f32_16x16x32_bf16 v[160:163], v[92:95], v[84:87], v[160:163]
    v_permlane16_swap_b32 v151, v155
    v_cvt_pk_bf16_f32 v64, v148, v149
    v_cvt_pk_bf16_f32 v65, v150, v151
    v_mfma_f32_16x16x32_bf16 v[160:163], v[116:119], v[108:111], v[160:163]
    v_cvt_pk_bf16_f32 v66, v152, v153
    v_cvt_pk_bf16_f32 v67, v154, v155
    s_add_u32 s44, s42, 65536
    buffer_store_dwordx4 v[64:67], v167, s[52:55], s44 offen sc1
    s_nop 3
    v_permlane16_swap_b32 v156, v160
    v_permlane16_swap_b32 v157, v161
    v_permlane16_swap_b32 v158, v162
    v_permlane16_swap_b32 v159, v163
    v_cvt_pk_bf16_f32 v68, v156, v157
    v_cvt_pk_bf16_f32 v69, v158, v159
    v_cvt_pk_bf16_f32 v70, v160, v161
    v_cvt_pk_bf16_f32 v71, v162, v163
    s_add_u32 s44, s42, 98304
    buffer_store_dwordx4 v[68:71], v167, s[52:55], s44 offen sc1
F_end:
    s_endpgm
F_y:
    s_nop 0
    ds_read_b32 v7, v6
    ds_read_b128 v[24:27], v128 offset:0
    ds_read_b128 v[28:31], v128 offset:64
    ds_read_b128 v[32:35], v129 offset:0
    ds_read_b128 v[36:39], v129 offset:64
    ds_read_b128 v[40:43], v130 offset:0
    ds_read_b128 v[44:47], v130 offset:64
    ds_read_b128 v[48:51], v131 offset:0
    ds_read_b128 v[52:55], v131 offset:64
    s_waitcnt lgkmcnt(8)
    v_cmp_gt_u32 vcc, 9, v7
    s_waitcnt lgkmcnt(0)
    s_cbranch_vccnz F_y
    s_mov_b64 exec, s[60:61]
    v_fmac_f32 v132, v24, v14
    v_fmac_f32 v133, v25, v14
    v_fmac_f32 v134, v26, v14
    v_fmac_f32 v135, v27, v14
    v_fmac_f32 v136, v28, v14
    v_fmac_f32 v137, v29, v14
    v_fmac_f32 v138, v30, v14
    v_fmac_f32 v139, v31, v14
    s_mov_b64 exec, s[62:63]
    v_fmac_f32 v140, v32, v15
    v_fmac_f32 v141, v33, v15
    v_fmac_f32 v142, v34, v15
    v_fmac_f32 v143, v35, v15
    v_fmac_f32 v144, v36, v15
    v_fmac_f32 v145, v37, v15
    v_fmac_f32 v146, v38, v15
    v_fmac_f32 v147, v39, v15
    s_mov_b64 exec, s[64:65]
    v_fmac_f32 v148, v40, v16
    v_fmac_f32 v149, v41, v16
    v_fmac_f32 v150, v42, v16
    v_fmac_f32 v151, v43, v16
    v_fmac_f32 v152, v44, v16
    v_fmac_f32 v153, v45, v16
    v_fmac_f32 v154, v46, v16
    v_fmac_f32 v155, v47, v16
    s_mov_b64 exec, s[66:67]
    v_fmac_f32 v156, v48, v17
    v_fmac_f32 v157, v49, v17
    v_fmac_f32 v158, v50, v17
    v_fmac_f32 v159, v51, v17
    v_fmac_f32 v160, v52, v17
    v_fmac_f32 v161, v53, v17
    v_fmac_f32 v162, v54, v17
    v_fmac_f32 v163, v55, v17
    s_mov_b64 exec, -1
    s_nop 1
    s_branch F_fin
F_ys:
    s_mov_b32 s48, 0xbfb8aa3b
    s_lshl_b32 s44, s3, 7
    s_add_u32 s44, s44, 27648
    v_and_or_b32 v63, v0, 48, s44
    v_mov_b32 v6, 24736

    v_cmp_ne_u32 s[60:61], 0, v128
    v_and_b32 v14, 0xffff0000, v128
    v_ashrrev_i32 v7, 31, v14
    v_not_b32 v7, v7
    v_or_b32 v7, 0x80000000, v7
    v_xor_b32 v14, v14, v7
    v_and_b32 v14, 0xffff0000, v14
    v_mul_f32 v14, s48, v14
    v_exp_f32 v14, v14
    s_nop 0
    v_add_f32 v14, 1.0, v14
    v_rcp_f32 v14, v14
    s_nop 0
    v_cvt_pk_bf16_f32 v14, v14, v14
    v_lshlrev_b32 v14, 16, v14
    v_bfe_u32 v128, v128, 11, 3
    v_lshl_add_u32 v128, v128, 9, v63
    v_cmp_ne_u32 s[62:63], 0, v129
    v_and_b32 v15, 0xffff0000, v129
    v_ashrrev_i32 v7, 31, v15
    v_not_b32 v7, v7
    v_or_b32 v7, 0x80000000, v7
    v_xor_b32 v15, v15, v7
    v_and_b32 v15, 0xffff0000, v15
    v_mul_f32 v15, s48, v15
    v_exp_f32 v15, v15
    s_nop 0
    v_add_f32 v15, 1.0, v15
    v_rcp_f32 v15, v15
    s_nop 0
    v_cvt_pk_bf16_f32 v15, v15, v15
    v_lshlrev_b32 v15, 16, v15
    v_bfe_u32 v129, v129, 11, 3
    v_lshl_add_u32 v129, v129, 9, v63
    v_cmp_ne_u32 s[64:65], 0, v130
    v_and_b32 v16, 0xffff0000, v130
    v_ashrrev_i32 v7, 31, v16
    v_not_b32 v7, v7
    v_or_b32 v7, 0x80000000, v7
    v_xor_b32 v16, v16, v7
    v_and_b32 v16, 0xffff0000, v16
    v_mul_f32 v16, s48, v16
    v_exp_f32 v16, v16
    s_nop 0
    v_add_f32 v16, 1.0, v16
    v_rcp_f32 v16, v16
    s_nop 0
    v_cvt_pk_bf16_f32 v16, v16, v16
    v_lshlrev_b32 v16, 16, v16
    v_bfe_u32 v130, v130, 11, 3
    v_lshl_add_u32 v130, v130, 9, v63
    v_cmp_ne_u32 s[66:67], 0, v131
    v_and_b32 v17, 0xffff0000, v131
    v_ashrrev_i32 v7, 31, v17
    v_not_b32 v7, v7
    v_or_b32 v7, 0x80000000, v7
    v_xor_b32 v17, v17, v7
    v_and_b32 v17, 0xffff0000, v17
    v_mul_f32 v17, s48, v17
    v_exp_f32 v17, v17
    s_nop 0
    v_add_f32 v17, 1.0, v17
    v_rcp_f32 v17, v17
    s_nop 0
    v_cvt_pk_bf16_f32 v17, v17, v17
    v_lshlrev_b32 v17, 16, v17
    v_bfe_u32 v131, v131, 11, 3
    v_lshl_add_u32 v131, v131, 9, v63
    s_branch F_ys1
F_loader:
    s_mov_b32 s48, 0x76542130
    s_mov_b32 s49, 0xfedca9b8
    s_cmp_eq_u32 s35, 1
    s_cselect_b32 s48, 0x75463021, s48
    s_cselect_b32 s49, 0xfdceba98, s49
    s_cmp_eq_u32 s35, 2
    s_cselect_b32 s48, 0x96543102, s48
    s_cselect_b32 s49, 0xfedcba87, s49
    s_cmp_eq_u32 s35, 3
    s_cselect_b32 s48, 0x76532410, s48
    s_cselect_b32 s49, 0xfedbac98, s49
    s_cmp_eq_u32 s35, 4
    s_cselect_b32 s48, 0x65743021, s48
    s_cselect_b32 s49, 0xedfcba98, s49
    s_cmp_eq_u32 s35, 5
    s_cselect_b32 s48, 0x76543102, s48
    s_cselect_b32 s49, 0xfedcb98a, s49
    s_cmp_eq_u32 s35, 6
    s_cselect_b32 s48, 0x76435210, s48
    s_cselect_b32 s49, 0xfecbda98, s49
    s_cmp_eq_u32 s35, 7
    s_cselect_b32 s48, 0x68543021, s48
    s_cselect_b32 s49, 0xfedcba97, s49
    s_setprio 0
    s_sub_u32 s3, s3, 8
    v_lshrrev_b32 v2, 3, v0
    v_and_b32 v3, 7, v0
    v_lshrrev_b32 v4, 1, v2
    v_xor_b32 v5, v3, v4
    v_xor_b32 v6, 4, v5
    v_lshlrev_b32 v5, 4, v5
    v_lshlrev_b32 v6, 4, v6
    v_lshlrev_b32 v7, 11, v2
    v_add_u32 v12, v5, v7
    v_add_u32 v13, v6, v7
    v_and_b32 v4, 1, v4
    v_lshlrev_b32 v4, 1, v4
    v_xor_b32 v8, v3, v4
    v_xor_b32 v9, 4, v8
    v_lshlrev_b32 v8, 4, v8
    v_lshlrev_b32 v9, 4, v9
    v_mul_u32_u24 v7, 6144, v2
    v_add_u32 v14, v8, v7
    v_add_u32 v15, v9, v7
    s_lshl_b32 s36, s32, 18
    s_lshl_b32 s37, s3, 16
    s_add_u32 s36, s36, s37
    s_lshl_b32 s38, s33, 7
    s_mul_i32 s37, s3, 98304
    s_add_u32 s38, s38, s37
    s_sub_u32 s47, s10, s33
    s_lshl_b32 s47, s47, 7
    s_and_b32 s42, s39, 8
    s_and_b32 s43, s30, 6
    s_or_b32 s42, s42, s43
    s_and_b32 s43, s34, 0
    s_lshl_b32 s43, s43, 0
    s_xor_b32 s42, s42, s43
    s_lshl_b32 s44, s3, 12
    s_lshl_b32 s45, s3, 11
    s_waitcnt lgkmcnt(0)
    s_mov_b32 s12, s4
    s_mov_b32 s13, s5
    s_mov_b32 s14, 0x400000
    s_mov_b32 s15, 0x00020000
    s_mov_b32 s16, s6
    s_mov_b32 s17, s7
    s_mov_b32 s18, 0x600000
    s_mov_b32 s19, 0x00020000
    s_bfe_u32 s40, s48, 0x40000
    s_bitcmp1_b32 s40, 3
    s_cselect_b32 s41, s39, s42
    s_xor_b32 s40, s40, s41
    s_mul_i32 s41, s40, 393216
    s_add_u32 s41, s41, s38
    s_lshl_b32 s40, s40, 7
    s_add_u32 s40, s40, s36
    s_add_u32 m0, s44, 0
    s_add_u32 s46, s40, 0
    buffer_load_dwordx4 v12, s[12:15], s46 offen lds
    s_add_u32 m0, s45, 24576
    s_add_u32 s46, s41, 2048
    buffer_load_dwordx4 v14, s[16:19], s46 offen lds
    s_add_u32 m0, s45, 25600
    s_add_u32 s46, s41, 51200
    buffer_load_dwordx4 v15, s[16:19], s46 offen lds
    s_add_u32 m0, s45, 16384
    s_add_u32 s46, s41, 0
    s_add_u32 s46, s46, s47
    buffer_load_dwordx4 v14, s[16:19], s46 offen lds
    s_add_u32 m0, s45, 17408
    s_add_u32 s46, s41, 49152
    s_add_u32 s46, s46, s47
    s_nop 0
    buffer_load_dwordx4 v15, s[16:19], s46 offen lds
    s_add_u32 m0, s45, 32768
    s_add_u32 s46, s41, 4096
    buffer_load_dwordx4 v14, s[16:19], s46 offen lds
    s_add_u32 m0, s45, 33792
    s_add_u32 s46, s41, 53248
    buffer_load_dwordx4 v15, s[16:19], s46 offen lds
    s_add_u32 m0, s44, 1024
    s_add_u32 s46, s40, 16384
    buffer_load_dwordx4 v13, s[12:15], s46 offen lds
    s_add_u32 m0, s44, 2048
    s_add_u32 s46, s40, 32768
    buffer_load_dwordx4 v12, s[12:15], s46 offen lds
    s_add_u32 m0, s44, 3072
    s_add_u32 s46, s40, 49152
    buffer_load_dwordx4 v13, s[12:15], s46 offen lds
    s_bfe_u32 s40, s48, 0x40004
    s_bitcmp1_b32 s40, 3
    s_cselect_b32 s41, s39, s42
    s_xor_b32 s40, s40, s41
    s_mul_i32 s41, s40, 393216
    s_add_u32 s41, s41, s38
    s_lshl_b32 s40, s40, 7
    s_add_u32 s40, s40, s36
    s_add_u32 m0, s44, 40960
    s_add_u32 s46, s40, 0
    s_nop 0
    buffer_load_dwordx4 v12, s[12:15], s46 offen lds
    s_add_u32 m0, s45, 65536
    s_add_u32 s46, s41, 2048
    buffer_load_dwordx4 v14, s[16:19], s46 offen lds
    s_add_u32 m0, s45, 66560
    s_add_u32 s46, s41, 51200
    buffer_load_dwordx4 v15, s[16:19], s46 offen lds
    s_add_u32 m0, s45, 57344
    s_add_u32 s46, s41, 0
    s_add_u32 s46, s46, s47
    buffer_load_dwordx4 v14, s[16:19], s46 offen lds
    s_add_u32 m0, s45, 58368
    s_add_u32 s46, s41, 49152
    s_add_u32 s46, s46, s47
    s_nop 0
    buffer_load_dwordx4 v15, s[16:19], s46 offen lds
    s_add_u32 m0, s45, 73728
    s_add_u32 s46, s41, 4096
    buffer_load_dwordx4 v14, s[16:19], s46 offen lds
    s_add_u32 m0, s45, 74752
    s_add_u32 s46, s41, 53248
    buffer_load_dwordx4 v15, s[16:19], s46 offen lds
    s_add_u32 m0, s44, 41984
    s_add_u32 s46, s40, 16384
    buffer_load_dwordx4 v13, s[12:15], s46 offen lds
    s_waitcnt vmcnt(8)
    s_barrier
    s_add_u32 m0, s44, 43008
    s_add_u32 s46, s40, 32768
    buffer_load_dwordx4 v12, s[12:15], s46 offen lds
    s_add_u32 m0, s44, 44032
    s_add_u32 s46, s40, 49152
    buffer_load_dwordx4 v13, s[12:15], s46 offen lds
    s_bfe_u32 s40, s48, 0x40008
    s_bitcmp1_b32 s40, 3
    s_cselect_b32 s41, s39, s42
    s_xor_b32 s40, s40, s41
    s_mul_i32 s41, s40, 393216
    s_add_u32 s41, s41, s38
    s_lshl_b32 s40, s40, 7
    s_add_u32 s40, s40, s36
    s_add_u32 m0, s44, 81920
    s_add_u32 s46, s40, 0
    s_nop 0
    buffer_load_dwordx4 v12, s[12:15], s46 offen lds
    s_add_u32 m0, s45, 106496
    s_add_u32 s46, s41, 2048
    buffer_load_dwordx4 v14, s[16:19], s46 offen lds
    s_add_u32 m0, s45, 107520
    s_add_u32 s46, s41, 51200
    buffer_load_dwordx4 v15, s[16:19], s46 offen lds
    s_add_u32 m0, s45, 98304
    s_add_u32 s46, s41, 0
    s_add_u32 s46, s46, s47
    buffer_load_dwordx4 v14, s[16:19], s46 offen lds
    s_add_u32 m0, s45, 99328
    s_add_u32 s46, s41, 49152
    s_add_u32 s46, s46, s47
    s_nop 0
    buffer_load_dwordx4 v15, s[16:19], s46 offen lds
    s_add_u32 m0, s45, 114688
    s_add_u32 s46, s41, 4096
    buffer_load_dwordx4 v14, s[16:19], s46 offen lds
    s_add_u32 m0, s45, 115712
    s_add_u32 s46, s41, 53248
    buffer_load_dwordx4 v15, s[16:19], s46 offen lds
    s_add_u32 m0, s44, 82944
    s_add_u32 s46, s40, 16384
    buffer_load_dwordx4 v13, s[12:15], s46 offen lds
    s_add_u32 m0, s44, 83968
    s_add_u32 s46, s40, 32768
    buffer_load_dwordx4 v12, s[12:15], s46 offen lds
    s_add_u32 m0, s44, 84992
    s_add_u32 s46, s40, 49152
    buffer_load_dwordx4 v13, s[12:15], s46 offen lds
    s_waitcnt vmcnt(10)
    s_barrier
    s_bfe_u32 s40, s48, 0x4000c
    s_bitcmp1_b32 s40, 3
    s_cselect_b32 s41, s39, s42
    s_xor_b32 s40, s40, s41
    s_mul_i32 s41, s40, 393216
    s_add_u32 s41, s41, s38
    s_lshl_b32 s40, s40, 7
    s_add_u32 s40, s40, s36
    s_add_u32 m0, s44, 122880
    s_add_u32 s46, s40, 0
    s_nop 0
    buffer_load_dwordx4 v12, s[12:15], s46 offen lds
    s_add_u32 m0, s45, 147456
    s_add_u32 s46, s41, 2048
    buffer_load_dwordx4 v14, s[16:19], s46 offen lds
    s_add_u32 m0, s45, 148480
    s_add_u32 s46, s41, 51200
    buffer_load_dwordx4 v15, s[16:19], s46 offen lds
    s_add_u32 m0, s45, 139264
    s_add_u32 s46, s41, 0
    s_add_u32 s46, s46, s47
    buffer_load_dwordx4 v14, s[16:19], s46 offen lds
    s_add_u32 m0, s45, 140288
    s_add_u32 s46, s41, 49152
    s_add_u32 s46, s46, s47
    s_nop 0
    buffer_load_dwordx4 v15, s[16:19], s46 offen lds
    s_add_u32 m0, s45, 155648
    s_add_u32 s46, s41, 4096
    buffer_load_dwordx4 v14, s[16:19], s46 offen lds
    s_add_u32 m0, s45, 156672
    s_add_u32 s46, s41, 53248
    buffer_load_dwordx4 v15, s[16:19], s46 offen lds
    s_add_u32 m0, s44, 123904
    s_add_u32 s46, s40, 16384
    buffer_load_dwordx4 v13, s[12:15], s46 offen lds
    s_add_u32 m0, s44, 124928
    s_add_u32 s46, s40, 32768
    buffer_load_dwordx4 v12, s[12:15], s46 offen lds
    s_add_u32 m0, s44, 125952
    s_add_u32 s46, s40, 49152
    buffer_load_dwordx4 v13, s[12:15], s46 offen lds
    s_bfe_u32 s40, s48, 0x40010
    s_bitcmp1_b32 s40, 3
    s_cselect_b32 s41, s39, s42
    s_xor_b32 s40, s40, s41
    s_mul_i32 s41, s40, 393216
    s_add_u32 s41, s41, s38
    s_lshl_b32 s40, s40, 7
    s_add_u32 s40, s40, s36
    s_add_u32 m0, s44, 0
    s_add_u32 s46, s40, 0
    buffer_load_dwordx4 v12, s[12:15], s46 offen lds
    s_add_u32 m0, s45, 24576
    s_add_u32 s46, s41, 2048
    buffer_load_dwordx4 v14, s[16:19], s46 offen lds
    s_waitcnt vmcnt(12)
    s_barrier
    s_add_u32 m0, s45, 25600
    s_add_u32 s46, s41, 51200
    buffer_load_dwordx4 v15, s[16:19], s46 offen lds
    s_add_u32 m0, s45, 16384
    s_add_u32 s46, s41, 0
    s_add_u32 s46, s46, s47
    buffer_load_dwordx4 v14, s[16:19], s46 offen lds
    s_add_u32 m0, s45, 17408
    s_add_u32 s46, s41, 49152
    s_add_u32 s46, s46, s47
    s_nop 0
    buffer_load_dwordx4 v15, s[16:19], s46 offen lds
    s_add_u32 m0, s45, 32768
    s_add_u32 s46, s41, 4096
    buffer_load_dwordx4 v14, s[16:19], s46 offen lds
    s_add_u32 m0, s45, 33792
    s_add_u32 s46, s41, 53248
    buffer_load_dwordx4 v15, s[16:19], s46 offen lds
    s_add_u32 m0, s44, 1024
    s_add_u32 s46, s40, 16384
    buffer_load_dwordx4 v13, s[12:15], s46 offen lds
    s_add_u32 m0, s44, 2048
    s_add_u32 s46, s40, 32768
    buffer_load_dwordx4 v12, s[12:15], s46 offen lds
    s_add_u32 m0, s44, 3072
    s_add_u32 s46, s40, 49152
    buffer_load_dwordx4 v13, s[12:15], s46 offen lds
    s_bfe_u32 s40, s48, 0x40014
    s_bitcmp1_b32 s40, 3
    s_cselect_b32 s41, s39, s42
    s_xor_b32 s40, s40, s41
    s_mul_i32 s41, s40, 393216
    s_add_u32 s41, s41, s38
    s_lshl_b32 s40, s40, 7
    s_add_u32 s40, s40, s36
    s_add_u32 m0, s44, 40960
    s_add_u32 s46, s40, 0
    s_nop 0
    buffer_load_dwordx4 v12, s[12:15], s46 offen lds
    s_add_u32 m0, s45, 65536
    s_add_u32 s46, s41, 2048
    buffer_load_dwordx4 v14, s[16:19], s46 offen lds
    s_add_u32 m0, s45, 66560
    s_add_u32 s46, s41, 51200
    buffer_load_dwordx4 v15, s[16:19], s46 offen lds
    s_add_u32 m0, s45, 57344
    s_add_u32 s46, s41, 0
    s_add_u32 s46, s46, s47
    buffer_load_dwordx4 v14, s[16:19], s46 offen lds
    s_waitcnt vmcnt(14)
    s_barrier
    s_add_u32 m0, s45, 58368
    s_add_u32 s46, s41, 49152
    s_add_u32 s46, s46, s47
    s_nop 0
    buffer_load_dwordx4 v15, s[16:19], s46 offen lds
    s_add_u32 m0, s45, 73728
    s_add_u32 s46, s41, 4096
    buffer_load_dwordx4 v14, s[16:19], s46 offen lds
    s_add_u32 m0, s45, 74752
    s_add_u32 s46, s41, 53248
    buffer_load_dwordx4 v15, s[16:19], s46 offen lds
    s_add_u32 m0, s44, 41984
    s_add_u32 s46, s40, 16384
    buffer_load_dwordx4 v13, s[12:15], s46 offen lds
    s_add_u32 m0, s44, 43008
    s_add_u32 s46, s40, 32768
    buffer_load_dwordx4 v12, s[12:15], s46 offen lds
    s_add_u32 m0, s44, 44032
    s_add_u32 s46, s40, 49152
    buffer_load_dwordx4 v13, s[12:15], s46 offen lds
    s_bfe_u32 s40, s48, 0x40018
    s_bitcmp1_b32 s40, 3
    s_cselect_b32 s41, s39, s42
    s_xor_b32 s40, s40, s41
    s_mul_i32 s41, s40, 393216
    s_add_u32 s41, s41, s38
    s_lshl_b32 s40, s40, 7
    s_add_u32 s40, s40, s36
    s_add_u32 m0, s44, 81920
    s_add_u32 s46, s40, 0
    s_nop 0
    buffer_load_dwordx4 v12, s[12:15], s46 offen lds
    s_add_u32 m0, s45, 106496
    s_add_u32 s46, s41, 2048
    buffer_load_dwordx4 v14, s[16:19], s46 offen lds
    s_add_u32 m0, s45, 107520
    s_add_u32 s46, s41, 51200
    buffer_load_dwordx4 v15, s[16:19], s46 offen lds
    s_add_u32 m0, s45, 98304
    s_add_u32 s46, s41, 0
    s_add_u32 s46, s46, s47
    buffer_load_dwordx4 v14, s[16:19], s46 offen lds
    s_add_u32 m0, s45, 99328
    s_add_u32 s46, s41, 49152
    s_add_u32 s46, s46, s47
    buffer_load_dwordx4 v15, s[16:19], s46 offen lds
    s_add_u32 m0, s45, 114688
    s_add_u32 s46, s41, 4096
    buffer_load_dwordx4 v14, s[16:19], s46 offen lds
    s_waitcnt vmcnt(16)
    s_barrier
    s_nop 0
    s_add_u32 m0, s45, 115712
    s_add_u32 s46, s41, 53248
    buffer_load_dwordx4 v15, s[16:19], s46 offen lds
    s_add_u32 m0, s44, 82944
    s_add_u32 s46, s40, 16384
    buffer_load_dwordx4 v13, s[12:15], s46 offen lds
    s_add_u32 m0, s44, 83968
    s_add_u32 s46, s40, 32768
    buffer_load_dwordx4 v12, s[12:15], s46 offen lds
    s_add_u32 m0, s44, 84992
    s_add_u32 s46, s40, 49152
    buffer_load_dwordx4 v13, s[12:15], s46 offen lds
    s_bfe_u32 s40, s48, 0x4001c
    s_bitcmp1_b32 s40, 3
    s_cselect_b32 s41, s39, s42
    s_xor_b32 s40, s40, s41
    s_mul_i32 s41, s40, 393216
    s_add_u32 s41, s41, s38
    s_lshl_b32 s40, s40, 7
    s_add_u32 s40, s40, s36
    s_add_u32 m0, s44, 122880
    s_add_u32 s46, s40, 0
    s_nop 0
    buffer_load_dwordx4 v12, s[12:15], s46 offen lds
    s_add_u32 m0, s45, 147456
    s_add_u32 s46, s41, 2048
    buffer_load_dwordx4 v14, s[16:19], s46 offen lds
    s_add_u32 m0, s45, 148480
    s_add_u32 s46, s41, 51200
    buffer_load_dwordx4 v15, s[16:19], s46 offen lds
    s_add_u32 m0, s45, 139264
    s_add_u32 s46, s41, 0
    s_add_u32 s46, s46, s47
    buffer_load_dwordx4 v14, s[16:19], s46 offen lds
    s_add_u32 m0, s45, 140288
    s_add_u32 s46, s41, 49152
    s_add_u32 s46, s46, s47
    s_nop 0
    buffer_load_dwordx4 v15, s[16:19], s46 offen lds
    s_add_u32 m0, s45, 155648
    s_add_u32 s46, s41, 4096
    buffer_load_dwordx4 v14, s[16:19], s46 offen lds
    s_add_u32 m0, s45, 156672
    s_add_u32 s46, s41, 53248
    buffer_load_dwordx4 v15, s[16:19], s46 offen lds
    s_add_u32 m0, s44, 123904
    s_add_u32 s46, s40, 16384
    buffer_load_dwordx4 v13, s[12:15], s46 offen lds
    s_waitcnt vmcnt(18)
    s_barrier
    s_add_u32 m0, s44, 124928
    s_add_u32 s46, s40, 32768
    buffer_load_dwordx4 v12, s[12:15], s46 offen lds
    s_add_u32 m0, s44, 125952
    s_add_u32 s46, s40, 49152
    buffer_load_dwordx4 v13, s[12:15], s46 offen lds
    s_bfe_u32 s40, s49, 0x40000
    s_bitcmp1_b32 s40, 3
    s_cselect_b32 s41, s39, s42
    s_xor_b32 s40, s40, s41
    s_mul_i32 s41, s40, 393216
    s_add_u32 s41, s41, s38
    s_lshl_b32 s40, s40, 7
    s_add_u32 s40, s40, s36
    s_add_u32 m0, s44, 0
    s_add_u32 s46, s40, 0
    buffer_load_dwordx4 v12, s[12:15], s46 offen lds
    s_add_u32 m0, s45, 24576
    s_add_u32 s46, s41, 2048
    buffer_load_dwordx4 v14, s[16:19], s46 offen lds
    s_add_u32 m0, s45, 25600
    s_add_u32 s46, s41, 51200
    buffer_load_dwordx4 v15, s[16:19], s46 offen lds
    s_add_u32 m0, s45, 16384
    s_add_u32 s46, s41, 0
    s_add_u32 s46, s46, s47
    buffer_load_dwordx4 v14, s[16:19], s46 offen lds
    s_add_u32 m0, s45, 17408
    s_add_u32 s46, s41, 49152
    s_add_u32 s46, s46, s47
    s_nop 0
    buffer_load_dwordx4 v15, s[16:19], s46 offen lds
    s_add_u32 m0, s45, 32768
    s_add_u32 s46, s41, 4096
    buffer_load_dwordx4 v14, s[16:19], s46 offen lds
    s_add_u32 m0, s45, 33792
    s_add_u32 s46, s41, 53248
    buffer_load_dwordx4 v15, s[16:19], s46 offen lds
    s_add_u32 m0, s44, 1024
    s_add_u32 s46, s40, 16384
    buffer_load_dwordx4 v13, s[12:15], s46 offen lds
    s_add_u32 m0, s44, 2048
    s_add_u32 s46, s40, 32768
    buffer_load_dwordx4 v12, s[12:15], s46 offen lds
    s_add_u32 m0, s44, 3072
    s_add_u32 s46, s40, 49152
    buffer_load_dwordx4 v13, s[12:15], s46 offen lds
    s_waitcnt vmcnt(20)
    s_barrier
    s_bfe_u32 s40, s49, 0x40004
    s_bitcmp1_b32 s40, 3
    s_cselect_b32 s41, s39, s42
    s_xor_b32 s40, s40, s41
    s_mul_i32 s41, s40, 393216
    s_add_u32 s41, s41, s38
    s_lshl_b32 s40, s40, 7
    s_add_u32 s40, s40, s36
    s_add_u32 m0, s44, 40960
    s_add_u32 s46, s40, 0
    s_nop 0
    buffer_load_dwordx4 v12, s[12:15], s46 offen lds
    s_add_u32 m0, s45, 65536
    s_add_u32 s46, s41, 2048
    buffer_load_dwordx4 v14, s[16:19], s46 offen lds
    s_add_u32 m0, s45, 66560
    s_add_u32 s46, s41, 51200
    buffer_load_dwordx4 v15, s[16:19], s46 offen lds
    s_add_u32 m0, s45, 57344
    s_add_u32 s46, s41, 0
    s_add_u32 s46, s46, s47
    buffer_load_dwordx4 v14, s[16:19], s46 offen lds
    s_add_u32 m0, s45, 58368
    s_add_u32 s46, s41, 49152
    s_add_u32 s46, s46, s47
    s_nop 0
    buffer_load_dwordx4 v15, s[16:19], s46 offen lds
    s_add_u32 m0, s45, 73728
    s_add_u32 s46, s41, 4096
    buffer_load_dwordx4 v14, s[16:19], s46 offen lds
    s_add_u32 m0, s45, 74752
    s_add_u32 s46, s41, 53248
    buffer_load_dwordx4 v15, s[16:19], s46 offen lds
    s_add_u32 m0, s44, 41984
    s_add_u32 s46, s40, 16384
    buffer_load_dwordx4 v13, s[12:15], s46 offen lds
    s_add_u32 m0, s44, 43008
    s_add_u32 s46, s40, 32768
    buffer_load_dwordx4 v12, s[12:15], s46 offen lds
    s_add_u32 m0, s44, 44032
    s_add_u32 s46, s40, 49152
    buffer_load_dwordx4 v13, s[12:15], s46 offen lds
    s_mov_b32 s20, s8
    s_mov_b32 s21, s9
    s_mov_b32 s22, 0x200000
    s_mov_b32 s23, 0x00020000
    s_lshl_b32 s50, s2, 13
    s_lshl_b32 s51, s3, 11
    s_add_u32 s50, s50, s51
    v_lshlrev_b32 v104, 7, v0
    s_mov_b64 exec, 0xffff
    buffer_load_dword v112, v104, s[20:23], s50 offen
    s_mov_b64 exec, -1

    s_waitcnt vmcnt(21)
    s_barrier
    s_bfe_u32 s40, s49, 0x40008
    s_bitcmp1_b32 s40, 3
    s_cselect_b32 s41, s39, s42
    s_xor_b32 s40, s40, s41
    s_mul_i32 s41, s40, 393216
    s_add_u32 s41, s41, s38
    s_lshl_b32 s40, s40, 7
    s_add_u32 s40, s40, s36
    s_add_u32 m0, s44, 81920
    s_add_u32 s46, s40, 0
    buffer_load_dwordx4 v12, s[12:15], s46 offen lds
    s_add_u32 m0, s45, 106496
    s_add_u32 s46, s41, 2048
    buffer_load_dwordx4 v14, s[16:19], s46 offen lds
    s_add_u32 m0, s45, 107520
    s_add_u32 s46, s41, 51200
    buffer_load_dwordx4 v15, s[16:19], s46 offen lds
    s_add_u32 m0, s45, 98304
    s_add_u32 s46, s41, 0
    s_add_u32 s46, s46, s47
    buffer_load_dwordx4 v14, s[16:19], s46 offen lds
    s_add_u32 m0, s45, 99328
    s_add_u32 s46, s41, 49152
    s_add_u32 s46, s46, s47
    s_nop 0
    buffer_load_dwordx4 v15, s[16:19], s46 offen lds
    s_add_u32 m0, s45, 114688
    s_add_u32 s46, s41, 4096
    buffer_load_dwordx4 v14, s[16:19], s46 offen lds
    s_add_u32 m0, s45, 115712
    s_add_u32 s46, s41, 53248
    buffer_load_dwordx4 v15, s[16:19], s46 offen lds
    s_add_u32 m0, s44, 82944
    s_add_u32 s46, s40, 16384
    buffer_load_dwordx4 v13, s[12:15], s46 offen lds
    s_add_u32 m0, s44, 83968
    s_add_u32 s46, s40, 32768
    buffer_load_dwordx4 v12, s[12:15], s46 offen lds
    s_add_u32 m0, s44, 84992
    s_add_u32 s46, s40, 49152
    buffer_load_dwordx4 v13, s[12:15], s46 offen lds
    s_waitcnt vmcnt(21)
    s_barrier
    s_bfe_u32 s40, s49, 0x4000c
    s_bitcmp1_b32 s40, 3
    s_cselect_b32 s41, s39, s42
    s_xor_b32 s40, s40, s41
    s_mul_i32 s41, s40, 393216
    s_add_u32 s41, s41, s38
    s_lshl_b32 s40, s40, 7
    s_add_u32 s40, s40, s36
    s_add_u32 m0, s44, 122880
    s_add_u32 s46, s40, 0
    s_nop 0
    buffer_load_dwordx4 v12, s[12:15], s46 offen lds
    s_add_u32 m0, s45, 147456
    s_add_u32 s46, s41, 2048
    buffer_load_dwordx4 v14, s[16:19], s46 offen lds
    s_add_u32 m0, s45, 148480
    s_add_u32 s46, s41, 51200
    buffer_load_dwordx4 v15, s[16:19], s46 offen lds
    s_add_u32 m0, s45, 139264
    s_add_u32 s46, s41, 0
    s_add_u32 s46, s46, s47
    buffer_load_dwordx4 v14, s[16:19], s46 offen lds
    s_add_u32 m0, s45, 140288
    s_add_u32 s46, s41, 49152
    s_add_u32 s46, s46, s47
    s_nop 0
    buffer_load_dwordx4 v15, s[16:19], s46 offen lds
    s_add_u32 m0, s45, 155648
    s_add_u32 s46, s41, 4096
    buffer_load_dwordx4 v14, s[16:19], s46 offen lds
    s_add_u32 m0, s45, 156672
    s_add_u32 s46, s41, 53248
    buffer_load_dwordx4 v15, s[16:19], s46 offen lds
    s_add_u32 m0, s44, 123904
    s_add_u32 s46, s40, 16384
    buffer_load_dwordx4 v13, s[12:15], s46 offen lds
    s_add_u32 m0, s44, 124928
    s_add_u32 s46, s40, 32768
    buffer_load_dwordx4 v12, s[12:15], s46 offen lds
    s_add_u32 m0, s44, 125952
    s_add_u32 s46, s40, 49152
    buffer_load_dwordx4 v13, s[12:15], s46 offen lds
    s_waitcnt vmcnt(21)
    s_barrier
    s_bfe_u32 s40, s49, 0x40010
    s_bitcmp1_b32 s40, 3
    s_cselect_b32 s41, s39, s42
    s_xor_b32 s40, s40, s41
    s_mul_i32 s41, s40, 393216
    s_add_u32 s41, s41, s38
    s_lshl_b32 s40, s40, 7
    s_add_u32 s40, s40, s36
    s_add_u32 m0, s44, 0
    s_add_u32 s46, s40, 0
    buffer_load_dwordx4 v12, s[12:15], s46 offen lds
    s_add_u32 m0, s45, 24576
    s_add_u32 s46, s41, 2048
    buffer_load_dwordx4 v14, s[16:19], s46 offen lds
    s_add_u32 m0, s45, 25600
    s_add_u32 s46, s41, 51200
    buffer_load_dwordx4 v15, s[16:19], s46 offen lds
    s_add_u32 m0, s45, 16384
    s_add_u32 s46, s41, 0
    s_add_u32 s46, s46, s47
    buffer_load_dwordx4 v14, s[16:19], s46 offen lds
    s_add_u32 m0, s45, 17408
    s_add_u32 s46, s41, 49152
    s_add_u32 s46, s46, s47
    s_nop 0
    buffer_load_dwordx4 v15, s[16:19], s46 offen lds
    s_add_u32 m0, s45, 32768
    s_add_u32 s46, s41, 4096
    buffer_load_dwordx4 v14, s[16:19], s46 offen lds
    s_add_u32 m0, s45, 33792
    s_add_u32 s46, s41, 53248
    buffer_load_dwordx4 v15, s[16:19], s46 offen lds
    s_add_u32 m0, s44, 1024
    s_add_u32 s46, s40, 16384
    buffer_load_dwordx4 v13, s[12:15], s46 offen lds
    s_add_u32 m0, s44, 2048
    s_add_u32 s46, s40, 32768
    buffer_load_dwordx4 v12, s[12:15], s46 offen lds
    s_add_u32 m0, s44, 3072
    s_add_u32 s46, s40, 49152
    buffer_load_dwordx4 v13, s[12:15], s46 offen lds
    s_waitcnt vmcnt(20)
    s_barrier
    s_bfe_u32 s40, s49, 0x40014
    s_bitcmp1_b32 s40, 3
    s_cselect_b32 s41, s39, s42
    s_xor_b32 s40, s40, s41
    s_mul_i32 s41, s40, 393216
    s_add_u32 s41, s41, s38
    s_lshl_b32 s40, s40, 7
    s_add_u32 s40, s40, s36
    s_add_u32 m0, s44, 40960
    s_add_u32 s46, s40, 0
    s_nop 0
    buffer_load_dwordx4 v12, s[12:15], s46 offen lds
    s_add_u32 m0, s45, 65536
    s_add_u32 s46, s41, 2048
    buffer_load_dwordx4 v14, s[16:19], s46 offen lds
    s_add_u32 m0, s45, 66560
    s_add_u32 s46, s41, 51200
    buffer_load_dwordx4 v15, s[16:19], s46 offen lds
    s_add_u32 m0, s45, 57344
    s_add_u32 s46, s41, 0
    s_add_u32 s46, s46, s47
    buffer_load_dwordx4 v14, s[16:19], s46 offen lds
    s_add_u32 m0, s45, 58368
    s_add_u32 s46, s41, 49152
    s_add_u32 s46, s46, s47
    s_nop 0
    buffer_load_dwordx4 v15, s[16:19], s46 offen lds
    s_add_u32 m0, s45, 73728
    s_add_u32 s46, s41, 4096
    buffer_load_dwordx4 v14, s[16:19], s46 offen lds
    s_add_u32 m0, s45, 74752
    s_add_u32 s46, s41, 53248
    buffer_load_dwordx4 v15, s[16:19], s46 offen lds
    s_add_u32 m0, s44, 41984
    s_add_u32 s46, s40, 16384
    buffer_load_dwordx4 v13, s[12:15], s46 offen lds
    s_add_u32 m0, s44, 43008
    s_add_u32 s46, s40, 32768
    buffer_load_dwordx4 v12, s[12:15], s46 offen lds
    s_add_u32 m0, s44, 44032
    s_add_u32 s46, s40, 49152
    buffer_load_dwordx4 v13, s[12:15], s46 offen lds
    v_lshlrev_b32_e64 v10, 4, v0
    s_add_u32 s68, s72, 0x900000
    s_addc_u32 s69, s73, 0
    s_mov_b32 s70, 0x18000
    s_mov_b32 s71, 0x00020000
    s_lshl_b32 s52, s32, 11
    s_add_u32 s52, s52, 65536
    s_lshl_b32 s76, s3, 2
    s_add_u32 s52, s52, s76
    s_lshl_b32 s76, s3, 9
    s_add_u32 s58, s76, 24832

    s_waitcnt vmcnt(20)
    s_barrier
    s_bfe_u32 s40, s49, 0x40018
    s_bitcmp1_b32 s40, 3
    s_cselect_b32 s41, s39, s42
    s_xor_b32 s40, s40, s41
    s_mul_i32 s41, s40, 393216
    s_add_u32 s41, s41, s38
    s_lshl_b32 s40, s40, 7
    s_add_u32 s40, s40, s36
    s_add_u32 m0, s44, 81920
    s_add_u32 s46, s40, 0
    buffer_load_dwordx4 v12, s[12:15], s46 offen lds
    s_add_u32 m0, s45, 106496
    s_add_u32 s46, s41, 2048
    buffer_load_dwordx4 v14, s[16:19], s46 offen lds
    s_add_u32 m0, s45, 107520
    s_add_u32 s46, s41, 51200
    buffer_load_dwordx4 v15, s[16:19], s46 offen lds
    s_add_u32 m0, s45, 98304
    s_add_u32 s46, s41, 0
    s_add_u32 s46, s46, s47
    buffer_load_dwordx4 v14, s[16:19], s46 offen lds
    s_add_u32 m0, s45, 99328
    s_add_u32 s46, s41, 49152
    s_add_u32 s46, s46, s47
    s_nop 0
    buffer_load_dwordx4 v15, s[16:19], s46 offen lds
    s_add_u32 m0, s45, 114688
    s_add_u32 s46, s41, 4096
    buffer_load_dwordx4 v14, s[16:19], s46 offen lds
    s_add_u32 m0, s45, 115712
    s_add_u32 s46, s41, 53248
    buffer_load_dwordx4 v15, s[16:19], s46 offen lds
    s_add_u32 m0, s44, 82944
    s_add_u32 s46, s40, 16384
    buffer_load_dwordx4 v13, s[12:15], s46 offen lds
    s_add_u32 m0, s44, 83968
    s_add_u32 s46, s40, 32768
    buffer_load_dwordx4 v12, s[12:15], s46 offen lds
    s_add_u32 m0, s44, 84992
    s_add_u32 s46, s40, 49152
    buffer_load_dwordx4 v13, s[12:15], s46 offen lds
    s_add_u32 s84, s72, 0xb00000
    s_addc_u32 s85, s73, 0
    s_mov_b32 s86, 0x30000
    s_mov_b32 s87, 0x00020000
    v_bfe_u32 v113, v0, 2, 2
    v_min_u32 v113, 2, v113
    v_lshlrev_b32 v114, 8, v113
    v_lshlrev_b32 v113, 12, v113
    v_and_b32 v112, 3, v0
    v_lshl_add_u32 v113, v112, 4, v113
    v_lshl_add_u32 v114, v112, 4, v114
    v_lshrrev_b32 v112, 4, v0
    v_mul_u32_u24 v112, 12288, v112
    v_add_u32 v113, v113, v112
    s_lshl_b32 s76, s3, 6
    s_lshl_b32 s53, s33, 8
    s_add_u32 s53, s53, s76
    s_add_u32 s76, s76, 26368
    v_add_u32 v114, s76, v114

    s_waitcnt vmcnt(20)
    s_barrier
    s_bfe_u32 s40, s49, 0x4001c
    s_bitcmp1_b32 s40, 3
    s_cselect_b32 s41, s39, s42
    s_xor_b32 s40, s40, s41
    s_mul_i32 s41, s40, 393216
    s_add_u32 s41, s41, s38
    s_lshl_b32 s40, s40, 7
    s_add_u32 s40, s40, s36
    s_add_u32 m0, s44, 122880
    s_add_u32 s46, s40, 0
    buffer_load_dwordx4 v12, s[12:15], s46 offen lds
    s_add_u32 m0, s45, 147456
    s_add_u32 s46, s41, 2048
    buffer_load_dwordx4 v14, s[16:19], s46 offen lds
    s_add_u32 m0, s45, 148480
    s_add_u32 s46, s41, 51200
    buffer_load_dwordx4 v15, s[16:19], s46 offen lds
    s_add_u32 m0, s45, 139264
    s_add_u32 s46, s41, 0
    s_add_u32 s46, s46, s47
    buffer_load_dwordx4 v14, s[16:19], s46 offen lds
    s_add_u32 m0, s45, 140288
    s_add_u32 s46, s41, 49152
    s_add_u32 s46, s46, s47
    s_nop 0
    buffer_load_dwordx4 v15, s[16:19], s46 offen lds
    s_add_u32 m0, s45, 155648
    s_add_u32 s46, s41, 4096
    buffer_load_dwordx4 v14, s[16:19], s46 offen lds
    s_add_u32 m0, s45, 156672
    s_add_u32 s46, s41, 53248
    buffer_load_dwordx4 v15, s[16:19], s46 offen lds
    s_add_u32 m0, s44, 123904
    s_add_u32 s46, s40, 16384
    buffer_load_dwordx4 v13, s[12:15], s46 offen lds
    s_add_u32 m0, s44, 124928
    s_add_u32 s46, s40, 32768
    buffer_load_dwordx4 v12, s[12:15], s46 offen lds
    s_add_u32 m0, s44, 125952
    s_add_u32 s46, s40, 49152
    buffer_load_dwordx4 v13, s[12:15], s46 offen lds
    s_add_u32 s76, s53, 0
    s_nop 0
    buffer_load_dwordx4 v[72:75], v113, s[84:87], s76 offen sc0 sc1
    s_add_u32 s76, s53, 49152
    buffer_load_dwordx4 v[76:79], v113, s[84:87], s76 offen sc0 sc1
    s_add_u32 s76, s53, 98304
    buffer_load_dwordx4 v[80:83], v113, s[84:87], s76 offen sc0 sc1
    s_add_u32 s76, s53, 147456
    buffer_load_dwordx4 v[84:87], v113, s[84:87], s76 offen sc0 sc1
    s_mov_b32 m0, s58
    s_setprio 3
    s_waitcnt vmcnt(24)
    s_barrier
    s_cmp_eq_u32 s3, 3
    s_cbranch_scc1 F_d0
    buffer_load_dword v10, s[68:71], s52 offen sc0 sc1 lds
    s_add_u32 m0, m0, 256
    s_add_u32 s52, s52, 1024
    buffer_load_dword v10, s[68:71], s52 offen sc0 sc1 lds
    s_branch F_d1
F_d0:
    s_nop 0
    s_mov_b32 m0, 24576
    s_mov_b32 s52, 0x7ff00000
    s_mov_b64 exec, 0xfff
    buffer_load_dwordx4 v10, s[84:87], s52 offen lds
    buffer_load_dwordx4 v10, s[84:87], s52 offen lds
    s_mov_b64 exec, -1
F_d1:

    s_setprio 0
    s_waitcnt vmcnt(16)
    s_barrier
    s_waitcnt vmcnt(2)
F_cs0:
    v_min3_u32 v96, v72, v76, v80
    v_min_u32 v96, v96, v84
    v_cmp_eq_u32 vcc, 0, v96
    s_cbranch_vccz F_cs1
    s_sleep 8

    s_add_u32 s76, s53, 0
    buffer_load_dwordx4 v[72:75], v113, s[84:87], s76 offen sc0 sc1
    s_add_u32 s76, s53, 49152
    buffer_load_dwordx4 v[76:79], v113, s[84:87], s76 offen sc0 sc1
    s_add_u32 s76, s53, 98304
    buffer_load_dwordx4 v[80:83], v113, s[84:87], s76 offen sc0 sc1
    s_add_u32 s76, s53, 147456
    buffer_load_dwordx4 v[84:87], v113, s[84:87], s76 offen sc0 sc1
    s_waitcnt vmcnt(0)
    s_branch F_cs0
F_cs1:
    v_add_f32 v72, v72, v76
    v_add_f32 v80, v80, v84
    v_add_f32 v73, v73, v77
    v_add_f32 v81, v81, v85
    v_add_f32 v74, v74, v78
    v_add_f32 v82, v82, v86
    v_add_f32 v75, v75, v79
    v_add_f32 v83, v83, v87
    v_add_f32 v72, v72, v80
    v_add_f32 v73, v73, v81
    v_add_f32 v74, v74, v82
    v_add_f32 v75, v75, v83
    v_mov_b32 v76, v72
    v_mov_b32 v77, v73
    v_mov_b32 v78, v74
    v_mov_b32 v79, v75
    v_permlane32_swap_b32 v72, v76
    v_permlane32_swap_b32 v73, v77
    v_permlane32_swap_b32 v74, v78
    v_permlane32_swap_b32 v75, v79
    v_add_f32 v72, v72, v76
    v_add_f32 v73, v73, v77
    v_add_f32 v74, v74, v78
    v_add_f32 v75, v75, v79
    v_mov_b32 v76, v72
    v_mov_b32 v77, v73
    v_mov_b32 v78, v74
    v_mov_b32 v79, v75
    v_permlane16_swap_b32 v72, v76
    v_permlane16_swap_b32 v73, v77
    v_permlane16_swap_b32 v74, v78
    v_permlane16_swap_b32 v75, v79
    v_add_f32 v72, v72, v76
    v_add_f32 v73, v73, v77
    v_add_f32 v74, v74, v78
    v_add_f32 v75, v75, v79
    s_mov_b64 exec, 0xfff
    ds_write_b128 v114, v[72:75]
    s_mov_b64 exec, -1
    s_waitcnt lgkmcnt(0)

    s_waitcnt vmcnt(0)
    s_barrier
    s_add_u32 s24, s72, 0x800000
    s_addc_u32 s25, s73, 0
    s_mov_b32 s26, 0x100000
    s_mov_b32 s27, 0x00020000
    s_add_u32 s12, s72, 0x400000
    s_addc_u32 s13, s73, 0
    s_mov_b32 s14, 0x400000
    s_mov_b32 s15, 0x00020000
    s_mov_b32 s16, s8
    s_mov_b32 s17, s9
    s_mov_b32 s18, 0x200000
    s_mov_b32 s19, 0x00020000
    v_lshrrev_b32 v4, 4, v0
    v_and_b32 v3, 15, v0
    v_lshlrev_b32 v6, 1, v4
    v_xor_b32 v8, v3, v6
    v_xor_b32 v9, 8, v8
    v_lshlrev_b32 v8, 4, v8
    v_lshlrev_b32 v9, 4, v9
    v_lshl_add_u32 v8, v4, 11, v8
    v_lshl_add_u32 v9, v4, 11, v9
    s_lshl_b32 s38, s29, 8
    s_lshl_b32 s45, s3, 15
    s_add_u32 s38, s38, s45
    s_lshl_b32 s45, s3, 12
    s_mul_i32 s39, s35, 2
    s_mul_i32 s40, s34, 1
    s_add_u32 s39, s39, s40
    s_and_b32 s59, s34, 0

    s_lshr_b32 s36, s3, 1
    s_and_b32 s37, s3, 1
    s_lshl_b32 s43, s36, 6
    s_lshl_b32 s42, s33, 1
    s_add_u32 s42, s42, s37
    s_mul_i32 s82, s42, 4224
    s_add_u32 s83, s82, 4096
    s_add_u32 s83, s83, s43
    s_lshl_b32 s44, s36, 11
    s_add_u32 s82, s82, s44
    s_mul_i32 s51, s42, 16*64
    s_add_u32 s51, s51, 192512
    s_lshl_b32 s42, s10, 1
    s_add_u32 s42, s42, s37
    s_lshl_b32 s50, s42, 4
    s_add_u32 s50, s50, s32
    s_lshl_b32 s50, s50, 6
    v_lshlrev_b32 v10, 4, v0
    v_lshlrev_b32 v11, 2, v0
    s_lshl_b32 s42, s3, 2
    s_add_u32 s42, s42, 24640
    v_mov_b32 v1, s42
    v_and_b32 v2, 3, v0
    v_lshlrev_b32 v2, 2, v2
    v_add_u32 v2, 24640, v2
    v_and_b32 v105, 1, v0
    v_lshlrev_b32 v105, 3, v105
    s_lshl_b32 s42, s37, 2
    s_add_u32 s42, s42, 24640
    v_add_u32 v105, s42, v105
    s_lshl_b32 s42, s37, 12
    s_add_u32 s42, s42, s44
    s_add_u32 s42, s42, 65536
    v_add_u32 v106, s42, v11
    s_lshl_b32 s42, s37, 7
    s_add_u32 s42, s42, s43
    s_add_u32 s42, s42, 27136
    v_add_u32 v107, s42, v11
    v_mul_u32_u24 v108, 64*16/4, v0
    v_mov_b32 v109, 1
    s_mov_b32 s60, 0
    s_mov_b32 s62, 0xa001024
    s_mov_b32 s63, 0x1a1e14
    s_lshl_b32 s36, s28, 2
    s_add_u32 s36, s36, s3
    s_lshl_b32 s36, s36, 15
    s_lshl_b32 s44, s3, 11
    s_lshl_b32 s50, s28, 3
    s_and_b32 s76, s29, 4-1
    s_mul_i32 s76, s76, 8/4
    s_add_u32 s50, s50, s76
    s_mul_i32 s50, s50, 64
    s_add_u32 s78, s50, 0x837000
    s_add_u32 s78, s72, s78
    s_addc_u32 s79, s73, 0
    s_setprio 3
    s_sleep 10
    s_lshr_b32 s56, s3, 1
    s_add_u32 s56, s56, 1
    ds_read_b32 v114, v105
FW_11:
    s_waitcnt lgkmcnt(0)
    v_cmp_gt_u32 vcc, s56, v114
    s_cbranch_vccz FO_12
    s_sleep 1
    ds_read_b32 v114, v105
    s_branch FW_11
FO_12:
    ds_read2st64_b32 v[12:13], v106 offset0:0 offset1:1
    ds_read2st64_b32 v[20:21], v106 offset0:32 offset1:33
    ds_read2st64_b32 v[14:15], v106 offset0:2 offset1:3
    ds_read2st64_b32 v[22:23], v106 offset0:34 offset1:35
    ds_read2st64_b32 v[16:17], v106 offset0:4 offset1:5
    ds_read2st64_b32 v[24:25], v106 offset0:36 offset1:37
    ds_read2st64_b32 v[18:19], v106 offset0:6 offset1:7
    ds_read2st64_b32 v[26:27], v106 offset0:38 offset1:39
    ds_read2st64_b32 v[28:29], v107 offset0:0 offset1:1
    s_waitcnt lgkmcnt(7)
    v_add_f32 v12, v12, v20
    buffer_atomic_add_f32 v12, v11, s[24:27], s82 offen offset:0
    v_add_f32 v13, v13, v21
    buffer_atomic_add_f32 v13, v11, s[24:27], s82 offen offset:256
    s_waitcnt lgkmcnt(5)
    v_add_f32 v14, v14, v22
    buffer_atomic_add_f32 v14, v11, s[24:27], s82 offen offset:512
    v_add_f32 v15, v15, v23
    buffer_atomic_add_f32 v15, v11, s[24:27], s82 offen offset:768
    s_waitcnt lgkmcnt(3)
    v_add_f32 v16, v16, v24
    buffer_atomic_add_f32 v16, v11, s[24:27], s82 offen offset:1024
    v_add_f32 v17, v17, v25
    buffer_atomic_add_f32 v17, v11, s[24:27], s82 offen offset:1280
    s_waitcnt lgkmcnt(1)
    v_add_f32 v18, v18, v26
    buffer_atomic_add_f32 v18, v11, s[24:27], s82 offen offset:1536
    v_add_f32 v19, v19, v27
    buffer_atomic_add_f32 v19, v11, s[24:27], s82 offen offset:1792
    s_waitcnt lgkmcnt(0)
    v_add_f32 v28, v28, v29
    s_mov_b64 exec, 0xffff
    buffer_atomic_add_f32 v28, v11, s[24:27], s83 offen
    s_mov_b64 exec, -1
    v_mov_b32 v113, 1
    s_mov_b64 exec, 1
    ds_write_b32 v1, v113 offset:32
    s_mov_b64 exec, -1
    s_add_u32 s54, s51, 0x800000
    s_add_u32 s54, s72, s54
    s_addc_u32 s55, s73, 0
    s_mov_b32 s57, 1
    s_waitcnt vmcnt(4)
    ds_read2_b32 v[102:103], v2 offset0:0 offset1:8
    ds_read_b32 v104, v2 offset:16
    s_waitcnt lgkmcnt(0)
    v_cmp_ne_u32 vcc, 3, v102
    v_cmp_eq_u32 s[42:43], 0, v103
    s_nop 0
    s_or_b64 vcc, vcc, s[42:43]
    v_cmp_gt_u32 s[42:43], 2, v104
    s_nop 0
    s_or_b64 vcc, vcc, s[42:43]
    s_waitcnt vmcnt(0)
    s_atomic_add s57, s[54:55], 0
    s_atomic_add s57, s[54:55], 256
    s_atomic_add s57, s[54:55], 512
    s_atomic_add s57, s[54:55], 768
    s_cbranch_vccnz F_pe
    s_add_u32 s41, s39, 0
    s_and_b32 s41, s41, 15
    s_xor_b32 s41, s41, s59
    s_lshl_b32 s41, s41, 17
    s_add_u32 s41, s41, s38
    s_add_u32 m0, s45, 147456
    s_add_u32 s76, s41, 0
    buffer_load_dwordx4 v8, s[16:19], s76 offen lds
    s_add_u32 m0, s45, 148480
    s_add_u32 s76, s41, 8192
    buffer_load_dwordx4 v9, s[16:19], s76 offen lds
    s_add_u32 m0, s45, 149504
    s_add_u32 s76, s41, 16384
    buffer_load_dwordx4 v8, s[16:19], s76 offen lds
    s_add_u32 m0, s45, 150528
    s_add_u32 s76, s41, 24576
    buffer_load_dwordx4 v9, s[16:19], s76 offen lds
    s_add_u32 s41, s39, 1
    s_and_b32 s41, s41, 15
    s_xor_b32 s41, s41, s59
    s_lshl_b32 s41, s41, 17
    s_add_u32 s41, s41, s38
    s_add_u32 m0, s45, 65536
    s_add_u32 s76, s41, 0
    buffer_load_dwordx4 v8, s[16:19], s76 offen lds
    s_add_u32 m0, s45, 66560
    s_add_u32 s76, s41, 8192
    buffer_load_dwordx4 v9, s[16:19], s76 offen lds
    s_add_u32 m0, s45, 67584
    s_add_u32 s76, s41, 16384
    buffer_load_dwordx4 v8, s[16:19], s76 offen lds
    s_add_u32 m0, s45, 68608
    s_add_u32 s76, s41, 24576
    buffer_load_dwordx4 v9, s[16:19], s76 offen lds
    s_add_u32 s41, s39, 2
    s_and_b32 s41, s41, 15
    s_xor_b32 s41, s41, s59
    s_lshl_b32 s41, s41, 17
    s_add_u32 s41, s41, s38
    s_add_u32 m0, s45, 0
    s_add_u32 s76, s41, 0
    s_nop 0
    buffer_load_dwordx4 v8, s[16:19], s76 offen lds
    s_add_u32 m0, s45, 1024
    s_add_u32 s76, s41, 8192
    buffer_load_dwordx4 v9, s[16:19], s76 offen lds
    s_add_u32 m0, s45, 2048
    s_add_u32 s76, s41, 16384
    buffer_load_dwordx4 v8, s[16:19], s76 offen lds
    s_add_u32 m0, s45, 3072
    s_add_u32 s76, s41, 24576
    buffer_load_dwordx4 v9, s[16:19], s76 offen lds
    s_mov_b32 s60, 3
F_pe:
    s_setprio 1
F_pr0:
    s_waitcnt vmcnt(8)
    ds_read2_b32 v[102:103], v2 offset0:0 offset1:8
    s_cmp_lt_u32 s60, 2
    s_cselect_b32 s61, 1, 3
    s_waitcnt lgkmcnt(0)
    v_cmp_le_u32 vcc, 4, v102
    s_cbranch_vccz F_pr3
    s_mov_b32 s61, 5
F_pr3:
    v_cmp_gt_u32 vcc, s61, v102
    v_cmp_gt_u32 s[42:43], 1, v103
    s_nop 0
    s_or_b64 vcc, vcc, s[42:43]
    s_cbranch_vccz F_pr2
    s_sleep 2
    s_branch F_pr0
F_pr2:
    s_cmp_lt_u32 s60, 6
    s_cbranch_scc1 F_pr4
    ds_read_b32 v102, v2 offset:16
    s_waitcnt lgkmcnt(0)
    v_cmp_gt_u32 vcc, 2, v102
    s_cbranch_vccz F_pr4
    s_sleep 2
    s_branch F_pr0
F_pr4:
    s_add_u32 s41, s39, s60
    s_and_b32 s41, s41, 15
    s_xor_b32 s41, s41, s59
    s_lshl_b32 s41, s41, 17
    s_add_u32 s41, s41, s38
    s_lshl_b32 s76, s60, 3
    s_lshr_b64 s[42:43], s[62:63], s76
    s_and_b32 s42, s42, 0xff
    s_lshl_b32 s42, s42, 12
    s_add_u32 m0, s42, s45
    s_add_u32 s60, s60, 1
    buffer_load_dwordx4 v8, s[16:19], s41 offen lds
    s_add_u32 m0, m0, 1024
    s_add_u32 s41, s41, 8192
    buffer_load_dwordx4 v9, s[16:19], s41 offen lds
    s_add_u32 m0, m0, 1024
    s_add_u32 s41, s41, 8192
    buffer_load_dwordx4 v8, s[16:19], s41 offen lds
    s_add_u32 m0, m0, 1024
    s_add_u32 s41, s41, 8192
    buffer_load_dwordx4 v9, s[16:19], s41 offen lds
    s_cmp_ge_u32 s60, 7
    s_cbranch_scc1 F_pr1
    s_cmp_eq_u32 s61, 5
    s_cbranch_scc1 F_pr2
    s_branch F_pr0
F_pr1:
    s_cmp_lg_u32 s3, 0
    s_cbranch_scc1 F_l4
SP_13:
    s_load_dword s58, s[78:79], 0 glc
    s_waitcnt lgkmcnt(0)
    s_cmp_ge_u32 s58, 32
    s_cbranch_scc1 SD_14
    s_sleep 1
    s_branch SP_13
SD_14:
    v_mov_b32 v113, 3
    s_mov_b64 exec, 1
    ds_write_b32 v1, v113 offset:112
    s_mov_b64 exec, -1
    s_branch F_l5
F_l4:
    v_mov_b32 v4, 24752
    ds_read_b32 v13, v4
FW_15:
    s_waitcnt lgkmcnt(0)
    v_cmp_gt_u32_e64 vcc, 3, v13
    s_cbranch_vccz FO_16
    s_sleep 1
    ds_read_b32 v13, v4
    s_branch FW_15
FO_16:
F_l5:
    s_add_u32 s40, s39, 0
    s_and_b32 s40, s40, 15
    s_xor_b32 s40, s40, s59
    s_lshl_b32 s40, s40, 11
    s_add_u32 s40, s40, s36
    s_add_u32 m0, s44, 16384
    s_nop 0
    buffer_load_dwordx4 v10, s[12:15], s40 offen offset:0 sc1 lds
    s_add_u32 m0, s44, 16384
    s_nop 0
    buffer_load_dwordx4 v10, s[12:15], s40 offen offset:1024 sc1 lds
    s_add_u32 s40, s39, 1
    s_and_b32 s40, s40, 15
    s_xor_b32 s40, s40, s59
    s_lshl_b32 s40, s40, 11
    s_add_u32 s40, s40, s36
    s_add_u32 m0, s44, 98304
    s_nop 0
    buffer_load_dwordx4 v10, s[12:15], s40 offen offset:0 sc1 lds
    s_add_u32 m0, s44, 98304
    s_nop 0
    buffer_load_dwordx4 v10, s[12:15], s40 offen offset:1024 sc1 lds
    s_add_u32 s40, s39, 2
    s_and_b32 s40, s40, 15
    s_xor_b32 s40, s40, s59
    s_lshl_b32 s40, s40, 11
    s_add_u32 s40, s40, s36
    s_add_u32 m0, s44, 139264
    s_nop 0
    buffer_load_dwordx4 v10, s[12:15], s40 offen offset:0 sc1 lds
    s_add_u32 m0, s44, 139264
    s_nop 0
    buffer_load_dwordx4 v10, s[12:15], s40 offen offset:1024 sc1 lds
    s_waitcnt vmcnt(4)
    s_barrier
    s_add_u32 s40, s39, 3
    s_and_b32 s40, s40, 15
    s_xor_b32 s40, s40, s59
    s_lshl_b32 s40, s40, 11
    s_add_u32 s40, s40, s36
    s_add_u32 m0, s44, 57344
    s_nop 0
    buffer_load_dwordx4 v10, s[12:15], s40 offen offset:0 sc1 lds
    s_add_u32 m0, s44, 57344
    s_nop 0
    buffer_load_dwordx4 v10, s[12:15], s40 offen offset:1024 sc1 lds
    s_setprio 0
    s_waitcnt vmcnt(4)
    s_barrier
    s_add_u32 s40, s39, 4
    s_and_b32 s40, s40, 15
    s_xor_b32 s40, s40, s59
    s_lshl_b32 s40, s40, 11
    s_add_u32 s40, s40, s36
    s_add_u32 m0, s44, 16384
    s_nop 0
    buffer_load_dwordx4 v10, s[12:15], s40 offen offset:0 sc1 lds
    s_add_u32 m0, s44, 16384
    s_nop 0
    buffer_load_dwordx4 v10, s[12:15], s40 offen offset:1024 sc1 lds
    s_add_u32 s41, s39, 7
    s_and_b32 s41, s41, 15
    s_xor_b32 s41, s41, s59
    s_lshl_b32 s41, s41, 17
    s_add_u32 s41, s41, s38
    s_add_u32 m0, s45, 147456
    s_add_u32 s76, s41, 0
    buffer_load_dwordx4 v8, s[16:19], s76 offen lds
    s_add_u32 m0, s45, 148480
    s_add_u32 s76, s41, 8192
    buffer_load_dwordx4 v9, s[16:19], s76 offen lds
    s_add_u32 m0, s45, 149504
    s_add_u32 s76, s41, 16384
    buffer_load_dwordx4 v8, s[16:19], s76 offen lds
    s_add_u32 m0, s45, 150528
    s_add_u32 s76, s41, 24576
    buffer_load_dwordx4 v9, s[16:19], s76 offen lds
    s_waitcnt vmcnt(8)
    s_barrier
    s_add_u32 s40, s39, 5
    s_and_b32 s40, s40, 15
    s_xor_b32 s40, s40, s59
    s_lshl_b32 s40, s40, 11
    s_add_u32 s40, s40, s36
    s_add_u32 m0, s44, 98304
    s_nop 0
    buffer_load_dwordx4 v10, s[12:15], s40 offen offset:0 sc1 lds
    s_add_u32 m0, s44, 98304
    s_nop 0
    buffer_load_dwordx4 v10, s[12:15], s40 offen offset:1024 sc1 lds
    s_add_u32 s41, s39, 8
    s_and_b32 s41, s41, 15
    s_xor_b32 s41, s41, s59
    s_lshl_b32 s41, s41, 17
    s_add_u32 s41, s41, s38
    s_add_u32 m0, s45, 65536
    s_add_u32 s76, s41, 0
    s_nop 0
    buffer_load_dwordx4 v8, s[16:19], s76 offen lds
    s_add_u32 m0, s45, 66560
    s_add_u32 s76, s41, 8192
    buffer_load_dwordx4 v9, s[16:19], s76 offen lds
    s_add_u32 m0, s45, 67584
    s_add_u32 s76, s41, 16384
    buffer_load_dwordx4 v8, s[16:19], s76 offen lds
    s_add_u32 m0, s45, 68608
    s_add_u32 s76, s41, 24576
    buffer_load_dwordx4 v9, s[16:19], s76 offen lds
    s_waitcnt vmcnt(12)
    s_barrier
    s_add_u32 s40, s39, 6
    s_and_b32 s40, s40, 15
    s_xor_b32 s40, s40, s59
    s_lshl_b32 s40, s40, 11
    s_add_u32 s40, s40, s36
    s_add_u32 m0, s44, 139264
    s_nop 0
    buffer_load_dwordx4 v10, s[12:15], s40 offen offset:0 sc1 lds
    s_add_u32 m0, s44, 139264
    s_nop 0
    buffer_load_dwordx4 v10, s[12:15], s40 offen offset:1024 sc1 lds
    s_add_u32 s41, s39, 9
    s_and_b32 s41, s41, 15
    s_xor_b32 s41, s41, s59
    s_lshl_b32 s41, s41, 17
    s_add_u32 s41, s41, s38
    s_add_u32 m0, s45, 0
    s_add_u32 s76, s41, 0
    buffer_load_dwordx4 v8, s[16:19], s76 offen lds
    s_add_u32 m0, s45, 1024
    s_add_u32 s76, s41, 8192
    buffer_load_dwordx4 v9, s[16:19], s76 offen lds
    s_add_u32 m0, s45, 2048
    s_add_u32 s76, s41, 16384
    buffer_load_dwordx4 v8, s[16:19], s76 offen lds
    s_add_u32 m0, s45, 3072
    s_add_u32 s76, s41, 24576
    buffer_load_dwordx4 v9, s[16:19], s76 offen lds
    s_waitcnt vmcnt(16)
    s_barrier
    s_add_u32 s40, s39, 7
    s_and_b32 s40, s40, 15
    s_xor_b32 s40, s40, s59
    s_lshl_b32 s40, s40, 11
    s_add_u32 s40, s40, s36
    s_add_u32 m0, s44, 57344
    s_nop 0
    buffer_load_dwordx4 v10, s[12:15], s40 offen offset:0 sc1 lds
    s_add_u32 m0, s44, 57344
    s_nop 0
    buffer_load_dwordx4 v10, s[12:15], s40 offen offset:1024 sc1 lds
    s_add_u32 s41, s39, 10
    s_and_b32 s41, s41, 15
    s_xor_b32 s41, s41, s59
    s_lshl_b32 s41, s41, 17
    s_add_u32 s41, s41, s38
    s_add_u32 m0, s45, 40960
    s_add_u32 s76, s41, 0
    s_nop 0
    buffer_load_dwordx4 v8, s[16:19], s76 offen lds
    s_add_u32 m0, s45, 41984
    s_add_u32 s76, s41, 8192
    buffer_load_dwordx4 v9, s[16:19], s76 offen lds
    s_add_u32 m0, s45, 43008
    s_add_u32 s76, s41, 16384
    buffer_load_dwordx4 v8, s[16:19], s76 offen lds
    s_add_u32 m0, s45, 44032
    s_add_u32 s76, s41, 24576
    buffer_load_dwordx4 v9, s[16:19], s76 offen lds
    s_waitcnt vmcnt(16)
    s_barrier
    s_add_u32 s40, s39, 8
    s_and_b32 s40, s40, 15
    s_xor_b32 s40, s40, s59
    s_lshl_b32 s40, s40, 11
    s_add_u32 s40, s40, s36
    s_add_u32 m0, s44, 16384
    s_nop 0
    buffer_load_dwordx4 v10, s[12:15], s40 offen offset:0 sc1 lds
    s_add_u32 m0, s44, 16384
    s_nop 0
    buffer_load_dwordx4 v10, s[12:15], s40 offen offset:1024 sc1 lds
    s_add_u32 s41, s39, 11
    s_and_b32 s41, s41, 15
    s_xor_b32 s41, s41, s59
    s_lshl_b32 s41, s41, 17
    s_add_u32 s41, s41, s38
    s_add_u32 m0, s45, 81920
    s_add_u32 s76, s41, 0
    s_nop 0
    buffer_load_dwordx4 v8, s[16:19], s76 offen lds
    s_add_u32 m0, s45, 82944
    s_add_u32 s76, s41, 8192
    buffer_load_dwordx4 v9, s[16:19], s76 offen lds
    s_add_u32 m0, s45, 83968
    s_add_u32 s76, s41, 16384
    buffer_load_dwordx4 v8, s[16:19], s76 offen lds
    s_add_u32 m0, s45, 84992
    s_add_u32 s76, s41, 24576
    buffer_load_dwordx4 v9, s[16:19], s76 offen lds
    s_waitcnt vmcnt(16)
    s_barrier
    s_add_u32 s40, s39, 9
    s_and_b32 s40, s40, 15
    s_xor_b32 s40, s40, s59
    s_lshl_b32 s40, s40, 11
    s_add_u32 s40, s40, s36
    s_add_u32 m0, s44, 98304
    s_nop 0
    buffer_load_dwordx4 v10, s[12:15], s40 offen offset:0 sc1 lds
    s_add_u32 m0, s44, 98304
    s_nop 0
    buffer_load_dwordx4 v10, s[12:15], s40 offen offset:1024 sc1 lds
    s_add_u32 s41, s39, 12
    s_and_b32 s41, s41, 15
    s_xor_b32 s41, s41, s59
    s_lshl_b32 s41, s41, 17
    s_add_u32 s41, s41, s38
    s_add_u32 m0, s45, 122880
    s_add_u32 s76, s41, 0
    s_nop 0
    buffer_load_dwordx4 v8, s[16:19], s76 offen lds
    s_add_u32 m0, s45, 123904
    s_add_u32 s76, s41, 8192
    buffer_load_dwordx4 v9, s[16:19], s76 offen lds
    s_add_u32 m0, s45, 124928
    s_add_u32 s76, s41, 16384
    buffer_load_dwordx4 v8, s[16:19], s76 offen lds
    s_add_u32 m0, s45, 125952
    s_add_u32 s76, s41, 24576
    buffer_load_dwordx4 v9, s[16:19], s76 offen lds
    s_waitcnt vmcnt(16)
    s_barrier
    s_add_u32 s40, s39, 10
    s_and_b32 s40, s40, 15
    s_xor_b32 s40, s40, s59
    s_lshl_b32 s40, s40, 11
    s_add_u32 s40, s40, s36
    s_add_u32 m0, s44, 139264
    s_nop 0
    buffer_load_dwordx4 v10, s[12:15], s40 offen offset:0 sc1 lds
    s_add_u32 m0, s44, 139264
    s_nop 0
    buffer_load_dwordx4 v10, s[12:15], s40 offen offset:1024 sc1 lds
    s_add_u32 s41, s39, 13
    s_and_b32 s41, s41, 15
    s_xor_b32 s41, s41, s59
    s_lshl_b32 s41, s41, 17
    s_add_u32 s41, s41, s38
    s_add_u32 m0, s45, 106496
    s_add_u32 s76, s41, 0
    s_nop 0
    buffer_load_dwordx4 v8, s[16:19], s76 offen lds
    s_add_u32 m0, s45, 107520
    s_add_u32 s76, s41, 8192
    buffer_load_dwordx4 v9, s[16:19], s76 offen lds
    s_add_u32 m0, s45, 108544
    s_add_u32 s76, s41, 16384
    buffer_load_dwordx4 v8, s[16:19], s76 offen lds
    s_add_u32 m0, s45, 109568
    s_add_u32 s76, s41, 24576
    buffer_load_dwordx4 v9, s[16:19], s76 offen lds
    s_waitcnt vmcnt(16)
    s_barrier
    s_add_u32 s40, s39, 11
    s_and_b32 s40, s40, 15
    s_xor_b32 s40, s40, s59
    s_lshl_b32 s40, s40, 11
    s_add_u32 s40, s40, s36
    s_add_u32 m0, s44, 57344
    s_nop 0
    buffer_load_dwordx4 v10, s[12:15], s40 offen offset:0 sc1 lds
    s_add_u32 m0, s44, 57344
    s_nop 0
    buffer_load_dwordx4 v10, s[12:15], s40 offen offset:1024 sc1 lds
    s_add_u32 s41, s39, 14
    s_and_b32 s41, s41, 15
    s_xor_b32 s41, s41, s59
    s_lshl_b32 s41, s41, 17
    s_add_u32 s41, s41, s38
    s_add_u32 m0, s45, 147456
    s_add_u32 s76, s41, 0
    s_nop 0
    buffer_load_dwordx4 v8, s[16:19], s76 offen lds
    s_add_u32 m0, s45, 148480
    s_add_u32 s76, s41, 8192
    buffer_load_dwordx4 v9, s[16:19], s76 offen lds
    s_add_u32 m0, s45, 149504
    s_add_u32 s76, s41, 16384
    buffer_load_dwordx4 v8, s[16:19], s76 offen lds
    s_add_u32 m0, s45, 150528
    s_add_u32 s76, s41, 24576
    buffer_load_dwordx4 v9, s[16:19], s76 offen lds
    s_waitcnt vmcnt(16)
    s_barrier
    s_add_u32 s40, s39, 12
    s_and_b32 s40, s40, 15
    s_xor_b32 s40, s40, s59
    s_lshl_b32 s40, s40, 11
    s_add_u32 s40, s40, s36
    s_add_u32 m0, s44, 16384
    s_nop 0
    buffer_load_dwordx4 v10, s[12:15], s40 offen offset:0 sc1 lds
    s_add_u32 m0, s44, 16384
    s_nop 0
    buffer_load_dwordx4 v10, s[12:15], s40 offen offset:1024 sc1 lds
    s_add_u32 s41, s39, 15
    s_and_b32 s41, s41, 15
    s_xor_b32 s41, s41, s59
    s_lshl_b32 s41, s41, 17
    s_add_u32 s41, s41, s38
    s_add_u32 m0, s45, 65536
    s_add_u32 s76, s41, 0
    s_nop 0
    buffer_load_dwordx4 v8, s[16:19], s76 offen lds
    s_add_u32 m0, s45, 66560
    s_add_u32 s76, s41, 8192
    buffer_load_dwordx4 v9, s[16:19], s76 offen lds
    s_add_u32 m0, s45, 67584
    s_add_u32 s76, s41, 16384
    buffer_load_dwordx4 v8, s[16:19], s76 offen lds
    s_add_u32 m0, s45, 68608
    s_add_u32 s76, s41, 24576
    buffer_load_dwordx4 v9, s[16:19], s76 offen lds
    s_waitcnt vmcnt(16)
    s_barrier
    s_add_u32 s40, s39, 13
    s_and_b32 s40, s40, 15
    s_xor_b32 s40, s40, s59
    s_lshl_b32 s40, s40, 11
    s_add_u32 s40, s40, s36
    s_add_u32 m0, s44, 98304
    s_nop 0
    buffer_load_dwordx4 v10, s[12:15], s40 offen offset:0 sc1 lds
    s_add_u32 m0, s44, 98304
    s_nop 0
    buffer_load_dwordx4 v10, s[12:15], s40 offen offset:1024 sc1 lds
    s_waitcnt vmcnt(12)
    s_barrier
    s_add_u32 s40, s39, 14
    s_and_b32 s40, s40, 15
    s_xor_b32 s40, s40, s59
    s_lshl_b32 s40, s40, 11
    s_add_u32 s40, s40, s36
    s_add_u32 m0, s44, 139264
    s_nop 0
    buffer_load_dwordx4 v10, s[12:15], s40 offen offset:0 sc1 lds
    s_add_u32 m0, s44, 139264
    s_nop 0
    buffer_load_dwordx4 v10, s[12:15], s40 offen offset:1024 sc1 lds
    s_waitcnt vmcnt(8)
    s_barrier
    s_add_u32 s40, s39, 15
    s_and_b32 s40, s40, 15
    s_xor_b32 s40, s40, s59
    s_lshl_b32 s40, s40, 11
    s_add_u32 s40, s40, s36
    s_add_u32 m0, s44, 57344
    s_nop 0
    buffer_load_dwordx4 v10, s[12:15], s40 offen offset:0 sc1 lds
    s_add_u32 m0, s44, 57344
    s_nop 0
    buffer_load_dwordx4 v10, s[12:15], s40 offen offset:1024 sc1 lds
    s_waitcnt vmcnt(4)
    s_barrier
    s_waitcnt vmcnt(2)
    s_barrier
    s_waitcnt vmcnt(0)
    s_barrier
    s_endpgm
F_aux:
    s_barrier
    s_setprio 0
    s_sub_u32 s3, s3, 4
    s_and_b32 s36, s2, 3
    s_bfe_u32 s37, s2, 0x10002
    s_lshr_b32 s38, s2, 3
    v_lshlrev_b32 v3, 2, v0
    s_lshl_b32 s77, s36, 1
    s_add_u32 s77, s77, s37
    s_mul_i32 s77, s77, 114688
    s_lshl_b32 s46, s38, 12
    s_add_u32 s77, s77, s46
    s_lshl_b32 s46, s3, 10
    s_add_u32 s77, s77, s46
    s_cmp_ge_u32 s2, 224
    s_cselect_b32 s77, 0x7ff00000, s77
    v_mov_b32 v140, 0
    v_mov_b32 v141, 0
    v_mov_b32 v142, 0
    v_mov_b32 v143, 0
    s_add_u32 s12, s72, 0xa00000
    s_addc_u32 s13, s73, 0
    s_mov_b32 s14, 0xe0000
    s_mov_b32 s15, 0x00020000
    buffer_store_dwordx4 v[140:143], v2, s[12:15], s77 offen sc0 sc1
    s_add_u32 s12, s72, 0xb00000
    s_addc_u32 s13, s73, 0
    s_mov_b32 s14, 0x30000
    s_mov_b32 s15, 0x00020000
    s_lshl_b32 s47, s32, 8
    s_add_u32 s56, s47, 0x908000
    s_add_u32 s56, s72, s56
    s_addc_u32 s57, s73, 0
    s_cmp_eq_u32 s37, 0
    s_cselect_b32 s16, s62, s64
    s_cselect_b32 s17, s63, s65
    s_mov_b32 s18, 7340032
    s_mov_b32 s19, 0x00020000
    s_lshl_b32 s44, s3, 2
    s_add_u32 s44, s44, 24640
    v_mov_b32 v10, s44
    v_lshrrev_b32 v5, 4, v0
    v_mul_u32_u24 v6, 57344, v5
    v_and_b32 v7, 15, v0
    v_lshl_add_u32 v6, v7, 4, v6
    s_lshl_b32 s44, s36, 2
    s_add_u32 s44, s44, s3
    s_mul_i32 s54, s44, 458752
    s_lshl_b32 s45, s38, 8
    s_add_u32 s54, s54, s45
    s_cmp_ge_u32 s2, 224
    s_cselect_b32 s54, 0x70000000, s54
    s_lshl_b32 s55, s44, 7
    v_mov_b32 v8, 0
    s_mov_b32 s80, s66
    s_mov_b32 s81, s67
    s_mov_b32 s82, 0x700000
    s_mov_b32 s83, 0x00020000
    v_bfe_u32 v21, v0, 2, 2
    v_lshl_add_u32 v22, v5, 3, v21
    v_lshrrev_b32 v21, 1, v21
    v_and_b32 v20, 1, v5
    v_lshl_add_u32 v21, v20, 1, v21
    v_xor_b32 v21, s3, v21
    v_lshlrev_b32 v21, 5, v21
    v_lshl_add_u32 v21, v22, 7, v21
    v_and_b32 v20, 3, v0
    v_lshl_add_u32 v21, v20, 3, v21
    s_mov_b32 s44, 0x23453342
    s_lshl_b32 s89, s35, 2
    s_lshr_b32 s89, s44, s89
    s_and_b32 s89, s89, 15
    s_and_b32 s44, s89, 3
    s_mul_i32 s44, s44, 40960
    s_add_u32 s44, s44, 16384
    v_add_u32 v112, s44, v21
    v_lshlrev_b32_e64 v113, 2, v7
    v_lshl_add_u32 v113, v5, 12, v113
    s_lshl_b32 s91, s33, 8
    s_lshl_b32 s45, s3, 6
    s_add_u32 s91, s91, s45
    s_mul_i32 s88, s32, 12288
    s_add_u32 s88, s88, s91
    s_mov_b32 exec_hi, 0xffff
    buffer_store_dword v8, v113, s[12:15], s88 offen sc0 sc1
    s_mov_b64 exec, -1
    s_getpc_b64 s[64:65]
F_cp:
    s_add_u32 s64, s64, F_co-F_cp
    s_addc_u32 s65, s65, 0
    s_branch F_cx
F_co:
    ds_read_b64_tr_b16 v[72:73], v112 offset:0
    ds_read_b64_tr_b16 v[74:75], v112 offset:512
    ds_read_b64_tr_b16 v[76:77], v112 offset:4096
    ds_read_b64_tr_b16 v[78:79], v112 offset:4608
    ds_read_b64_tr_b16 v[80:81], v112 offset:8192
    ds_read_b64_tr_b16 v[82:83], v112 offset:8704
    ds_read_b64_tr_b16 v[84:85], v112 offset:12288
    ds_read_b64_tr_b16 v[86:87], v112 offset:12800
    ds_read_b64_tr_b16 v[88:89], v112 offset:16384
    ds_read_b64_tr_b16 v[90:91], v112 offset:16896
    ds_read_b64_tr_b16 v[92:93], v112 offset:20480
    ds_read_b64_tr_b16 v[94:95], v112 offset:20992
    v_mov_b32 v108, 0x3f803f80
    v_mov_b32 v109, 0x3f803f80
    v_mov_b32 v110, 0x3f803f80
    v_mov_b32 v111, 0x3f803f80
    s_waitcnt lgkmcnt(0)
    s_swappc_b64 s[64:65], s[66:67]
    s_setprio 3
    v_mfma_f32_16x16x32_bf16 v[96:99], v[108:111], v[72:75], 0
    v_mfma_f32_16x16x32_bf16 v[100:103], v[108:111], v[80:83], 0
    v_mfma_f32_16x16x32_bf16 v[104:107], v[108:111], v[88:91], 0
    v_mfma_f32_16x16x32_bf16 v[96:99], v[108:111], v[76:79], v[96:99]
    v_mfma_f32_16x16x32_bf16 v[100:103], v[108:111], v[84:87], v[100:103]
    v_mfma_f32_16x16x32_bf16 v[104:107], v[108:111], v[92:95], v[104:107]
    s_setprio 0
    v_cmp_eq_u32 vcc, 1, v5
    s_nop 4
    v_cndmask_b32 v96, v96, v100, vcc
    v_cmp_eq_u32 vcc, 2, v5
    s_nop 1
    v_cndmask_b32 v96, v96, v104, vcc
    v_max_u32 v96, 1, v96
    s_sleep 4
    s_mov_b32 exec_hi, 0xffff
    buffer_store_dword v96, v113, s[12:15], s88 offen sc0 sc1
    s_mov_b64 exec, -1
    s_setpc_b64 s[66:67]
F_cx:
    s_cmp_eq_u32 s3, 0
    s_cbranch_scc1 F_ax0
    s_cmp_eq_u32 s3, 2
    s_cbranch_scc1 F_ax2
    s_barrier
    s_waitcnt vmcnt(0)
    s_barrier
    s_sub_u32 s45, 2, s89
    s_cmp_gt_u32 s45, 1
    s_cbranch_scc1 CB_17
    s_swappc_b64 s[66:67], s[64:65]
CB_17:
    s_barrier
    s_sub_u32 s45, 3, s89
    s_cmp_gt_u32 s45, 1
    s_cbranch_scc1 CB_18
    s_swappc_b64 s[66:67], s[64:65]
CB_18:
    s_barrier
    s_sub_u32 s45, 4, s89
    s_cmp_gt_u32 s45, 1
    s_cbranch_scc1 CB_19
    s_swappc_b64 s[66:67], s[64:65]
CB_19:
    s_barrier
    s_sub_u32 s45, 5, s89
    s_cmp_gt_u32 s45, 1
    s_cbranch_scc1 CB_20
    s_swappc_b64 s[66:67], s[64:65]
CB_20:
    s_barrier
    s_sub_u32 s45, 6, s89
    s_cmp_gt_u32 s45, 1
    s_cbranch_scc1 CB_21
    s_swappc_b64 s[66:67], s[64:65]
CB_21:
    s_barrier
    s_barrier
    s_barrier
    s_barrier
    s_barrier
    s_branch F_aj
F_ax0:
    s_lshl_b32 s44, s32, 2
    buffer_load_dword v9, v8, s[48:51], s44 offen sc0 sc1
    s_barrier
    s_waitcnt vmcnt(0)
    v_cmp_eq_u32 vcc, 0, v9
    s_cbranch_vccz F_ax0r
PL_22:
    buffer_load_dword v9, v8, s[48:51], s44 offen sc0 sc1
    s_waitcnt vmcnt(0)
    v_cmp_gt_u32 vcc, 1, v9
    s_cbranch_vccz PD_23
    s_sleep 1
    s_branch PL_22
PD_23:
F_ax0r:
    s_barrier
    s_mov_b32 s76, 1
    s_atomic_add s76, s[56:57], 0 glc
    s_sub_u32 s45, 2, s89
    s_cmp_gt_u32 s45, 1
    s_cbranch_scc1 CB_24
    s_swappc_b64 s[66:67], s[64:65]
CB_24:
    s_barrier
    s_mov_b32 s75, 0
    s_waitcnt lgkmcnt(0)
    s_cmp_lg_u32 s76, 15
    s_cbranch_scc1 F_ax0c
    s_mov_b32 s75, 1
    s_atomic_add s75, s[70:71], 64 glc
F_ax0c:
    s_sub_u32 s45, 3, s89
    s_cmp_gt_u32 s45, 1
    s_cbranch_scc1 CB_25
    s_swappc_b64 s[66:67], s[64:65]
CB_25:
    s_barrier
    s_sub_u32 s45, 4, s89
    s_cmp_gt_u32 s45, 1
    s_cbranch_scc1 CB_26
    s_swappc_b64 s[66:67], s[64:65]
CB_26:
    s_waitcnt lgkmcnt(0)
    s_cmp_lg_u32 s75, 15
    s_cbranch_scc1 F_ax0d
    v_lshlrev_b32 v9, 8, v0
    v_mov_b32 v11, 1000
    s_mov_b32 s44, 32768
    s_mov_b64 exec, 0xffff
    buffer_store_dword v11, v9, s[40:43], s44 offen sc0 sc1
    s_mov_b64 exec, -1
F_ax0d:
    s_barrier
    s_sub_u32 s45, 5, s89
    s_cmp_gt_u32 s45, 1
    s_cbranch_scc1 CB_27
    s_swappc_b64 s[66:67], s[64:65]
CB_27:
    s_barrier
    s_sub_u32 s45, 6, s89
    s_cmp_gt_u32 s45, 1
    s_cbranch_scc1 CB_28
    s_swappc_b64 s[66:67], s[64:65]
CB_28:
    s_barrier
    s_barrier
    s_barrier
    s_barrier
    s_barrier
    s_branch F_aj
F_ax2:
    s_lshl_b32 s44, s2, 10
    buffer_store_dwordx4 v[140:143], v2, s[24:27], s44 offen sc0 sc1
    s_mov_b64 exec, -1
    s_barrier
    s_waitcnt vmcnt(0)
    s_cmp_lg_u32 s2, 2
    s_cbranch_scc1 F_ax2n
    s_barrier
    s_sub_u32 s45, 2, s89
    s_cmp_gt_u32 s45, 1
    s_cbranch_scc1 CB_29
    s_swappc_b64 s[66:67], s[64:65]
CB_29:
    s_barrier
    s_sub_u32 s45, 3, s89
    s_cmp_gt_u32 s45, 1
    s_cbranch_scc1 CB_30
    s_swappc_b64 s[66:67], s[64:65]
CB_30:
    s_barrier
    s_sub_u32 s45, 4, s89
    s_cmp_gt_u32 s45, 1
    s_cbranch_scc1 CB_31
    s_swappc_b64 s[66:67], s[64:65]
CB_31:
    s_barrier
    s_sub_u32 s45, 5, s89
    s_cmp_gt_u32 s45, 1
    s_cbranch_scc1 CB_32
    s_swappc_b64 s[66:67], s[64:65]
CB_32:
    s_barrier
    s_sub_u32 s45, 6, s89
    s_cmp_gt_u32 s45, 1
    s_cbranch_scc1 CB_33
    s_swappc_b64 s[66:67], s[64:65]
CB_33:
    s_load_dword s76, s[56:57], 0 glc
    s_barrier
    s_waitcnt lgkmcnt(0)
    s_cmp_ge_u32 s76, 1000
    s_cbranch_scc1 F_ax2g
SP_34:
    s_load_dword s76, s[56:57], 0 glc
    s_waitcnt lgkmcnt(0)
    s_cmp_ge_u32 s76, 1000
    s_cbranch_scc1 SD_35
    s_sleep 2
    s_branch SP_34
SD_35:
F_ax2g:
    s_movk_i32 s44, 0
    buffer_load_dwordx4 v[16:19], v2, s[40:43], s44 offen sc0 sc1
    s_movk_i32 s44, 1024
    buffer_load_dwordx4 v[20:23], v2, s[40:43], s44 offen sc0 sc1
    s_movk_i32 s44, 2048
    buffer_load_dwordx4 v[24:27], v2, s[40:43], s44 offen sc0 sc1
    s_movk_i32 s44, 3072
    buffer_load_dwordx4 v[28:31], v2, s[40:43], s44 offen sc0 sc1
    s_movk_i32 s44, 4096
    buffer_load_dwordx4 v[32:35], v2, s[40:43], s44 offen sc0 sc1
    s_movk_i32 s44, 5120
    buffer_load_dwordx4 v[36:39], v2, s[40:43], s44 offen sc0 sc1
    s_movk_i32 s44, 6144
    buffer_load_dwordx4 v[40:43], v2, s[40:43], s44 offen sc0 sc1
    s_movk_i32 s44, 7168
    buffer_load_dwordx4 v[44:47], v2, s[40:43], s44 offen sc0 sc1
    s_mov_b32 s53, 0
    v_and_b32 v13, 7, v0
    v_lshlrev_b32 v13, 2, v13
    v_lshrrev_b32 v9, 3, v0
    v_lshl_add_u32 v13, v9, 7, v13
    s_barrier
    s_waitcnt vmcnt(0)
    s_mov_b32 s58, 0x01010101
    s_mov_b32 s59, s58
    v_max3_u32 v48, v16, v17, v18
    v_med3_u32 v49, v16, v17, v18
    v_min3_u32 v50, v16, v17, v18
    v_med3_u32 v50, v49, v50, v19
    v_med3_u32 v49, v48, v49, v19
    v_max_u32 v48, v48, v19
    v_med3_u32 v50, v49, v50, v20
    v_med3_u32 v49, v48, v49, v20
    v_max_u32 v48, v48, v20
    v_med3_u32 v50, v49, v50, v21
    v_med3_u32 v49, v48, v49, v21
    v_max_u32 v48, v48, v21
    v_med3_u32 v50, v49, v50, v22
    v_med3_u32 v49, v48, v49, v22
    v_max_u32 v48, v48, v22
    v_med3_u32 v50, v49, v50, v23
    v_med3_u32 v49, v48, v49, v23
    v_max_u32 v48, v48, v23
    v_med3_u32 v50, v49, v50, v24
    v_med3_u32 v49, v48, v49, v24
    v_max_u32 v48, v48, v24
    v_med3_u32 v50, v49, v50, v25
    v_med3_u32 v49, v48, v49, v25
    v_max_u32 v48, v48, v25
    v_med3_u32 v50, v49, v50, v26
    v_med3_u32 v49, v48, v49, v26
    v_max_u32 v48, v48, v26
    v_med3_u32 v50, v49, v50, v27
    v_med3_u32 v49, v48, v49, v27
    v_max_u32 v48, v48, v27
    v_med3_u32 v50, v49, v50, v28
    v_med3_u32 v49, v48, v49, v28
    v_max_u32 v48, v48, v28
    v_med3_u32 v50, v49, v50, v29
    v_med3_u32 v49, v48, v49, v29
    v_max_u32 v48, v48, v29
    v_med3_u32 v50, v49, v50, v30
    v_med3_u32 v49, v48, v49, v30
    v_max_u32 v48, v48, v30
    v_med3_u32 v50, v49, v50, v31
    v_med3_u32 v49, v48, v49, v31
    v_max_u32 v48, v48, v31
    v_med3_u32 v50, v49, v50, v32
    v_med3_u32 v49, v48, v49, v32
    v_max_u32 v48, v48, v32
    s_barrier
    v_med3_u32 v50, v49, v50, v33
    v_med3_u32 v49, v48, v49, v33
    v_max_u32 v48, v48, v33
    v_med3_u32 v50, v49, v50, v34
    v_med3_u32 v49, v48, v49, v34
    v_max_u32 v48, v48, v34
    v_med3_u32 v50, v49, v50, v35
    v_med3_u32 v49, v48, v49, v35
    v_max_u32 v48, v48, v35
    v_med3_u32 v50, v49, v50, v36
    v_med3_u32 v49, v48, v49, v36
    v_max_u32 v48, v48, v36
    v_med3_u32 v50, v49, v50, v37
    v_med3_u32 v49, v48, v49, v37
    v_max_u32 v48, v48, v37
    v_med3_u32 v50, v49, v50, v38
    v_med3_u32 v49, v48, v49, v38
    v_max_u32 v48, v48, v38
    v_med3_u32 v50, v49, v50, v39
    v_med3_u32 v49, v48, v49, v39
    v_max_u32 v48, v48, v39
    v_med3_u32 v50, v49, v50, v40
    v_med3_u32 v49, v48, v49, v40
    v_max_u32 v48, v48, v40
    v_med3_u32 v50, v49, v50, v41
    v_med3_u32 v49, v48, v49, v41
    v_max_u32 v48, v48, v41
    v_med3_u32 v50, v49, v50, v42
    v_med3_u32 v49, v48, v49, v42
    v_max_u32 v48, v48, v42
    v_med3_u32 v50, v49, v50, v43
    v_med3_u32 v49, v48, v49, v43
    v_max_u32 v48, v48, v43
    v_med3_u32 v50, v49, v50, v44
    v_med3_u32 v49, v48, v49, v44
    v_max_u32 v48, v48, v44
    v_med3_u32 v50, v49, v50, v45
    v_med3_u32 v49, v48, v49, v45
    v_max_u32 v48, v48, v45
    v_med3_u32 v50, v49, v50, v46
    v_med3_u32 v49, v48, v49, v46
    v_max_u32 v48, v48, v46
    v_med3_u32 v50, v49, v50, v47
    v_med3_u32 v49, v48, v49, v47
    v_max_u32 v48, v48, v47
    v_mov_b32 v4, v48
    s_nop 1
    v_max_u32_dpp v4, v4, v4 row_shr:1 row_mask:0xf bank_mask:0xf bound_ctrl:0
    s_nop 1
    v_max_u32_dpp v4, v4, v4 row_shr:2 row_mask:0xf bank_mask:0xf bound_ctrl:0
    s_nop 1
    v_max_u32_dpp v4, v4, v4 row_shr:4 row_mask:0xf bank_mask:0xf bound_ctrl:0
    s_nop 1
    v_max_u32_dpp v4, v4, v4 row_shr:8 row_mask:0xf bank_mask:0xf bound_ctrl:0
    s_nop 1
    v_max_u32_dpp v4, v4, v4 row_bcast:15 row_mask:0xa bank_mask:0xf
    s_nop 1
    v_max_u32_dpp v4, v4, v4 row_bcast:31 row_mask:0xc bank_mask:0xf
    s_nop 0
    v_readlane_b32 s52, v4, 63
    s_lshl_b64 exec, s[58:59], 0
    s_nop 0
    v_mov_b32 v12, s52
    s_mov_b64 exec, -1
    v_cmp_eq_u32 vcc, s52, v48
    s_nop 1
    v_cndmask_b32 v48, v48, v49, vcc
    v_cndmask_b32 v49, v49, v50, vcc
    v_cndmask_b32 v50, v50, 0, vcc
    s_barrier
    v_mov_b32 v4, v48
    s_nop 1
    v_max_u32_dpp v4, v4, v4 row_shr:1 row_mask:0xf bank_mask:0xf bound_ctrl:0
    s_nop 1
    v_max_u32_dpp v4, v4, v4 row_shr:2 row_mask:0xf bank_mask:0xf bound_ctrl:0
    s_nop 1
    v_max_u32_dpp v4, v4, v4 row_shr:4 row_mask:0xf bank_mask:0xf bound_ctrl:0
    s_nop 1
    v_max_u32_dpp v4, v4, v4 row_shr:8 row_mask:0xf bank_mask:0xf bound_ctrl:0
    s_nop 1
    v_max_u32_dpp v4, v4, v4 row_bcast:15 row_mask:0xa bank_mask:0xf
    s_nop 1
    v_max_u32_dpp v4, v4, v4 row_bcast:31 row_mask:0xc bank_mask:0xf
    s_nop 0
    v_readlane_b32 s52, v4, 63
    s_lshl_b64 exec, s[58:59], 1
    s_nop 0
    v_mov_b32 v12, s52
    s_mov_b64 exec, -1
    v_cmp_eq_u32 vcc, s52, v48
    s_nop 1
    v_cndmask_b32 v48, v48, v49, vcc
    v_cndmask_b32 v49, v49, v50, vcc
    v_cndmask_b32 v50, v50, 0, vcc
    v_mov_b32 v4, v48
    s_nop 1
    v_max_u32_dpp v4, v4, v4 row_shr:1 row_mask:0xf bank_mask:0xf bound_ctrl:0
    s_nop 1
    v_max_u32_dpp v4, v4, v4 row_shr:2 row_mask:0xf bank_mask:0xf bound_ctrl:0
    s_nop 1
    v_max_u32_dpp v4, v4, v4 row_shr:4 row_mask:0xf bank_mask:0xf bound_ctrl:0
    s_nop 1
    v_max_u32_dpp v4, v4, v4 row_shr:8 row_mask:0xf bank_mask:0xf bound_ctrl:0
    s_nop 1
    v_max_u32_dpp v4, v4, v4 row_bcast:15 row_mask:0xa bank_mask:0xf
    s_nop 1
    v_max_u32_dpp v4, v4, v4 row_bcast:31 row_mask:0xc bank_mask:0xf
    s_nop 0
    v_readlane_b32 s52, v4, 63
    s_lshl_b64 exec, s[58:59], 2
    s_nop 0
    v_mov_b32 v12, s52
    s_mov_b64 exec, -1
    v_cmp_eq_u32 vcc, s52, v48
    s_nop 1
    v_cndmask_b32 v48, v48, v49, vcc
    v_cndmask_b32 v49, v49, v50, vcc
    v_cndmask_b32 v50, v50, 0, vcc
    v_mov_b32 v4, v48
    s_nop 1
    v_max_u32_dpp v4, v4, v4 row_shr:1 row_mask:0xf bank_mask:0xf bound_ctrl:0
    s_nop 1
    v_max_u32_dpp v4, v4, v4 row_shr:2 row_mask:0xf bank_mask:0xf bound_ctrl:0
    s_nop 1
    v_max_u32_dpp v4, v4, v4 row_shr:4 row_mask:0xf bank_mask:0xf bound_ctrl:0
    s_nop 1
    v_max_u32_dpp v4, v4, v4 row_shr:8 row_mask:0xf bank_mask:0xf bound_ctrl:0
    s_nop 1
    v_max_u32_dpp v4, v4, v4 row_bcast:15 row_mask:0xa bank_mask:0xf
    s_nop 1
    v_max_u32_dpp v4, v4, v4 row_bcast:31 row_mask:0xc bank_mask:0xf
    s_nop 0
    v_readlane_b32 s52, v4, 63
    s_lshl_b64 exec, s[58:59], 3
    s_nop 0
    v_mov_b32 v12, s52
    s_mov_b64 exec, -1
    v_cmp_eq_u32 vcc, s52, v48
    s_nop 1
    v_cndmask_b32 v48, v48, v49, vcc
    v_cndmask_b32 v49, v49, v50, vcc
    v_cndmask_b32 v50, v50, 0, vcc
    v_mov_b32 v4, v48
    s_nop 1
    v_max_u32_dpp v4, v4, v4 row_shr:1 row_mask:0xf bank_mask:0xf bound_ctrl:0
    s_nop 1
    v_max_u32_dpp v4, v4, v4 row_shr:2 row_mask:0xf bank_mask:0xf bound_ctrl:0
    s_nop 1
    v_max_u32_dpp v4, v4, v4 row_shr:4 row_mask:0xf bank_mask:0xf bound_ctrl:0
    s_nop 1
    v_max_u32_dpp v4, v4, v4 row_shr:8 row_mask:0xf bank_mask:0xf bound_ctrl:0
    s_nop 1
    v_max_u32_dpp v4, v4, v4 row_bcast:15 row_mask:0xa bank_mask:0xf
    s_nop 1
    v_max_u32_dpp v4, v4, v4 row_bcast:31 row_mask:0xc bank_mask:0xf
    s_nop 0
    v_readlane_b32 s52, v4, 63
    s_lshl_b64 exec, s[58:59], 4
    s_nop 0
    v_mov_b32 v12, s52
    s_mov_b64 exec, -1
    v_cmp_eq_u32 vcc, s52, v48
    s_nop 1
    v_cndmask_b32 v48, v48, v49, vcc
    v_cndmask_b32 v49, v49, v50, vcc
    v_cndmask_b32 v50, v50, 0, vcc
    s_barrier
    v_mov_b32 v4, v48
    s_nop 1
    v_max_u32_dpp v4, v4, v4 row_shr:1 row_mask:0xf bank_mask:0xf bound_ctrl:0
    s_nop 1
    v_max_u32_dpp v4, v4, v4 row_shr:2 row_mask:0xf bank_mask:0xf bound_ctrl:0
    s_nop 1
    v_max_u32_dpp v4, v4, v4 row_shr:4 row_mask:0xf bank_mask:0xf bound_ctrl:0
    s_nop 1
    v_max_u32_dpp v4, v4, v4 row_shr:8 row_mask:0xf bank_mask:0xf bound_ctrl:0
    s_nop 1
    v_max_u32_dpp v4, v4, v4 row_bcast:15 row_mask:0xa bank_mask:0xf
    s_nop 1
    v_max_u32_dpp v4, v4, v4 row_bcast:31 row_mask:0xc bank_mask:0xf
    s_nop 0
    v_readlane_b32 s52, v4, 63
    s_lshl_b64 exec, s[58:59], 5
    s_nop 0
    v_mov_b32 v12, s52
    s_mov_b64 exec, -1
    v_cmp_eq_u32 vcc, s52, v48
    s_nop 1
    v_cndmask_b32 v48, v48, v49, vcc
    v_cndmask_b32 v49, v49, v50, vcc
    v_cndmask_b32 v50, v50, 0, vcc
    v_mov_b32 v4, v48
    s_nop 1
    v_max_u32_dpp v4, v4, v4 row_shr:1 row_mask:0xf bank_mask:0xf bound_ctrl:0
    s_nop 1
    v_max_u32_dpp v4, v4, v4 row_shr:2 row_mask:0xf bank_mask:0xf bound_ctrl:0
    s_nop 1
    v_max_u32_dpp v4, v4, v4 row_shr:4 row_mask:0xf bank_mask:0xf bound_ctrl:0
    s_nop 1
    v_max_u32_dpp v4, v4, v4 row_shr:8 row_mask:0xf bank_mask:0xf bound_ctrl:0
    s_nop 1
    v_max_u32_dpp v4, v4, v4 row_bcast:15 row_mask:0xa bank_mask:0xf
    s_nop 1
    v_max_u32_dpp v4, v4, v4 row_bcast:31 row_mask:0xc bank_mask:0xf
    s_nop 0
    v_readlane_b32 s52, v4, 63
    s_lshl_b64 exec, s[58:59], 6
    s_nop 0
    v_mov_b32 v12, s52
    s_mov_b64 exec, -1
    v_cmp_eq_u32 vcc, s52, v48
    s_nop 1
    v_cndmask_b32 v48, v48, v49, vcc
    v_cndmask_b32 v49, v49, v50, vcc
    v_cndmask_b32 v50, v50, 0, vcc
    v_mov_b32 v4, v48
    s_nop 1
    v_max_u32_dpp v4, v4, v4 row_shr:1 row_mask:0xf bank_mask:0xf bound_ctrl:0
    s_nop 1
    v_max_u32_dpp v4, v4, v4 row_shr:2 row_mask:0xf bank_mask:0xf bound_ctrl:0
    s_nop 1
    v_max_u32_dpp v4, v4, v4 row_shr:4 row_mask:0xf bank_mask:0xf bound_ctrl:0
    s_nop 1
    v_max_u32_dpp v4, v4, v4 row_shr:8 row_mask:0xf bank_mask:0xf bound_ctrl:0
    s_nop 1
    v_max_u32_dpp v4, v4, v4 row_bcast:15 row_mask:0xa bank_mask:0xf
    s_nop 1
    v_max_u32_dpp v4, v4, v4 row_bcast:31 row_mask:0xc bank_mask:0xf
    s_nop 0
    v_readlane_b32 s52, v4, 63
    s_lshl_b64 exec, s[58:59], 7
    s_nop 0
    v_mov_b32 v12, s52
    s_mov_b64 exec, -1
    v_cmp_eq_u32 vcc, 0, v48
    s_cbranch_vccz F_tk2
    s_mov_b32 s52, 0
    s_mov_b32 s45, 0
F_tk1:
    v_subrev_u32 v16, s52, v16
    v_subrev_u32 v17, s52, v17
    v_subrev_u32 v18, s52, v18
    v_subrev_u32 v19, s52, v19
    v_subrev_u32 v20, s52, v20
    v_subrev_u32 v21, s52, v21
    v_subrev_u32 v22, s52, v22
    v_subrev_u32 v23, s52, v23
    v_subrev_u32 v24, s52, v24
    v_subrev_u32 v25, s52, v25
    v_subrev_u32 v26, s52, v26
    v_subrev_u32 v27, s52, v27
    v_subrev_u32 v28, s52, v28
    v_subrev_u32 v29, s52, v29
    v_subrev_u32 v30, s52, v30
    v_subrev_u32 v31, s52, v31
    v_subrev_u32 v32, s52, v32
    v_subrev_u32 v33, s52, v33
    v_subrev_u32 v34, s52, v34
    v_subrev_u32 v35, s52, v35
    v_subrev_u32 v36, s52, v36
    v_subrev_u32 v37, s52, v37
    v_subrev_u32 v38, s52, v38
    v_subrev_u32 v39, s52, v39
    v_subrev_u32 v40, s52, v40
    v_subrev_u32 v41, s52, v41
    v_subrev_u32 v42, s52, v42
    v_subrev_u32 v43, s52, v43
    v_subrev_u32 v44, s52, v44
    v_subrev_u32 v45, s52, v45
    v_subrev_u32 v46, s52, v46
    v_subrev_u32 v47, s52, v47
    v_max3_u32 v4, v16, v17, v18
    v_max3_u32 v4, v4, v19, v20
    v_max3_u32 v4, v4, v21, v22
    v_max3_u32 v4, v4, v23, v24
    v_max3_u32 v4, v4, v25, v26
    v_max3_u32 v4, v4, v27, v28
    v_max3_u32 v4, v4, v29, v30
    v_max3_u32 v4, v4, v31, v32
    v_max3_u32 v4, v4, v33, v34
    v_max3_u32 v4, v4, v35, v36
    v_max3_u32 v4, v4, v37, v38
    v_max3_u32 v4, v4, v39, v40
    v_max3_u32 v4, v4, v41, v42
    v_max3_u32 v4, v4, v43, v44
    v_max3_u32 v4, v4, v45, v46
    v_max_u32 v4, v4, v47
    s_nop 1
    v_max_u32_dpp v4, v4, v4 row_shr:1 row_mask:0xf bank_mask:0xf bound_ctrl:0
    s_nop 1
    v_max_u32_dpp v4, v4, v4 row_shr:2 row_mask:0xf bank_mask:0xf bound_ctrl:0
    s_nop 1
    v_max_u32_dpp v4, v4, v4 row_shr:4 row_mask:0xf bank_mask:0xf bound_ctrl:0
    s_nop 1
    v_max_u32_dpp v4, v4, v4 row_shr:8 row_mask:0xf bank_mask:0xf bound_ctrl:0
    s_nop 1
    v_max_u32_dpp v4, v4, v4 row_bcast:15 row_mask:0xa bank_mask:0xf
    s_nop 1
    v_max_u32_dpp v4, v4, v4 row_bcast:31 row_mask:0xc bank_mask:0xf
    s_nop 0
    v_readlane_b32 s52, v4, 63
    s_nop 0
    s_add_u32 s53, s53, s52
    s_lshl_b64 exec, s[58:59], s45
    v_mov_b32 v12, s53
    s_mov_b64 exec, -1
    s_add_u32 s45, s45, 1
    s_cmp_lt_u32 s45, 8
    s_cbranch_scc1 F_tk1
F_tk2:
    v_or_b32 v12, 0x8000, v12
    s_mov_b32 s44, 184320
    buffer_store_dword v12, v13, s[24:27], s44 offen offset:0 sc0 sc1
    buffer_store_dword v12, v13, s[24:27], s44 offen offset:1024 sc0 sc1
    buffer_store_dword v12, v13, s[24:27], s44 offen offset:2048 sc0 sc1
    buffer_store_dword v12, v13, s[24:27], s44 offen offset:3072 sc0 sc1
    s_mov_b32 s44, 188416
    buffer_store_dword v12, v13, s[24:27], s44 offen offset:0 sc0 sc1
    buffer_store_dword v12, v13, s[24:27], s44 offen offset:1024 sc0 sc1
    buffer_store_dword v12, v13, s[24:27], s44 offen offset:2048 sc0 sc1
    buffer_store_dword v12, v13, s[24:27], s44 offen offset:3072 sc0 sc1
    s_branch F_aj
F_ax2n:
    s_barrier
    s_sub_u32 s45, 2, s89
    s_cmp_gt_u32 s45, 1
    s_cbranch_scc1 CB_36
    s_swappc_b64 s[66:67], s[64:65]
CB_36:
    s_barrier
    s_sub_u32 s45, 3, s89
    s_cmp_gt_u32 s45, 1
    s_cbranch_scc1 CB_37
    s_swappc_b64 s[66:67], s[64:65]
CB_37:
    s_barrier
    s_sub_u32 s45, 4, s89
    s_cmp_gt_u32 s45, 1
    s_cbranch_scc1 CB_38
    s_swappc_b64 s[66:67], s[64:65]
CB_38:
    s_barrier
    s_sub_u32 s45, 5, s89
    s_cmp_gt_u32 s45, 1
    s_cbranch_scc1 CB_39
    s_swappc_b64 s[66:67], s[64:65]
CB_39:
    s_barrier
    s_sub_u32 s45, 6, s89
    s_cmp_gt_u32 s45, 1
    s_cbranch_scc1 CB_40
    s_swappc_b64 s[66:67], s[64:65]
CB_40:
    s_barrier
    s_load_dword s76, s[56:57], 0 glc
    s_barrier
    s_waitcnt lgkmcnt(0)
    s_cmp_ge_u32 s76, 1000
    s_cbranch_scc1 F_ax2h
SP_41:
    s_load_dword s76, s[56:57], 0 glc
    s_waitcnt lgkmcnt(0)
    s_cmp_ge_u32 s76, 1000
    s_cbranch_scc1 SD_42
    s_sleep 8
    s_branch SP_41
SD_42:
F_ax2h:
    s_barrier
    s_barrier
    s_barrier
F_aj:
    s_add_u32 s12, s72, 0xa00000
    s_addc_u32 s13, s73, 0
    s_mov_b32 s14, 0xe0000
    s_mov_b32 s15, 0x00020000
    s_and_b32 s46, s2, 63
    s_lshl_b32 s46, s46, 7
    s_add_u32 s56, s46, 0x82d000
    s_add_u32 s56, s72, s56
    s_addc_u32 s57, s73, 0
    s_mov_b32 s58, 0x01010101
    s_mov_b32 s59, s58
    s_mov_b32 s52, 0x05040100
    s_mov_b32 s53, 0x07060302
    v_and_b32 v13, 3, v0
    v_lshlrev_b32 v13, 2, v13
    v_add_u32 v13, 24656, v13
    s_mul_i32 s78, s28, 112
    s_mul_i32 s79, s3, 28
    s_add_u32 s78, s78, s79
    s_lshl_b32 s78, s78, 11
    s_lshl_b32 s79, s29, 8
    s_add_u32 s78, s78, s79

    v_mul_u32_u24 v160, 14336, v5
    v_lshl_add_u32 v160, v7, 4, v160
    s_and_b32 s88, s3, 1
    s_lshl_b32 s88, s88, 12
    s_lshr_b32 s45, s3, 1
    s_mul_i32 s45, s45, 24576
    s_add_u32 s88, s88, s45
    v_subrev_u32 v163, 16, v13
    v_lshrrev_b32 v164, 1, v5
    v_lshlrev_b32 v164, 2, v164
    v_and_b32 v165, 7, v7
    v_xor_b32 v164, v164, v165
    v_lshlrev_b32 v164, 5, v164
    v_lshl_add_u32 v164, v7, 8, v164
    v_and_b32 v165, 1, v5
    v_lshl_add_u32 v164, v165, 4, v164
    s_lshl_b32 s45, s3, 12
    s_add_u32 s45, s45, 106496
    v_add_u32 v164, s45, v164
    s_lshl_b32 s45, s3, 2
    v_add_u32 v165, s45, v5
    v_and_b32 v165, 7, v165
    v_lshlrev_b32 v165, 5, v165
    v_xor_b32 v165, v165, v2
    s_lshl_b32 s45, s3, 10
    s_add_u32 s45, s45, 106496
    v_add_u32 v165, s45, v165
    v_add_u32_e64 v162, 16, v13
    s_barrier
    s_barrier
    s_sleep 2
    s_add_u32 s45, s54, 0
    buffer_load_dwordx4 v[72:75], v6, s[16:19], s45 offen nt
    s_add_u32 s45, s54, 7168
    buffer_load_dwordx4 v[76:79], v6, s[16:19], s45 offen nt
    s_add_u32 s45, s54, 14336
    buffer_load_dwordx4 v[80:83], v6, s[16:19], s45 offen nt
    s_add_u32 s45, s54, 21504
    buffer_load_dwordx4 v[84:87], v6, s[16:19], s45 offen nt
    s_barrier
    s_nop 0
    s_load_dwordx8 s[60:67], s[56:57], 0 glc
    s_add_u32 s45, s54, 28672
    buffer_load_dwordx4 v[88:91], v6, s[16:19], s45 offen nt
    s_add_u32 s45, s54, 35840
    buffer_load_dwordx4 v[92:95], v6, s[16:19], s45 offen nt
    s_add_u32 s45, s54, 43008
    buffer_load_dwordx4 v[96:99], v6, s[16:19], s45 offen nt
    s_add_u32 s45, s54, 50176
    buffer_load_dwordx4 v[100:103], v6, s[16:19], s45 offen nt
    s_barrier
    s_setprio 1
F_sc:
    s_waitcnt lgkmcnt(0)
    s_and_b64 s[74:75], s[60:61], s[62:63]
    s_and_b64 s[74:75], s[74:75], s[64:65]
    s_and_b64 s[74:75], s[74:75], s[66:67]
    s_and_b32 s74, s74, s75
    s_bitcmp1_b32 s74, 15
    s_cbranch_scc1 F_sd
    s_sleep 4
    s_load_dwordx8 s[60:67], s[56:57], 0 glc
    s_branch F_sc
F_sd:

    s_lshl_b64 exec, s[58:59], 0
    v_mov_b32 v4, s60
    s_lshl_b64 exec, s[58:59], 1
    v_mov_b32 v4, s61
    s_lshl_b64 exec, s[58:59], 2
    v_mov_b32 v4, s62
    s_lshl_b64 exec, s[58:59], 3
    v_mov_b32 v4, s63
    s_lshl_b64 exec, s[58:59], 4
    v_mov_b32 v4, s64
    s_lshl_b64 exec, s[58:59], 5
    v_mov_b32 v4, s65
    s_lshl_b64 exec, s[58:59], 6
    v_mov_b32 v4, s66
    s_lshl_b64 exec, s[58:59], 7
    v_mov_b32 v4, s67
    s_mov_b64 exec, -1
    s_mov_b32 s46, 65536
    v_and_b32 v4, 0x7ff, v4
    v_sub_u32 v4, 2047, v4
    v_lshlrev_b32 v9, 4, v4
    v_lshlrev_b32 v4, 11, v4
    v_lshl_add_u32 v4, v5, 4, v4

    buffer_load_dwordx4 v[64:67], v4, s[20:23], s55 offen
    buffer_load_dwordx4 v[68:71], v4, s[20:23], s55 offen offset:64
    buffer_load_dwordx2 v[14:15], v9, s[40:43], s46 offen sc0 sc1
    s_cmp_lt_u32 s2, 224
    s_cbranch_scc1 F_ag
    s_add_u32 s79, s78, 0
    buffer_load_dwordx4 v[16:19], v160, s[80:83], s79 offen nt
    s_add_u32 s79, s78, 2048
    buffer_load_dwordx4 v[20:23], v160, s[80:83], s79 offen nt
    s_add_u32 s79, s78, 4096
    buffer_load_dwordx4 v[24:27], v160, s[80:83], s79 offen nt
    s_add_u32 s79, s78, 6144
    buffer_load_dwordx4 v[28:31], v160, s[80:83], s79 offen nt
    s_add_u32 s79, s78, 8192
    buffer_load_dwordx4 v[144:147], v160, s[80:83], s79 offen nt
    s_add_u32 s79, s78, 10240
    buffer_load_dwordx4 v[148:151], v160, s[80:83], s79 offen nt
    s_add_u32 s79, s78, 12288
    buffer_load_dwordx4 v[152:155], v160, s[80:83], s79 offen nt
    s_sleep 32
    s_branch F_adown
F_ag:
    s_add_u32 s45, s54, 229376
    buffer_load_dwordx4 v[104:107], v6, s[16:19], s45 offen nt
    s_add_u32 s45, s54, 236544
    buffer_load_dwordx4 v[108:111], v6, s[16:19], s45 offen nt
    s_add_u32 s45, s54, 243712
    buffer_load_dwordx4 v[112:115], v6, s[16:19], s45 offen nt
    s_add_u32 s45, s54, 250880
    buffer_load_dwordx4 v[116:119], v6, s[16:19], s45 offen nt
    s_add_u32 s45, s54, 258048
    buffer_load_dwordx4 v[120:123], v6, s[16:19], s45 offen nt
    s_add_u32 s45, s54, 265216
    buffer_load_dwordx4 v[124:127], v6, s[16:19], s45 offen nt
    s_add_u32 s45, s54, 272384
    buffer_load_dwordx4 v[128:131], v6, s[16:19], s45 offen nt
    s_add_u32 s45, s54, 279552
    buffer_load_dwordx4 v[132:135], v6, s[16:19], s45 offen nt
    s_waitcnt vmcnt(8)
    v_lshlrev_b32 v34, 16, v64
    v_and_b32 v35, 0xffff0000, v64
    v_lshlrev_b32 v36, 16, v65
    v_and_b32 v37, 0xffff0000, v65
    v_lshlrev_b32 v38, 16, v66
    v_and_b32 v39, 0xffff0000, v66
    v_lshlrev_b32 v40, 16, v67
    v_and_b32 v41, 0xffff0000, v67
    v_lshlrev_b32 v42, 16, v68
    v_and_b32 v43, 0xffff0000, v68
    v_lshlrev_b32 v44, 16, v69
    v_and_b32 v45, 0xffff0000, v69
    v_lshlrev_b32 v46, 16, v70
    v_and_b32 v47, 0xffff0000, v70
    v_lshlrev_b32 v48, 16, v71
    v_and_b32 v49, 0xffff0000, v71
    v_add_f32 v34, v34, v14
    v_add_f32 v35, v35, v14
    v_add_f32 v36, v36, v14
    v_add_f32 v37, v37, v14
    v_add_f32 v38, v38, v14
    v_add_f32 v39, v39, v14
    v_add_f32 v40, v40, v14
    v_add_f32 v41, v41, v14
    v_add_f32 v42, v42, v14
    v_add_f32 v43, v43, v14
    v_add_f32 v44, v44, v14
    v_add_f32 v45, v45, v14
    v_add_f32 v46, v46, v14
    v_add_f32 v47, v47, v14
    v_add_f32 v48, v48, v14
    v_add_f32_e64 v49, v49, v14
    v_cvt_pk_bf16_f32 v64, v34, v35
    v_cvt_pk_bf16_f32 v65, v36, v37
    v_cvt_pk_bf16_f32 v66, v38, v39
    v_cvt_pk_bf16_f32 v67, v40, v41
    v_cvt_pk_bf16_f32 v68, v42, v43
    v_cvt_pk_bf16_f32 v69, v44, v45
    v_cvt_pk_bf16_f32 v70, v46, v47
    v_cvt_pk_bf16_f32 v71, v48, v49
    v_lshlrev_b32 v34, 16, v64
    v_and_b32 v35, 0xffff0000, v64
    v_lshlrev_b32 v36, 16, v65
    v_and_b32 v37, 0xffff0000, v65
    v_lshlrev_b32 v38, 16, v66
    v_and_b32 v39, 0xffff0000, v66
    v_lshlrev_b32 v40, 16, v67
    v_and_b32 v41, 0xffff0000, v67
    v_lshlrev_b32 v42, 16, v68
    v_and_b32 v43, 0xffff0000, v68
    v_lshlrev_b32 v44, 16, v69
    v_and_b32 v45, 0xffff0000, v69
    v_lshlrev_b32 v46, 16, v70
    v_and_b32 v47, 0xffff0000, v70
    v_lshlrev_b32 v48, 16, v71
    v_and_b32 v49, 0xffff0000, v71
    v_mul_f32 v34, v34, v15
    v_mul_f32 v35, v35, v15
    v_mul_f32 v36, v36, v15
    v_mul_f32 v37, v37, v15
    v_mul_f32 v38, v38, v15
    v_mul_f32 v39, v39, v15
    v_mul_f32 v40, v40, v15
    v_mul_f32 v41, v41, v15
    v_mul_f32 v42, v42, v15
    v_mul_f32 v43, v43, v15
    v_mul_f32 v44, v44, v15
    v_mul_f32 v45, v45, v15
    v_mul_f32 v46, v46, v15
    v_mul_f32 v47, v47, v15
    v_mul_f32 v48, v48, v15
    v_mul_f32 v49, v49, v15
    v_cvt_pk_bf16_f32 v64, v34, v35
    v_cvt_pk_bf16_f32 v65, v36, v37
    v_cvt_pk_bf16_f32 v66, v38, v39
    v_cvt_pk_bf16_f32 v67, v40, v41
    v_cvt_pk_bf16_f32 v68, v42, v43
    v_cvt_pk_bf16_f32 v69, v44, v45
    v_cvt_pk_bf16_f32 v70, v46, v47
    v_cvt_pk_bf16_f32 v71, v48, v49
    s_waitcnt vmcnt(8)
    v_perm_b32 v136, v76, v72, s52
    v_perm_b32 v137, v84, v80, s52
    v_perm_b32 v138, v92, v88, s52
    v_perm_b32 v139, v100, v96, s52
    s_nop 1
    v_mfma_f32_16x16x32_bf16 v[32:35], v[64:67], v[136:139], 0
    v_perm_b32 v140, v76, v72, s53
    v_perm_b32 v141, v84, v80, s53
    v_perm_b32 v142, v92, v88, s53
    v_perm_b32 v143, v100, v96, s53
    s_nop 1
    v_mfma_f32_16x16x32_bf16 v[36:39], v[64:67], v[140:143], 0
    v_perm_b32 v136, v77, v73, s52
    v_perm_b32 v137, v85, v81, s52
    v_perm_b32 v138, v93, v89, s52
    v_perm_b32 v139, v101, v97, s52
    s_nop 1
    v_mfma_f32_16x16x32_bf16 v[40:43], v[64:67], v[136:139], 0
    v_perm_b32 v140, v77, v73, s53
    v_perm_b32 v141, v85, v81, s53
    v_perm_b32 v142, v93, v89, s53
    v_perm_b32 v143, v101, v97, s53
    s_nop 1
    v_mfma_f32_16x16x32_bf16 v[44:47], v[64:67], v[140:143], 0
    v_perm_b32 v136, v78, v74, s52
    v_perm_b32 v137, v86, v82, s52
    v_perm_b32 v138, v94, v90, s52
    v_perm_b32 v139, v102, v98, s52
    s_nop 1
    v_mfma_f32_16x16x32_bf16 v[48:51], v[64:67], v[136:139], 0
    v_perm_b32 v140, v78, v74, s53
    v_perm_b32 v141, v86, v82, s53
    v_perm_b32 v142, v94, v90, s53
    v_perm_b32 v143, v102, v98, s53
    s_nop 1
    v_mfma_f32_16x16x32_bf16 v[52:55], v[64:67], v[140:143], 0
    v_perm_b32 v136, v79, v75, s52
    v_perm_b32 v137, v87, v83, s52
    v_perm_b32 v138, v95, v91, s52
    v_perm_b32 v139, v103, v99, s52
    s_nop 1
    v_mfma_f32_16x16x32_bf16 v[56:59], v[64:67], v[136:139], 0
    v_perm_b32 v140, v79, v75, s53
    v_perm_b32 v141, v87, v83, s53
    v_perm_b32 v142, v95, v91, s53
    v_perm_b32 v143, v103, v99, s53
    s_nop 1
    v_mfma_f32_16x16x32_bf16 v[60:63], v[64:67], v[140:143], 0
    s_waitcnt vmcnt(0)
    s_add_u32 s79, s78, 0
    s_nop 0
    buffer_load_dwordx4 v[16:19], v160, s[80:83], s79 offen nt
    s_add_u32 s79, s78, 2048
    buffer_load_dwordx4 v[20:23], v160, s[80:83], s79 offen nt
    s_add_u32 s79, s78, 4096
    buffer_load_dwordx4 v[24:27], v160, s[80:83], s79 offen nt
    s_add_u32 s79, s78, 6144
    buffer_load_dwordx4 v[28:31], v160, s[80:83], s79 offen nt
    s_add_u32 s79, s78, 8192
    buffer_load_dwordx4 v[144:147], v160, s[80:83], s79 offen nt
    s_add_u32 s79, s78, 10240
    buffer_load_dwordx4 v[148:151], v160, s[80:83], s79 offen nt
    s_add_u32 s79, s78, 12288
    buffer_load_dwordx4 v[152:155], v160, s[80:83], s79 offen nt
    v_perm_b32 v136, v108, v104, s52
    v_perm_b32 v137, v116, v112, s52
    v_perm_b32 v138, v124, v120, s52
    v_perm_b32 v139, v132, v128, s52
    s_nop 1
    v_mfma_f32_16x16x32_bf16 v[32:35], v[68:71], v[136:139], v[32:35]
    v_perm_b32 v140, v108, v104, s53
    v_perm_b32 v141, v116, v112, s53
    v_perm_b32 v142, v124, v120, s53
    v_perm_b32 v143, v132, v128, s53
    s_nop 1
    v_mfma_f32_16x16x32_bf16 v[36:39], v[68:71], v[140:143], v[36:39]
    v_perm_b32 v136, v109, v105, s52
    v_perm_b32 v137, v117, v113, s52
    v_perm_b32 v138, v125, v121, s52
    v_perm_b32 v139, v133, v129, s52
    s_nop 1
    v_mfma_f32_16x16x32_bf16 v[40:43], v[68:71], v[136:139], v[40:43]
    v_perm_b32 v140, v109, v105, s53
    v_perm_b32 v141, v117, v113, s53
    v_perm_b32 v142, v125, v121, s53
    v_perm_b32 v143, v133, v129, s53
    s_nop 1
    v_mfma_f32_16x16x32_bf16 v[44:47], v[68:71], v[140:143], v[44:47]
    v_perm_b32 v136, v110, v106, s52
    v_perm_b32 v137, v118, v114, s52
    v_perm_b32 v138, v126, v122, s52
    v_perm_b32 v139, v134, v130, s52
    s_nop 1
    v_mfma_f32_16x16x32_bf16 v[48:51], v[68:71], v[136:139], v[48:51]
    v_perm_b32 v140, v110, v106, s53
    v_perm_b32 v141, v118, v114, s53
    v_perm_b32 v142, v126, v122, s53
    v_perm_b32 v143, v134, v130, s53
    s_nop 1
    v_mfma_f32_16x16x32_bf16 v[52:55], v[68:71], v[140:143], v[52:55]
    v_perm_b32 v136, v111, v107, s52
    v_perm_b32 v137, v119, v115, s52
    v_perm_b32 v138, v127, v123, s52
    v_perm_b32 v139, v135, v131, s52
    s_nop 1
    v_mfma_f32_16x16x32_bf16 v[56:59], v[68:71], v[136:139], v[56:59]
    v_perm_b32 v140, v111, v107, s53
    v_perm_b32 v141, v119, v115, s53
    v_perm_b32 v142, v127, v123, s53
    v_perm_b32 v143, v135, v131, s53
    s_nop 1
    v_mfma_f32_16x16x32_bf16 v[60:63], v[68:71], v[140:143], v[60:63]
    v_cmp_gt_u32 vcc, 32, v0
    s_nop 1
    v_cndmask_b32 v32, v48, v32, vcc
    v_cndmask_b32 v33, v49, v33, vcc
    v_cndmask_b32 v34, v50, v34, vcc
    v_cndmask_b32 v35, v51, v35, vcc
    ds_write_b128 v164, v[32:35]
    v_cndmask_b32 v36, v52, v36, vcc
    v_cndmask_b32 v37, v53, v37, vcc
    v_cndmask_b32 v38, v54, v38, vcc
    v_cndmask_b32 v39, v55, v39, vcc
    v_xor_b32 v4, 32, v164
    ds_write_b128 v4, v[36:39]
    v_cndmask_b32 v40, v56, v40, vcc
    v_cndmask_b32 v41, v57, v41, vcc
    v_cndmask_b32 v42, v58, v42, vcc
    v_cndmask_b32 v43, v59, v43, vcc
    v_xor_b32 v4, 64, v164
    ds_write_b128 v4, v[40:43]
    v_cndmask_b32 v44, v60, v44, vcc
    v_cndmask_b32 v45, v61, v45, vcc
    v_cndmask_b32 v46, v62, v46, vcc
    v_cndmask_b32 v47, v63, v47, vcc
    v_xor_b32 v4, 96, v164
    ds_write_b128 v4, v[44:47]
    v_mov_b32 v4, 1
    s_mov_b64 exec, 1
    ds_write_b32 v10, v4 offset:16
    s_mov_b64 exec, -1
    ds_read_b32 v12, v13
FW_43:
    s_waitcnt lgkmcnt(0)
    v_cmp_gt_u32 vcc, 1, v12
    s_cbranch_vccz FO_44
    s_sleep 1
    ds_read_b32 v12, v13
    s_branch FW_43
FO_44:
    ds_read_b128 v[72:75], v165 offset:0
    ds_read_b128 v[76:79], v165 offset:4096
    ds_read_b128 v[80:83], v165 offset:8192
    ds_read_b128 v[84:87], v165 offset:12288
    s_waitcnt lgkmcnt(0)
    v_add_f32 v72, v72, v76
    v_add_f32 v80, v80, v84
    v_add_f32 v73, v73, v77
    v_add_f32 v81, v81, v85
    v_add_f32 v74, v74, v78
    v_add_f32 v82, v82, v86
    v_add_f32 v75, v75, v79
    v_add_f32 v83, v83, v87
    v_add_f32 v72, v72, v80
    v_add_f32 v73, v73, v81
    v_add_f32 v74, v74, v82
    v_add_f32 v75, v75, v83
    v_max_u32 v72, 1, v72
    v_max_u32 v74, 1, v74
    buffer_store_dwordx4 v[72:75], v2, s[12:15], s77 offen sc0 sc1
    s_lshl_b32 s44, s38, 2
    s_add_u32 s44, s44, s3
    s_mul_i32 s44, s44, 64
    s_add_u32 s44, s44, 241664
    v_mov_b32 v4, 1
    s_mov_b64 exec, 1
    buffer_atomic_add v4, v8, s[24:27], s44 offen
    s_mov_b64 exec, -1
F_adown:
    v_mov_b32 v4, 2
    s_mov_b64 exec, 1
    ds_write_b32 v10, v4 offset:16
    s_mov_b64 exec, -1
    s_mul_i32 s36, s28, 112
    s_mul_i32 s37, s3, 28
    s_add_u32 s36, s36, s37
    v_min_u32 v4, 55, v0
    v_lshlrev_b32 v4, 4, v4
    s_lshl_b32 s38, s36, 5
    s_lshr_b32 s44, s36, 5
    s_mul_i32 s44, s44, 64
    s_add_u32 s45, s36, 27
    s_lshr_b32 s45, s45, 5
    s_mul_i32 s45, s45, 64
    s_add_u32 s56, s44, 0x83b000
    s_add_u32 s56, s72, s56
    s_addc_u32 s57, s73, 0
    s_add_u32 s58, s45, 0x83b000
    s_add_u32 s58, s72, s58
    s_addc_u32 s59, s73, 0
    v_mov_b32 v156, 0
    v_mov_b32 v157, 0
    v_mov_b32 v158, 0
    v_mov_b32 v159, 0
    s_mov_b32 s48, 0xbfb8aa3b
    ds_read_b32 v12, v163
FW_45:
    s_waitcnt lgkmcnt(0)
    v_cmp_gt_u32 vcc, 3, v12
    s_cbranch_vccz FO_46
    s_sleep 2
    ds_read_b32 v12, v163
    s_branch FW_45
FO_46:
    s_add_u32 s44, s88, 32768
    v_lshlrev_b32 v9, 3, v0
    v_add_u32 v9, s44, v9
    ds_write_b64 v9, v[156:157]
    v_lshrrev_b32 v11, 1, v0
    v_mul_u32_u24 v9, 37, v11
    v_lshrrev_b32 v9, 8, v9
    v_add_u32 v11, v11, v9
    v_lshlrev_b32 v11, 1, v11
    v_and_b32 v9, 1, v0
    v_lshl_add_u32 v11, v9, 8, v11
    v_add_u32 v11, s44, v11
    v_and_b32 v9, 7, v0
    v_lshlrev_b32 v9, 6, v9
    v_lshl_add_u32 v9, v5, 4, v9
    v_add_u32 v9, s44, v9
    s_waitcnt vmcnt(2)
    s_cmp_lt_u32 s2, 224
    s_cbranch_scc1 F_dp
    s_waitcnt vmcnt(0)
F_dp:
    v_perm_b32 v72, v20, v16, s52
    v_perm_b32 v73, v28, v24, s52
    v_perm_b32 v74, v148, v144, s52
    v_perm_b32 v75, v156, v152, s52
    v_perm_b32 v76, v20, v16, s53
    v_perm_b32 v77, v28, v24, s53
    v_perm_b32 v78, v148, v144, s53
    v_perm_b32 v79, v156, v152, s53
    v_perm_b32 v80, v21, v17, s52
    v_perm_b32 v81, v29, v25, s52
    v_perm_b32 v82, v149, v145, s52
    v_perm_b32 v83, v157, v153, s52
    v_perm_b32 v84, v21, v17, s53
    v_perm_b32 v85, v29, v25, s53
    v_perm_b32 v86, v149, v145, s53
    v_perm_b32 v87, v157, v153, s53
    v_perm_b32 v88, v22, v18, s52
    v_perm_b32 v89, v30, v26, s52
    v_perm_b32 v90, v150, v146, s52
    v_perm_b32 v91, v158, v154, s52
    v_perm_b32 v92, v22, v18, s53
    v_perm_b32 v93, v30, v26, s53
    v_perm_b32 v94, v150, v146, s53
    v_perm_b32 v95, v158, v154, s53
    v_perm_b32 v96, v23, v19, s52
    v_perm_b32 v97, v31, v27, s52
    v_perm_b32 v98, v151, v147, s52
    v_perm_b32 v99, v159, v155, s52
    v_perm_b32 v100, v23, v19, s53
    v_perm_b32 v101, v31, v27, s53
    v_perm_b32 v102, v151, v147, s53
    v_perm_b32 v103, v159, v155, s53
    v_and_b32 v14, 1, v5
    v_lshlrev_b32 v14, 11, v14
    v_lshl_add_u32 v14, v7, 5, v14
    v_lshrrev_b32 v15, 1, v5
    v_lshl_add_u32 v14, v15, 4, v14
    v_add_u32 v14, s44, v14
    s_lshl_b32 s45, s3, 10
    s_add_u32 s45, s45, 32768
    v_add_u32 v15, s45, v3
    v_add_u32 v13, 48, v13
    v_and_b32 v17, 31, v0
    v_lshlrev_b32 v17, 4, v17
SP_47:
    s_load_dword s74, s[56:57], 0 glc
    s_load_dword s75, s[58:59], 0 glc
    s_waitcnt lgkmcnt(0)
    s_min_u32 s74, s74, s75
    s_cmp_ge_u32 s74, 8
    s_cbranch_scc1 SD_48
    s_sleep 16
    s_branch SP_47
SD_48:
F_dl:
    s_add_u32 s45, s38, 0
    buffer_load_dwordx4 v[32:35], v4, s[12:15], s45 offen sc0 sc1
    s_add_u32 s45, s38, 114688
    buffer_load_dwordx4 v[36:39], v4, s[12:15], s45 offen sc0 sc1
    s_add_u32 s45, s38, 229376
    buffer_load_dwordx4 v[40:43], v4, s[12:15], s45 offen sc0 sc1
    s_add_u32 s45, s38, 344064
    buffer_load_dwordx4 v[44:47], v4, s[12:15], s45 offen sc0 sc1
    s_add_u32 s45, s38, 458752
    buffer_load_dwordx4 v[48:51], v4, s[12:15], s45 offen sc0 sc1
    s_add_u32 s45, s38, 573440
    buffer_load_dwordx4 v[52:55], v4, s[12:15], s45 offen sc0 sc1
    s_add_u32 s45, s38, 688128
    buffer_load_dwordx4 v[56:59], v4, s[12:15], s45 offen sc0 sc1
    s_add_u32 s45, s38, 802816
    buffer_load_dwordx4 v[60:63], v4, s[12:15], s45 offen sc0 sc1
    s_waitcnt vmcnt(0)
    s_nop 0
    v_min3_u32 v12, v32, v34, v36
    v_min3_u32 v12, v12, v38, v40
    v_min3_u32 v12, v12, v42, v44
    v_min3_u32 v12, v12, v46, v48
    v_min3_u32 v12, v12, v50, v52
    v_min3_u32 v12, v12, v54, v56
    v_min3_u32 v12, v12, v58, v60
    v_min_u32 v12, v12, v62
    v_cmp_eq_u32 vcc, 0, v12
    s_cbranch_vccz F_dm
    s_sleep 6
    s_branch F_dl
F_dm:
    v_add_f32 v32, v32, v40
    v_add_f32 v48, v48, v56
    v_add_f32 v33, v33, v41
    v_add_f32 v49, v49, v57
    v_add_f32 v34, v34, v42
    v_add_f32 v50, v50, v58
    v_add_f32 v35, v35, v43
    v_add_f32 v51, v51, v59
    v_add_f32 v32, v32, v48
    v_add_f32 v33, v33, v49
    v_add_f32 v34, v34, v50
    v_add_f32 v35, v35, v51
    v_add_f32 v36, v36, v44
    v_add_f32 v52, v52, v60
    v_add_f32 v37, v37, v45
    v_add_f32 v53, v53, v61
    v_add_f32 v38, v38, v46
    v_add_f32 v54, v54, v62
    v_add_f32 v39, v39, v47
    v_add_f32 v55, v55, v63
    v_add_f32 v36, v36, v52
    v_add_f32 v37, v37, v53
    v_add_f32 v38, v38, v54
    v_add_f32 v39, v39, v55
    v_cvt_pk_bf16_f32 v40, v32, v36
    v_cvt_pk_bf16_f32 v41, v33, v37
    v_cvt_pk_bf16_f32 v42, v34, v38
    v_cvt_pk_bf16_f32 v43, v35, v39
    v_lshlrev_b32 v32, 16, v40
    v_and_b32 v36, 0xffff0000, v40
    v_lshlrev_b32 v33, 16, v41
    v_and_b32 v37, 0xffff0000, v41
    v_lshlrev_b32 v34, 16, v42
    v_and_b32 v38, 0xffff0000, v42
    v_lshlrev_b32 v35, 16, v43
    v_and_b32 v39, 0xffff0000, v43
    v_mul_f32 v40, s48, v32
    v_mul_f32 v41, s48, v33
    v_mul_f32 v42, s48, v34
    v_mul_f32 v43, s48, v35
    v_exp_f32 v40, v40
    v_exp_f32 v41, v41
    v_exp_f32 v42, v42
    v_exp_f32 v43, v43
    v_add_f32 v40, 1.0, v40
    v_add_f32 v41, 1.0, v41
    v_add_f32 v42, 1.0, v42
    v_add_f32 v43, 1.0, v43
    v_rcp_f32 v40, v40
    v_rcp_f32 v41, v41
    v_rcp_f32 v42, v42
    v_rcp_f32 v43, v43
    v_mul_f32 v32, v32, v40
    v_mul_f32 v33, v33, v41
    v_mul_f32 v34, v34, v42
    v_mul_f32 v35, v35, v43
    v_cvt_pk_bf16_f32 v32, v32, v32
    v_cvt_pk_bf16_f32 v33, v33, v33
    v_cvt_pk_bf16_f32 v34, v34, v34
    v_cvt_pk_bf16_f32 v35, v35, v35
    v_lshlrev_b32 v32, 16, v32
    v_lshlrev_b32 v33, 16, v33
    v_lshlrev_b32 v34, 16, v34
    v_lshlrev_b32 v35, 16, v35
    v_mul_f32 v32, v32, v36
    v_mul_f32 v33, v33, v37
    v_mul_f32 v34, v34, v38
    v_mul_f32 v35, v35, v39
    v_cvt_pk_bf16_f32 v32, v32, v32
    v_cvt_pk_bf16_f32 v33, v33, v33
    v_cvt_pk_bf16_f32 v34, v34, v34
    v_cvt_pk_bf16_f32 v35, v35, v35
    v_cmp_gt_u32 vcc, 56, v0
    s_nop 0
    s_and_saveexec_b64 s[50:51], vcc
    ds_write_b16 v11, v32 offset:0
    ds_write_b16 v11, v33 offset:64
    ds_write_b16 v11, v34 offset:128
    ds_write_b16 v11, v35 offset:192
    s_mov_b64 exec, s[50:51]
    ds_read_b128 v[64:67], v9
    s_waitcnt lgkmcnt(0)
    v_mfma_f32_16x16x32_bf16 v[104:107], v[64:67], v[72:75], 0
    v_mfma_f32_16x16x32_bf16 v[108:111], v[64:67], v[76:79], 0
    v_mfma_f32_16x16x32_bf16 v[112:115], v[64:67], v[80:83], 0
    v_mfma_f32_16x16x32_bf16 v[116:119], v[64:67], v[84:87], 0
    v_mfma_f32_16x16x32_bf16 v[120:123], v[64:67], v[88:91], 0
    v_mfma_f32_16x16x32_bf16 v[124:127], v[64:67], v[92:95], 0
    v_mfma_f32_16x16x32_bf16 v[128:131], v[64:67], v[96:99], 0
    v_mfma_f32_16x16x32_bf16 v[132:135], v[64:67], v[100:103], 0
    v_cmp_gt_u32 vcc, 32, v0
    s_nop 3
    v_cndmask_b32 v32, v120, v104, vcc
    v_cndmask_b32 v33, v124, v108, vcc
    v_cndmask_b32 v34, v128, v112, vcc
    v_cndmask_b32 v35, v132, v116, vcc
    ds_write_b128 v14, v[32:35] offset:0
    v_cndmask_b32 v36, v121, v105, vcc
    v_cndmask_b32 v37, v125, v109, vcc
    v_cndmask_b32 v38, v129, v113, vcc
    v_cndmask_b32 v39, v133, v117, vcc
    ds_write_b128 v14, v[36:39] offset:512
    v_cndmask_b32 v40, v122, v106, vcc
    v_cndmask_b32 v41, v126, v110, vcc
    v_cndmask_b32 v42, v130, v114, vcc
    v_cndmask_b32 v43, v134, v118, vcc
    ds_write_b128 v14, v[40:43] offset:1024
    v_cndmask_b32 v44, v123, v107, vcc
    v_cndmask_b32 v45, v127, v111, vcc
    v_cndmask_b32 v46, v131, v115, vcc
    v_cndmask_b32 v47, v135, v119, vcc
    ds_write_b128 v14, v[44:47] offset:1536
    v_mov_b32 v4, 1
    s_mov_b64 exec, 1
    ds_write_b32 v10, v4 offset:64
    s_mov_b64 exec, -1
    s_lshl_b32 s45, s29, 7
    s_add_u32 s56, s45, 0x82a000
    s_add_u32 s56, s72, s56
    s_addc_u32 s57, s73, 0
    s_lshl_b32 s44, s3, 13
    s_lshl_b32 s50, s29, 9
    s_add_u32 s50, s50, 135168
    s_add_u32 s44, s44, s50
    s_add_u32 s45, s44, 4096
    ds_read_b32 v12, v13
FW_49:
    s_waitcnt lgkmcnt(0)
    v_cmp_gt_u32 vcc, 1, v12
    s_cbranch_vccz FO_50
    s_sleep 1
    ds_read_b32 v12, v13
    s_branch FW_49
FO_50:
    ds_read2st64_b32 v[48:49], v15 offset0:0 offset1:1
    ds_read2st64_b32 v[52:53], v15 offset0:16 offset1:17
    ds_read2st64_b32 v[56:57], v15 offset0:96 offset1:97
    ds_read2st64_b32 v[60:61], v15 offset0:112 offset1:113
    ds_read2st64_b32 v[50:51], v15 offset0:2 offset1:3
    ds_read2st64_b32 v[54:55], v15 offset0:18 offset1:19
    ds_read2st64_b32 v[58:59], v15 offset0:98 offset1:99
    ds_read2st64_b32 v[62:63], v15 offset0:114 offset1:115
    s_waitcnt lgkmcnt(4)
    v_add_f32 v48, v48, v52
    v_add_f32 v56, v56, v60
    v_add_f32 v48, v48, v56
    buffer_atomic_add_f32 v48, v3, s[24:27], s44 offen offset:0
    v_add_f32 v49, v49, v53
    v_add_f32 v57, v57, v61
    v_add_f32 v49, v49, v57
    buffer_atomic_add_f32 v49, v3, s[24:27], s44 offen offset:256
    s_waitcnt lgkmcnt(0)
    v_add_f32 v50, v50, v54
    v_add_f32 v58, v58, v62
    v_add_f32 v50, v50, v58
    buffer_atomic_add_f32 v50, v3, s[24:27], s45 offen offset:0
    v_add_f32 v51, v51, v55
    v_add_f32 v59, v59, v63
    v_add_f32 v51, v51, v59
    buffer_atomic_add_f32 v51, v3, s[24:27], s45 offen offset:256
    s_barrier
    s_barrier
    s_barrier
    s_barrier
    s_waitcnt vmcnt(0)
    s_barrier
    s_mov_b32 s47, 5
    s_cmp_lg_u32 s3, 0
    s_cbranch_scc1 F_end
    s_mov_b32 s76, 1
    s_atomic_add s76, s[56:57], 0
    s_lshl_b32 s44, s28, 6
    s_sub_u32 s44, 2047, s44
    s_movk_i32 s46, 0x7fff
    s_and_b32 s45, s60, 0x7ff
    s_sub_u32 s45, s44, s45
    s_min_u32 s46, s46, s45
    s_and_b32 s45, s61, 0x7ff
    s_sub_u32 s45, s44, s45
    s_min_u32 s46, s46, s45
    s_and_b32 s45, s62, 0x7ff
    s_sub_u32 s45, s44, s45
    s_min_u32 s46, s46, s45
    s_and_b32 s45, s63, 0x7ff
    s_sub_u32 s45, s44, s45
    s_min_u32 s46, s46, s45
    s_and_b32 s45, s64, 0x7ff
    s_sub_u32 s45, s44, s45
    s_min_u32 s46, s46, s45
    s_and_b32 s45, s65, 0x7ff
    s_sub_u32 s45, s44, s45
    s_min_u32 s46, s46, s45
    s_and_b32 s45, s66, 0x7ff
    s_sub_u32 s45, s44, s45
    s_min_u32 s46, s46, s45
    s_and_b32 s45, s67, 0x7ff
    s_sub_u32 s45, s44, s45
    s_min_u32 s46, s46, s45
    v_lshrrev_b32 v4, 5, v0
    v_lshl_add_u32 v4, v4, 12, v17
    s_barrier
    s_barrier
    s_barrier
    s_barrier
    s_barrier
    s_mov_b32 s47, 10
    s_cmp_ge_u32 s46, 64
    s_cbranch_scc1 F_end
F_y3:
    s_load_dword s58, s[56:57], 0 glc
    s_cmp_ge_u32 s47, 16
    s_cbranch_scc1 YB_51
    s_barrier
    s_add_u32 s47, s47, 1
YB_51:
    s_cmp_ge_u32 s47, 16
    s_cbranch_scc1 YB_52
    s_barrier
    s_add_u32 s47, s47, 1
YB_52:
    s_waitcnt lgkmcnt(0)
    s_cmp_lt_u32 s58, 32
    s_cbranch_scc1 F_y3
    s_mov_b32 m0, 27648
    s_nop 0
    buffer_load_dwordx4 v4, s[24:27], s50 offen sc0 sc1 lds
    s_add_u32 s50, s50, 8192
    s_add_u32 m0, m0, 1024
    s_nop 0
    buffer_load_dwordx4 v4, s[24:27], s50 offen sc0 sc1 lds
    s_add_u32 s50, s50, 8192
    s_add_u32 m0, m0, 1024
    s_nop 0
    buffer_load_dwordx4 v4, s[24:27], s50 offen sc0 sc1 lds
    s_add_u32 s50, s50, 8192
    s_add_u32 m0, m0, 1024
    s_nop 0
    buffer_load_dwordx4 v4, s[24:27], s50 offen sc0 sc1 lds
    s_add_u32 s50, s50, 8192
    s_add_u32 m0, m0, 1024
    s_cmp_ge_u32 s47, 16
    s_cbranch_scc1 YB_53
    s_barrier
    s_add_u32 s47, s47, 1
YB_53:
    s_cmp_ge_u32 s47, 16
    s_cbranch_scc1 YB_54
    s_barrier
    s_add_u32 s47, s47, 1
YB_54:
    s_cmp_ge_u32 s47, 16
    s_cbranch_scc1 YB_55
    s_barrier
    s_add_u32 s47, s47, 1
YB_55:
    s_waitcnt vmcnt(0)
    v_mov_b32 v4, 9
    s_mov_b64 exec, 1
    ds_write_b32 v10, v4 offset:96
    s_mov_b64 exec, -1
    s_endpgm
F_codeend:
.section .rodata,"a"
.p2align 6
.amdhsa_kernel parallel_sum__linear_attn_block__moe_arch_mod__prompt_kernel
  .amdhsa_next_free_vgpr 168
  .amdhsa_next_free_sgpr 96
  .amdhsa_accum_offset 168
  .amdhsa_group_segment_fixed_size 0
  .amdhsa_kernarg_size 88
  .amdhsa_user_sgpr_count 2
  .amdhsa_user_sgpr_kernarg_segment_ptr 1
  .amdhsa_system_sgpr_workgroup_id_x 1
  .amdhsa_float_denorm_mode_32 3
  .amdhsa_float_denorm_mode_16_64 3
.end_amdhsa_kernel
```

```asm
; @launch grid=(256,1,1) block=(768,1,1) lds=163840
.amdgcn_target "amdgcn-amd-amdhsa--gfx950"
.text
.globl parallel_sum__linear_attn_block__moe_arch_mod__prompt_kernel
.p2align 8
.type parallel_sum__linear_attn_block__moe_arch_mod__prompt_kernel,@function
parallel_sum__linear_attn_block__moe_arch_mod__prompt_kernel:
    s_load_dwordx4 s[4:7], s[0:1], 0
    s_load_dwordx8 s[60:67], s[0:1], 32
    s_load_dwordx2 s[72:73], s[0:1], 80
    s_load_dwordx4 s[68:71], s[0:1], 64
    s_load_dwordx2 s[8:9], s[0:1], 16
    s_cmp_ge_u32 s2, 256
    s_cbranch_scc1 F_end
    v_lshrrev_b32 v1, 6, v0
    v_and_b32 v0, 63, v0
    s_and_b32 s30, s2, 7
    v_readfirstlane_b32 s3, v1
    s_lshr_b32 s31, s2, 3
    s_and_b32 s32, s30, 1
    s_lshl_b32 s32, s32, 3
    s_and_b32 s35, s31, 7
    s_add_u32 s32, s32, s35
    s_lshr_b32 s33, s30, 1
    s_lshl_b32 s33, s33, 2
    s_lshr_b32 s34, s31, 3
    s_add_u32 s33, s33, s34
    s_lshl_b32 s28, s32, 1
    s_bfe_u32 s29, s30, 0x10001
    s_add_u32 s28, s28, s29
    s_lshl_b32 s29, s30, 2
    s_xor_b32 s29, s29, s30
    s_and_b32 s29, s29, 4
    s_add_u32 s29, s29, s34
    s_lshl_b32 s39, s29, 1
    s_xor_b32 s39, s39, 14
    s_add_u32 s10, s33, 4
    s_and_b32 s10, s10, 15
    v_lshlrev_b32 v2, 4, v0
    s_cmp_ge_u32 s3, 8
    s_cbranch_scc1 F_loader
    s_lshl_b32 s77, s32, 4
    s_add_u32 s77, s77, s33
    s_lshl_b32 s77, s77, 3
    s_add_u32 s77, s77, s3
    s_cmp_lg_u32 s3, 7
    s_cbranch_scc1 F_nt
    s_getpc_b64 s[46:47]
F_pc:
    s_sub_u32 s46, s46, F_pc-parallel_sum__linear_attn_block__moe_arch_mod__prompt_kernel
    s_subb_u32 s47, s47, 0
    s_and_b32 s44, s31, 7
    s_lshl_b32 s44, s44, 13
    v_min_u32 v60, 63, v0
    v_lshlrev_b32 v60, 7, v60
    v_add_u32 v60, s44, v60
    v_min_u32 v60, F_codeend-parallel_sum__linear_attn_block__moe_arch_mod__prompt_kernel-4, v60
    global_load_dword v161, v60, s[46:47]
F_nt:
    s_lshl_b32 s44, s77, 11
    s_waitcnt lgkmcnt(0)

    s_mov_b32 s20, s4
    s_mov_b32 s21, s5
    s_mov_b32 s22, 0x400000
    s_mov_b32 s23, 0x00020000
    buffer_load_dwordx4 v[4:7], v2, s[20:23], s44 offen
    buffer_load_dwordx4 v[8:11], v2, s[20:23], s44 offen offset:1024
    s_mov_b32 s16, s60
    s_mov_b32 s17, s61
    s_mov_b32 s18, 0x800
    s_mov_b32 s19, 0x00020000
    buffer_load_dwordx4 v[12:15], v2, s[16:19], 0 offen
    buffer_load_dwordx4 v[16:19], v2, s[16:19], 0 offen offset:1024
    s_add_u32 s24, s72, 0x800000
    s_addc_u32 s25, s73, 0
    s_mov_b32 s26, 0x100000
    s_mov_b32 s27, 0x00020000
    s_add_u32 s40, s72, 0x900000
    s_addc_u32 s41, s73, 0
    s_mov_b32 s42, 0x18000
    s_mov_b32 s43, 0x00020000
    s_mov_b32 s48, s70
    s_mov_b32 s49, s71
    s_mov_b32 s50, 0x100
    s_mov_b32 s51, 0x00020000
    v_mov_b32 v20, 0
    v_mov_b32 v21, 0
    v_mov_b32 v22, 0
    v_mov_b32 v23, 0
    s_cmp_lg_u32 s3, 5
    s_cbranch_scc1 F_a0
    s_cmp_lg_u32 s33, 0
    s_cbranch_scc1 F_a0
    s_lshl_b32 s44, s32, 8
    s_add_u32 s44, s44, 32768
    s_lshl_b32 s45, s32, 2
    s_mov_b64 exec, 0xffff
    buffer_store_dwordx4 v[20:23], v2, s[40:43], s44 offen sc0 sc1
    s_mov_b64 exec, 1
    s_waitcnt vmcnt(0)
    v_mov_b32 v24, 1
    buffer_store_dword v24, v20, s[48:51], s45 offen sc0 sc1
    s_mov_b64 exec, -1
    s_branch F_a1
F_a0:
    s_waitcnt vmcnt(0)
F_a1:

    v_lshlrev_b32 v24, 16, v4
    v_and_b32 v25, 0xffff0000, v4
    v_lshlrev_b32 v26, 16, v5
    v_and_b32 v27, 0xffff0000, v5
    v_lshlrev_b32 v28, 16, v6
    v_and_b32 v29, 0xffff0000, v6
    v_lshlrev_b32 v30, 16, v7
    v_and_b32 v31, 0xffff0000, v7
    v_lshlrev_b32 v32, 16, v8
    v_and_b32 v33, 0xffff0000, v8
    v_lshlrev_b32 v34, 16, v9
    v_and_b32 v35, 0xffff0000, v9
    v_lshlrev_b32 v36, 16, v10
    v_and_b32 v37, 0xffff0000, v10
    v_lshlrev_b32 v38, 16, v11
    v_and_b32 v39, 0xffff0000, v11
    v_add_f32 v40, v24, v25
    v_add_f32 v41, v26, v27
    v_add_f32 v42, v28, v29
    v_add_f32 v43, v30, v31
    v_add_f32 v44, v32, v33
    v_add_f32 v45, v34, v35
    v_add_f32 v46, v36, v37
    v_add_f32 v47, v38, v39
    v_add_f32 v40, v40, v44
    v_add_f32 v41, v41, v45
    v_add_f32 v42, v42, v46
    v_add_f32 v43, v43, v47
    v_add_f32 v40, v40, v42
    v_add_f32 v41, v41, v43
    v_add_f32 v40, v40, v41
    s_nop 1
    v_add_f32_dpp v40, v40, v40 row_shr:1 row_mask:0xf bank_mask:0xf bound_ctrl:0
    s_nop 1
    v_add_f32_dpp v40, v40, v40 row_shr:2 row_mask:0xf bank_mask:0xf bound_ctrl:0
    s_nop 1
    v_add_f32_dpp v40, v40, v40 row_shr:4 row_mask:0xf bank_mask:0xf bound_ctrl:0
    s_nop 1
    v_add_f32_dpp v40, v40, v40 row_shr:8 row_mask:0xf bank_mask:0xf bound_ctrl:0
    s_nop 1
    v_add_f32_dpp v40, v40, v40 row_bcast:15 row_mask:0xa bank_mask:0xf
    s_nop 1
    v_add_f32_dpp v40, v40, v40 row_bcast:31 row_mask:0xc bank_mask:0xf
    s_nop 0
    v_readlane_b32 s52, v40, 63
    v_mov_b32 v41, 0x3a800000
    s_nop 0
    v_mul_f32 v41, s52, v41
    v_sub_f32 v44, v24, v41
    v_sub_f32 v45, v25, v41
    v_sub_f32 v46, v26, v41
    v_sub_f32 v47, v27, v41
    v_sub_f32 v48, v28, v41
    v_sub_f32 v49, v29, v41
    v_sub_f32 v50, v30, v41
    v_sub_f32 v51, v31, v41
    v_sub_f32 v52, v32, v41
    v_sub_f32 v53, v33, v41
    v_sub_f32 v54, v34, v41
    v_sub_f32 v55, v35, v41
    v_sub_f32 v56, v36, v41
    v_sub_f32 v57, v37, v41
    v_sub_f32 v58, v38, v41
    v_sub_f32 v59, v39, v41
    v_mul_f32 v40, v44, v44
    v_mul_f32 v42, v45, v45
    v_fmac_f32 v40, v46, v46
    v_fmac_f32 v42, v47, v47
    v_fmac_f32 v40, v48, v48
    v_fmac_f32 v42, v49, v49
    v_fmac_f32 v40, v50, v50
    v_fmac_f32 v42, v51, v51
    v_fmac_f32 v40, v52, v52
    v_fmac_f32 v42, v53, v53
    v_fmac_f32 v40, v54, v54
    v_fmac_f32 v42, v55, v55
    v_fmac_f32 v40, v56, v56
    v_fmac_f32 v42, v57, v57
    v_fmac_f32 v40, v58, v58
    v_fmac_f32 v42, v59, v59
    v_add_f32 v40, v40, v42
    s_nop 1
    v_add_f32_dpp v40, v40, v40 row_shr:1 row_mask:0xf bank_mask:0xf bound_ctrl:0
    s_nop 1
    v_add_f32_dpp v40, v40, v40 row_shr:2 row_mask:0xf bank_mask:0xf bound_ctrl:0
    s_nop 1
    v_add_f32_dpp v40, v40, v40 row_shr:4 row_mask:0xf bank_mask:0xf bound_ctrl:0
    s_nop 1
    v_add_f32_dpp v40, v40, v40 row_shr:8 row_mask:0xf bank_mask:0xf bound_ctrl:0
    s_nop 1
    v_add_f32_dpp v40, v40, v40 row_bcast:15 row_mask:0xa bank_mask:0xf
    s_nop 1
    v_add_f32_dpp v40, v40, v40 row_bcast:31 row_mask:0xc bank_mask:0xf
    s_nop 0
    v_readlane_b32 s52, v40, 63
    v_mov_b32 v42, 0x3a800000
    s_nop 0
    v_mul_f32 v42, s52, v42
    v_cvt_pk_bf16_f32 v43, v41, v42
    v_lshlrev_b32 v41, 16, v43
    v_and_b32 v42, 0xffff0000, v43
    v_add_f32 v42, 0x3727c5ac, v42
    v_cvt_pk_bf16_f32 v42, v42, v42
    v_lshlrev_b32 v42, 16, v42
    v_sqrt_f32 v42, v42
    s_nop 0
    v_cvt_pk_bf16_f32 v42, v42, v42
    v_lshlrev_b32 v42, 16, v42
    v_rcp_f32 v42, v42
    v_sub_f32 v24, v24, v41
    v_sub_f32 v25, v25, v41
    v_sub_f32 v26, v26, v41
    v_sub_f32 v27, v27, v41
    v_sub_f32 v28, v28, v41
    v_sub_f32 v29, v29, v41
    v_sub_f32 v30, v30, v41
    v_sub_f32 v31, v31, v41
    v_sub_f32 v32, v32, v41
    v_sub_f32 v33, v33, v41
    v_sub_f32 v34, v34, v41
    v_sub_f32 v35, v35, v41
    v_sub_f32 v36, v36, v41
    v_sub_f32 v37, v37, v41
    v_sub_f32 v38, v38, v41
    v_sub_f32 v39, v39, v41
    v_cvt_pk_bf16_f32 v4, v24, v25
    v_cvt_pk_bf16_f32 v5, v26, v27
    v_cvt_pk_bf16_f32 v6, v28, v29
    v_cvt_pk_bf16_f32 v7, v30, v31
    v_cvt_pk_bf16_f32 v8, v32, v33
    v_cvt_pk_bf16_f32 v9, v34, v35
    v_cvt_pk_bf16_f32 v10, v36, v37
    v_cvt_pk_bf16_f32 v11, v38, v39
    v_lshlrev_b32 v24, 16, v4
    v_and_b32 v25, 0xffff0000, v4
    v_lshlrev_b32 v26, 16, v5
    v_and_b32 v27, 0xffff0000, v5
    v_lshlrev_b32 v28, 16, v6
    v_and_b32 v29, 0xffff0000, v6
    v_lshlrev_b32 v30, 16, v7
    v_and_b32 v31, 0xffff0000, v7
    v_lshlrev_b32 v32, 16, v8
    v_and_b32 v33, 0xffff0000, v8
    v_lshlrev_b32 v34, 16, v9
    v_and_b32 v35, 0xffff0000, v9
    v_lshlrev_b32 v36, 16, v10
    v_and_b32 v37, 0xffff0000, v10
    v_lshlrev_b32 v38, 16, v11
    v_and_b32 v39, 0xffff0000, v11
    v_mul_f32 v24, v24, v42
    v_mul_f32 v25, v25, v42
    v_mul_f32 v26, v26, v42
    v_mul_f32 v27, v27, v42
    v_mul_f32 v28, v28, v42
    v_mul_f32 v29, v29, v42
    v_mul_f32 v30, v30, v42
    v_mul_f32 v31, v31, v42
    v_mul_f32 v32, v32, v42
    v_mul_f32 v33, v33, v42
    v_mul_f32 v34, v34, v42
    v_mul_f32 v35, v35, v42
    v_mul_f32 v36, v36, v42
    v_mul_f32 v37, v37, v42
    v_mul_f32 v38, v38, v42
    v_mul_f32 v39, v39, v42
    v_cvt_pk_bf16_f32 v4, v24, v25
    v_cvt_pk_bf16_f32 v5, v26, v27
    v_cvt_pk_bf16_f32 v6, v28, v29
    v_cvt_pk_bf16_f32 v7, v30, v31
    v_cvt_pk_bf16_f32 v8, v32, v33
    v_cvt_pk_bf16_f32 v9, v34, v35
    v_cvt_pk_bf16_f32 v10, v36, v37
    v_cvt_pk_bf16_f32 v11, v38, v39
    v_mov_b32 v40, 0
    v_mov_b32 v43, 0
    v_dot2_f32_bf16 v40, v4, v12, v40
    v_dot2_f32_bf16 v43, v5, v13, v43
    v_dot2_f32_bf16 v40, v6, v14, v40
    v_dot2_f32_bf16 v43, v7, v15, v43
    v_dot2_f32_bf16 v40, v8, v16, v40
    v_dot2_f32_bf16 v43, v9, v17, v43
    v_dot2_f32_bf16 v40, v10, v18, v40
    v_dot2_f32_bf16 v43, v11, v19, v43
    s_nop 2
    v_add_f32 v40, v40, v43
    s_nop 1
    v_add_f32_dpp v40, v40, v40 row_shr:1 row_mask:0xf bank_mask:0xf bound_ctrl:0
    s_nop 1
    v_add_f32_dpp v40, v40, v40 row_shr:2 row_mask:0xf bank_mask:0xf bound_ctrl:0
    s_nop 1
    v_add_f32_dpp v40, v40, v40 row_shr:4 row_mask:0xf bank_mask:0xf bound_ctrl:0
    s_nop 1
    v_add_f32_dpp v40, v40, v40 row_shr:8 row_mask:0xf bank_mask:0xf bound_ctrl:0
    s_nop 1
    v_add_f32_dpp v40, v40, v40 row_bcast:15 row_mask:0xa bank_mask:0xf
    s_nop 1
    v_add_f32_dpp v40, v40, v40 row_bcast:31 row_mask:0xc bank_mask:0xf
    s_nop 0
    v_readlane_b32 s52, v40, 63
    s_nop 1
    v_mov_b32 v44, s52
    v_cvt_pk_bf16_f32 v44, v44, v44
    v_and_b32 v44, 0xffff0000, v44
    v_ashrrev_i32 v45, 31, v44
    v_or_b32 v45, 0x80000000, v45
    v_xor_b32 v44, v44, v45
    v_and_b32 v44, 0xffff0000, v44
    s_sub_u32 s44, 2047, s77
    v_or_b32 v44, s44, v44
    v_xor_b32 v46, 0x80000000, v41
    v_mov_b32 v47, v42
    v_mul_f32 v48, 0x3fb8aa3b, v42
    s_lshl_b32 s44, s77, 2
    s_lshl_b32 s45, s77, 4
    s_add_u32 s45, s45, 65536
    v_mov_b32 v45, 0
    s_mov_b64 exec, 1
    buffer_store_dword v44, v45, s[40:43], s44 offen sc0 sc1
    buffer_store_dwordx3 v[46:48], v45, s[40:43], s45 offen sc0 sc1
    s_mov_b64 exec, -1

    s_cmp_ge_u32 s3, 4
    s_cbranch_scc1 F_aux
    s_setprio 2
    s_lshr_b32 s36, s3, 1
    s_and_b32 s37, s3, 1
    s_lshl_b32 s38, s36, 13
    s_lshl_b32 s42, s37, 1

    v_and_b32 v1, 15, v0
    v_lshrrev_b32 v2, 4, v0
    v_lshrrev_b32 v3, 1, v1
    v_xor_b32 v3, v3, v2
    v_lshlrev_b32 v3, 4, v3
    v_lshlrev_b32 v1, 7, v1
    v_add3_u32 v4, v1, v3, s38
    v_xor_b32 v5, 64, v4
    v_add_u32 v6, 81920, v4
    v_add_u32 v7, 81920, v5
    v_bfe_u32 v1, v0, 2, 2
    v_lshl_add_u32 v3, v2, 3, v1
    v_lshrrev_b32 v1, 1, v1
    v_and_b32 v2, 1, v2
    v_lshl_add_u32 v1, v2, 1, v1
    v_xor_b32 v1, s42, v1
    v_lshlrev_b32 v1, 5, v1
    v_lshl_add_u32 v1, v3, 7, v1
    v_and_b32 v2, 3, v0
    v_lshl_add_u32 v1, v2, 3, v1

    v_add_u32 v8, 16384, v1
    v_xor_b32 v9, 32, v8
    v_add_u32 v10, 81920, v8
    v_add_u32 v11, 81920, v9
    s_mov_b32 s40, 0x3f800008
    s_mov_b32 s41, s40
    s_mov_b32 s74, 0x358637bd
    s_mov_b32 s75, s74
    s_lshl_b32 s42, s36, 8
    s_add_u32 s42, s42, 24832
    v_and_or_b32 v164, v0, 48, s42
    v_and_b32 v165, 15, v0
    s_lshl_b32 s42, s37, 7
    s_add_u32 s42, s42, 26368
    v_lshl_add_u32 v165, v165, 2, s42
    s_lshl_b32 s42, s3, 12
    s_add_u32 s42, s42, 65536
    v_lshl_add_u32 v1, v0, 4, s42
    s_lshl_b32 s42, s3, 7
    s_add_u32 s42, s42, 27136
    v_and_or_b32 v2, v0, 48, s42
    s_lshl_b32 s42, s3, 2
    s_add_u32 s42, s42, 24640
    v_mov_b32_e64 v3, s42
    s_lshl_b32 s46, s28, 6
    s_lshl_b32 s78, s10, 1
    s_add_u32 s78, s78, s37
    s_lshl_b32 s79, s32, 18
    s_lshl_b32 s80, s36, 17
    s_add_u32 s79, s79, s80
    s_lshl_b32 s80, s78, 10
    s_add_u32 s79, s79, s80
    s_lshl_b32 s45, s32, 1
    s_add_u32 s45, s45, s36
    s_mul_i32 s45, s45, 8*64
    s_add_u32 s45, s45, 225280
    s_mul_i32 s82, s78, 4224
    s_add_u32 s83, s82, 4096
    s_lshl_b32 s50, s78, 4
    s_and_b32 s44, s32, 4-1
    s_mul_i32 s44, s44, 16/4
    s_add_u32 s50, s50, s44
    s_mul_i32 s50, s50, 64

    s_add_u32 s56, s50, 0x82f000
    s_add_u32 s56, s72, s56
    s_addc_u32 s57, s73, 0
    s_add_u32 s16, s72, 0x400000
    s_addc_u32 s17, s73, 0
    s_mov_b32 s18, 0x400000
    s_mov_b32 s19, 0x00020000
    s_add_u32 s68, s45, 0x800000
    s_add_u32 s68, s72, s68
    s_addc_u32 s69, s73, 0
    s_mov_b32 s76, 1
    s_barrier
    ds_read_b128 v[12:15], v4 offset:0
    ds_read_b64_tr_b16 v[44:45], v8 offset:8192
    ds_read_b64_tr_b16 v[46:47], v8 offset:8704
    ds_read_b128 v[28:31], v5 offset:0
    ds_read_b64_tr_b16 v[48:49], v8 offset:12288
    ds_read_b64_tr_b16 v[50:51], v8 offset:12800
    ds_read_b128 v[16:19], v4 offset:2048
    ds_read_b128 v[32:35], v5 offset:2048
    ds_read_b128 v[20:23], v4 offset:4096
    ds_read_b128 v[36:39], v5 offset:4096
    ds_read_b128 v[24:27], v4 offset:6144
    ds_read_b128 v[40:43], v5 offset:6144
    ds_read_b64_tr_b16 v[52:53], v9 offset:8192
    ds_read_b64_tr_b16 v[54:55], v9 offset:8704
    s_waitcnt lgkmcnt(11)
    v_mfma_f32_16x16x32_bf16 v[100:103], v[12:15], v[44:47], 0
    ds_read_b64_tr_b16 v[56:57], v9 offset:12288
    s_waitcnt lgkmcnt(9)
    v_mfma_f32_16x16x32_bf16 v[100:103], v[28:31], v[48:51], v[100:103]
    ds_read_b64_tr_b16 v[58:59], v9 offset:12800
    s_waitcnt lgkmcnt(9)
    v_mfma_f32_16x16x32_bf16 v[104:107], v[16:19], v[44:47], 0
    ds_read_b64_tr_b16 v[60:61], v8 offset:16384
    s_waitcnt lgkmcnt(9)
    v_mfma_f32_16x16x32_bf16 v[104:107], v[32:35], v[48:51], v[104:107]
    ds_read_b64_tr_b16 v[62:63], v8 offset:16896
    s_waitcnt lgkmcnt(9)
    v_mfma_f32_16x16x32_bf16 v[108:111], v[20:23], v[44:47], 0
    ds_read_b64_tr_b16 v[64:65], v8 offset:20480
    s_waitcnt lgkmcnt(9)
    v_mfma_f32_16x16x32_bf16 v[108:111], v[36:39], v[48:51], v[108:111]
    ds_read_b64_tr_b16 v[66:67], v8 offset:20992
    s_waitcnt lgkmcnt(9)
    v_mfma_f32_16x16x32_bf16 v[112:115], v[24:27], v[44:47], 0
    ds_read_b64_tr_b16 v[44:45], v9 offset:16384
    s_waitcnt lgkmcnt(9)
    v_mfma_f32_16x16x32_bf16 v[112:115], v[40:43], v[48:51], v[112:115]
    ds_read_b64_tr_b16 v[46:47], v9 offset:16896
    s_waitcnt lgkmcnt(8)
    v_mfma_f32_16x16x32_bf16 v[116:119], v[12:15], v[52:55], 0
    ds_read_b64_tr_b16 v[48:49], v9 offset:20480
    s_waitcnt lgkmcnt(7)
    v_mfma_f32_16x16x32_bf16 v[116:119], v[28:31], v[56:59], v[116:119]
    ds_read_b64_tr_b16 v[50:51], v9 offset:20992
    v_mfma_f32_16x16x32_bf16 v[120:123], v[16:19], v[52:55], 0
    v_mfma_f32_16x16x32_bf16 v[120:123], v[32:35], v[56:59], v[120:123]
    v_mfma_f32_16x16x32_bf16 v[124:127], v[20:23], v[52:55], 0
    v_mfma_f32_16x16x32_bf16 v[124:127], v[36:39], v[56:59], v[124:127]
    v_mfma_f32_16x16x32_bf16 v[128:131], v[24:27], v[52:55], 0
    ds_read_b64_tr_b16 v[52:53], v8 offset:0
    v_mfma_f32_16x16x32_bf16 v[128:131], v[40:43], v[56:59], v[128:131]
    ds_read_b64_tr_b16 v[54:55], v8 offset:512
    s_waitcnt lgkmcnt(5)
    v_mfma_f32_16x16x32_bf16 v[132:135], v[12:15], v[60:63], 0
    ds_read_b64_tr_b16 v[56:57], v8 offset:4096
    v_mfma_f32_16x16x32_bf16 v[132:135], v[28:31], v[64:67], v[132:135]
    ds_read_b64_tr_b16 v[58:59], v8 offset:4608
    v_mfma_f32_16x16x32_bf16 v[136:139], v[16:19], v[60:63], 0
    v_mfma_f32_16x16x32_bf16 v[136:139], v[32:35], v[64:67], v[136:139]
    v_mfma_f32_16x16x32_bf16 v[140:143], v[20:23], v[60:63], 0
    v_mfma_f32_16x16x32_bf16 v[140:143], v[36:39], v[64:67], v[140:143]
    v_mfma_f32_16x16x32_bf16 v[144:147], v[24:27], v[60:63], 0
    ds_read_b64_tr_b16 v[60:61], v9 offset:0
    v_mfma_f32_16x16x32_bf16 v[144:147], v[40:43], v[64:67], v[144:147]
    ds_read_b64_tr_b16 v[62:63], v9 offset:512
    s_waitcnt lgkmcnt(5)
    v_mfma_f32_16x16x32_bf16 v[148:151], v[12:15], v[44:47], 0
    ds_read_b64_tr_b16 v[64:65], v9 offset:4096
    v_mfma_f32_16x16x32_bf16 v[148:151], v[28:31], v[48:51], v[148:151]
    ds_read_b64_tr_b16 v[66:67], v9 offset:4608
    v_mfma_f32_16x16x32_bf16 v[152:155], v[16:19], v[44:47], 0
    v_mfma_f32_16x16x32_bf16 v[152:155], v[32:35], v[48:51], v[152:155]
    v_mfma_f32_16x16x32_bf16 v[156:159], v[20:23], v[44:47], 0
    v_mfma_f32_16x16x32_bf16 v[156:159], v[36:39], v[48:51], v[156:159]
    s_waitcnt lgkmcnt(0)
    s_barrier
    v_mfma_f32_16x16x32_bf16 v[160:163], v[24:27], v[44:47], 0
    ds_read_b64_tr_b16 v[44:45], v8 offset:49152
    v_mfma_f32_16x16x32_bf16 v[160:163], v[40:43], v[48:51], v[160:163]
    ds_read_b64_tr_b16 v[46:47], v8 offset:49664
    v_mfma_f32_16x16x32_bf16 v[68:71], v[52:55], v[12:15], 0
    ds_read_b64_tr_b16 v[48:49], v8 offset:53248
    v_mfma_f32_16x16x32_bf16 v[68:71], v[56:59], v[28:31], v[68:71]
    ds_read_b64_tr_b16 v[50:51], v8 offset:53760
    v_mfma_f32_16x16x32_bf16 v[84:87], v[60:63], v[12:15], 0
    ds_read_b128 v[12:15], v4 offset:40960
    v_mfma_f32_16x16x32_bf16 v[84:87], v[64:67], v[28:31], v[84:87]
    ds_read_b128 v[28:31], v5 offset:40960
    v_mfma_f32_16x16x32_bf16 v[72:75], v[52:55], v[16:19], 0
    v_mfma_f32_16x16x32_bf16 v[72:75], v[56:59], v[32:35], v[72:75]
    v_mfma_f32_16x16x32_bf16 v[88:91], v[60:63], v[16:19], 0
    ds_read_b128 v[16:19], v4 offset:43008
    v_mfma_f32_16x16x32_bf16 v[88:91], v[64:67], v[32:35], v[88:91]
    ds_read_b128 v[32:35], v5 offset:43008
    v_mfma_f32_16x16x32_bf16 v[76:79], v[52:55], v[20:23], 0
    v_mfma_f32_16x16x32_bf16 v[76:79], v[56:59], v[36:39], v[76:79]
    v_mfma_f32_16x16x32_bf16 v[92:95], v[60:63], v[20:23], 0
    ds_read_b128 v[20:23], v4 offset:45056
    v_mfma_f32_16x16x32_bf16 v[92:95], v[64:67], v[36:39], v[92:95]
    ds_read_b128 v[36:39], v5 offset:45056
    v_mfma_f32_16x16x32_bf16 v[80:83], v[52:55], v[24:27], 0
    ds_read_b64_tr_b16 v[52:53], v9 offset:49152
    v_mfma_f32_16x16x32_bf16 v[80:83], v[56:59], v[40:43], v[80:83]
    ds_read_b64_tr_b16 v[54:55], v9 offset:49664
    v_mfma_f32_16x16x32_bf16 v[96:99], v[60:63], v[24:27], 0
    ds_read_b128 v[24:27], v4 offset:47104
    v_mfma_f32_16x16x32_bf16 v[96:99], v[64:67], v[40:43], v[96:99]
    ds_read_b128 v[40:43], v5 offset:47104
    s_waitcnt lgkmcnt(7)
    v_mfma_f32_16x16x32_bf16 v[100:103], v[12:15], v[44:47], v[100:103]
    ds_read_b64_tr_b16 v[56:57], v9 offset:53248
    v_mfma_f32_16x16x32_bf16 v[100:103], v[28:31], v[48:51], v[100:103]
    ds_read_b64_tr_b16 v[58:59], v9 offset:53760
    v_mfma_f32_16x16x32_bf16 v[104:107], v[16:19], v[44:47], v[104:107]
    ds_read_b64_tr_b16 v[60:61], v8 offset:57344
    s_waitcnt lgkmcnt(9)
    v_mfma_f32_16x16x32_bf16 v[104:107], v[32:35], v[48:51], v[104:107]
    ds_read_b64_tr_b16 v[62:63], v8 offset:57856
    s_waitcnt lgkmcnt(9)
    v_mfma_f32_16x16x32_bf16 v[108:111], v[20:23], v[44:47], v[108:111]
    ds_read_b64_tr_b16 v[64:65], v8 offset:61440
    s_waitcnt lgkmcnt(9)
    v_mfma_f32_16x16x32_bf16 v[108:111], v[36:39], v[48:51], v[108:111]
    ds_read_b64_tr_b16 v[66:67], v8 offset:61952
    s_waitcnt lgkmcnt(7)
    v_mfma_f32_16x16x32_bf16 v[112:115], v[24:27], v[44:47], v[112:115]
    ds_read_b64_tr_b16 v[44:45], v9 offset:57344
    s_waitcnt lgkmcnt(7)
    v_mfma_f32_16x16x32_bf16 v[112:115], v[40:43], v[48:51], v[112:115]
    ds_read_b64_tr_b16 v[46:47], v9 offset:57856
    v_mfma_f32_16x16x32_bf16 v[116:119], v[12:15], v[52:55], v[116:119]
    ds_read_b64_tr_b16 v[48:49], v9 offset:61440
    s_waitcnt lgkmcnt(7)
    v_mfma_f32_16x16x32_bf16 v[116:119], v[28:31], v[56:59], v[116:119]
    ds_read_b64_tr_b16 v[50:51], v9 offset:61952
    v_mfma_f32_16x16x32_bf16 v[120:123], v[16:19], v[52:55], v[120:123]
    v_mfma_f32_16x16x32_bf16 v[120:123], v[32:35], v[56:59], v[120:123]
    v_mfma_f32_16x16x32_bf16 v[124:127], v[20:23], v[52:55], v[124:127]
    v_mfma_f32_16x16x32_bf16 v[124:127], v[36:39], v[56:59], v[124:127]
    v_mfma_f32_16x16x32_bf16 v[128:131], v[24:27], v[52:55], v[128:131]
    ds_read_b64_tr_b16 v[52:53], v8 offset:40960
    v_mfma_f32_16x16x32_bf16 v[128:131], v[40:43], v[56:59], v[128:131]
    ds_read_b64_tr_b16 v[54:55], v8 offset:41472
    s_waitcnt lgkmcnt(5)
    v_mfma_f32_16x16x32_bf16 v[132:135], v[12:15], v[60:63], v[132:135]
    ds_read_b64_tr_b16 v[56:57], v8 offset:45056
    v_mfma_f32_16x16x32_bf16 v[132:135], v[28:31], v[64:67], v[132:135]
    ds_read_b64_tr_b16 v[58:59], v8 offset:45568
    v_mfma_f32_16x16x32_bf16 v[136:139], v[16:19], v[60:63], v[136:139]
    v_mfma_f32_16x16x32_bf16 v[136:139], v[32:35], v[64:67], v[136:139]
    v_mfma_f32_16x16x32_bf16 v[140:143], v[20:23], v[60:63], v[140:143]
    v_mfma_f32_16x16x32_bf16 v[140:143], v[36:39], v[64:67], v[140:143]
    v_mfma_f32_16x16x32_bf16 v[144:147], v[24:27], v[60:63], v[144:147]
    ds_read_b64_tr_b16 v[60:61], v9 offset:40960
    v_mfma_f32_16x16x32_bf16 v[144:147], v[40:43], v[64:67], v[144:147]
    ds_read_b64_tr_b16 v[62:63], v9 offset:41472
    s_waitcnt lgkmcnt(5)
    v_mfma_f32_16x16x32_bf16 v[148:151], v[12:15], v[44:47], v[148:151]
    ds_read_b64_tr_b16 v[64:65], v9 offset:45056
    v_mfma_f32_16x16x32_bf16 v[148:151], v[28:31], v[48:51], v[148:151]
    ds_read_b64_tr_b16 v[66:67], v9 offset:45568
    v_mfma_f32_16x16x32_bf16 v[152:155], v[16:19], v[44:47], v[152:155]
    v_mfma_f32_16x16x32_bf16 v[152:155], v[32:35], v[48:51], v[152:155]
    v_mfma_f32_16x16x32_bf16 v[156:159], v[20:23], v[44:47], v[156:159]
    v_mfma_f32_16x16x32_bf16 v[156:159], v[36:39], v[48:51], v[156:159]
    s_waitcnt lgkmcnt(0)
    s_waitcnt vmcnt(0)
    s_barrier
    v_mfma_f32_16x16x32_bf16 v[160:163], v[24:27], v[44:47], v[160:163]
    ds_read_b64_tr_b16 v[44:45], v10 offset:8192
    v_mfma_f32_16x16x32_bf16 v[160:163], v[40:43], v[48:51], v[160:163]
    ds_read_b64_tr_b16 v[46:47], v10 offset:8704
    v_mfma_f32_16x16x32_bf16 v[68:71], v[52:55], v[12:15], v[68:71]
    ds_read_b64_tr_b16 v[48:49], v10 offset:12288
    v_mfma_f32_16x16x32_bf16 v[68:71], v[56:59], v[28:31], v[68:71]
    ds_read_b64_tr_b16 v[50:51], v10 offset:12800
    v_mfma_f32_16x16x32_bf16 v[84:87], v[60:63], v[12:15], v[84:87]
    ds_read_b128 v[12:15], v6 offset:0
    v_mfma_f32_16x16x32_bf16 v[84:87], v[64:67], v[28:31], v[84:87]
    ds_read_b128 v[28:31], v7 offset:0
    v_mfma_f32_16x16x32_bf16 v[72:75], v[52:55], v[16:19], v[72:75]
    v_mfma_f32_16x16x32_bf16 v[72:75], v[56:59], v[32:35], v[72:75]
    v_mfma_f32_16x16x32_bf16 v[88:91], v[60:63], v[16:19], v[88:91]
    ds_read_b128 v[16:19], v6 offset:2048
    v_mfma_f32_16x16x32_bf16 v[88:91], v[64:67], v[32:35], v[88:91]
    ds_read_b128 v[32:35], v7 offset:2048
    v_mfma_f32_16x16x32_bf16 v[76:79], v[52:55], v[20:23], v[76:79]
    v_mfma_f32_16x16x32_bf16 v[76:79], v[56:59], v[36:39], v[76:79]
    v_mfma_f32_16x16x32_bf16 v[92:95], v[60:63], v[20:23], v[92:95]
    ds_read_b128 v[20:23], v6 offset:4096
    v_mfma_f32_16x16x32_bf16 v[92:95], v[64:67], v[36:39], v[92:95]
    ds_read_b128 v[36:39], v7 offset:4096
    v_mfma_f32_16x16x32_bf16 v[80:83], v[52:55], v[24:27], v[80:83]
    ds_read_b64_tr_b16 v[52:53], v11 offset:8192
    v_mfma_f32_16x16x32_bf16 v[80:83], v[56:59], v[40:43], v[80:83]
    ds_read_b64_tr_b16 v[54:55], v11 offset:8704
    v_mfma_f32_16x16x32_bf16 v[96:99], v[60:63], v[24:27], v[96:99]
    ds_read_b128 v[24:27], v6 offset:6144
    v_mfma_f32_16x16x32_bf16 v[96:99], v[64:67], v[40:43], v[96:99]
    ds_read_b128 v[40:43], v7 offset:6144
    v_swap_b32 v4, v6
    v_swap_b32 v5, v7
    v_swap_b32 v8, v10
    v_swap_b32 v9, v11
    s_mov_b32 s81, 5
F_p1:
    s_waitcnt lgkmcnt(7)
    v_mfma_f32_16x16x32_bf16 v[100:103], v[12:15], v[44:47], v[100:103]
    ds_read_b64_tr_b16 v[56:57], v9 offset:12288
    v_mfma_f32_16x16x32_bf16 v[100:103], v[28:31], v[48:51], v[100:103]
    ds_read_b64_tr_b16 v[58:59], v9 offset:12800
    v_mfma_f32_16x16x32_bf16 v[104:107], v[16:19], v[44:47], v[104:107]
    ds_read_b64_tr_b16 v[60:61], v8 offset:16384
    s_waitcnt lgkmcnt(9)
    v_mfma_f32_16x16x32_bf16 v[104:107], v[32:35], v[48:51], v[104:107]
    ds_read_b64_tr_b16 v[62:63], v8 offset:16896
    s_waitcnt lgkmcnt(9)
    v_mfma_f32_16x16x32_bf16 v[108:111], v[20:23], v[44:47], v[108:111]
    ds_read_b64_tr_b16 v[64:65], v8 offset:20480
    s_waitcnt lgkmcnt(9)
    v_mfma_f32_16x16x32_bf16 v[108:111], v[36:39], v[48:51], v[108:111]
    ds_read_b64_tr_b16 v[66:67], v8 offset:20992
    s_waitcnt lgkmcnt(7)
    v_mfma_f32_16x16x32_bf16 v[112:115], v[24:27], v[44:47], v[112:115]
    ds_read_b64_tr_b16 v[44:45], v9 offset:16384
    s_waitcnt lgkmcnt(7)
    v_mfma_f32_16x16x32_bf16 v[112:115], v[40:43], v[48:51], v[112:115]
    ds_read_b64_tr_b16 v[46:47], v9 offset:16896
    v_mfma_f32_16x16x32_bf16 v[116:119], v[12:15], v[52:55], v[116:119]
    ds_read_b64_tr_b16 v[48:49], v9 offset:20480
    s_waitcnt lgkmcnt(7)
    v_mfma_f32_16x16x32_bf16 v[116:119], v[28:31], v[56:59], v[116:119]
    ds_read_b64_tr_b16 v[50:51], v9 offset:20992
    v_mfma_f32_16x16x32_bf16 v[120:123], v[16:19], v[52:55], v[120:123]
    v_mfma_f32_16x16x32_bf16 v[120:123], v[32:35], v[56:59], v[120:123]
    v_mfma_f32_16x16x32_bf16 v[124:127], v[20:23], v[52:55], v[124:127]
    v_mfma_f32_16x16x32_bf16 v[124:127], v[36:39], v[56:59], v[124:127]
    v_mfma_f32_16x16x32_bf16 v[128:131], v[24:27], v[52:55], v[128:131]
    ds_read_b64_tr_b16 v[52:53], v8 offset:0
    v_mfma_f32_16x16x32_bf16 v[128:131], v[40:43], v[56:59], v[128:131]
    ds_read_b64_tr_b16 v[54:55], v8 offset:512
    s_waitcnt lgkmcnt(5)
    v_mfma_f32_16x16x32_bf16 v[132:135], v[12:15], v[60:63], v[132:135]
    ds_read_b64_tr_b16 v[56:57], v8 offset:4096
    v_mfma_f32_16x16x32_bf16 v[132:135], v[28:31], v[64:67], v[132:135]
    ds_read_b64_tr_b16 v[58:59], v8 offset:4608
    v_mfma_f32_16x16x32_bf16 v[136:139], v[16:19], v[60:63], v[136:139]
    v_mfma_f32_16x16x32_bf16 v[136:139], v[32:35], v[64:67], v[136:139]
    v_mfma_f32_16x16x32_bf16 v[140:143], v[20:23], v[60:63], v[140:143]
    v_mfma_f32_16x16x32_bf16 v[140:143], v[36:39], v[64:67], v[140:143]
    v_mfma_f32_16x16x32_bf16 v[144:147], v[24:27], v[60:63], v[144:147]
    ds_read_b64_tr_b16 v[60:61], v9 offset:0
    v_mfma_f32_16x16x32_bf16 v[144:147], v[40:43], v[64:67], v[144:147]
    ds_read_b64_tr_b16 v[62:63], v9 offset:512
    s_waitcnt lgkmcnt(5)
    v_mfma_f32_16x16x32_bf16 v[148:151], v[12:15], v[44:47], v[148:151]
    ds_read_b64_tr_b16 v[64:65], v9 offset:4096
    v_mfma_f32_16x16x32_bf16 v[148:151], v[28:31], v[48:51], v[148:151]
    ds_read_b64_tr_b16 v[66:67], v9 offset:4608
    v_mfma_f32_16x16x32_bf16 v[152:155], v[16:19], v[44:47], v[152:155]
    v_mfma_f32_16x16x32_bf16 v[152:155], v[32:35], v[48:51], v[152:155]
    v_mfma_f32_16x16x32_bf16 v[156:159], v[20:23], v[44:47], v[156:159]
    v_mfma_f32_16x16x32_bf16 v[156:159], v[36:39], v[48:51], v[156:159]
    s_waitcnt lgkmcnt(0)
    s_barrier
    v_mfma_f32_16x16x32_bf16 v[160:163], v[24:27], v[44:47], v[160:163]
    ds_read_b64_tr_b16 v[44:45], v8 offset:49152
    v_mfma_f32_16x16x32_bf16 v[160:163], v[40:43], v[48:51], v[160:163]
    ds_read_b64_tr_b16 v[46:47], v8 offset:49664
    v_mfma_f32_16x16x32_bf16 v[68:71], v[52:55], v[12:15], v[68:71]
    ds_read_b64_tr_b16 v[48:49], v8 offset:53248
    v_mfma_f32_16x16x32_bf16 v[68:71], v[56:59], v[28:31], v[68:71]
    ds_read_b64_tr_b16 v[50:51], v8 offset:53760
    v_mfma_f32_16x16x32_bf16 v[84:87], v[60:63], v[12:15], v[84:87]
    ds_read_b128 v[12:15], v4 offset:40960
    v_mfma_f32_16x16x32_bf16 v[84:87], v[64:67], v[28:31], v[84:87]
    ds_read_b128 v[28:31], v5 offset:40960
    v_mfma_f32_16x16x32_bf16 v[72:75], v[52:55], v[16:19], v[72:75]
    v_mfma_f32_16x16x32_bf16 v[72:75], v[56:59], v[32:35], v[72:75]
    v_mfma_f32_16x16x32_bf16 v[88:91], v[60:63], v[16:19], v[88:91]
    ds_read_b128 v[16:19], v4 offset:43008
    v_mfma_f32_16x16x32_bf16 v[88:91], v[64:67], v[32:35], v[88:91]
    ds_read_b128 v[32:35], v5 offset:43008
    v_mfma_f32_16x16x32_bf16 v[76:79], v[52:55], v[20:23], v[76:79]
    v_mfma_f32_16x16x32_bf16 v[76:79], v[56:59], v[36:39], v[76:79]
    v_mfma_f32_16x16x32_bf16 v[92:95], v[60:63], v[20:23], v[92:95]
    ds_read_b128 v[20:23], v4 offset:45056
    v_mfma_f32_16x16x32_bf16 v[92:95], v[64:67], v[36:39], v[92:95]
    ds_read_b128 v[36:39], v5 offset:45056
    v_mfma_f32_16x16x32_bf16 v[80:83], v[52:55], v[24:27], v[80:83]
    ds_read_b64_tr_b16 v[52:53], v9 offset:49152
    v_mfma_f32_16x16x32_bf16 v[80:83], v[56:59], v[40:43], v[80:83]
    ds_read_b64_tr_b16 v[54:55], v9 offset:49664
    v_mfma_f32_16x16x32_bf16 v[96:99], v[60:63], v[24:27], v[96:99]
    ds_read_b128 v[24:27], v4 offset:47104
    v_mfma_f32_16x16x32_bf16 v[96:99], v[64:67], v[40:43], v[96:99]
    ds_read_b128 v[40:43], v5 offset:47104
    s_waitcnt lgkmcnt(7)
    v_mfma_f32_16x16x32_bf16 v[100:103], v[12:15], v[44:47], v[100:103]
    ds_read_b64_tr_b16 v[56:57], v9 offset:53248
    v_mfma_f32_16x16x32_bf16 v[100:103], v[28:31], v[48:51], v[100:103]
    ds_read_b64_tr_b16 v[58:59], v9 offset:53760
    v_mfma_f32_16x16x32_bf16 v[104:107], v[16:19], v[44:47], v[104:107]
    ds_read_b64_tr_b16 v[60:61], v8 offset:57344
    s_waitcnt lgkmcnt(9)
    v_mfma_f32_16x16x32_bf16 v[104:107], v[32:35], v[48:51], v[104:107]
    ds_read_b64_tr_b16 v[62:63], v8 offset:57856
    s_waitcnt lgkmcnt(9)
    v_mfma_f32_16x16x32_bf16 v[108:111], v[20:23], v[44:47], v[108:111]
    ds_read_b64_tr_b16 v[64:65], v8 offset:61440
    s_waitcnt lgkmcnt(9)
    v_mfma_f32_16x16x32_bf16 v[108:111], v[36:39], v[48:51], v[108:111]
    ds_read_b64_tr_b16 v[66:67], v8 offset:61952
    s_waitcnt lgkmcnt(7)
    v_mfma_f32_16x16x32_bf16 v[112:115], v[24:27], v[44:47], v[112:115]
    ds_read_b64_tr_b16 v[44:45], v9 offset:57344
    s_waitcnt lgkmcnt(7)
    v_mfma_f32_16x16x32_bf16 v[112:115], v[40:43], v[48:51], v[112:115]
    ds_read_b64_tr_b16 v[46:47], v9 offset:57856
    v_mfma_f32_16x16x32_bf16 v[116:119], v[12:15], v[52:55], v[116:119]
    ds_read_b64_tr_b16 v[48:49], v9 offset:61440
    s_waitcnt lgkmcnt(7)
    v_mfma_f32_16x16x32_bf16 v[116:119], v[28:31], v[56:59], v[116:119]
    ds_read_b64_tr_b16 v[50:51], v9 offset:61952
    v_mfma_f32_16x16x32_bf16 v[120:123], v[16:19], v[52:55], v[120:123]
    v_mfma_f32_16x16x32_bf16 v[120:123], v[32:35], v[56:59], v[120:123]
    v_mfma_f32_16x16x32_bf16 v[124:127], v[20:23], v[52:55], v[124:127]
    v_mfma_f32_16x16x32_bf16 v[124:127], v[36:39], v[56:59], v[124:127]
    v_mfma_f32_16x16x32_bf16 v[128:131], v[24:27], v[52:55], v[128:131]
    ds_read_b64_tr_b16 v[52:53], v8 offset:40960
    v_mfma_f32_16x16x32_bf16 v[128:131], v[40:43], v[56:59], v[128:131]
    ds_read_b64_tr_b16 v[54:55], v8 offset:41472
    s_waitcnt lgkmcnt(5)
    v_mfma_f32_16x16x32_bf16 v[132:135], v[12:15], v[60:63], v[132:135]
    ds_read_b64_tr_b16 v[56:57], v8 offset:45056
    v_mfma_f32_16x16x32_bf16 v[132:135], v[28:31], v[64:67], v[132:135]
    ds_read_b64_tr_b16 v[58:59], v8 offset:45568
    v_mfma_f32_16x16x32_bf16 v[136:139], v[16:19], v[60:63], v[136:139]
    v_mfma_f32_16x16x32_bf16 v[136:139], v[32:35], v[64:67], v[136:139]
    v_mfma_f32_16x16x32_bf16 v[140:143], v[20:23], v[60:63], v[140:143]
    v_mfma_f32_16x16x32_bf16 v[140:143], v[36:39], v[64:67], v[140:143]
    v_mfma_f32_16x16x32_bf16 v[144:147], v[24:27], v[60:63], v[144:147]
    ds_read_b64_tr_b16 v[60:61], v9 offset:40960
    v_mfma_f32_16x16x32_bf16 v[144:147], v[40:43], v[64:67], v[144:147]
    ds_read_b64_tr_b16 v[62:63], v9 offset:41472
    s_waitcnt lgkmcnt(5)
    v_mfma_f32_16x16x32_bf16 v[148:151], v[12:15], v[44:47], v[148:151]
    ds_read_b64_tr_b16 v[64:65], v9 offset:45056
    v_mfma_f32_16x16x32_bf16 v[148:151], v[28:31], v[48:51], v[148:151]
    ds_read_b64_tr_b16 v[66:67], v9 offset:45568
    v_mfma_f32_16x16x32_bf16 v[152:155], v[16:19], v[44:47], v[152:155]
    v_mfma_f32_16x16x32_bf16 v[152:155], v[32:35], v[48:51], v[152:155]
    v_mfma_f32_16x16x32_bf16 v[156:159], v[20:23], v[44:47], v[156:159]
    v_mfma_f32_16x16x32_bf16 v[156:159], v[36:39], v[48:51], v[156:159]
    s_waitcnt lgkmcnt(0)
    s_barrier
    v_mfma_f32_16x16x32_bf16 v[160:163], v[24:27], v[44:47], v[160:163]
    ds_read_b64_tr_b16 v[44:45], v10 offset:8192
    v_mfma_f32_16x16x32_bf16 v[160:163], v[40:43], v[48:51], v[160:163]
    ds_read_b64_tr_b16 v[46:47], v10 offset:8704
    v_mfma_f32_16x16x32_bf16 v[68:71], v[52:55], v[12:15], v[68:71]
    ds_read_b64_tr_b16 v[48:49], v10 offset:12288
    v_mfma_f32_16x16x32_bf16 v[68:71], v[56:59], v[28:31], v[68:71]
    ds_read_b64_tr_b16 v[50:51], v10 offset:12800
    v_mfma_f32_16x16x32_bf16 v[84:87], v[60:63], v[12:15], v[84:87]
    ds_read_b128 v[12:15], v6 offset:0
    v_mfma_f32_16x16x32_bf16 v[84:87], v[64:67], v[28:31], v[84:87]
    ds_read_b128 v[28:31], v7 offset:0
    v_mfma_f32_16x16x32_bf16 v[72:75], v[52:55], v[16:19], v[72:75]
    v_mfma_f32_16x16x32_bf16 v[72:75], v[56:59], v[32:35], v[72:75]
    v_mfma_f32_16x16x32_bf16 v[88:91], v[60:63], v[16:19], v[88:91]
    ds_read_b128 v[16:19], v6 offset:2048
    v_mfma_f32_16x16x32_bf16 v[88:91], v[64:67], v[32:35], v[88:91]
    ds_read_b128 v[32:35], v7 offset:2048
    v_mfma_f32_16x16x32_bf16 v[76:79], v[52:55], v[20:23], v[76:79]
    v_mfma_f32_16x16x32_bf16 v[76:79], v[56:59], v[36:39], v[76:79]
    v_mfma_f32_16x16x32_bf16 v[92:95], v[60:63], v[20:23], v[92:95]
    ds_read_b128 v[20:23], v6 offset:4096
    v_mfma_f32_16x16x32_bf16 v[92:95], v[64:67], v[36:39], v[92:95]
    ds_read_b128 v[36:39], v7 offset:4096
    v_mfma_f32_16x16x32_bf16 v[80:83], v[52:55], v[24:27], v[80:83]
    ds_read_b64_tr_b16 v[52:53], v11 offset:8192
    v_mfma_f32_16x16x32_bf16 v[80:83], v[56:59], v[40:43], v[80:83]
    ds_read_b64_tr_b16 v[54:55], v11 offset:8704
    v_mfma_f32_16x16x32_bf16 v[96:99], v[60:63], v[24:27], v[96:99]
    ds_read_b128 v[24:27], v6 offset:6144
    v_mfma_f32_16x16x32_bf16 v[96:99], v[64:67], v[40:43], v[96:99]
    ds_read_b128 v[40:43], v7 offset:6144
    v_swap_b32 v4, v6
    v_swap_b32 v5, v7
    v_swap_b32 v8, v10
    v_swap_b32 v9, v11
    s_sub_u32 s81, s81, 1
    s_cmp_lg_u32 s81, 0
    s_cbranch_scc1 F_p1
    s_waitcnt lgkmcnt(7)
    v_mfma_f32_16x16x32_bf16 v[100:103], v[12:15], v[44:47], v[100:103]
    ds_read_b64_tr_b16 v[56:57], v9 offset:12288
    v_mfma_f32_16x16x32_bf16 v[100:103], v[28:31], v[48:51], v[100:103]
    ds_read_b64_tr_b16 v[58:59], v9 offset:12800
    v_mfma_f32_16x16x32_bf16 v[104:107], v[16:19], v[44:47], v[104:107]
    ds_read_b64_tr_b16 v[60:61], v8 offset:16384
    s_waitcnt lgkmcnt(9)
    v_mfma_f32_16x16x32_bf16 v[104:107], v[32:35], v[48:51], v[104:107]
    ds_read_b64_tr_b16 v[62:63], v8 offset:16896
    s_waitcnt lgkmcnt(9)
    v_mfma_f32_16x16x32_bf16 v[108:111], v[20:23], v[44:47], v[108:111]
    ds_read_b64_tr_b16 v[64:65], v8 offset:20480
    s_waitcnt lgkmcnt(9)
    v_mfma_f32_16x16x32_bf16 v[108:111], v[36:39], v[48:51], v[108:111]
    ds_read_b64_tr_b16 v[66:67], v8 offset:20992
    s_waitcnt lgkmcnt(7)
    v_mfma_f32_16x16x32_bf16 v[112:115], v[24:27], v[44:47], v[112:115]
    ds_read_b64_tr_b16 v[44:45], v9 offset:16384
    s_waitcnt lgkmcnt(7)
    v_mfma_f32_16x16x32_bf16 v[112:115], v[40:43], v[48:51], v[112:115]
    ds_read_b64_tr_b16 v[46:47], v9 offset:16896
    v_mfma_f32_16x16x32_bf16 v[116:119], v[12:15], v[52:55], v[116:119]
    ds_read_b64_tr_b16 v[48:49], v9 offset:20480
    s_waitcnt lgkmcnt(7)
    v_mfma_f32_16x16x32_bf16 v[116:119], v[28:31], v[56:59], v[116:119]
    ds_read_b64_tr_b16 v[50:51], v9 offset:20992
    v_mfma_f32_16x16x32_bf16 v[120:123], v[16:19], v[52:55], v[120:123]
    v_mfma_f32_16x16x32_bf16 v[120:123], v[32:35], v[56:59], v[120:123]
    v_mfma_f32_16x16x32_bf16 v[124:127], v[20:23], v[52:55], v[124:127]
    v_mfma_f32_16x16x32_bf16 v[124:127], v[36:39], v[56:59], v[124:127]
    s_waitcnt lgkmcnt(0)
    s_barrier
    v_mfma_f32_16x16x32_bf16 v[128:131], v[24:27], v[52:55], v[128:131]
    ds_read_b64_tr_b16 v[52:53], v8 offset:49152
    v_mfma_f32_16x16x32_bf16 v[128:131], v[40:43], v[56:59], v[128:131]
    ds_read_b64_tr_b16 v[54:55], v8 offset:49664
    v_mfma_f32_16x16x32_bf16 v[132:135], v[12:15], v[60:63], v[132:135]
    ds_read_b64_tr_b16 v[56:57], v8 offset:53248
    v_mfma_f32_16x16x32_bf16 v[132:135], v[28:31], v[64:67], v[132:135]
    ds_read_b64_tr_b16 v[58:59], v8 offset:53760
    v_mfma_f32_16x16x32_bf16 v[148:151], v[12:15], v[44:47], v[148:151]
    ds_read_b128 v[12:15], v4 offset:40960
    v_mfma_f32_16x16x32_bf16 v[148:151], v[28:31], v[48:51], v[148:151]
    ds_read_b128 v[28:31], v5 offset:40960
    v_mfma_f32_16x16x32_bf16 v[136:139], v[16:19], v[60:63], v[136:139]
    v_mfma_f32_16x16x32_bf16 v[136:139], v[32:35], v[64:67], v[136:139]
    v_mfma_f32_16x16x32_bf16 v[152:155], v[16:19], v[44:47], v[152:155]
    ds_read_b128 v[16:19], v4 offset:43008
    v_mfma_f32_16x16x32_bf16 v[152:155], v[32:35], v[48:51], v[152:155]
    ds_read_b128 v[32:35], v5 offset:43008
    v_mfma_f32_16x16x32_bf16 v[140:143], v[20:23], v[60:63], v[140:143]
    v_mfma_f32_16x16x32_bf16 v[140:143], v[36:39], v[64:67], v[140:143]
    v_mfma_f32_16x16x32_bf16 v[156:159], v[20:23], v[44:47], v[156:159]
    ds_read_b128 v[20:23], v4 offset:45056
    v_mfma_f32_16x16x32_bf16 v[156:159], v[36:39], v[48:51], v[156:159]
    ds_read_b128 v[36:39], v5 offset:45056
    v_mfma_f32_16x16x32_bf16 v[144:147], v[24:27], v[60:63], v[144:147]
    ds_read_b64_tr_b16 v[60:61], v9 offset:49152
    v_mfma_f32_16x16x32_bf16 v[144:147], v[40:43], v[64:67], v[144:147]
    ds_read_b64_tr_b16 v[62:63], v9 offset:49664
    v_mfma_f32_16x16x32_bf16 v[160:163], v[24:27], v[44:47], v[160:163]
    ds_read_b128 v[24:27], v4 offset:47104
    v_mfma_f32_16x16x32_bf16 v[160:163], v[40:43], v[48:51], v[160:163]
    ds_read_b128 v[40:43], v5 offset:47104
    s_waitcnt lgkmcnt(7)
    v_mfma_f32_16x16x32_bf16 v[100:103], v[12:15], v[52:55], v[100:103]
    ds_read_b64_tr_b16 v[64:65], v9 offset:53248
    v_mfma_f32_16x16x32_bf16 v[100:103], v[28:31], v[56:59], v[100:103]
    ds_read_b64_tr_b16 v[66:67], v9 offset:53760
    v_mfma_f32_16x16x32_bf16 v[104:107], v[16:19], v[52:55], v[104:107]
    ds_read_b64_tr_b16 v[44:45], v8 offset:57344
    s_waitcnt lgkmcnt(9)
    v_mfma_f32_16x16x32_bf16 v[104:107], v[32:35], v[56:59], v[104:107]
    ds_read_b64_tr_b16 v[46:47], v8 offset:57856
    s_waitcnt lgkmcnt(9)
    v_mfma_f32_16x16x32_bf16 v[108:111], v[20:23], v[52:55], v[108:111]
    ds_read_b64_tr_b16 v[48:49], v8 offset:61440
    s_waitcnt lgkmcnt(9)
    v_mfma_f32_16x16x32_bf16 v[108:111], v[36:39], v[56:59], v[108:111]
    ds_read_b64_tr_b16 v[50:51], v8 offset:61952
    s_waitcnt lgkmcnt(7)
    v_mfma_f32_16x16x32_bf16 v[112:115], v[24:27], v[52:55], v[112:115]
    ds_read_b64_tr_b16 v[52:53], v9 offset:57344
    s_waitcnt lgkmcnt(7)
    v_mfma_f32_16x16x32_bf16 v[112:115], v[40:43], v[56:59], v[112:115]
    ds_read_b64_tr_b16 v[54:55], v9 offset:57856
    v_mfma_f32_16x16x32_bf16 v[116:119], v[12:15], v[60:63], v[116:119]
    ds_read_b64_tr_b16 v[56:57], v9 offset:61440
    s_waitcnt lgkmcnt(7)
    v_mfma_f32_16x16x32_bf16 v[116:119], v[28:31], v[64:67], v[116:119]
    ds_read_b64_tr_b16 v[58:59], v9 offset:61952
    v_mfma_f32_16x16x32_bf16 v[120:123], v[16:19], v[60:63], v[120:123]
    v_mfma_f32_16x16x32_bf16 v[120:123], v[32:35], v[64:67], v[120:123]
    v_mfma_f32_16x16x32_bf16 v[124:127], v[20:23], v[60:63], v[124:127]
    v_mfma_f32_16x16x32_bf16 v[124:127], v[36:39], v[64:67], v[124:127]
    s_waitcnt lgkmcnt(0)
    s_barrier
    v_mfma_f32_16x16x32_bf16 v[128:131], v[24:27], v[60:63], v[128:131]
    ds_read_b64_tr_b16 v[60:61], v10 offset:8192
    v_mfma_f32_16x16x32_bf16 v[128:131], v[40:43], v[64:67], v[128:131]
    ds_read_b64_tr_b16 v[62:63], v10 offset:8704
    v_mfma_f32_16x16x32_bf16 v[132:135], v[12:15], v[44:47], v[132:135]
    ds_read_b64_tr_b16 v[64:65], v10 offset:12288
    v_mfma_f32_16x16x32_bf16 v[132:135], v[28:31], v[48:51], v[132:135]
    ds_read_b64_tr_b16 v[66:67], v10 offset:12800
    v_mfma_f32_16x16x32_bf16 v[148:151], v[12:15], v[52:55], v[148:151]
    ds_read_b128 v[12:15], v6 offset:0
    v_mfma_f32_16x16x32_bf16 v[148:151], v[28:31], v[56:59], v[148:151]
    ds_read_b128 v[28:31], v7 offset:0
    v_mfma_f32_16x16x32_bf16 v[136:139], v[16:19], v[44:47], v[136:139]
    v_mfma_f32_16x16x32_bf16 v[136:139], v[32:35], v[48:51], v[136:139]
    v_mfma_f32_16x16x32_bf16 v[152:155], v[16:19], v[52:55], v[152:155]
    ds_read_b128 v[16:19], v6 offset:2048
    v_mfma_f32_16x16x32_bf16 v[152:155], v[32:35], v[56:59], v[152:155]
    ds_read_b128 v[32:35], v7 offset:2048
    v_mfma_f32_16x16x32_bf16 v[140:143], v[20:23], v[44:47], v[140:143]
    v_mfma_f32_16x16x32_bf16 v[140:143], v[36:39], v[48:51], v[140:143]
    v_mfma_f32_16x16x32_bf16 v[156:159], v[20:23], v[52:55], v[156:159]
    ds_read_b128 v[20:23], v6 offset:4096
    v_mfma_f32_16x16x32_bf16 v[156:159], v[36:39], v[56:59], v[156:159]
    ds_read_b128 v[36:39], v7 offset:4096
    v_mfma_f32_16x16x32_bf16 v[144:147], v[24:27], v[44:47], v[144:147]
    ds_read_b64_tr_b16 v[44:45], v11 offset:8192
    v_mfma_f32_16x16x32_bf16 v[144:147], v[40:43], v[48:51], v[144:147]
    ds_read_b64_tr_b16 v[46:47], v11 offset:8704
    v_mfma_f32_16x16x32_bf16 v[160:163], v[24:27], v[52:55], v[160:163]
    ds_read_b128 v[24:27], v6 offset:6144
    v_mfma_f32_16x16x32_bf16 v[160:163], v[40:43], v[56:59], v[160:163]
    ds_read_b128 v[40:43], v7 offset:6144
    s_waitcnt lgkmcnt(7)
    v_mfma_f32_16x16x32_bf16 v[100:103], v[12:15], v[60:63], v[100:103]
    ds_read_b64_tr_b16 v[48:49], v11 offset:12288
    v_mfma_f32_16x16x32_bf16 v[100:103], v[28:31], v[64:67], v[100:103]
    ds_read_b64_tr_b16 v[50:51], v11 offset:12800
    v_mfma_f32_16x16x32_bf16 v[104:107], v[16:19], v[60:63], v[104:107]
    ds_read_b64_tr_b16 v[52:53], v10 offset:16384
    s_waitcnt lgkmcnt(9)
    v_mfma_f32_16x16x32_bf16 v[104:107], v[32:35], v[64:67], v[104:107]
    ds_read_b64_tr_b16 v[54:55], v10 offset:16896
    s_waitcnt lgkmcnt(9)
    v_mfma_f32_16x16x32_bf16 v[108:111], v[20:23], v[60:63], v[108:111]
    ds_read_b64_tr_b16 v[56:57], v10 offset:20480
    s_waitcnt lgkmcnt(9)
    v_mfma_f32_16x16x32_bf16 v[108:111], v[36:39], v[64:67], v[108:111]
    ds_read_b64_tr_b16 v[58:59], v10 offset:20992
    s_waitcnt lgkmcnt(7)
    v_mfma_f32_16x16x32_bf16 v[112:115], v[24:27], v[60:63], v[112:115]
    ds_read_b64_tr_b16 v[60:61], v11 offset:16384
    s_waitcnt lgkmcnt(7)
    v_mfma_f32_16x16x32_bf16 v[112:115], v[40:43], v[64:67], v[112:115]
    ds_read_b64_tr_b16 v[62:63], v11 offset:16896
    v_mfma_f32_16x16x32_bf16 v[116:119], v[12:15], v[44:47], v[116:119]
    ds_read_b64_tr_b16 v[64:65], v11 offset:20480
    s_waitcnt lgkmcnt(7)
    v_mfma_f32_16x16x32_bf16 v[116:119], v[28:31], v[48:51], v[116:119]
    ds_read_b64_tr_b16 v[66:67], v11 offset:20992
    v_mfma_f32_16x16x32_bf16 v[120:123], v[16:19], v[44:47], v[120:123]
    v_mfma_f32_16x16x32_bf16 v[120:123], v[32:35], v[48:51], v[120:123]
    v_mfma_f32_16x16x32_bf16 v[124:127], v[20:23], v[44:47], v[124:127]
    v_mfma_f32_16x16x32_bf16 v[124:127], v[36:39], v[48:51], v[124:127]
    s_waitcnt lgkmcnt(0)
    s_barrier
    v_mfma_f32_16x16x32_bf16 v[128:131], v[24:27], v[44:47], v[128:131]
    ds_read_b64_tr_b16 v[44:45], v10 offset:49152
    v_mfma_f32_16x16x32_bf16 v[128:131], v[40:43], v[48:51], v[128:131]
    ds_read_b64_tr_b16 v[46:47], v10 offset:49664
    v_mfma_f32_16x16x32_bf16 v[132:135], v[12:15], v[52:55], v[132:135]
    ds_read_b64_tr_b16 v[48:49], v10 offset:53248
    v_mfma_f32_16x16x32_bf16 v[132:135], v[28:31], v[56:59], v[132:135]
    ds_read_b64_tr_b16 v[50:51], v10 offset:53760
    v_mfma_f32_16x16x32_bf16 v[148:151], v[12:15], v[60:63], v[148:151]
    ds_read_b128 v[12:15], v6 offset:40960
    v_mfma_f32_16x16x32_bf16 v[148:151], v[28:31], v[64:67], v[148:151]
    ds_read_b128 v[28:31], v7 offset:40960
    v_mfma_f32_16x16x32_bf16 v[136:139], v[16:19], v[52:55], v[136:139]
    v_mfma_f32_16x16x32_bf16 v[136:139], v[32:35], v[56:59], v[136:139]
    v_mfma_f32_16x16x32_bf16 v[152:155], v[16:19], v[60:63], v[152:155]
    ds_read_b128 v[16:19], v6 offset:43008
    v_mfma_f32_16x16x32_bf16 v[152:155], v[32:35], v[64:67], v[152:155]
    ds_read_b128 v[32:35], v7 offset:43008
    v_mfma_f32_16x16x32_bf16 v[140:143], v[20:23], v[52:55], v[140:143]
    v_mfma_f32_16x16x32_bf16 v[140:143], v[36:39], v[56:59], v[140:143]
    v_mfma_f32_16x16x32_bf16 v[156:159], v[20:23], v[60:63], v[156:159]
    ds_read_b128 v[20:23], v6 offset:45056
    v_mfma_f32_16x16x32_bf16 v[156:159], v[36:39], v[64:67], v[156:159]
    ds_read_b128 v[36:39], v7 offset:45056
    v_mfma_f32_16x16x32_bf16 v[144:147], v[24:27], v[52:55], v[144:147]
    ds_read_b64_tr_b16 v[52:53], v11 offset:49152
    v_mfma_f32_16x16x32_bf16 v[144:147], v[40:43], v[56:59], v[144:147]
    ds_read_b64_tr_b16 v[54:55], v11 offset:49664
    v_mfma_f32_16x16x32_bf16 v[160:163], v[24:27], v[60:63], v[160:163]
    ds_read_b128 v[24:27], v6 offset:47104
    v_mfma_f32_16x16x32_bf16 v[160:163], v[40:43], v[64:67], v[160:163]
    ds_read_b128 v[40:43], v7 offset:47104
    s_waitcnt lgkmcnt(7)
    v_mfma_f32_16x16x32_bf16 v[100:103], v[12:15], v[44:47], v[100:103]
    ds_read_b64_tr_b16 v[56:57], v11 offset:53248
    v_mfma_f32_16x16x32_bf16 v[100:103], v[28:31], v[48:51], v[100:103]
    ds_read_b64_tr_b16 v[58:59], v11 offset:53760
    v_mfma_f32_16x16x32_bf16 v[104:107], v[16:19], v[44:47], v[104:107]
    ds_read_b64_tr_b16 v[60:61], v10 offset:57344
    s_waitcnt lgkmcnt(9)
    v_mfma_f32_16x16x32_bf16 v[104:107], v[32:35], v[48:51], v[104:107]
    ds_read_b64_tr_b16 v[62:63], v10 offset:57856
    s_waitcnt lgkmcnt(9)
    v_mfma_f32_16x16x32_bf16 v[108:111], v[20:23], v[44:47], v[108:111]
    ds_read_b64_tr_b16 v[64:65], v10 offset:61440
    s_waitcnt lgkmcnt(9)
    v_mfma_f32_16x16x32_bf16 v[108:111], v[36:39], v[48:51], v[108:111]
    ds_read_b64_tr_b16 v[66:67], v10 offset:61952
    s_waitcnt lgkmcnt(7)
    v_mfma_f32_16x16x32_bf16 v[112:115], v[24:27], v[44:47], v[112:115]
    ds_read_b64_tr_b16 v[44:45], v11 offset:57344
    s_waitcnt lgkmcnt(7)
    v_mfma_f32_16x16x32_bf16 v[112:115], v[40:43], v[48:51], v[112:115]
    ds_read_b64_tr_b16 v[46:47], v11 offset:57856
    v_mfma_f32_16x16x32_bf16 v[116:119], v[12:15], v[52:55], v[116:119]
    ds_read_b64_tr_b16 v[48:49], v11 offset:61440
    s_waitcnt lgkmcnt(7)
    v_mfma_f32_16x16x32_bf16 v[116:119], v[28:31], v[56:59], v[116:119]
    ds_read_b64_tr_b16 v[50:51], v11 offset:61952
    v_mfma_f32_16x16x32_bf16 v[120:123], v[16:19], v[52:55], v[120:123]
    v_mfma_f32_16x16x32_bf16 v[120:123], v[32:35], v[56:59], v[120:123]
    v_mfma_f32_16x16x32_bf16 v[124:127], v[20:23], v[52:55], v[124:127]
    v_mfma_f32_16x16x32_bf16 v[124:127], v[36:39], v[56:59], v[124:127]
    v_mfma_f32_16x16x32_bf16 v[128:131], v[24:27], v[52:55], v[128:131]
    ds_read2_b32 v[52:53], v165 offset0:64 offset1:64
    v_mfma_f32_16x16x32_bf16 v[128:131], v[40:43], v[56:59], v[128:131]
    ds_read2_b32 v[54:55], v165 offset0:80 offset1:80
    s_waitcnt lgkmcnt(5)
    v_mfma_f32_16x16x32_bf16 v[132:135], v[12:15], v[60:63], v[132:135]
    ds_read2_b32 v[56:57], v165 offset0:128 offset1:128
    v_mfma_f32_16x16x32_bf16 v[132:135], v[28:31], v[64:67], v[132:135]
    ds_read2_b32 v[58:59], v165 offset0:144 offset1:144
    s_waitcnt lgkmcnt(5)
    v_mfma_f32_16x16x32_bf16 v[148:151], v[12:15], v[44:47], v[148:151]
    ds_read_b128 v[12:15], v164 offset:0
    s_waitcnt lgkmcnt(5)
    v_mfma_f32_16x16x32_bf16 v[148:151], v[28:31], v[48:51], v[148:151]
    ds_read_b128 v[28:31], v164 offset:512
    v_mfma_f32_16x16x32_bf16 v[136:139], v[16:19], v[60:63], v[136:139]
    v_mfma_f32_16x16x32_bf16 v[136:139], v[32:35], v[64:67], v[136:139]
    v_mfma_f32_16x16x32_bf16 v[152:155], v[16:19], v[44:47], v[152:155]
    ds_read_b128 v[16:19], v164 offset:64
    v_mfma_f32_16x16x32_bf16 v[152:155], v[32:35], v[48:51], v[152:155]
    ds_read_b128 v[32:35], v164 offset:576
    v_mfma_f32_16x16x32_bf16 v[140:143], v[20:23], v[60:63], v[140:143]
    v_mfma_f32_16x16x32_bf16 v[140:143], v[36:39], v[64:67], v[140:143]
    v_mfma_f32_16x16x32_bf16 v[156:159], v[20:23], v[44:47], v[156:159]
    v_mfma_f32_16x16x32_bf16 v[156:159], v[36:39], v[48:51], v[156:159]
    v_mfma_f32_16x16x32_bf16 v[144:147], v[24:27], v[60:63], v[144:147]
    ds_read_b128 v[60:63], v164 offset:1024
    v_mfma_f32_16x16x32_bf16 v[144:147], v[40:43], v[64:67], v[144:147]
    ds_read_b128 v[64:67], v164 offset:1088
    v_mfma_f32_16x16x32_bf16 v[160:163], v[24:27], v[44:47], v[160:163]
    v_mfma_f32_16x16x32_bf16 v[160:163], v[40:43], v[48:51], v[160:163]
    s_mov_b32 s50, 0x10001
    s_mov_b32 s51, s50
    ds_read_b128 v[36:39], v164 offset:128
    ds_read_b128 v[40:43], v164 offset:192
    ds_read_b128 v[44:47], v164 offset:640
    ds_read_b128 v[48:51], v164 offset:704
    s_waitcnt lgkmcnt(9)
    v_pk_fma_f32 v[100:101], v[12:13], v[52:53], v[100:101]
    v_pk_fma_f32 v[102:103], v[14:15], v[52:53], v[102:103]
    s_waitcnt lgkmcnt(7)
    v_pk_fma_f32 v[104:105], v[16:17], v[52:53], v[104:105]
    v_pk_fma_f32 v[106:107], v[18:19], v[52:53], v[106:107]
    s_waitcnt lgkmcnt(5)
    v_pk_mul_f32 v[20:21], v[100:101], v[60:61]
    v_pk_mul_f32 v[22:23], v[102:103], v[62:63]
    s_waitcnt lgkmcnt(4)
    v_pk_mul_f32 v[24:25], v[104:105], v[64:65]
    v_pk_mul_f32 v[26:27], v[106:107], v[66:67]
    v_pk_fma_f32 v[100:101], v[100:101], v[28:29], s[40:41]
    v_pk_fma_f32 v[102:103], v[102:103], v[30:31], s[40:41]
    v_pk_fma_f32 v[104:105], v[104:105], v[32:33], s[40:41]
    v_pk_fma_f32 v[106:107], v[106:107], v[34:35], s[40:41]
    v_exp_f32 v20, v20 clamp
    v_exp_f32 v21, v21 clamp
    v_exp_f32 v22, v22 clamp
    v_exp_f32 v23, v23 clamp
    v_exp_f32 v24, v24 clamp
    v_exp_f32 v25, v25 clamp
    v_exp_f32 v26, v26 clamp
    v_exp_f32 v27, v27 clamp
    v_pk_add_f32 v[20:21], v[20:21], s[74:75]
    v_pk_add_f32 v[22:23], v[22:23], s[74:75]
    v_pk_add_f32 v[24:25], v[24:25], s[74:75]
    v_pk_add_f32 v[26:27], v[26:27], s[74:75]
    v_max_f32 v100, v100, v20
    v_max_f32 v101, v101, v21
    v_max_f32 v102, v102, v22
    v_max_f32 v103, v103, v23
    v_max_f32 v104, v104, v24
    v_max_f32 v105, v105, v25
    v_max_f32 v106, v106, v26
    v_max_f32 v107, v107, v27
    v_cvt_pk_bf16_f32 v100, v100, v101
    v_cvt_pk_bf16_f32 v101, v102, v103
    v_cvt_pk_bf16_f32 v102, v104, v105
    v_cvt_pk_bf16_f32 v103, v106, v107
    s_waitcnt lgkmcnt(3)
    v_pk_fma_f32 v[140:141], v[36:37], v[56:57], v[140:141]
    v_pk_fma_f32 v[142:143], v[38:39], v[56:57], v[142:143]
    s_waitcnt lgkmcnt(2)
    v_pk_fma_f32 v[144:145], v[40:41], v[56:57], v[144:145]
    v_pk_fma_f32 v[146:147], v[42:43], v[56:57], v[146:147]
    s_waitcnt lgkmcnt(1)
    v_pk_mul_f32 v[140:141], v[140:141], v[44:45]
    v_pk_mul_f32 v[142:143], v[142:143], v[46:47]
    s_waitcnt lgkmcnt(0)
    v_pk_mul_f32 v[144:145], v[144:145], v[48:49]
    v_pk_mul_f32 v[146:147], v[146:147], v[50:51]
    v_cvt_pk_bf16_f32 v140, v140, v141
    v_cvt_pk_bf16_f32 v141, v142, v143
    v_cvt_pk_bf16_f32 v142, v144, v145
    v_cvt_pk_bf16_f32 v143, v146, v147
    v_pk_fma_f32 v[156:157], v[36:37], v[58:59], v[156:157]
    v_pk_fma_f32 v[158:159], v[38:39], v[58:59], v[158:159]
    v_pk_fma_f32 v[160:161], v[40:41], v[58:59], v[160:161]
    v_pk_fma_f32 v[162:163], v[42:43], v[58:59], v[162:163]
    v_pk_mul_f32 v[156:157], v[156:157], v[44:45]
    v_pk_mul_f32 v[158:159], v[158:159], v[46:47]
    v_pk_mul_f32 v[160:161], v[160:161], v[48:49]
    v_pk_mul_f32 v[162:163], v[162:163], v[50:51]
    v_cvt_pk_bf16_f32 v156, v156, v157
    v_cvt_pk_bf16_f32 v157, v158, v159
    v_cvt_pk_bf16_f32 v158, v160, v161
    v_cvt_pk_bf16_f32 v159, v162, v163
    ds_read_b128 v[144:147], v164 offset:1152
    ds_read_b128 v[160:163], v164 offset:1216
    v_pk_fma_f32 v[132:133], v[12:13], v[56:57], v[132:133]
    v_pk_fma_f32 v[134:135], v[14:15], v[56:57], v[134:135]
    v_pk_fma_f32 v[136:137], v[16:17], v[56:57], v[136:137]
    v_pk_fma_f32 v[138:139], v[18:19], v[56:57], v[138:139]
    v_pk_mul_f32 v[132:133], v[132:133], v[28:29]
    v_pk_mul_f32 v[134:135], v[134:135], v[30:31]
    v_pk_mul_f32 v[136:137], v[136:137], v[32:33]
    v_pk_mul_f32 v[138:139], v[138:139], v[34:35]
    v_cvt_pk_bf16_f32 v132, v132, v133
    v_cvt_pk_bf16_f32 v133, v134, v135
    v_cvt_pk_bf16_f32 v134, v136, v137
    v_cvt_pk_bf16_f32 v135, v138, v139
    v_pk_fma_f32 v[148:149], v[12:13], v[58:59], v[148:149]
    v_pk_fma_f32 v[150:151], v[14:15], v[58:59], v[150:151]
    v_pk_fma_f32 v[152:153], v[16:17], v[58:59], v[152:153]
    v_pk_fma_f32 v[154:155], v[18:19], v[58:59], v[154:155]
    v_pk_mul_f32 v[148:149], v[148:149], v[28:29]
    v_pk_mul_f32 v[150:151], v[150:151], v[30:31]
    v_pk_mul_f32 v[152:153], v[152:153], v[32:33]
    v_pk_mul_f32 v[154:155], v[154:155], v[34:35]
    v_cvt_pk_bf16_f32 v148, v148, v149
    v_cvt_pk_bf16_f32 v149, v150, v151
    v_cvt_pk_bf16_f32 v150, v152, v153
    v_cvt_pk_bf16_f32 v151, v154, v155
    v_mov_b32 v56, 0x3f803f80
    v_mov_b32 v57, 0x3f803f80
    v_mov_b32 v58, 0x3f803f80
    v_mov_b32 v59, 0x3f803f80
    v_mov_b32 v164, 1
    v_mov_b32 v165, 2
    v_pk_fma_f32 v[108:109], v[36:37], v[52:53], v[108:109]
    v_pk_fma_f32 v[110:111], v[38:39], v[52:53], v[110:111]
    v_pk_fma_f32 v[112:113], v[40:41], v[52:53], v[112:113]
    v_pk_fma_f32 v[114:115], v[42:43], v[52:53], v[114:115]
    s_waitcnt lgkmcnt(1)
    v_pk_mul_f32 v[20:21], v[108:109], v[144:145]
    v_pk_mul_f32 v[22:23], v[110:111], v[146:147]
    s_waitcnt lgkmcnt(0)
    v_pk_mul_f32 v[24:25], v[112:113], v[160:161]
    v_pk_mul_f32 v[26:27], v[114:115], v[162:163]
    v_pk_fma_f32 v[108:109], v[108:109], v[44:45], s[40:41]
    v_pk_fma_f32 v[110:111], v[110:111], v[46:47], s[40:41]
    v_pk_fma_f32 v[112:113], v[112:113], v[48:49], s[40:41]
    v_pk_fma_f32 v[114:115], v[114:115], v[50:51], s[40:41]
    v_mfma_f32_16x16x32_bf16 v[136:139], v[100:103], v[132:135], 0
    v_exp_f32 v20, v20 clamp
    v_mfma_f32_16x16x32_bf16 v[152:155], v[100:103], v[148:151], 0
    v_exp_f32 v21, v21 clamp
    v_mfma_f32_16x16x32_bf16 v[104:107], v[100:103], v[56:59], 0
    v_exp_f32 v22, v22 clamp
    v_exp_f32 v23, v23 clamp
    v_exp_f32 v24, v24 clamp
    v_exp_f32 v25, v25 clamp
    v_exp_f32 v26, v26 clamp
    v_exp_f32 v27, v27 clamp
    v_pk_add_f32 v[20:21], v[20:21], s[74:75]
    v_pk_add_f32 v[22:23], v[22:23], s[74:75]
    v_pk_add_f32 v[24:25], v[24:25], s[74:75]
    v_pk_add_f32 v[26:27], v[26:27], s[74:75]
    v_max_f32 v108, v108, v20
    v_max_f32 v109, v109, v21
    v_max_f32 v110, v110, v22
    v_max_f32 v111, v111, v23
    v_max_f32 v112, v112, v24
    v_max_f32 v113, v113, v25
    v_max_f32 v114, v114, v26
    v_max_f32 v115, v115, v27
    v_cvt_pk_bf16_f32 v108, v108, v109
    v_cvt_pk_bf16_f32 v109, v110, v111
    v_cvt_pk_bf16_f32 v110, v112, v113
    v_cvt_pk_bf16_f32 v111, v114, v115
    v_pk_fma_f32 v[116:117], v[12:13], v[54:55], v[116:117]
    v_pk_fma_f32 v[118:119], v[14:15], v[54:55], v[118:119]
    v_pk_fma_f32 v[120:121], v[16:17], v[54:55], v[120:121]
    v_pk_fma_f32 v[122:123], v[18:19], v[54:55], v[122:123]
    v_pk_mul_f32 v[20:21], v[116:117], v[60:61]
    v_pk_mul_f32 v[22:23], v[118:119], v[62:63]
    v_pk_mul_f32 v[24:25], v[120:121], v[64:65]
    v_pk_mul_f32 v[26:27], v[122:123], v[66:67]
    v_pk_fma_f32 v[116:117], v[116:117], v[28:29], s[40:41]
    v_pk_fma_f32 v[118:119], v[118:119], v[30:31], s[40:41]
    v_pk_fma_f32 v[120:121], v[120:121], v[32:33], s[40:41]
    v_pk_fma_f32 v[122:123], v[122:123], v[34:35], s[40:41]
    v_mfma_f32_16x16x32_bf16 v[136:139], v[108:111], v[140:143], v[136:139]
    v_exp_f32 v20, v20 clamp
    v_mfma_f32_16x16x32_bf16 v[152:155], v[108:111], v[156:159], v[152:155]
    v_exp_f32 v21, v21 clamp
    v_mfma_f32_16x16x32_bf16 v[104:107], v[108:111], v[56:59], v[104:107]
    v_exp_f32 v22, v22 clamp
    v_exp_f32 v23, v23 clamp
    v_exp_f32 v24, v24 clamp
    v_exp_f32 v25, v25 clamp
    v_exp_f32 v26, v26 clamp
    v_exp_f32 v27, v27 clamp
    v_pk_add_f32 v[20:21], v[20:21], s[74:75]
    v_pk_add_f32 v[22:23], v[22:23], s[74:75]
    v_pk_add_f32 v[24:25], v[24:25], s[74:75]
    v_pk_add_f32 v[26:27], v[26:27], s[74:75]
    ds_write_b128 v1, v[136:139] offset:0
    ds_write_b128 v1, v[152:155] offset:1024
    s_mov_b64 exec, s[50:51]
    ds_write_b128 v2, v[104:107] offset:0
    s_mov_b64 exec, 1
    ds_write_b32 v3, v164
    s_mov_b64 exec, -1
    v_max_f32 v116, v116, v20
    v_max_f32 v117, v117, v21
    v_max_f32 v118, v118, v22
    v_max_f32 v119, v119, v23
    v_max_f32 v120, v120, v24
    v_max_f32 v121, v121, v25
    v_max_f32 v122, v122, v26
    v_max_f32_e64 v123, v123, v27
    v_cvt_pk_bf16_f32 v116, v116, v117
    v_cvt_pk_bf16_f32 v117, v118, v119
    v_cvt_pk_bf16_f32 v118, v120, v121
    v_cvt_pk_bf16_f32 v119, v122, v123
    v_pk_fma_f32 v[124:125], v[36:37], v[54:55], v[124:125]
    v_pk_fma_f32 v[126:127], v[38:39], v[54:55], v[126:127]
    v_pk_fma_f32 v[128:129], v[40:41], v[54:55], v[128:129]
    v_pk_fma_f32 v[130:131], v[42:43], v[54:55], v[130:131]
    v_pk_mul_f32 v[20:21], v[124:125], v[144:145]
    v_pk_mul_f32 v[22:23], v[126:127], v[146:147]
    v_pk_mul_f32 v[24:25], v[128:129], v[160:161]
    v_pk_mul_f32 v[26:27], v[130:131], v[162:163]
    v_pk_fma_f32 v[124:125], v[124:125], v[44:45], s[40:41]
    v_pk_fma_f32 v[126:127], v[126:127], v[46:47], s[40:41]
    v_pk_fma_f32 v[128:129], v[128:129], v[48:49], s[40:41]
    v_pk_fma_f32 v[130:131], v[130:131], v[50:51], s[40:41]
    v_mfma_f32_16x16x32_bf16 v[112:115], v[116:119], v[132:135], 0
    v_exp_f32 v20, v20 clamp
    v_mfma_f32_16x16x32_bf16 v[120:123], v[116:119], v[148:151], 0
    v_exp_f32 v21, v21 clamp
    v_mfma_f32_16x16x32_bf16 v[100:103], v[116:119], v[56:59], 0
    v_exp_f32 v22, v22 clamp
    v_exp_f32 v23, v23 clamp
    v_exp_f32 v24, v24 clamp
    v_exp_f32 v25, v25 clamp
    v_exp_f32 v26, v26 clamp
    v_exp_f32 v27, v27 clamp
    v_pk_add_f32 v[20:21], v[20:21], s[74:75]
    v_pk_add_f32 v[22:23], v[22:23], s[74:75]
    v_pk_add_f32 v[24:25], v[24:25], s[74:75]
    v_pk_add_f32 v[26:27], v[26:27], s[74:75]
    v_max_f32 v124, v124, v20
    v_max_f32 v125, v125, v21
    v_max_f32 v126, v126, v22
    v_max_f32 v127, v127, v23
    v_max_f32 v128, v128, v24
    v_max_f32 v129, v129, v25
    v_max_f32 v130, v130, v26
    v_max_f32 v131, v131, v27
    v_cvt_pk_bf16_f32 v124, v124, v125
    v_cvt_pk_bf16_f32 v125, v126, v127
    v_cvt_pk_bf16_f32 v126, v128, v129
    v_cvt_pk_bf16_f32 v127, v130, v131
    s_nop 1
    v_mfma_f32_16x16x32_bf16 v[112:115], v[124:127], v[140:143], v[112:115]
    v_mfma_f32_16x16x32_bf16 v[120:123], v[124:127], v[156:159], v[120:123]
    v_mfma_f32_16x16x32_bf16 v[100:103], v[124:127], v[56:59], v[100:103]
    ds_read_b128 v[28:31], v4 offset:0
    ds_read_b64_tr_b16 v[44:45], v8 offset:0
    ds_read_b64_tr_b16 v[46:47], v8 offset:512
    ds_read_b128 v[32:35], v4 offset:2048
    ds_read_b128 v[36:39], v4 offset:4096
    ds_read_b128 v[40:43], v4 offset:6144
    ds_write_b128 v1, v[112:115] offset:2048
    ds_write_b128 v1, v[120:123] offset:3072
    s_mov_b64 exec, s[50:51]
    ds_write_b128 v2, v[100:103] offset:64
    s_mov_b64 exec, 1
    ds_write_b32 v3, v165
    s_mov_b64 exec, -1
    ds_read_b64_tr_b16 v[48:49], v9 offset:0
    s_waitcnt lgkmcnt(8)
    ds_read_b64_tr_b16 v[50:51], v9 offset:512
    s_setprio 0
    v_and_b32 v132, 15, v0
    s_lshl_b32 s44, s36, 8
    s_add_u32 s44, s44, 24832
    v_lshl_add_u32 v132, v132, 2, s44
    v_add_u32 v133, 1024, v132
    s_lshl_b32 s44, s37, 7
    s_add_u32 s44, s44, 26368
    v_and_or_b32 v134, v0, 48, s44
    s_lshl_b32 s44, s35, 2
    s_and_b32 s47, s3, 2
    s_add_u32 s44, s44, s47
    s_lshr_b32 s44, 0xeee7eece, s44
    s_and_b32 s44, s44, 3
    s_mul_i32 s44, s44, 40960
    s_and_b32 s47, s28, 1
    s_lshl_b32 s47, s47, 13
    s_add_u32 s44, s44, s47
    s_lshl_b32 s47, s37, 6
    v_lshrrev_b32 v140, 4, v0
    v_lshlrev_b32 v140, 3, v140
    v_xor_b32 v140, s47, v140
    v_and_b32 v141, 14, v0
    v_lshlrev_b32 v141, 3, v141
    v_xor_b32 v140, v140, v141
    v_and_b32 v141, 15, v0
    v_lshlrev_b32 v141, 7, v141
    v_add3_u32 v140, v140, v141, s44
    v_xor_b32 v141, 32, v140

    s_waitcnt lgkmcnt(9)
    v_mfma_f32_16x16x32_bf16 v[68:71], v[44:47], v[28:31], v[68:71]
    ds_read_b128 v[12:15], v5 offset:0
    ds_read_b64_tr_b16 v[52:53], v8 offset:4096
    s_waitcnt lgkmcnt(10)
    v_mfma_f32_16x16x32_bf16 v[72:75], v[44:47], v[32:35], v[72:75]
    ds_read_b64_tr_b16 v[54:55], v8 offset:4608
    ds_read_b128 v[16:19], v5 offset:2048
    s_waitcnt lgkmcnt(11)
    v_mfma_f32_16x16x32_bf16 v[76:79], v[44:47], v[36:39], v[76:79]
    ds_read_b128 v[20:23], v5 offset:4096
    ds_read_b128 v[24:27], v5 offset:6144
    s_waitcnt lgkmcnt(12)
    v_mfma_f32_16x16x32_bf16 v[80:83], v[44:47], v[40:43], v[80:83]
    ds_read_b64_tr_b16 v[56:57], v9 offset:4096
    ds_read_b64_tr_b16 v[58:59], v9 offset:4608
    s_waitcnt lgkmcnt(8)
    v_mfma_f32_16x16x32_bf16 v[84:87], v[48:51], v[28:31], v[84:87]
    v_mfma_f32_16x16x32_bf16 v[88:91], v[48:51], v[32:35], v[88:91]
    v_mfma_f32_16x16x32_bf16 v[92:95], v[48:51], v[36:39], v[92:95]
    v_mfma_f32_16x16x32_bf16 v[96:99], v[48:51], v[40:43], v[96:99]
    s_waitcnt lgkmcnt(5)
    v_mfma_f32_16x16x32_bf16 v[68:71], v[52:55], v[12:15], v[68:71]
    ds_read_b128 v[28:31], v4 offset:40960
    ds_read_b64_tr_b16 v[44:45], v8 offset:40960
    s_waitcnt lgkmcnt(6)
    v_mfma_f32_16x16x32_bf16 v[72:75], v[52:55], v[16:19], v[72:75]
    ds_read_b64_tr_b16 v[46:47], v8 offset:41472
    ds_read_b128 v[32:35], v4 offset:43008
    s_waitcnt lgkmcnt(7)
    v_mfma_f32_16x16x32_bf16 v[76:79], v[52:55], v[20:23], v[76:79]
    ds_read_b128 v[36:39], v4 offset:45056
    ds_read_b128 v[40:43], v4 offset:47104
    s_waitcnt lgkmcnt(8)
    v_mfma_f32_16x16x32_bf16 v[80:83], v[52:55], v[24:27], v[80:83]
    ds_read_b64_tr_b16 v[48:49], v9 offset:40960
    ds_read_b64_tr_b16 v[50:51], v9 offset:41472
    s_waitcnt lgkmcnt(8)
    v_mfma_f32_16x16x32_bf16 v[84:87], v[56:59], v[12:15], v[84:87]
    v_mfma_f32_16x16x32_bf16 v[88:91], v[56:59], v[16:19], v[88:91]
    v_mfma_f32_16x16x32_bf16 v[92:95], v[56:59], v[20:23], v[92:95]
    v_mfma_f32_16x16x32_bf16 v[96:99], v[56:59], v[24:27], v[96:99]
    s_waitcnt lgkmcnt(5)
    v_mfma_f32_16x16x32_bf16 v[68:71], v[44:47], v[28:31], v[68:71]
    ds_read_b128 v[12:15], v5 offset:40960
    ds_read_b64_tr_b16 v[52:53], v8 offset:45056
    s_waitcnt lgkmcnt(6)
    v_mfma_f32_16x16x32_bf16 v[72:75], v[44:47], v[32:35], v[72:75]
    ds_read_b64_tr_b16 v[54:55], v8 offset:45568
    ds_read_b128 v[16:19], v5 offset:43008
    s_waitcnt lgkmcnt(7)
    v_mfma_f32_16x16x32_bf16 v[76:79], v[44:47], v[36:39], v[76:79]
    ds_read_b128 v[20:23], v5 offset:45056
    ds_read_b128 v[24:27], v5 offset:47104
    s_waitcnt lgkmcnt(8)
    v_mfma_f32_16x16x32_bf16 v[80:83], v[44:47], v[40:43], v[80:83]
    ds_read_b64_tr_b16 v[56:57], v9 offset:45056
    ds_read_b64_tr_b16 v[58:59], v9 offset:45568
    s_waitcnt lgkmcnt(8)
    v_mfma_f32_16x16x32_bf16 v[84:87], v[48:51], v[28:31], v[84:87]
    ds_read_b64 v[148:149], v140 offset:0
    ds_read_b64 v[150:151], v141 offset:0
    v_mfma_f32_16x16x32_bf16 v[88:91], v[48:51], v[32:35], v[88:91]
    ds_read_b64 v[152:153], v140 offset:2048
    ds_read_b64 v[154:155], v141 offset:2048
    v_mfma_f32_16x16x32_bf16 v[92:95], v[48:51], v[36:39], v[92:95]
    v_mfma_f32_16x16x32_bf16 v[96:99], v[48:51], v[40:43], v[96:99]
    s_waitcnt lgkmcnt(9)
    v_mfma_f32_16x16x32_bf16 v[68:71], v[52:55], v[12:15], v[68:71]
    ds_read_b128 v[28:31], v6 offset:0
    ds_read_b64_tr_b16 v[44:45], v10 offset:0
    s_waitcnt lgkmcnt(10)
    v_mfma_f32_16x16x32_bf16 v[72:75], v[52:55], v[16:19], v[72:75]
    ds_read_b64_tr_b16 v[46:47], v10 offset:512
    ds_read_b128 v[32:35], v6 offset:2048
    s_waitcnt lgkmcnt(11)
    v_mfma_f32_16x16x32_bf16 v[76:79], v[52:55], v[20:23], v[76:79]
    ds_read_b128 v[36:39], v6 offset:4096
    ds_read_b128 v[40:43], v6 offset:6144
    s_waitcnt lgkmcnt(12)
    v_mfma_f32_16x16x32_bf16 v[80:83], v[52:55], v[24:27], v[80:83]
    ds_read_b64_tr_b16 v[48:49], v11 offset:0
    ds_read_b64_tr_b16 v[50:51], v11 offset:512
    s_waitcnt lgkmcnt(12)
    v_mfma_f32_16x16x32_bf16 v[84:87], v[56:59], v[12:15], v[84:87]
    ds_read_b64 v[156:157], v140 offset:4096
    ds_read_b64 v[158:159], v141 offset:4096
    v_mfma_f32_16x16x32_bf16 v[88:91], v[56:59], v[16:19], v[88:91]
    ds_read_b64 v[160:161], v140 offset:6144
    s_waitcnt lgkmcnt(8)
    ds_read_b64 v[162:163], v141 offset:6144
    v_mfma_f32_16x16x32_bf16 v[92:95], v[56:59], v[20:23], v[92:95]
    v_mfma_f32_16x16x32_bf16 v[96:99], v[56:59], v[24:27], v[96:99]
    s_waitcnt lgkmcnt(9)
    v_mfma_f32_16x16x32_bf16 v[68:71], v[44:47], v[28:31], v[68:71]
    ds_read_b128 v[12:15], v7 offset:0
    ds_read_b64_tr_b16 v[52:53], v10 offset:4096
    s_waitcnt lgkmcnt(10)
    v_mfma_f32_16x16x32_bf16 v[72:75], v[44:47], v[32:35], v[72:75]
    ds_read_b64_tr_b16 v[54:55], v10 offset:4608
    ds_read_b128 v[16:19], v7 offset:2048
    s_waitcnt lgkmcnt(11)
    v_mfma_f32_16x16x32_bf16 v[76:79], v[44:47], v[36:39], v[76:79]
    ds_read_b128 v[20:23], v7 offset:4096
    ds_read_b128 v[24:27], v7 offset:6144
    s_waitcnt lgkmcnt(12)
    v_mfma_f32_16x16x32_bf16 v[80:83], v[44:47], v[40:43], v[80:83]
    ds_read_b64_tr_b16 v[56:57], v11 offset:4096
    ds_read_b64_tr_b16 v[58:59], v11 offset:4608
    s_waitcnt lgkmcnt(12)
    v_mfma_f32_16x16x32_bf16 v[84:87], v[48:51], v[28:31], v[84:87]
    v_mfma_f32_16x16x32_bf16 v[88:91], v[48:51], v[32:35], v[88:91]
    v_mfma_f32_16x16x32_bf16 v[92:95], v[48:51], v[36:39], v[92:95]
    v_mfma_f32_16x16x32_bf16 v[96:99], v[48:51], v[40:43], v[96:99]
    s_waitcnt lgkmcnt(5)
    v_mfma_f32_16x16x32_bf16 v[68:71], v[52:55], v[12:15], v[68:71]
    ds_read_b128 v[28:31], v6 offset:40960
    ds_read_b64_tr_b16 v[44:45], v10 offset:40960
    s_waitcnt lgkmcnt(6)
    v_mfma_f32_16x16x32_bf16 v[72:75], v[52:55], v[16:19], v[72:75]
    ds_read_b64_tr_b16 v[46:47], v10 offset:41472
    ds_read_b128 v[32:35], v6 offset:43008
    s_waitcnt lgkmcnt(7)
    v_mfma_f32_16x16x32_bf16 v[76:79], v[52:55], v[20:23], v[76:79]
    ds_read_b128 v[36:39], v6 offset:45056
    ds_read_b128 v[40:43], v6 offset:47104
    s_waitcnt lgkmcnt(8)
    v_mfma_f32_16x16x32_bf16 v[80:83], v[52:55], v[24:27], v[80:83]
    ds_read_b64_tr_b16 v[48:49], v11 offset:40960
    ds_read_b64_tr_b16 v[50:51], v11 offset:41472
    s_waitcnt lgkmcnt(8)
    v_mfma_f32_16x16x32_bf16 v[84:87], v[56:59], v[12:15], v[84:87]
    v_mfma_f32_16x16x32_bf16 v[88:91], v[56:59], v[16:19], v[88:91]
    v_mfma_f32_16x16x32_bf16 v[92:95], v[56:59], v[20:23], v[92:95]
    v_mfma_f32_16x16x32_bf16 v[96:99], v[56:59], v[24:27], v[96:99]
    s_waitcnt lgkmcnt(5)
    v_mfma_f32_16x16x32_bf16 v[68:71], v[44:47], v[28:31], v[68:71]
    ds_read_b128 v[12:15], v7 offset:40960
    ds_read_b64_tr_b16 v[52:53], v10 offset:45056
    s_waitcnt lgkmcnt(6)
    v_mfma_f32_16x16x32_bf16 v[72:75], v[44:47], v[32:35], v[72:75]
    ds_read_b64_tr_b16 v[54:55], v10 offset:45568
    ds_read_b128 v[16:19], v7 offset:43008
    s_waitcnt lgkmcnt(7)
    v_mfma_f32_16x16x32_bf16 v[76:79], v[44:47], v[36:39], v[76:79]
    ds_read_b128 v[20:23], v7 offset:45056
    ds_read_b128 v[24:27], v7 offset:47104
    s_waitcnt lgkmcnt(8)
    v_mfma_f32_16x16x32_bf16 v[80:83], v[44:47], v[40:43], v[80:83]
    ds_read_b64_tr_b16 v[56:57], v11 offset:45056
    ds_read_b64_tr_b16 v[58:59], v11 offset:45568
    s_waitcnt lgkmcnt(8)
    v_mfma_f32_16x16x32_bf16 v[84:87], v[48:51], v[28:31], v[84:87]
    v_mfma_f32_16x16x32_bf16 v[88:91], v[48:51], v[32:35], v[88:91]
    v_mfma_f32_16x16x32_bf16 v[92:95], v[48:51], v[36:39], v[92:95]
    v_mfma_f32_16x16x32_bf16 v[96:99], v[48:51], v[40:43], v[96:99]
    s_waitcnt lgkmcnt(5)
    v_mfma_f32_16x16x32_bf16 v[68:71], v[52:55], v[12:15], v[68:71]
    v_mov_b32 v135, 3
    s_mov_b64 exec, 1
    ds_write_b32 v3, v135 offset:0
    s_mov_b64 exec, -1
    ds_read_b128 v[100:103], v134 offset:0
    ds_read_b128 v[104:107], v134 offset:64
    s_waitcnt lgkmcnt(7)
    v_mfma_f32_16x16x32_bf16 v[72:75], v[52:55], v[16:19], v[72:75]
    ds_read2_b32 v[108:109], v132 offset0:0 offset1:0
    ds_read2_b32 v[110:111], v132 offset0:16 offset1:16
    s_waitcnt lgkmcnt(8)
    v_mfma_f32_16x16x32_bf16 v[76:79], v[52:55], v[20:23], v[76:79]
    ds_read2_b32 v[112:113], v132 offset0:32 offset1:32
    ds_read2_b32 v[114:115], v132 offset0:48 offset1:48
    s_waitcnt lgkmcnt(9)
    v_mfma_f32_16x16x32_bf16 v[80:83], v[52:55], v[24:27], v[80:83]
    ds_read2_b32 v[124:125], v133 offset0:0 offset1:0
    ds_read2_b32 v[126:127], v133 offset0:16 offset1:16
    s_waitcnt lgkmcnt(9)
    v_mfma_f32_16x16x32_bf16 v[84:87], v[56:59], v[12:15], v[84:87]
    ds_read2_b32 v[128:129], v133 offset0:32 offset1:32
    ds_read2_b32 v[130:131], v133 offset0:48 offset1:48
    v_mfma_f32_16x16x32_bf16 v[88:91], v[56:59], v[16:19], v[88:91]
    ds_read2_b32 v[116:117], v132 offset0:128 offset1:128
    ds_read2_b32 v[118:119], v132 offset0:144 offset1:144
    v_mfma_f32_16x16x32_bf16 v[92:95], v[56:59], v[20:23], v[92:95]
    ds_read2_b32 v[120:121], v132 offset0:160 offset1:160
    ds_read2_b32 v[122:123], v132 offset0:176 offset1:176
    v_mfma_f32_16x16x32_bf16 v[96:99], v[56:59], v[24:27], v[96:99]
    s_waitcnt lgkmcnt(11)
    v_pk_fma_f32 v[68:69], v[100:101], v[108:109], v[68:69]
    v_pk_fma_f32 v[70:71], v[102:103], v[108:109], v[70:71]
    v_pk_fma_f32 v[84:85], v[104:105], v[108:109], v[84:85]
    v_pk_fma_f32 v[86:87], v[106:107], v[108:109], v[86:87]
    s_waitcnt lgkmcnt(10)
    v_pk_fma_f32 v[72:73], v[100:101], v[110:111], v[72:73]
    v_pk_fma_f32 v[74:75], v[102:103], v[110:111], v[74:75]
    v_pk_fma_f32 v[88:89], v[104:105], v[110:111], v[88:89]
    v_pk_fma_f32 v[90:91], v[106:107], v[110:111], v[90:91]
    s_waitcnt lgkmcnt(9)
    v_pk_fma_f32 v[76:77], v[100:101], v[112:113], v[76:77]
    v_pk_fma_f32 v[78:79], v[102:103], v[112:113], v[78:79]
    v_pk_fma_f32 v[92:93], v[104:105], v[112:113], v[92:93]
    v_pk_fma_f32 v[94:95], v[106:107], v[112:113], v[94:95]
    s_waitcnt lgkmcnt(8)
    v_pk_fma_f32 v[80:81], v[100:101], v[114:115], v[80:81]
    v_pk_fma_f32 v[82:83], v[102:103], v[114:115], v[82:83]
    v_pk_fma_f32 v[96:97], v[104:105], v[114:115], v[96:97]
    v_pk_fma_f32 v[98:99], v[106:107], v[114:115], v[98:99]
    s_waitcnt lgkmcnt(7)
    v_pk_mul_f32 v[12:13], v[68:69], v[124:125]
    v_pk_mul_f32 v[14:15], v[70:71], v[124:125]
    v_pk_mul_f32 v[16:17], v[84:85], v[124:125]
    v_pk_mul_f32 v[18:19], v[86:87], v[124:125]
    s_waitcnt lgkmcnt(6)
    v_pk_mul_f32 v[20:21], v[72:73], v[126:127]
    v_pk_mul_f32 v[22:23], v[74:75], v[126:127]
    v_pk_mul_f32 v[24:25], v[88:89], v[126:127]
    v_pk_mul_f32 v[26:27], v[90:91], v[126:127]
    s_waitcnt lgkmcnt(5)
    v_pk_mul_f32 v[28:29], v[76:77], v[128:129]
    v_pk_mul_f32 v[30:31], v[78:79], v[128:129]
    v_pk_mul_f32 v[32:33], v[92:93], v[128:129]
    v_pk_mul_f32 v[34:35], v[94:95], v[128:129]
    s_waitcnt lgkmcnt(4)
    v_pk_mul_f32 v[36:37], v[80:81], v[130:131]
    v_pk_mul_f32 v[38:39], v[82:83], v[130:131]
    v_pk_mul_f32 v[40:41], v[96:97], v[130:131]
    v_pk_mul_f32 v[42:43], v[98:99], v[130:131]
    s_waitcnt lgkmcnt(3)
    v_pk_fma_f32 v[68:69], v[68:69], v[116:117], s[40:41]
    v_pk_fma_f32 v[70:71], v[70:71], v[116:117], s[40:41]
    v_pk_fma_f32 v[84:85], v[84:85], v[116:117], s[40:41]
    v_pk_fma_f32 v[86:87], v[86:87], v[116:117], s[40:41]
    s_waitcnt lgkmcnt(2)
    v_pk_fma_f32 v[72:73], v[72:73], v[118:119], s[40:41]
    v_pk_fma_f32 v[74:75], v[74:75], v[118:119], s[40:41]
    v_pk_fma_f32 v[88:89], v[88:89], v[118:119], s[40:41]
    v_pk_fma_f32 v[90:91], v[90:91], v[118:119], s[40:41]
    s_waitcnt lgkmcnt(1)
    v_pk_fma_f32 v[76:77], v[76:77], v[120:121], s[40:41]
    v_pk_fma_f32 v[78:79], v[78:79], v[120:121], s[40:41]
    v_pk_fma_f32 v[92:93], v[92:93], v[120:121], s[40:41]
    v_pk_fma_f32 v[94:95], v[94:95], v[120:121], s[40:41]
    s_waitcnt lgkmcnt(0)
    v_pk_fma_f32 v[80:81], v[80:81], v[122:123], s[40:41]
    v_pk_fma_f32 v[82:83], v[82:83], v[122:123], s[40:41]
    v_pk_fma_f32 v[96:97], v[96:97], v[122:123], s[40:41]
    v_pk_fma_f32 v[98:99], v[98:99], v[122:123], s[40:41]
    v_exp_f32 v12, v12 clamp
    v_exp_f32 v13, v13 clamp
    v_exp_f32 v14, v14 clamp
    v_exp_f32 v15, v15 clamp
    v_exp_f32 v16, v16 clamp
    v_exp_f32 v17, v17 clamp
    v_exp_f32 v18, v18 clamp
    v_exp_f32 v19, v19 clamp
    v_exp_f32 v20, v20 clamp
    v_exp_f32 v21, v21 clamp
    v_exp_f32 v22, v22 clamp
    v_exp_f32 v23, v23 clamp
    v_exp_f32 v24, v24 clamp
    v_exp_f32 v25, v25 clamp
    v_exp_f32 v26, v26 clamp
    v_exp_f32 v27, v27 clamp
    v_exp_f32 v28, v28 clamp
    v_exp_f32 v29, v29 clamp
    v_exp_f32 v30, v30 clamp
    v_exp_f32 v31, v31 clamp
    v_exp_f32 v32, v32 clamp
    v_exp_f32 v33, v33 clamp
    v_exp_f32 v34, v34 clamp
    v_exp_f32 v35, v35 clamp
    v_exp_f32 v36, v36 clamp
    v_exp_f32 v37, v37 clamp
    v_exp_f32 v38, v38 clamp
    v_exp_f32 v39, v39 clamp
    v_exp_f32 v40, v40 clamp
    v_exp_f32 v41, v41 clamp
    v_exp_f32 v42, v42 clamp
    v_exp_f32 v43, v43 clamp
    v_pk_add_f32 v[12:13], v[12:13], s[74:75]
    v_pk_add_f32 v[14:15], v[14:15], s[74:75]
    v_pk_add_f32 v[16:17], v[16:17], s[74:75]
    v_pk_add_f32 v[18:19], v[18:19], s[74:75]
    v_pk_add_f32 v[20:21], v[20:21], s[74:75]
    v_pk_add_f32 v[22:23], v[22:23], s[74:75]
    v_pk_add_f32 v[24:25], v[24:25], s[74:75]
    v_pk_add_f32 v[26:27], v[26:27], s[74:75]
    v_pk_add_f32 v[28:29], v[28:29], s[74:75]
    v_pk_add_f32 v[30:31], v[30:31], s[74:75]
    v_pk_add_f32 v[32:33], v[32:33], s[74:75]
    v_pk_add_f32 v[34:35], v[34:35], s[74:75]
    v_pk_add_f32 v[36:37], v[36:37], s[74:75]
    v_pk_add_f32 v[38:39], v[38:39], s[74:75]
    v_pk_add_f32 v[40:41], v[40:41], s[74:75]
    v_pk_add_f32 v[42:43], v[42:43], s[74:75]
    v_max_f32 v68, v68, v12
    v_max_f32 v69, v69, v13
    v_max_f32 v70, v70, v14
    v_max_f32 v71, v71, v15
    v_max_f32 v84, v84, v16
    v_max_f32 v85, v85, v17
    v_max_f32 v86, v86, v18
    v_max_f32 v87, v87, v19
    v_max_f32 v72, v72, v20
    v_max_f32 v73, v73, v21
    v_max_f32 v74, v74, v22
    v_max_f32 v75, v75, v23
    v_max_f32 v88, v88, v24
    v_max_f32 v89, v89, v25
    v_max_f32 v90, v90, v26
    v_max_f32 v91, v91, v27
    v_max_f32 v76, v76, v28
    v_max_f32 v77, v77, v29
    v_max_f32 v78, v78, v30
    v_max_f32 v79, v79, v31
    v_max_f32 v92, v92, v32
    v_max_f32 v93, v93, v33
    v_max_f32 v94, v94, v34
    v_max_f32 v95, v95, v35
    v_max_f32 v80, v80, v36
    v_max_f32 v81, v81, v37
    v_max_f32 v82, v82, v38
    v_max_f32 v83, v83, v39
    v_max_f32 v96, v96, v40
    v_max_f32 v97, v97, v41
    v_max_f32 v98, v98, v42
    v_max_f32 v99, v99, v43
    v_cvt_pk_bf16_f32 v44, v68, v69
    v_cvt_pk_bf16_f32 v45, v70, v71
    v_cvt_pk_bf16_f32 v46, v84, v85
    v_cvt_pk_bf16_f32 v47, v86, v87
    v_cvt_pk_bf16_f32 v48, v72, v73
    v_cvt_pk_bf16_f32 v49, v74, v75
    v_cvt_pk_bf16_f32 v50, v88, v89
    v_cvt_pk_bf16_f32 v51, v90, v91
    v_cvt_pk_bf16_f32 v52, v76, v77
    v_cvt_pk_bf16_f32 v53, v78, v79
    v_cvt_pk_bf16_f32 v54, v92, v93
    v_cvt_pk_bf16_f32 v55, v94, v95
    v_cvt_pk_bf16_f32 v56, v80, v81
    v_cvt_pk_bf16_f32 v57, v82, v83
    v_cvt_pk_bf16_f32 v58, v96, v97
    v_cvt_pk_bf16_f32 v59, v98, v99
    s_and_b32 s44, s46, 127
    s_lshl_b32 s44, s44, 2
    s_add_u32 s44, s44, 24832
    v_and_b32 v1, 15, v0
    v_lshl_add_u32 v63, v1, 2, s44

    v_lshrrev_b32 v2, 4, v0
    v_bfe_u32 v1, v0, 2, 2
    v_lshl_add_u32 v1, v2, 2, v1
    v_and_b32 v2, 7, v1
    s_lshl_b32 s44, s3, 1
    v_xor_b32 v2, s44, v2
    v_lshlrev_b32 v2, 5, v2
    v_lshl_add_u32 v2, v1, 8, v2
    v_and_b32 v1, 3, v0
    v_lshl_add_u32 v2, v1, 3, v2
    v_add_u32 v128, 65536, v2
    v_xor_b32 v129, 32, v128
    v_add_u32 v130, 122880, v2
    v_xor_b32 v131, 32, v130
    v_lshlrev_b32_e64 v2, 2, v1
    v_add_u32 v2, 24672, v2

    ds_read2_b32 v[4:5], v63 offset0:0 offset1:0
    ds_read2_b32 v[6:7], v63 offset0:16 offset1:16
    ds_read2_b32 v[8:9], v63 offset0:32 offset1:32
    ds_read2_b32 v[10:11], v63 offset0:48 offset1:48
    ds_read2_b32 v[12:13], v63 offset0:128 offset1:128
    ds_read2_b32 v[14:15], v63 offset0:144 offset1:144
    ds_read2_b32 v[16:17], v63 offset0:160 offset1:160
    ds_read2_b32 v[18:19], v63 offset0:176 offset1:176
    v_lshlrev_b32 v60, 4, v0
    v_and_b32 v61, 48, v0
    s_setprio 2
SP_1:
    s_load_dword s58, s[56:57], 0 glc
    s_waitcnt lgkmcnt(0)
    s_cmp_ge_u32 s58, 32
    s_cbranch_scc1 SD_2
    s_sleep 1
    s_branch SP_1
SD_2:
F_kp:
    buffer_load_dwordx4 v[36:39], v61, s[24:27], s83 offen offset:0 sc0 sc1
    buffer_load_dwordx4 v[40:43], v61, s[24:27], s83 offen offset:64 sc0 sc1
    buffer_load_dwordx4 v[20:23], v60, s[24:27], s82 offen offset:0 sc0 sc1
    buffer_load_dwordx4 v[24:27], v60, s[24:27], s82 offen offset:2048 sc0 sc1
    buffer_load_dwordx4 v[28:31], v60, s[24:27], s82 offen offset:1024 sc0 sc1
    buffer_load_dwordx4 v[32:35], v60, s[24:27], s82 offen offset:3072 sc0 sc1
    v_mov_b32 v62, 4
    s_mov_b64 exec, 1
    ds_write_b32 v3, v62 offset:0
    s_mov_b64 exec, -1
    s_waitcnt vmcnt(4)
    v_cvt_pk_bf16_f32 v124, v36, v37
    v_cvt_pk_bf16_f32 v125, v38, v39
    v_cvt_pk_bf16_f32 v126, v40, v41
    v_cvt_pk_bf16_f32 v127, v42, v43
    s_nop 1
    v_mfma_f32_16x16x32_bf16 v[76:79], v[124:127], v[44:47], 0
    v_mfma_f32_16x16x32_bf16 v[88:91], v[124:127], v[48:51], 0
    v_mfma_f32_16x16x32_bf16 v[100:103], v[124:127], v[52:55], 0
    v_mfma_f32_16x16x32_bf16 v[112:115], v[124:127], v[56:59], 0
    s_waitcnt vmcnt(2)
    v_cvt_pk_bf16_f32 v116, v20, v21
    v_cvt_pk_bf16_f32 v117, v22, v23
    v_cvt_pk_bf16_f32 v118, v24, v25
    v_cvt_pk_bf16_f32 v119, v26, v27
    s_nop 1
    v_mfma_f32_16x16x32_bf16 v[68:71], v[116:119], v[44:47], 0
    v_mfma_f32_16x16x32_bf16 v[80:83], v[116:119], v[48:51], 0
    v_mfma_f32_16x16x32_bf16 v[92:95], v[116:119], v[52:55], 0
    v_mfma_f32_16x16x32_bf16 v[104:107], v[116:119], v[56:59], 0
    v_add_f32 v76, s74, v76
    v_rcp_f32 v76, v76
    s_nop 0
    v_mov_b32 v77, v76
    v_add_f32 v88, s74, v88
    v_rcp_f32 v88, v88
    s_nop 0
    v_mov_b32 v89, v88
    v_add_f32 v100, s74, v100
    v_rcp_f32 v100, v100
    s_nop 0
    v_mov_b32 v101, v100
    v_add_f32 v112, s74, v112
    v_rcp_f32 v112, v112
    s_nop 0
    v_mov_b32_e64 v113, v112
    s_waitcnt vmcnt(0)
    v_cvt_pk_bf16_f32 v120, v28, v29
    v_cvt_pk_bf16_f32 v121, v30, v31
    v_cvt_pk_bf16_f32 v122, v32, v33
    v_cvt_pk_bf16_f32 v123, v34, v35
    s_nop 1
    v_mfma_f32_16x16x32_bf16 v[72:75], v[120:123], v[44:47], 0
    v_mfma_f32_16x16x32_bf16 v[84:87], v[120:123], v[48:51], 0
    v_mfma_f32_16x16x32_bf16 v[96:99], v[120:123], v[52:55], 0
    v_mfma_f32_16x16x32_bf16 v[108:111], v[120:123], v[56:59], 0
    s_add_u32 s80, s79, 0
    v_pk_mul_f32 v[68:69], v[68:69], v[76:77]
    v_pk_mul_f32 v[70:71], v[70:71], v[76:77]
    s_nop 1
    v_pk_mul_f32 v[72:73], v[72:73], v[76:77]
    v_pk_mul_f32 v[74:75], v[74:75], v[76:77]
    v_cvt_pk_bf16_f32 v28, v68, v69
    v_cvt_pk_bf16_f32 v29, v70, v71
    v_cvt_pk_bf16_f32 v30, v72, v73
    v_cvt_pk_bf16_f32 v31, v74, v75
    buffer_store_dwordx4 v[28:31], v60, s[16:19], s80 offen sc0 sc1
    s_add_u32 s80, s79, 32768
    v_pk_mul_f32 v[80:81], v[80:81], v[88:89]
    v_pk_mul_f32 v[82:83], v[82:83], v[88:89]
    v_pk_mul_f32 v[84:85], v[84:85], v[88:89]
    v_pk_mul_f32 v[86:87], v[86:87], v[88:89]
    v_cvt_pk_bf16_f32 v32, v80, v81
    v_cvt_pk_bf16_f32 v33, v82, v83
    v_cvt_pk_bf16_f32 v34, v84, v85
    v_cvt_pk_bf16_f32 v35, v86, v87
    buffer_store_dwordx4 v[32:35], v60, s[16:19], s80 offen sc0 sc1
    s_add_u32 s80, s79, 65536
    v_pk_mul_f32 v[92:93], v[92:93], v[100:101]
    v_pk_mul_f32 v[94:95], v[94:95], v[100:101]
    v_pk_mul_f32 v[96:97], v[96:97], v[100:101]
    v_pk_mul_f32 v[98:99], v[98:99], v[100:101]
    v_cvt_pk_bf16_f32 v36, v92, v93
    v_cvt_pk_bf16_f32 v37, v94, v95
    v_cvt_pk_bf16_f32 v38, v96, v97
    v_cvt_pk_bf16_f32 v39, v98, v99
    buffer_store_dwordx4 v[36:39], v60, s[16:19], s80 offen sc0 sc1
    s_add_u32 s80, s79, 98304
    v_pk_mul_f32 v[104:105], v[104:105], v[112:113]
    v_pk_mul_f32 v[106:107], v[106:107], v[112:113]
    v_pk_mul_f32 v[108:109], v[108:109], v[112:113]
    v_pk_mul_f32 v[110:111], v[110:111], v[112:113]
    v_cvt_pk_bf16_f32 v40, v104, v105
    v_cvt_pk_bf16_f32 v41, v106, v107
    v_cvt_pk_bf16_f32 v42, v108, v109
    v_cvt_pk_bf16_f32 v43, v110, v111
    buffer_store_dwordx4 v[40:43], v60, s[16:19], s80 offen sc0 sc1
    v_lshlrev_b32 v132, 16, v148
    v_and_b32 v133, 0xffff0000, v148
    v_lshlrev_b32 v134, 16, v149
    v_and_b32 v135, 0xffff0000, v149
    v_lshlrev_b32 v136, 16, v150
    v_and_b32 v137, 0xffff0000, v150
    v_lshlrev_b32 v138, 16, v151
    v_and_b32 v139, 0xffff0000, v151
    v_pk_add_f32 v[76:77], v[132:133], v[4:5]
    v_pk_add_f32 v[78:79], v[134:135], v[4:5]
    v_pk_add_f32 v[80:81], v[136:137], v[4:5]
    v_pk_add_f32 v[82:83], v[138:139], v[4:5]
    v_cvt_pk_bf16_f32 v72, v76, v77
    v_cvt_pk_bf16_f32 v73, v78, v79
    v_cvt_pk_bf16_f32 v74, v80, v81
    v_cvt_pk_bf16_f32 v75, v82, v83
    v_lshlrev_b32 v76, 16, v72
    v_and_b32 v77, 0xffff0000, v72
    v_lshlrev_b32 v78, 16, v73
    v_and_b32 v79, 0xffff0000, v73
    v_lshlrev_b32 v80, 16, v74
    v_and_b32 v81, 0xffff0000, v74
    v_lshlrev_b32 v82, 16, v75
    v_and_b32 v83, 0xffff0000, v75
    v_pk_mul_f32 v[76:77], v[76:77], v[12:13]
    v_pk_mul_f32 v[78:79], v[78:79], v[12:13]
    v_pk_mul_f32 v[80:81], v[80:81], v[12:13]
    v_pk_mul_f32 v[82:83], v[82:83], v[12:13]
    v_cvt_pk_bf16_f32 v72, v76, v77
    v_cvt_pk_bf16_f32 v73, v78, v79
    v_cvt_pk_bf16_f32 v74, v80, v81
    v_cvt_pk_bf16_f32 v75, v82, v83
    v_lshlrev_b32 v76, 16, v72
    v_and_b32 v77, 0xffff0000, v72
    v_lshlrev_b32 v78, 16, v73
    v_and_b32 v79, 0xffff0000, v73
    v_lshlrev_b32 v80, 16, v74
    v_and_b32 v81, 0xffff0000, v74
    v_lshlrev_b32 v82, 16, v75
    v_and_b32 v83, 0xffff0000, v75
    v_pk_add_f32 v[132:133], v[132:133], v[76:77]
    v_pk_add_f32 v[134:135], v[134:135], v[78:79]
    v_pk_add_f32 v[136:137], v[136:137], v[80:81]
    v_pk_add_f32 v[138:139], v[138:139], v[82:83]
    v_lshlrev_b32 v140, 16, v152
    v_and_b32 v141, 0xffff0000, v152
    v_lshlrev_b32 v142, 16, v153
    v_and_b32 v143, 0xffff0000, v153
    v_lshlrev_b32 v144, 16, v154
    v_and_b32 v145, 0xffff0000, v154
    v_lshlrev_b32 v146, 16, v155
    v_and_b32 v147, 0xffff0000, v155
    v_pk_add_f32 v[76:77], v[140:141], v[6:7]
    v_pk_add_f32 v[78:79], v[142:143], v[6:7]
    v_pk_add_f32 v[80:81], v[144:145], v[6:7]
    v_pk_add_f32 v[82:83], v[146:147], v[6:7]
    v_cvt_pk_bf16_f32 v72, v76, v77
    v_cvt_pk_bf16_f32 v73, v78, v79
    v_cvt_pk_bf16_f32 v74, v80, v81
    v_cvt_pk_bf16_f32 v75, v82, v83
    v_lshlrev_b32 v76, 16, v72
    v_and_b32 v77, 0xffff0000, v72
    v_lshlrev_b32 v78, 16, v73
    v_and_b32 v79, 0xffff0000, v73
    v_lshlrev_b32 v80, 16, v74
    v_and_b32 v81, 0xffff0000, v74
    v_lshlrev_b32 v82, 16, v75
    v_and_b32 v83, 0xffff0000, v75
    v_pk_mul_f32 v[76:77], v[76:77], v[14:15]
    v_pk_mul_f32 v[78:79], v[78:79], v[14:15]
    v_pk_mul_f32 v[80:81], v[80:81], v[14:15]
    v_pk_mul_f32 v[82:83], v[82:83], v[14:15]
    v_cvt_pk_bf16_f32 v72, v76, v77
    v_cvt_pk_bf16_f32 v73, v78, v79
    v_cvt_pk_bf16_f32 v74, v80, v81
    v_cvt_pk_bf16_f32 v75, v82, v83
    v_lshlrev_b32 v76, 16, v72
    v_and_b32 v77, 0xffff0000, v72
    v_lshlrev_b32 v78, 16, v73
    v_and_b32 v79, 0xffff0000, v73
    v_lshlrev_b32 v80, 16, v74
    v_and_b32 v81, 0xffff0000, v74
    v_lshlrev_b32 v82, 16, v75
    v_and_b32 v83, 0xffff0000, v75
    v_pk_add_f32 v[140:141], v[140:141], v[76:77]
    v_pk_add_f32 v[142:143], v[142:143], v[78:79]
    v_pk_add_f32 v[144:145], v[144:145], v[80:81]
    v_pk_add_f32 v[146:147], v[146:147], v[82:83]
    v_mov_b32 v62, 5
    s_waitcnt vmcnt(0)
    s_atomic_add s76, s[68:69], 0
    s_atomic_add s76, s[68:69], 128
    s_atomic_add s76, s[68:69], 256
    s_atomic_add s76, s[68:69], 384
    s_mov_b64 exec, 1
    ds_write_b32 v3, v62
    s_mov_b64 exec, -1
    s_setprio 0
    v_lshlrev_b32 v148, 16, v156
    v_and_b32 v149, 0xffff0000, v156
    v_lshlrev_b32 v150, 16, v157
    v_and_b32 v151, 0xffff0000, v157
    v_lshlrev_b32 v152, 16, v158
    v_and_b32 v153, 0xffff0000, v158
    v_lshlrev_b32_e64 v154, 16, v159
    v_and_b32 v155, 0xffff0000, v159
    v_pk_add_f32 v[76:77], v[148:149], v[8:9]
    v_pk_add_f32 v[78:79], v[150:151], v[8:9]
    v_pk_add_f32 v[80:81], v[152:153], v[8:9]
    v_pk_add_f32 v[82:83], v[154:155], v[8:9]
    v_cvt_pk_bf16_f32 v72, v76, v77
    v_cvt_pk_bf16_f32 v73, v78, v79
    v_cvt_pk_bf16_f32 v74, v80, v81
    v_cvt_pk_bf16_f32 v75, v82, v83
    v_lshlrev_b32 v76, 16, v72
    v_and_b32 v77, 0xffff0000, v72
    v_lshlrev_b32 v78, 16, v73
    v_and_b32 v79, 0xffff0000, v73
    v_lshlrev_b32 v80, 16, v74
    v_and_b32 v81, 0xffff0000, v74
    v_lshlrev_b32 v82, 16, v75
    v_and_b32 v83, 0xffff0000, v75
    v_pk_mul_f32 v[76:77], v[76:77], v[16:17]
    v_pk_mul_f32 v[78:79], v[78:79], v[16:17]
    v_pk_mul_f32 v[80:81], v[80:81], v[16:17]
    v_pk_mul_f32 v[82:83], v[82:83], v[16:17]
    v_cvt_pk_bf16_f32 v72, v76, v77
    v_cvt_pk_bf16_f32 v73, v78, v79
    v_cvt_pk_bf16_f32 v74, v80, v81
    v_cvt_pk_bf16_f32 v75, v82, v83
    v_lshlrev_b32 v76, 16, v72
    v_and_b32 v77, 0xffff0000, v72
    v_lshlrev_b32 v78, 16, v73
    v_and_b32 v79, 0xffff0000, v73
    v_lshlrev_b32 v80, 16, v74
    v_and_b32 v81, 0xffff0000, v74
    v_lshlrev_b32 v82, 16, v75
    v_and_b32 v83, 0xffff0000, v75
    v_pk_add_f32 v[148:149], v[148:149], v[76:77]
    v_pk_add_f32 v[150:151], v[150:151], v[78:79]
    v_pk_add_f32 v[152:153], v[152:153], v[80:81]
    v_pk_add_f32 v[154:155], v[154:155], v[82:83]
    v_lshlrev_b32 v156, 16, v160
    v_and_b32 v157, 0xffff0000, v160
    v_lshlrev_b32 v158, 16, v161
    v_and_b32 v159, 0xffff0000, v161
    v_lshlrev_b32 v160, 16, v162
    v_and_b32 v161, 0xffff0000, v162
    v_lshlrev_b32 v162, 16, v163
    v_and_b32 v163, 0xffff0000, v163
    v_pk_add_f32 v[76:77], v[156:157], v[10:11]
    v_pk_add_f32 v[78:79], v[158:159], v[10:11]
    v_pk_add_f32 v[80:81], v[160:161], v[10:11]
    v_pk_add_f32 v[82:83], v[162:163], v[10:11]
    v_cvt_pk_bf16_f32 v72, v76, v77
    v_cvt_pk_bf16_f32 v73, v78, v79
    v_cvt_pk_bf16_f32 v74, v80, v81
    v_cvt_pk_bf16_f32 v75, v82, v83
    v_lshlrev_b32 v76, 16, v72
    v_and_b32 v77, 0xffff0000, v72
    v_lshlrev_b32 v78, 16, v73
    v_and_b32 v79, 0xffff0000, v73
    v_lshlrev_b32 v80, 16, v74
    v_and_b32 v81, 0xffff0000, v74
    v_lshlrev_b32 v82, 16, v75
    v_and_b32 v83, 0xffff0000, v75
    v_pk_mul_f32 v[76:77], v[76:77], v[18:19]
    v_pk_mul_f32 v[78:79], v[78:79], v[18:19]
    v_pk_mul_f32 v[80:81], v[80:81], v[18:19]
    v_pk_mul_f32 v[82:83], v[82:83], v[18:19]
    v_cvt_pk_bf16_f32 v72, v76, v77
    v_cvt_pk_bf16_f32 v73, v78, v79
    v_cvt_pk_bf16_f32 v74, v80, v81
    v_cvt_pk_bf16_f32 v75, v82, v83
    v_lshlrev_b32 v76, 16, v72
    v_and_b32 v77, 0xffff0000, v72
    v_lshlrev_b32 v78, 16, v73
    v_and_b32 v79, 0xffff0000, v73
    v_lshlrev_b32 v80, 16, v74
    v_and_b32 v81, 0xffff0000, v74
    v_lshlrev_b32 v82, 16, v75
    v_and_b32 v83, 0xffff0000, v75
    v_pk_add_f32 v[156:157], v[156:157], v[76:77]
    v_pk_add_f32 v[158:159], v[158:159], v[78:79]
    v_pk_add_f32 v[160:161], v[160:161], v[80:81]
    v_pk_add_f32 v[162:163], v[162:163], v[82:83]
    v_lshlrev_b32 v4, 4, v0
    v_add_u32 v5, 98304, v4
    v_add_u32 v4, 16384, v4
    v_subrev_u32 v8, 65536, v128
    v_subrev_u32 v9, 65536, v129
    v_and_b32 v1, 15, v0
    s_lshl_b32 s44, s3, 6
    s_add_u32 s44, s44, 0
    v_lshrrev_b32 v18, 4, v0
    v_lshl_add_u32 v18, v18, 3, s44
    v_mul_u32_u24 v19, 272, v1
    v_add_u32_e64 v18, v18, v19
    v_add_u32 v19, 4352, v18
    v_add_u32 v20, 8704, v18
    v_add_u32 v21, 13056, v18

    s_setprio 2
    s_waitcnt lgkmcnt(0)
    s_barrier
    ds_read_b64_tr_b16 v[40:41], v130 offset:24576
    ds_read_b64_tr_b16 v[42:43], v130 offset:28672
    ds_read_b128 v[24:27], v4 offset:0
    ds_read_b64_tr_b16 v[64:65], v130 offset:32768
    ds_read_b64_tr_b16 v[66:67], v130 offset:36864
    ds_read_b128 v[48:51], v4 offset:1024
    ds_read_b64_tr_b16 v[44:45], v131 offset:24576
    ds_read_b64_tr_b16 v[46:47], v131 offset:28672
    ds_read_b64_tr_b16 v[68:69], v131 offset:32768
    ds_read_b64_tr_b16 v[70:71], v131 offset:36864
    ds_read_b128 v[28:31], v4 offset:2048
    ds_read_b128 v[52:55], v4 offset:3072
    ds_read_b128 v[32:35], v4 offset:4096
    ds_read_b128 v[56:59], v4 offset:5120
    ds_read_b128 v[36:39], v4 offset:6144
    s_waitcnt lgkmcnt(8)
    ds_read_b128 v[60:63], v4 offset:7168
    s_waitcnt lgkmcnt(13)
    v_mfma_f32_16x16x32_bf16 v[132:135], v[40:43], v[24:27], v[132:135]
    s_waitcnt lgkmcnt(10)
    v_mfma_f32_16x16x32_bf16 v[132:135], v[64:67], v[48:51], v[132:135]
    s_waitcnt lgkmcnt(8)
    v_mfma_f32_16x16x32_bf16 v[136:139], v[44:47], v[24:27], v[136:139]
    s_waitcnt lgkmcnt(6)
    v_mfma_f32_16x16x32_bf16 v[136:139], v[68:71], v[48:51], v[136:139]
    s_waitcnt lgkmcnt(5)
    v_mfma_f32_16x16x32_bf16 v[140:143], v[40:43], v[28:31], v[140:143]
    s_waitcnt lgkmcnt(4)
    v_mfma_f32_16x16x32_bf16 v[140:143], v[64:67], v[52:55], v[140:143]
    s_waitcnt lgkmcnt(0)
    s_barrier
    ds_read_b64_tr_b16 v[88:89], v128 offset:0
    ds_read_b64_tr_b16 v[90:91], v128 offset:4096
    v_mfma_f32_16x16x32_bf16 v[144:147], v[44:47], v[28:31], v[144:147]
    ds_read_b128 v[72:75], v5 offset:0
    ds_read_b64_tr_b16 v[112:113], v128 offset:8192
    v_mfma_f32_16x16x32_bf16 v[144:147], v[68:71], v[52:55], v[144:147]
    ds_read_b64_tr_b16 v[114:115], v128 offset:12288
    ds_read_b128 v[96:99], v5 offset:1024
    v_mfma_f32_16x16x32_bf16 v[148:151], v[40:43], v[32:35], v[148:151]
    ds_read_b64_tr_b16 v[92:93], v129 offset:0
    ds_read_b64_tr_b16 v[94:95], v129 offset:4096
    v_mfma_f32_16x16x32_bf16 v[148:151], v[64:67], v[56:59], v[148:151]
    ds_read_b64_tr_b16 v[116:117], v129 offset:8192
    ds_read_b64_tr_b16 v[118:119], v129 offset:12288
    v_mfma_f32_16x16x32_bf16 v[152:155], v[44:47], v[32:35], v[152:155]
    ds_read_b128 v[76:79], v5 offset:2048
    ds_read_b128 v[100:103], v5 offset:3072
    v_mfma_f32_16x16x32_bf16 v[152:155], v[68:71], v[56:59], v[152:155]
    ds_read_b128 v[80:83], v5 offset:4096
    ds_read_b128 v[104:107], v5 offset:5120
    v_mfma_f32_16x16x32_bf16 v[156:159], v[40:43], v[36:39], v[156:159]
    s_waitcnt lgkmcnt(8)
    ds_read_b128 v[84:87], v5 offset:6144
    ds_read_b128 v[108:111], v5 offset:7168
    v_mfma_f32_16x16x32_bf16 v[156:159], v[64:67], v[60:63], v[156:159]
    v_mfma_f32_16x16x32_bf16 v[160:163], v[44:47], v[36:39], v[160:163]
    v_mfma_f32_16x16x32_bf16 v[160:163], v[68:71], v[60:63], v[160:163]
    s_waitcnt lgkmcnt(4)
    v_mfma_f32_16x16x32_bf16 v[132:135], v[88:91], v[72:75], v[132:135]
    v_mfma_f32_16x16x32_bf16 v[132:135], v[112:115], v[96:99], v[132:135]
    s_waitcnt lgkmcnt(0)
    s_barrier
    ds_read_b64_tr_b16 v[40:41], v8 offset:0
    ds_read_b64_tr_b16 v[42:43], v8 offset:4096
    v_mfma_f32_16x16x32_bf16 v[136:139], v[92:95], v[72:75], v[136:139]
    ds_read_b128 v[24:27], v5 offset:40960
    ds_read_b64_tr_b16 v[64:65], v8 offset:8192
    v_mfma_f32_16x16x32_bf16 v[136:139], v[116:119], v[96:99], v[136:139]
    ds_read_b64_tr_b16 v[66:67], v8 offset:12288
    ds_read_b128 v[48:51], v5 offset:41984
    v_mfma_f32_16x16x32_bf16 v[140:143], v[88:91], v[76:79], v[140:143]
    ds_read_b64_tr_b16 v[44:45], v9 offset:0
    ds_read_b64_tr_b16 v[46:47], v9 offset:4096
    v_mfma_f32_16x16x32_bf16 v[140:143], v[112:115], v[100:103], v[140:143]
    ds_read_b64_tr_b16 v[68:69], v9 offset:8192
    v_mfma_f32_16x16x32_bf16 v[144:147], v[92:95], v[76:79], v[144:147]
    ds_read_b64_tr_b16 v[70:71], v9 offset:12288
    v_mfma_f32_16x16x32_bf16 v[144:147], v[116:119], v[100:103], v[144:147]
    ds_read_b128 v[28:31], v5 offset:43008
    v_mfma_f32_16x16x32_bf16 v[148:151], v[88:91], v[80:83], v[148:151]
    ds_read_b128 v[52:55], v5 offset:44032
    v_mfma_f32_16x16x32_bf16 v[148:151], v[112:115], v[104:107], v[148:151]
    ds_read_b128 v[32:35], v5 offset:45056
    v_mfma_f32_16x16x32_bf16 v[152:155], v[92:95], v[80:83], v[152:155]
    ds_read_b128 v[56:59], v5 offset:46080
    v_mfma_f32_16x16x32_bf16 v[152:155], v[116:119], v[104:107], v[152:155]
    s_waitcnt lgkmcnt(8)
    ds_read_b128 v[36:39], v5 offset:47104
    v_mfma_f32_16x16x32_bf16 v[156:159], v[88:91], v[84:87], v[156:159]
    ds_read_b128 v[60:63], v5 offset:48128
    v_mfma_f32_16x16x32_bf16 v[156:159], v[112:115], v[108:111], v[156:159]
    v_mfma_f32_16x16x32_bf16 v[160:163], v[92:95], v[84:87], v[160:163]
    v_mfma_f32_16x16x32_bf16 v[160:163], v[116:119], v[108:111], v[160:163]
    s_waitcnt lgkmcnt(4)
    v_mfma_f32_16x16x32_bf16 v[132:135], v[40:43], v[24:27], v[132:135]
    v_mfma_f32_16x16x32_bf16 v[132:135], v[64:67], v[48:51], v[132:135]
    s_waitcnt lgkmcnt(0)
    s_barrier
    ds_read_b64_tr_b16 v[88:89], v8 offset:40960
    ds_read_b64_tr_b16 v[90:91], v8 offset:45056
    v_mfma_f32_16x16x32_bf16 v[136:139], v[44:47], v[24:27], v[136:139]
    ds_read_b128 v[72:75], v4 offset:40960
    ds_read_b64_tr_b16 v[112:113], v8 offset:49152
    v_mfma_f32_16x16x32_bf16 v[136:139], v[68:71], v[48:51], v[136:139]
    ds_read_b64_tr_b16 v[114:115], v8 offset:53248
    ds_read_b128 v[96:99], v4 offset:41984
    v_mfma_f32_16x16x32_bf16 v[140:143], v[40:43], v[28:31], v[140:143]
    ds_read_b64_tr_b16 v[92:93], v9 offset:40960
    ds_read_b64_tr_b16 v[94:95], v9 offset:45056
    v_mfma_f32_16x16x32_bf16 v[140:143], v[64:67], v[52:55], v[140:143]
    ds_read_b64_tr_b16 v[116:117], v9 offset:49152
    v_mfma_f32_16x16x32_bf16 v[144:147], v[44:47], v[28:31], v[144:147]
    ds_read_b64_tr_b16 v[118:119], v9 offset:53248
    v_mfma_f32_16x16x32_bf16 v[144:147], v[68:71], v[52:55], v[144:147]
    ds_read_b128 v[76:79], v4 offset:43008
    v_mfma_f32_16x16x32_bf16 v[148:151], v[40:43], v[32:35], v[148:151]
    ds_read_b128 v[100:103], v4 offset:44032
    v_mfma_f32_16x16x32_bf16 v[148:151], v[64:67], v[56:59], v[148:151]
    ds_read_b128 v[80:83], v4 offset:45056
    v_mfma_f32_16x16x32_bf16 v[152:155], v[44:47], v[32:35], v[152:155]
    ds_read_b128 v[104:107], v4 offset:46080
    v_mfma_f32_16x16x32_bf16 v[152:155], v[68:71], v[56:59], v[152:155]
    s_waitcnt lgkmcnt(8)
    ds_read_b128 v[84:87], v4 offset:47104
    v_mfma_f32_16x16x32_bf16 v[156:159], v[40:43], v[36:39], v[156:159]
    ds_read_b128 v[108:111], v4 offset:48128
    v_mfma_f32_16x16x32_bf16 v[156:159], v[64:67], v[60:63], v[156:159]
    v_mfma_f32_16x16x32_bf16 v[160:163], v[44:47], v[36:39], v[160:163]
    v_mfma_f32_16x16x32_bf16 v[160:163], v[68:71], v[60:63], v[160:163]
    s_waitcnt lgkmcnt(4)
    v_mfma_f32_16x16x32_bf16 v[132:135], v[88:91], v[72:75], v[132:135]
    v_mfma_f32_16x16x32_bf16 v[132:135], v[112:115], v[96:99], v[132:135]
    s_waitcnt lgkmcnt(0)
    s_barrier
    ds_read_b64_tr_b16 v[40:41], v128 offset:16384
    ds_read_b64_tr_b16 v[42:43], v128 offset:20480
    v_mfma_f32_16x16x32_bf16 v[136:139], v[92:95], v[72:75], v[136:139]
    ds_read_b128 v[24:27], v4 offset:0
    ds_read_b64_tr_b16 v[64:65], v128 offset:24576
    v_mfma_f32_16x16x32_bf16 v[136:139], v[116:119], v[96:99], v[136:139]
    ds_read_b64_tr_b16 v[66:67], v128 offset:28672
    ds_read_b128 v[48:51], v4 offset:1024
    v_mfma_f32_16x16x32_bf16 v[140:143], v[88:91], v[76:79], v[140:143]
    ds_read_b64_tr_b16 v[44:45], v129 offset:16384
    ds_read_b64_tr_b16 v[46:47], v129 offset:20480
    v_mfma_f32_16x16x32_bf16 v[140:143], v[112:115], v[100:103], v[140:143]
    ds_read_b64_tr_b16 v[68:69], v129 offset:24576
    v_mfma_f32_16x16x32_bf16 v[144:147], v[92:95], v[76:79], v[144:147]
    ds_read_b64_tr_b16 v[70:71], v129 offset:28672
    v_mfma_f32_16x16x32_bf16 v[144:147], v[116:119], v[100:103], v[144:147]
    ds_read_b128 v[28:31], v4 offset:2048
    v_mfma_f32_16x16x32_bf16 v[148:151], v[88:91], v[80:83], v[148:151]
    ds_read_b128 v[52:55], v4 offset:3072
    v_mfma_f32_16x16x32_bf16 v[148:151], v[112:115], v[104:107], v[148:151]
    ds_read_b128 v[32:35], v4 offset:4096
    v_mfma_f32_16x16x32_bf16 v[152:155], v[92:95], v[80:83], v[152:155]
    ds_read_b128 v[56:59], v4 offset:5120
    v_mfma_f32_16x16x32_bf16 v[152:155], v[116:119], v[104:107], v[152:155]
    s_waitcnt lgkmcnt(8)
    ds_read_b128 v[36:39], v4 offset:6144
    v_mfma_f32_16x16x32_bf16 v[156:159], v[88:91], v[84:87], v[156:159]
    ds_read_b128 v[60:63], v4 offset:7168
    v_mfma_f32_16x16x32_bf16 v[156:159], v[112:115], v[108:111], v[156:159]
    v_mfma_f32_16x16x32_bf16 v[160:163], v[92:95], v[84:87], v[160:163]
    v_mfma_f32_16x16x32_bf16 v[160:163], v[116:119], v[108:111], v[160:163]
    s_waitcnt lgkmcnt(4)
    v_mfma_f32_16x16x32_bf16 v[132:135], v[40:43], v[24:27], v[132:135]
    v_mfma_f32_16x16x32_bf16 v[132:135], v[64:67], v[48:51], v[132:135]
    s_waitcnt lgkmcnt(0)
    s_barrier
    ds_read_b64_tr_b16 v[88:89], v130 offset:0
    ds_read_b64_tr_b16 v[90:91], v130 offset:4096
    v_mfma_f32_16x16x32_bf16 v[136:139], v[44:47], v[24:27], v[136:139]
    ds_read_b128 v[72:75], v5 offset:0
    ds_read_b64_tr_b16 v[112:113], v130 offset:8192
    v_mfma_f32_16x16x32_bf16 v[136:139], v[68:71], v[48:51], v[136:139]
    ds_read_b64_tr_b16 v[114:115], v130 offset:12288
    ds_read_b128 v[96:99], v5 offset:1024
    v_mfma_f32_16x16x32_bf16 v[140:143], v[40:43], v[28:31], v[140:143]
    ds_read_b64_tr_b16 v[92:93], v131 offset:0
    ds_read_b64_tr_b16 v[94:95], v131 offset:4096
    v_mfma_f32_16x16x32_bf16 v[140:143], v[64:67], v[52:55], v[140:143]
    ds_read_b64_tr_b16 v[116:117], v131 offset:8192
    v_mfma_f32_16x16x32_bf16 v[144:147], v[44:47], v[28:31], v[144:147]
    ds_read_b64_tr_b16 v[118:119], v131 offset:12288
    v_mfma_f32_16x16x32_bf16 v[144:147], v[68:71], v[52:55], v[144:147]
    ds_read_b128 v[76:79], v5 offset:2048
    v_mfma_f32_16x16x32_bf16 v[148:151], v[40:43], v[32:35], v[148:151]
    ds_read_b128 v[100:103], v5 offset:3072
    v_mfma_f32_16x16x32_bf16 v[148:151], v[64:67], v[56:59], v[148:151]
    ds_read_b128 v[80:83], v5 offset:4096
    v_mfma_f32_16x16x32_bf16 v[152:155], v[44:47], v[32:35], v[152:155]
    ds_read_b128 v[104:107], v5 offset:5120
    v_mfma_f32_16x16x32_bf16 v[152:155], v[68:71], v[56:59], v[152:155]
    s_waitcnt lgkmcnt(8)
    ds_read_b128 v[84:87], v5 offset:6144
    v_mfma_f32_16x16x32_bf16 v[156:159], v[40:43], v[36:39], v[156:159]
    ds_read_b128 v[108:111], v5 offset:7168
    v_mfma_f32_16x16x32_bf16 v[156:159], v[64:67], v[60:63], v[156:159]
    v_mfma_f32_16x16x32_bf16 v[160:163], v[44:47], v[36:39], v[160:163]
    v_mfma_f32_16x16x32_bf16 v[160:163], v[68:71], v[60:63], v[160:163]
    s_waitcnt lgkmcnt(4)
    v_mfma_f32_16x16x32_bf16 v[132:135], v[88:91], v[72:75], v[132:135]
    v_mfma_f32_16x16x32_bf16 v[132:135], v[112:115], v[96:99], v[132:135]
    s_waitcnt lgkmcnt(0)
    s_barrier
    ds_read_b64_tr_b16 v[40:41], v128 offset:40960
    ds_read_b64_tr_b16 v[42:43], v128 offset:45056
    v_mfma_f32_16x16x32_bf16 v[136:139], v[92:95], v[72:75], v[136:139]
    ds_read_b128 v[24:27], v5 offset:40960
    ds_read_b64_tr_b16 v[64:65], v128 offset:49152
    v_mfma_f32_16x16x32_bf16 v[136:139], v[116:119], v[96:99], v[136:139]
    ds_read_b64_tr_b16 v[66:67], v128 offset:53248
    ds_read_b128 v[48:51], v5 offset:41984
    v_mfma_f32_16x16x32_bf16 v[140:143], v[88:91], v[76:79], v[140:143]
    ds_read_b64_tr_b16 v[44:45], v129 offset:40960
    ds_read_b64_tr_b16 v[46:47], v129 offset:45056
    v_mfma_f32_16x16x32_bf16 v[140:143], v[112:115], v[100:103], v[140:143]
    ds_read_b64_tr_b16 v[68:69], v129 offset:49152
    v_mfma_f32_16x16x32_bf16 v[144:147], v[92:95], v[76:79], v[144:147]
    ds_read_b64_tr_b16 v[70:71], v129 offset:53248
    v_mfma_f32_16x16x32_bf16 v[144:147], v[116:119], v[100:103], v[144:147]
    ds_read_b128 v[28:31], v5 offset:43008
    v_mfma_f32_16x16x32_bf16 v[148:151], v[88:91], v[80:83], v[148:151]
    ds_read_b128 v[52:55], v5 offset:44032
    v_mfma_f32_16x16x32_bf16 v[148:151], v[112:115], v[104:107], v[148:151]
    ds_read_b128 v[32:35], v5 offset:45056
    v_mfma_f32_16x16x32_bf16 v[152:155], v[92:95], v[80:83], v[152:155]
    ds_read_b128 v[56:59], v5 offset:46080
    v_mfma_f32_16x16x32_bf16 v[152:155], v[116:119], v[104:107], v[152:155]
    s_waitcnt lgkmcnt(8)
    ds_read_b128 v[36:39], v5 offset:47104
    v_mfma_f32_16x16x32_bf16 v[156:159], v[88:91], v[84:87], v[156:159]
    ds_read_b128 v[60:63], v5 offset:48128
    v_mfma_f32_16x16x32_bf16 v[156:159], v[112:115], v[108:111], v[156:159]
    v_mfma_f32_16x16x32_bf16 v[160:163], v[92:95], v[84:87], v[160:163]
    v_mfma_f32_16x16x32_bf16 v[160:163], v[116:119], v[108:111], v[160:163]
    s_waitcnt lgkmcnt(4)
    v_mfma_f32_16x16x32_bf16 v[132:135], v[40:43], v[24:27], v[132:135]
    v_mfma_f32_16x16x32_bf16 v[132:135], v[64:67], v[48:51], v[132:135]
    s_waitcnt lgkmcnt(0)
    s_barrier
    ds_read_b64_tr_b16 v[88:89], v130 offset:24576
    ds_read_b64_tr_b16 v[90:91], v130 offset:28672
    v_mfma_f32_16x16x32_bf16 v[136:139], v[44:47], v[24:27], v[136:139]
    ds_read_b128 v[72:75], v4 offset:40960
    ds_read_b64_tr_b16 v[112:113], v130 offset:32768
    v_mfma_f32_16x16x32_bf16 v[136:139], v[68:71], v[48:51], v[136:139]
    ds_read_b64_tr_b16 v[114:115], v130 offset:36864
    ds_read_b128 v[96:99], v4 offset:41984
    v_mfma_f32_16x16x32_bf16 v[140:143], v[40:43], v[28:31], v[140:143]
    ds_read_b64_tr_b16 v[92:93], v131 offset:24576
    ds_read_b64_tr_b16 v[94:95], v131 offset:28672
    v_mfma_f32_16x16x32_bf16 v[140:143], v[64:67], v[52:55], v[140:143]
    ds_read_b64_tr_b16 v[116:117], v131 offset:32768
    v_mfma_f32_16x16x32_bf16 v[144:147], v[44:47], v[28:31], v[144:147]
    ds_read_b64_tr_b16 v[118:119], v131 offset:36864
    v_mfma_f32_16x16x32_bf16 v[144:147], v[68:71], v[52:55], v[144:147]
    ds_read_b128 v[76:79], v4 offset:43008
    v_mfma_f32_16x16x32_bf16 v[148:151], v[40:43], v[32:35], v[148:151]
    ds_read_b128 v[100:103], v4 offset:44032
    v_mfma_f32_16x16x32_bf16 v[148:151], v[64:67], v[56:59], v[148:151]
    ds_read_b128 v[80:83], v4 offset:45056
    v_mfma_f32_16x16x32_bf16 v[152:155], v[44:47], v[32:35], v[152:155]
    ds_read_b128 v[104:107], v4 offset:46080
    v_mfma_f32_16x16x32_bf16 v[152:155], v[68:71], v[56:59], v[152:155]
    s_waitcnt lgkmcnt(8)
    ds_read_b128 v[84:87], v4 offset:47104
    v_mfma_f32_16x16x32_bf16 v[156:159], v[40:43], v[36:39], v[156:159]
    ds_read_b128 v[108:111], v4 offset:48128
    v_mfma_f32_16x16x32_bf16 v[156:159], v[64:67], v[60:63], v[156:159]
    v_mfma_f32_16x16x32_bf16 v[160:163], v[44:47], v[36:39], v[160:163]
    v_mfma_f32_16x16x32_bf16 v[160:163], v[68:71], v[60:63], v[160:163]
    s_waitcnt lgkmcnt(4)
    v_mfma_f32_16x16x32_bf16 v[132:135], v[88:91], v[72:75], v[132:135]
    v_mfma_f32_16x16x32_bf16 v[132:135], v[112:115], v[96:99], v[132:135]
    s_waitcnt lgkmcnt(0)
    s_barrier
    ds_read_b64_tr_b16 v[40:41], v128 offset:0
    ds_read_b64_tr_b16 v[42:43], v128 offset:4096
    v_mfma_f32_16x16x32_bf16 v[136:139], v[92:95], v[72:75], v[136:139]
    ds_read_b128 v[24:27], v4 offset:0
    ds_read_b64_tr_b16 v[64:65], v128 offset:8192
    v_mfma_f32_16x16x32_bf16 v[136:139], v[116:119], v[96:99], v[136:139]
    ds_read_b64_tr_b16 v[66:67], v128 offset:12288
    ds_read_b128 v[48:51], v4 offset:1024
    v_mfma_f32_16x16x32_bf16 v[140:143], v[88:91], v[76:79], v[140:143]
    ds_read_b64_tr_b16 v[44:45], v129 offset:0
    ds_read_b64_tr_b16 v[46:47], v129 offset:4096
    v_mfma_f32_16x16x32_bf16 v[140:143], v[112:115], v[100:103], v[140:143]
    ds_read_b64_tr_b16 v[68:69], v129 offset:8192
    v_mfma_f32_16x16x32_bf16 v[144:147], v[92:95], v[76:79], v[144:147]
    ds_read_b64_tr_b16 v[70:71], v129 offset:12288
    v_mfma_f32_16x16x32_bf16 v[144:147], v[116:119], v[100:103], v[144:147]
    ds_read_b128 v[28:31], v4 offset:2048
    v_mfma_f32_16x16x32_bf16 v[148:151], v[88:91], v[80:83], v[148:151]
    ds_read_b128 v[52:55], v4 offset:3072
    v_mfma_f32_16x16x32_bf16 v[148:151], v[112:115], v[104:107], v[148:151]
    ds_read_b128 v[32:35], v4 offset:4096
    v_mfma_f32_16x16x32_bf16 v[152:155], v[92:95], v[80:83], v[152:155]
    ds_read_b128 v[56:59], v4 offset:5120
    v_mfma_f32_16x16x32_bf16 v[152:155], v[116:119], v[104:107], v[152:155]
    s_waitcnt lgkmcnt(8)
    ds_read_b128 v[36:39], v4 offset:6144
    v_mfma_f32_16x16x32_bf16 v[156:159], v[88:91], v[84:87], v[156:159]
    ds_read_b128 v[60:63], v4 offset:7168
    v_mfma_f32_16x16x32_bf16 v[156:159], v[112:115], v[108:111], v[156:159]
    v_mfma_f32_16x16x32_bf16 v[160:163], v[92:95], v[84:87], v[160:163]
    v_mfma_f32_16x16x32_bf16 v[160:163], v[116:119], v[108:111], v[160:163]
    s_waitcnt lgkmcnt(4)
    v_mfma_f32_16x16x32_bf16 v[132:135], v[40:43], v[24:27], v[132:135]
    v_mfma_f32_16x16x32_bf16 v[132:135], v[64:67], v[48:51], v[132:135]
    s_waitcnt lgkmcnt(0)
    s_barrier
    ds_read_b64_tr_b16 v[88:89], v8 offset:0
    ds_read_b64_tr_b16 v[90:91], v8 offset:4096
    v_mfma_f32_16x16x32_bf16 v[136:139], v[44:47], v[24:27], v[136:139]
    ds_read_b128 v[72:75], v5 offset:0
    ds_read_b64_tr_b16 v[112:113], v8 offset:8192
    v_mfma_f32_16x16x32_bf16 v[136:139], v[68:71], v[48:51], v[136:139]
    ds_read_b64_tr_b16 v[114:115], v8 offset:12288
    ds_read_b128 v[96:99], v5 offset:1024
    v_mfma_f32_16x16x32_bf16 v[140:143], v[40:43], v[28:31], v[140:143]
    ds_read_b64_tr_b16 v[92:93], v9 offset:0
    ds_read_b64_tr_b16 v[94:95], v9 offset:4096
    v_mfma_f32_16x16x32_bf16 v[140:143], v[64:67], v[52:55], v[140:143]
    ds_read_b64_tr_b16 v[116:117], v9 offset:8192
    v_mfma_f32_16x16x32_bf16 v[144:147], v[44:47], v[28:31], v[144:147]
    ds_read_b64_tr_b16 v[118:119], v9 offset:12288
    v_mfma_f32_16x16x32_bf16 v[144:147], v[68:71], v[52:55], v[144:147]
    ds_read_b128 v[76:79], v5 offset:2048
    v_mfma_f32_16x16x32_bf16 v[148:151], v[40:43], v[32:35], v[148:151]
    ds_read_b128 v[100:103], v5 offset:3072
    v_mfma_f32_16x16x32_bf16 v[148:151], v[64:67], v[56:59], v[148:151]
    ds_read_b128 v[80:83], v5 offset:4096
    v_mfma_f32_16x16x32_bf16 v[152:155], v[44:47], v[32:35], v[152:155]
    ds_read_b128 v[104:107], v5 offset:5120
    v_mfma_f32_16x16x32_bf16 v[152:155], v[68:71], v[56:59], v[152:155]
    s_waitcnt lgkmcnt(8)
    ds_read_b128 v[84:87], v5 offset:6144
    v_mfma_f32_16x16x32_bf16 v[156:159], v[40:43], v[36:39], v[156:159]
    ds_read_b128 v[108:111], v5 offset:7168
    v_mfma_f32_16x16x32_bf16 v[156:159], v[64:67], v[60:63], v[156:159]
    v_mfma_f32_16x16x32_bf16 v[160:163], v[44:47], v[36:39], v[160:163]
    v_mfma_f32_16x16x32_bf16 v[160:163], v[68:71], v[60:63], v[160:163]
    s_waitcnt lgkmcnt(4)
    v_mfma_f32_16x16x32_bf16 v[132:135], v[88:91], v[72:75], v[132:135]
    v_mfma_f32_16x16x32_bf16 v[132:135], v[112:115], v[96:99], v[132:135]
    s_waitcnt lgkmcnt(0)
    s_barrier
    ds_read_b64_tr_b16 v[40:41], v8 offset:40960
    ds_read_b64_tr_b16 v[42:43], v8 offset:45056
    v_mfma_f32_16x16x32_bf16 v[136:139], v[92:95], v[72:75], v[136:139]
    ds_read_b128 v[24:27], v5 offset:40960
    ds_read_b64_tr_b16 v[64:65], v8 offset:49152
    v_mfma_f32_16x16x32_bf16 v[136:139], v[116:119], v[96:99], v[136:139]
    ds_read_b64_tr_b16 v[66:67], v8 offset:53248
    ds_read_b128 v[48:51], v5 offset:41984
    v_mfma_f32_16x16x32_bf16 v[140:143], v[88:91], v[76:79], v[140:143]
    ds_read_b64_tr_b16 v[44:45], v9 offset:40960
    ds_read_b64_tr_b16 v[46:47], v9 offset:45056
    v_mfma_f32_16x16x32_bf16 v[140:143], v[112:115], v[100:103], v[140:143]
    ds_read_b64_tr_b16 v[68:69], v9 offset:49152
    v_mfma_f32_16x16x32_bf16 v[144:147], v[92:95], v[76:79], v[144:147]
    ds_read_b64_tr_b16 v[70:71], v9 offset:53248
    v_mfma_f32_16x16x32_bf16 v[144:147], v[116:119], v[100:103], v[144:147]
    ds_read_b128 v[28:31], v5 offset:43008
    v_mfma_f32_16x16x32_bf16 v[148:151], v[88:91], v[80:83], v[148:151]
    ds_read_b128 v[52:55], v5 offset:44032
    v_mfma_f32_16x16x32_bf16 v[148:151], v[112:115], v[104:107], v[148:151]
    ds_read_b128 v[32:35], v5 offset:45056
    v_mfma_f32_16x16x32_bf16 v[152:155], v[92:95], v[80:83], v[152:155]
    ds_read_b128 v[56:59], v5 offset:46080
    v_mfma_f32_16x16x32_bf16 v[152:155], v[116:119], v[104:107], v[152:155]
    s_waitcnt lgkmcnt(8)
    ds_read_b128 v[36:39], v5 offset:47104
    v_mfma_f32_16x16x32_bf16 v[156:159], v[88:91], v[84:87], v[156:159]
    ds_read_b128 v[60:63], v5 offset:48128
    v_mfma_f32_16x16x32_bf16 v[156:159], v[112:115], v[108:111], v[156:159]
    v_mfma_f32_16x16x32_bf16 v[160:163], v[92:95], v[84:87], v[160:163]
    v_mfma_f32_16x16x32_bf16 v[160:163], v[116:119], v[108:111], v[160:163]
    s_waitcnt lgkmcnt(4)
    v_mfma_f32_16x16x32_bf16 v[132:135], v[40:43], v[24:27], v[132:135]
    v_mfma_f32_16x16x32_bf16 v[132:135], v[64:67], v[48:51], v[132:135]
    s_waitcnt lgkmcnt(0)
    s_barrier
    ds_read_b64_tr_b16 v[88:89], v128 offset:16384
    ds_read_b64_tr_b16 v[90:91], v128 offset:20480
    v_mfma_f32_16x16x32_bf16 v[136:139], v[44:47], v[24:27], v[136:139]
    ds_read_b128 v[72:75], v4 offset:40960
    ds_read_b64_tr_b16 v[112:113], v128 offset:24576
    v_mfma_f32_16x16x32_bf16 v[136:139], v[68:71], v[48:51], v[136:139]
    ds_read_b64_tr_b16 v[114:115], v128 offset:28672
    ds_read_b128 v[96:99], v4 offset:41984
    v_mfma_f32_16x16x32_bf16 v[140:143], v[40:43], v[28:31], v[140:143]
    ds_read_b64_tr_b16 v[92:93], v129 offset:16384
    ds_read_b64_tr_b16 v[94:95], v129 offset:20480
    v_mfma_f32_16x16x32_bf16 v[140:143], v[64:67], v[52:55], v[140:143]
    ds_read_b64_tr_b16 v[116:117], v129 offset:24576
    v_mfma_f32_16x16x32_bf16 v[144:147], v[44:47], v[28:31], v[144:147]
    ds_read_b64_tr_b16 v[118:119], v129 offset:28672
    v_mfma_f32_16x16x32_bf16 v[144:147], v[68:71], v[52:55], v[144:147]
    ds_read_b128 v[76:79], v4 offset:43008
    v_mfma_f32_16x16x32_bf16 v[148:151], v[40:43], v[32:35], v[148:151]
    ds_read_b128 v[100:103], v4 offset:44032
    v_mfma_f32_16x16x32_bf16 v[148:151], v[64:67], v[56:59], v[148:151]
    ds_read_b128 v[80:83], v4 offset:45056
    v_mfma_f32_16x16x32_bf16 v[152:155], v[44:47], v[32:35], v[152:155]
    ds_read_b128 v[104:107], v4 offset:46080
    v_mfma_f32_16x16x32_bf16 v[152:155], v[68:71], v[56:59], v[152:155]
    s_waitcnt lgkmcnt(8)
    ds_read_b128 v[84:87], v4 offset:47104
    v_mfma_f32_16x16x32_bf16 v[156:159], v[40:43], v[36:39], v[156:159]
    ds_read_b128 v[108:111], v4 offset:48128
    v_mfma_f32_16x16x32_bf16 v[156:159], v[64:67], v[60:63], v[156:159]
    v_mfma_f32_16x16x32_bf16 v[160:163], v[44:47], v[36:39], v[160:163]
    v_mfma_f32_16x16x32_bf16 v[160:163], v[68:71], v[60:63], v[160:163]
    s_waitcnt lgkmcnt(4)
    v_mfma_f32_16x16x32_bf16 v[132:135], v[88:91], v[72:75], v[132:135]
    v_mfma_f32_16x16x32_bf16 v[132:135], v[112:115], v[96:99], v[132:135]
    s_waitcnt lgkmcnt(0)
    s_barrier
    ds_read_b64_tr_b16 v[40:41], v130 offset:0
    ds_read_b64_tr_b16 v[42:43], v130 offset:4096
    v_mfma_f32_16x16x32_bf16 v[136:139], v[92:95], v[72:75], v[136:139]
    ds_read_b128 v[24:27], v4 offset:0
    ds_read_b64_tr_b16 v[64:65], v130 offset:8192
    v_mfma_f32_16x16x32_bf16 v[136:139], v[116:119], v[96:99], v[136:139]
    ds_read_b64_tr_b16 v[66:67], v130 offset:12288
    ds_read_b128 v[48:51], v4 offset:1024
    v_mfma_f32_16x16x32_bf16 v[140:143], v[88:91], v[76:79], v[140:143]
    ds_read_b64_tr_b16 v[44:45], v131 offset:0
    ds_read_b64_tr_b16 v[46:47], v131 offset:4096
    v_mfma_f32_16x16x32_bf16 v[140:143], v[112:115], v[100:103], v[140:143]
    ds_read_b64_tr_b16 v[68:69], v131 offset:8192
    v_mfma_f32_16x16x32_bf16 v[144:147], v[92:95], v[76:79], v[144:147]
    ds_read_b64_tr_b16 v[70:71], v131 offset:12288
    v_mfma_f32_16x16x32_bf16 v[144:147], v[116:119], v[100:103], v[144:147]
    ds_read_b128 v[28:31], v4 offset:2048
    v_mfma_f32_16x16x32_bf16 v[148:151], v[88:91], v[80:83], v[148:151]
    ds_read_b128 v[52:55], v4 offset:3072
    v_mfma_f32_16x16x32_bf16 v[148:151], v[112:115], v[104:107], v[148:151]
    ds_read_b128 v[32:35], v4 offset:4096
    v_mfma_f32_16x16x32_bf16 v[152:155], v[92:95], v[80:83], v[152:155]
    ds_read_b128 v[56:59], v4 offset:5120
    v_mfma_f32_16x16x32_bf16 v[152:155], v[116:119], v[104:107], v[152:155]
    s_waitcnt lgkmcnt(8)
    ds_read_b128 v[36:39], v4 offset:6144
    v_mfma_f32_16x16x32_bf16 v[156:159], v[88:91], v[84:87], v[156:159]
    ds_read_b128 v[60:63], v4 offset:7168
    v_mfma_f32_16x16x32_bf16 v[156:159], v[112:115], v[108:111], v[156:159]
    v_mfma_f32_16x16x32_bf16 v[160:163], v[92:95], v[84:87], v[160:163]
    v_mfma_f32_16x16x32_bf16 v[160:163], v[116:119], v[108:111], v[160:163]
    s_waitcnt lgkmcnt(4)
    v_mfma_f32_16x16x32_bf16 v[132:135], v[40:43], v[24:27], v[132:135]
    v_mfma_f32_16x16x32_bf16 v[132:135], v[64:67], v[48:51], v[132:135]
    s_waitcnt lgkmcnt(0)
    s_barrier
    ds_read_b64_tr_b16 v[88:89], v128 offset:40960
    ds_read_b64_tr_b16 v[90:91], v128 offset:45056
    v_mfma_f32_16x16x32_bf16 v[136:139], v[44:47], v[24:27], v[136:139]
    ds_read_b128 v[72:75], v5 offset:0
    ds_read_b64_tr_b16 v[112:113], v128 offset:49152
    v_mfma_f32_16x16x32_bf16 v[136:139], v[68:71], v[48:51], v[136:139]
    ds_read_b64_tr_b16 v[114:115], v128 offset:53248
    ds_read_b128 v[96:99], v5 offset:1024
    v_mfma_f32_16x16x32_bf16 v[140:143], v[40:43], v[28:31], v[140:143]
    ds_read_b64_tr_b16 v[92:93], v129 offset:40960
    ds_read_b64_tr_b16 v[94:95], v129 offset:45056
    v_mfma_f32_16x16x32_bf16 v[140:143], v[64:67], v[52:55], v[140:143]
    ds_read_b64_tr_b16 v[116:117], v129 offset:49152
    v_mfma_f32_16x16x32_bf16 v[144:147], v[44:47], v[28:31], v[144:147]
    ds_read_b64_tr_b16 v[118:119], v129 offset:53248
    v_mfma_f32_16x16x32_bf16 v[144:147], v[68:71], v[52:55], v[144:147]
    ds_read_b128 v[76:79], v5 offset:2048
    v_mfma_f32_16x16x32_bf16 v[148:151], v[40:43], v[32:35], v[148:151]
    ds_read_b128 v[100:103], v5 offset:3072
    v_mfma_f32_16x16x32_bf16 v[148:151], v[64:67], v[56:59], v[148:151]
    ds_read_b128 v[80:83], v5 offset:4096
    v_mfma_f32_16x16x32_bf16 v[152:155], v[44:47], v[32:35], v[152:155]
    ds_read_b128 v[104:107], v5 offset:5120
    v_mfma_f32_16x16x32_bf16 v[152:155], v[68:71], v[56:59], v[152:155]
    s_waitcnt lgkmcnt(8)
    ds_read_b128 v[84:87], v5 offset:6144
    v_mfma_f32_16x16x32_bf16 v[156:159], v[40:43], v[36:39], v[156:159]
    ds_read_b128 v[108:111], v5 offset:7168
    v_mfma_f32_16x16x32_bf16 v[156:159], v[64:67], v[60:63], v[156:159]
    v_mfma_f32_16x16x32_bf16 v[160:163], v[44:47], v[36:39], v[160:163]
    v_mfma_f32_16x16x32_bf16 v[160:163], v[68:71], v[60:63], v[160:163]
    s_waitcnt lgkmcnt(4)
    v_mfma_f32_16x16x32_bf16 v[132:135], v[88:91], v[72:75], v[132:135]
    v_mfma_f32_16x16x32_bf16 v[132:135], v[112:115], v[96:99], v[132:135]
    s_waitcnt lgkmcnt(0)
    s_barrier
    ds_read_b64_tr_b16 v[40:41], v130 offset:24576
    ds_read_b64_tr_b16 v[42:43], v130 offset:28672
    v_mfma_f32_16x16x32_bf16 v[136:139], v[92:95], v[72:75], v[136:139]
    ds_read_b128 v[24:27], v5 offset:40960
    ds_read_b64_tr_b16 v[64:65], v130 offset:32768
    v_mfma_f32_16x16x32_bf16 v[136:139], v[116:119], v[96:99], v[136:139]
    ds_read_b64_tr_b16 v[66:67], v130 offset:36864
    ds_read_b128 v[48:51], v5 offset:41984
    v_mfma_f32_16x16x32_bf16 v[140:143], v[88:91], v[76:79], v[140:143]
    ds_read_b64_tr_b16 v[44:45], v131 offset:24576
    ds_read_b64_tr_b16 v[46:47], v131 offset:28672
    v_mfma_f32_16x16x32_bf16 v[140:143], v[112:115], v[100:103], v[140:143]
    ds_read_b64_tr_b16 v[68:69], v131 offset:32768
    v_mfma_f32_16x16x32_bf16 v[144:147], v[92:95], v[76:79], v[144:147]
    ds_read_b64_tr_b16 v[70:71], v131 offset:36864
    v_mfma_f32_16x16x32_bf16 v[144:147], v[116:119], v[100:103], v[144:147]
    ds_read_b128 v[28:31], v5 offset:43008
    v_mfma_f32_16x16x32_bf16 v[148:151], v[88:91], v[80:83], v[148:151]
    ds_read_b128 v[52:55], v5 offset:44032
    v_mfma_f32_16x16x32_bf16 v[148:151], v[112:115], v[104:107], v[148:151]
    ds_read_b128 v[32:35], v5 offset:45056
    v_mfma_f32_16x16x32_bf16 v[152:155], v[92:95], v[80:83], v[152:155]
    ds_read_b128 v[56:59], v5 offset:46080
    v_mfma_f32_16x16x32_bf16 v[152:155], v[116:119], v[104:107], v[152:155]
    s_waitcnt lgkmcnt(8)
    ds_read_b128 v[36:39], v5 offset:47104
    v_mfma_f32_16x16x32_bf16 v[156:159], v[88:91], v[84:87], v[156:159]
    ds_read_b128 v[60:63], v5 offset:48128
    v_mfma_f32_16x16x32_bf16 v[156:159], v[112:115], v[108:111], v[156:159]
    v_mfma_f32_16x16x32_bf16 v[160:163], v[92:95], v[84:87], v[160:163]
    v_mfma_f32_16x16x32_bf16 v[160:163], v[116:119], v[108:111], v[160:163]
    s_waitcnt lgkmcnt(4)
    v_mfma_f32_16x16x32_bf16 v[132:135], v[40:43], v[24:27], v[132:135]
    v_mfma_f32_16x16x32_bf16 v[132:135], v[64:67], v[48:51], v[132:135]
    s_waitcnt lgkmcnt(0)
    s_barrier
    ds_read_b64_tr_b16 v[88:89], v128 offset:0
    ds_read_b64_tr_b16 v[90:91], v128 offset:4096
    v_mfma_f32_16x16x32_bf16 v[136:139], v[44:47], v[24:27], v[136:139]
    ds_read_b128 v[72:75], v4 offset:40960
    ds_read_b64_tr_b16 v[112:113], v128 offset:8192
    v_mfma_f32_16x16x32_bf16 v[136:139], v[68:71], v[48:51], v[136:139]
    ds_read_b64_tr_b16 v[114:115], v128 offset:12288
    ds_read_b128 v[96:99], v4 offset:41984
    v_mfma_f32_16x16x32_bf16 v[140:143], v[40:43], v[28:31], v[140:143]
    ds_read_b64_tr_b16 v[92:93], v129 offset:0
    ds_read_b64_tr_b16 v[94:95], v129 offset:4096
    v_mfma_f32_16x16x32_bf16 v[140:143], v[64:67], v[52:55], v[140:143]
    ds_read_b64_tr_b16 v[116:117], v129 offset:8192
    ds_read_b64_tr_b16 v[118:119], v129 offset:12288
    v_mfma_f32_16x16x32_bf16 v[144:147], v[44:47], v[28:31], v[144:147]
    ds_read_b128 v[76:79], v4 offset:43008
    v_mfma_f32_16x16x32_bf16 v[144:147], v[68:71], v[52:55], v[144:147]
    ds_read_b128 v[100:103], v4 offset:44032
    s_waitcnt lgkmcnt(9)
    v_mfma_f32_16x16x32_bf16 v[132:135], v[88:91], v[72:75], v[132:135]
    ds_read_b128 v[80:83], v4 offset:45056
    s_waitcnt lgkmcnt(7)
    v_mfma_f32_16x16x32_bf16 v[132:135], v[112:115], v[96:99], v[132:135]
    ds_read_b128 v[104:107], v4 offset:46080
    s_waitcnt lgkmcnt(6)
    v_mfma_f32_16x16x32_bf16 v[136:139], v[92:95], v[72:75], v[136:139]
    ds_read_b128 v[84:87], v4 offset:47104
    s_waitcnt lgkmcnt(5)
    v_mfma_f32_16x16x32_bf16 v[136:139], v[116:119], v[96:99], v[136:139]
    ds_read_b128 v[108:111], v4 offset:48128
    v_mfma_f32_16x16x32_bf16 v[148:151], v[40:43], v[32:35], v[148:151]
    v_mfma_f32_16x16x32_bf16 v[148:151], v[64:67], v[56:59], v[148:151]
    v_mfma_f32_16x16x32_bf16 v[152:155], v[44:47], v[32:35], v[152:155]
    v_cvt_pk_bf16_f32 v132, v132, v133
    v_cvt_pk_bf16_f32 v133, v134, v135
    v_mfma_f32_16x16x32_bf16 v[152:155], v[68:71], v[56:59], v[152:155]
    s_nop 0
    v_cvt_pk_bf16_f32 v134, v136, v137
    v_cvt_pk_bf16_f32 v135, v138, v139
    s_waitcnt lgkmcnt(5)
    v_mfma_f32_16x16x32_bf16 v[140:143], v[88:91], v[76:79], v[140:143]
    ds_write2_b64 v18, v[132:133], v[134:135] offset0:0 offset1:4
    s_waitcnt lgkmcnt(5)
    v_mfma_f32_16x16x32_bf16 v[140:143], v[112:115], v[100:103], v[140:143]
    v_mfma_f32_16x16x32_bf16 v[144:147], v[92:95], v[76:79], v[144:147]
    v_mfma_f32_16x16x32_bf16 v[144:147], v[116:119], v[100:103], v[144:147]
    v_mfma_f32_16x16x32_bf16 v[156:159], v[40:43], v[36:39], v[156:159]
    v_mfma_f32_16x16x32_bf16 v[156:159], v[64:67], v[60:63], v[156:159]
    v_mfma_f32_16x16x32_bf16 v[160:163], v[44:47], v[36:39], v[160:163]
    s_waitcnt lgkmcnt(0)
    s_barrier
    s_nop 0
    v_cvt_pk_bf16_f32 v140, v140, v141
    v_mfma_f32_16x16x32_bf16 v[160:163], v[68:71], v[60:63], v[160:163]
    v_cvt_pk_bf16_f32 v141, v142, v143
    v_cvt_pk_bf16_f32 v142, v144, v145
    v_mfma_f32_16x16x32_bf16 v[148:151], v[88:91], v[80:83], v[148:151]
    v_cvt_pk_bf16_f32 v143, v146, v147
    ds_write2_b64 v19, v[140:141], v[142:143] offset0:0 offset1:4
    v_mfma_f32_16x16x32_bf16 v[148:151], v[112:115], v[104:107], v[148:151]
    v_mfma_f32_16x16x32_bf16 v[152:155], v[92:95], v[80:83], v[152:155]
    v_mfma_f32_16x16x32_bf16 v[152:155], v[116:119], v[104:107], v[152:155]
    v_mfma_f32_16x16x32_bf16 v[156:159], v[88:91], v[84:87], v[156:159]
    v_mfma_f32_16x16x32_bf16 v[156:159], v[112:115], v[108:111], v[156:159]
    v_mfma_f32_16x16x32_bf16 v[160:163], v[92:95], v[84:87], v[160:163]
    s_waitcnt lgkmcnt(0)
    s_barrier
    s_nop 0
    v_cvt_pk_bf16_f32 v148, v148, v149
    v_cvt_pk_bf16_f32 v149, v150, v151
    v_mfma_f32_16x16x32_bf16 v[160:163], v[116:119], v[108:111], v[160:163]
    v_cvt_pk_bf16_f32 v150, v152, v153
    v_cvt_pk_bf16_f32 v151, v154, v155
    ds_write2_b64 v20, v[148:149], v[150:151] offset0:0 offset1:4
    v_cvt_pk_bf16_f32 v156, v156, v157
    v_cvt_pk_bf16_f32 v157, v158, v159
    s_nop 2
    v_cvt_pk_bf16_f32 v158, v160, v161
    v_cvt_pk_bf16_f32 v159, v162, v163
    ds_write2_b64 v21, v[156:157], v[158:159] offset0:0 offset1:4
    s_waitcnt lgkmcnt(0)
    s_barrier
F_end:
    s_endpgm
F_loader:
    s_mov_b32 s48, 0x76542130
    s_mov_b32 s49, 0xfedca9b8
    s_cmp_eq_u32 s35, 1
    s_cselect_b32 s48, 0x75463021, s48
    s_cselect_b32 s49, 0xfdceba98, s49
    s_cmp_eq_u32 s35, 2
    s_cselect_b32 s48, 0x96543102, s48
    s_cselect_b32 s49, 0xfedcba87, s49
    s_cmp_eq_u32 s35, 3
    s_cselect_b32 s48, 0x76532410, s48
    s_cselect_b32 s49, 0xfedbac98, s49
    s_cmp_eq_u32 s35, 4
    s_cselect_b32 s48, 0x65743021, s48
    s_cselect_b32 s49, 0xedfcba98, s49
    s_cmp_eq_u32 s35, 5
    s_cselect_b32 s48, 0x76543102, s48
    s_cselect_b32 s49, 0xfedcb98a, s49
    s_cmp_eq_u32 s35, 6
    s_cselect_b32 s48, 0x76435210, s48
    s_cselect_b32 s49, 0xfecbda98, s49
    s_cmp_eq_u32 s35, 7
    s_cselect_b32 s48, 0x68543021, s48
    s_cselect_b32 s49, 0xfedcba97, s49
    s_setprio 0
    s_sub_u32 s3, s3, 8
    v_lshrrev_b32 v2, 3, v0
    v_and_b32 v3, 7, v0
    v_lshrrev_b32 v4, 1, v2
    v_xor_b32 v5, v3, v4
    v_xor_b32 v6, 4, v5
    v_lshlrev_b32 v5, 4, v5
    v_lshlrev_b32 v6, 4, v6
    v_lshlrev_b32 v7, 11, v2
    v_add_u32 v12, v5, v7
    v_add_u32 v13, v6, v7
    v_and_b32 v4, 1, v4
    v_lshlrev_b32 v4, 1, v4
    v_xor_b32 v8, v3, v4
    v_xor_b32 v9, 4, v8
    v_lshlrev_b32 v8, 4, v8
    v_lshlrev_b32 v9, 4, v9
    v_mul_u32_u24 v7, 6144, v2
    v_add_u32 v14, v8, v7
    v_add_u32_e64 v15, v9, v7
    s_lshl_b32 s36, s32, 18
    s_lshl_b32 s37, s3, 16
    s_add_u32 s36, s36, s37
    s_lshl_b32 s38, s33, 7
    s_mul_i32 s37, s3, 98304
    s_add_u32 s38, s38, s37
    s_sub_u32 s47, s10, s33
    s_lshl_b32 s47, s47, 7
    s_and_b32 s42, s39, 8
    s_and_b32 s43, s30, 6
    s_or_b32 s42, s42, s43
    s_and_b32 s43, s34, 0
    s_lshl_b32 s43, s43, 0
    s_xor_b32 s42, s42, s43
    s_lshl_b32 s44, s3, 12
    s_lshl_b32 s45, s3, 11
    s_waitcnt lgkmcnt(0)
    s_mov_b32 s12, s4
    s_mov_b32 s13, s5
    s_mov_b32 s14, 0x400000
    s_mov_b32 s15, 0x00020000
    s_mov_b32 s16, s6
    s_mov_b32 s17, s7
    s_mov_b32 s18, 0x600000
    s_mov_b32 s19, 0x00020000
    s_bfe_u32 s40, s48, 0x40000
    s_bitcmp1_b32 s40, 3
    s_cselect_b32 s41, s39, s42
    s_xor_b32 s40, s40, s41
    s_mul_i32 s41, s40, 393216
    s_add_u32 s41, s41, s38
    s_lshl_b32 s40, s40, 7
    s_add_u32 s40, s40, s36
    s_add_u32 m0, s44, 0
    s_add_u32 s46, s40, 0
    buffer_load_dwordx4 v12, s[12:15], s46 offen lds
    s_add_u32 m0, s45, 24576
    s_add_u32 s46, s41, 2048
    buffer_load_dwordx4 v14, s[16:19], s46 offen lds
    s_add_u32 m0, s45, 25600
    s_add_u32 s46, s41, 51200
    buffer_load_dwordx4 v15, s[16:19], s46 offen lds
    s_add_u32 m0, s45, 16384
    s_add_u32 s46, s41, 0
    s_add_u32 s46, s46, s47
    buffer_load_dwordx4 v14, s[16:19], s46 offen lds
    s_add_u32 m0, s45, 17408
    s_add_u32 s46, s41, 49152
    s_add_u32 s46, s46, s47
    s_nop 0
    buffer_load_dwordx4 v15, s[16:19], s46 offen lds
    s_add_u32 m0, s45, 32768
    s_add_u32 s46, s41, 4096
    buffer_load_dwordx4 v14, s[16:19], s46 offen lds
    s_add_u32 m0, s45, 33792
    s_add_u32 s46, s41, 53248
    buffer_load_dwordx4 v15, s[16:19], s46 offen lds
    s_add_u32 m0, s44, 1024
    s_add_u32 s46, s40, 16384
    buffer_load_dwordx4 v13, s[12:15], s46 offen lds
    s_add_u32 m0, s44, 2048
    s_add_u32 s46, s40, 32768
    buffer_load_dwordx4 v12, s[12:15], s46 offen lds
    s_add_u32 m0, s44, 3072
    s_add_u32 s46, s40, 49152
    buffer_load_dwordx4 v13, s[12:15], s46 offen lds
    s_bfe_u32 s40, s48, 0x40004
    s_bitcmp1_b32 s40, 3
    s_cselect_b32 s41, s39, s42
    s_xor_b32 s40, s40, s41
    s_mul_i32 s41, s40, 393216
    s_add_u32 s41, s41, s38
    s_lshl_b32 s40, s40, 7
    s_add_u32 s40, s40, s36
    s_add_u32 m0, s44, 40960
    s_add_u32 s46, s40, 0
    s_nop 0
    buffer_load_dwordx4 v12, s[12:15], s46 offen lds
    s_add_u32 m0, s45, 65536
    s_add_u32 s46, s41, 2048
    buffer_load_dwordx4 v14, s[16:19], s46 offen lds
    s_add_u32 m0, s45, 66560
    s_add_u32 s46, s41, 51200
    buffer_load_dwordx4 v15, s[16:19], s46 offen lds
    s_add_u32 m0, s45, 57344
    s_add_u32 s46, s41, 0
    s_add_u32 s46, s46, s47
    buffer_load_dwordx4 v14, s[16:19], s46 offen lds
    s_add_u32 m0, s45, 58368
    s_add_u32 s46, s41, 49152
    s_add_u32 s46, s46, s47
    s_nop 0
    buffer_load_dwordx4 v15, s[16:19], s46 offen lds
    s_add_u32 m0, s45, 73728
    s_add_u32 s46, s41, 4096
    buffer_load_dwordx4 v14, s[16:19], s46 offen lds
    s_add_u32 m0, s45, 74752
    s_add_u32 s46, s41, 53248
    buffer_load_dwordx4 v15, s[16:19], s46 offen lds
    s_add_u32 m0, s44, 41984
    s_add_u32 s46, s40, 16384
    buffer_load_dwordx4 v13, s[12:15], s46 offen lds
    s_waitcnt vmcnt(8)
    s_barrier
    s_add_u32 m0, s44, 43008
    s_add_u32 s46, s40, 32768
    buffer_load_dwordx4 v12, s[12:15], s46 offen lds
    s_add_u32 m0, s44, 44032
    s_add_u32 s46, s40, 49152
    buffer_load_dwordx4 v13, s[12:15], s46 offen lds
    s_bfe_u32 s40, s48, 0x40008
    s_bitcmp1_b32 s40, 3
    s_cselect_b32 s41, s39, s42
    s_xor_b32 s40, s40, s41
    s_mul_i32 s41, s40, 393216
    s_add_u32 s41, s41, s38
    s_lshl_b32 s40, s40, 7
    s_add_u32 s40, s40, s36
    s_add_u32 m0, s44, 81920
    s_add_u32 s46, s40, 0
    s_nop 0
    buffer_load_dwordx4 v12, s[12:15], s46 offen lds
    s_add_u32 m0, s45, 106496
    s_add_u32 s46, s41, 2048
    buffer_load_dwordx4 v14, s[16:19], s46 offen lds
    s_add_u32 m0, s45, 107520
    s_add_u32 s46, s41, 51200
    buffer_load_dwordx4 v15, s[16:19], s46 offen lds
    s_add_u32 m0, s45, 98304
    s_add_u32 s46, s41, 0
    s_add_u32 s46, s46, s47
    buffer_load_dwordx4 v14, s[16:19], s46 offen lds
    s_add_u32 m0, s45, 99328
    s_add_u32 s46, s41, 49152
    s_add_u32 s46, s46, s47
    s_nop 0
    buffer_load_dwordx4 v15, s[16:19], s46 offen lds
    s_add_u32 m0, s45, 114688
    s_add_u32 s46, s41, 4096
    buffer_load_dwordx4 v14, s[16:19], s46 offen lds
    s_add_u32 m0, s45, 115712
    s_add_u32 s46, s41, 53248
    buffer_load_dwordx4 v15, s[16:19], s46 offen lds
    s_add_u32 m0, s44, 82944
    s_add_u32 s46, s40, 16384
    buffer_load_dwordx4 v13, s[12:15], s46 offen lds
    s_add_u32 m0, s44, 83968
    s_add_u32 s46, s40, 32768
    buffer_load_dwordx4 v12, s[12:15], s46 offen lds
    s_add_u32 m0, s44, 84992
    s_add_u32 s46, s40, 49152
    buffer_load_dwordx4 v13, s[12:15], s46 offen lds
    s_waitcnt vmcnt(10)
    s_barrier
    s_bfe_u32 s40, s48, 0x4000c
    s_bitcmp1_b32 s40, 3
    s_cselect_b32 s41, s39, s42
    s_xor_b32 s40, s40, s41
    s_mul_i32 s41, s40, 393216
    s_add_u32 s41, s41, s38
    s_lshl_b32 s40, s40, 7
    s_add_u32 s40, s40, s36
    s_add_u32 m0, s44, 122880
    s_add_u32 s46, s40, 0
    s_nop 0
    buffer_load_dwordx4 v12, s[12:15], s46 offen lds
    s_add_u32 m0, s45, 147456
    s_add_u32 s46, s41, 2048
    buffer_load_dwordx4 v14, s[16:19], s46 offen lds
    s_add_u32 m0, s45, 148480
    s_add_u32 s46, s41, 51200
    buffer_load_dwordx4 v15, s[16:19], s46 offen lds
    s_add_u32 m0, s45, 139264
    s_add_u32 s46, s41, 0
    s_add_u32 s46, s46, s47
    buffer_load_dwordx4 v14, s[16:19], s46 offen lds
    s_add_u32 m0, s45, 140288
    s_add_u32 s46, s41, 49152
    s_add_u32 s46, s46, s47
    s_nop 0
    buffer_load_dwordx4 v15, s[16:19], s46 offen lds
    s_add_u32 m0, s45, 155648
    s_add_u32 s46, s41, 4096
    buffer_load_dwordx4 v14, s[16:19], s46 offen lds
    s_add_u32 m0, s45, 156672
    s_add_u32 s46, s41, 53248
    buffer_load_dwordx4 v15, s[16:19], s46 offen lds
    s_add_u32 m0, s44, 123904
    s_add_u32 s46, s40, 16384
    buffer_load_dwordx4 v13, s[12:15], s46 offen lds
    s_add_u32 m0, s44, 124928
    s_add_u32 s46, s40, 32768
    buffer_load_dwordx4 v12, s[12:15], s46 offen lds
    s_add_u32 m0, s44, 125952
    s_add_u32 s46, s40, 49152
    buffer_load_dwordx4 v13, s[12:15], s46 offen lds
    s_bfe_u32 s40, s48, 0x40010
    s_bitcmp1_b32 s40, 3
    s_cselect_b32 s41, s39, s42
    s_xor_b32 s40, s40, s41
    s_mul_i32 s41, s40, 393216
    s_add_u32 s41, s41, s38
    s_lshl_b32 s40, s40, 7
    s_add_u32 s40, s40, s36
    s_add_u32 m0, s44, 0
    s_add_u32 s46, s40, 0
    buffer_load_dwordx4 v12, s[12:15], s46 offen lds
    s_add_u32 m0, s45, 24576
    s_add_u32 s46, s41, 2048
    buffer_load_dwordx4 v14, s[16:19], s46 offen lds
    s_waitcnt vmcnt(12)
    s_barrier
    s_add_u32 m0, s45, 25600
    s_add_u32 s46, s41, 51200
    buffer_load_dwordx4 v15, s[16:19], s46 offen lds
    s_add_u32 m0, s45, 16384
    s_add_u32 s46, s41, 0
    s_add_u32 s46, s46, s47
    buffer_load_dwordx4 v14, s[16:19], s46 offen lds
    s_add_u32 m0, s45, 17408
    s_add_u32 s46, s41, 49152
    s_add_u32 s46, s46, s47
    s_nop 0
    buffer_load_dwordx4 v15, s[16:19], s46 offen lds
    s_add_u32 m0, s45, 32768
    s_add_u32 s46, s41, 4096
    buffer_load_dwordx4 v14, s[16:19], s46 offen lds
    s_add_u32 m0, s45, 33792
    s_add_u32 s46, s41, 53248
    buffer_load_dwordx4 v15, s[16:19], s46 offen lds
    s_add_u32 m0, s44, 1024
    s_add_u32 s46, s40, 16384
    buffer_load_dwordx4 v13, s[12:15], s46 offen lds
    s_add_u32 m0, s44, 2048
    s_add_u32 s46, s40, 32768
    buffer_load_dwordx4 v12, s[12:15], s46 offen lds
    s_add_u32 m0, s44, 3072
    s_add_u32 s46, s40, 49152
    buffer_load_dwordx4 v13, s[12:15], s46 offen lds
    s_bfe_u32 s40, s48, 0x40014
    s_bitcmp1_b32 s40, 3
    s_cselect_b32 s41, s39, s42
    s_xor_b32 s40, s40, s41
    s_mul_i32 s41, s40, 393216
    s_add_u32 s41, s41, s38
    s_lshl_b32 s40, s40, 7
    s_add_u32 s40, s40, s36
    s_add_u32 m0, s44, 40960
    s_add_u32 s46, s40, 0
    s_nop 0
    buffer_load_dwordx4 v12, s[12:15], s46 offen lds
    s_add_u32 m0, s45, 65536
    s_add_u32 s46, s41, 2048
    buffer_load_dwordx4 v14, s[16:19], s46 offen lds
    s_add_u32 m0, s45, 66560
    s_add_u32 s46, s41, 51200
    buffer_load_dwordx4 v15, s[16:19], s46 offen lds
    s_add_u32 m0, s45, 57344
    s_add_u32 s46, s41, 0
    s_add_u32 s46, s46, s47
    buffer_load_dwordx4 v14, s[16:19], s46 offen lds
    s_waitcnt vmcnt(14)
    s_barrier
    s_add_u32 m0, s45, 58368
    s_add_u32 s46, s41, 49152
    s_add_u32 s46, s46, s47
    s_nop 0
    buffer_load_dwordx4 v15, s[16:19], s46 offen lds
    s_add_u32 m0, s45, 73728
    s_add_u32 s46, s41, 4096
    buffer_load_dwordx4 v14, s[16:19], s46 offen lds
    s_add_u32 m0, s45, 74752
    s_add_u32 s46, s41, 53248
    buffer_load_dwordx4 v15, s[16:19], s46 offen lds
    s_add_u32 m0, s44, 41984
    s_add_u32 s46, s40, 16384
    buffer_load_dwordx4 v13, s[12:15], s46 offen lds
    s_add_u32 m0, s44, 43008
    s_add_u32 s46, s40, 32768
    buffer_load_dwordx4 v12, s[12:15], s46 offen lds
    s_add_u32 m0, s44, 44032
    s_add_u32 s46, s40, 49152
    buffer_load_dwordx4 v13, s[12:15], s46 offen lds
    s_bfe_u32 s40, s48, 0x40018
    s_bitcmp1_b32 s40, 3
    s_cselect_b32 s41, s39, s42
    s_xor_b32 s40, s40, s41
    s_mul_i32 s41, s40, 393216
    s_add_u32 s41, s41, s38
    s_lshl_b32 s40, s40, 7
    s_add_u32 s40, s40, s36
    s_add_u32 m0, s44, 81920
    s_add_u32 s46, s40, 0
    s_nop 0
    buffer_load_dwordx4 v12, s[12:15], s46 offen lds
    s_add_u32 m0, s45, 106496
    s_add_u32 s46, s41, 2048
    buffer_load_dwordx4 v14, s[16:19], s46 offen lds
    s_add_u32 m0, s45, 107520
    s_add_u32 s46, s41, 51200
    buffer_load_dwordx4 v15, s[16:19], s46 offen lds
    s_add_u32 m0, s45, 98304
    s_add_u32 s46, s41, 0
    s_add_u32 s46, s46, s47
    buffer_load_dwordx4 v14, s[16:19], s46 offen lds
    s_add_u32 m0, s45, 99328
    s_add_u32 s46, s41, 49152
    s_add_u32 s46, s46, s47
    buffer_load_dwordx4 v15, s[16:19], s46 offen lds
    s_add_u32 m0, s45, 114688
    s_add_u32 s46, s41, 4096
    buffer_load_dwordx4 v14, s[16:19], s46 offen lds
    s_waitcnt vmcnt(16)
    s_barrier
    s_nop 0
    s_add_u32 m0, s45, 115712
    s_add_u32 s46, s41, 53248
    buffer_load_dwordx4 v15, s[16:19], s46 offen lds
    s_add_u32 m0, s44, 82944
    s_add_u32 s46, s40, 16384
    buffer_load_dwordx4 v13, s[12:15], s46 offen lds
    s_add_u32 m0, s44, 83968
    s_add_u32 s46, s40, 32768
    buffer_load_dwordx4 v12, s[12:15], s46 offen lds
    s_add_u32 m0, s44, 84992
    s_add_u32 s46, s40, 49152
    buffer_load_dwordx4 v13, s[12:15], s46 offen lds
    s_bfe_u32 s40, s48, 0x4001c
    s_bitcmp1_b32 s40, 3
    s_cselect_b32 s41, s39, s42
    s_xor_b32 s40, s40, s41
    s_mul_i32 s41, s40, 393216
    s_add_u32 s41, s41, s38
    s_lshl_b32 s40, s40, 7
    s_add_u32 s40, s40, s36
    s_add_u32 m0, s44, 122880
    s_add_u32 s46, s40, 0
    s_nop 0
    buffer_load_dwordx4 v12, s[12:15], s46 offen lds
    s_add_u32 m0, s45, 147456
    s_add_u32 s46, s41, 2048
    buffer_load_dwordx4 v14, s[16:19], s46 offen lds
    s_add_u32 m0, s45, 148480
    s_add_u32 s46, s41, 51200
    buffer_load_dwordx4 v15, s[16:19], s46 offen lds
    s_add_u32 m0, s45, 139264
    s_add_u32 s46, s41, 0
    s_add_u32 s46, s46, s47
    buffer_load_dwordx4 v14, s[16:19], s46 offen lds
    s_add_u32 m0, s45, 140288
    s_add_u32 s46, s41, 49152
    s_add_u32 s46, s46, s47
    s_nop 0
    buffer_load_dwordx4 v15, s[16:19], s46 offen lds
    s_add_u32 m0, s45, 155648
    s_add_u32 s46, s41, 4096
    buffer_load_dwordx4 v14, s[16:19], s46 offen lds
    s_add_u32 m0, s45, 156672
    s_add_u32 s46, s41, 53248
    buffer_load_dwordx4 v15, s[16:19], s46 offen lds
    s_add_u32 m0, s44, 123904
    s_add_u32 s46, s40, 16384
    buffer_load_dwordx4 v13, s[12:15], s46 offen lds
    s_waitcnt vmcnt(18)
    s_barrier
    s_add_u32 m0, s44, 124928
    s_add_u32 s46, s40, 32768
    buffer_load_dwordx4 v12, s[12:15], s46 offen lds
    s_add_u32 m0, s44, 125952
    s_add_u32 s46, s40, 49152
    buffer_load_dwordx4 v13, s[12:15], s46 offen lds
    s_bfe_u32 s40, s49, 0x40000
    s_bitcmp1_b32 s40, 3
    s_cselect_b32 s41, s39, s42
    s_xor_b32 s40, s40, s41
    s_mul_i32 s41, s40, 393216
    s_add_u32 s41, s41, s38
    s_lshl_b32 s40, s40, 7
    s_add_u32 s40, s40, s36
    s_add_u32 m0, s44, 0
    s_add_u32 s46, s40, 0
    buffer_load_dwordx4 v12, s[12:15], s46 offen lds
    s_add_u32 m0, s45, 24576
    s_add_u32 s46, s41, 2048
    buffer_load_dwordx4 v14, s[16:19], s46 offen lds
    s_add_u32 m0, s45, 25600
    s_add_u32 s46, s41, 51200
    buffer_load_dwordx4 v15, s[16:19], s46 offen lds
    s_add_u32 m0, s45, 16384
    s_add_u32 s46, s41, 0
    s_add_u32 s46, s46, s47
    buffer_load_dwordx4 v14, s[16:19], s46 offen lds
    s_add_u32 m0, s45, 17408
    s_add_u32 s46, s41, 49152
    s_add_u32 s46, s46, s47
    s_nop 0
    buffer_load_dwordx4 v15, s[16:19], s46 offen lds
    s_add_u32 m0, s45, 32768
    s_add_u32 s46, s41, 4096
    buffer_load_dwordx4 v14, s[16:19], s46 offen lds
    s_add_u32 m0, s45, 33792
    s_add_u32 s46, s41, 53248
    buffer_load_dwordx4 v15, s[16:19], s46 offen lds
    s_add_u32 m0, s44, 1024
    s_add_u32 s46, s40, 16384
    buffer_load_dwordx4 v13, s[12:15], s46 offen lds
    s_add_u32 m0, s44, 2048
    s_add_u32 s46, s40, 32768
    buffer_load_dwordx4 v12, s[12:15], s46 offen lds
    s_add_u32 m0, s44, 3072
    s_add_u32 s46, s40, 49152
    buffer_load_dwordx4 v13, s[12:15], s46 offen lds
    s_waitcnt vmcnt(20)
    s_barrier
    s_bfe_u32 s40, s49, 0x40004
    s_bitcmp1_b32 s40, 3
    s_cselect_b32 s41, s39, s42
    s_xor_b32 s40, s40, s41
    s_mul_i32 s41, s40, 393216
    s_add_u32 s41, s41, s38
    s_lshl_b32 s40, s40, 7
    s_add_u32 s40, s40, s36
    s_add_u32 m0, s44, 40960
    s_add_u32 s46, s40, 0
    s_nop 0
    buffer_load_dwordx4 v12, s[12:15], s46 offen lds
    s_add_u32 m0, s45, 65536
    s_add_u32 s46, s41, 2048
    buffer_load_dwordx4 v14, s[16:19], s46 offen lds
    s_add_u32 m0, s45, 66560
    s_add_u32 s46, s41, 51200
    buffer_load_dwordx4 v15, s[16:19], s46 offen lds
    s_add_u32 m0, s45, 57344
    s_add_u32 s46, s41, 0
    s_add_u32 s46, s46, s47
    buffer_load_dwordx4 v14, s[16:19], s46 offen lds
    s_add_u32 m0, s45, 58368
    s_add_u32 s46, s41, 49152
    s_add_u32 s46, s46, s47
    s_nop 0
    buffer_load_dwordx4 v15, s[16:19], s46 offen lds
    s_add_u32 m0, s45, 73728
    s_add_u32 s46, s41, 4096
    buffer_load_dwordx4 v14, s[16:19], s46 offen lds
    s_add_u32 m0, s45, 74752
    s_add_u32 s46, s41, 53248
    buffer_load_dwordx4 v15, s[16:19], s46 offen lds
    s_add_u32 m0, s44, 41984
    s_add_u32 s46, s40, 16384
    buffer_load_dwordx4 v13, s[12:15], s46 offen lds
    s_add_u32 m0, s44, 43008
    s_add_u32 s46, s40, 32768
    buffer_load_dwordx4 v12, s[12:15], s46 offen lds
    s_add_u32 m0, s44, 44032
    s_add_u32 s46, s40, 49152
    buffer_load_dwordx4 v13, s[12:15], s46 offen lds
    s_mov_b32 s20, s8
    s_mov_b32 s21, s9
    s_mov_b32 s22, 0x200000
    s_mov_b32 s23, 0x00020000
    s_lshl_b32 s50, s2, 13
    s_lshl_b32 s51, s3, 11
    s_add_u32 s50, s50, s51
    v_lshlrev_b32 v104, 7, v0
    s_mov_b64 exec, 0xffff
    buffer_load_dword v112, v104, s[20:23], s50 offen
    s_mov_b64 exec, -1

    s_waitcnt vmcnt(21)
    s_barrier
    s_bfe_u32 s40, s49, 0x40008
    s_bitcmp1_b32 s40, 3
    s_cselect_b32 s41, s39, s42
    s_xor_b32 s40, s40, s41
    s_mul_i32 s41, s40, 393216
    s_add_u32 s41, s41, s38
    s_lshl_b32 s40, s40, 7
    s_add_u32 s40, s40, s36
    s_add_u32 m0, s44, 81920
    s_add_u32 s46, s40, 0
    buffer_load_dwordx4 v12, s[12:15], s46 offen lds
    s_add_u32 m0, s45, 106496
    s_add_u32 s46, s41, 2048
    buffer_load_dwordx4 v14, s[16:19], s46 offen lds
    s_add_u32 m0, s45, 107520
    s_add_u32 s46, s41, 51200
    buffer_load_dwordx4 v15, s[16:19], s46 offen lds
    s_add_u32 m0, s45, 98304
    s_add_u32 s46, s41, 0
    s_add_u32 s46, s46, s47
    buffer_load_dwordx4 v14, s[16:19], s46 offen lds
    s_add_u32 m0, s45, 99328
    s_add_u32 s46, s41, 49152
    s_add_u32 s46, s46, s47
    s_nop 0
    buffer_load_dwordx4 v15, s[16:19], s46 offen lds
    s_add_u32 m0, s45, 114688
    s_add_u32 s46, s41, 4096
    buffer_load_dwordx4 v14, s[16:19], s46 offen lds
    s_add_u32 m0, s45, 115712
    s_add_u32 s46, s41, 53248
    buffer_load_dwordx4 v15, s[16:19], s46 offen lds
    s_add_u32 m0, s44, 82944
    s_add_u32 s46, s40, 16384
    buffer_load_dwordx4 v13, s[12:15], s46 offen lds
    s_add_u32 m0, s44, 83968
    s_add_u32 s46, s40, 32768
    buffer_load_dwordx4 v12, s[12:15], s46 offen lds
    s_add_u32 m0, s44, 84992
    s_add_u32 s46, s40, 49152
    buffer_load_dwordx4 v13, s[12:15], s46 offen lds
    s_waitcnt vmcnt(21)
    s_barrier
    s_bfe_u32 s40, s49, 0x4000c
    s_bitcmp1_b32 s40, 3
    s_cselect_b32 s41, s39, s42
    s_xor_b32 s40, s40, s41
    s_mul_i32 s41, s40, 393216
    s_add_u32 s41, s41, s38
    s_lshl_b32 s40, s40, 7
    s_add_u32 s40, s40, s36
    s_add_u32 m0, s44, 122880
    s_add_u32 s46, s40, 0
    s_nop 0
    buffer_load_dwordx4 v12, s[12:15], s46 offen lds
    s_add_u32 m0, s45, 147456
    s_add_u32 s46, s41, 2048
    buffer_load_dwordx4 v14, s[16:19], s46 offen lds
    s_add_u32 m0, s45, 148480
    s_add_u32 s46, s41, 51200
    buffer_load_dwordx4 v15, s[16:19], s46 offen lds
    s_add_u32 m0, s45, 139264
    s_add_u32 s46, s41, 0
    s_add_u32 s46, s46, s47
    buffer_load_dwordx4 v14, s[16:19], s46 offen lds
    s_add_u32 m0, s45, 140288
    s_add_u32 s46, s41, 49152
    s_add_u32 s46, s46, s47
    s_nop 0
    buffer_load_dwordx4 v15, s[16:19], s46 offen lds
    s_add_u32 m0, s45, 155648
    s_add_u32 s46, s41, 4096
    buffer_load_dwordx4 v14, s[16:19], s46 offen lds
    s_add_u32 m0, s45, 156672
    s_add_u32 s46, s41, 53248
    buffer_load_dwordx4 v15, s[16:19], s46 offen lds
    s_add_u32 m0, s44, 123904
    s_add_u32 s46, s40, 16384
    buffer_load_dwordx4 v13, s[12:15], s46 offen lds
    s_add_u32 m0, s44, 124928
    s_add_u32 s46, s40, 32768
    buffer_load_dwordx4 v12, s[12:15], s46 offen lds
    s_add_u32 m0, s44, 125952
    s_add_u32 s46, s40, 49152
    buffer_load_dwordx4 v13, s[12:15], s46 offen lds
    s_waitcnt vmcnt(21)
    s_barrier
    s_bfe_u32 s40, s49, 0x40010
    s_bitcmp1_b32 s40, 3
    s_cselect_b32 s41, s39, s42
    s_xor_b32 s40, s40, s41
    s_mul_i32 s41, s40, 393216
    s_add_u32 s41, s41, s38
    s_lshl_b32 s40, s40, 7
    s_add_u32 s40, s40, s36
    s_add_u32 m0, s44, 0
    s_add_u32 s46, s40, 0
    buffer_load_dwordx4 v12, s[12:15], s46 offen lds
    s_add_u32 m0, s45, 24576
    s_add_u32 s46, s41, 2048
    buffer_load_dwordx4 v14, s[16:19], s46 offen lds
    s_add_u32 m0, s45, 25600
    s_add_u32 s46, s41, 51200
    buffer_load_dwordx4 v15, s[16:19], s46 offen lds
    s_add_u32 m0, s45, 16384
    s_add_u32 s46, s41, 0
    s_add_u32 s46, s46, s47
    buffer_load_dwordx4 v14, s[16:19], s46 offen lds
    s_add_u32 m0, s45, 17408
    s_add_u32 s46, s41, 49152
    s_add_u32 s46, s46, s47
    s_nop 0
    buffer_load_dwordx4 v15, s[16:19], s46 offen lds
    s_add_u32 m0, s45, 32768
    s_add_u32 s46, s41, 4096
    buffer_load_dwordx4 v14, s[16:19], s46 offen lds
    s_add_u32 m0, s45, 33792
    s_add_u32 s46, s41, 53248
    buffer_load_dwordx4 v15, s[16:19], s46 offen lds
    s_add_u32 m0, s44, 1024
    s_add_u32 s46, s40, 16384
    buffer_load_dwordx4 v13, s[12:15], s46 offen lds
    s_add_u32 m0, s44, 2048
    s_add_u32 s46, s40, 32768
    buffer_load_dwordx4 v12, s[12:15], s46 offen lds
    s_add_u32 m0, s44, 3072
    s_add_u32 s46, s40, 49152
    buffer_load_dwordx4 v13, s[12:15], s46 offen lds
    s_waitcnt vmcnt(20)
    s_barrier
    s_bfe_u32 s40, s49, 0x40014
    s_bitcmp1_b32 s40, 3
    s_cselect_b32 s41, s39, s42
    s_xor_b32 s40, s40, s41
    s_mul_i32 s41, s40, 393216
    s_add_u32 s41, s41, s38
    s_lshl_b32 s40, s40, 7
    s_add_u32 s40, s40, s36
    s_add_u32 m0, s44, 40960
    s_add_u32 s46, s40, 0
    s_nop 0
    buffer_load_dwordx4 v12, s[12:15], s46 offen lds
    s_add_u32 m0, s45, 65536
    s_add_u32 s46, s41, 2048
    buffer_load_dwordx4 v14, s[16:19], s46 offen lds
    s_add_u32 m0, s45, 66560
    s_add_u32 s46, s41, 51200
    buffer_load_dwordx4 v15, s[16:19], s46 offen lds
    s_add_u32 m0, s45, 57344
    s_add_u32 s46, s41, 0
    s_add_u32 s46, s46, s47
    buffer_load_dwordx4 v14, s[16:19], s46 offen lds
    s_add_u32 m0, s45, 58368
    s_add_u32 s46, s41, 49152
    s_add_u32 s46, s46, s47
    s_nop 0
    buffer_load_dwordx4 v15, s[16:19], s46 offen lds
    s_add_u32 m0, s45, 73728
    s_add_u32 s46, s41, 4096
    buffer_load_dwordx4 v14, s[16:19], s46 offen lds
    s_add_u32 m0, s45, 74752
    s_add_u32 s46, s41, 53248
    buffer_load_dwordx4 v15, s[16:19], s46 offen lds
    s_add_u32 m0, s44, 41984
    s_add_u32 s46, s40, 16384
    buffer_load_dwordx4 v13, s[12:15], s46 offen lds
    s_add_u32 m0, s44, 43008
    s_add_u32 s46, s40, 32768
    buffer_load_dwordx4 v12, s[12:15], s46 offen lds
    s_add_u32 m0, s44, 44032
    s_add_u32 s46, s40, 49152
    buffer_load_dwordx4 v13, s[12:15], s46 offen lds
    v_lshlrev_b32_e64 v10, 4, v0
    s_add_u32 s68, s72, 0x900000
    s_addc_u32 s69, s73, 0
    s_mov_b32 s70, 0x18000
    s_mov_b32 s71, 0x00020000
    s_lshl_b32 s52, s32, 11
    s_add_u32 s52, s52, 65536
    s_lshl_b32 s76, s3, 2
    s_add_u32 s52, s52, s76
    s_lshl_b32 s76, s3, 9
    s_add_u32 s58, s76, 24832

    s_waitcnt vmcnt(20)
    s_barrier
    s_bfe_u32 s40, s49, 0x40018
    s_bitcmp1_b32 s40, 3
    s_cselect_b32 s41, s39, s42
    s_xor_b32 s40, s40, s41
    s_mul_i32 s41, s40, 393216
    s_add_u32 s41, s41, s38
    s_lshl_b32 s40, s40, 7
    s_add_u32 s40, s40, s36
    s_add_u32 m0, s44, 81920
    s_add_u32 s46, s40, 0
    buffer_load_dwordx4 v12, s[12:15], s46 offen lds
    s_add_u32 m0, s45, 106496
    s_add_u32 s46, s41, 2048
    buffer_load_dwordx4 v14, s[16:19], s46 offen lds
    s_add_u32 m0, s45, 107520
    s_add_u32 s46, s41, 51200
    buffer_load_dwordx4 v15, s[16:19], s46 offen lds
    s_add_u32 m0, s45, 98304
    s_add_u32 s46, s41, 0
    s_add_u32 s46, s46, s47
    buffer_load_dwordx4 v14, s[16:19], s46 offen lds
    s_add_u32 m0, s45, 99328
    s_add_u32 s46, s41, 49152
    s_add_u32 s46, s46, s47
    s_nop 0
    buffer_load_dwordx4 v15, s[16:19], s46 offen lds
    s_add_u32 m0, s45, 114688
    s_add_u32 s46, s41, 4096
    buffer_load_dwordx4 v14, s[16:19], s46 offen lds
    s_add_u32 m0, s45, 115712
    s_add_u32 s46, s41, 53248
    buffer_load_dwordx4 v15, s[16:19], s46 offen lds
    s_add_u32 m0, s44, 82944
    s_add_u32 s46, s40, 16384
    buffer_load_dwordx4 v13, s[12:15], s46 offen lds
    s_add_u32 m0, s44, 83968
    s_add_u32 s46, s40, 32768
    buffer_load_dwordx4 v12, s[12:15], s46 offen lds
    s_add_u32 m0, s44, 84992
    s_add_u32 s46, s40, 49152
    buffer_load_dwordx4 v13, s[12:15], s46 offen lds
    s_add_u32 s84, s72, 0xb00000
    s_addc_u32 s85, s73, 0
    s_mov_b32 s86, 0x30000
    s_mov_b32 s87, 0x00020000
    v_bfe_u32 v113, v0, 2, 2
    v_min_u32 v113, 2, v113
    v_lshlrev_b32 v114, 8, v113
    v_lshlrev_b32 v113, 12, v113
    v_and_b32 v112, 3, v0
    v_lshl_add_u32 v113, v112, 4, v113
    v_lshl_add_u32 v114, v112, 4, v114
    v_lshrrev_b32 v112, 4, v0
    v_mul_u32_u24 v112, 12288, v112
    v_add_u32 v113, v113, v112
    s_lshl_b32 s76, s3, 6
    s_lshl_b32 s53, s33, 8
    s_add_u32 s53, s53, s76
    s_add_u32 s76, s76, 26368
    v_add_u32 v114, s76, v114

    s_waitcnt vmcnt(20)
    s_barrier
    s_bfe_u32 s40, s49, 0x4001c
    s_bitcmp1_b32 s40, 3
    s_cselect_b32 s41, s39, s42
    s_xor_b32 s40, s40, s41
    s_mul_i32 s41, s40, 393216
    s_add_u32 s41, s41, s38
    s_lshl_b32 s40, s40, 7
    s_add_u32 s40, s40, s36
    s_add_u32 m0, s44, 122880
    s_add_u32 s46, s40, 0
    buffer_load_dwordx4 v12, s[12:15], s46 offen lds
    s_add_u32 m0, s45, 147456
    s_add_u32 s46, s41, 2048
    buffer_load_dwordx4 v14, s[16:19], s46 offen lds
    s_add_u32 m0, s45, 148480
    s_add_u32 s46, s41, 51200
    buffer_load_dwordx4 v15, s[16:19], s46 offen lds
    s_add_u32 m0, s45, 139264
    s_add_u32 s46, s41, 0
    s_add_u32 s46, s46, s47
    buffer_load_dwordx4 v14, s[16:19], s46 offen lds
    s_add_u32 m0, s45, 140288
    s_add_u32 s46, s41, 49152
    s_add_u32 s46, s46, s47
    s_nop 0
    buffer_load_dwordx4 v15, s[16:19], s46 offen lds
    s_add_u32 m0, s45, 155648
    s_add_u32 s46, s41, 4096
    buffer_load_dwordx4 v14, s[16:19], s46 offen lds
    s_add_u32 m0, s45, 156672
    s_add_u32 s46, s41, 53248
    buffer_load_dwordx4 v15, s[16:19], s46 offen lds
    s_add_u32 m0, s44, 123904
    s_add_u32 s46, s40, 16384
    buffer_load_dwordx4 v13, s[12:15], s46 offen lds
    s_add_u32 m0, s44, 124928
    s_add_u32 s46, s40, 32768
    buffer_load_dwordx4 v12, s[12:15], s46 offen lds
    s_add_u32 m0, s44, 125952
    s_add_u32 s46, s40, 49152
    buffer_load_dwordx4 v13, s[12:15], s46 offen lds
    s_add_u32 s76, s53, 0
    s_nop 0
    buffer_load_dwordx4 v[72:75], v113, s[84:87], s76 offen sc0 sc1
    s_add_u32 s76, s53, 49152
    buffer_load_dwordx4 v[76:79], v113, s[84:87], s76 offen sc0 sc1
    s_add_u32 s76, s53, 98304
    buffer_load_dwordx4 v[80:83], v113, s[84:87], s76 offen sc0 sc1
    s_add_u32 s76, s53, 147456
    buffer_load_dwordx4 v[84:87], v113, s[84:87], s76 offen sc0 sc1
    s_mov_b32 m0, s58
    s_setprio 3
    s_waitcnt vmcnt(24)
    s_barrier
    s_cmp_eq_u32 s3, 3
    s_cbranch_scc1 F_d0
    buffer_load_dword v10, s[68:71], s52 offen sc0 sc1 lds
    s_add_u32 m0, m0, 256
    s_add_u32 s52, s52, 1024
    buffer_load_dword v10, s[68:71], s52 offen sc0 sc1 lds
    s_branch F_d1
F_d0:
    s_nop 0
    s_mov_b32 m0, 24576
    s_mov_b32 s52, 0x7ff00000
    s_mov_b64 exec, 0xfff
    buffer_load_dwordx4 v10, s[84:87], s52 offen lds
    buffer_load_dwordx4 v10, s[84:87], s52 offen lds
    s_mov_b64 exec, -1
F_d1:

    s_setprio 0
    s_waitcnt vmcnt(16)
    s_barrier
    s_waitcnt vmcnt(2)
F_cs0:
    v_min3_u32 v96, v72, v76, v80
    v_min_u32 v96, v96, v84
    v_cmp_eq_u32 vcc, 0, v96
    s_cbranch_vccz F_cs1
    s_sleep 8

    s_add_u32 s76, s53, 0
    buffer_load_dwordx4 v[72:75], v113, s[84:87], s76 offen sc0 sc1
    s_add_u32 s76, s53, 49152
    buffer_load_dwordx4 v[76:79], v113, s[84:87], s76 offen sc0 sc1
    s_add_u32 s76, s53, 98304
    buffer_load_dwordx4 v[80:83], v113, s[84:87], s76 offen sc0 sc1
    s_add_u32 s76, s53, 147456
    buffer_load_dwordx4 v[84:87], v113, s[84:87], s76 offen sc0 sc1
    s_waitcnt vmcnt(0)
    s_branch F_cs0
F_cs1:
    v_add_f32 v72, v72, v76
    v_add_f32 v80, v80, v84
    v_add_f32 v73, v73, v77
    v_add_f32 v81, v81, v85
    v_add_f32 v74, v74, v78
    v_add_f32 v82, v82, v86
    v_add_f32 v75, v75, v79
    v_add_f32 v83, v83, v87
    v_add_f32 v72, v72, v80
    v_add_f32 v73, v73, v81
    v_add_f32 v74, v74, v82
    v_add_f32 v75, v75, v83
    v_mov_b32 v76, v72
    v_mov_b32 v77, v73
    v_mov_b32 v78, v74
    v_mov_b32 v79, v75
    v_permlane32_swap_b32 v72, v76
    v_permlane32_swap_b32 v73, v77
    v_permlane32_swap_b32 v74, v78
    v_permlane32_swap_b32 v75, v79
    v_add_f32 v72, v72, v76
    v_add_f32 v73, v73, v77
    v_add_f32 v74, v74, v78
    v_add_f32 v75, v75, v79
    v_mov_b32 v76, v72
    v_mov_b32 v77, v73
    v_mov_b32 v78, v74
    v_mov_b32 v79, v75
    v_permlane16_swap_b32 v72, v76
    v_permlane16_swap_b32 v73, v77
    v_permlane16_swap_b32 v74, v78
    v_permlane16_swap_b32 v75, v79
    v_add_f32 v72, v72, v76
    v_add_f32 v73, v73, v77
    v_add_f32 v74, v74, v78
    v_add_f32 v75, v75, v79
    s_mov_b64 exec, 0xfff
    ds_write_b128 v114, v[72:75]
    s_mov_b64 exec, -1
    s_waitcnt lgkmcnt(0)

    s_waitcnt vmcnt(0)
    s_barrier
    s_add_u32 s24, s72, 0x800000
    s_addc_u32 s25, s73, 0
    s_mov_b32 s26, 0x100000
    s_mov_b32 s27, 0x00020000
    s_add_u32 s12, s72, 0x400000
    s_addc_u32 s13, s73, 0
    s_mov_b32 s14, 0x400000
    s_mov_b32 s15, 0x00020000
    s_mov_b32 s16, s8
    s_mov_b32 s17, s9
    s_mov_b32 s18, 0x200000
    s_mov_b32 s19, 0x00020000
    v_lshrrev_b32 v4, 4, v0
    v_and_b32 v3, 15, v0
    v_lshlrev_b32 v6, 1, v4
    v_xor_b32 v8, v3, v6
    v_xor_b32 v9, 8, v8
    v_lshlrev_b32 v8, 4, v8
    v_lshlrev_b32 v9, 4, v9
    v_lshl_add_u32 v8, v4, 11, v8
    v_lshl_add_u32 v9, v4, 11, v9
    s_lshl_b32 s38, s29, 8
    s_lshl_b32 s45, s3, 15
    s_add_u32 s38, s38, s45
    s_lshl_b32 s45, s3, 12
    s_mul_i32 s39, s35, 4
    s_mul_i32 s40, s34, 0
    s_add_u32 s39, s39, s40
    s_and_b32 s59, s34, 3

    s_lshr_b32 s36, s3, 1
    s_and_b32 s37, s3, 1
    s_lshl_b32 s43, s36, 6
    s_lshl_b32 s42, s33, 1
    s_add_u32 s42, s42, s37
    s_mul_i32 s82, s42, 4224
    s_add_u32 s83, s82, 4096
    s_add_u32 s83, s83, s43
    s_lshl_b32 s44, s36, 11
    s_add_u32 s82, s82, s44
    s_mul_i32 s51, s42, 16*64
    s_add_u32 s51, s51, 192512
    s_lshl_b32 s42, s10, 1
    s_add_u32 s42, s42, s37
    s_lshl_b32 s50, s42, 4
    s_add_u32 s50, s50, s32
    s_lshl_b32 s50, s50, 6
    v_lshlrev_b32 v10, 4, v0
    v_lshlrev_b32 v11, 2, v0
    s_lshl_b32 s42, s3, 2
    s_add_u32 s42, s42, 24640
    v_mov_b32 v1, s42
    v_and_b32 v2, 3, v0
    v_lshlrev_b32 v2, 2, v2
    v_add_u32 v2, 24640, v2
    v_and_b32 v105, 1, v0
    v_lshlrev_b32 v105, 3, v105
    s_lshl_b32 s42, s37, 2
    s_add_u32 s42, s42, 24640
    v_add_u32 v105, s42, v105
    s_lshl_b32 s42, s37, 12
    s_add_u32 s42, s42, s44
    s_add_u32 s42, s42, 65536
    v_add_u32 v106, s42, v11
    s_lshl_b32 s42, s37, 7
    s_add_u32 s42, s42, s43
    s_add_u32 s42, s42, 27136
    v_add_u32 v107, s42, v11
    v_mul_u32_u24 v108, 64*16/4, v0
    v_mov_b32 v109, 1
    s_mov_b32 s60, 0
    s_mov_b32 s62, 0xa001024
    s_mov_b32 s63, 0x1a1e14
    s_lshl_b32 s36, s28, 2
    s_add_u32 s36, s36, s3
    s_lshl_b32 s36, s36, 15
    s_lshl_b32 s44, s3, 11
    s_lshl_b32 s50, s28, 3
    s_and_b32 s76, s29, 4-1
    s_mul_i32 s76, s76, 8/4
    s_add_u32 s50, s50, s76
    s_mul_i32 s50, s50, 64
    s_add_u32 s78, s50, 0x837000
    s_add_u32 s78, s72, s78
    s_addc_u32 s79, s73, 0
    s_setprio 3
    s_sleep 10
    s_lshr_b32 s56, s3, 1
    s_add_u32 s56, s56, 1
    ds_read_b32 v114, v105
FW_3:
    s_waitcnt lgkmcnt(0)
    v_cmp_gt_u32 vcc, s56, v114
    s_cbranch_vccz FO_4
    s_sleep 1
    ds_read_b32 v114, v105
    s_branch FW_3
FO_4:
    ds_read2st64_b32 v[12:13], v106 offset0:0 offset1:1
    ds_read2st64_b32 v[20:21], v106 offset0:32 offset1:33
    ds_read2st64_b32 v[14:15], v106 offset0:2 offset1:3
    ds_read2st64_b32 v[22:23], v106 offset0:34 offset1:35
    ds_read2st64_b32 v[16:17], v106 offset0:4 offset1:5
    ds_read2st64_b32 v[24:25], v106 offset0:36 offset1:37
    ds_read2st64_b32 v[18:19], v106 offset0:6 offset1:7
    ds_read2st64_b32 v[26:27], v106 offset0:38 offset1:39
    ds_read2st64_b32 v[28:29], v107 offset0:0 offset1:1
    s_waitcnt lgkmcnt(7)
    v_add_f32 v12, v12, v20
    buffer_atomic_add_f32 v12, v11, s[24:27], s82 offen offset:0
    v_add_f32 v13, v13, v21
    buffer_atomic_add_f32 v13, v11, s[24:27], s82 offen offset:256
    s_waitcnt lgkmcnt(5)
    v_add_f32 v14, v14, v22
    buffer_atomic_add_f32 v14, v11, s[24:27], s82 offen offset:512
    v_add_f32 v15, v15, v23
    buffer_atomic_add_f32 v15, v11, s[24:27], s82 offen offset:768
    s_waitcnt lgkmcnt(3)
    v_add_f32 v16, v16, v24
    buffer_atomic_add_f32 v16, v11, s[24:27], s82 offen offset:1024
    v_add_f32 v17, v17, v25
    buffer_atomic_add_f32 v17, v11, s[24:27], s82 offen offset:1280
    s_waitcnt lgkmcnt(1)
    v_add_f32 v18, v18, v26
    buffer_atomic_add_f32 v18, v11, s[24:27], s82 offen offset:1536
    v_add_f32 v19, v19, v27
    buffer_atomic_add_f32 v19, v11, s[24:27], s82 offen offset:1792
    s_waitcnt lgkmcnt(0)
    v_add_f32 v28, v28, v29
    s_mov_b64 exec, 0xffff
    buffer_atomic_add_f32 v28, v11, s[24:27], s83 offen
    s_mov_b64 exec, -1
    v_mov_b32 v113, 1
    s_mov_b64 exec, 1
    ds_write_b32 v1, v113 offset:32
    s_mov_b64 exec, -1
    s_add_u32 s54, s51, 0x800000
    s_add_u32 s54, s72, s54
    s_addc_u32 s55, s73, 0
    s_mov_b32 s57, 1
    s_waitcnt vmcnt(4)
    ds_read2_b32 v[102:103], v2 offset0:0 offset1:8
    ds_read_b32 v104, v2 offset:16
    s_waitcnt lgkmcnt(0)
    v_cmp_ne_u32 vcc, 3, v102
    v_cmp_eq_u32 s[42:43], 0, v103
    s_nop 0
    s_or_b64 vcc, vcc, s[42:43]
    v_cmp_gt_u32 s[42:43], 2, v104
    s_nop 0
    s_or_b64 vcc, vcc, s[42:43]
    s_waitcnt vmcnt(0)
    s_atomic_add s57, s[54:55], 0
    s_atomic_add s57, s[54:55], 256
    s_atomic_add s57, s[54:55], 512
    s_atomic_add s57, s[54:55], 768
    s_cbranch_vccnz F_pe
    s_add_u32 s41, s39, 0
    s_and_b32 s41, s41, 15
    s_xor_b32 s41, s41, s59
    s_lshl_b32 s41, s41, 17
    s_add_u32 s41, s41, s38
    s_add_u32 m0, s45, 147456
    s_add_u32 s76, s41, 0
    buffer_load_dwordx4 v8, s[16:19], s76 offen lds
    s_add_u32 m0, s45, 148480
    s_add_u32 s76, s41, 8192
    buffer_load_dwordx4 v9, s[16:19], s76 offen lds
    s_add_u32 m0, s45, 149504
    s_add_u32 s76, s41, 16384
    buffer_load_dwordx4 v8, s[16:19], s76 offen lds
    s_add_u32 m0, s45, 150528
    s_add_u32 s76, s41, 24576
    buffer_load_dwordx4 v9, s[16:19], s76 offen lds
    s_add_u32 s41, s39, 1
    s_and_b32 s41, s41, 15
    s_xor_b32 s41, s41, s59
    s_lshl_b32 s41, s41, 17
    s_add_u32 s41, s41, s38
    s_add_u32 m0, s45, 65536
    s_add_u32 s76, s41, 0
    buffer_load_dwordx4 v8, s[16:19], s76 offen lds
    s_add_u32 m0, s45, 66560
    s_add_u32 s76, s41, 8192
    buffer_load_dwordx4 v9, s[16:19], s76 offen lds
    s_add_u32 m0, s45, 67584
    s_add_u32 s76, s41, 16384
    buffer_load_dwordx4 v8, s[16:19], s76 offen lds
    s_add_u32 m0, s45, 68608
    s_add_u32 s76, s41, 24576
    buffer_load_dwordx4 v9, s[16:19], s76 offen lds
    s_add_u32 s41, s39, 2
    s_and_b32 s41, s41, 15
    s_xor_b32 s41, s41, s59
    s_lshl_b32 s41, s41, 17
    s_add_u32 s41, s41, s38
    s_add_u32 m0, s45, 0
    s_add_u32 s76, s41, 0
    s_nop 0
    buffer_load_dwordx4 v8, s[16:19], s76 offen lds
    s_add_u32 m0, s45, 1024
    s_add_u32 s76, s41, 8192
    buffer_load_dwordx4 v9, s[16:19], s76 offen lds
    s_add_u32 m0, s45, 2048
    s_add_u32 s76, s41, 16384
    buffer_load_dwordx4 v8, s[16:19], s76 offen lds
    s_add_u32 m0, s45, 3072
    s_add_u32 s76, s41, 24576
    buffer_load_dwordx4 v9, s[16:19], s76 offen lds
    s_mov_b32 s60, 3
F_pe:
    s_setprio 1
F_pr0:
    s_waitcnt vmcnt(8)
    ds_read2_b32 v[102:103], v2 offset0:0 offset1:8
    s_cmp_lt_u32 s60, 2
    s_cselect_b32 s61, 1, 3
    s_waitcnt lgkmcnt(0)
    v_cmp_le_u32 vcc, 4, v102
    s_cbranch_vccz F_pr3
    s_mov_b32 s61, 5
F_pr3:
    v_cmp_gt_u32 vcc, s61, v102
    v_cmp_gt_u32 s[42:43], 1, v103
    s_nop 0
    s_or_b64 vcc, vcc, s[42:43]
    s_cbranch_vccz F_pr2
    s_sleep 2
    s_branch F_pr0
F_pr2:
    s_cmp_lt_u32 s60, 6
    s_cbranch_scc1 F_pr4
    ds_read_b32 v102, v2 offset:16
    s_waitcnt lgkmcnt(0)
    v_cmp_gt_u32 vcc, 2, v102
    s_cbranch_vccz F_pr4
    s_sleep 2
    s_branch F_pr0
F_pr4:
    s_cmp_lg_u32 s60, 99
    s_cbranch_scc1 F_pr6
    s_waitcnt vmcnt(16)
    v_mov_b32_e64 v113, 2
    s_mov_b64 exec, 1
    ds_write_b32 v1, v113 offset:32
    s_mov_b64 exec, -1
F_pr6:
    s_add_u32 s41, s39, s60
    s_and_b32 s41, s41, 15
    s_xor_b32 s41, s41, s59
    s_lshl_b32 s41, s41, 17
    s_add_u32 s41, s41, s38
    s_lshl_b32 s76, s60, 3
    s_lshr_b64 s[42:43], s[62:63], s76
    s_and_b32 s42, s42, 0xff
    s_lshl_b32 s42, s42, 12
    s_add_u32 m0, s42, s45
    s_add_u32 s60, s60, 1
    buffer_load_dwordx4 v8, s[16:19], s41 offen lds
    s_add_u32 m0, m0, 1024
    s_add_u32 s41, s41, 8192
    buffer_load_dwordx4 v9, s[16:19], s41 offen lds
    s_add_u32 m0, m0, 1024
    s_add_u32 s41, s41, 8192
    buffer_load_dwordx4 v8, s[16:19], s41 offen lds
    s_add_u32 m0, m0, 1024
    s_add_u32 s41, s41, 8192
    buffer_load_dwordx4 v9, s[16:19], s41 offen lds
    s_cmp_ge_u32 s60, 7
    s_cbranch_scc1 F_pr1
    s_cmp_eq_u32 s61, 5
    s_cbranch_scc1 F_pr2
    s_branch F_pr0
F_pr1:
    s_cmp_lg_u32 s3, 0
    s_cbranch_scc1 F_l4
SP_5:
    s_load_dword s58, s[78:79], 0 glc
    s_waitcnt lgkmcnt(0)
    s_cmp_ge_u32 s58, 32
    s_cbranch_scc1 SD_6
    s_sleep 1
    s_branch SP_5
SD_6:
F_l6:
    v_mov_b32 v113, 3
    s_mov_b64 exec, 1
    ds_write_b32 v1, v113 offset:112
    s_mov_b64 exec, -1
    s_branch F_l5
F_l4:
    v_mov_b32 v4, 24752
    ds_read_b32 v13, v4
FW_7:
    s_waitcnt lgkmcnt(0)
    v_cmp_gt_u32_e64 vcc, 3, v13
    s_cbranch_vccz FO_8
    s_sleep 1
    ds_read_b32 v13, v4
    s_branch FW_7
FO_8:
F_l5:
    s_add_u32 s40, s39, 0
    s_and_b32 s40, s40, 15
    s_xor_b32 s40, s40, s59
    s_lshl_b32 s40, s40, 11
    s_add_u32 s40, s40, s36
    s_add_u32 m0, s44, 16384
    s_nop 0
    buffer_load_dwordx4 v10, s[12:15], s40 offen offset:0 sc1 lds
    s_add_u32 m0, s44, 16384
    s_nop 0
    buffer_load_dwordx4 v10, s[12:15], s40 offen offset:1024 sc1 lds
    s_add_u32 s40, s39, 1
    s_and_b32 s40, s40, 15
    s_xor_b32 s40, s40, s59
    s_lshl_b32 s40, s40, 11
    s_add_u32 s40, s40, s36
    s_add_u32 m0, s44, 98304
    s_nop 0
    buffer_load_dwordx4 v10, s[12:15], s40 offen offset:0 sc1 lds
    s_add_u32 m0, s44, 98304
    s_nop 0
    buffer_load_dwordx4 v10, s[12:15], s40 offen offset:1024 sc1 lds
    s_add_u32 s40, s39, 2
    s_and_b32 s40, s40, 15
    s_xor_b32 s40, s40, s59
    s_lshl_b32 s40, s40, 11
    s_add_u32 s40, s40, s36
    s_add_u32 m0, s44, 139264
    s_nop 0
    buffer_load_dwordx4 v10, s[12:15], s40 offen offset:0 sc1 lds
    s_add_u32 m0, s44, 139264
    s_nop 0
    buffer_load_dwordx4 v10, s[12:15], s40 offen offset:1024 sc1 lds
    s_waitcnt vmcnt(4)
    s_barrier
    s_add_u32 s40, s39, 3
    s_and_b32 s40, s40, 15
    s_xor_b32 s40, s40, s59
    s_lshl_b32 s40, s40, 11
    s_add_u32 s40, s40, s36
    s_add_u32 m0, s44, 57344
    s_nop 0
    buffer_load_dwordx4 v10, s[12:15], s40 offen offset:0 sc1 lds
    s_add_u32 m0, s44, 57344
    s_nop 0
    buffer_load_dwordx4 v10, s[12:15], s40 offen offset:1024 sc1 lds
    s_setprio 0
    s_waitcnt vmcnt(4)
    s_barrier
    s_add_u32 s40, s39, 4
    s_and_b32 s40, s40, 15
    s_xor_b32 s40, s40, s59
    s_lshl_b32 s40, s40, 11
    s_add_u32 s40, s40, s36
    s_add_u32 m0, s44, 16384
    s_nop 0
    buffer_load_dwordx4 v10, s[12:15], s40 offen offset:0 sc1 lds
    s_add_u32 m0, s44, 16384
    s_nop 0
    buffer_load_dwordx4 v10, s[12:15], s40 offen offset:1024 sc1 lds
    s_add_u32 s41, s39, 7
    s_and_b32 s41, s41, 15
    s_xor_b32 s41, s41, s59
    s_lshl_b32 s41, s41, 17
    s_add_u32 s41, s41, s38
    s_add_u32 m0, s45, 147456
    s_add_u32 s76, s41, 0
    buffer_load_dwordx4 v8, s[16:19], s76 offen lds
    s_add_u32 m0, s45, 148480
    s_add_u32 s76, s41, 8192
    buffer_load_dwordx4 v9, s[16:19], s76 offen lds
    s_add_u32 m0, s45, 149504
    s_add_u32 s76, s41, 16384
    buffer_load_dwordx4 v8, s[16:19], s76 offen lds
    s_add_u32 m0, s45, 150528
    s_add_u32 s76, s41, 24576
    buffer_load_dwordx4 v9, s[16:19], s76 offen lds
    s_waitcnt vmcnt(8)
    s_barrier
    s_add_u32 s40, s39, 5
    s_and_b32 s40, s40, 15
    s_xor_b32 s40, s40, s59
    s_lshl_b32 s40, s40, 11
    s_add_u32 s40, s40, s36
    s_add_u32 m0, s44, 98304
    s_nop 0
    buffer_load_dwordx4 v10, s[12:15], s40 offen offset:0 sc1 lds
    s_add_u32 m0, s44, 98304
    s_nop 0
    buffer_load_dwordx4 v10, s[12:15], s40 offen offset:1024 sc1 lds
    s_add_u32 s41, s39, 8
    s_and_b32 s41, s41, 15
    s_xor_b32 s41, s41, s59
    s_lshl_b32 s41, s41, 17
    s_add_u32 s41, s41, s38
    s_add_u32 m0, s45, 65536
    s_add_u32 s76, s41, 0
    s_nop 0
    buffer_load_dwordx4 v8, s[16:19], s76 offen lds
    s_add_u32 m0, s45, 66560
    s_add_u32 s76, s41, 8192
    buffer_load_dwordx4 v9, s[16:19], s76 offen lds
    s_add_u32 m0, s45, 67584
    s_add_u32 s76, s41, 16384
    buffer_load_dwordx4 v8, s[16:19], s76 offen lds
    s_add_u32 m0, s45, 68608
    s_add_u32 s76, s41, 24576
    buffer_load_dwordx4 v9, s[16:19], s76 offen lds
    s_waitcnt vmcnt(12)
    s_barrier
    s_add_u32 s40, s39, 6
    s_and_b32 s40, s40, 15
    s_xor_b32 s40, s40, s59
    s_lshl_b32 s40, s40, 11
    s_add_u32 s40, s40, s36
    s_add_u32 m0, s44, 139264
    s_nop 0
    buffer_load_dwordx4 v10, s[12:15], s40 offen offset:0 sc1 lds
    s_add_u32 m0, s44, 139264
    s_nop 0
    buffer_load_dwordx4 v10, s[12:15], s40 offen offset:1024 sc1 lds
    s_add_u32 s41, s39, 9
    s_and_b32 s41, s41, 15
    s_xor_b32 s41, s41, s59
    s_lshl_b32 s41, s41, 17
    s_add_u32 s41, s41, s38
    s_add_u32 m0, s45, 0
    s_add_u32 s76, s41, 0
    buffer_load_dwordx4 v8, s[16:19], s76 offen lds
    s_add_u32 m0, s45, 1024
    s_add_u32 s76, s41, 8192
    buffer_load_dwordx4 v9, s[16:19], s76 offen lds
    s_add_u32 m0, s45, 2048
    s_add_u32 s76, s41, 16384
    buffer_load_dwordx4 v8, s[16:19], s76 offen lds
    s_add_u32 m0, s45, 3072
    s_add_u32 s76, s41, 24576
    buffer_load_dwordx4 v9, s[16:19], s76 offen lds
    s_waitcnt vmcnt(16)
    s_barrier
    s_add_u32 s40, s39, 7
    s_and_b32 s40, s40, 15
    s_xor_b32 s40, s40, s59
    s_lshl_b32 s40, s40, 11
    s_add_u32 s40, s40, s36
    s_add_u32 m0, s44, 57344
    s_nop 0
    buffer_load_dwordx4 v10, s[12:15], s40 offen offset:0 sc1 lds
    s_add_u32 m0, s44, 57344
    s_nop 0
    buffer_load_dwordx4 v10, s[12:15], s40 offen offset:1024 sc1 lds
    s_add_u32 s41, s39, 10
    s_and_b32 s41, s41, 15
    s_xor_b32 s41, s41, s59
    s_lshl_b32 s41, s41, 17
    s_add_u32 s41, s41, s38
    s_add_u32 m0, s45, 40960
    s_add_u32 s76, s41, 0
    s_nop 0
    buffer_load_dwordx4 v8, s[16:19], s76 offen lds
    s_add_u32 m0, s45, 41984
    s_add_u32 s76, s41, 8192
    buffer_load_dwordx4 v9, s[16:19], s76 offen lds
    s_add_u32 m0, s45, 43008
    s_add_u32 s76, s41, 16384
    buffer_load_dwordx4 v8, s[16:19], s76 offen lds
    s_add_u32 m0, s45, 44032
    s_add_u32 s76, s41, 24576
    buffer_load_dwordx4 v9, s[16:19], s76 offen lds
    s_waitcnt vmcnt(16)
    s_barrier
    s_add_u32 s40, s39, 8
    s_and_b32 s40, s40, 15
    s_xor_b32 s40, s40, s59
    s_lshl_b32 s40, s40, 11
    s_add_u32 s40, s40, s36
    s_add_u32 m0, s44, 16384
    s_nop 0
    buffer_load_dwordx4 v10, s[12:15], s40 offen offset:0 sc1 lds
    s_add_u32 m0, s44, 16384
    s_nop 0
    buffer_load_dwordx4 v10, s[12:15], s40 offen offset:1024 sc1 lds
    s_add_u32 s41, s39, 11
    s_and_b32 s41, s41, 15
    s_xor_b32 s41, s41, s59
    s_lshl_b32 s41, s41, 17
    s_add_u32 s41, s41, s38
    s_add_u32 m0, s45, 81920
    s_add_u32 s76, s41, 0
    s_nop 0
    buffer_load_dwordx4 v8, s[16:19], s76 offen lds
    s_add_u32 m0, s45, 82944
    s_add_u32 s76, s41, 8192
    buffer_load_dwordx4 v9, s[16:19], s76 offen lds
    s_add_u32 m0, s45, 83968
    s_add_u32 s76, s41, 16384
    buffer_load_dwordx4 v8, s[16:19], s76 offen lds
    s_add_u32 m0, s45, 84992
    s_add_u32 s76, s41, 24576
    buffer_load_dwordx4 v9, s[16:19], s76 offen lds
    s_waitcnt vmcnt(16)
    s_barrier
    s_add_u32 s40, s39, 9
    s_and_b32 s40, s40, 15
    s_xor_b32 s40, s40, s59
    s_lshl_b32 s40, s40, 11
    s_add_u32 s40, s40, s36
    s_add_u32 m0, s44, 98304
    s_nop 0
    buffer_load_dwordx4 v10, s[12:15], s40 offen offset:0 sc1 lds
    s_add_u32 m0, s44, 98304
    s_nop 0
    buffer_load_dwordx4 v10, s[12:15], s40 offen offset:1024 sc1 lds
    s_add_u32 s41, s39, 12
    s_and_b32 s41, s41, 15
    s_xor_b32 s41, s41, s59
    s_lshl_b32 s41, s41, 17
    s_add_u32 s41, s41, s38
    s_add_u32 m0, s45, 122880
    s_add_u32 s76, s41, 0
    s_nop 0
    buffer_load_dwordx4 v8, s[16:19], s76 offen lds
    s_add_u32 m0, s45, 123904
    s_add_u32 s76, s41, 8192
    buffer_load_dwordx4 v9, s[16:19], s76 offen lds
    s_add_u32 m0, s45, 124928
    s_add_u32 s76, s41, 16384
    buffer_load_dwordx4 v8, s[16:19], s76 offen lds
    s_add_u32 m0, s45, 125952
    s_add_u32 s76, s41, 24576
    buffer_load_dwordx4 v9, s[16:19], s76 offen lds
    s_waitcnt vmcnt(16)
    s_barrier
    s_add_u32 s40, s39, 10
    s_and_b32 s40, s40, 15
    s_xor_b32 s40, s40, s59
    s_lshl_b32 s40, s40, 11
    s_add_u32 s40, s40, s36
    s_add_u32 m0, s44, 139264
    s_nop 0
    buffer_load_dwordx4 v10, s[12:15], s40 offen offset:0 sc1 lds
    s_add_u32 m0, s44, 139264
    s_nop 0
    buffer_load_dwordx4 v10, s[12:15], s40 offen offset:1024 sc1 lds
    s_add_u32 s41, s39, 13
    s_and_b32 s41, s41, 15
    s_xor_b32 s41, s41, s59
    s_lshl_b32 s41, s41, 17
    s_add_u32 s41, s41, s38
    s_add_u32 m0, s45, 106496
    s_add_u32 s76, s41, 0
    s_nop 0
    buffer_load_dwordx4 v8, s[16:19], s76 offen lds
    s_add_u32 m0, s45, 107520
    s_add_u32 s76, s41, 8192
    buffer_load_dwordx4 v9, s[16:19], s76 offen lds
    s_add_u32 m0, s45, 108544
    s_add_u32 s76, s41, 16384
    buffer_load_dwordx4 v8, s[16:19], s76 offen lds
    s_add_u32 m0, s45, 109568
    s_add_u32 s76, s41, 24576
    buffer_load_dwordx4 v9, s[16:19], s76 offen lds
    s_waitcnt vmcnt(16)
    s_barrier
    s_add_u32 s40, s39, 11
    s_and_b32 s40, s40, 15
    s_xor_b32 s40, s40, s59
    s_lshl_b32 s40, s40, 11
    s_add_u32 s40, s40, s36
    s_add_u32 m0, s44, 57344
    s_nop 0
    buffer_load_dwordx4 v10, s[12:15], s40 offen offset:0 sc1 lds
    s_add_u32 m0, s44, 57344
    s_nop 0
    buffer_load_dwordx4 v10, s[12:15], s40 offen offset:1024 sc1 lds
    s_add_u32 s41, s39, 14
    s_and_b32 s41, s41, 15
    s_xor_b32 s41, s41, s59
    s_lshl_b32 s41, s41, 17
    s_add_u32 s41, s41, s38
    s_add_u32 m0, s45, 147456
    s_add_u32 s76, s41, 0
    s_nop 0
    buffer_load_dwordx4 v8, s[16:19], s76 offen lds
    s_add_u32 m0, s45, 148480
    s_add_u32 s76, s41, 8192
    buffer_load_dwordx4 v9, s[16:19], s76 offen lds
    s_add_u32 m0, s45, 149504
    s_add_u32 s76, s41, 16384
    buffer_load_dwordx4 v8, s[16:19], s76 offen lds
    s_add_u32 m0, s45, 150528
    s_add_u32 s76, s41, 24576
    buffer_load_dwordx4 v9, s[16:19], s76 offen lds
    s_waitcnt vmcnt(16)
    s_barrier
    s_add_u32 s40, s39, 12
    s_and_b32 s40, s40, 15
    s_xor_b32 s40, s40, s59
    s_lshl_b32 s40, s40, 11
    s_add_u32 s40, s40, s36
    s_add_u32 m0, s44, 16384
    s_nop 0
    buffer_load_dwordx4 v10, s[12:15], s40 offen offset:0 sc1 lds
    s_add_u32 m0, s44, 16384
    s_nop 0
    buffer_load_dwordx4 v10, s[12:15], s40 offen offset:1024 sc1 lds
    s_add_u32 s41, s39, 15
    s_and_b32 s41, s41, 15
    s_xor_b32 s41, s41, s59
    s_lshl_b32 s41, s41, 17
    s_add_u32 s41, s41, s38
    s_add_u32 m0, s45, 65536
    s_add_u32 s76, s41, 0
    s_nop 0
    buffer_load_dwordx4 v8, s[16:19], s76 offen lds
    s_add_u32 m0, s45, 66560
    s_add_u32 s76, s41, 8192
    buffer_load_dwordx4 v9, s[16:19], s76 offen lds
    s_add_u32 m0, s45, 67584
    s_add_u32 s76, s41, 16384
    buffer_load_dwordx4 v8, s[16:19], s76 offen lds
    s_add_u32 m0, s45, 68608
    s_add_u32 s76, s41, 24576
    buffer_load_dwordx4 v9, s[16:19], s76 offen lds
    s_waitcnt vmcnt(16)
    s_barrier
    s_add_u32 s40, s39, 13
    s_and_b32 s40, s40, 15
    s_xor_b32 s40, s40, s59
    s_lshl_b32 s40, s40, 11
    s_add_u32 s40, s40, s36
    s_add_u32 m0, s44, 98304
    s_nop 0
    buffer_load_dwordx4 v10, s[12:15], s40 offen offset:0 sc1 lds
    s_add_u32 m0, s44, 98304
    s_nop 0
    buffer_load_dwordx4 v10, s[12:15], s40 offen offset:1024 sc1 lds
    s_waitcnt vmcnt(12)
    s_barrier
    s_add_u32 s40, s39, 14
    s_and_b32 s40, s40, 15
    s_xor_b32 s40, s40, s59
    s_lshl_b32 s40, s40, 11
    s_add_u32 s40, s40, s36
    s_add_u32 m0, s44, 139264
    s_nop 0
    buffer_load_dwordx4 v10, s[12:15], s40 offen offset:0 sc1 lds
    s_add_u32 m0, s44, 139264
    s_nop 0
    buffer_load_dwordx4 v10, s[12:15], s40 offen offset:1024 sc1 lds
    s_waitcnt vmcnt(8)
    s_barrier
    s_add_u32 s40, s39, 15
    s_and_b32 s40, s40, 15
    s_xor_b32 s40, s40, s59
    s_lshl_b32 s40, s40, 11
    s_add_u32 s40, s40, s36
    s_add_u32 m0, s44, 57344
    s_nop 0
    buffer_load_dwordx4 v10, s[12:15], s40 offen offset:0 sc1 lds
    s_add_u32 m0, s44, 57344
    s_nop 0
    buffer_load_dwordx4 v10, s[12:15], s40 offen offset:1024 sc1 lds
    s_waitcnt vmcnt(4)
    s_barrier
    s_waitcnt vmcnt(2)
    s_barrier
    s_waitcnt vmcnt(0)
    s_barrier
    s_endpgm
F_aux:
    s_barrier
    s_setprio 0
    s_sub_u32 s3, s3, 4
    s_and_b32 s36, s2, 3
    s_bfe_u32 s37, s2, 0x10002
    s_lshr_b32 s38, s2, 3
    v_lshlrev_b32 v3, 2, v0
    s_lshl_b32 s77, s36, 1
    s_add_u32 s77, s77, s37
    s_mul_i32 s77, s77, 114688
    s_lshl_b32 s46, s38, 12
    s_add_u32 s77, s77, s46
    s_lshl_b32 s46, s3, 10
    s_add_u32 s77, s77, s46
    s_cmp_ge_u32 s2, 224
    s_cselect_b32 s77, 0x7ff00000, s77
    v_mov_b32 v140, 0
    v_mov_b32 v141, 0
    v_mov_b32 v142, 0
    v_mov_b32 v143, 0
    s_add_u32 s12, s72, 0xa00000
    s_addc_u32 s13, s73, 0
    s_mov_b32 s14, 0xe0000
    s_mov_b32 s15, 0x00020000
    buffer_store_dwordx4 v[140:143], v2, s[12:15], s77 offen sc0 sc1
    s_add_u32 s12, s72, 0xb00000
    s_addc_u32 s13, s73, 0
    s_mov_b32 s14, 0x30000
    s_mov_b32 s15, 0x00020000
    s_lshl_b32 s47, s32, 8
    s_add_u32 s56, s47, 0x908000
    s_add_u32 s56, s72, s56
    s_addc_u32 s57, s73, 0
    s_cmp_eq_u32 s37, 0
    s_cselect_b32 s16, s62, s64
    s_cselect_b32 s17, s63, s65
    s_mov_b32 s18, 7340032
    s_mov_b32 s19, 0x00020000
    s_lshl_b32 s44, s3, 2
    s_add_u32 s44, s44, 24640
    v_mov_b32 v10, s44
    v_lshrrev_b32 v5, 4, v0
    v_mul_u32_u24 v6, 57344, v5
    v_and_b32 v7, 15, v0
    v_lshl_add_u32 v6, v7, 4, v6
    s_lshl_b32 s44, s36, 2
    s_add_u32 s44, s44, s3
    s_mul_i32 s54, s44, 458752
    s_lshl_b32 s45, s38, 8
    s_add_u32 s54, s54, s45
    s_cmp_ge_u32 s2, 224
    s_cselect_b32 s54, 0x70000000, s54
    s_lshl_b32 s55, s44, 7
    v_mov_b32 v8, 0
    s_mov_b32 s80, s66
    s_mov_b32 s81, s67
    s_mov_b32 s82, 0x700000
    s_mov_b32 s83, 0x00020000
    v_bfe_u32 v21, v0, 2, 2
    v_lshl_add_u32 v22, v5, 3, v21
    v_lshrrev_b32 v21, 1, v21
    v_and_b32 v20, 1, v5
    v_lshl_add_u32 v21, v20, 1, v21
    v_xor_b32 v21, s3, v21
    v_lshlrev_b32 v21, 5, v21
    v_lshl_add_u32 v21, v22, 7, v21
    v_and_b32 v20, 3, v0
    v_lshl_add_u32 v21, v20, 3, v21
    s_mov_b32 s44, 0x23453342
    s_lshl_b32 s89, s35, 2
    s_lshr_b32 s89, s44, s89
    s_and_b32 s89, s89, 15
    s_and_b32 s44, s89, 3
    s_mul_i32 s44, s44, 40960
    s_add_u32 s44, s44, 16384
    v_add_u32 v112, s44, v21
    v_lshlrev_b32_e64 v113, 2, v7
    v_lshl_add_u32 v113, v5, 12, v113
    s_lshl_b32 s91, s33, 8
    s_lshl_b32 s45, s3, 6
    s_add_u32 s91, s91, s45
    s_mul_i32 s88, s32, 12288
    s_add_u32 s88, s88, s91
    s_mov_b32 exec_hi, 0xffff
    buffer_store_dword v8, v113, s[12:15], s88 offen sc0 sc1
    s_mov_b64 exec, -1
    s_getpc_b64 s[64:65]
F_cp:
    s_add_u32 s64, s64, F_co-F_cp
    s_addc_u32 s65, s65, 0
    s_branch F_cx
F_co:
    ds_read_b64_tr_b16 v[72:73], v112 offset:0
    ds_read_b64_tr_b16 v[74:75], v112 offset:512
    ds_read_b64_tr_b16 v[76:77], v112 offset:4096
    ds_read_b64_tr_b16 v[78:79], v112 offset:4608
    ds_read_b64_tr_b16 v[80:81], v112 offset:8192
    ds_read_b64_tr_b16 v[82:83], v112 offset:8704
    ds_read_b64_tr_b16 v[84:85], v112 offset:12288
    ds_read_b64_tr_b16 v[86:87], v112 offset:12800
    ds_read_b64_tr_b16 v[88:89], v112 offset:16384
    ds_read_b64_tr_b16 v[90:91], v112 offset:16896
    ds_read_b64_tr_b16 v[92:93], v112 offset:20480
    ds_read_b64_tr_b16 v[94:95], v112 offset:20992
    v_mov_b32 v108, 0x3f803f80
    v_mov_b32 v109, 0x3f803f80
    v_mov_b32 v110, 0x3f803f80
    v_mov_b32 v111, 0x3f803f80
    s_waitcnt lgkmcnt(0)
    s_swappc_b64 s[64:65], s[66:67]
    s_setprio 3
    v_mfma_f32_16x16x32_bf16 v[96:99], v[108:111], v[72:75], 0
    v_mfma_f32_16x16x32_bf16 v[100:103], v[108:111], v[80:83], 0
    v_mfma_f32_16x16x32_bf16 v[104:107], v[108:111], v[88:91], 0
    v_mfma_f32_16x16x32_bf16 v[96:99], v[108:111], v[76:79], v[96:99]
    v_mfma_f32_16x16x32_bf16 v[100:103], v[108:111], v[84:87], v[100:103]
    v_mfma_f32_16x16x32_bf16 v[104:107], v[108:111], v[92:95], v[104:107]
    s_setprio 0
    v_cmp_eq_u32 vcc, 1, v5
    s_nop 4
    v_cndmask_b32 v96, v96, v100, vcc
    v_cmp_eq_u32 vcc, 2, v5
    s_nop 1
    v_cndmask_b32 v96, v96, v104, vcc
    v_max_u32 v96, 1, v96
    s_sleep 4
    s_mov_b32 exec_hi, 0xffff
    buffer_store_dword v96, v113, s[12:15], s88 offen sc0 sc1
    s_mov_b64 exec, -1
    s_setpc_b64 s[66:67]
F_cx:
    s_cmp_eq_u32 s3, 0
    s_cbranch_scc1 F_ax0
    s_cmp_eq_u32 s3, 2
    s_cbranch_scc1 F_ax2
    s_barrier
    s_waitcnt vmcnt(0)
    s_barrier
    s_sub_u32 s45, 2, s89
    s_cmp_gt_u32 s45, 1
    s_cbranch_scc1 CB_9
    s_swappc_b64 s[66:67], s[64:65]
CB_9:
    s_barrier
    s_sub_u32 s45, 3, s89
    s_cmp_gt_u32 s45, 1
    s_cbranch_scc1 CB_10
    s_swappc_b64 s[66:67], s[64:65]
CB_10:
    s_barrier
    s_sub_u32 s45, 4, s89
    s_cmp_gt_u32 s45, 1
    s_cbranch_scc1 CB_11
    s_swappc_b64 s[66:67], s[64:65]
CB_11:
    s_barrier
    s_sub_u32 s45, 5, s89
    s_cmp_gt_u32 s45, 1
    s_cbranch_scc1 CB_12
    s_swappc_b64 s[66:67], s[64:65]
CB_12:
    s_barrier
    s_sub_u32 s45, 6, s89
    s_cmp_gt_u32 s45, 1
    s_cbranch_scc1 CB_13
    s_swappc_b64 s[66:67], s[64:65]
CB_13:
    s_barrier
    s_barrier
    s_barrier
    s_barrier
    s_barrier
    s_branch F_aj
F_ax0:
    s_lshl_b32 s44, s32, 2
    buffer_load_dword v9, v8, s[48:51], s44 offen sc0 sc1
    s_barrier
    s_waitcnt vmcnt(0)
    v_cmp_eq_u32 vcc, 0, v9
    s_cbranch_vccz F_ax0r
PL_14:
    buffer_load_dword v9, v8, s[48:51], s44 offen sc0 sc1
    s_waitcnt vmcnt(0)
    v_cmp_gt_u32 vcc, 1, v9
    s_cbranch_vccz PD_15
    s_sleep 1
    s_branch PL_14
PD_15:
F_ax0r:
    s_barrier
    s_mov_b32 s76, 1
    s_atomic_add s76, s[56:57], 0 glc
    s_sub_u32 s45, 2, s89
    s_cmp_gt_u32 s45, 1
    s_cbranch_scc1 CB_16
    s_swappc_b64 s[66:67], s[64:65]
CB_16:
    s_barrier
    s_mov_b32 s75, 0
    s_waitcnt lgkmcnt(0)
    s_cmp_lg_u32 s76, 15
    s_cbranch_scc1 F_ax0c
    s_mov_b32 s75, 1
    s_atomic_add s75, s[70:71], 64 glc
F_ax0c:
    s_sub_u32 s45, 3, s89
    s_cmp_gt_u32 s45, 1
    s_cbranch_scc1 CB_17
    s_swappc_b64 s[66:67], s[64:65]
CB_17:
    s_barrier
    s_sub_u32 s45, 4, s89
    s_cmp_gt_u32 s45, 1
    s_cbranch_scc1 CB_18
    s_swappc_b64 s[66:67], s[64:65]
CB_18:
    s_waitcnt lgkmcnt(0)
    s_cmp_lg_u32 s75, 15
    s_cbranch_scc1 F_ax0d
    v_lshlrev_b32 v9, 8, v0
    v_mov_b32 v11, 1000
    s_mov_b32 s44, 32768
    s_mov_b64 exec, 0xffff
    buffer_store_dword v11, v9, s[40:43], s44 offen sc0 sc1
    s_mov_b64 exec, -1
F_ax0d:
    s_barrier
    s_sub_u32 s45, 5, s89
    s_cmp_gt_u32 s45, 1
    s_cbranch_scc1 CB_19
    s_swappc_b64 s[66:67], s[64:65]
CB_19:
    s_barrier
    s_sub_u32 s45, 6, s89
    s_cmp_gt_u32 s45, 1
    s_cbranch_scc1 CB_20
    s_swappc_b64 s[66:67], s[64:65]
CB_20:
    s_barrier
    s_barrier
    s_barrier
    s_barrier
    s_barrier
    s_branch F_aj
F_ax2:
    s_lshl_b32 s44, s2, 10
    buffer_store_dwordx4 v[140:143], v2, s[24:27], s44 offen sc0 sc1
    s_mov_b64 exec, -1
    s_barrier
    s_waitcnt vmcnt(0)
    s_cmp_lg_u32 s2, 2
    s_cbranch_scc1 F_ax2n
    s_barrier
    s_sub_u32 s45, 2, s89
    s_cmp_gt_u32 s45, 1
    s_cbranch_scc1 CB_21
    s_swappc_b64 s[66:67], s[64:65]
CB_21:
    s_barrier
    s_sub_u32 s45, 3, s89
    s_cmp_gt_u32 s45, 1
    s_cbranch_scc1 CB_22
    s_swappc_b64 s[66:67], s[64:65]
CB_22:
    s_barrier
    s_sub_u32 s45, 4, s89
    s_cmp_gt_u32 s45, 1
    s_cbranch_scc1 CB_23
    s_swappc_b64 s[66:67], s[64:65]
CB_23:
    s_barrier
    s_sub_u32 s45, 5, s89
    s_cmp_gt_u32 s45, 1
    s_cbranch_scc1 CB_24
    s_swappc_b64 s[66:67], s[64:65]
CB_24:
    s_barrier
    s_sub_u32 s45, 6, s89
    s_cmp_gt_u32 s45, 1
    s_cbranch_scc1 CB_25
    s_swappc_b64 s[66:67], s[64:65]
CB_25:
    s_load_dword s76, s[56:57], 0 glc
    s_barrier
    s_waitcnt lgkmcnt(0)
    s_cmp_ge_u32 s76, 1000
    s_cbranch_scc1 F_ax2g
SP_26:
    s_load_dword s76, s[56:57], 0 glc
    s_waitcnt lgkmcnt(0)
    s_cmp_ge_u32 s76, 1000
    s_cbranch_scc1 SD_27
    s_sleep 2
    s_branch SP_26
SD_27:
F_ax2g:
    s_movk_i32 s44, 0
    buffer_load_dwordx4 v[16:19], v2, s[40:43], s44 offen sc0 sc1
    s_movk_i32 s44, 1024
    buffer_load_dwordx4 v[20:23], v2, s[40:43], s44 offen sc0 sc1
    s_movk_i32 s44, 2048
    buffer_load_dwordx4 v[24:27], v2, s[40:43], s44 offen sc0 sc1
    s_movk_i32 s44, 3072
    buffer_load_dwordx4 v[28:31], v2, s[40:43], s44 offen sc0 sc1
    s_movk_i32 s44, 4096
    buffer_load_dwordx4 v[32:35], v2, s[40:43], s44 offen sc0 sc1
    s_movk_i32 s44, 5120
    buffer_load_dwordx4 v[36:39], v2, s[40:43], s44 offen sc0 sc1
    s_movk_i32 s44, 6144
    buffer_load_dwordx4 v[40:43], v2, s[40:43], s44 offen sc0 sc1
    s_movk_i32 s44, 7168
    buffer_load_dwordx4 v[44:47], v2, s[40:43], s44 offen sc0 sc1
    s_mov_b32 s53, 0
    v_and_b32 v13, 7, v0
    v_lshlrev_b32 v13, 2, v13
    v_lshrrev_b32 v9, 3, v0
    v_lshl_add_u32 v13, v9, 7, v13
    s_barrier
    s_waitcnt vmcnt(0)
    s_mov_b32 s58, 0x01010101
    s_mov_b32 s59, s58
    v_max3_u32 v48, v16, v17, v18
    v_med3_u32 v49, v16, v17, v18
    v_min3_u32 v50, v16, v17, v18
    v_med3_u32 v50, v49, v50, v19
    v_med3_u32 v49, v48, v49, v19
    v_max_u32 v48, v48, v19
    v_med3_u32 v50, v49, v50, v20
    v_med3_u32 v49, v48, v49, v20
    v_max_u32 v48, v48, v20
    v_med3_u32 v50, v49, v50, v21
    v_med3_u32 v49, v48, v49, v21
    v_max_u32 v48, v48, v21
    v_med3_u32 v50, v49, v50, v22
    v_med3_u32 v49, v48, v49, v22
    v_max_u32 v48, v48, v22
    v_med3_u32 v50, v49, v50, v23
    v_med3_u32 v49, v48, v49, v23
    v_max_u32 v48, v48, v23
    v_med3_u32 v50, v49, v50, v24
    v_med3_u32 v49, v48, v49, v24
    v_max_u32 v48, v48, v24
    v_med3_u32 v50, v49, v50, v25
    v_med3_u32 v49, v48, v49, v25
    v_max_u32 v48, v48, v25
    v_med3_u32 v50, v49, v50, v26
    v_med3_u32 v49, v48, v49, v26
    v_max_u32 v48, v48, v26
    v_med3_u32 v50, v49, v50, v27
    v_med3_u32 v49, v48, v49, v27
    v_max_u32 v48, v48, v27
    v_med3_u32 v50, v49, v50, v28
    v_med3_u32 v49, v48, v49, v28
    v_max_u32 v48, v48, v28
    v_med3_u32 v50, v49, v50, v29
    v_med3_u32 v49, v48, v49, v29
    v_max_u32 v48, v48, v29
    v_med3_u32 v50, v49, v50, v30
    v_med3_u32 v49, v48, v49, v30
    v_max_u32 v48, v48, v30
    v_med3_u32 v50, v49, v50, v31
    v_med3_u32 v49, v48, v49, v31
    v_max_u32 v48, v48, v31
    v_med3_u32 v50, v49, v50, v32
    v_med3_u32 v49, v48, v49, v32
    v_max_u32 v48, v48, v32
    s_barrier
    v_med3_u32 v50, v49, v50, v33
    v_med3_u32 v49, v48, v49, v33
    v_max_u32 v48, v48, v33
    v_med3_u32 v50, v49, v50, v34
    v_med3_u32 v49, v48, v49, v34
    v_max_u32 v48, v48, v34
    v_med3_u32 v50, v49, v50, v35
    v_med3_u32 v49, v48, v49, v35
    v_max_u32 v48, v48, v35
    v_med3_u32 v50, v49, v50, v36
    v_med3_u32 v49, v48, v49, v36
    v_max_u32 v48, v48, v36
    v_med3_u32 v50, v49, v50, v37
    v_med3_u32 v49, v48, v49, v37
    v_max_u32 v48, v48, v37
    v_med3_u32 v50, v49, v50, v38
    v_med3_u32 v49, v48, v49, v38
    v_max_u32 v48, v48, v38
    v_med3_u32 v50, v49, v50, v39
    v_med3_u32 v49, v48, v49, v39
    v_max_u32 v48, v48, v39
    v_med3_u32 v50, v49, v50, v40
    v_med3_u32 v49, v48, v49, v40
    v_max_u32 v48, v48, v40
    v_med3_u32 v50, v49, v50, v41
    v_med3_u32 v49, v48, v49, v41
    v_max_u32 v48, v48, v41
    v_med3_u32 v50, v49, v50, v42
    v_med3_u32 v49, v48, v49, v42
    v_max_u32 v48, v48, v42
    v_med3_u32 v50, v49, v50, v43
    v_med3_u32 v49, v48, v49, v43
    v_max_u32 v48, v48, v43
    v_med3_u32 v50, v49, v50, v44
    v_med3_u32 v49, v48, v49, v44
    v_max_u32 v48, v48, v44
    v_med3_u32 v50, v49, v50, v45
    v_med3_u32 v49, v48, v49, v45
    v_max_u32 v48, v48, v45
    v_med3_u32 v50, v49, v50, v46
    v_med3_u32 v49, v48, v49, v46
    v_max_u32 v48, v48, v46
    v_med3_u32 v50, v49, v50, v47
    v_med3_u32 v49, v48, v49, v47
    v_max_u32 v48, v48, v47
    v_mov_b32 v4, v48
    s_nop 1
    v_max_u32_dpp v4, v4, v4 row_shr:1 row_mask:0xf bank_mask:0xf bound_ctrl:0
    s_nop 1
    v_max_u32_dpp v4, v4, v4 row_shr:2 row_mask:0xf bank_mask:0xf bound_ctrl:0
    s_nop 1
    v_max_u32_dpp v4, v4, v4 row_shr:4 row_mask:0xf bank_mask:0xf bound_ctrl:0
    s_nop 1
    v_max_u32_dpp v4, v4, v4 row_shr:8 row_mask:0xf bank_mask:0xf bound_ctrl:0
    s_nop 1
    v_max_u32_dpp v4, v4, v4 row_bcast:15 row_mask:0xa bank_mask:0xf
    s_nop 1
    v_max_u32_dpp v4, v4, v4 row_bcast:31 row_mask:0xc bank_mask:0xf
    s_nop 0
    v_readlane_b32 s52, v4, 63
    s_lshl_b64 exec, s[58:59], 0
    s_nop 0
    v_mov_b32 v12, s52
    s_mov_b64 exec, -1
    v_cmp_eq_u32 vcc, s52, v48
    s_nop 1
    v_cndmask_b32 v48, v48, v49, vcc
    v_cndmask_b32 v49, v49, v50, vcc
    v_cndmask_b32 v50, v50, 0, vcc
    s_barrier
    v_mov_b32 v4, v48
    s_nop 1
    v_max_u32_dpp v4, v4, v4 row_shr:1 row_mask:0xf bank_mask:0xf bound_ctrl:0
    s_nop 1
    v_max_u32_dpp v4, v4, v4 row_shr:2 row_mask:0xf bank_mask:0xf bound_ctrl:0
    s_nop 1
    v_max_u32_dpp v4, v4, v4 row_shr:4 row_mask:0xf bank_mask:0xf bound_ctrl:0
    s_nop 1
    v_max_u32_dpp v4, v4, v4 row_shr:8 row_mask:0xf bank_mask:0xf bound_ctrl:0
    s_nop 1
    v_max_u32_dpp v4, v4, v4 row_bcast:15 row_mask:0xa bank_mask:0xf
    s_nop 1
    v_max_u32_dpp v4, v4, v4 row_bcast:31 row_mask:0xc bank_mask:0xf
    s_nop 0
    v_readlane_b32 s52, v4, 63
    s_lshl_b64 exec, s[58:59], 1
    s_nop 0
    v_mov_b32 v12, s52
    s_mov_b64 exec, -1
    v_cmp_eq_u32 vcc, s52, v48
    s_nop 1
    v_cndmask_b32 v48, v48, v49, vcc
    v_cndmask_b32 v49, v49, v50, vcc
    v_cndmask_b32 v50, v50, 0, vcc
    v_mov_b32 v4, v48
    s_nop 1
    v_max_u32_dpp v4, v4, v4 row_shr:1 row_mask:0xf bank_mask:0xf bound_ctrl:0
    s_nop 1
    v_max_u32_dpp v4, v4, v4 row_shr:2 row_mask:0xf bank_mask:0xf bound_ctrl:0
    s_nop 1
    v_max_u32_dpp v4, v4, v4 row_shr:4 row_mask:0xf bank_mask:0xf bound_ctrl:0
    s_nop 1
    v_max_u32_dpp v4, v4, v4 row_shr:8 row_mask:0xf bank_mask:0xf bound_ctrl:0
    s_nop 1
    v_max_u32_dpp v4, v4, v4 row_bcast:15 row_mask:0xa bank_mask:0xf
    s_nop 1
    v_max_u32_dpp v4, v4, v4 row_bcast:31 row_mask:0xc bank_mask:0xf
    s_nop 0
    v_readlane_b32 s52, v4, 63
    s_lshl_b64 exec, s[58:59], 2
    s_nop 0
    v_mov_b32 v12, s52
    s_mov_b64 exec, -1
    v_cmp_eq_u32 vcc, s52, v48
    s_nop 1
    v_cndmask_b32 v48, v48, v49, vcc
    v_cndmask_b32 v49, v49, v50, vcc
    v_cndmask_b32 v50, v50, 0, vcc
    v_mov_b32 v4, v48
    s_nop 1
    v_max_u32_dpp v4, v4, v4 row_shr:1 row_mask:0xf bank_mask:0xf bound_ctrl:0
    s_nop 1
    v_max_u32_dpp v4, v4, v4 row_shr:2 row_mask:0xf bank_mask:0xf bound_ctrl:0
    s_nop 1
    v_max_u32_dpp v4, v4, v4 row_shr:4 row_mask:0xf bank_mask:0xf bound_ctrl:0
    s_nop 1
    v_max_u32_dpp v4, v4, v4 row_shr:8 row_mask:0xf bank_mask:0xf bound_ctrl:0
    s_nop 1
    v_max_u32_dpp v4, v4, v4 row_bcast:15 row_mask:0xa bank_mask:0xf
    s_nop 1
    v_max_u32_dpp v4, v4, v4 row_bcast:31 row_mask:0xc bank_mask:0xf
    s_nop 0
    v_readlane_b32 s52, v4, 63
    s_lshl_b64 exec, s[58:59], 3
    s_nop 0
    v_mov_b32 v12, s52
    s_mov_b64 exec, -1
    v_cmp_eq_u32 vcc, s52, v48
    s_nop 1
    v_cndmask_b32 v48, v48, v49, vcc
    v_cndmask_b32 v49, v49, v50, vcc
    v_cndmask_b32 v50, v50, 0, vcc
    v_mov_b32 v4, v48
    s_nop 1
    v_max_u32_dpp v4, v4, v4 row_shr:1 row_mask:0xf bank_mask:0xf bound_ctrl:0
    s_nop 1
    v_max_u32_dpp v4, v4, v4 row_shr:2 row_mask:0xf bank_mask:0xf bound_ctrl:0
    s_nop 1
    v_max_u32_dpp v4, v4, v4 row_shr:4 row_mask:0xf bank_mask:0xf bound_ctrl:0
    s_nop 1
    v_max_u32_dpp v4, v4, v4 row_shr:8 row_mask:0xf bank_mask:0xf bound_ctrl:0
    s_nop 1
    v_max_u32_dpp v4, v4, v4 row_bcast:15 row_mask:0xa bank_mask:0xf
    s_nop 1
    v_max_u32_dpp v4, v4, v4 row_bcast:31 row_mask:0xc bank_mask:0xf
    s_nop 0
    v_readlane_b32 s52, v4, 63
    s_lshl_b64 exec, s[58:59], 4
    s_nop 0
    v_mov_b32 v12, s52
    s_mov_b64 exec, -1
    v_cmp_eq_u32 vcc, s52, v48
    s_nop 1
    v_cndmask_b32 v48, v48, v49, vcc
    v_cndmask_b32 v49, v49, v50, vcc
    v_cndmask_b32 v50, v50, 0, vcc
    s_barrier
    v_mov_b32 v4, v48
    s_nop 1
    v_max_u32_dpp v4, v4, v4 row_shr:1 row_mask:0xf bank_mask:0xf bound_ctrl:0
    s_nop 1
    v_max_u32_dpp v4, v4, v4 row_shr:2 row_mask:0xf bank_mask:0xf bound_ctrl:0
    s_nop 1
    v_max_u32_dpp v4, v4, v4 row_shr:4 row_mask:0xf bank_mask:0xf bound_ctrl:0
    s_nop 1
    v_max_u32_dpp v4, v4, v4 row_shr:8 row_mask:0xf bank_mask:0xf bound_ctrl:0
    s_nop 1
    v_max_u32_dpp v4, v4, v4 row_bcast:15 row_mask:0xa bank_mask:0xf
    s_nop 1
    v_max_u32_dpp v4, v4, v4 row_bcast:31 row_mask:0xc bank_mask:0xf
    s_nop 0
    v_readlane_b32 s52, v4, 63
    s_lshl_b64 exec, s[58:59], 5
    s_nop 0
    v_mov_b32 v12, s52
    s_mov_b64 exec, -1
    v_cmp_eq_u32 vcc, s52, v48
    s_nop 1
    v_cndmask_b32 v48, v48, v49, vcc
    v_cndmask_b32 v49, v49, v50, vcc
    v_cndmask_b32 v50, v50, 0, vcc
    v_mov_b32 v4, v48
    s_nop 1
    v_max_u32_dpp v4, v4, v4 row_shr:1 row_mask:0xf bank_mask:0xf bound_ctrl:0
    s_nop 1
    v_max_u32_dpp v4, v4, v4 row_shr:2 row_mask:0xf bank_mask:0xf bound_ctrl:0
    s_nop 1
    v_max_u32_dpp v4, v4, v4 row_shr:4 row_mask:0xf bank_mask:0xf bound_ctrl:0
    s_nop 1
    v_max_u32_dpp v4, v4, v4 row_shr:8 row_mask:0xf bank_mask:0xf bound_ctrl:0
    s_nop 1
    v_max_u32_dpp v4, v4, v4 row_bcast:15 row_mask:0xa bank_mask:0xf
    s_nop 1
    v_max_u32_dpp v4, v4, v4 row_bcast:31 row_mask:0xc bank_mask:0xf
    s_nop 0
    v_readlane_b32 s52, v4, 63
    s_lshl_b64 exec, s[58:59], 6
    s_nop 0
    v_mov_b32 v12, s52
    s_mov_b64 exec, -1
    v_cmp_eq_u32 vcc, s52, v48
    s_nop 1
    v_cndmask_b32 v48, v48, v49, vcc
    v_cndmask_b32 v49, v49, v50, vcc
    v_cndmask_b32 v50, v50, 0, vcc
    v_mov_b32 v4, v48
    s_nop 1
    v_max_u32_dpp v4, v4, v4 row_shr:1 row_mask:0xf bank_mask:0xf bound_ctrl:0
    s_nop 1
    v_max_u32_dpp v4, v4, v4 row_shr:2 row_mask:0xf bank_mask:0xf bound_ctrl:0
    s_nop 1
    v_max_u32_dpp v4, v4, v4 row_shr:4 row_mask:0xf bank_mask:0xf bound_ctrl:0
    s_nop 1
    v_max_u32_dpp v4, v4, v4 row_shr:8 row_mask:0xf bank_mask:0xf bound_ctrl:0
    s_nop 1
    v_max_u32_dpp v4, v4, v4 row_bcast:15 row_mask:0xa bank_mask:0xf
    s_nop 1
    v_max_u32_dpp v4, v4, v4 row_bcast:31 row_mask:0xc bank_mask:0xf
    s_nop 0
    v_readlane_b32 s52, v4, 63
    s_lshl_b64 exec, s[58:59], 7
    s_nop 0
    v_mov_b32 v12, s52
    s_mov_b64 exec, -1
    v_cmp_eq_u32 vcc, 0, v48
    s_cbranch_vccz F_tk2
    s_mov_b32 s52, 0
    s_mov_b32 s45, 0
F_tk1:
    v_subrev_u32 v16, s52, v16
    v_subrev_u32 v17, s52, v17
    v_subrev_u32 v18, s52, v18
    v_subrev_u32 v19, s52, v19
    v_subrev_u32 v20, s52, v20
    v_subrev_u32 v21, s52, v21
    v_subrev_u32 v22, s52, v22
    v_subrev_u32 v23, s52, v23
    v_subrev_u32 v24, s52, v24
    v_subrev_u32 v25, s52, v25
    v_subrev_u32 v26, s52, v26
    v_subrev_u32 v27, s52, v27
    v_subrev_u32 v28, s52, v28
    v_subrev_u32 v29, s52, v29
    v_subrev_u32 v30, s52, v30
    v_subrev_u32 v31, s52, v31
    v_subrev_u32 v32, s52, v32
    v_subrev_u32 v33, s52, v33
    v_subrev_u32 v34, s52, v34
    v_subrev_u32 v35, s52, v35
    v_subrev_u32 v36, s52, v36
    v_subrev_u32 v37, s52, v37
    v_subrev_u32 v38, s52, v38
    v_subrev_u32 v39, s52, v39
    v_subrev_u32 v40, s52, v40
    v_subrev_u32 v41, s52, v41
    v_subrev_u32 v42, s52, v42
    v_subrev_u32 v43, s52, v43
    v_subrev_u32 v44, s52, v44
    v_subrev_u32 v45, s52, v45
    v_subrev_u32 v46, s52, v46
    v_subrev_u32 v47, s52, v47
    v_max3_u32 v4, v16, v17, v18
    v_max3_u32 v4, v4, v19, v20
    v_max3_u32 v4, v4, v21, v22
    v_max3_u32 v4, v4, v23, v24
    v_max3_u32 v4, v4, v25, v26
    v_max3_u32 v4, v4, v27, v28
    v_max3_u32 v4, v4, v29, v30
    v_max3_u32 v4, v4, v31, v32
    v_max3_u32 v4, v4, v33, v34
    v_max3_u32 v4, v4, v35, v36
    v_max3_u32 v4, v4, v37, v38
    v_max3_u32 v4, v4, v39, v40
    v_max3_u32 v4, v4, v41, v42
    v_max3_u32 v4, v4, v43, v44
    v_max3_u32 v4, v4, v45, v46
    v_max_u32 v4, v4, v47
    s_nop 1
    v_max_u32_dpp v4, v4, v4 row_shr:1 row_mask:0xf bank_mask:0xf bound_ctrl:0
    s_nop 1
    v_max_u32_dpp v4, v4, v4 row_shr:2 row_mask:0xf bank_mask:0xf bound_ctrl:0
    s_nop 1
    v_max_u32_dpp v4, v4, v4 row_shr:4 row_mask:0xf bank_mask:0xf bound_ctrl:0
    s_nop 1
    v_max_u32_dpp v4, v4, v4 row_shr:8 row_mask:0xf bank_mask:0xf bound_ctrl:0
    s_nop 1
    v_max_u32_dpp v4, v4, v4 row_bcast:15 row_mask:0xa bank_mask:0xf
    s_nop 1
    v_max_u32_dpp v4, v4, v4 row_bcast:31 row_mask:0xc bank_mask:0xf
    s_nop 0
    v_readlane_b32 s52, v4, 63
    s_nop 0
    s_add_u32 s53, s53, s52
    s_lshl_b64 exec, s[58:59], s45
    v_mov_b32 v12, s53
    s_mov_b64 exec, -1
    s_add_u32 s45, s45, 1
    s_cmp_lt_u32 s45, 8
    s_cbranch_scc1 F_tk1
F_tk2:
    v_or_b32 v12, 0x8000, v12
    s_mov_b32 s44, 184320
    buffer_store_dword v12, v13, s[24:27], s44 offen offset:0 sc0 sc1
    buffer_store_dword v12, v13, s[24:27], s44 offen offset:1024 sc0 sc1
    buffer_store_dword v12, v13, s[24:27], s44 offen offset:2048 sc0 sc1
    buffer_store_dword v12, v13, s[24:27], s44 offen offset:3072 sc0 sc1
    s_mov_b32 s44, 188416
    buffer_store_dword v12, v13, s[24:27], s44 offen offset:0 sc0 sc1
    buffer_store_dword v12, v13, s[24:27], s44 offen offset:1024 sc0 sc1
    buffer_store_dword v12, v13, s[24:27], s44 offen offset:2048 sc0 sc1
    buffer_store_dword v12, v13, s[24:27], s44 offen offset:3072 sc0 sc1
    s_branch F_aj
F_ax2n:
    s_barrier
    s_sub_u32 s45, 2, s89
    s_cmp_gt_u32 s45, 1
    s_cbranch_scc1 CB_28
    s_swappc_b64 s[66:67], s[64:65]
CB_28:
    s_barrier
    s_sub_u32 s45, 3, s89
    s_cmp_gt_u32 s45, 1
    s_cbranch_scc1 CB_29
    s_swappc_b64 s[66:67], s[64:65]
CB_29:
    s_barrier
    s_sub_u32 s45, 4, s89
    s_cmp_gt_u32 s45, 1
    s_cbranch_scc1 CB_30
    s_swappc_b64 s[66:67], s[64:65]
CB_30:
    s_barrier
    s_sub_u32 s45, 5, s89
    s_cmp_gt_u32 s45, 1
    s_cbranch_scc1 CB_31
    s_swappc_b64 s[66:67], s[64:65]
CB_31:
    s_barrier
    s_sub_u32 s45, 6, s89
    s_cmp_gt_u32 s45, 1
    s_cbranch_scc1 CB_32
    s_swappc_b64 s[66:67], s[64:65]
CB_32:
    s_barrier
    s_load_dword s76, s[56:57], 0 glc
    s_barrier
    s_waitcnt lgkmcnt(0)
    s_cmp_ge_u32 s76, 1000
    s_cbranch_scc1 F_ax2h
SP_33:
    s_load_dword s76, s[56:57], 0 glc
    s_waitcnt lgkmcnt(0)
    s_cmp_ge_u32 s76, 1000
    s_cbranch_scc1 SD_34
    s_sleep 8
    s_branch SP_33
SD_34:
F_ax2h:
    s_barrier
    s_barrier
    s_barrier
F_aj:
    s_add_u32 s12, s72, 0xa00000
    s_addc_u32 s13, s73, 0
    s_mov_b32 s14, 0xe0000
    s_mov_b32 s15, 0x00020000
    s_and_b32 s46, s2, 63
    s_lshl_b32 s46, s46, 7
    s_add_u32 s56, s46, 0x82d000
    s_add_u32 s56, s72, s56
    s_addc_u32 s57, s73, 0
    s_mov_b32 s58, 0x01010101
    s_mov_b32 s59, s58
    s_mov_b32 s52, 0x05040100
    s_mov_b32 s53, 0x07060302
    v_and_b32 v13, 3, v0
    v_lshlrev_b32 v13, 2, v13
    v_add_u32 v13, 24656, v13
    s_mul_i32 s78, s28, 112
    s_mul_i32 s79, s3, 28
    s_add_u32 s78, s78, s79
    s_lshl_b32 s78, s78, 11
    s_lshl_b32 s79, s29, 8
    s_add_u32 s78, s78, s79

    v_mul_u32_u24 v160, 14336, v5
    v_lshl_add_u32 v160, v7, 4, v160
    s_and_b32 s88, s3, 1
    s_lshl_b32 s88, s88, 12
    s_lshr_b32 s45, s3, 1
    s_mul_i32 s45, s45, 24576
    s_add_u32 s88, s88, s45
    v_subrev_u32 v163, 16, v13
    v_lshrrev_b32 v164, 1, v5
    v_lshlrev_b32 v164, 2, v164
    v_and_b32 v165, 7, v7
    v_xor_b32 v164, v164, v165
    v_lshlrev_b32 v164, 5, v164
    v_lshl_add_u32 v164, v7, 8, v164
    v_and_b32 v165, 1, v5
    v_lshl_add_u32 v164, v165, 4, v164
    s_lshl_b32 s45, s3, 12
    s_add_u32 s45, s45, 106496
    v_add_u32 v164, s45, v164
    s_lshl_b32 s45, s3, 2
    v_add_u32 v165, s45, v5
    v_and_b32 v165, 7, v165
    v_lshlrev_b32 v165, 5, v165
    v_xor_b32 v165, v165, v2
    s_lshl_b32 s45, s3, 10
    s_add_u32 s45, s45, 106496
    v_add_u32 v165, s45, v165
    v_add_u32_e64 v162, 16, v13
    s_barrier
    s_barrier
    s_sleep 2
    s_add_u32 s45, s54, 0
    buffer_load_dwordx4 v[72:75], v6, s[16:19], s45 offen nt
    s_add_u32 s45, s54, 7168
    buffer_load_dwordx4 v[76:79], v6, s[16:19], s45 offen nt
    s_add_u32 s45, s54, 14336
    buffer_load_dwordx4 v[80:83], v6, s[16:19], s45 offen nt
    s_add_u32 s45, s54, 21504
    buffer_load_dwordx4 v[84:87], v6, s[16:19], s45 offen nt
    s_barrier
    s_nop 0
    s_load_dwordx8 s[60:67], s[56:57], 0 glc
    s_add_u32 s45, s54, 28672
    buffer_load_dwordx4 v[88:91], v6, s[16:19], s45 offen nt
    s_add_u32 s45, s54, 35840
    buffer_load_dwordx4 v[92:95], v6, s[16:19], s45 offen nt
    s_add_u32 s45, s54, 43008
    buffer_load_dwordx4 v[96:99], v6, s[16:19], s45 offen nt
    s_add_u32 s45, s54, 50176
    buffer_load_dwordx4 v[100:103], v6, s[16:19], s45 offen nt
    s_barrier
    s_setprio 1
F_sc:
    s_waitcnt lgkmcnt(0)
    s_and_b64 s[74:75], s[60:61], s[62:63]
    s_and_b64 s[74:75], s[74:75], s[64:65]
    s_and_b64 s[74:75], s[74:75], s[66:67]
    s_and_b32 s74, s74, s75
    s_bitcmp1_b32 s74, 15
    s_cbranch_scc1 F_sd
    s_sleep 4
    s_load_dwordx8 s[60:67], s[56:57], 0 glc
    s_branch F_sc
F_sd:

    s_lshl_b64 exec, s[58:59], 0
    v_mov_b32 v4, s60
    s_lshl_b64 exec, s[58:59], 1
    v_mov_b32 v4, s61
    s_lshl_b64 exec, s[58:59], 2
    v_mov_b32 v4, s62
    s_lshl_b64 exec, s[58:59], 3
    v_mov_b32 v4, s63
    s_lshl_b64 exec, s[58:59], 4
    v_mov_b32 v4, s64
    s_lshl_b64 exec, s[58:59], 5
    v_mov_b32 v4, s65
    s_lshl_b64 exec, s[58:59], 6
    v_mov_b32 v4, s66
    s_lshl_b64 exec, s[58:59], 7
    v_mov_b32 v4, s67
    s_mov_b64 exec, -1
    s_mov_b32 s46, 65536
    v_and_b32 v4, 0x7ff, v4
    v_sub_u32 v4, 2047, v4
    v_lshlrev_b32 v9, 4, v4
    v_lshlrev_b32 v4, 11, v4
    v_lshl_add_u32 v4, v5, 4, v4

    buffer_load_dwordx4 v[64:67], v4, s[20:23], s55 offen
    buffer_load_dwordx4 v[68:71], v4, s[20:23], s55 offen offset:64
    buffer_load_dwordx2 v[14:15], v9, s[40:43], s46 offen sc0 sc1
    s_cmp_lt_u32 s2, 224
    s_cbranch_scc1 F_ag
    s_add_u32 s79, s78, 0
    buffer_load_dwordx4 v[16:19], v160, s[80:83], s79 offen nt
    s_add_u32 s79, s78, 2048
    buffer_load_dwordx4 v[20:23], v160, s[80:83], s79 offen nt
    s_add_u32 s79, s78, 4096
    buffer_load_dwordx4 v[24:27], v160, s[80:83], s79 offen nt
    s_add_u32 s79, s78, 6144
    buffer_load_dwordx4 v[28:31], v160, s[80:83], s79 offen nt
    s_add_u32 s79, s78, 8192
    buffer_load_dwordx4 v[144:147], v160, s[80:83], s79 offen nt
    s_add_u32 s79, s78, 10240
    buffer_load_dwordx4 v[148:151], v160, s[80:83], s79 offen nt
    s_add_u32 s79, s78, 12288
    buffer_load_dwordx4 v[152:155], v160, s[80:83], s79 offen nt
    s_sleep 32
    s_branch F_adown
F_ag:
    s_add_u32 s45, s54, 229376
    buffer_load_dwordx4 v[104:107], v6, s[16:19], s45 offen nt
    s_add_u32 s45, s54, 236544
    buffer_load_dwordx4 v[108:111], v6, s[16:19], s45 offen nt
    s_add_u32 s45, s54, 243712
    buffer_load_dwordx4 v[112:115], v6, s[16:19], s45 offen nt
    s_add_u32 s45, s54, 250880
    buffer_load_dwordx4 v[116:119], v6, s[16:19], s45 offen nt
    s_add_u32 s45, s54, 258048
    buffer_load_dwordx4 v[120:123], v6, s[16:19], s45 offen nt
    s_add_u32 s45, s54, 265216
    buffer_load_dwordx4 v[124:127], v6, s[16:19], s45 offen nt
    s_add_u32 s45, s54, 272384
    buffer_load_dwordx4 v[128:131], v6, s[16:19], s45 offen nt
    s_add_u32 s45, s54, 279552
    buffer_load_dwordx4 v[132:135], v6, s[16:19], s45 offen nt
    s_waitcnt vmcnt(8)
    v_lshlrev_b32 v34, 16, v64
    v_and_b32 v35, 0xffff0000, v64
    v_lshlrev_b32 v36, 16, v65
    v_and_b32 v37, 0xffff0000, v65
    v_lshlrev_b32 v38, 16, v66
    v_and_b32 v39, 0xffff0000, v66
    v_lshlrev_b32 v40, 16, v67
    v_and_b32 v41, 0xffff0000, v67
    v_lshlrev_b32 v42, 16, v68
    v_and_b32 v43, 0xffff0000, v68
    v_lshlrev_b32 v44, 16, v69
    v_and_b32 v45, 0xffff0000, v69
    v_lshlrev_b32 v46, 16, v70
    v_and_b32 v47, 0xffff0000, v70
    v_lshlrev_b32 v48, 16, v71
    v_and_b32 v49, 0xffff0000, v71
    v_add_f32 v34, v34, v14
    v_add_f32 v35, v35, v14
    v_add_f32 v36, v36, v14
    v_add_f32 v37, v37, v14
    v_add_f32 v38, v38, v14
    v_add_f32 v39, v39, v14
    v_add_f32 v40, v40, v14
    v_add_f32 v41, v41, v14
    v_add_f32 v42, v42, v14
    v_add_f32 v43, v43, v14
    v_add_f32 v44, v44, v14
    v_add_f32 v45, v45, v14
    v_add_f32 v46, v46, v14
    v_add_f32 v47, v47, v14
    v_add_f32 v48, v48, v14
    v_add_f32_e64 v49, v49, v14
    v_cvt_pk_bf16_f32 v64, v34, v35
    v_cvt_pk_bf16_f32 v65, v36, v37
    v_cvt_pk_bf16_f32 v66, v38, v39
    v_cvt_pk_bf16_f32 v67, v40, v41
    v_cvt_pk_bf16_f32 v68, v42, v43
    v_cvt_pk_bf16_f32 v69, v44, v45
    v_cvt_pk_bf16_f32 v70, v46, v47
    v_cvt_pk_bf16_f32 v71, v48, v49
    v_lshlrev_b32 v34, 16, v64
    v_and_b32 v35, 0xffff0000, v64
    v_lshlrev_b32 v36, 16, v65
    v_and_b32 v37, 0xffff0000, v65
    v_lshlrev_b32 v38, 16, v66
    v_and_b32 v39, 0xffff0000, v66
    v_lshlrev_b32 v40, 16, v67
    v_and_b32 v41, 0xffff0000, v67
    v_lshlrev_b32 v42, 16, v68
    v_and_b32 v43, 0xffff0000, v68
    v_lshlrev_b32 v44, 16, v69
    v_and_b32 v45, 0xffff0000, v69
    v_lshlrev_b32 v46, 16, v70
    v_and_b32 v47, 0xffff0000, v70
    v_lshlrev_b32 v48, 16, v71
    v_and_b32 v49, 0xffff0000, v71
    v_mul_f32 v34, v34, v15
    v_mul_f32 v35, v35, v15
    v_mul_f32 v36, v36, v15
    v_mul_f32 v37, v37, v15
    v_mul_f32 v38, v38, v15
    v_mul_f32 v39, v39, v15
    v_mul_f32 v40, v40, v15
    v_mul_f32 v41, v41, v15
    v_mul_f32 v42, v42, v15
    v_mul_f32 v43, v43, v15
    v_mul_f32 v44, v44, v15
    v_mul_f32 v45, v45, v15
    v_mul_f32 v46, v46, v15
    v_mul_f32 v47, v47, v15
    v_mul_f32 v48, v48, v15
    v_mul_f32 v49, v49, v15
    v_cvt_pk_bf16_f32 v64, v34, v35
    v_cvt_pk_bf16_f32 v65, v36, v37
    v_cvt_pk_bf16_f32 v66, v38, v39
    v_cvt_pk_bf16_f32 v67, v40, v41
    v_cvt_pk_bf16_f32 v68, v42, v43
    v_cvt_pk_bf16_f32 v69, v44, v45
    v_cvt_pk_bf16_f32 v70, v46, v47
    v_cvt_pk_bf16_f32 v71, v48, v49
    s_waitcnt vmcnt(8)
    v_perm_b32 v136, v76, v72, s52
    v_perm_b32 v137, v84, v80, s52
    v_perm_b32 v138, v92, v88, s52
    v_perm_b32 v139, v100, v96, s52
    s_nop 1
    v_mfma_f32_16x16x32_bf16 v[32:35], v[64:67], v[136:139], 0
    v_perm_b32 v140, v76, v72, s53
    v_perm_b32 v141, v84, v80, s53
    v_perm_b32 v142, v92, v88, s53
    v_perm_b32 v143, v100, v96, s53
    s_nop 1
    v_mfma_f32_16x16x32_bf16 v[36:39], v[64:67], v[140:143], 0
    v_perm_b32 v136, v77, v73, s52
    v_perm_b32 v137, v85, v81, s52
    v_perm_b32 v138, v93, v89, s52
    v_perm_b32 v139, v101, v97, s52
    s_nop 1
    v_mfma_f32_16x16x32_bf16 v[40:43], v[64:67], v[136:139], 0
    v_perm_b32 v140, v77, v73, s53
    v_perm_b32 v141, v85, v81, s53
    v_perm_b32 v142, v93, v89, s53
    v_perm_b32 v143, v101, v97, s53
    s_nop 1
    v_mfma_f32_16x16x32_bf16 v[44:47], v[64:67], v[140:143], 0
    v_perm_b32 v136, v78, v74, s52
    v_perm_b32 v137, v86, v82, s52
    v_perm_b32 v138, v94, v90, s52
    v_perm_b32 v139, v102, v98, s52
    s_nop 1
    v_mfma_f32_16x16x32_bf16 v[48:51], v[64:67], v[136:139], 0
    v_perm_b32 v140, v78, v74, s53
    v_perm_b32 v141, v86, v82, s53
    v_perm_b32 v142, v94, v90, s53
    v_perm_b32 v143, v102, v98, s53
    s_nop 1
    v_mfma_f32_16x16x32_bf16 v[52:55], v[64:67], v[140:143], 0
    v_perm_b32 v136, v79, v75, s52
    v_perm_b32 v137, v87, v83, s52
    v_perm_b32 v138, v95, v91, s52
    v_perm_b32 v139, v103, v99, s52
    s_nop 1
    v_mfma_f32_16x16x32_bf16 v[56:59], v[64:67], v[136:139], 0
    v_perm_b32 v140, v79, v75, s53
    v_perm_b32 v141, v87, v83, s53
    v_perm_b32 v142, v95, v91, s53
    v_perm_b32 v143, v103, v99, s53
    s_nop 1
    v_mfma_f32_16x16x32_bf16 v[60:63], v[64:67], v[140:143], 0
    s_waitcnt vmcnt(0)
    s_add_u32 s79, s78, 0
    s_nop 0
    buffer_load_dwordx4 v[16:19], v160, s[80:83], s79 offen nt
    s_add_u32 s79, s78, 2048
    buffer_load_dwordx4 v[20:23], v160, s[80:83], s79 offen nt
    s_add_u32 s79, s78, 4096
    buffer_load_dwordx4 v[24:27], v160, s[80:83], s79 offen nt
    s_add_u32 s79, s78, 6144
    buffer_load_dwordx4 v[28:31], v160, s[80:83], s79 offen nt
    s_add_u32 s79, s78, 8192
    buffer_load_dwordx4 v[144:147], v160, s[80:83], s79 offen nt
    s_add_u32 s79, s78, 10240
    buffer_load_dwordx4 v[148:151], v160, s[80:83], s79 offen nt
    s_add_u32 s79, s78, 12288
    buffer_load_dwordx4 v[152:155], v160, s[80:83], s79 offen nt
    v_perm_b32 v136, v108, v104, s52
    v_perm_b32 v137, v116, v112, s52
    v_perm_b32 v138, v124, v120, s52
    v_perm_b32 v139, v132, v128, s52
    s_nop 1
    v_mfma_f32_16x16x32_bf16 v[32:35], v[68:71], v[136:139], v[32:35]
    v_perm_b32 v140, v108, v104, s53
    v_perm_b32 v141, v116, v112, s53
    v_perm_b32 v142, v124, v120, s53
    v_perm_b32 v143, v132, v128, s53
    s_nop 1
    v_mfma_f32_16x16x32_bf16 v[36:39], v[68:71], v[140:143], v[36:39]
    v_perm_b32 v136, v109, v105, s52
    v_perm_b32 v137, v117, v113, s52
    v_perm_b32 v138, v125, v121, s52
    v_perm_b32 v139, v133, v129, s52
    s_nop 1
    v_mfma_f32_16x16x32_bf16 v[40:43], v[68:71], v[136:139], v[40:43]
    v_perm_b32 v140, v109, v105, s53
    v_perm_b32 v141, v117, v113, s53
    v_perm_b32 v142, v125, v121, s53
    v_perm_b32 v143, v133, v129, s53
    s_nop 1
    v_mfma_f32_16x16x32_bf16 v[44:47], v[68:71], v[140:143], v[44:47]
    v_perm_b32 v136, v110, v106, s52
    v_perm_b32 v137, v118, v114, s52
    v_perm_b32 v138, v126, v122, s52
    v_perm_b32 v139, v134, v130, s52
    s_nop 1
    v_mfma_f32_16x16x32_bf16 v[48:51], v[68:71], v[136:139], v[48:51]
    v_perm_b32 v140, v110, v106, s53
    v_perm_b32 v141, v118, v114, s53
    v_perm_b32 v142, v126, v122, s53
    v_perm_b32 v143, v134, v130, s53
    s_nop 1
    v_mfma_f32_16x16x32_bf16 v[52:55], v[68:71], v[140:143], v[52:55]
    v_perm_b32 v136, v111, v107, s52
    v_perm_b32 v137, v119, v115, s52
    v_perm_b32 v138, v127, v123, s52
    v_perm_b32 v139, v135, v131, s52
    s_nop 1
    v_mfma_f32_16x16x32_bf16 v[56:59], v[68:71], v[136:139], v[56:59]
    v_perm_b32 v140, v111, v107, s53
    v_perm_b32 v141, v119, v115, s53
    v_perm_b32 v142, v127, v123, s53
    v_perm_b32 v143, v135, v131, s53
    s_nop 1
    v_mfma_f32_16x16x32_bf16 v[60:63], v[68:71], v[140:143], v[60:63]
    v_cmp_gt_u32 vcc, 32, v0
    s_nop 1
    v_cndmask_b32 v32, v48, v32, vcc
    v_cndmask_b32 v33, v49, v33, vcc
    v_cndmask_b32 v34, v50, v34, vcc
    v_cndmask_b32 v35, v51, v35, vcc
    ds_write_b128 v164, v[32:35]
    v_cndmask_b32 v36, v52, v36, vcc
    v_cndmask_b32 v37, v53, v37, vcc
    v_cndmask_b32 v38, v54, v38, vcc
    v_cndmask_b32 v39, v55, v39, vcc
    v_xor_b32 v4, 32, v164
    ds_write_b128 v4, v[36:39]
    v_cndmask_b32 v40, v56, v40, vcc
    v_cndmask_b32 v41, v57, v41, vcc
    v_cndmask_b32 v42, v58, v42, vcc
    v_cndmask_b32 v43, v59, v43, vcc
    v_xor_b32 v4, 64, v164
    ds_write_b128 v4, v[40:43]
    v_cndmask_b32 v44, v60, v44, vcc
    v_cndmask_b32 v45, v61, v45, vcc
    v_cndmask_b32 v46, v62, v46, vcc
    v_cndmask_b32 v47, v63, v47, vcc
    v_xor_b32 v4, 96, v164
    ds_write_b128 v4, v[44:47]
    v_mov_b32 v4, 1
    s_mov_b64 exec, 1
    ds_write_b32 v10, v4 offset:16
    s_mov_b64 exec, -1
    ds_read_b32 v12, v13
FW_35:
    s_waitcnt lgkmcnt(0)
    v_cmp_gt_u32 vcc, 1, v12
    s_cbranch_vccz FO_36
    s_sleep 1
    ds_read_b32 v12, v13
    s_branch FW_35
FO_36:
    ds_read_b128 v[72:75], v165 offset:0
    ds_read_b128 v[76:79], v165 offset:4096
    ds_read_b128 v[80:83], v165 offset:8192
    ds_read_b128 v[84:87], v165 offset:12288
    s_waitcnt lgkmcnt(0)
    v_add_f32 v72, v72, v76
    v_add_f32 v80, v80, v84
    v_add_f32 v73, v73, v77
    v_add_f32 v81, v81, v85
    v_add_f32 v74, v74, v78
    v_add_f32 v82, v82, v86
    v_add_f32 v75, v75, v79
    v_add_f32 v83, v83, v87
    v_add_f32 v72, v72, v80
    v_add_f32 v73, v73, v81
    v_add_f32 v74, v74, v82
    v_add_f32 v75, v75, v83
    v_max_u32 v72, 1, v72
    v_max_u32 v74, 1, v74
    buffer_store_dwordx4 v[72:75], v2, s[12:15], s77 offen sc0 sc1
    s_lshl_b32 s44, s38, 2
    s_add_u32 s44, s44, s3
    s_mul_i32 s44, s44, 64
    s_add_u32 s44, s44, 241664
    v_mov_b32 v4, 1
    s_mov_b64 exec, 1
    buffer_atomic_add v4, v8, s[24:27], s44 offen
    s_mov_b64 exec, -1
F_adown:
    v_mov_b32 v4, 2
    s_mov_b64 exec, 1
    ds_write_b32 v10, v4 offset:16
    s_mov_b64 exec, -1
    s_mul_i32 s36, s28, 112
    s_mul_i32 s37, s3, 28
    s_add_u32 s36, s36, s37
    v_min_u32 v4, 55, v0
    v_lshlrev_b32 v4, 4, v4
    s_lshl_b32 s38, s36, 5
    s_lshr_b32 s44, s36, 5
    s_mul_i32 s44, s44, 64
    s_add_u32 s45, s36, 27
    s_lshr_b32 s45, s45, 5
    s_mul_i32 s45, s45, 64
    s_add_u32 s56, s44, 0x83b000
    s_add_u32 s56, s72, s56
    s_addc_u32 s57, s73, 0
    s_add_u32 s58, s45, 0x83b000
    s_add_u32 s58, s72, s58
    s_addc_u32 s59, s73, 0
    v_mov_b32 v156, 0
    v_mov_b32 v157, 0
    v_mov_b32 v158, 0
    v_mov_b32 v159, 0
    s_mov_b32 s48, 0xbfb8aa3b
    ds_read_b32 v12, v163
FW_37:
    s_waitcnt lgkmcnt(0)
    v_cmp_gt_u32 vcc, 3, v12
    s_cbranch_vccz FO_38
    s_sleep 2
    ds_read_b32 v12, v163
    s_branch FW_37
FO_38:
    s_add_u32 s44, s88, 32768
    v_lshlrev_b32 v9, 3, v0
    v_add_u32 v9, s44, v9
    ds_write_b64 v9, v[156:157]
    v_lshrrev_b32 v11, 1, v0
    v_mul_u32_u24 v9, 37, v11
    v_lshrrev_b32 v9, 8, v9
    v_add_u32 v11, v11, v9
    v_lshlrev_b32 v11, 1, v11
    v_and_b32 v9, 1, v0
    v_lshl_add_u32 v11, v9, 8, v11
    v_add_u32 v11, s44, v11
    v_and_b32 v9, 7, v0
    v_lshlrev_b32 v9, 6, v9
    v_lshl_add_u32 v9, v5, 4, v9
    v_add_u32 v9, s44, v9
    s_waitcnt vmcnt(2)
    s_cmp_lt_u32 s2, 224
    s_cbranch_scc1 F_dp
    s_waitcnt vmcnt(0)
F_dp:
    v_perm_b32 v72, v20, v16, s52
    v_perm_b32 v73, v28, v24, s52
    v_perm_b32 v74, v148, v144, s52
    v_perm_b32 v75, v156, v152, s52
    v_perm_b32 v76, v20, v16, s53
    v_perm_b32 v77, v28, v24, s53
    v_perm_b32 v78, v148, v144, s53
    v_perm_b32 v79, v156, v152, s53
    v_perm_b32 v80, v21, v17, s52
    v_perm_b32 v81, v29, v25, s52
    v_perm_b32 v82, v149, v145, s52
    v_perm_b32 v83, v157, v153, s52
    v_perm_b32 v84, v21, v17, s53
    v_perm_b32 v85, v29, v25, s53
    v_perm_b32 v86, v149, v145, s53
    v_perm_b32 v87, v157, v153, s53
    v_perm_b32 v88, v22, v18, s52
    v_perm_b32 v89, v30, v26, s52
    v_perm_b32 v90, v150, v146, s52
    v_perm_b32 v91, v158, v154, s52
    v_perm_b32 v92, v22, v18, s53
    v_perm_b32 v93, v30, v26, s53
    v_perm_b32 v94, v150, v146, s53
    v_perm_b32 v95, v158, v154, s53
    v_perm_b32 v96, v23, v19, s52
    v_perm_b32 v97, v31, v27, s52
    v_perm_b32 v98, v151, v147, s52
    v_perm_b32 v99, v159, v155, s52
    v_perm_b32 v100, v23, v19, s53
    v_perm_b32 v101, v31, v27, s53
    v_perm_b32 v102, v151, v147, s53
    v_perm_b32 v103, v159, v155, s53
    v_and_b32 v14, 1, v5
    v_lshlrev_b32 v14, 11, v14
    v_lshl_add_u32 v14, v7, 5, v14
    v_lshrrev_b32 v15, 1, v5
    v_lshl_add_u32 v14, v15, 4, v14
    v_add_u32 v14, s44, v14
    s_lshl_b32 s45, s3, 10
    s_add_u32 s45, s45, 32768
    v_add_u32 v15, s45, v3
    v_add_u32 v13, 48, v13
    v_and_b32 v17, 31, v0
    v_lshlrev_b32 v17, 4, v17
    s_mov_b32 s80, s68
    s_mov_b32 s81, s69
    s_mov_b32 s82, 0x400000
    s_mov_b32 s83, 0x00020000
    s_lshl_b32 s46, s3, 2
    v_add_u32 v16, s46, v5
    v_lshlrev_b32 v152, 4, v7
    v_mul_u32_u24 v18, 272, v16
    v_add3_u32 v153, v152, v18, 0
    v_lshl_add_u32 v152, v16, 11, v152
    s_lshl_b32 s78, s28, 17
    s_lshl_b32 s79, s29, 8
    s_add_u32 s78, s78, s79
    s_lshl_b32 s47, s28, 6
    s_add_u32 s47, s47, s46
    s_sub_u32 s47, 2047, s47
    s_mov_b32 s77, 0
    v_mov_b32 v144, 0
    v_mov_b32 v145, 0
    v_mov_b32 v146, 0
    v_mov_b32 v147, 0
    s_and_b32 s46, s60, 0x7ff
    s_sub_u32 s46, s47, s46
    s_and_b32 s45, s46, 0xffffffcc
    s_cbranch_scc1 SD_39
    s_mov_b32 s77, 1
    s_or_b32 s45, s60, 0x4000
    v_mov_b32 v18, s45
    v_cmp_eq_u32 vcc, s46, v5
    s_sub_u32 s46, s46, 16
    s_nop 0
    v_cndmask_b32 v144, v144, v18, vcc
    v_cmp_eq_u32 vcc, s46, v5
    s_sub_u32 s46, s46, 16
    s_nop 0
    v_cndmask_b32 v145, v145, v18, vcc
    v_cmp_eq_u32 vcc, s46, v5
    s_sub_u32 s46, s46, 16
    s_nop 0
    v_cndmask_b32 v146, v146, v18, vcc
    v_cmp_eq_u32 vcc, s46, v5
    s_sub_u32 s46, s46, 16
    s_nop 0
    v_cndmask_b32 v147, v147, v18, vcc
SD_39:
    s_and_b32 s46, s61, 0x7ff
    s_sub_u32 s46, s47, s46
    s_and_b32 s45, s46, 0xffffffcc
    s_cbranch_scc1 SD_40
    s_mov_b32 s77, 1
    s_or_b32 s45, s61, 0x4800
    v_mov_b32 v18, s45
    v_cmp_eq_u32 vcc, s46, v5
    s_sub_u32 s46, s46, 16
    s_nop 0
    v_cndmask_b32 v144, v144, v18, vcc
    v_cmp_eq_u32 vcc, s46, v5
    s_sub_u32 s46, s46, 16
    s_nop 0
    v_cndmask_b32 v145, v145, v18, vcc
    v_cmp_eq_u32 vcc, s46, v5
    s_sub_u32 s46, s46, 16
    s_nop 0
    v_cndmask_b32 v146, v146, v18, vcc
    v_cmp_eq_u32 vcc, s46, v5
    s_sub_u32 s46, s46, 16
    s_nop 0
    v_cndmask_b32 v147, v147, v18, vcc
SD_40:
    s_and_b32 s46, s62, 0x7ff
    s_sub_u32 s46, s47, s46
    s_and_b32 s45, s46, 0xffffffcc
    s_cbranch_scc1 SD_41
    s_mov_b32 s77, 1
    s_or_b32 s45, s62, 0x5000
    v_mov_b32 v18, s45
    v_cmp_eq_u32 vcc, s46, v5
    s_sub_u32 s46, s46, 16
    s_nop 0
    v_cndmask_b32 v144, v144, v18, vcc
    v_cmp_eq_u32 vcc, s46, v5
    s_sub_u32 s46, s46, 16
    s_nop 0
    v_cndmask_b32 v145, v145, v18, vcc
    v_cmp_eq_u32 vcc, s46, v5
    s_sub_u32 s46, s46, 16
    s_nop 0
    v_cndmask_b32 v146, v146, v18, vcc
    v_cmp_eq_u32 vcc, s46, v5
    s_sub_u32 s46, s46, 16
    s_nop 0
    v_cndmask_b32 v147, v147, v18, vcc
SD_41:
    s_and_b32 s46, s63, 0x7ff
    s_sub_u32 s46, s47, s46
    s_and_b32 s45, s46, 0xffffffcc
    s_cbranch_scc1 SD_42
    s_mov_b32 s77, 1
    s_or_b32 s45, s63, 0x5800
    v_mov_b32 v18, s45
    v_cmp_eq_u32 vcc, s46, v5
    s_sub_u32 s46, s46, 16
    s_nop 0
    v_cndmask_b32 v144, v144, v18, vcc
    v_cmp_eq_u32 vcc, s46, v5
    s_sub_u32 s46, s46, 16
    s_nop 0
    v_cndmask_b32 v145, v145, v18, vcc
    v_cmp_eq_u32 vcc, s46, v5
    s_sub_u32 s46, s46, 16
    s_nop 0
    v_cndmask_b32 v146, v146, v18, vcc
    v_cmp_eq_u32 vcc, s46, v5
    s_sub_u32 s46, s46, 16
    s_nop 0
    v_cndmask_b32 v147, v147, v18, vcc
SD_42:
    s_and_b32 s46, s64, 0x7ff
    s_sub_u32 s46, s47, s46
    s_and_b32 s45, s46, 0xffffffcc
    s_cbranch_scc1 SD_43
    s_mov_b32 s77, 1
    s_or_b32 s45, s64, 0x6000
    v_mov_b32 v18, s45
    v_cmp_eq_u32 vcc, s46, v5
    s_sub_u32 s46, s46, 16
    s_nop 0
    v_cndmask_b32 v144, v144, v18, vcc
    v_cmp_eq_u32 vcc, s46, v5
    s_sub_u32 s46, s46, 16
    s_nop 0
    v_cndmask_b32 v145, v145, v18, vcc
    v_cmp_eq_u32 vcc, s46, v5
    s_sub_u32 s46, s46, 16
    s_nop 0
    v_cndmask_b32 v146, v146, v18, vcc
    v_cmp_eq_u32 vcc, s46, v5
    s_sub_u32 s46, s46, 16
    s_nop 0
    v_cndmask_b32 v147, v147, v18, vcc
SD_43:
    s_and_b32 s46, s65, 0x7ff
    s_sub_u32 s46, s47, s46
    s_and_b32 s45, s46, 0xffffffcc
    s_cbranch_scc1 SD_44
    s_mov_b32 s77, 1
    s_or_b32 s45, s65, 0x6800
    v_mov_b32 v18, s45
    v_cmp_eq_u32 vcc, s46, v5
    s_sub_u32 s46, s46, 16
    s_nop 0
    v_cndmask_b32 v144, v144, v18, vcc
    v_cmp_eq_u32 vcc, s46, v5
    s_sub_u32 s46, s46, 16
    s_nop 0
    v_cndmask_b32 v145, v145, v18, vcc
    v_cmp_eq_u32 vcc, s46, v5
    s_sub_u32 s46, s46, 16
    s_nop 0
    v_cndmask_b32 v146, v146, v18, vcc
    v_cmp_eq_u32 vcc, s46, v5
    s_sub_u32 s46, s46, 16
    s_nop 0
    v_cndmask_b32 v147, v147, v18, vcc
SD_44:
    s_and_b32 s46, s66, 0x7ff
    s_sub_u32 s46, s47, s46
    s_and_b32 s45, s46, 0xffffffcc
    s_cbranch_scc1 SD_45
    s_mov_b32 s77, 1
    s_or_b32 s45, s66, 0x7000
    v_mov_b32 v18, s45
    v_cmp_eq_u32 vcc, s46, v5
    s_sub_u32 s46, s46, 16
    s_nop 0
    v_cndmask_b32 v144, v144, v18, vcc
    v_cmp_eq_u32 vcc, s46, v5
    s_sub_u32 s46, s46, 16
    s_nop 0
    v_cndmask_b32 v145, v145, v18, vcc
    v_cmp_eq_u32 vcc, s46, v5
    s_sub_u32 s46, s46, 16
    s_nop 0
    v_cndmask_b32 v146, v146, v18, vcc
    v_cmp_eq_u32 vcc, s46, v5
    s_sub_u32 s46, s46, 16
    s_nop 0
    v_cndmask_b32 v147, v147, v18, vcc
SD_45:
    s_and_b32 s46, s67, 0x7ff
    s_sub_u32 s46, s47, s46
    s_and_b32 s45, s46, 0xffffffcc
    s_cbranch_scc1 SD_46
    s_mov_b32 s77, 1
    s_or_b32 s45, s67, 0x7800
    v_mov_b32 v18, s45
    v_cmp_eq_u32 vcc, s46, v5
    s_sub_u32 s46, s46, 16
    s_nop 0
    v_cndmask_b32 v144, v144, v18, vcc
    v_cmp_eq_u32 vcc, s46, v5
    s_sub_u32 s46, s46, 16
    s_nop 0
    v_cndmask_b32 v145, v145, v18, vcc
    v_cmp_eq_u32 vcc, s46, v5
    s_sub_u32 s46, s46, 16
    s_nop 0
    v_cndmask_b32 v146, v146, v18, vcc
    v_cmp_eq_u32 vcc, s46, v5
    s_sub_u32 s46, s46, 16
    s_nop 0
    v_cndmask_b32 v147, v147, v18, vcc
SD_46:
    s_cmp_eq_u32 s77, 0
    s_cbranch_scc1 F_ys1
    v_lshlrev_b32 v19, 5, v7
    v_cmp_ne_u32 s[60:61], 0, v144
    v_and_b32 v148, 0xffff0000, v144
    v_ashrrev_i32 v18, 31, v148
    v_not_b32 v18, v18
    v_or_b32 v18, 0x80000000, v18
    v_xor_b32 v148, v148, v18
    v_and_b32 v148, 0xffff0000, v148
    v_mul_f32 v148, s48, v148
    v_exp_f32 v148, v148
    s_nop 0
    v_add_f32 v148, 1.0, v148
    v_rcp_f32 v148, v148
    s_nop 0
    v_cvt_pk_bf16_f32 v148, v148, v148
    v_lshlrev_b32 v148, 16, v148
    v_bfe_u32 v144, v144, 11, 3
    v_lshl_add_u32 v144, v144, 12, v19
    v_cmp_ne_u32 s[62:63], 0, v145
    v_and_b32 v149, 0xffff0000, v145
    v_ashrrev_i32 v18, 31, v149
    v_not_b32 v18, v18
    v_or_b32 v18, 0x80000000, v18
    v_xor_b32 v149, v149, v18
    v_and_b32 v149, 0xffff0000, v149
    v_mul_f32 v149, s48, v149
    v_exp_f32 v149, v149
    s_nop 0
    v_add_f32 v149, 1.0, v149
    v_rcp_f32 v149, v149
    s_nop 0
    v_cvt_pk_bf16_f32 v149, v149, v149
    v_lshlrev_b32 v149, 16, v149
    v_bfe_u32 v145, v145, 11, 3
    v_lshl_add_u32 v145, v145, 12, v19
    v_cmp_ne_u32 s[64:65], 0, v146
    v_and_b32 v150, 0xffff0000, v146
    v_ashrrev_i32 v18, 31, v150
    v_not_b32 v18, v18
    v_or_b32 v18, 0x80000000, v18
    v_xor_b32 v150, v150, v18
    v_and_b32 v150, 0xffff0000, v150
    v_mul_f32 v150, s48, v150
    v_exp_f32 v150, v150
    s_nop 0
    v_add_f32 v150, 1.0, v150
    v_rcp_f32 v150, v150
    s_nop 0
    v_cvt_pk_bf16_f32 v150, v150, v150
    v_lshlrev_b32 v150, 16, v150
    v_bfe_u32 v146, v146, 11, 3
    v_lshl_add_u32 v146, v146, 12, v19
    v_cmp_ne_u32 s[66:67], 0, v147
    v_and_b32 v151, 0xffff0000, v147
    v_ashrrev_i32 v18, 31, v151
    v_not_b32 v18, v18
    v_or_b32 v18, 0x80000000, v18
    v_xor_b32 v151, v151, v18
    v_and_b32 v151, 0xffff0000, v151
    v_mul_f32 v151, s48, v151
    v_exp_f32 v151, v151
    s_nop 0
    v_add_f32 v151, 1.0, v151
    v_rcp_f32 v151, v151
    s_nop 0
    v_cvt_pk_bf16_f32 v151, v151, v151
    v_lshlrev_b32 v151, 16, v151
    v_bfe_u32 v147, v147, 11, 3
    v_lshl_add_u32 v147, v147, 12, v19
F_ys1:
SP_47:
    s_load_dword s74, s[56:57], 0 glc
    s_load_dword s75, s[58:59], 0 glc
    s_waitcnt lgkmcnt(0)
    s_min_u32 s74, s74, s75
    s_cmp_ge_u32 s74, 8
    s_cbranch_scc1 SD_48
    s_sleep 16
    s_branch SP_47
SD_48:
F_dl:
    s_add_u32 s45, s38, 0
    buffer_load_dwordx4 v[32:35], v4, s[12:15], s45 offen sc0 sc1
    s_add_u32 s45, s38, 114688
    buffer_load_dwordx4 v[36:39], v4, s[12:15], s45 offen sc0 sc1
    s_add_u32 s45, s38, 229376
    buffer_load_dwordx4 v[40:43], v4, s[12:15], s45 offen sc0 sc1
    s_add_u32 s45, s38, 344064
    buffer_load_dwordx4 v[44:47], v4, s[12:15], s45 offen sc0 sc1
    s_add_u32 s45, s38, 458752
    buffer_load_dwordx4 v[48:51], v4, s[12:15], s45 offen sc0 sc1
    s_add_u32 s45, s38, 573440
    buffer_load_dwordx4 v[52:55], v4, s[12:15], s45 offen sc0 sc1
    s_add_u32 s45, s38, 688128
    buffer_load_dwordx4 v[56:59], v4, s[12:15], s45 offen sc0 sc1
    s_add_u32 s45, s38, 802816
    buffer_load_dwordx4 v[60:63], v4, s[12:15], s45 offen sc0 sc1
    s_waitcnt vmcnt(0)
    s_nop 0
    v_min3_u32 v12, v32, v34, v36
    v_min3_u32 v12, v12, v38, v40
    v_min3_u32 v12, v12, v42, v44
    v_min3_u32 v12, v12, v46, v48
    v_min3_u32 v12, v12, v50, v52
    v_min3_u32 v12, v12, v54, v56
    v_min3_u32 v12, v12, v58, v60
    v_min_u32 v12, v12, v62
    v_cmp_eq_u32 vcc, 0, v12
    s_cbranch_vccz F_dm
    s_sleep 6
    s_branch F_dl
F_dm:
    v_add_f32 v32, v32, v40
    v_add_f32 v48, v48, v56
    v_add_f32 v33, v33, v41
    v_add_f32 v49, v49, v57
    v_add_f32 v34, v34, v42
    v_add_f32 v50, v50, v58
    v_add_f32 v35, v35, v43
    v_add_f32 v51, v51, v59
    v_add_f32 v32, v32, v48
    v_add_f32 v33, v33, v49
    v_add_f32 v34, v34, v50
    v_add_f32 v35, v35, v51
    v_add_f32 v36, v36, v44
    v_add_f32 v52, v52, v60
    v_add_f32 v37, v37, v45
    v_add_f32 v53, v53, v61
    v_add_f32 v38, v38, v46
    v_add_f32 v54, v54, v62
    v_add_f32 v39, v39, v47
    v_add_f32 v55, v55, v63
    v_add_f32 v36, v36, v52
    v_add_f32 v37, v37, v53
    v_add_f32 v38, v38, v54
    v_add_f32 v39, v39, v55
    v_cvt_pk_bf16_f32 v40, v32, v36
    v_cvt_pk_bf16_f32 v41, v33, v37
    v_cvt_pk_bf16_f32 v42, v34, v38
    v_cvt_pk_bf16_f32 v43, v35, v39
    v_lshlrev_b32 v32, 16, v40
    v_and_b32 v36, 0xffff0000, v40
    v_lshlrev_b32 v33, 16, v41
    v_and_b32 v37, 0xffff0000, v41
    v_lshlrev_b32 v34, 16, v42
    v_and_b32 v38, 0xffff0000, v42
    v_lshlrev_b32 v35, 16, v43
    v_and_b32 v39, 0xffff0000, v43
    v_mul_f32 v40, s48, v32
    v_mul_f32 v41, s48, v33
    v_mul_f32 v42, s48, v34
    v_mul_f32 v43, s48, v35
    v_exp_f32 v40, v40
    v_exp_f32 v41, v41
    v_exp_f32 v42, v42
    v_exp_f32 v43, v43
    v_add_f32 v40, 1.0, v40
    v_add_f32 v41, 1.0, v41
    v_add_f32 v42, 1.0, v42
    v_add_f32 v43, 1.0, v43
    v_rcp_f32 v40, v40
    v_rcp_f32 v41, v41
    v_rcp_f32 v42, v42
    v_rcp_f32 v43, v43
    v_mul_f32 v32, v32, v40
    v_mul_f32 v33, v33, v41
    v_mul_f32 v34, v34, v42
    v_mul_f32 v35, v35, v43
    v_cvt_pk_bf16_f32 v32, v32, v32
    v_cvt_pk_bf16_f32 v33, v33, v33
    v_cvt_pk_bf16_f32 v34, v34, v34
    v_cvt_pk_bf16_f32 v35, v35, v35
    v_lshlrev_b32 v32, 16, v32
    v_lshlrev_b32 v33, 16, v33
    v_lshlrev_b32 v34, 16, v34
    v_lshlrev_b32 v35, 16, v35
    v_mul_f32 v32, v32, v36
    v_mul_f32 v33, v33, v37
    v_mul_f32 v34, v34, v38
    v_mul_f32 v35, v35, v39
    v_cvt_pk_bf16_f32 v32, v32, v32
    v_cvt_pk_bf16_f32 v33, v33, v33
    v_cvt_pk_bf16_f32 v34, v34, v34
    v_cvt_pk_bf16_f32 v35, v35, v35
    v_cmp_gt_u32 vcc, 56, v0
    s_nop 0
    s_and_saveexec_b64 s[50:51], vcc
    ds_write_b16 v11, v32 offset:0
    ds_write_b16 v11, v33 offset:64
    ds_write_b16 v11, v34 offset:128
    ds_write_b16 v11, v35 offset:192
    s_mov_b64 exec, s[50:51]
    ds_read_b128 v[64:67], v9
    s_waitcnt lgkmcnt(0)
    v_mfma_f32_16x16x32_bf16 v[104:107], v[64:67], v[72:75], 0
    v_mfma_f32_16x16x32_bf16 v[108:111], v[64:67], v[76:79], 0
    v_mfma_f32_16x16x32_bf16 v[112:115], v[64:67], v[80:83], 0
    v_mfma_f32_16x16x32_bf16 v[116:119], v[64:67], v[84:87], 0
    v_mfma_f32_16x16x32_bf16 v[120:123], v[64:67], v[88:91], 0
    v_mfma_f32_16x16x32_bf16 v[124:127], v[64:67], v[92:95], 0
    v_mfma_f32_16x16x32_bf16 v[128:131], v[64:67], v[96:99], 0
    v_mfma_f32_16x16x32_bf16 v[132:135], v[64:67], v[100:103], 0
    v_cmp_gt_u32 vcc, 32, v0
    s_nop 3
    v_cndmask_b32 v32, v120, v104, vcc
    v_cndmask_b32 v33, v124, v108, vcc
    v_cndmask_b32 v34, v128, v112, vcc
    v_cndmask_b32 v35, v132, v116, vcc
    ds_write_b128 v14, v[32:35] offset:0
    v_cndmask_b32 v36, v121, v105, vcc
    v_cndmask_b32 v37, v125, v109, vcc
    v_cndmask_b32 v38, v129, v113, vcc
    v_cndmask_b32 v39, v133, v117, vcc
    ds_write_b128 v14, v[36:39] offset:512
    v_cndmask_b32 v40, v122, v106, vcc
    v_cndmask_b32 v41, v126, v110, vcc
    v_cndmask_b32 v42, v130, v114, vcc
    v_cndmask_b32 v43, v134, v118, vcc
    ds_write_b128 v14, v[40:43] offset:1024
    v_cndmask_b32 v44, v123, v107, vcc
    v_cndmask_b32 v45, v127, v111, vcc
    v_cndmask_b32 v46, v131, v115, vcc
    v_cndmask_b32 v47, v135, v119, vcc
    ds_write_b128 v14, v[44:47] offset:1536
    v_mov_b32 v4, 1
    s_mov_b64 exec, 1
    ds_write_b32 v10, v4 offset:64
    s_mov_b64 exec, -1
    s_lshl_b32 s45, s29, 7
    s_add_u32 s56, s45, 0x82a000
    s_add_u32 s56, s72, s56
    s_addc_u32 s57, s73, 0
    s_lshl_b32 s44, s3, 13
    s_lshl_b32 s50, s29, 9
    s_add_u32 s50, s50, 135168
    s_add_u32 s44, s44, s50
    s_add_u32 s45, s44, 4096
    ds_read_b32 v12, v13
FW_49:
    s_waitcnt lgkmcnt(0)
    v_cmp_gt_u32 vcc, 1, v12
    s_cbranch_vccz FO_50
    s_sleep 1
    ds_read_b32 v12, v13
    s_branch FW_49
FO_50:
    ds_read2st64_b32 v[48:49], v15 offset0:0 offset1:1
    ds_read2st64_b32 v[52:53], v15 offset0:16 offset1:17
    ds_read2st64_b32 v[56:57], v15 offset0:96 offset1:97
    ds_read2st64_b32 v[60:61], v15 offset0:112 offset1:113
    ds_read2st64_b32 v[50:51], v15 offset0:2 offset1:3
    ds_read2st64_b32 v[54:55], v15 offset0:18 offset1:19
    ds_read2st64_b32 v[58:59], v15 offset0:98 offset1:99
    ds_read2st64_b32 v[62:63], v15 offset0:114 offset1:115
    s_waitcnt lgkmcnt(4)
    v_add_f32 v48, v48, v52
    v_add_f32 v56, v56, v60
    v_add_f32 v48, v48, v56
    buffer_atomic_add_f32 v48, v3, s[24:27], s44 offen offset:0
    v_add_f32 v49, v49, v53
    v_add_f32 v57, v57, v61
    v_add_f32 v49, v49, v57
    buffer_atomic_add_f32 v49, v3, s[24:27], s44 offen offset:256
    s_waitcnt lgkmcnt(0)
    v_add_f32 v50, v50, v54
    v_add_f32 v58, v58, v62
    v_add_f32 v50, v50, v58
    buffer_atomic_add_f32 v50, v3, s[24:27], s45 offen offset:0
    v_add_f32 v51, v51, v55
    v_add_f32 v59, v59, v63
    v_add_f32 v51, v51, v59
    buffer_atomic_add_f32 v51, v3, s[24:27], s45 offen offset:256
    s_barrier
    s_barrier
    s_barrier
    s_barrier
    s_waitcnt vmcnt(0)
    s_barrier
    s_cmp_lg_u32 s3, 0
    s_cbranch_scc1 F_y0
    s_mov_b32 s76, 1
    s_atomic_add s76, s[56:57], 0
F_y0:
    s_barrier
    s_barrier
    s_barrier
    s_barrier
    s_barrier
    s_barrier
    s_cmp_lg_u32 s77, 0
    s_cbranch_scc1 F_y1
    s_barrier
    s_barrier
    s_barrier
    s_barrier
    s_barrier
F_y3:
    s_waitcnt lgkmcnt(0)
    s_setprio 3
    s_barrier
    ds_read_b128 v[16:19], v153 offset:0
    s_cmp_lg_u32 s77, 0
    s_waitcnt lgkmcnt(0)
    s_cbranch_scc1 F_ya0
F_yb0:
    buffer_store_dwordx4 v[16:19], v152, s[80:83], s78 offen sc1
    s_add_u32 s78, s78, 32768
    s_barrier
    ds_read_b128 v[20:23], v153 offset:4352
    s_cmp_lg_u32 s77, 0
    s_waitcnt lgkmcnt(0)
    s_cbranch_scc1 F_ya1
F_yb1:
    buffer_store_dwordx4 v[20:23], v152, s[80:83], s78 offen sc1
    s_add_u32 s78, s78, 32768
    s_barrier
    ds_read_b128 v[24:27], v153 offset:8704
    ds_read_b128 v[28:31], v153 offset:13056
    s_cmp_lg_u32 s77, 0
    s_waitcnt lgkmcnt(1)
    s_cbranch_scc1 F_ya2
F_yb2:
    buffer_store_dwordx4 v[24:27], v152, s[80:83], s78 offen sc1
    s_add_u32 s78, s78, 32768
    s_cmp_lg_u32 s77, 0
    s_waitcnt lgkmcnt(0)
    s_cbranch_scc1 F_ya3
F_yb3:
    buffer_store_dwordx4 v[28:31], v152, s[80:83], s78 offen sc1
    s_add_u32 s78, s78, 32768
    s_endpgm
F_y1:
    s_load_dword s58, s[56:57], 0 glc
    s_barrier
    s_barrier
    s_waitcnt lgkmcnt(0)
    s_cmp_lt_u32 s58, 32
    s_cbranch_scc1 F_y2
    s_mov_b64 exec, s[60:61]
    s_cbranch_execz YL_51
    buffer_load_dwordx4 v[72:75], v144, s[24:27], s50 offen offset:0 sc0 sc1
    buffer_load_dwordx4 v[76:79], v144, s[24:27], s50 offen offset:16 sc0 sc1
YL_51:
    s_mov_b64 exec, s[62:63]
    s_cbranch_execz YL_52
    buffer_load_dwordx4 v[80:83], v145, s[24:27], s50 offen offset:0 sc0 sc1
    buffer_load_dwordx4 v[84:87], v145, s[24:27], s50 offen offset:16 sc0 sc1
YL_52:
    s_mov_b64 exec, s[64:65]
    s_cbranch_execz YL_53
    buffer_load_dwordx4 v[88:91], v146, s[24:27], s50 offen offset:0 sc0 sc1
    buffer_load_dwordx4 v[92:95], v146, s[24:27], s50 offen offset:16 sc0 sc1
YL_53:
    s_mov_b64 exec, s[66:67]
    s_cbranch_execz YL_54
    buffer_load_dwordx4 v[96:99], v147, s[24:27], s50 offen offset:0 sc0 sc1
    buffer_load_dwordx4 v[100:103], v147, s[24:27], s50 offen offset:16 sc0 sc1
YL_54:
    s_mov_b64 exec, -1
    s_barrier
    s_barrier
    s_barrier
    s_branch F_y3
F_y2:
    s_barrier
    s_barrier
    s_barrier
SP_55:
    s_load_dword s58, s[56:57], 0 glc
    s_waitcnt lgkmcnt(0)
    s_cmp_ge_u32 s58, 32
    s_cbranch_scc1 SD_56
    s_sleep 2
    s_branch SP_55
SD_56:
    s_mov_b64 exec, s[60:61]
    s_cbranch_execz YL_57
    buffer_load_dwordx4 v[72:75], v144, s[24:27], s50 offen offset:0 sc0 sc1
    buffer_load_dwordx4 v[76:79], v144, s[24:27], s50 offen offset:16 sc0 sc1
YL_57:
    s_mov_b64 exec, s[62:63]
    s_cbranch_execz YL_58
    buffer_load_dwordx4 v[80:83], v145, s[24:27], s50 offen offset:0 sc0 sc1
    buffer_load_dwordx4 v[84:87], v145, s[24:27], s50 offen offset:16 sc0 sc1
YL_58:
    s_mov_b64 exec, s[64:65]
    s_cbranch_execz YL_59
    buffer_load_dwordx4 v[88:91], v146, s[24:27], s50 offen offset:0 sc0 sc1
    buffer_load_dwordx4 v[92:95], v146, s[24:27], s50 offen offset:16 sc0 sc1
YL_59:
    s_mov_b64 exec, s[66:67]
    s_cbranch_execz YL_60
    buffer_load_dwordx4 v[96:99], v147, s[24:27], s50 offen offset:0 sc0 sc1
    buffer_load_dwordx4 v[100:103], v147, s[24:27], s50 offen offset:16 sc0 sc1
YL_60:
    s_mov_b64 exec, -1
    s_branch F_y3
F_ya0:
    s_cmp_eq_u64 s[60:61], 0
    s_cbranch_scc1 F_yb0
    s_mov_b64 exec, s[60:61]
    v_lshlrev_b32 v32, 16, v16
    v_and_b32 v33, 0xffff0000, v16
    v_lshlrev_b32 v34, 16, v17
    v_and_b32 v35, 0xffff0000, v17
    v_lshlrev_b32 v36, 16, v18
    v_and_b32 v37, 0xffff0000, v18
    v_lshlrev_b32 v38, 16, v19
    v_and_b32 v39, 0xffff0000, v19
    s_waitcnt vmcnt(0)
    v_fmac_f32 v32, v72, v148
    v_fmac_f32 v33, v73, v148
    v_fmac_f32 v34, v74, v148
    v_fmac_f32 v35, v75, v148
    v_fmac_f32 v36, v76, v148
    v_fmac_f32 v37, v77, v148
    v_fmac_f32 v38, v78, v148
    v_fmac_f32 v39, v79, v148
    v_cvt_pk_bf16_f32 v16, v32, v33
    v_cvt_pk_bf16_f32 v17, v34, v35
    v_cvt_pk_bf16_f32 v18, v36, v37
    v_cvt_pk_bf16_f32 v19, v38, v39
    s_mov_b64 exec, -1
    s_branch F_yb0
F_ya1:
    s_cmp_eq_u64 s[62:63], 0
    s_cbranch_scc1 F_yb1
    s_mov_b64 exec, s[62:63]
    v_lshlrev_b32 v32, 16, v20
    v_and_b32 v33, 0xffff0000, v20
    v_lshlrev_b32 v34, 16, v21
    v_and_b32 v35, 0xffff0000, v21
    v_lshlrev_b32 v36, 16, v22
    v_and_b32 v37, 0xffff0000, v22
    v_lshlrev_b32 v38, 16, v23
    v_and_b32 v39, 0xffff0000, v23
    s_waitcnt vmcnt(1)
    v_fmac_f32 v32, v80, v149
    v_fmac_f32 v33, v81, v149
    v_fmac_f32 v34, v82, v149
    v_fmac_f32 v35, v83, v149
    v_fmac_f32 v36, v84, v149
    v_fmac_f32 v37, v85, v149
    v_fmac_f32 v38, v86, v149
    v_fmac_f32 v39, v87, v149
    v_cvt_pk_bf16_f32 v20, v32, v33
    v_cvt_pk_bf16_f32 v21, v34, v35
    v_cvt_pk_bf16_f32 v22, v36, v37
    v_cvt_pk_bf16_f32 v23, v38, v39
    s_mov_b64 exec, -1
    s_branch F_yb1
F_ya2:
    s_cmp_eq_u64 s[64:65], 0
    s_cbranch_scc1 F_yb2
    s_mov_b64 exec, s[64:65]
    v_lshlrev_b32 v32, 16, v24
    v_and_b32 v33, 0xffff0000, v24
    v_lshlrev_b32 v34, 16, v25
    v_and_b32 v35, 0xffff0000, v25
    v_lshlrev_b32 v36, 16, v26
    v_and_b32 v37, 0xffff0000, v26
    v_lshlrev_b32 v38, 16, v27
    v_and_b32 v39, 0xffff0000, v27
    s_waitcnt vmcnt(2)
    v_fmac_f32 v32, v88, v150
    v_fmac_f32 v33, v89, v150
    v_fmac_f32 v34, v90, v150
    v_fmac_f32 v35, v91, v150
    v_fmac_f32 v36, v92, v150
    v_fmac_f32 v37, v93, v150
    v_fmac_f32 v38, v94, v150
    v_fmac_f32 v39, v95, v150
    v_cvt_pk_bf16_f32 v24, v32, v33
    v_cvt_pk_bf16_f32 v25, v34, v35
    v_cvt_pk_bf16_f32 v26, v36, v37
    v_cvt_pk_bf16_f32 v27, v38, v39
    s_mov_b64 exec, -1
    s_branch F_yb2
F_ya3:
    s_cmp_eq_u64 s[66:67], 0
    s_cbranch_scc1 F_yb3
    s_mov_b64 exec, s[66:67]
    v_lshlrev_b32 v32, 16, v28
    v_and_b32 v33, 0xffff0000, v28
    v_lshlrev_b32 v34, 16, v29
    v_and_b32 v35, 0xffff0000, v29
    v_lshlrev_b32 v36, 16, v30
    v_and_b32 v37, 0xffff0000, v30
    v_lshlrev_b32 v38, 16, v31
    v_and_b32 v39, 0xffff0000, v31
    s_waitcnt vmcnt(3)
    v_fmac_f32 v32, v96, v151
    v_fmac_f32 v33, v97, v151
    v_fmac_f32 v34, v98, v151
    v_fmac_f32 v35, v99, v151
    v_fmac_f32 v36, v100, v151
    v_fmac_f32 v37, v101, v151
    v_fmac_f32 v38, v102, v151
    v_fmac_f32 v39, v103, v151
    v_cvt_pk_bf16_f32 v28, v32, v33
    v_cvt_pk_bf16_f32 v29, v34, v35
    v_cvt_pk_bf16_f32 v30, v36, v37
    v_cvt_pk_bf16_f32 v31, v38, v39
    s_mov_b64 exec, -1
    s_branch F_yb3
F_codeend:
.section .rodata,"a"
.p2align 6
.amdhsa_kernel parallel_sum__linear_attn_block__moe_arch_mod__prompt_kernel
  .amdhsa_next_free_vgpr 168
  .amdhsa_next_free_sgpr 96
  .amdhsa_accum_offset 168
  .amdhsa_group_segment_fixed_size 0
  .amdhsa_kernarg_size 88
  .amdhsa_user_sgpr_count 2
  .amdhsa_user_sgpr_kernarg_segment_ptr 1
  .amdhsa_system_sgpr_workgroup_id_x 1
  .amdhsa_float_denorm_mode_32 3
  .amdhsa_float_denorm_mode_16_64 3
.end_amdhsa_kernel
```

```asm
; @launch grid=(256,1,1) block=(768,1,1) lds=163840
.amdgcn_target "amdgcn-amd-amdhsa--gfx950"
.text
.globl parallel_sum__linear_attn_block__moe_arch_mod__prompt_kernel
.p2align 8
.type parallel_sum__linear_attn_block__moe_arch_mod__prompt_kernel,@function
parallel_sum__linear_attn_block__moe_arch_mod__prompt_kernel:
    s_load_dwordx4 s[4:7], s[0:1], 0
    s_load_dwordx8 s[60:67], s[0:1], 32
    s_load_dwordx2 s[72:73], s[0:1], 80
    s_load_dwordx4 s[68:71], s[0:1], 64
    s_load_dwordx2 s[8:9], s[0:1], 16
    s_cmp_ge_u32 s2, 256
    s_cbranch_scc1 F_end
    v_lshrrev_b32 v1, 6, v0
    v_and_b32 v0, 63, v0
    s_and_b32 s30, s2, 7
    v_readfirstlane_b32 s3, v1
    s_lshr_b32 s31, s2, 3
    s_and_b32 s32, s30, 1
    s_lshl_b32 s32, s32, 3
    s_and_b32 s35, s31, 7
    s_add_u32 s32, s32, s35
    s_lshr_b32 s33, s30, 1
    s_lshl_b32 s33, s33, 2
    s_lshr_b32 s34, s31, 3
    s_add_u32 s33, s33, s34
    s_lshl_b32 s28, s32, 1
    s_bfe_u32 s29, s30, 0x10001
    s_add_u32 s28, s28, s29
    s_lshl_b32 s29, s30, 2
    s_xor_b32 s29, s29, s30
    s_and_b32 s29, s29, 4
    s_add_u32 s29, s29, s34
    s_lshl_b32 s39, s29, 1
    s_xor_b32 s39, s39, 14
    s_add_u32 s10, s33, 4
    s_and_b32 s10, s10, 15
    v_lshlrev_b32 v2, 4, v0
    s_cmp_ge_u32 s3, 8
    s_cbranch_scc1 F_loader
    s_lshl_b32 s77, s32, 4
    s_add_u32 s77, s77, s33
    s_lshl_b32 s77, s77, 3
    s_add_u32 s77, s77, s3
    s_cmp_lg_u32 s3, 7
    s_cbranch_scc1 F_nt
    s_getpc_b64 s[46:47]
F_pc:
    s_sub_u32 s46, s46, F_pc-parallel_sum__linear_attn_block__moe_arch_mod__prompt_kernel
    s_subb_u32 s47, s47, 0
    s_and_b32 s44, s31, 7
    s_lshl_b32 s44, s44, 13
    v_min_u32 v60, 63, v0
    v_lshlrev_b32 v60, 7, v60
    v_add_u32 v60, s44, v60
    v_min_u32 v60, F_codeend-parallel_sum__linear_attn_block__moe_arch_mod__prompt_kernel-4, v60
    global_load_dword v161, v60, s[46:47]
F_nt:
    s_lshl_b32 s44, s77, 11
    s_waitcnt lgkmcnt(0)

    s_mov_b32 s20, s4
    s_mov_b32 s21, s5
    s_mov_b32 s22, 0x400000
    s_mov_b32 s23, 0x00020000
    buffer_load_dwordx4 v[4:7], v2, s[20:23], s44 offen
    buffer_load_dwordx4 v[8:11], v2, s[20:23], s44 offen offset:1024
    s_mov_b32 s16, s60
    s_mov_b32 s17, s61
    s_mov_b32 s18, 0x800
    s_mov_b32 s19, 0x00020000
    buffer_load_dwordx4 v[12:15], v2, s[16:19], 0 offen
    buffer_load_dwordx4 v[16:19], v2, s[16:19], 0 offen offset:1024
    s_add_u32 s24, s72, 0x800000
    s_addc_u32 s25, s73, 0
    s_mov_b32 s26, 0x100000
    s_mov_b32 s27, 0x00020000
    s_add_u32 s40, s72, 0x900000
    s_addc_u32 s41, s73, 0
    s_mov_b32 s42, 0x18000
    s_mov_b32 s43, 0x00020000
    s_mov_b32 s48, s70
    s_mov_b32 s49, s71
    s_mov_b32 s50, 0x100
    s_mov_b32 s51, 0x00020000
    v_mov_b32 v20, 0
    v_mov_b32 v21, 0
    v_mov_b32 v22, 0
    v_mov_b32 v23, 0
    s_cmp_lg_u32 s3, 5
    s_cbranch_scc1 F_a0
    s_cmp_lg_u32 s33, 0
    s_cbranch_scc1 F_a0
    s_lshl_b32 s44, s32, 8
    s_add_u32 s44, s44, 32768
    s_lshl_b32 s45, s32, 2
    s_mov_b64 exec, 0xffff
    buffer_store_dwordx4 v[20:23], v2, s[40:43], s44 offen sc0 sc1
    s_mov_b64 exec, 1
    s_waitcnt vmcnt(0)
    v_mov_b32 v24, 1
    buffer_store_dword v24, v20, s[48:51], s45 offen sc0 sc1
    s_mov_b64 exec, -1
    s_branch F_a1
F_a0:

    s_cmp_lg_u32 s3, 0
    s_cbranch_scc1 F_w2
    s_mov_b64 exec, 0
    s_branch F_k
F_w2:
    s_cmp_lg_u32 s3, 4
    s_cbranch_scc1 F_w1
    s_mov_b64 exec, 0
    s_branch F_aux
F_w0:
    s_mov_b64 exec, -1
F_w1:

    s_waitcnt vmcnt(0)
F_a1:

    v_lshlrev_b32 v24, 16, v4
    v_and_b32 v25, 0xffff0000, v4
    v_lshlrev_b32 v26, 16, v5
    v_and_b32 v27, 0xffff0000, v5
    v_lshlrev_b32 v28, 16, v6
    v_and_b32 v29, 0xffff0000, v6
    v_lshlrev_b32 v30, 16, v7
    v_and_b32 v31, 0xffff0000, v7
    v_lshlrev_b32 v32, 16, v8
    v_and_b32 v33, 0xffff0000, v8
    v_lshlrev_b32 v34, 16, v9
    v_and_b32 v35, 0xffff0000, v9
    v_lshlrev_b32 v36, 16, v10
    v_and_b32 v37, 0xffff0000, v10
    v_lshlrev_b32 v38, 16, v11
    v_and_b32 v39, 0xffff0000, v11
    v_add_f32 v40, v24, v25
    v_add_f32 v41, v26, v27
    v_add_f32 v42, v28, v29
    v_add_f32 v43, v30, v31
    v_add_f32 v44, v32, v33
    v_add_f32 v45, v34, v35
    v_add_f32 v46, v36, v37
    v_add_f32 v47, v38, v39
    v_add_f32 v40, v40, v44
    v_add_f32 v41, v41, v45
    v_add_f32 v42, v42, v46
    v_add_f32 v43, v43, v47
    v_add_f32 v40, v40, v42
    v_add_f32 v41, v41, v43
    v_add_f32 v40, v40, v41
    s_nop 1
    v_add_f32_dpp v40, v40, v40 row_shr:1 row_mask:0xf bank_mask:0xf bound_ctrl:0
    s_nop 1
    v_add_f32_dpp v40, v40, v40 row_shr:2 row_mask:0xf bank_mask:0xf bound_ctrl:0
    s_nop 1
    v_add_f32_dpp v40, v40, v40 row_shr:4 row_mask:0xf bank_mask:0xf bound_ctrl:0
    s_nop 1
    v_add_f32_dpp v40, v40, v40 row_shr:8 row_mask:0xf bank_mask:0xf bound_ctrl:0
    s_nop 1
    v_add_f32_dpp v40, v40, v40 row_bcast:15 row_mask:0xa bank_mask:0xf
    s_nop 1
    v_add_f32_dpp v40, v40, v40 row_bcast:31 row_mask:0xc bank_mask:0xf
    s_nop 0
    v_readlane_b32 s52, v40, 63
    v_mov_b32 v41, 0x3a800000
    s_nop 0
    v_mul_f32 v41, s52, v41
    v_sub_f32 v44, v24, v41
    v_sub_f32 v45, v25, v41
    v_sub_f32 v46, v26, v41
    v_sub_f32 v47, v27, v41
    v_sub_f32 v48, v28, v41
    v_sub_f32 v49, v29, v41
    v_sub_f32 v50, v30, v41
    v_sub_f32 v51, v31, v41
    v_sub_f32 v52, v32, v41
    v_sub_f32 v53, v33, v41
    v_sub_f32 v54, v34, v41
    v_sub_f32 v55, v35, v41
    v_sub_f32 v56, v36, v41
    v_sub_f32 v57, v37, v41
    v_sub_f32 v58, v38, v41
    v_sub_f32 v59, v39, v41
    v_mul_f32 v40, v44, v44
    v_mul_f32 v42, v45, v45
    v_fmac_f32 v40, v46, v46
    v_fmac_f32 v42, v47, v47
    v_fmac_f32 v40, v48, v48
    v_fmac_f32 v42, v49, v49
    v_fmac_f32 v40, v50, v50
    v_fmac_f32 v42, v51, v51
    v_fmac_f32 v40, v52, v52
    v_fmac_f32 v42, v53, v53
    v_fmac_f32 v40, v54, v54
    v_fmac_f32 v42, v55, v55
    v_fmac_f32 v40, v56, v56
    v_fmac_f32 v42, v57, v57
    v_fmac_f32 v40, v58, v58
    v_fmac_f32 v42, v59, v59
    v_add_f32 v40, v40, v42
    s_nop 1
    v_add_f32_dpp v40, v40, v40 row_shr:1 row_mask:0xf bank_mask:0xf bound_ctrl:0
    s_nop 1
    v_add_f32_dpp v40, v40, v40 row_shr:2 row_mask:0xf bank_mask:0xf bound_ctrl:0
    s_nop 1
    v_add_f32_dpp v40, v40, v40 row_shr:4 row_mask:0xf bank_mask:0xf bound_ctrl:0
    s_nop 1
    v_add_f32_dpp v40, v40, v40 row_shr:8 row_mask:0xf bank_mask:0xf bound_ctrl:0
    s_nop 1
    v_add_f32_dpp v40, v40, v40 row_bcast:15 row_mask:0xa bank_mask:0xf
    s_nop 1
    v_add_f32_dpp v40, v40, v40 row_bcast:31 row_mask:0xc bank_mask:0xf
    s_nop 0
    v_readlane_b32 s52, v40, 63
    v_mov_b32 v42, 0x3a800000
    s_nop 0
    v_mul_f32 v42, s52, v42
    v_cvt_pk_bf16_f32 v43, v41, v42
    v_lshlrev_b32 v41, 16, v43
    v_and_b32 v42, 0xffff0000, v43
    v_add_f32 v42, 0x3727c5ac, v42
    v_cvt_pk_bf16_f32 v42, v42, v42
    v_lshlrev_b32 v42, 16, v42
    v_sqrt_f32 v42, v42
    s_nop 0
    v_cvt_pk_bf16_f32 v42, v42, v42
    v_lshlrev_b32 v42, 16, v42
    v_rcp_f32 v42, v42
    v_sub_f32 v24, v24, v41
    v_sub_f32 v25, v25, v41
    v_sub_f32 v26, v26, v41
    v_sub_f32 v27, v27, v41
    v_sub_f32 v28, v28, v41
    v_sub_f32 v29, v29, v41
    v_sub_f32 v30, v30, v41
    v_sub_f32 v31, v31, v41
    v_sub_f32 v32, v32, v41
    v_sub_f32 v33, v33, v41
    v_sub_f32 v34, v34, v41
    v_sub_f32 v35, v35, v41
    v_sub_f32 v36, v36, v41
    v_sub_f32 v37, v37, v41
    v_sub_f32 v38, v38, v41
    v_sub_f32_e64 v39, v39, v41
    v_cvt_pk_bf16_f32 v4, v24, v25
    v_cvt_pk_bf16_f32 v5, v26, v27
    v_cvt_pk_bf16_f32 v6, v28, v29
    v_cvt_pk_bf16_f32 v7, v30, v31
    v_cvt_pk_bf16_f32 v8, v32, v33
    v_cvt_pk_bf16_f32 v9, v34, v35
    v_cvt_pk_bf16_f32 v10, v36, v37
    v_cvt_pk_bf16_f32 v11, v38, v39
    v_lshlrev_b32 v24, 16, v4
    v_and_b32 v25, 0xffff0000, v4
    v_lshlrev_b32 v26, 16, v5
    v_and_b32 v27, 0xffff0000, v5
    v_lshlrev_b32 v28, 16, v6
    v_and_b32 v29, 0xffff0000, v6
    v_lshlrev_b32 v30, 16, v7
    v_and_b32 v31, 0xffff0000, v7
    v_lshlrev_b32 v32, 16, v8
    v_and_b32 v33, 0xffff0000, v8
    v_lshlrev_b32 v34, 16, v9
    v_and_b32 v35, 0xffff0000, v9
    v_lshlrev_b32 v36, 16, v10
    v_and_b32 v37, 0xffff0000, v10
    v_lshlrev_b32 v38, 16, v11
    v_and_b32 v39, 0xffff0000, v11
    v_mul_f32 v24, v24, v42
    v_mul_f32 v25, v25, v42
    v_mul_f32 v26, v26, v42
    v_mul_f32 v27, v27, v42
    v_mul_f32 v28, v28, v42
    v_mul_f32 v29, v29, v42
    v_mul_f32 v30, v30, v42
    v_mul_f32 v31, v31, v42
    v_mul_f32 v32, v32, v42
    v_mul_f32 v33, v33, v42
    v_mul_f32 v34, v34, v42
    v_mul_f32 v35, v35, v42
    v_mul_f32 v36, v36, v42
    v_mul_f32 v37, v37, v42
    v_mul_f32 v38, v38, v42
    v_mul_f32 v39, v39, v42
    v_cvt_pk_bf16_f32 v4, v24, v25
    v_cvt_pk_bf16_f32 v5, v26, v27
    v_cvt_pk_bf16_f32 v6, v28, v29
    v_cvt_pk_bf16_f32 v7, v30, v31
    v_cvt_pk_bf16_f32 v8, v32, v33
    v_cvt_pk_bf16_f32 v9, v34, v35
    v_cvt_pk_bf16_f32 v10, v36, v37
    v_cvt_pk_bf16_f32 v11, v38, v39
    v_mov_b32 v40, 0
    v_mov_b32 v43, 0
    v_dot2_f32_bf16 v40, v4, v12, v40
    v_dot2_f32_bf16 v43, v5, v13, v43
    v_dot2_f32_bf16 v40, v6, v14, v40
    v_dot2_f32_bf16 v43, v7, v15, v43
    v_dot2_f32_bf16 v40, v8, v16, v40
    v_dot2_f32_bf16 v43, v9, v17, v43
    v_dot2_f32_bf16 v40, v10, v18, v40
    v_dot2_f32_bf16 v43, v11, v19, v43
    s_nop 2
    v_add_f32 v40, v40, v43
    s_nop 1
    v_add_f32_dpp v40, v40, v40 row_shr:1 row_mask:0xf bank_mask:0xf bound_ctrl:0
    s_nop 1
    v_add_f32_dpp v40, v40, v40 row_shr:2 row_mask:0xf bank_mask:0xf bound_ctrl:0
    s_nop 1
    v_add_f32_dpp v40, v40, v40 row_shr:4 row_mask:0xf bank_mask:0xf bound_ctrl:0
    s_nop 1
    v_add_f32_dpp v40, v40, v40 row_shr:8 row_mask:0xf bank_mask:0xf bound_ctrl:0
    s_nop 1
    v_add_f32_dpp v40, v40, v40 row_bcast:15 row_mask:0xa bank_mask:0xf
    s_nop 1
    v_add_f32_dpp v40, v40, v40 row_bcast:31 row_mask:0xc bank_mask:0xf
    s_nop 0
    v_readlane_b32 s52, v40, 63
    s_nop 1
    v_mov_b32 v44, s52
    v_cvt_pk_bf16_f32 v44, v44, v44
    v_and_b32 v44, 0xffff0000, v44
    v_ashrrev_i32 v45, 31, v44
    v_or_b32 v45, 0x80000000, v45
    v_xor_b32 v44, v44, v45
    v_and_b32 v44, 0xffff0000, v44
    s_sub_u32 s44, 2047, s77
    v_or_b32 v44, s44, v44
    v_xor_b32 v46, 0x80000000, v41
    v_mov_b32 v47, v42
    v_mul_f32 v48, 0x3fb8aa3b, v42
    s_lshl_b32 s44, s77, 2
    s_lshl_b32 s45, s77, 4
    s_add_u32 s45, s45, 65536
    v_mov_b32 v45, 0
    s_mov_b64 exec, 1
    buffer_store_dword v44, v45, s[40:43], s44 offen sc0 sc1
    buffer_store_dwordx3 v[46:48], v45, s[40:43], s45 offen sc0 sc1
    s_mov_b64 exec, -1

    s_cmp_ge_u32 s3, 4
    s_cbranch_scc1 F_aux
    s_branch F_k
.p2align 12
F_k:
    s_cbranch_execz F_w0
    s_nop 0
    s_setprio 2
    s_lshr_b32 s36, s3, 1
    s_and_b32 s37, s3, 1
    s_lshl_b32 s38, s36, 13
    s_lshl_b32 s42, s37, 1

    v_and_b32 v1, 15, v0
    v_lshrrev_b32 v2, 4, v0
    v_lshrrev_b32 v3, 1, v1
    v_xor_b32 v3, v3, v2
    v_lshlrev_b32 v3, 4, v3
    v_lshlrev_b32 v1, 7, v1
    v_add3_u32 v4, v1, v3, s38
    v_xor_b32 v5, 64, v4
    v_add_u32 v6, 81920, v4
    v_add_u32 v7, 81920, v5
    v_bfe_u32 v1, v0, 2, 2
    v_lshl_add_u32 v3, v2, 3, v1
    v_lshrrev_b32 v1, 1, v1
    v_and_b32 v2, 1, v2
    v_lshl_add_u32 v1, v2, 1, v1
    v_xor_b32 v1, s42, v1
    v_lshlrev_b32 v1, 5, v1
    v_lshl_add_u32 v1, v3, 7, v1
    v_and_b32 v2, 3, v0
    v_lshl_add_u32 v1, v2, 3, v1

    v_add_u32 v8, 16384, v1
    v_xor_b32 v9, 32, v8
    v_add_u32 v10, 81920, v8
    v_add_u32 v11, 81920, v9
    s_mov_b32 s40, 0x3f800008
    s_mov_b32 s41, s40
    s_mov_b32 s74, 0x358637bd
    s_mov_b32 s75, s74
    s_lshl_b32 s42, s36, 8
    s_add_u32 s42, s42, 24832
    v_and_or_b32 v164, v0, 48, s42
    v_and_b32 v165, 15, v0
    s_lshl_b32 s42, s37, 7
    s_add_u32 s42, s42, 26368
    v_lshl_add_u32 v165, v165, 2, s42
    s_lshl_b32 s42, s3, 12
    s_add_u32 s42, s42, 65536
    v_lshl_add_u32 v1, v0, 4, s42
    s_lshl_b32 s42, s3, 7
    s_add_u32 s42, s42, 27136
    v_and_or_b32 v2, v0, 48, s42
    s_lshl_b32 s42, s3, 2
    s_add_u32 s42, s42, 24640
    v_mov_b32_e64 v3, s42
    s_lshl_b32 s46, s28, 6
    s_lshl_b32 s78, s10, 1
    s_add_u32 s78, s78, s37
    s_lshl_b32 s79, s32, 18
    s_lshl_b32 s80, s36, 17
    s_add_u32 s79, s79, s80
    s_lshl_b32 s80, s78, 10
    s_add_u32 s79, s79, s80
    s_lshl_b32 s45, s32, 1
    s_add_u32 s45, s45, s36
    s_mul_i32 s45, s45, 8*64
    s_add_u32 s45, s45, 225280
    s_mul_i32 s82, s78, 4224
    s_add_u32 s83, s82, 4096
    s_lshl_b32 s50, s78, 4
    s_and_b32 s44, s32, 4-1
    s_mul_i32 s44, s44, 16/4
    s_add_u32 s50, s50, s44
    s_mul_i32 s50, s50, 64

    s_add_u32 s56, s50, 0x82f000
    s_add_u32 s56, s72, s56
    s_addc_u32 s57, s73, 0
    s_add_u32 s16, s72, 0x400000
    s_addc_u32 s17, s73, 0
    s_mov_b32 s18, 0x400000
    s_mov_b32 s19, 0x00020000
    s_add_u32 s68, s45, 0x800000
    s_add_u32 s68, s72, s68
    s_addc_u32 s69, s73, 0
    s_mov_b32 s76, 1
    s_barrier
    ds_read_b128 v[12:15], v4 offset:0
    ds_read_b64_tr_b16 v[44:45], v8 offset:8192
    ds_read_b64_tr_b16 v[46:47], v8 offset:8704
    ds_read_b128 v[28:31], v5 offset:0
    ds_read_b64_tr_b16 v[48:49], v8 offset:12288
    ds_read_b64_tr_b16 v[50:51], v8 offset:12800
    ds_read_b128 v[16:19], v4 offset:2048
    ds_read_b128 v[32:35], v5 offset:2048
    ds_read_b128 v[20:23], v4 offset:4096
    ds_read_b128 v[36:39], v5 offset:4096
    ds_read_b128 v[24:27], v4 offset:6144
    ds_read_b128 v[40:43], v5 offset:6144
    ds_read_b64_tr_b16 v[52:53], v9 offset:8192
    ds_read_b64_tr_b16 v[54:55], v9 offset:8704
    s_waitcnt lgkmcnt(11)
    v_mfma_f32_16x16x32_bf16 v[100:103], v[12:15], v[44:47], 0
    ds_read_b64_tr_b16 v[56:57], v9 offset:12288
    s_waitcnt lgkmcnt(9)
    v_mfma_f32_16x16x32_bf16 v[100:103], v[28:31], v[48:51], v[100:103]
    ds_read_b64_tr_b16 v[58:59], v9 offset:12800
    s_waitcnt lgkmcnt(9)
    v_mfma_f32_16x16x32_bf16 v[104:107], v[16:19], v[44:47], 0
    ds_read_b64_tr_b16 v[60:61], v8 offset:16384
    s_waitcnt lgkmcnt(9)
    v_mfma_f32_16x16x32_bf16 v[104:107], v[32:35], v[48:51], v[104:107]
    ds_read_b64_tr_b16 v[62:63], v8 offset:16896
    s_waitcnt lgkmcnt(9)
    v_mfma_f32_16x16x32_bf16 v[108:111], v[20:23], v[44:47], 0
    ds_read_b64_tr_b16 v[64:65], v8 offset:20480
    s_waitcnt lgkmcnt(9)
    v_mfma_f32_16x16x32_bf16 v[108:111], v[36:39], v[48:51], v[108:111]
    ds_read_b64_tr_b16 v[66:67], v8 offset:20992
    s_waitcnt lgkmcnt(9)
    v_mfma_f32_16x16x32_bf16 v[112:115], v[24:27], v[44:47], 0
    ds_read_b64_tr_b16 v[44:45], v9 offset:16384
    s_waitcnt lgkmcnt(9)
    v_mfma_f32_16x16x32_bf16 v[112:115], v[40:43], v[48:51], v[112:115]
    ds_read_b64_tr_b16 v[46:47], v9 offset:16896
    s_waitcnt lgkmcnt(8)
    v_mfma_f32_16x16x32_bf16 v[116:119], v[12:15], v[52:55], 0
    ds_read_b64_tr_b16 v[48:49], v9 offset:20480
    s_waitcnt lgkmcnt(7)
    v_mfma_f32_16x16x32_bf16 v[116:119], v[28:31], v[56:59], v[116:119]
    ds_read_b64_tr_b16 v[50:51], v9 offset:20992
    v_mfma_f32_16x16x32_bf16 v[120:123], v[16:19], v[52:55], 0
    v_mfma_f32_16x16x32_bf16 v[120:123], v[32:35], v[56:59], v[120:123]
    v_mfma_f32_16x16x32_bf16 v[124:127], v[20:23], v[52:55], 0
    v_mfma_f32_16x16x32_bf16 v[124:127], v[36:39], v[56:59], v[124:127]
    v_mfma_f32_16x16x32_bf16 v[128:131], v[24:27], v[52:55], 0
    ds_read_b64_tr_b16 v[52:53], v8 offset:0
    v_mfma_f32_16x16x32_bf16 v[128:131], v[40:43], v[56:59], v[128:131]
    ds_read_b64_tr_b16 v[54:55], v8 offset:512
    s_waitcnt lgkmcnt(5)
    v_mfma_f32_16x16x32_bf16 v[132:135], v[12:15], v[60:63], 0
    ds_read_b64_tr_b16 v[56:57], v8 offset:4096
    v_mfma_f32_16x16x32_bf16 v[132:135], v[28:31], v[64:67], v[132:135]
    ds_read_b64_tr_b16 v[58:59], v8 offset:4608
    v_mfma_f32_16x16x32_bf16 v[136:139], v[16:19], v[60:63], 0
    v_mfma_f32_16x16x32_bf16 v[136:139], v[32:35], v[64:67], v[136:139]
    v_mfma_f32_16x16x32_bf16 v[140:143], v[20:23], v[60:63], 0
    v_mfma_f32_16x16x32_bf16 v[140:143], v[36:39], v[64:67], v[140:143]
    v_mfma_f32_16x16x32_bf16 v[144:147], v[24:27], v[60:63], 0
    ds_read_b64_tr_b16 v[60:61], v9 offset:0
    v_mfma_f32_16x16x32_bf16 v[144:147], v[40:43], v[64:67], v[144:147]
    ds_read_b64_tr_b16 v[62:63], v9 offset:512
    s_waitcnt lgkmcnt(5)
    v_mfma_f32_16x16x32_bf16 v[148:151], v[12:15], v[44:47], 0
    ds_read_b64_tr_b16 v[64:65], v9 offset:4096
    v_mfma_f32_16x16x32_bf16 v[148:151], v[28:31], v[48:51], v[148:151]
    ds_read_b64_tr_b16 v[66:67], v9 offset:4608
    v_mfma_f32_16x16x32_bf16 v[152:155], v[16:19], v[44:47], 0
    v_mfma_f32_16x16x32_bf16 v[152:155], v[32:35], v[48:51], v[152:155]
    v_mfma_f32_16x16x32_bf16 v[156:159], v[20:23], v[44:47], 0
    v_mfma_f32_16x16x32_bf16 v[156:159], v[36:39], v[48:51], v[156:159]
    s_waitcnt lgkmcnt(0)
    s_barrier
    v_mfma_f32_16x16x32_bf16 v[160:163], v[24:27], v[44:47], 0
    ds_read_b64_tr_b16 v[44:45], v8 offset:49152
    v_mfma_f32_16x16x32_bf16 v[160:163], v[40:43], v[48:51], v[160:163]
    ds_read_b64_tr_b16 v[46:47], v8 offset:49664
    v_mfma_f32_16x16x32_bf16 v[68:71], v[52:55], v[12:15], 0
    ds_read_b64_tr_b16 v[48:49], v8 offset:53248
    v_mfma_f32_16x16x32_bf16 v[68:71], v[56:59], v[28:31], v[68:71]
    ds_read_b64_tr_b16 v[50:51], v8 offset:53760
    v_mfma_f32_16x16x32_bf16 v[84:87], v[60:63], v[12:15], 0
    ds_read_b128 v[12:15], v4 offset:40960
    v_mfma_f32_16x16x32_bf16 v[84:87], v[64:67], v[28:31], v[84:87]
    ds_read_b128 v[28:31], v5 offset:40960
    v_mfma_f32_16x16x32_bf16 v[72:75], v[52:55], v[16:19], 0
    v_mfma_f32_16x16x32_bf16 v[72:75], v[56:59], v[32:35], v[72:75]
    v_mfma_f32_16x16x32_bf16 v[88:91], v[60:63], v[16:19], 0
    ds_read_b128 v[16:19], v4 offset:43008
    v_mfma_f32_16x16x32_bf16 v[88:91], v[64:67], v[32:35], v[88:91]
    ds_read_b128 v[32:35], v5 offset:43008
    v_mfma_f32_16x16x32_bf16 v[76:79], v[52:55], v[20:23], 0
    v_mfma_f32_16x16x32_bf16 v[76:79], v[56:59], v[36:39], v[76:79]
    v_mfma_f32_16x16x32_bf16 v[92:95], v[60:63], v[20:23], 0
    ds_read_b128 v[20:23], v4 offset:45056
    v_mfma_f32_16x16x32_bf16 v[92:95], v[64:67], v[36:39], v[92:95]
    ds_read_b128 v[36:39], v5 offset:45056
    v_mfma_f32_16x16x32_bf16 v[80:83], v[52:55], v[24:27], 0
    ds_read_b64_tr_b16 v[52:53], v9 offset:49152
    v_mfma_f32_16x16x32_bf16 v[80:83], v[56:59], v[40:43], v[80:83]
    ds_read_b64_tr_b16 v[54:55], v9 offset:49664
    v_mfma_f32_16x16x32_bf16 v[96:99], v[60:63], v[24:27], 0
    ds_read_b128 v[24:27], v4 offset:47104
    v_mfma_f32_16x16x32_bf16 v[96:99], v[64:67], v[40:43], v[96:99]
    ds_read_b128 v[40:43], v5 offset:47104
    s_waitcnt lgkmcnt(7)
    v_mfma_f32_16x16x32_bf16 v[100:103], v[12:15], v[44:47], v[100:103]
    ds_read_b64_tr_b16 v[56:57], v9 offset:53248
    v_mfma_f32_16x16x32_bf16 v[100:103], v[28:31], v[48:51], v[100:103]
    ds_read_b64_tr_b16 v[58:59], v9 offset:53760
    v_mfma_f32_16x16x32_bf16 v[104:107], v[16:19], v[44:47], v[104:107]
    ds_read_b64_tr_b16 v[60:61], v8 offset:57344
    s_waitcnt lgkmcnt(9)
    v_mfma_f32_16x16x32_bf16 v[104:107], v[32:35], v[48:51], v[104:107]
    ds_read_b64_tr_b16 v[62:63], v8 offset:57856
    s_waitcnt lgkmcnt(9)
    v_mfma_f32_16x16x32_bf16 v[108:111], v[20:23], v[44:47], v[108:111]
    ds_read_b64_tr_b16 v[64:65], v8 offset:61440
    s_waitcnt lgkmcnt(9)
    v_mfma_f32_16x16x32_bf16 v[108:111], v[36:39], v[48:51], v[108:111]
    ds_read_b64_tr_b16 v[66:67], v8 offset:61952
    s_waitcnt lgkmcnt(7)
    v_mfma_f32_16x16x32_bf16 v[112:115], v[24:27], v[44:47], v[112:115]
    ds_read_b64_tr_b16 v[44:45], v9 offset:57344
    s_waitcnt lgkmcnt(7)
    v_mfma_f32_16x16x32_bf16 v[112:115], v[40:43], v[48:51], v[112:115]
    ds_read_b64_tr_b16 v[46:47], v9 offset:57856
    v_mfma_f32_16x16x32_bf16 v[116:119], v[12:15], v[52:55], v[116:119]
    ds_read_b64_tr_b16 v[48:49], v9 offset:61440
    s_waitcnt lgkmcnt(7)
    v_mfma_f32_16x16x32_bf16 v[116:119], v[28:31], v[56:59], v[116:119]
    ds_read_b64_tr_b16 v[50:51], v9 offset:61952
    v_mfma_f32_16x16x32_bf16 v[120:123], v[16:19], v[52:55], v[120:123]
    v_mfma_f32_16x16x32_bf16 v[120:123], v[32:35], v[56:59], v[120:123]
    v_mfma_f32_16x16x32_bf16 v[124:127], v[20:23], v[52:55], v[124:127]
    v_mfma_f32_16x16x32_bf16 v[124:127], v[36:39], v[56:59], v[124:127]
    v_mfma_f32_16x16x32_bf16 v[128:131], v[24:27], v[52:55], v[128:131]
    ds_read_b64_tr_b16 v[52:53], v8 offset:40960
    v_mfma_f32_16x16x32_bf16 v[128:131], v[40:43], v[56:59], v[128:131]
    ds_read_b64_tr_b16 v[54:55], v8 offset:41472
    s_waitcnt lgkmcnt(5)
    v_mfma_f32_16x16x32_bf16 v[132:135], v[12:15], v[60:63], v[132:135]
    ds_read_b64_tr_b16 v[56:57], v8 offset:45056
    v_mfma_f32_16x16x32_bf16 v[132:135], v[28:31], v[64:67], v[132:135]
    ds_read_b64_tr_b16 v[58:59], v8 offset:45568
    v_mfma_f32_16x16x32_bf16 v[136:139], v[16:19], v[60:63], v[136:139]
    v_mfma_f32_16x16x32_bf16 v[136:139], v[32:35], v[64:67], v[136:139]
    v_mfma_f32_16x16x32_bf16 v[140:143], v[20:23], v[60:63], v[140:143]
    v_mfma_f32_16x16x32_bf16 v[140:143], v[36:39], v[64:67], v[140:143]
    v_mfma_f32_16x16x32_bf16 v[144:147], v[24:27], v[60:63], v[144:147]
    ds_read_b64_tr_b16 v[60:61], v9 offset:40960
    v_mfma_f32_16x16x32_bf16 v[144:147], v[40:43], v[64:67], v[144:147]
    ds_read_b64_tr_b16 v[62:63], v9 offset:41472
    s_waitcnt lgkmcnt(5)
    v_mfma_f32_16x16x32_bf16 v[148:151], v[12:15], v[44:47], v[148:151]
    ds_read_b64_tr_b16 v[64:65], v9 offset:45056
    v_mfma_f32_16x16x32_bf16 v[148:151], v[28:31], v[48:51], v[148:151]
    ds_read_b64_tr_b16 v[66:67], v9 offset:45568
    v_mfma_f32_16x16x32_bf16 v[152:155], v[16:19], v[44:47], v[152:155]
    v_mfma_f32_16x16x32_bf16 v[152:155], v[32:35], v[48:51], v[152:155]
    v_mfma_f32_16x16x32_bf16 v[156:159], v[20:23], v[44:47], v[156:159]
    v_mfma_f32_16x16x32_bf16 v[156:159], v[36:39], v[48:51], v[156:159]
    s_waitcnt lgkmcnt(0)
    s_waitcnt vmcnt(0)
    s_barrier
    v_mfma_f32_16x16x32_bf16 v[160:163], v[24:27], v[44:47], v[160:163]
    ds_read_b64_tr_b16 v[44:45], v10 offset:8192
    v_mfma_f32_16x16x32_bf16 v[160:163], v[40:43], v[48:51], v[160:163]
    ds_read_b64_tr_b16 v[46:47], v10 offset:8704
    v_mfma_f32_16x16x32_bf16 v[68:71], v[52:55], v[12:15], v[68:71]
    ds_read_b64_tr_b16 v[48:49], v10 offset:12288
    v_mfma_f32_16x16x32_bf16 v[68:71], v[56:59], v[28:31], v[68:71]
    ds_read_b64_tr_b16 v[50:51], v10 offset:12800
    v_mfma_f32_16x16x32_bf16 v[84:87], v[60:63], v[12:15], v[84:87]
    ds_read_b128 v[12:15], v6 offset:0
    v_mfma_f32_16x16x32_bf16 v[84:87], v[64:67], v[28:31], v[84:87]
    ds_read_b128 v[28:31], v7 offset:0
    v_mfma_f32_16x16x32_bf16 v[72:75], v[52:55], v[16:19], v[72:75]
    v_mfma_f32_16x16x32_bf16 v[72:75], v[56:59], v[32:35], v[72:75]
    v_mfma_f32_16x16x32_bf16 v[88:91], v[60:63], v[16:19], v[88:91]
    ds_read_b128 v[16:19], v6 offset:2048
    v_mfma_f32_16x16x32_bf16 v[88:91], v[64:67], v[32:35], v[88:91]
    ds_read_b128 v[32:35], v7 offset:2048
    v_mfma_f32_16x16x32_bf16 v[76:79], v[52:55], v[20:23], v[76:79]
    v_mfma_f32_16x16x32_bf16 v[76:79], v[56:59], v[36:39], v[76:79]
    v_mfma_f32_16x16x32_bf16 v[92:95], v[60:63], v[20:23], v[92:95]
    ds_read_b128 v[20:23], v6 offset:4096
    v_mfma_f32_16x16x32_bf16 v[92:95], v[64:67], v[36:39], v[92:95]
    ds_read_b128 v[36:39], v7 offset:4096
    v_mfma_f32_16x16x32_bf16 v[80:83], v[52:55], v[24:27], v[80:83]
    ds_read_b64_tr_b16 v[52:53], v11 offset:8192
    v_mfma_f32_16x16x32_bf16 v[80:83], v[56:59], v[40:43], v[80:83]
    ds_read_b64_tr_b16 v[54:55], v11 offset:8704
    v_mfma_f32_16x16x32_bf16 v[96:99], v[60:63], v[24:27], v[96:99]
    ds_read_b128 v[24:27], v6 offset:6144
    v_mfma_f32_16x16x32_bf16 v[96:99], v[64:67], v[40:43], v[96:99]
    ds_read_b128 v[40:43], v7 offset:6144
    v_swap_b32 v4, v6
    v_swap_b32 v5, v7
    v_swap_b32 v8, v10
    v_swap_b32 v9, v11
    s_mov_b32 s81, 5
F_p1:
    s_waitcnt lgkmcnt(7)
    v_mfma_f32_16x16x32_bf16 v[100:103], v[12:15], v[44:47], v[100:103]
    ds_read_b64_tr_b16 v[56:57], v9 offset:12288
    v_mfma_f32_16x16x32_bf16 v[100:103], v[28:31], v[48:51], v[100:103]
    ds_read_b64_tr_b16 v[58:59], v9 offset:12800
    v_mfma_f32_16x16x32_bf16 v[104:107], v[16:19], v[44:47], v[104:107]
    ds_read_b64_tr_b16 v[60:61], v8 offset:16384
    s_waitcnt lgkmcnt(9)
    v_mfma_f32_16x16x32_bf16 v[104:107], v[32:35], v[48:51], v[104:107]
    ds_read_b64_tr_b16 v[62:63], v8 offset:16896
    s_waitcnt lgkmcnt(9)
    v_mfma_f32_16x16x32_bf16 v[108:111], v[20:23], v[44:47], v[108:111]
    ds_read_b64_tr_b16 v[64:65], v8 offset:20480
    s_waitcnt lgkmcnt(9)
    v_mfma_f32_16x16x32_bf16 v[108:111], v[36:39], v[48:51], v[108:111]
    ds_read_b64_tr_b16 v[66:67], v8 offset:20992
    s_waitcnt lgkmcnt(7)
    v_mfma_f32_16x16x32_bf16 v[112:115], v[24:27], v[44:47], v[112:115]
    ds_read_b64_tr_b16 v[44:45], v9 offset:16384
    s_waitcnt lgkmcnt(7)
    v_mfma_f32_16x16x32_bf16 v[112:115], v[40:43], v[48:51], v[112:115]
    ds_read_b64_tr_b16 v[46:47], v9 offset:16896
    v_mfma_f32_16x16x32_bf16 v[116:119], v[12:15], v[52:55], v[116:119]
    ds_read_b64_tr_b16 v[48:49], v9 offset:20480
    s_waitcnt lgkmcnt(7)
    v_mfma_f32_16x16x32_bf16 v[116:119], v[28:31], v[56:59], v[116:119]
    ds_read_b64_tr_b16 v[50:51], v9 offset:20992
    v_mfma_f32_16x16x32_bf16 v[120:123], v[16:19], v[52:55], v[120:123]
    v_mfma_f32_16x16x32_bf16 v[120:123], v[32:35], v[56:59], v[120:123]
    v_mfma_f32_16x16x32_bf16 v[124:127], v[20:23], v[52:55], v[124:127]
    v_mfma_f32_16x16x32_bf16 v[124:127], v[36:39], v[56:59], v[124:127]
    v_mfma_f32_16x16x32_bf16 v[128:131], v[24:27], v[52:55], v[128:131]
    ds_read_b64_tr_b16 v[52:53], v8 offset:0
    v_mfma_f32_16x16x32_bf16 v[128:131], v[40:43], v[56:59], v[128:131]
    ds_read_b64_tr_b16 v[54:55], v8 offset:512
    s_waitcnt lgkmcnt(5)
    v_mfma_f32_16x16x32_bf16 v[132:135], v[12:15], v[60:63], v[132:135]
    ds_read_b64_tr_b16 v[56:57], v8 offset:4096
    v_mfma_f32_16x16x32_bf16 v[132:135], v[28:31], v[64:67], v[132:135]
    ds_read_b64_tr_b16 v[58:59], v8 offset:4608
    v_mfma_f32_16x16x32_bf16 v[136:139], v[16:19], v[60:63], v[136:139]
    v_mfma_f32_16x16x32_bf16 v[136:139], v[32:35], v[64:67], v[136:139]
    v_mfma_f32_16x16x32_bf16 v[140:143], v[20:23], v[60:63], v[140:143]
    v_mfma_f32_16x16x32_bf16 v[140:143], v[36:39], v[64:67], v[140:143]
    v_mfma_f32_16x16x32_bf16 v[144:147], v[24:27], v[60:63], v[144:147]
    ds_read_b64_tr_b16 v[60:61], v9 offset:0
    v_mfma_f32_16x16x32_bf16 v[144:147], v[40:43], v[64:67], v[144:147]
    ds_read_b64_tr_b16 v[62:63], v9 offset:512
    s_waitcnt lgkmcnt(5)
    v_mfma_f32_16x16x32_bf16 v[148:151], v[12:15], v[44:47], v[148:151]
    ds_read_b64_tr_b16 v[64:65], v9 offset:4096
    v_mfma_f32_16x16x32_bf16 v[148:151], v[28:31], v[48:51], v[148:151]
    ds_read_b64_tr_b16 v[66:67], v9 offset:4608
    v_mfma_f32_16x16x32_bf16 v[152:155], v[16:19], v[44:47], v[152:155]
    v_mfma_f32_16x16x32_bf16 v[152:155], v[32:35], v[48:51], v[152:155]
    v_mfma_f32_16x16x32_bf16 v[156:159], v[20:23], v[44:47], v[156:159]
    v_mfma_f32_16x16x32_bf16 v[156:159], v[36:39], v[48:51], v[156:159]
    s_waitcnt lgkmcnt(0)
    s_barrier
    v_mfma_f32_16x16x32_bf16 v[160:163], v[24:27], v[44:47], v[160:163]
    ds_read_b64_tr_b16 v[44:45], v8 offset:49152
    v_mfma_f32_16x16x32_bf16 v[160:163], v[40:43], v[48:51], v[160:163]
    ds_read_b64_tr_b16 v[46:47], v8 offset:49664
    v_mfma_f32_16x16x32_bf16 v[68:71], v[52:55], v[12:15], v[68:71]
    ds_read_b64_tr_b16 v[48:49], v8 offset:53248
    v_mfma_f32_16x16x32_bf16 v[68:71], v[56:59], v[28:31], v[68:71]
    ds_read_b64_tr_b16 v[50:51], v8 offset:53760
    v_mfma_f32_16x16x32_bf16 v[84:87], v[60:63], v[12:15], v[84:87]
    ds_read_b128 v[12:15], v4 offset:40960
    v_mfma_f32_16x16x32_bf16 v[84:87], v[64:67], v[28:31], v[84:87]
    ds_read_b128 v[28:31], v5 offset:40960
    v_mfma_f32_16x16x32_bf16 v[72:75], v[52:55], v[16:19], v[72:75]
    v_mfma_f32_16x16x32_bf16 v[72:75], v[56:59], v[32:35], v[72:75]
    v_mfma_f32_16x16x32_bf16 v[88:91], v[60:63], v[16:19], v[88:91]
    ds_read_b128 v[16:19], v4 offset:43008
    v_mfma_f32_16x16x32_bf16 v[88:91], v[64:67], v[32:35], v[88:91]
    ds_read_b128 v[32:35], v5 offset:43008
    v_mfma_f32_16x16x32_bf16 v[76:79], v[52:55], v[20:23], v[76:79]
    v_mfma_f32_16x16x32_bf16 v[76:79], v[56:59], v[36:39], v[76:79]
    v_mfma_f32_16x16x32_bf16 v[92:95], v[60:63], v[20:23], v[92:95]
    ds_read_b128 v[20:23], v4 offset:45056
    v_mfma_f32_16x16x32_bf16 v[92:95], v[64:67], v[36:39], v[92:95]
    ds_read_b128 v[36:39], v5 offset:45056
    v_mfma_f32_16x16x32_bf16 v[80:83], v[52:55], v[24:27], v[80:83]
    ds_read_b64_tr_b16 v[52:53], v9 offset:49152
    v_mfma_f32_16x16x32_bf16 v[80:83], v[56:59], v[40:43], v[80:83]
    ds_read_b64_tr_b16 v[54:55], v9 offset:49664
    v_mfma_f32_16x16x32_bf16 v[96:99], v[60:63], v[24:27], v[96:99]
    ds_read_b128 v[24:27], v4 offset:47104
    v_mfma_f32_16x16x32_bf16 v[96:99], v[64:67], v[40:43], v[96:99]
    ds_read_b128 v[40:43], v5 offset:47104
    s_waitcnt lgkmcnt(7)
    v_mfma_f32_16x16x32_bf16 v[100:103], v[12:15], v[44:47], v[100:103]
    ds_read_b64_tr_b16 v[56:57], v9 offset:53248
    v_mfma_f32_16x16x32_bf16 v[100:103], v[28:31], v[48:51], v[100:103]
    ds_read_b64_tr_b16 v[58:59], v9 offset:53760
    v_mfma_f32_16x16x32_bf16 v[104:107], v[16:19], v[44:47], v[104:107]
    ds_read_b64_tr_b16 v[60:61], v8 offset:57344
    s_waitcnt lgkmcnt(9)
    v_mfma_f32_16x16x32_bf16 v[104:107], v[32:35], v[48:51], v[104:107]
    ds_read_b64_tr_b16 v[62:63], v8 offset:57856
    s_waitcnt lgkmcnt(9)
    v_mfma_f32_16x16x32_bf16 v[108:111], v[20:23], v[44:47], v[108:111]
    ds_read_b64_tr_b16 v[64:65], v8 offset:61440
    s_waitcnt lgkmcnt(9)
    v_mfma_f32_16x16x32_bf16 v[108:111], v[36:39], v[48:51], v[108:111]
    ds_read_b64_tr_b16 v[66:67], v8 offset:61952
    s_waitcnt lgkmcnt(7)
    v_mfma_f32_16x16x32_bf16 v[112:115], v[24:27], v[44:47], v[112:115]
    ds_read_b64_tr_b16 v[44:45], v9 offset:57344
    s_waitcnt lgkmcnt(7)
    v_mfma_f32_16x16x32_bf16 v[112:115], v[40:43], v[48:51], v[112:115]
    ds_read_b64_tr_b16 v[46:47], v9 offset:57856
    v_mfma_f32_16x16x32_bf16 v[116:119], v[12:15], v[52:55], v[116:119]
    ds_read_b64_tr_b16 v[48:49], v9 offset:61440
    s_waitcnt lgkmcnt(7)
    v_mfma_f32_16x16x32_bf16 v[116:119], v[28:31], v[56:59], v[116:119]
    ds_read_b64_tr_b16 v[50:51], v9 offset:61952
    v_mfma_f32_16x16x32_bf16 v[120:123], v[16:19], v[52:55], v[120:123]
    v_mfma_f32_16x16x32_bf16 v[120:123], v[32:35], v[56:59], v[120:123]
    v_mfma_f32_16x16x32_bf16 v[124:127], v[20:23], v[52:55], v[124:127]
    v_mfma_f32_16x16x32_bf16 v[124:127], v[36:39], v[56:59], v[124:127]
    v_mfma_f32_16x16x32_bf16 v[128:131], v[24:27], v[52:55], v[128:131]
    ds_read_b64_tr_b16 v[52:53], v8 offset:40960
    v_mfma_f32_16x16x32_bf16 v[128:131], v[40:43], v[56:59], v[128:131]
    ds_read_b64_tr_b16 v[54:55], v8 offset:41472
    s_waitcnt lgkmcnt(5)
    v_mfma_f32_16x16x32_bf16 v[132:135], v[12:15], v[60:63], v[132:135]
    ds_read_b64_tr_b16 v[56:57], v8 offset:45056
    v_mfma_f32_16x16x32_bf16 v[132:135], v[28:31], v[64:67], v[132:135]
    ds_read_b64_tr_b16 v[58:59], v8 offset:45568
    v_mfma_f32_16x16x32_bf16 v[136:139], v[16:19], v[60:63], v[136:139]
    v_mfma_f32_16x16x32_bf16 v[136:139], v[32:35], v[64:67], v[136:139]
    v_mfma_f32_16x16x32_bf16 v[140:143], v[20:23], v[60:63], v[140:143]
    v_mfma_f32_16x16x32_bf16 v[140:143], v[36:39], v[64:67], v[140:143]
    v_mfma_f32_16x16x32_bf16 v[144:147], v[24:27], v[60:63], v[144:147]
    ds_read_b64_tr_b16 v[60:61], v9 offset:40960
    v_mfma_f32_16x16x32_bf16 v[144:147], v[40:43], v[64:67], v[144:147]
    ds_read_b64_tr_b16 v[62:63], v9 offset:41472
    s_waitcnt lgkmcnt(5)
    v_mfma_f32_16x16x32_bf16 v[148:151], v[12:15], v[44:47], v[148:151]
    ds_read_b64_tr_b16 v[64:65], v9 offset:45056
    v_mfma_f32_16x16x32_bf16 v[148:151], v[28:31], v[48:51], v[148:151]
    ds_read_b64_tr_b16 v[66:67], v9 offset:45568
    v_mfma_f32_16x16x32_bf16 v[152:155], v[16:19], v[44:47], v[152:155]
    v_mfma_f32_16x16x32_bf16 v[152:155], v[32:35], v[48:51], v[152:155]
    v_mfma_f32_16x16x32_bf16 v[156:159], v[20:23], v[44:47], v[156:159]
    v_mfma_f32_16x16x32_bf16 v[156:159], v[36:39], v[48:51], v[156:159]
    s_waitcnt lgkmcnt(0)
    s_barrier
    v_mfma_f32_16x16x32_bf16 v[160:163], v[24:27], v[44:47], v[160:163]
    ds_read_b64_tr_b16 v[44:45], v10 offset:8192
    v_mfma_f32_16x16x32_bf16 v[160:163], v[40:43], v[48:51], v[160:163]
    ds_read_b64_tr_b16 v[46:47], v10 offset:8704
    v_mfma_f32_16x16x32_bf16 v[68:71], v[52:55], v[12:15], v[68:71]
    ds_read_b64_tr_b16 v[48:49], v10 offset:12288
    v_mfma_f32_16x16x32_bf16 v[68:71], v[56:59], v[28:31], v[68:71]
    ds_read_b64_tr_b16 v[50:51], v10 offset:12800
    v_mfma_f32_16x16x32_bf16 v[84:87], v[60:63], v[12:15], v[84:87]
    ds_read_b128 v[12:15], v6 offset:0
    v_mfma_f32_16x16x32_bf16 v[84:87], v[64:67], v[28:31], v[84:87]
    ds_read_b128 v[28:31], v7 offset:0
    v_mfma_f32_16x16x32_bf16 v[72:75], v[52:55], v[16:19], v[72:75]
    v_mfma_f32_16x16x32_bf16 v[72:75], v[56:59], v[32:35], v[72:75]
    v_mfma_f32_16x16x32_bf16 v[88:91], v[60:63], v[16:19], v[88:91]
    ds_read_b128 v[16:19], v6 offset:2048
    v_mfma_f32_16x16x32_bf16 v[88:91], v[64:67], v[32:35], v[88:91]
    ds_read_b128 v[32:35], v7 offset:2048
    v_mfma_f32_16x16x32_bf16 v[76:79], v[52:55], v[20:23], v[76:79]
    v_mfma_f32_16x16x32_bf16 v[76:79], v[56:59], v[36:39], v[76:79]
    v_mfma_f32_16x16x32_bf16 v[92:95], v[60:63], v[20:23], v[92:95]
    ds_read_b128 v[20:23], v6 offset:4096
    v_mfma_f32_16x16x32_bf16 v[92:95], v[64:67], v[36:39], v[92:95]
    ds_read_b128 v[36:39], v7 offset:4096
    v_mfma_f32_16x16x32_bf16 v[80:83], v[52:55], v[24:27], v[80:83]
    ds_read_b64_tr_b16 v[52:53], v11 offset:8192
    v_mfma_f32_16x16x32_bf16 v[80:83], v[56:59], v[40:43], v[80:83]
    ds_read_b64_tr_b16 v[54:55], v11 offset:8704
    v_mfma_f32_16x16x32_bf16 v[96:99], v[60:63], v[24:27], v[96:99]
    ds_read_b128 v[24:27], v6 offset:6144
    v_mfma_f32_16x16x32_bf16 v[96:99], v[64:67], v[40:43], v[96:99]
    ds_read_b128 v[40:43], v7 offset:6144
    v_swap_b32 v4, v6
    v_swap_b32 v5, v7
    v_swap_b32 v8, v10
    v_swap_b32 v9, v11
    s_sub_u32 s81, s81, 1
    s_cmp_lg_u32 s81, 0
    s_cbranch_scc1 F_p1
    s_waitcnt lgkmcnt(7)
    v_mfma_f32_16x16x32_bf16 v[100:103], v[12:15], v[44:47], v[100:103]
    ds_read_b64_tr_b16 v[56:57], v9 offset:12288
    v_mfma_f32_16x16x32_bf16 v[100:103], v[28:31], v[48:51], v[100:103]
    ds_read_b64_tr_b16 v[58:59], v9 offset:12800
    v_mfma_f32_16x16x32_bf16 v[104:107], v[16:19], v[44:47], v[104:107]
    ds_read_b64_tr_b16 v[60:61], v8 offset:16384
    s_waitcnt lgkmcnt(9)
    v_mfma_f32_16x16x32_bf16 v[104:107], v[32:35], v[48:51], v[104:107]
    ds_read_b64_tr_b16 v[62:63], v8 offset:16896
    s_waitcnt lgkmcnt(9)
    v_mfma_f32_16x16x32_bf16 v[108:111], v[20:23], v[44:47], v[108:111]
    ds_read_b64_tr_b16 v[64:65], v8 offset:20480
    s_waitcnt lgkmcnt(9)
    v_mfma_f32_16x16x32_bf16 v[108:111], v[36:39], v[48:51], v[108:111]
    ds_read_b64_tr_b16 v[66:67], v8 offset:20992
    s_waitcnt lgkmcnt(7)
    v_mfma_f32_16x16x32_bf16 v[112:115], v[24:27], v[44:47], v[112:115]
    ds_read_b64_tr_b16 v[44:45], v9 offset:16384
    s_waitcnt lgkmcnt(7)
    v_mfma_f32_16x16x32_bf16 v[112:115], v[40:43], v[48:51], v[112:115]
    ds_read_b64_tr_b16 v[46:47], v9 offset:16896
    v_mfma_f32_16x16x32_bf16 v[116:119], v[12:15], v[52:55], v[116:119]
    ds_read_b64_tr_b16 v[48:49], v9 offset:20480
    s_waitcnt lgkmcnt(7)
    v_mfma_f32_16x16x32_bf16 v[116:119], v[28:31], v[56:59], v[116:119]
    ds_read_b64_tr_b16 v[50:51], v9 offset:20992
    v_mfma_f32_16x16x32_bf16 v[120:123], v[16:19], v[52:55], v[120:123]
    v_mfma_f32_16x16x32_bf16 v[120:123], v[32:35], v[56:59], v[120:123]
    v_mfma_f32_16x16x32_bf16 v[124:127], v[20:23], v[52:55], v[124:127]
    v_mfma_f32_16x16x32_bf16 v[124:127], v[36:39], v[56:59], v[124:127]
    s_waitcnt lgkmcnt(0)
    s_barrier
    v_mfma_f32_16x16x32_bf16 v[128:131], v[24:27], v[52:55], v[128:131]
    ds_read_b64_tr_b16 v[52:53], v8 offset:49152
    v_mfma_f32_16x16x32_bf16 v[128:131], v[40:43], v[56:59], v[128:131]
    ds_read_b64_tr_b16 v[54:55], v8 offset:49664
    v_mfma_f32_16x16x32_bf16 v[132:135], v[12:15], v[60:63], v[132:135]
    ds_read_b64_tr_b16 v[56:57], v8 offset:53248
    v_mfma_f32_16x16x32_bf16 v[132:135], v[28:31], v[64:67], v[132:135]
    ds_read_b64_tr_b16 v[58:59], v8 offset:53760
    v_mfma_f32_16x16x32_bf16 v[148:151], v[12:15], v[44:47], v[148:151]
    ds_read_b128 v[12:15], v4 offset:40960
    v_mfma_f32_16x16x32_bf16 v[148:151], v[28:31], v[48:51], v[148:151]
    ds_read_b128 v[28:31], v5 offset:40960
    v_mfma_f32_16x16x32_bf16 v[136:139], v[16:19], v[60:63], v[136:139]
    v_mfma_f32_16x16x32_bf16 v[136:139], v[32:35], v[64:67], v[136:139]
    v_mfma_f32_16x16x32_bf16 v[152:155], v[16:19], v[44:47], v[152:155]
    ds_read_b128 v[16:19], v4 offset:43008
    v_mfma_f32_16x16x32_bf16 v[152:155], v[32:35], v[48:51], v[152:155]
    ds_read_b128 v[32:35], v5 offset:43008
    v_mfma_f32_16x16x32_bf16 v[140:143], v[20:23], v[60:63], v[140:143]
    v_mfma_f32_16x16x32_bf16 v[140:143], v[36:39], v[64:67], v[140:143]
    v_mfma_f32_16x16x32_bf16 v[156:159], v[20:23], v[44:47], v[156:159]
    ds_read_b128 v[20:23], v4 offset:45056
    v_mfma_f32_16x16x32_bf16 v[156:159], v[36:39], v[48:51], v[156:159]
    ds_read_b128 v[36:39], v5 offset:45056
    v_mfma_f32_16x16x32_bf16 v[144:147], v[24:27], v[60:63], v[144:147]
    ds_read_b64_tr_b16 v[60:61], v9 offset:49152
    v_mfma_f32_16x16x32_bf16 v[144:147], v[40:43], v[64:67], v[144:147]
    ds_read_b64_tr_b16 v[62:63], v9 offset:49664
    v_mfma_f32_16x16x32_bf16 v[160:163], v[24:27], v[44:47], v[160:163]
    ds_read_b128 v[24:27], v4 offset:47104
    v_mfma_f32_16x16x32_bf16 v[160:163], v[40:43], v[48:51], v[160:163]
    ds_read_b128 v[40:43], v5 offset:47104
    s_waitcnt lgkmcnt(7)
    v_mfma_f32_16x16x32_bf16 v[100:103], v[12:15], v[52:55], v[100:103]
    ds_read_b64_tr_b16 v[64:65], v9 offset:53248
    v_mfma_f32_16x16x32_bf16 v[100:103], v[28:31], v[56:59], v[100:103]
    ds_read_b64_tr_b16 v[66:67], v9 offset:53760
    v_mfma_f32_16x16x32_bf16 v[104:107], v[16:19], v[52:55], v[104:107]
    ds_read_b64_tr_b16 v[44:45], v8 offset:57344
    s_waitcnt lgkmcnt(9)
    v_mfma_f32_16x16x32_bf16 v[104:107], v[32:35], v[56:59], v[104:107]
    ds_read_b64_tr_b16 v[46:47], v8 offset:57856
    s_waitcnt lgkmcnt(9)
    v_mfma_f32_16x16x32_bf16 v[108:111], v[20:23], v[52:55], v[108:111]
    ds_read_b64_tr_b16 v[48:49], v8 offset:61440
    s_waitcnt lgkmcnt(9)
    v_mfma_f32_16x16x32_bf16 v[108:111], v[36:39], v[56:59], v[108:111]
    ds_read_b64_tr_b16 v[50:51], v8 offset:61952
    s_waitcnt lgkmcnt(7)
    v_mfma_f32_16x16x32_bf16 v[112:115], v[24:27], v[52:55], v[112:115]
    ds_read_b64_tr_b16 v[52:53], v9 offset:57344
    s_waitcnt lgkmcnt(7)
    v_mfma_f32_16x16x32_bf16 v[112:115], v[40:43], v[56:59], v[112:115]
    ds_read_b64_tr_b16 v[54:55], v9 offset:57856
    v_mfma_f32_16x16x32_bf16 v[116:119], v[12:15], v[60:63], v[116:119]
    ds_read_b64_tr_b16 v[56:57], v9 offset:61440
    s_waitcnt lgkmcnt(7)
    v_mfma_f32_16x16x32_bf16 v[116:119], v[28:31], v[64:67], v[116:119]
    ds_read_b64_tr_b16 v[58:59], v9 offset:61952
    v_mfma_f32_16x16x32_bf16 v[120:123], v[16:19], v[60:63], v[120:123]
    v_mfma_f32_16x16x32_bf16 v[120:123], v[32:35], v[64:67], v[120:123]
    v_mfma_f32_16x16x32_bf16 v[124:127], v[20:23], v[60:63], v[124:127]
    v_mfma_f32_16x16x32_bf16 v[124:127], v[36:39], v[64:67], v[124:127]
    s_waitcnt lgkmcnt(0)
    s_barrier
    v_mfma_f32_16x16x32_bf16 v[128:131], v[24:27], v[60:63], v[128:131]
    ds_read_b64_tr_b16 v[60:61], v10 offset:8192
W_1:
    s_cbranch_execz R_1
    s_nop 0
    v_mfma_f32_16x16x32_bf16 v[128:131], v[40:43], v[64:67], v[128:131]
    ds_read_b64_tr_b16 v[62:63], v10 offset:8704
    v_mfma_f32_16x16x32_bf16 v[132:135], v[12:15], v[44:47], v[132:135]
    ds_read_b64_tr_b16 v[64:65], v10 offset:12288
    v_mfma_f32_16x16x32_bf16 v[132:135], v[28:31], v[48:51], v[132:135]
    ds_read_b64_tr_b16 v[66:67], v10 offset:12800
    v_mfma_f32_16x16x32_bf16 v[148:151], v[12:15], v[52:55], v[148:151]
    ds_read_b128 v[12:15], v6 offset:0
    v_mfma_f32_16x16x32_bf16 v[148:151], v[28:31], v[56:59], v[148:151]
    ds_read_b128 v[28:31], v7 offset:0
    v_mfma_f32_16x16x32_bf16 v[136:139], v[16:19], v[44:47], v[136:139]
    v_mfma_f32_16x16x32_bf16 v[136:139], v[32:35], v[48:51], v[136:139]
    v_mfma_f32_16x16x32_bf16 v[152:155], v[16:19], v[52:55], v[152:155]
    ds_read_b128 v[16:19], v6 offset:2048
    v_mfma_f32_16x16x32_bf16 v[152:155], v[32:35], v[56:59], v[152:155]
    ds_read_b128 v[32:35], v7 offset:2048
    v_mfma_f32_16x16x32_bf16 v[140:143], v[20:23], v[44:47], v[140:143]
    v_mfma_f32_16x16x32_bf16 v[140:143], v[36:39], v[48:51], v[140:143]
    v_mfma_f32_16x16x32_bf16 v[156:159], v[20:23], v[52:55], v[156:159]
    ds_read_b128 v[20:23], v6 offset:4096
    v_mfma_f32_16x16x32_bf16 v[156:159], v[36:39], v[56:59], v[156:159]
    ds_read_b128 v[36:39], v7 offset:4096
    v_mfma_f32_16x16x32_bf16 v[144:147], v[24:27], v[44:47], v[144:147]
    ds_read_b64_tr_b16 v[44:45], v11 offset:8192
    v_mfma_f32_16x16x32_bf16 v[144:147], v[40:43], v[48:51], v[144:147]
    ds_read_b64_tr_b16 v[46:47], v11 offset:8704
    v_mfma_f32_16x16x32_bf16 v[160:163], v[24:27], v[52:55], v[160:163]
    ds_read_b128 v[24:27], v6 offset:6144
    v_mfma_f32_16x16x32_bf16 v[160:163], v[40:43], v[56:59], v[160:163]
    ds_read_b128 v[40:43], v7 offset:6144
    s_waitcnt lgkmcnt(7)
    v_mfma_f32_16x16x32_bf16 v[100:103], v[12:15], v[60:63], v[100:103]
    ds_read_b64_tr_b16 v[48:49], v11 offset:12288
    v_mfma_f32_16x16x32_bf16 v[100:103], v[28:31], v[64:67], v[100:103]
    ds_read_b64_tr_b16 v[50:51], v11 offset:12800
    v_mfma_f32_16x16x32_bf16 v[104:107], v[16:19], v[60:63], v[104:107]
    ds_read_b64_tr_b16 v[52:53], v10 offset:16384
    s_waitcnt lgkmcnt(9)
    v_mfma_f32_16x16x32_bf16 v[104:107], v[32:35], v[64:67], v[104:107]
    ds_read_b64_tr_b16 v[54:55], v10 offset:16896
    s_waitcnt lgkmcnt(9)
    v_mfma_f32_16x16x32_bf16 v[108:111], v[20:23], v[60:63], v[108:111]
    ds_read_b64_tr_b16 v[56:57], v10 offset:20480
    s_waitcnt lgkmcnt(9)
    v_mfma_f32_16x16x32_bf16 v[108:111], v[36:39], v[64:67], v[108:111]
    ds_read_b64_tr_b16 v[58:59], v10 offset:20992
    s_waitcnt lgkmcnt(7)
    v_mfma_f32_16x16x32_bf16 v[112:115], v[24:27], v[60:63], v[112:115]
    ds_read_b64_tr_b16 v[60:61], v11 offset:16384
    s_waitcnt lgkmcnt(7)
    v_mfma_f32_16x16x32_bf16 v[112:115], v[40:43], v[64:67], v[112:115]
    ds_read_b64_tr_b16 v[62:63], v11 offset:16896
    v_mfma_f32_16x16x32_bf16 v[116:119], v[12:15], v[44:47], v[116:119]
    ds_read_b64_tr_b16 v[64:65], v11 offset:20480
    s_waitcnt lgkmcnt(7)
    v_mfma_f32_16x16x32_bf16 v[116:119], v[28:31], v[48:51], v[116:119]
    ds_read_b64_tr_b16 v[66:67], v11 offset:20992
    v_mfma_f32_16x16x32_bf16 v[120:123], v[16:19], v[44:47], v[120:123]
    v_mfma_f32_16x16x32_bf16 v[120:123], v[32:35], v[48:51], v[120:123]
    v_mfma_f32_16x16x32_bf16 v[124:127], v[20:23], v[44:47], v[124:127]
    v_mfma_f32_16x16x32_bf16 v[124:127], v[36:39], v[48:51], v[124:127]
    s_waitcnt lgkmcnt(0)
    s_barrier
    v_mfma_f32_16x16x32_bf16 v[128:131], v[24:27], v[44:47], v[128:131]
    ds_read_b64_tr_b16 v[44:45], v10 offset:49152
    v_mfma_f32_16x16x32_bf16 v[128:131], v[40:43], v[48:51], v[128:131]
    ds_read_b64_tr_b16 v[46:47], v10 offset:49664
    v_mfma_f32_16x16x32_bf16 v[132:135], v[12:15], v[52:55], v[132:135]
    ds_read_b64_tr_b16 v[48:49], v10 offset:53248
    v_mfma_f32_16x16x32_bf16 v[132:135], v[28:31], v[56:59], v[132:135]
    ds_read_b64_tr_b16 v[50:51], v10 offset:53760
    v_mfma_f32_16x16x32_bf16 v[148:151], v[12:15], v[60:63], v[148:151]
    ds_read_b128 v[12:15], v6 offset:40960
    v_mfma_f32_16x16x32_bf16 v[148:151], v[28:31], v[64:67], v[148:151]
    ds_read_b128 v[28:31], v7 offset:40960
    v_mfma_f32_16x16x32_bf16 v[136:139], v[16:19], v[52:55], v[136:139]
    v_mfma_f32_16x16x32_bf16 v[136:139], v[32:35], v[56:59], v[136:139]
    v_mfma_f32_16x16x32_bf16 v[152:155], v[16:19], v[60:63], v[152:155]
    ds_read_b128 v[16:19], v6 offset:43008
    v_mfma_f32_16x16x32_bf16 v[152:155], v[32:35], v[64:67], v[152:155]
    ds_read_b128 v[32:35], v7 offset:43008
    v_mfma_f32_16x16x32_bf16 v[140:143], v[20:23], v[52:55], v[140:143]
    v_mfma_f32_16x16x32_bf16 v[140:143], v[36:39], v[56:59], v[140:143]
    v_mfma_f32_16x16x32_bf16 v[156:159], v[20:23], v[60:63], v[156:159]
    ds_read_b128 v[20:23], v6 offset:45056
    v_mfma_f32_16x16x32_bf16 v[156:159], v[36:39], v[64:67], v[156:159]
    ds_read_b128 v[36:39], v7 offset:45056
    v_mfma_f32_16x16x32_bf16 v[144:147], v[24:27], v[52:55], v[144:147]
    ds_read_b64_tr_b16 v[52:53], v11 offset:49152
    v_mfma_f32_16x16x32_bf16 v[144:147], v[40:43], v[56:59], v[144:147]
    ds_read_b64_tr_b16 v[54:55], v11 offset:49664
    v_mfma_f32_16x16x32_bf16 v[160:163], v[24:27], v[60:63], v[160:163]
    ds_read_b128 v[24:27], v6 offset:47104
    v_mfma_f32_16x16x32_bf16 v[160:163], v[40:43], v[64:67], v[160:163]
    ds_read_b128 v[40:43], v7 offset:47104
    s_waitcnt lgkmcnt(7)
    v_mfma_f32_16x16x32_bf16 v[100:103], v[12:15], v[44:47], v[100:103]
    ds_read_b64_tr_b16 v[56:57], v11 offset:53248
    v_mfma_f32_16x16x32_bf16 v[100:103], v[28:31], v[48:51], v[100:103]
    ds_read_b64_tr_b16 v[58:59], v11 offset:53760
    v_mfma_f32_16x16x32_bf16 v[104:107], v[16:19], v[44:47], v[104:107]
    ds_read_b64_tr_b16 v[60:61], v10 offset:57344
    s_waitcnt lgkmcnt(9)
    v_mfma_f32_16x16x32_bf16 v[104:107], v[32:35], v[48:51], v[104:107]
    ds_read_b64_tr_b16 v[62:63], v10 offset:57856
    s_waitcnt lgkmcnt(9)
    v_mfma_f32_16x16x32_bf16 v[108:111], v[20:23], v[44:47], v[108:111]
    ds_read_b64_tr_b16 v[64:65], v10 offset:61440
    s_waitcnt lgkmcnt(9)
    v_mfma_f32_16x16x32_bf16 v[108:111], v[36:39], v[48:51], v[108:111]
    ds_read_b64_tr_b16 v[66:67], v10 offset:61952
    s_waitcnt lgkmcnt(7)
    v_mfma_f32_16x16x32_bf16 v[112:115], v[24:27], v[44:47], v[112:115]
    ds_read_b64_tr_b16 v[44:45], v11 offset:57344
    s_waitcnt lgkmcnt(7)
    v_mfma_f32_16x16x32_bf16 v[112:115], v[40:43], v[48:51], v[112:115]
    ds_read_b64_tr_b16 v[46:47], v11 offset:57856
    v_mfma_f32_16x16x32_bf16 v[116:119], v[12:15], v[52:55], v[116:119]
    ds_read_b64_tr_b16 v[48:49], v11 offset:61440
    s_waitcnt lgkmcnt(7)
    v_mfma_f32_16x16x32_bf16 v[116:119], v[28:31], v[56:59], v[116:119]
    ds_read_b64_tr_b16 v[50:51], v11 offset:61952
    v_mfma_f32_16x16x32_bf16 v[120:123], v[16:19], v[52:55], v[120:123]
    v_mfma_f32_16x16x32_bf16 v[120:123], v[32:35], v[56:59], v[120:123]
    v_mfma_f32_16x16x32_bf16 v[124:127], v[20:23], v[52:55], v[124:127]
    v_mfma_f32_16x16x32_bf16 v[124:127], v[36:39], v[56:59], v[124:127]
    v_mfma_f32_16x16x32_bf16 v[128:131], v[24:27], v[52:55], v[128:131]
    ds_read2_b32 v[52:53], v165 offset0:64 offset1:64
    v_mfma_f32_16x16x32_bf16 v[128:131], v[40:43], v[56:59], v[128:131]
    ds_read2_b32 v[54:55], v165 offset0:80 offset1:80
    s_waitcnt lgkmcnt(5)
    v_mfma_f32_16x16x32_bf16 v[132:135], v[12:15], v[60:63], v[132:135]
    ds_read2_b32 v[56:57], v165 offset0:128 offset1:128
    v_mfma_f32_16x16x32_bf16 v[132:135], v[28:31], v[64:67], v[132:135]
    ds_read2_b32 v[58:59], v165 offset0:144 offset1:144
    s_waitcnt lgkmcnt(5)
    v_mfma_f32_16x16x32_bf16 v[148:151], v[12:15], v[44:47], v[148:151]
    ds_read_b128 v[12:15], v164 offset:0
    s_waitcnt lgkmcnt(5)
    v_mfma_f32_16x16x32_bf16 v[148:151], v[28:31], v[48:51], v[148:151]
    ds_read_b128 v[28:31], v164 offset:512
    v_mfma_f32_16x16x32_bf16 v[136:139], v[16:19], v[60:63], v[136:139]
    v_mfma_f32_16x16x32_bf16 v[136:139], v[32:35], v[64:67], v[136:139]
    v_mfma_f32_16x16x32_bf16 v[152:155], v[16:19], v[44:47], v[152:155]
    ds_read_b128 v[16:19], v164 offset:64
    v_mfma_f32_16x16x32_bf16 v[152:155], v[32:35], v[48:51], v[152:155]
    ds_read_b128 v[32:35], v164 offset:576
    v_mfma_f32_16x16x32_bf16 v[140:143], v[20:23], v[60:63], v[140:143]
    v_mfma_f32_16x16x32_bf16 v[140:143], v[36:39], v[64:67], v[140:143]
    v_mfma_f32_16x16x32_bf16 v[156:159], v[20:23], v[44:47], v[156:159]
    v_mfma_f32_16x16x32_bf16 v[156:159], v[36:39], v[48:51], v[156:159]
    v_mfma_f32_16x16x32_bf16 v[144:147], v[24:27], v[60:63], v[144:147]
    ds_read_b128 v[60:63], v164 offset:1024
    v_mfma_f32_16x16x32_bf16 v[144:147], v[40:43], v[64:67], v[144:147]
    ds_read_b128 v[64:67], v164 offset:1088
    v_mfma_f32_16x16x32_bf16 v[160:163], v[24:27], v[44:47], v[160:163]
    v_mfma_f32_16x16x32_bf16 v[160:163], v[40:43], v[48:51], v[160:163]
    s_mov_b32 s50, 0x10001
    s_mov_b32 s51, s50
    ds_read_b128 v[36:39], v164 offset:128
    ds_read_b128 v[40:43], v164 offset:192
    ds_read_b128 v[44:47], v164 offset:640
    ds_read_b128 v[48:51], v164 offset:704
    s_waitcnt lgkmcnt(9)
    v_pk_fma_f32 v[100:101], v[12:13], v[52:53], v[100:101]
    v_pk_fma_f32 v[102:103], v[14:15], v[52:53], v[102:103]
    s_waitcnt lgkmcnt(7)
    v_pk_fma_f32 v[104:105], v[16:17], v[52:53], v[104:105]
    v_pk_fma_f32 v[106:107], v[18:19], v[52:53], v[106:107]
    s_waitcnt lgkmcnt(5)
    v_pk_mul_f32 v[20:21], v[100:101], v[60:61]
    v_pk_mul_f32 v[22:23], v[102:103], v[62:63]
    s_waitcnt lgkmcnt(4)
    v_pk_mul_f32 v[24:25], v[104:105], v[64:65]
    v_pk_mul_f32 v[26:27], v[106:107], v[66:67]
    v_pk_fma_f32 v[100:101], v[100:101], v[28:29], s[40:41]
    v_pk_fma_f32 v[102:103], v[102:103], v[30:31], s[40:41]
    v_pk_fma_f32 v[104:105], v[104:105], v[32:33], s[40:41]
    v_pk_fma_f32 v[106:107], v[106:107], v[34:35], s[40:41]
    v_exp_f32 v20, v20 clamp
    v_exp_f32 v21, v21 clamp
    v_exp_f32 v22, v22 clamp
    v_exp_f32 v23, v23 clamp
    v_exp_f32 v24, v24 clamp
    v_exp_f32 v25, v25 clamp
    v_exp_f32 v26, v26 clamp
    v_exp_f32 v27, v27 clamp
    v_pk_add_f32 v[20:21], v[20:21], s[74:75]
    v_pk_add_f32 v[22:23], v[22:23], s[74:75]
    v_pk_add_f32 v[24:25], v[24:25], s[74:75]
    v_pk_add_f32 v[26:27], v[26:27], s[74:75]
    v_max_f32 v100, v100, v20
    v_max_f32 v101, v101, v21
    v_max_f32 v102, v102, v22
    v_max_f32 v103, v103, v23
    v_max_f32 v104, v104, v24
    v_max_f32 v105, v105, v25
    v_max_f32 v106, v106, v26
    v_max_f32 v107, v107, v27
    v_cvt_pk_bf16_f32 v100, v100, v101
    v_cvt_pk_bf16_f32 v101, v102, v103
    v_cvt_pk_bf16_f32 v102, v104, v105
    v_cvt_pk_bf16_f32 v103, v106, v107
    s_waitcnt lgkmcnt(3)
    v_pk_fma_f32 v[140:141], v[36:37], v[56:57], v[140:141]
    v_pk_fma_f32 v[142:143], v[38:39], v[56:57], v[142:143]
    s_waitcnt lgkmcnt(2)
    v_pk_fma_f32 v[144:145], v[40:41], v[56:57], v[144:145]
    v_pk_fma_f32 v[146:147], v[42:43], v[56:57], v[146:147]
    s_waitcnt lgkmcnt(1)
    v_pk_mul_f32 v[140:141], v[140:141], v[44:45]
    v_pk_mul_f32 v[142:143], v[142:143], v[46:47]
    s_waitcnt lgkmcnt(0)
    v_pk_mul_f32 v[144:145], v[144:145], v[48:49]
    v_pk_mul_f32 v[146:147], v[146:147], v[50:51]
    v_cvt_pk_bf16_f32 v140, v140, v141
    v_cvt_pk_bf16_f32 v141, v142, v143
    v_cvt_pk_bf16_f32 v142, v144, v145
    v_cvt_pk_bf16_f32 v143, v146, v147
    v_pk_fma_f32 v[156:157], v[36:37], v[58:59], v[156:157]
    v_pk_fma_f32 v[158:159], v[38:39], v[58:59], v[158:159]
    v_pk_fma_f32 v[160:161], v[40:41], v[58:59], v[160:161]
    v_pk_fma_f32 v[162:163], v[42:43], v[58:59], v[162:163]
    v_pk_mul_f32 v[156:157], v[156:157], v[44:45]
    v_pk_mul_f32 v[158:159], v[158:159], v[46:47]
    v_pk_mul_f32 v[160:161], v[160:161], v[48:49]
    v_pk_mul_f32 v[162:163], v[162:163], v[50:51]
    v_cvt_pk_bf16_f32 v156, v156, v157
    v_cvt_pk_bf16_f32 v157, v158, v159
    v_cvt_pk_bf16_f32 v158, v160, v161
    v_cvt_pk_bf16_f32 v159, v162, v163
    ds_read_b128 v[144:147], v164 offset:1152
    ds_read_b128 v[160:163], v164 offset:1216
    v_pk_fma_f32 v[132:133], v[12:13], v[56:57], v[132:133]
    v_pk_fma_f32 v[134:135], v[14:15], v[56:57], v[134:135]
    v_pk_fma_f32 v[136:137], v[16:17], v[56:57], v[136:137]
    v_pk_fma_f32 v[138:139], v[18:19], v[56:57], v[138:139]
    v_pk_mul_f32 v[132:133], v[132:133], v[28:29]
    v_pk_mul_f32 v[134:135], v[134:135], v[30:31]
    v_pk_mul_f32 v[136:137], v[136:137], v[32:33]
    v_pk_mul_f32 v[138:139], v[138:139], v[34:35]
    v_cvt_pk_bf16_f32 v132, v132, v133
    v_cvt_pk_bf16_f32 v133, v134, v135
    v_cvt_pk_bf16_f32 v134, v136, v137
    v_cvt_pk_bf16_f32 v135, v138, v139
    v_pk_fma_f32 v[148:149], v[12:13], v[58:59], v[148:149]
    v_pk_fma_f32 v[150:151], v[14:15], v[58:59], v[150:151]
    v_pk_fma_f32 v[152:153], v[16:17], v[58:59], v[152:153]
    v_pk_fma_f32 v[154:155], v[18:19], v[58:59], v[154:155]
    v_pk_mul_f32 v[148:149], v[148:149], v[28:29]
    v_pk_mul_f32 v[150:151], v[150:151], v[30:31]
    v_pk_mul_f32 v[152:153], v[152:153], v[32:33]
    v_pk_mul_f32 v[154:155], v[154:155], v[34:35]
    v_cvt_pk_bf16_f32 v148, v148, v149
    v_cvt_pk_bf16_f32 v149, v150, v151
    v_cvt_pk_bf16_f32 v150, v152, v153
    v_cvt_pk_bf16_f32 v151, v154, v155
    v_mov_b32 v56, 0x3f803f80
    v_mov_b32 v57, 0x3f803f80
    v_mov_b32 v58, 0x3f803f80
    v_mov_b32 v59, 0x3f803f80
    v_mov_b32 v164, 1
    v_mov_b32 v165, 2
    v_pk_fma_f32 v[108:109], v[36:37], v[52:53], v[108:109]
    v_pk_fma_f32 v[110:111], v[38:39], v[52:53], v[110:111]
    v_pk_fma_f32 v[112:113], v[40:41], v[52:53], v[112:113]
    v_pk_fma_f32 v[114:115], v[42:43], v[52:53], v[114:115]
    s_waitcnt lgkmcnt(1)
    v_pk_mul_f32 v[20:21], v[108:109], v[144:145]
    v_pk_mul_f32 v[22:23], v[110:111], v[146:147]
    s_waitcnt lgkmcnt(0)
    v_pk_mul_f32 v[24:25], v[112:113], v[160:161]
    v_pk_mul_f32 v[26:27], v[114:115], v[162:163]
    v_pk_fma_f32 v[108:109], v[108:109], v[44:45], s[40:41]
    v_pk_fma_f32 v[110:111], v[110:111], v[46:47], s[40:41]
    v_pk_fma_f32 v[112:113], v[112:113], v[48:49], s[40:41]
    v_pk_fma_f32 v[114:115], v[114:115], v[50:51], s[40:41]
    v_mfma_f32_16x16x32_bf16 v[136:139], v[100:103], v[132:135], 0
    v_exp_f32 v20, v20 clamp
    v_mfma_f32_16x16x32_bf16 v[152:155], v[100:103], v[148:151], 0
    v_exp_f32 v21, v21 clamp
    v_mfma_f32_16x16x32_bf16 v[104:107], v[100:103], v[56:59], 0
    v_exp_f32 v22, v22 clamp
    v_exp_f32 v23, v23 clamp
    v_exp_f32 v24, v24 clamp
    v_exp_f32 v25, v25 clamp
    v_exp_f32 v26, v26 clamp
    v_exp_f32 v27, v27 clamp
    v_pk_add_f32 v[20:21], v[20:21], s[74:75]
    v_pk_add_f32 v[22:23], v[22:23], s[74:75]
    v_pk_add_f32 v[24:25], v[24:25], s[74:75]
    v_pk_add_f32 v[26:27], v[26:27], s[74:75]
    v_max_f32 v108, v108, v20
    v_max_f32 v109, v109, v21
    v_max_f32 v110, v110, v22
    v_max_f32 v111, v111, v23
    v_max_f32 v112, v112, v24
    v_max_f32 v113, v113, v25
    v_max_f32 v114, v114, v26
    v_max_f32 v115, v115, v27
    v_cvt_pk_bf16_f32 v108, v108, v109
    v_cvt_pk_bf16_f32 v109, v110, v111
    v_cvt_pk_bf16_f32 v110, v112, v113
    v_cvt_pk_bf16_f32 v111, v114, v115
    v_pk_fma_f32 v[116:117], v[12:13], v[54:55], v[116:117]
    v_pk_fma_f32 v[118:119], v[14:15], v[54:55], v[118:119]
    v_pk_fma_f32 v[120:121], v[16:17], v[54:55], v[120:121]
    v_pk_fma_f32 v[122:123], v[18:19], v[54:55], v[122:123]
    v_pk_mul_f32 v[20:21], v[116:117], v[60:61]
    v_pk_mul_f32 v[22:23], v[118:119], v[62:63]
    v_pk_mul_f32 v[24:25], v[120:121], v[64:65]
    v_pk_mul_f32 v[26:27], v[122:123], v[66:67]
    v_pk_fma_f32 v[116:117], v[116:117], v[28:29], s[40:41]
    v_pk_fma_f32 v[118:119], v[118:119], v[30:31], s[40:41]
    v_pk_fma_f32 v[120:121], v[120:121], v[32:33], s[40:41]
    v_pk_fma_f32 v[122:123], v[122:123], v[34:35], s[40:41]
    v_mfma_f32_16x16x32_bf16 v[136:139], v[108:111], v[140:143], v[136:139]
    v_exp_f32 v20, v20 clamp
    v_mfma_f32_16x16x32_bf16 v[152:155], v[108:111], v[156:159], v[152:155]
    v_exp_f32 v21, v21 clamp
    v_mfma_f32_16x16x32_bf16 v[104:107], v[108:111], v[56:59], v[104:107]
    v_exp_f32 v22, v22 clamp
    v_exp_f32 v23, v23 clamp
    v_exp_f32 v24, v24 clamp
    v_exp_f32 v25, v25 clamp
    v_exp_f32 v26, v26 clamp
    v_exp_f32 v27, v27 clamp
    v_pk_add_f32 v[20:21], v[20:21], s[74:75]
    v_pk_add_f32 v[22:23], v[22:23], s[74:75]
    v_pk_add_f32 v[24:25], v[24:25], s[74:75]
    v_pk_add_f32 v[26:27], v[26:27], s[74:75]
    ds_write_b128 v1, v[136:139] offset:0
    ds_write_b128 v1, v[152:155] offset:1024
    s_mov_b64 exec, s[50:51]
    ds_write_b128 v2, v[104:107] offset:0
    s_mov_b64 exec, 1
    ds_write_b32 v3, v164
    s_mov_b64 exec, -1
    v_max_f32 v116, v116, v20
    v_max_f32 v117, v117, v21
    v_max_f32 v118, v118, v22
    v_max_f32 v119, v119, v23
    v_max_f32 v120, v120, v24
    v_max_f32 v121, v121, v25
    v_max_f32 v122, v122, v26
    v_max_f32_e64 v123, v123, v27
    v_cvt_pk_bf16_f32 v116, v116, v117
    v_cvt_pk_bf16_f32 v117, v118, v119
    v_cvt_pk_bf16_f32 v118, v120, v121
    v_cvt_pk_bf16_f32 v119, v122, v123
    v_pk_fma_f32 v[124:125], v[36:37], v[54:55], v[124:125]
    v_pk_fma_f32 v[126:127], v[38:39], v[54:55], v[126:127]
    v_pk_fma_f32 v[128:129], v[40:41], v[54:55], v[128:129]
    v_pk_fma_f32 v[130:131], v[42:43], v[54:55], v[130:131]
    v_pk_mul_f32 v[20:21], v[124:125], v[144:145]
    v_pk_mul_f32 v[22:23], v[126:127], v[146:147]
    v_pk_mul_f32 v[24:25], v[128:129], v[160:161]
    v_pk_mul_f32 v[26:27], v[130:131], v[162:163]
    v_pk_fma_f32 v[124:125], v[124:125], v[44:45], s[40:41]
    v_pk_fma_f32 v[126:127], v[126:127], v[46:47], s[40:41]
    v_pk_fma_f32 v[128:129], v[128:129], v[48:49], s[40:41]
    v_pk_fma_f32 v[130:131], v[130:131], v[50:51], s[40:41]
    v_mfma_f32_16x16x32_bf16 v[112:115], v[116:119], v[132:135], 0
    v_exp_f32 v20, v20 clamp
    v_mfma_f32_16x16x32_bf16 v[120:123], v[116:119], v[148:151], 0
    v_exp_f32 v21, v21 clamp
    v_mfma_f32_16x16x32_bf16 v[100:103], v[116:119], v[56:59], 0
    v_exp_f32 v22, v22 clamp
    v_exp_f32 v23, v23 clamp
    v_exp_f32 v24, v24 clamp
    v_exp_f32 v25, v25 clamp
    v_exp_f32 v26, v26 clamp
    v_exp_f32 v27, v27 clamp
    v_pk_add_f32 v[20:21], v[20:21], s[74:75]
    v_pk_add_f32 v[22:23], v[22:23], s[74:75]
    v_pk_add_f32 v[24:25], v[24:25], s[74:75]
    v_pk_add_f32 v[26:27], v[26:27], s[74:75]
    v_max_f32 v124, v124, v20
    v_max_f32 v125, v125, v21
    v_max_f32 v126, v126, v22
    v_max_f32 v127, v127, v23
    v_max_f32 v128, v128, v24
    v_max_f32 v129, v129, v25
    v_max_f32 v130, v130, v26
    v_max_f32 v131, v131, v27
    v_cvt_pk_bf16_f32 v124, v124, v125
    v_cvt_pk_bf16_f32 v125, v126, v127
    v_cvt_pk_bf16_f32 v126, v128, v129
    v_cvt_pk_bf16_f32 v127, v130, v131
    s_nop 1
    v_mfma_f32_16x16x32_bf16 v[112:115], v[124:127], v[140:143], v[112:115]
    v_mfma_f32_16x16x32_bf16 v[120:123], v[124:127], v[156:159], v[120:123]
    v_mfma_f32_16x16x32_bf16 v[100:103], v[124:127], v[56:59], v[100:103]
    ds_read_b128 v[28:31], v4 offset:0
    ds_read_b64_tr_b16 v[44:45], v8 offset:0
    ds_read_b64_tr_b16 v[46:47], v8 offset:512
    ds_read_b128 v[32:35], v4 offset:2048
    ds_read_b128 v[36:39], v4 offset:4096
    ds_read_b128 v[40:43], v4 offset:6144
    ds_write_b128 v1, v[112:115] offset:2048
    ds_write_b128 v1, v[120:123] offset:3072
    s_mov_b64 exec, s[50:51]
    ds_write_b128 v2, v[100:103] offset:64
    s_mov_b64 exec, 1
    ds_write_b32 v3, v165
    s_mov_b64 exec, -1
    ds_read_b64_tr_b16 v[48:49], v9 offset:0
    s_waitcnt lgkmcnt(8)
    ds_read_b64_tr_b16 v[50:51], v9 offset:512
    s_setprio 0
    v_and_b32 v132, 15, v0
    s_lshl_b32 s44, s36, 8
    s_add_u32 s44, s44, 24832
    v_lshl_add_u32 v132, v132, 2, s44
    v_add_u32 v133, 1024, v132
    s_lshl_b32 s44, s37, 7
    s_add_u32 s44, s44, 26368
    v_and_or_b32 v134, v0, 48, s44
    s_lshl_b32 s44, s35, 2
    s_and_b32 s47, s3, 2
    s_add_u32 s44, s44, s47
    s_lshr_b32 s44, 0xeee7eece, s44
    s_and_b32 s44, s44, 3
    s_mul_i32 s44, s44, 40960
    s_and_b32 s47, s28, 1
    s_lshl_b32 s47, s47, 13
    s_add_u32 s44, s44, s47
    s_lshl_b32 s47, s37, 6
    v_lshrrev_b32 v140, 4, v0
    v_lshlrev_b32 v140, 3, v140
    v_xor_b32 v140, s47, v140
    v_and_b32 v141, 14, v0
    v_lshlrev_b32 v141, 3, v141
    v_xor_b32 v140, v140, v141
    v_and_b32 v141, 15, v0
    v_lshlrev_b32 v141, 7, v141
    v_add3_u32 v140, v140, v141, s44
    v_xor_b32 v141, 32, v140

    s_waitcnt lgkmcnt(9)
    v_mfma_f32_16x16x32_bf16 v[68:71], v[44:47], v[28:31], v[68:71]
    ds_read_b128 v[12:15], v5 offset:0
    ds_read_b64_tr_b16 v[52:53], v8 offset:4096
    s_waitcnt lgkmcnt(10)
    v_mfma_f32_16x16x32_bf16 v[72:75], v[44:47], v[32:35], v[72:75]
    ds_read_b64_tr_b16 v[54:55], v8 offset:4608
    ds_read_b128 v[16:19], v5 offset:2048
    s_waitcnt lgkmcnt(11)
    v_mfma_f32_16x16x32_bf16 v[76:79], v[44:47], v[36:39], v[76:79]
    ds_read_b128 v[20:23], v5 offset:4096
    ds_read_b128 v[24:27], v5 offset:6144
    s_waitcnt lgkmcnt(12)
    v_mfma_f32_16x16x32_bf16 v[80:83], v[44:47], v[40:43], v[80:83]
    ds_read_b64_tr_b16 v[56:57], v9 offset:4096
    ds_read_b64_tr_b16 v[58:59], v9 offset:4608
    s_waitcnt lgkmcnt(8)
    v_mfma_f32_16x16x32_bf16 v[84:87], v[48:51], v[28:31], v[84:87]
    v_mfma_f32_16x16x32_bf16 v[88:91], v[48:51], v[32:35], v[88:91]
    v_mfma_f32_16x16x32_bf16 v[92:95], v[48:51], v[36:39], v[92:95]
    v_mfma_f32_16x16x32_bf16 v[96:99], v[48:51], v[40:43], v[96:99]
    s_waitcnt lgkmcnt(5)
    v_mfma_f32_16x16x32_bf16 v[68:71], v[52:55], v[12:15], v[68:71]
    ds_read_b128 v[28:31], v4 offset:40960
    ds_read_b64_tr_b16 v[44:45], v8 offset:40960
    s_waitcnt lgkmcnt(6)
    v_mfma_f32_16x16x32_bf16 v[72:75], v[52:55], v[16:19], v[72:75]
    ds_read_b64_tr_b16 v[46:47], v8 offset:41472
    ds_read_b128 v[32:35], v4 offset:43008
    s_waitcnt lgkmcnt(7)
    v_mfma_f32_16x16x32_bf16 v[76:79], v[52:55], v[20:23], v[76:79]
    ds_read_b128 v[36:39], v4 offset:45056
    ds_read_b128 v[40:43], v4 offset:47104
    s_waitcnt lgkmcnt(8)
    v_mfma_f32_16x16x32_bf16 v[80:83], v[52:55], v[24:27], v[80:83]
    ds_read_b64_tr_b16 v[48:49], v9 offset:40960
    ds_read_b64_tr_b16 v[50:51], v9 offset:41472
    s_waitcnt lgkmcnt(8)
    v_mfma_f32_16x16x32_bf16 v[84:87], v[56:59], v[12:15], v[84:87]
    v_mfma_f32_16x16x32_bf16 v[88:91], v[56:59], v[16:19], v[88:91]
    v_mfma_f32_16x16x32_bf16 v[92:95], v[56:59], v[20:23], v[92:95]
    v_mfma_f32_16x16x32_bf16 v[96:99], v[56:59], v[24:27], v[96:99]
    s_waitcnt lgkmcnt(5)
    v_mfma_f32_16x16x32_bf16 v[68:71], v[44:47], v[28:31], v[68:71]
    ds_read_b128 v[12:15], v5 offset:40960
    ds_read_b64_tr_b16 v[52:53], v8 offset:45056
    s_waitcnt lgkmcnt(6)
    v_mfma_f32_16x16x32_bf16 v[72:75], v[44:47], v[32:35], v[72:75]
    ds_read_b64_tr_b16 v[54:55], v8 offset:45568
    ds_read_b128 v[16:19], v5 offset:43008
    s_waitcnt lgkmcnt(7)
    v_mfma_f32_16x16x32_bf16 v[76:79], v[44:47], v[36:39], v[76:79]
    ds_read_b128 v[20:23], v5 offset:45056
    ds_read_b128 v[24:27], v5 offset:47104
    s_waitcnt lgkmcnt(8)
    v_mfma_f32_16x16x32_bf16 v[80:83], v[44:47], v[40:43], v[80:83]
    ds_read_b64_tr_b16 v[56:57], v9 offset:45056
    ds_read_b64_tr_b16 v[58:59], v9 offset:45568
    s_waitcnt lgkmcnt(8)
    v_mfma_f32_16x16x32_bf16 v[84:87], v[48:51], v[28:31], v[84:87]
    ds_read_b64 v[148:149], v140 offset:0
    ds_read_b64 v[150:151], v141 offset:0
    v_mfma_f32_16x16x32_bf16 v[88:91], v[48:51], v[32:35], v[88:91]
    ds_read_b64 v[152:153], v140 offset:2048
    ds_read_b64 v[154:155], v141 offset:2048
    v_mfma_f32_16x16x32_bf16 v[92:95], v[48:51], v[36:39], v[92:95]
    v_mfma_f32_16x16x32_bf16 v[96:99], v[48:51], v[40:43], v[96:99]
    s_waitcnt lgkmcnt(9)
    v_mfma_f32_16x16x32_bf16 v[68:71], v[52:55], v[12:15], v[68:71]
    ds_read_b128 v[28:31], v6 offset:0
    ds_read_b64_tr_b16 v[44:45], v10 offset:0
    s_waitcnt lgkmcnt(10)
    v_mfma_f32_16x16x32_bf16 v[72:75], v[52:55], v[16:19], v[72:75]
    ds_read_b64_tr_b16 v[46:47], v10 offset:512
    ds_read_b128 v[32:35], v6 offset:2048
    s_waitcnt lgkmcnt(11)
    v_mfma_f32_16x16x32_bf16 v[76:79], v[52:55], v[20:23], v[76:79]
    ds_read_b128 v[36:39], v6 offset:4096
    ds_read_b128 v[40:43], v6 offset:6144
    s_waitcnt lgkmcnt(12)
    v_mfma_f32_16x16x32_bf16 v[80:83], v[52:55], v[24:27], v[80:83]
    ds_read_b64_tr_b16 v[48:49], v11 offset:0
    ds_read_b64_tr_b16 v[50:51], v11 offset:512
    s_waitcnt lgkmcnt(12)
    v_mfma_f32_16x16x32_bf16 v[84:87], v[56:59], v[12:15], v[84:87]
    ds_read_b64 v[156:157], v140 offset:4096
    ds_read_b64 v[158:159], v141 offset:4096
    v_mfma_f32_16x16x32_bf16 v[88:91], v[56:59], v[16:19], v[88:91]
    ds_read_b64 v[160:161], v140 offset:6144
    s_waitcnt lgkmcnt(8)
    ds_read_b64 v[162:163], v141 offset:6144
    v_mfma_f32_16x16x32_bf16 v[92:95], v[56:59], v[20:23], v[92:95]
    v_mfma_f32_16x16x32_bf16 v[96:99], v[56:59], v[24:27], v[96:99]
    s_waitcnt lgkmcnt(9)
    v_mfma_f32_16x16x32_bf16 v[68:71], v[44:47], v[28:31], v[68:71]
    ds_read_b128 v[12:15], v7 offset:0
    ds_read_b64_tr_b16 v[52:53], v10 offset:4096
    s_waitcnt lgkmcnt(10)
    v_mfma_f32_16x16x32_bf16 v[72:75], v[44:47], v[32:35], v[72:75]
    ds_read_b64_tr_b16 v[54:55], v10 offset:4608
    ds_read_b128 v[16:19], v7 offset:2048
    s_waitcnt lgkmcnt(11)
    v_mfma_f32_16x16x32_bf16 v[76:79], v[44:47], v[36:39], v[76:79]
    ds_read_b128 v[20:23], v7 offset:4096
    ds_read_b128 v[24:27], v7 offset:6144
    s_waitcnt lgkmcnt(12)
    v_mfma_f32_16x16x32_bf16 v[80:83], v[44:47], v[40:43], v[80:83]
    ds_read_b64_tr_b16 v[56:57], v11 offset:4096
    ds_read_b64_tr_b16 v[58:59], v11 offset:4608
    s_waitcnt lgkmcnt(12)
    v_mfma_f32_16x16x32_bf16 v[84:87], v[48:51], v[28:31], v[84:87]
    v_mfma_f32_16x16x32_bf16 v[88:91], v[48:51], v[32:35], v[88:91]
    v_mfma_f32_16x16x32_bf16 v[92:95], v[48:51], v[36:39], v[92:95]
    v_mfma_f32_16x16x32_bf16 v[96:99], v[48:51], v[40:43], v[96:99]
    s_waitcnt lgkmcnt(5)
    v_mfma_f32_16x16x32_bf16 v[68:71], v[52:55], v[12:15], v[68:71]
    ds_read_b128 v[28:31], v6 offset:40960
    ds_read_b64_tr_b16 v[44:45], v10 offset:40960
    s_waitcnt lgkmcnt(6)
    v_mfma_f32_16x16x32_bf16 v[72:75], v[52:55], v[16:19], v[72:75]
    ds_read_b64_tr_b16 v[46:47], v10 offset:41472
    ds_read_b128 v[32:35], v6 offset:43008
    s_waitcnt lgkmcnt(7)
    v_mfma_f32_16x16x32_bf16 v[76:79], v[52:55], v[20:23], v[76:79]
    ds_read_b128 v[36:39], v6 offset:45056
    ds_read_b128 v[40:43], v6 offset:47104
    s_waitcnt lgkmcnt(8)
    v_mfma_f32_16x16x32_bf16 v[80:83], v[52:55], v[24:27], v[80:83]
    ds_read_b64_tr_b16 v[48:49], v11 offset:40960
    ds_read_b64_tr_b16 v[50:51], v11 offset:41472
    s_waitcnt lgkmcnt(8)
    v_mfma_f32_16x16x32_bf16 v[84:87], v[56:59], v[12:15], v[84:87]
    v_mfma_f32_16x16x32_bf16 v[88:91], v[56:59], v[16:19], v[88:91]
    v_mfma_f32_16x16x32_bf16 v[92:95], v[56:59], v[20:23], v[92:95]
    v_mfma_f32_16x16x32_bf16 v[96:99], v[56:59], v[24:27], v[96:99]
W_2:
    s_cbranch_execz R_2
    s_nop 0
    s_waitcnt lgkmcnt(5)
    v_mfma_f32_16x16x32_bf16 v[68:71], v[44:47], v[28:31], v[68:71]
    ds_read_b128 v[12:15], v7 offset:40960
    ds_read_b64_tr_b16 v[52:53], v10 offset:45056
    s_waitcnt lgkmcnt(6)
    v_mfma_f32_16x16x32_bf16 v[72:75], v[44:47], v[32:35], v[72:75]
    ds_read_b64_tr_b16 v[54:55], v10 offset:45568
    ds_read_b128 v[16:19], v7 offset:43008
    s_waitcnt lgkmcnt(7)
    v_mfma_f32_16x16x32_bf16 v[76:79], v[44:47], v[36:39], v[76:79]
    ds_read_b128 v[20:23], v7 offset:45056
    ds_read_b128 v[24:27], v7 offset:47104
    s_waitcnt lgkmcnt(8)
    v_mfma_f32_16x16x32_bf16 v[80:83], v[44:47], v[40:43], v[80:83]
    ds_read_b64_tr_b16 v[56:57], v11 offset:45056
    ds_read_b64_tr_b16 v[58:59], v11 offset:45568
    s_waitcnt lgkmcnt(8)
    v_mfma_f32_16x16x32_bf16 v[84:87], v[48:51], v[28:31], v[84:87]
    v_mfma_f32_16x16x32_bf16 v[88:91], v[48:51], v[32:35], v[88:91]
    v_mfma_f32_16x16x32_bf16 v[92:95], v[48:51], v[36:39], v[92:95]
    v_mfma_f32_16x16x32_bf16 v[96:99], v[48:51], v[40:43], v[96:99]
    s_waitcnt lgkmcnt(5)
    v_mfma_f32_16x16x32_bf16 v[68:71], v[52:55], v[12:15], v[68:71]
    v_mov_b32 v135, 3
    s_mov_b64 exec, 1
    ds_write_b32 v3, v135 offset:0
    s_mov_b64 exec, -1
    ds_read_b128 v[100:103], v134 offset:0
    ds_read_b128 v[104:107], v134 offset:64
    s_waitcnt lgkmcnt(7)
    v_mfma_f32_16x16x32_bf16 v[72:75], v[52:55], v[16:19], v[72:75]
    ds_read2_b32 v[108:109], v132 offset0:0 offset1:0
    ds_read2_b32 v[110:111], v132 offset0:16 offset1:16
    s_waitcnt lgkmcnt(8)
    v_mfma_f32_16x16x32_bf16 v[76:79], v[52:55], v[20:23], v[76:79]
    ds_read2_b32 v[112:113], v132 offset0:32 offset1:32
    ds_read2_b32 v[114:115], v132 offset0:48 offset1:48
    s_waitcnt lgkmcnt(9)
    v_mfma_f32_16x16x32_bf16 v[80:83], v[52:55], v[24:27], v[80:83]
    ds_read2_b32 v[124:125], v133 offset0:0 offset1:0
    ds_read2_b32 v[126:127], v133 offset0:16 offset1:16
    s_waitcnt lgkmcnt(9)
    v_mfma_f32_16x16x32_bf16 v[84:87], v[56:59], v[12:15], v[84:87]
    ds_read2_b32 v[128:129], v133 offset0:32 offset1:32
    ds_read2_b32 v[130:131], v133 offset0:48 offset1:48
    v_mfma_f32_16x16x32_bf16 v[88:91], v[56:59], v[16:19], v[88:91]
    ds_read2_b32 v[116:117], v132 offset0:128 offset1:128
    ds_read2_b32 v[118:119], v132 offset0:144 offset1:144
    v_mfma_f32_16x16x32_bf16 v[92:95], v[56:59], v[20:23], v[92:95]
    ds_read2_b32 v[120:121], v132 offset0:160 offset1:160
    ds_read2_b32 v[122:123], v132 offset0:176 offset1:176
    v_mfma_f32_16x16x32_bf16 v[96:99], v[56:59], v[24:27], v[96:99]
    s_waitcnt lgkmcnt(11)
    v_pk_fma_f32 v[68:69], v[100:101], v[108:109], v[68:69]
    v_pk_fma_f32 v[70:71], v[102:103], v[108:109], v[70:71]
    v_pk_fma_f32 v[84:85], v[104:105], v[108:109], v[84:85]
    v_pk_fma_f32 v[86:87], v[106:107], v[108:109], v[86:87]
    s_waitcnt lgkmcnt(10)
    v_pk_fma_f32 v[72:73], v[100:101], v[110:111], v[72:73]
    v_pk_fma_f32 v[74:75], v[102:103], v[110:111], v[74:75]
    v_pk_fma_f32 v[88:89], v[104:105], v[110:111], v[88:89]
    v_pk_fma_f32 v[90:91], v[106:107], v[110:111], v[90:91]
    s_waitcnt lgkmcnt(9)
    v_pk_fma_f32 v[76:77], v[100:101], v[112:113], v[76:77]
    v_pk_fma_f32 v[78:79], v[102:103], v[112:113], v[78:79]
    v_pk_fma_f32 v[92:93], v[104:105], v[112:113], v[92:93]
    v_pk_fma_f32 v[94:95], v[106:107], v[112:113], v[94:95]
    s_waitcnt lgkmcnt(8)
    v_pk_fma_f32 v[80:81], v[100:101], v[114:115], v[80:81]
    v_pk_fma_f32 v[82:83], v[102:103], v[114:115], v[82:83]
    v_pk_fma_f32 v[96:97], v[104:105], v[114:115], v[96:97]
    v_pk_fma_f32 v[98:99], v[106:107], v[114:115], v[98:99]
    s_waitcnt lgkmcnt(7)
    v_pk_mul_f32 v[12:13], v[68:69], v[124:125]
    v_pk_mul_f32 v[14:15], v[70:71], v[124:125]
    v_pk_mul_f32 v[16:17], v[84:85], v[124:125]
    v_pk_mul_f32 v[18:19], v[86:87], v[124:125]
    s_waitcnt lgkmcnt(6)
    v_pk_mul_f32 v[20:21], v[72:73], v[126:127]
    v_pk_mul_f32 v[22:23], v[74:75], v[126:127]
    v_pk_mul_f32 v[24:25], v[88:89], v[126:127]
    v_pk_mul_f32 v[26:27], v[90:91], v[126:127]
    s_waitcnt lgkmcnt(5)
    v_pk_mul_f32 v[28:29], v[76:77], v[128:129]
    v_pk_mul_f32 v[30:31], v[78:79], v[128:129]
    v_pk_mul_f32 v[32:33], v[92:93], v[128:129]
    v_pk_mul_f32 v[34:35], v[94:95], v[128:129]
    s_waitcnt lgkmcnt(4)
    v_pk_mul_f32 v[36:37], v[80:81], v[130:131]
    v_pk_mul_f32 v[38:39], v[82:83], v[130:131]
    v_pk_mul_f32 v[40:41], v[96:97], v[130:131]
    v_pk_mul_f32 v[42:43], v[98:99], v[130:131]
    s_waitcnt lgkmcnt(3)
    v_pk_fma_f32 v[68:69], v[68:69], v[116:117], s[40:41]
    v_pk_fma_f32 v[70:71], v[70:71], v[116:117], s[40:41]
    v_pk_fma_f32 v[84:85], v[84:85], v[116:117], s[40:41]
    v_pk_fma_f32 v[86:87], v[86:87], v[116:117], s[40:41]
    s_waitcnt lgkmcnt(2)
    v_pk_fma_f32 v[72:73], v[72:73], v[118:119], s[40:41]
    v_pk_fma_f32 v[74:75], v[74:75], v[118:119], s[40:41]
    v_pk_fma_f32 v[88:89], v[88:89], v[118:119], s[40:41]
    v_pk_fma_f32 v[90:91], v[90:91], v[118:119], s[40:41]
    s_waitcnt lgkmcnt(1)
    v_pk_fma_f32 v[76:77], v[76:77], v[120:121], s[40:41]
    v_pk_fma_f32 v[78:79], v[78:79], v[120:121], s[40:41]
    v_pk_fma_f32 v[92:93], v[92:93], v[120:121], s[40:41]
    v_pk_fma_f32 v[94:95], v[94:95], v[120:121], s[40:41]
    s_waitcnt lgkmcnt(0)
    v_pk_fma_f32 v[80:81], v[80:81], v[122:123], s[40:41]
    v_pk_fma_f32 v[82:83], v[82:83], v[122:123], s[40:41]
    v_pk_fma_f32 v[96:97], v[96:97], v[122:123], s[40:41]
    v_pk_fma_f32 v[98:99], v[98:99], v[122:123], s[40:41]
    v_exp_f32 v12, v12 clamp
    v_exp_f32 v13, v13 clamp
    v_exp_f32 v14, v14 clamp
    v_exp_f32 v15, v15 clamp
    v_exp_f32 v16, v16 clamp
    v_exp_f32 v17, v17 clamp
    v_exp_f32 v18, v18 clamp
    v_exp_f32 v19, v19 clamp
    v_exp_f32 v20, v20 clamp
    v_exp_f32 v21, v21 clamp
    v_exp_f32 v22, v22 clamp
    v_exp_f32 v23, v23 clamp
    v_exp_f32 v24, v24 clamp
    v_exp_f32 v25, v25 clamp
    v_exp_f32 v26, v26 clamp
    v_exp_f32 v27, v27 clamp
    v_exp_f32 v28, v28 clamp
    v_exp_f32 v29, v29 clamp
    v_exp_f32 v30, v30 clamp
    v_exp_f32 v31, v31 clamp
    v_exp_f32 v32, v32 clamp
    v_exp_f32 v33, v33 clamp
    v_exp_f32 v34, v34 clamp
    v_exp_f32 v35, v35 clamp
    v_exp_f32 v36, v36 clamp
    v_exp_f32 v37, v37 clamp
    v_exp_f32 v38, v38 clamp
    v_exp_f32 v39, v39 clamp
    v_exp_f32 v40, v40 clamp
    v_exp_f32 v41, v41 clamp
    v_exp_f32 v42, v42 clamp
    v_exp_f32 v43, v43 clamp
    v_pk_add_f32 v[12:13], v[12:13], s[74:75]
    v_pk_add_f32 v[14:15], v[14:15], s[74:75]
    v_pk_add_f32 v[16:17], v[16:17], s[74:75]
    v_pk_add_f32 v[18:19], v[18:19], s[74:75]
    v_pk_add_f32 v[20:21], v[20:21], s[74:75]
    v_pk_add_f32 v[22:23], v[22:23], s[74:75]
    v_pk_add_f32 v[24:25], v[24:25], s[74:75]
    v_pk_add_f32 v[26:27], v[26:27], s[74:75]
    v_pk_add_f32 v[28:29], v[28:29], s[74:75]
    v_pk_add_f32 v[30:31], v[30:31], s[74:75]
    v_pk_add_f32 v[32:33], v[32:33], s[74:75]
    v_pk_add_f32 v[34:35], v[34:35], s[74:75]
    v_pk_add_f32 v[36:37], v[36:37], s[74:75]
    v_pk_add_f32 v[38:39], v[38:39], s[74:75]
    v_pk_add_f32 v[40:41], v[40:41], s[74:75]
    v_pk_add_f32 v[42:43], v[42:43], s[74:75]
    v_max_f32 v68, v68, v12
    v_max_f32 v69, v69, v13
    v_max_f32 v70, v70, v14
    v_max_f32 v71, v71, v15
    v_max_f32 v84, v84, v16
    v_max_f32 v85, v85, v17
    v_max_f32 v86, v86, v18
    v_max_f32 v87, v87, v19
    v_max_f32 v72, v72, v20
    v_max_f32 v73, v73, v21
    v_max_f32 v74, v74, v22
    v_max_f32 v75, v75, v23
    v_max_f32 v88, v88, v24
    v_max_f32 v89, v89, v25
    v_max_f32 v90, v90, v26
    v_max_f32 v91, v91, v27
    v_max_f32 v76, v76, v28
    v_max_f32 v77, v77, v29
    v_max_f32 v78, v78, v30
    v_max_f32 v79, v79, v31
    v_max_f32 v92, v92, v32
    v_max_f32 v93, v93, v33
    v_max_f32 v94, v94, v34
    v_max_f32 v95, v95, v35
    v_max_f32 v80, v80, v36
    v_max_f32 v81, v81, v37
    v_max_f32 v82, v82, v38
    v_max_f32 v83, v83, v39
    v_max_f32 v96, v96, v40
    v_max_f32 v97, v97, v41
    v_max_f32 v98, v98, v42
    v_max_f32 v99, v99, v43
    v_cvt_pk_bf16_f32 v44, v68, v69
    v_cvt_pk_bf16_f32 v45, v70, v71
    v_cvt_pk_bf16_f32 v46, v84, v85
    v_cvt_pk_bf16_f32 v47, v86, v87
    v_cvt_pk_bf16_f32 v48, v72, v73
    v_cvt_pk_bf16_f32 v49, v74, v75
    v_cvt_pk_bf16_f32 v50, v88, v89
    v_cvt_pk_bf16_f32 v51, v90, v91
    v_cvt_pk_bf16_f32 v52, v76, v77
    v_cvt_pk_bf16_f32 v53, v78, v79
    v_cvt_pk_bf16_f32 v54, v92, v93
    v_cvt_pk_bf16_f32 v55, v94, v95
    v_cvt_pk_bf16_f32 v56, v80, v81
    v_cvt_pk_bf16_f32 v57, v82, v83
    v_cvt_pk_bf16_f32 v58, v96, v97
    v_cvt_pk_bf16_f32 v59, v98, v99
    s_and_b32 s44, s46, 127
    s_lshl_b32 s44, s44, 2
    s_add_u32 s44, s44, 24832
    v_and_b32 v1, 15, v0
    v_lshl_add_u32 v63, v1, 2, s44

    v_lshrrev_b32 v2, 4, v0
    v_bfe_u32 v1, v0, 2, 2
    v_lshl_add_u32 v1, v2, 2, v1
    v_and_b32 v2, 7, v1
    s_lshl_b32 s44, s3, 1
    v_xor_b32 v2, s44, v2
    v_lshlrev_b32 v2, 5, v2
    v_lshl_add_u32 v2, v1, 8, v2
    v_and_b32 v1, 3, v0
    v_lshl_add_u32 v2, v1, 3, v2
    v_add_u32 v128, 65536, v2
    v_xor_b32 v129, 32, v128
    v_add_u32 v130, 122880, v2
    v_xor_b32 v131, 32, v130
    v_lshlrev_b32_e64 v2, 2, v1
    v_add_u32 v2, 24672, v2

    ds_read2_b32 v[4:5], v63 offset0:0 offset1:0
    ds_read2_b32 v[6:7], v63 offset0:16 offset1:16
    ds_read2_b32 v[8:9], v63 offset0:32 offset1:32
    ds_read2_b32 v[10:11], v63 offset0:48 offset1:48
    ds_read2_b32 v[12:13], v63 offset0:128 offset1:128
    ds_read2_b32 v[14:15], v63 offset0:144 offset1:144
    ds_read2_b32 v[16:17], v63 offset0:160 offset1:160
    ds_read2_b32 v[18:19], v63 offset0:176 offset1:176
    v_lshlrev_b32 v60, 4, v0
    v_and_b32 v61, 48, v0
    s_setprio 2
SP_1:
    s_load_dword s58, s[56:57], 0 glc
    s_waitcnt lgkmcnt(0)
    s_cmp_ge_u32 s58, 32
    s_cbranch_scc1 SD_2
    s_sleep 1
    s_branch SP_1
SD_2:
F_kp:
    buffer_load_dwordx4 v[36:39], v61, s[24:27], s83 offen offset:0 sc0 sc1
    buffer_load_dwordx4 v[40:43], v61, s[24:27], s83 offen offset:64 sc0 sc1
    buffer_load_dwordx4 v[20:23], v60, s[24:27], s82 offen offset:0 sc0 sc1
    buffer_load_dwordx4 v[24:27], v60, s[24:27], s82 offen offset:2048 sc0 sc1
    buffer_load_dwordx4 v[28:31], v60, s[24:27], s82 offen offset:1024 sc0 sc1
    buffer_load_dwordx4 v[32:35], v60, s[24:27], s82 offen offset:3072 sc0 sc1
    v_mov_b32 v62, 4
    s_mov_b64 exec, 1
    ds_write_b32 v3, v62 offset:0
    s_mov_b64 exec, -1
    s_waitcnt vmcnt(4)
    v_cvt_pk_bf16_f32 v124, v36, v37
    v_cvt_pk_bf16_f32 v125, v38, v39
    v_cvt_pk_bf16_f32 v126, v40, v41
    v_cvt_pk_bf16_f32 v127, v42, v43
    s_nop 1
    v_mfma_f32_16x16x32_bf16 v[76:79], v[124:127], v[44:47], 0
    v_mfma_f32_16x16x32_bf16 v[88:91], v[124:127], v[48:51], 0
    v_mfma_f32_16x16x32_bf16 v[100:103], v[124:127], v[52:55], 0
    v_mfma_f32_16x16x32_bf16 v[112:115], v[124:127], v[56:59], 0
    s_waitcnt vmcnt(2)
    v_cvt_pk_bf16_f32 v116, v20, v21
    v_cvt_pk_bf16_f32 v117, v22, v23
    v_cvt_pk_bf16_f32 v118, v24, v25
    v_cvt_pk_bf16_f32 v119, v26, v27
    s_nop 1
    v_mfma_f32_16x16x32_bf16 v[68:71], v[116:119], v[44:47], 0
    v_mfma_f32_16x16x32_bf16 v[80:83], v[116:119], v[48:51], 0
    v_mfma_f32_16x16x32_bf16 v[92:95], v[116:119], v[52:55], 0
    v_mfma_f32_16x16x32_bf16 v[104:107], v[116:119], v[56:59], 0
    v_add_f32 v76, s74, v76
    v_rcp_f32 v76, v76
    s_nop 0
    v_mov_b32 v77, v76
    v_add_f32 v88, s74, v88
    v_rcp_f32 v88, v88
    s_nop 0
    v_mov_b32 v89, v88
    v_add_f32 v100, s74, v100
    v_rcp_f32 v100, v100
    s_nop 0
    v_mov_b32 v101, v100
    v_add_f32 v112, s74, v112
    v_rcp_f32 v112, v112
    s_nop 0
    v_mov_b32_e64 v113, v112
    s_waitcnt vmcnt(0)
    v_cvt_pk_bf16_f32 v120, v28, v29
    v_cvt_pk_bf16_f32 v121, v30, v31
    v_cvt_pk_bf16_f32 v122, v32, v33
    v_cvt_pk_bf16_f32 v123, v34, v35
    s_nop 1
    v_mfma_f32_16x16x32_bf16 v[72:75], v[120:123], v[44:47], 0
    v_mfma_f32_16x16x32_bf16 v[84:87], v[120:123], v[48:51], 0
    v_mfma_f32_16x16x32_bf16 v[96:99], v[120:123], v[52:55], 0
    v_mfma_f32_16x16x32_bf16 v[108:111], v[120:123], v[56:59], 0
    s_add_u32 s80, s79, 0
    v_pk_mul_f32 v[68:69], v[68:69], v[76:77]
    v_pk_mul_f32 v[70:71], v[70:71], v[76:77]
    s_nop 1
    v_pk_mul_f32 v[72:73], v[72:73], v[76:77]
    v_pk_mul_f32 v[74:75], v[74:75], v[76:77]
    v_cvt_pk_bf16_f32 v28, v68, v69
    v_cvt_pk_bf16_f32 v29, v70, v71
    v_cvt_pk_bf16_f32 v30, v72, v73
    v_cvt_pk_bf16_f32 v31, v74, v75
    buffer_store_dwordx4 v[28:31], v60, s[16:19], s80 offen sc0 sc1
    s_add_u32 s80, s79, 32768
    v_pk_mul_f32 v[80:81], v[80:81], v[88:89]
    v_pk_mul_f32 v[82:83], v[82:83], v[88:89]
    v_pk_mul_f32 v[84:85], v[84:85], v[88:89]
    v_pk_mul_f32 v[86:87], v[86:87], v[88:89]
    v_cvt_pk_bf16_f32 v32, v80, v81
    v_cvt_pk_bf16_f32 v33, v82, v83
    v_cvt_pk_bf16_f32 v34, v84, v85
    v_cvt_pk_bf16_f32 v35, v86, v87
    buffer_store_dwordx4 v[32:35], v60, s[16:19], s80 offen sc0 sc1
    s_add_u32 s80, s79, 65536
    v_pk_mul_f32 v[92:93], v[92:93], v[100:101]
    v_pk_mul_f32 v[94:95], v[94:95], v[100:101]
    v_pk_mul_f32 v[96:97], v[96:97], v[100:101]
    v_pk_mul_f32 v[98:99], v[98:99], v[100:101]
    v_cvt_pk_bf16_f32 v36, v92, v93
    v_cvt_pk_bf16_f32 v37, v94, v95
    v_cvt_pk_bf16_f32 v38, v96, v97
    v_cvt_pk_bf16_f32 v39, v98, v99
    buffer_store_dwordx4 v[36:39], v60, s[16:19], s80 offen sc0 sc1
    s_add_u32 s80, s79, 98304
    v_pk_mul_f32 v[104:105], v[104:105], v[112:113]
    v_pk_mul_f32 v[106:107], v[106:107], v[112:113]
    v_pk_mul_f32 v[108:109], v[108:109], v[112:113]
    v_pk_mul_f32 v[110:111], v[110:111], v[112:113]
    v_cvt_pk_bf16_f32 v40, v104, v105
    v_cvt_pk_bf16_f32 v41, v106, v107
    v_cvt_pk_bf16_f32 v42, v108, v109
    v_cvt_pk_bf16_f32 v43, v110, v111
    buffer_store_dwordx4 v[40:43], v60, s[16:19], s80 offen sc0 sc1
    v_lshlrev_b32 v132, 16, v148
    v_and_b32 v133, 0xffff0000, v148
    v_lshlrev_b32 v134, 16, v149
    v_and_b32 v135, 0xffff0000, v149
    v_lshlrev_b32 v136, 16, v150
    v_and_b32 v137, 0xffff0000, v150
    v_lshlrev_b32 v138, 16, v151
    v_and_b32 v139, 0xffff0000, v151
    v_pk_add_f32 v[76:77], v[132:133], v[4:5]
    v_pk_add_f32 v[78:79], v[134:135], v[4:5]
    v_pk_add_f32 v[80:81], v[136:137], v[4:5]
    v_pk_add_f32 v[82:83], v[138:139], v[4:5]
    v_cvt_pk_bf16_f32 v72, v76, v77
    v_cvt_pk_bf16_f32 v73, v78, v79
    v_cvt_pk_bf16_f32 v74, v80, v81
    v_cvt_pk_bf16_f32 v75, v82, v83
    v_lshlrev_b32 v76, 16, v72
    v_and_b32 v77, 0xffff0000, v72
    v_lshlrev_b32 v78, 16, v73
    v_and_b32 v79, 0xffff0000, v73
    v_lshlrev_b32 v80, 16, v74
    v_and_b32 v81, 0xffff0000, v74
    v_lshlrev_b32 v82, 16, v75
    v_and_b32 v83, 0xffff0000, v75
    v_pk_mul_f32 v[76:77], v[76:77], v[12:13]
    v_pk_mul_f32 v[78:79], v[78:79], v[12:13]
    v_pk_mul_f32 v[80:81], v[80:81], v[12:13]
    v_pk_mul_f32 v[82:83], v[82:83], v[12:13]
    v_cvt_pk_bf16_f32 v72, v76, v77
    v_cvt_pk_bf16_f32 v73, v78, v79
    v_cvt_pk_bf16_f32 v74, v80, v81
    v_cvt_pk_bf16_f32 v75, v82, v83
    v_lshlrev_b32 v76, 16, v72
    v_and_b32 v77, 0xffff0000, v72
    v_lshlrev_b32 v78, 16, v73
    v_and_b32 v79, 0xffff0000, v73
    v_lshlrev_b32 v80, 16, v74
    v_and_b32 v81, 0xffff0000, v74
    v_lshlrev_b32 v82, 16, v75
    v_and_b32 v83, 0xffff0000, v75
    v_pk_add_f32 v[132:133], v[132:133], v[76:77]
    v_pk_add_f32 v[134:135], v[134:135], v[78:79]
    v_pk_add_f32 v[136:137], v[136:137], v[80:81]
    v_pk_add_f32 v[138:139], v[138:139], v[82:83]
    v_lshlrev_b32 v140, 16, v152
    v_and_b32 v141, 0xffff0000, v152
    v_lshlrev_b32 v142, 16, v153
    v_and_b32 v143, 0xffff0000, v153
    v_lshlrev_b32 v144, 16, v154
    v_and_b32 v145, 0xffff0000, v154
    v_lshlrev_b32 v146, 16, v155
    v_and_b32 v147, 0xffff0000, v155
    v_pk_add_f32 v[76:77], v[140:141], v[6:7]
    v_pk_add_f32 v[78:79], v[142:143], v[6:7]
    v_pk_add_f32 v[80:81], v[144:145], v[6:7]
    v_pk_add_f32 v[82:83], v[146:147], v[6:7]
    v_cvt_pk_bf16_f32 v72, v76, v77
    v_cvt_pk_bf16_f32 v73, v78, v79
    v_cvt_pk_bf16_f32 v74, v80, v81
    v_cvt_pk_bf16_f32 v75, v82, v83
    v_lshlrev_b32 v76, 16, v72
    v_and_b32 v77, 0xffff0000, v72
    v_lshlrev_b32 v78, 16, v73
    v_and_b32 v79, 0xffff0000, v73
    v_lshlrev_b32 v80, 16, v74
    v_and_b32 v81, 0xffff0000, v74
    v_lshlrev_b32 v82, 16, v75
    v_and_b32 v83, 0xffff0000, v75
    v_pk_mul_f32 v[76:77], v[76:77], v[14:15]
    v_pk_mul_f32 v[78:79], v[78:79], v[14:15]
    v_pk_mul_f32 v[80:81], v[80:81], v[14:15]
    v_pk_mul_f32 v[82:83], v[82:83], v[14:15]
    v_cvt_pk_bf16_f32 v72, v76, v77
    v_cvt_pk_bf16_f32 v73, v78, v79
    v_cvt_pk_bf16_f32 v74, v80, v81
    v_cvt_pk_bf16_f32 v75, v82, v83
    v_lshlrev_b32 v76, 16, v72
    v_and_b32 v77, 0xffff0000, v72
    v_lshlrev_b32 v78, 16, v73
    v_and_b32 v79, 0xffff0000, v73
    v_lshlrev_b32 v80, 16, v74
    v_and_b32 v81, 0xffff0000, v74
    v_lshlrev_b32 v82, 16, v75
    v_and_b32 v83, 0xffff0000, v75
    v_pk_add_f32 v[140:141], v[140:141], v[76:77]
    v_pk_add_f32 v[142:143], v[142:143], v[78:79]
    v_pk_add_f32 v[144:145], v[144:145], v[80:81]
    v_pk_add_f32 v[146:147], v[146:147], v[82:83]
    v_mov_b32 v62, 5
    s_waitcnt vmcnt(0)
    s_atomic_add s76, s[68:69], 0
    s_atomic_add s76, s[68:69], 128
    s_atomic_add s76, s[68:69], 256
    s_atomic_add s76, s[68:69], 384
    s_mov_b64 exec, 1
    ds_write_b32 v3, v62
    s_mov_b64 exec, -1
    s_setprio 0
    v_lshlrev_b32 v148, 16, v156
    v_and_b32 v149, 0xffff0000, v156
    v_lshlrev_b32 v150, 16, v157
    v_and_b32 v151, 0xffff0000, v157
    v_lshlrev_b32 v152, 16, v158
    v_and_b32 v153, 0xffff0000, v158
    v_lshlrev_b32_e64 v154, 16, v159
    v_and_b32 v155, 0xffff0000, v159
    v_pk_add_f32 v[76:77], v[148:149], v[8:9]
    v_pk_add_f32 v[78:79], v[150:151], v[8:9]
    v_pk_add_f32 v[80:81], v[152:153], v[8:9]
    v_pk_add_f32 v[82:83], v[154:155], v[8:9]
    v_cvt_pk_bf16_f32 v72, v76, v77
    v_cvt_pk_bf16_f32 v73, v78, v79
    v_cvt_pk_bf16_f32 v74, v80, v81
    v_cvt_pk_bf16_f32 v75, v82, v83
    v_lshlrev_b32 v76, 16, v72
    v_and_b32 v77, 0xffff0000, v72
    v_lshlrev_b32 v78, 16, v73
    v_and_b32 v79, 0xffff0000, v73
    v_lshlrev_b32 v80, 16, v74
    v_and_b32 v81, 0xffff0000, v74
    v_lshlrev_b32 v82, 16, v75
    v_and_b32 v83, 0xffff0000, v75
    v_pk_mul_f32 v[76:77], v[76:77], v[16:17]
    v_pk_mul_f32 v[78:79], v[78:79], v[16:17]
    v_pk_mul_f32 v[80:81], v[80:81], v[16:17]
    v_pk_mul_f32 v[82:83], v[82:83], v[16:17]
    v_cvt_pk_bf16_f32 v72, v76, v77
    v_cvt_pk_bf16_f32 v73, v78, v79
    v_cvt_pk_bf16_f32 v74, v80, v81
    v_cvt_pk_bf16_f32 v75, v82, v83
    v_lshlrev_b32 v76, 16, v72
    v_and_b32 v77, 0xffff0000, v72
    v_lshlrev_b32 v78, 16, v73
    v_and_b32 v79, 0xffff0000, v73
    v_lshlrev_b32 v80, 16, v74
    v_and_b32 v81, 0xffff0000, v74
    v_lshlrev_b32 v82, 16, v75
    v_and_b32 v83, 0xffff0000, v75
    v_pk_add_f32 v[148:149], v[148:149], v[76:77]
    v_pk_add_f32 v[150:151], v[150:151], v[78:79]
    v_pk_add_f32 v[152:153], v[152:153], v[80:81]
    v_pk_add_f32 v[154:155], v[154:155], v[82:83]
    v_lshlrev_b32 v156, 16, v160
    v_and_b32 v157, 0xffff0000, v160
    v_lshlrev_b32 v158, 16, v161
    v_and_b32 v159, 0xffff0000, v161
    v_lshlrev_b32 v160, 16, v162
    v_and_b32 v161, 0xffff0000, v162
    v_lshlrev_b32 v162, 16, v163
    v_and_b32 v163, 0xffff0000, v163
    v_pk_add_f32 v[76:77], v[156:157], v[10:11]
    v_pk_add_f32 v[78:79], v[158:159], v[10:11]
    v_pk_add_f32 v[80:81], v[160:161], v[10:11]
    v_pk_add_f32 v[82:83], v[162:163], v[10:11]
    v_cvt_pk_bf16_f32 v72, v76, v77
    v_cvt_pk_bf16_f32 v73, v78, v79
    v_cvt_pk_bf16_f32 v74, v80, v81
    v_cvt_pk_bf16_f32 v75, v82, v83
    v_lshlrev_b32 v76, 16, v72
    v_and_b32 v77, 0xffff0000, v72
    v_lshlrev_b32 v78, 16, v73
    v_and_b32 v79, 0xffff0000, v73
    v_lshlrev_b32 v80, 16, v74
    v_and_b32 v81, 0xffff0000, v74
    v_lshlrev_b32 v82, 16, v75
    v_and_b32 v83, 0xffff0000, v75
    v_pk_mul_f32 v[76:77], v[76:77], v[18:19]
    v_pk_mul_f32 v[78:79], v[78:79], v[18:19]
    v_pk_mul_f32 v[80:81], v[80:81], v[18:19]
    v_pk_mul_f32 v[82:83], v[82:83], v[18:19]
    v_cvt_pk_bf16_f32 v72, v76, v77
    v_cvt_pk_bf16_f32 v73, v78, v79
    v_cvt_pk_bf16_f32 v74, v80, v81
    v_cvt_pk_bf16_f32 v75, v82, v83
    v_lshlrev_b32 v76, 16, v72
    v_and_b32 v77, 0xffff0000, v72
    v_lshlrev_b32 v78, 16, v73
    v_and_b32 v79, 0xffff0000, v73
    v_lshlrev_b32 v80, 16, v74
    v_and_b32 v81, 0xffff0000, v74
    v_lshlrev_b32 v82, 16, v75
    v_and_b32 v83, 0xffff0000, v75
    v_pk_add_f32 v[156:157], v[156:157], v[76:77]
    v_pk_add_f32 v[158:159], v[158:159], v[78:79]
    v_pk_add_f32 v[160:161], v[160:161], v[80:81]
    v_pk_add_f32 v[162:163], v[162:163], v[82:83]
    v_lshlrev_b32 v4, 4, v0
    v_add_u32 v5, 98304, v4
    v_add_u32 v4, 16384, v4
    v_subrev_u32 v8, 65536, v128
    v_subrev_u32 v9, 65536, v129
    v_and_b32 v1, 15, v0
    s_lshl_b32 s44, s3, 6
    s_add_u32 s44, s44, 0
    v_lshrrev_b32 v18, 4, v0
    v_lshl_add_u32 v18, v18, 3, s44
    v_mul_u32_u24 v19, 272, v1
    v_add_u32_e64 v18, v18, v19
    v_add_u32 v19, 4352, v18
    v_add_u32 v20, 8704, v18
    v_add_u32 v21, 13056, v18

    s_setprio 2
    s_waitcnt lgkmcnt(0)
    s_barrier
    ds_read_b64_tr_b16 v[40:41], v130 offset:24576
    ds_read_b64_tr_b16 v[42:43], v130 offset:28672
    ds_read_b128 v[24:27], v4 offset:0
    ds_read_b64_tr_b16 v[64:65], v130 offset:32768
    ds_read_b64_tr_b16 v[66:67], v130 offset:36864
    ds_read_b128 v[48:51], v4 offset:1024
    ds_read_b64_tr_b16 v[44:45], v131 offset:24576
    ds_read_b64_tr_b16 v[46:47], v131 offset:28672
    ds_read_b64_tr_b16 v[68:69], v131 offset:32768
    ds_read_b64_tr_b16 v[70:71], v131 offset:36864
    ds_read_b128 v[28:31], v4 offset:2048
    ds_read_b128 v[52:55], v4 offset:3072
    ds_read_b128 v[32:35], v4 offset:4096
    ds_read_b128 v[56:59], v4 offset:5120
    ds_read_b128 v[36:39], v4 offset:6144
    s_waitcnt lgkmcnt(8)
    ds_read_b128 v[60:63], v4 offset:7168
    s_waitcnt lgkmcnt(13)
    v_mfma_f32_16x16x32_bf16 v[132:135], v[40:43], v[24:27], v[132:135]
    s_waitcnt lgkmcnt(10)
    v_mfma_f32_16x16x32_bf16 v[132:135], v[64:67], v[48:51], v[132:135]
    s_waitcnt lgkmcnt(8)
    v_mfma_f32_16x16x32_bf16 v[136:139], v[44:47], v[24:27], v[136:139]
    s_waitcnt lgkmcnt(6)
    v_mfma_f32_16x16x32_bf16 v[136:139], v[68:71], v[48:51], v[136:139]
    s_waitcnt lgkmcnt(5)
    v_mfma_f32_16x16x32_bf16 v[140:143], v[40:43], v[28:31], v[140:143]
    s_waitcnt lgkmcnt(4)
    v_mfma_f32_16x16x32_bf16 v[140:143], v[64:67], v[52:55], v[140:143]
    s_waitcnt lgkmcnt(0)
    s_barrier
    ds_read_b64_tr_b16 v[88:89], v128 offset:0
    ds_read_b64_tr_b16 v[90:91], v128 offset:4096
    v_mfma_f32_16x16x32_bf16 v[144:147], v[44:47], v[28:31], v[144:147]
    ds_read_b128 v[72:75], v5 offset:0
    ds_read_b64_tr_b16 v[112:113], v128 offset:8192
    v_mfma_f32_16x16x32_bf16 v[144:147], v[68:71], v[52:55], v[144:147]
    ds_read_b64_tr_b16 v[114:115], v128 offset:12288
    ds_read_b128 v[96:99], v5 offset:1024
    v_mfma_f32_16x16x32_bf16 v[148:151], v[40:43], v[32:35], v[148:151]
    ds_read_b64_tr_b16 v[92:93], v129 offset:0
    ds_read_b64_tr_b16 v[94:95], v129 offset:4096
    v_mfma_f32_16x16x32_bf16 v[148:151], v[64:67], v[56:59], v[148:151]
    ds_read_b64_tr_b16 v[116:117], v129 offset:8192
    ds_read_b64_tr_b16 v[118:119], v129 offset:12288
    v_mfma_f32_16x16x32_bf16 v[152:155], v[44:47], v[32:35], v[152:155]
    ds_read_b128 v[76:79], v5 offset:2048
    ds_read_b128 v[100:103], v5 offset:3072
    v_mfma_f32_16x16x32_bf16 v[152:155], v[68:71], v[56:59], v[152:155]
W_3:
    s_cbranch_execz R_3
    s_nop 0
    ds_read_b128 v[80:83], v5 offset:4096
    ds_read_b128 v[104:107], v5 offset:5120
    v_mfma_f32_16x16x32_bf16 v[156:159], v[40:43], v[36:39], v[156:159]
    s_waitcnt lgkmcnt(8)
    ds_read_b128 v[84:87], v5 offset:6144
    ds_read_b128 v[108:111], v5 offset:7168
    v_mfma_f32_16x16x32_bf16 v[156:159], v[64:67], v[60:63], v[156:159]
    v_mfma_f32_16x16x32_bf16 v[160:163], v[44:47], v[36:39], v[160:163]
    v_mfma_f32_16x16x32_bf16 v[160:163], v[68:71], v[60:63], v[160:163]
    s_waitcnt lgkmcnt(4)
    v_mfma_f32_16x16x32_bf16 v[132:135], v[88:91], v[72:75], v[132:135]
    v_mfma_f32_16x16x32_bf16 v[132:135], v[112:115], v[96:99], v[132:135]
    s_waitcnt lgkmcnt(0)
    s_barrier
    ds_read_b64_tr_b16 v[40:41], v8 offset:0
    ds_read_b64_tr_b16 v[42:43], v8 offset:4096
    v_mfma_f32_16x16x32_bf16 v[136:139], v[92:95], v[72:75], v[136:139]
    ds_read_b128 v[24:27], v5 offset:40960
    ds_read_b64_tr_b16 v[64:65], v8 offset:8192
    v_mfma_f32_16x16x32_bf16 v[136:139], v[116:119], v[96:99], v[136:139]
    ds_read_b64_tr_b16 v[66:67], v8 offset:12288
    ds_read_b128 v[48:51], v5 offset:41984
    v_mfma_f32_16x16x32_bf16 v[140:143], v[88:91], v[76:79], v[140:143]
    ds_read_b64_tr_b16 v[44:45], v9 offset:0
    ds_read_b64_tr_b16 v[46:47], v9 offset:4096
    v_mfma_f32_16x16x32_bf16 v[140:143], v[112:115], v[100:103], v[140:143]
    ds_read_b64_tr_b16 v[68:69], v9 offset:8192
    v_mfma_f32_16x16x32_bf16 v[144:147], v[92:95], v[76:79], v[144:147]
    ds_read_b64_tr_b16 v[70:71], v9 offset:12288
    v_mfma_f32_16x16x32_bf16 v[144:147], v[116:119], v[100:103], v[144:147]
    ds_read_b128 v[28:31], v5 offset:43008
    v_mfma_f32_16x16x32_bf16 v[148:151], v[88:91], v[80:83], v[148:151]
    ds_read_b128 v[52:55], v5 offset:44032
    v_mfma_f32_16x16x32_bf16 v[148:151], v[112:115], v[104:107], v[148:151]
    ds_read_b128 v[32:35], v5 offset:45056
    v_mfma_f32_16x16x32_bf16 v[152:155], v[92:95], v[80:83], v[152:155]
    ds_read_b128 v[56:59], v5 offset:46080
    v_mfma_f32_16x16x32_bf16 v[152:155], v[116:119], v[104:107], v[152:155]
    s_waitcnt lgkmcnt(8)
    ds_read_b128 v[36:39], v5 offset:47104
    v_mfma_f32_16x16x32_bf16 v[156:159], v[88:91], v[84:87], v[156:159]
    ds_read_b128 v[60:63], v5 offset:48128
    v_mfma_f32_16x16x32_bf16 v[156:159], v[112:115], v[108:111], v[156:159]
    v_mfma_f32_16x16x32_bf16 v[160:163], v[92:95], v[84:87], v[160:163]
    v_mfma_f32_16x16x32_bf16 v[160:163], v[116:119], v[108:111], v[160:163]
    s_waitcnt lgkmcnt(4)
    v_mfma_f32_16x16x32_bf16 v[132:135], v[40:43], v[24:27], v[132:135]
    v_mfma_f32_16x16x32_bf16 v[132:135], v[64:67], v[48:51], v[132:135]
    s_waitcnt lgkmcnt(0)
    s_barrier
    ds_read_b64_tr_b16 v[88:89], v8 offset:40960
    ds_read_b64_tr_b16 v[90:91], v8 offset:45056
    v_mfma_f32_16x16x32_bf16 v[136:139], v[44:47], v[24:27], v[136:139]
    ds_read_b128 v[72:75], v4 offset:40960
    ds_read_b64_tr_b16 v[112:113], v8 offset:49152
    v_mfma_f32_16x16x32_bf16 v[136:139], v[68:71], v[48:51], v[136:139]
    ds_read_b64_tr_b16 v[114:115], v8 offset:53248
    ds_read_b128 v[96:99], v4 offset:41984
    v_mfma_f32_16x16x32_bf16 v[140:143], v[40:43], v[28:31], v[140:143]
    ds_read_b64_tr_b16 v[92:93], v9 offset:40960
    ds_read_b64_tr_b16 v[94:95], v9 offset:45056
    v_mfma_f32_16x16x32_bf16 v[140:143], v[64:67], v[52:55], v[140:143]
    ds_read_b64_tr_b16 v[116:117], v9 offset:49152
    v_mfma_f32_16x16x32_bf16 v[144:147], v[44:47], v[28:31], v[144:147]
    ds_read_b64_tr_b16 v[118:119], v9 offset:53248
    v_mfma_f32_16x16x32_bf16 v[144:147], v[68:71], v[52:55], v[144:147]
    ds_read_b128 v[76:79], v4 offset:43008
    v_mfma_f32_16x16x32_bf16 v[148:151], v[40:43], v[32:35], v[148:151]
    ds_read_b128 v[100:103], v4 offset:44032
    v_mfma_f32_16x16x32_bf16 v[148:151], v[64:67], v[56:59], v[148:151]
    ds_read_b128 v[80:83], v4 offset:45056
    v_mfma_f32_16x16x32_bf16 v[152:155], v[44:47], v[32:35], v[152:155]
    ds_read_b128 v[104:107], v4 offset:46080
    v_mfma_f32_16x16x32_bf16 v[152:155], v[68:71], v[56:59], v[152:155]
    s_waitcnt lgkmcnt(8)
    ds_read_b128 v[84:87], v4 offset:47104
    v_mfma_f32_16x16x32_bf16 v[156:159], v[40:43], v[36:39], v[156:159]
    ds_read_b128 v[108:111], v4 offset:48128
    v_mfma_f32_16x16x32_bf16 v[156:159], v[64:67], v[60:63], v[156:159]
    v_mfma_f32_16x16x32_bf16 v[160:163], v[44:47], v[36:39], v[160:163]
    v_mfma_f32_16x16x32_bf16 v[160:163], v[68:71], v[60:63], v[160:163]
    s_waitcnt lgkmcnt(4)
    v_mfma_f32_16x16x32_bf16 v[132:135], v[88:91], v[72:75], v[132:135]
    v_mfma_f32_16x16x32_bf16 v[132:135], v[112:115], v[96:99], v[132:135]
    s_waitcnt lgkmcnt(0)
    s_barrier
    ds_read_b64_tr_b16 v[40:41], v128 offset:16384
    ds_read_b64_tr_b16 v[42:43], v128 offset:20480
    v_mfma_f32_16x16x32_bf16 v[136:139], v[92:95], v[72:75], v[136:139]
    ds_read_b128 v[24:27], v4 offset:0
    ds_read_b64_tr_b16 v[64:65], v128 offset:24576
    v_mfma_f32_16x16x32_bf16 v[136:139], v[116:119], v[96:99], v[136:139]
    ds_read_b64_tr_b16 v[66:67], v128 offset:28672
    ds_read_b128 v[48:51], v4 offset:1024
    v_mfma_f32_16x16x32_bf16 v[140:143], v[88:91], v[76:79], v[140:143]
    ds_read_b64_tr_b16 v[44:45], v129 offset:16384
    ds_read_b64_tr_b16 v[46:47], v129 offset:20480
    v_mfma_f32_16x16x32_bf16 v[140:143], v[112:115], v[100:103], v[140:143]
    ds_read_b64_tr_b16 v[68:69], v129 offset:24576
    v_mfma_f32_16x16x32_bf16 v[144:147], v[92:95], v[76:79], v[144:147]
    ds_read_b64_tr_b16 v[70:71], v129 offset:28672
    v_mfma_f32_16x16x32_bf16 v[144:147], v[116:119], v[100:103], v[144:147]
    ds_read_b128 v[28:31], v4 offset:2048
    v_mfma_f32_16x16x32_bf16 v[148:151], v[88:91], v[80:83], v[148:151]
    ds_read_b128 v[52:55], v4 offset:3072
    v_mfma_f32_16x16x32_bf16 v[148:151], v[112:115], v[104:107], v[148:151]
    ds_read_b128 v[32:35], v4 offset:4096
    v_mfma_f32_16x16x32_bf16 v[152:155], v[92:95], v[80:83], v[152:155]
    ds_read_b128 v[56:59], v4 offset:5120
    v_mfma_f32_16x16x32_bf16 v[152:155], v[116:119], v[104:107], v[152:155]
    s_waitcnt lgkmcnt(8)
    ds_read_b128 v[36:39], v4 offset:6144
    v_mfma_f32_16x16x32_bf16 v[156:159], v[88:91], v[84:87], v[156:159]
    ds_read_b128 v[60:63], v4 offset:7168
    v_mfma_f32_16x16x32_bf16 v[156:159], v[112:115], v[108:111], v[156:159]
    v_mfma_f32_16x16x32_bf16 v[160:163], v[92:95], v[84:87], v[160:163]
    v_mfma_f32_16x16x32_bf16 v[160:163], v[116:119], v[108:111], v[160:163]
    s_waitcnt lgkmcnt(4)
    v_mfma_f32_16x16x32_bf16 v[132:135], v[40:43], v[24:27], v[132:135]
    v_mfma_f32_16x16x32_bf16 v[132:135], v[64:67], v[48:51], v[132:135]
    s_waitcnt lgkmcnt(0)
    s_barrier
    ds_read_b64_tr_b16 v[88:89], v130 offset:0
    ds_read_b64_tr_b16 v[90:91], v130 offset:4096
    v_mfma_f32_16x16x32_bf16 v[136:139], v[44:47], v[24:27], v[136:139]
    ds_read_b128 v[72:75], v5 offset:0
    ds_read_b64_tr_b16 v[112:113], v130 offset:8192
    v_mfma_f32_16x16x32_bf16 v[136:139], v[68:71], v[48:51], v[136:139]
    ds_read_b64_tr_b16 v[114:115], v130 offset:12288
    ds_read_b128 v[96:99], v5 offset:1024
    v_mfma_f32_16x16x32_bf16 v[140:143], v[40:43], v[28:31], v[140:143]
    ds_read_b64_tr_b16 v[92:93], v131 offset:0
    ds_read_b64_tr_b16 v[94:95], v131 offset:4096
    v_mfma_f32_16x16x32_bf16 v[140:143], v[64:67], v[52:55], v[140:143]
    ds_read_b64_tr_b16 v[116:117], v131 offset:8192
    v_mfma_f32_16x16x32_bf16 v[144:147], v[44:47], v[28:31], v[144:147]
    ds_read_b64_tr_b16 v[118:119], v131 offset:12288
    v_mfma_f32_16x16x32_bf16 v[144:147], v[68:71], v[52:55], v[144:147]
    ds_read_b128 v[76:79], v5 offset:2048
    v_mfma_f32_16x16x32_bf16 v[148:151], v[40:43], v[32:35], v[148:151]
    ds_read_b128 v[100:103], v5 offset:3072
    v_mfma_f32_16x16x32_bf16 v[148:151], v[64:67], v[56:59], v[148:151]
    ds_read_b128 v[80:83], v5 offset:4096
    v_mfma_f32_16x16x32_bf16 v[152:155], v[44:47], v[32:35], v[152:155]
    ds_read_b128 v[104:107], v5 offset:5120
    v_mfma_f32_16x16x32_bf16 v[152:155], v[68:71], v[56:59], v[152:155]
    s_waitcnt lgkmcnt(8)
    ds_read_b128 v[84:87], v5 offset:6144
    v_mfma_f32_16x16x32_bf16 v[156:159], v[40:43], v[36:39], v[156:159]
    ds_read_b128 v[108:111], v5 offset:7168
    v_mfma_f32_16x16x32_bf16 v[156:159], v[64:67], v[60:63], v[156:159]
    v_mfma_f32_16x16x32_bf16 v[160:163], v[44:47], v[36:39], v[160:163]
    v_mfma_f32_16x16x32_bf16 v[160:163], v[68:71], v[60:63], v[160:163]
    s_waitcnt lgkmcnt(4)
    v_mfma_f32_16x16x32_bf16 v[132:135], v[88:91], v[72:75], v[132:135]
    v_mfma_f32_16x16x32_bf16 v[132:135], v[112:115], v[96:99], v[132:135]
    s_waitcnt lgkmcnt(0)
    s_barrier
    ds_read_b64_tr_b16 v[40:41], v128 offset:40960
    ds_read_b64_tr_b16 v[42:43], v128 offset:45056
    v_mfma_f32_16x16x32_bf16 v[136:139], v[92:95], v[72:75], v[136:139]
    ds_read_b128 v[24:27], v5 offset:40960
    ds_read_b64_tr_b16 v[64:65], v128 offset:49152
    v_mfma_f32_16x16x32_bf16 v[136:139], v[116:119], v[96:99], v[136:139]
    ds_read_b64_tr_b16 v[66:67], v128 offset:53248
    ds_read_b128 v[48:51], v5 offset:41984
    v_mfma_f32_16x16x32_bf16 v[140:143], v[88:91], v[76:79], v[140:143]
    ds_read_b64_tr_b16 v[44:45], v129 offset:40960
    ds_read_b64_tr_b16 v[46:47], v129 offset:45056
    v_mfma_f32_16x16x32_bf16 v[140:143], v[112:115], v[100:103], v[140:143]
    ds_read_b64_tr_b16 v[68:69], v129 offset:49152
    v_mfma_f32_16x16x32_bf16 v[144:147], v[92:95], v[76:79], v[144:147]
    ds_read_b64_tr_b16 v[70:71], v129 offset:53248
    v_mfma_f32_16x16x32_bf16 v[144:147], v[116:119], v[100:103], v[144:147]
    ds_read_b128 v[28:31], v5 offset:43008
    v_mfma_f32_16x16x32_bf16 v[148:151], v[88:91], v[80:83], v[148:151]
    ds_read_b128 v[52:55], v5 offset:44032
    v_mfma_f32_16x16x32_bf16 v[148:151], v[112:115], v[104:107], v[148:151]
    ds_read_b128 v[32:35], v5 offset:45056
    v_mfma_f32_16x16x32_bf16 v[152:155], v[92:95], v[80:83], v[152:155]
    ds_read_b128 v[56:59], v5 offset:46080
    v_mfma_f32_16x16x32_bf16 v[152:155], v[116:119], v[104:107], v[152:155]
    s_waitcnt lgkmcnt(8)
    ds_read_b128 v[36:39], v5 offset:47104
    v_mfma_f32_16x16x32_bf16 v[156:159], v[88:91], v[84:87], v[156:159]
    ds_read_b128 v[60:63], v5 offset:48128
    v_mfma_f32_16x16x32_bf16 v[156:159], v[112:115], v[108:111], v[156:159]
    v_mfma_f32_16x16x32_bf16 v[160:163], v[92:95], v[84:87], v[160:163]
    v_mfma_f32_16x16x32_bf16 v[160:163], v[116:119], v[108:111], v[160:163]
    s_waitcnt lgkmcnt(4)
    v_mfma_f32_16x16x32_bf16 v[132:135], v[40:43], v[24:27], v[132:135]
    v_mfma_f32_16x16x32_bf16 v[132:135], v[64:67], v[48:51], v[132:135]
    s_waitcnt lgkmcnt(0)
    s_barrier
    ds_read_b64_tr_b16 v[88:89], v130 offset:24576
    ds_read_b64_tr_b16 v[90:91], v130 offset:28672
    v_mfma_f32_16x16x32_bf16 v[136:139], v[44:47], v[24:27], v[136:139]
    ds_read_b128 v[72:75], v4 offset:40960
    ds_read_b64_tr_b16 v[112:113], v130 offset:32768
    v_mfma_f32_16x16x32_bf16 v[136:139], v[68:71], v[48:51], v[136:139]
    ds_read_b64_tr_b16 v[114:115], v130 offset:36864
    ds_read_b128 v[96:99], v4 offset:41984
    v_mfma_f32_16x16x32_bf16 v[140:143], v[40:43], v[28:31], v[140:143]
    ds_read_b64_tr_b16 v[92:93], v131 offset:24576
    ds_read_b64_tr_b16 v[94:95], v131 offset:28672
    v_mfma_f32_16x16x32_bf16 v[140:143], v[64:67], v[52:55], v[140:143]
    ds_read_b64_tr_b16 v[116:117], v131 offset:32768
    v_mfma_f32_16x16x32_bf16 v[144:147], v[44:47], v[28:31], v[144:147]
    ds_read_b64_tr_b16 v[118:119], v131 offset:36864
    v_mfma_f32_16x16x32_bf16 v[144:147], v[68:71], v[52:55], v[144:147]
    ds_read_b128 v[76:79], v4 offset:43008
    v_mfma_f32_16x16x32_bf16 v[148:151], v[40:43], v[32:35], v[148:151]
    ds_read_b128 v[100:103], v4 offset:44032
    v_mfma_f32_16x16x32_bf16 v[148:151], v[64:67], v[56:59], v[148:151]
    ds_read_b128 v[80:83], v4 offset:45056
    v_mfma_f32_16x16x32_bf16 v[152:155], v[44:47], v[32:35], v[152:155]
    ds_read_b128 v[104:107], v4 offset:46080
    v_mfma_f32_16x16x32_bf16 v[152:155], v[68:71], v[56:59], v[152:155]
    s_waitcnt lgkmcnt(8)
    ds_read_b128 v[84:87], v4 offset:47104
    v_mfma_f32_16x16x32_bf16 v[156:159], v[40:43], v[36:39], v[156:159]
    ds_read_b128 v[108:111], v4 offset:48128
    v_mfma_f32_16x16x32_bf16 v[156:159], v[64:67], v[60:63], v[156:159]
    v_mfma_f32_16x16x32_bf16 v[160:163], v[44:47], v[36:39], v[160:163]
    v_mfma_f32_16x16x32_bf16 v[160:163], v[68:71], v[60:63], v[160:163]
    s_waitcnt lgkmcnt(4)
    v_mfma_f32_16x16x32_bf16 v[132:135], v[88:91], v[72:75], v[132:135]
    v_mfma_f32_16x16x32_bf16 v[132:135], v[112:115], v[96:99], v[132:135]
    s_waitcnt lgkmcnt(0)
    s_barrier
    ds_read_b64_tr_b16 v[40:41], v128 offset:0
    ds_read_b64_tr_b16 v[42:43], v128 offset:4096
    v_mfma_f32_16x16x32_bf16 v[136:139], v[92:95], v[72:75], v[136:139]
    ds_read_b128 v[24:27], v4 offset:0
    ds_read_b64_tr_b16 v[64:65], v128 offset:8192
    v_mfma_f32_16x16x32_bf16 v[136:139], v[116:119], v[96:99], v[136:139]
    ds_read_b64_tr_b16 v[66:67], v128 offset:12288
    ds_read_b128 v[48:51], v4 offset:1024
    v_mfma_f32_16x16x32_bf16 v[140:143], v[88:91], v[76:79], v[140:143]
    ds_read_b64_tr_b16 v[44:45], v129 offset:0
    ds_read_b64_tr_b16 v[46:47], v129 offset:4096
    v_mfma_f32_16x16x32_bf16 v[140:143], v[112:115], v[100:103], v[140:143]
    ds_read_b64_tr_b16 v[68:69], v129 offset:8192
    v_mfma_f32_16x16x32_bf16 v[144:147], v[92:95], v[76:79], v[144:147]
    ds_read_b64_tr_b16 v[70:71], v129 offset:12288
    v_mfma_f32_16x16x32_bf16 v[144:147], v[116:119], v[100:103], v[144:147]
    ds_read_b128 v[28:31], v4 offset:2048
    v_mfma_f32_16x16x32_bf16 v[148:151], v[88:91], v[80:83], v[148:151]
    ds_read_b128 v[52:55], v4 offset:3072
    v_mfma_f32_16x16x32_bf16 v[148:151], v[112:115], v[104:107], v[148:151]
    ds_read_b128 v[32:35], v4 offset:4096
    v_mfma_f32_16x16x32_bf16 v[152:155], v[92:95], v[80:83], v[152:155]
    ds_read_b128 v[56:59], v4 offset:5120
    v_mfma_f32_16x16x32_bf16 v[152:155], v[116:119], v[104:107], v[152:155]
    s_waitcnt lgkmcnt(8)
    ds_read_b128 v[36:39], v4 offset:6144
    v_mfma_f32_16x16x32_bf16 v[156:159], v[88:91], v[84:87], v[156:159]
    ds_read_b128 v[60:63], v4 offset:7168
    v_mfma_f32_16x16x32_bf16 v[156:159], v[112:115], v[108:111], v[156:159]
    v_mfma_f32_16x16x32_bf16 v[160:163], v[92:95], v[84:87], v[160:163]
    v_mfma_f32_16x16x32_bf16 v[160:163], v[116:119], v[108:111], v[160:163]
    s_waitcnt lgkmcnt(4)
    v_mfma_f32_16x16x32_bf16 v[132:135], v[40:43], v[24:27], v[132:135]
    v_mfma_f32_16x16x32_bf16 v[132:135], v[64:67], v[48:51], v[132:135]
    s_waitcnt lgkmcnt(0)
    s_barrier
    ds_read_b64_tr_b16 v[88:89], v8 offset:0
    ds_read_b64_tr_b16 v[90:91], v8 offset:4096
    v_mfma_f32_16x16x32_bf16 v[136:139], v[44:47], v[24:27], v[136:139]
    ds_read_b128 v[72:75], v5 offset:0
    ds_read_b64_tr_b16 v[112:113], v8 offset:8192
    v_mfma_f32_16x16x32_bf16 v[136:139], v[68:71], v[48:51], v[136:139]
    ds_read_b64_tr_b16 v[114:115], v8 offset:12288
    ds_read_b128 v[96:99], v5 offset:1024
    v_mfma_f32_16x16x32_bf16 v[140:143], v[40:43], v[28:31], v[140:143]
    ds_read_b64_tr_b16 v[92:93], v9 offset:0
    ds_read_b64_tr_b16 v[94:95], v9 offset:4096
    v_mfma_f32_16x16x32_bf16 v[140:143], v[64:67], v[52:55], v[140:143]
    ds_read_b64_tr_b16 v[116:117], v9 offset:8192
    v_mfma_f32_16x16x32_bf16 v[144:147], v[44:47], v[28:31], v[144:147]
    ds_read_b64_tr_b16 v[118:119], v9 offset:12288
    v_mfma_f32_16x16x32_bf16 v[144:147], v[68:71], v[52:55], v[144:147]
    ds_read_b128 v[76:79], v5 offset:2048
    v_mfma_f32_16x16x32_bf16 v[148:151], v[40:43], v[32:35], v[148:151]
    ds_read_b128 v[100:103], v5 offset:3072
    v_mfma_f32_16x16x32_bf16 v[148:151], v[64:67], v[56:59], v[148:151]
    ds_read_b128 v[80:83], v5 offset:4096
    v_mfma_f32_16x16x32_bf16 v[152:155], v[44:47], v[32:35], v[152:155]
    ds_read_b128 v[104:107], v5 offset:5120
    v_mfma_f32_16x16x32_bf16 v[152:155], v[68:71], v[56:59], v[152:155]
    s_waitcnt lgkmcnt(8)
    ds_read_b128 v[84:87], v5 offset:6144
    v_mfma_f32_16x16x32_bf16 v[156:159], v[40:43], v[36:39], v[156:159]
    ds_read_b128 v[108:111], v5 offset:7168
    v_mfma_f32_16x16x32_bf16 v[156:159], v[64:67], v[60:63], v[156:159]
    v_mfma_f32_16x16x32_bf16 v[160:163], v[44:47], v[36:39], v[160:163]
    v_mfma_f32_16x16x32_bf16 v[160:163], v[68:71], v[60:63], v[160:163]
    s_waitcnt lgkmcnt(4)
    v_mfma_f32_16x16x32_bf16 v[132:135], v[88:91], v[72:75], v[132:135]
    v_mfma_f32_16x16x32_bf16 v[132:135], v[112:115], v[96:99], v[132:135]
    s_waitcnt lgkmcnt(0)
    s_barrier
    ds_read_b64_tr_b16 v[40:41], v8 offset:40960
    ds_read_b64_tr_b16 v[42:43], v8 offset:45056
    v_mfma_f32_16x16x32_bf16 v[136:139], v[92:95], v[72:75], v[136:139]
    ds_read_b128 v[24:27], v5 offset:40960
    ds_read_b64_tr_b16 v[64:65], v8 offset:49152
    v_mfma_f32_16x16x32_bf16 v[136:139], v[116:119], v[96:99], v[136:139]
    ds_read_b64_tr_b16 v[66:67], v8 offset:53248
    ds_read_b128 v[48:51], v5 offset:41984
    v_mfma_f32_16x16x32_bf16 v[140:143], v[88:91], v[76:79], v[140:143]
    ds_read_b64_tr_b16 v[44:45], v9 offset:40960
    ds_read_b64_tr_b16 v[46:47], v9 offset:45056
    v_mfma_f32_16x16x32_bf16 v[140:143], v[112:115], v[100:103], v[140:143]
    ds_read_b64_tr_b16 v[68:69], v9 offset:49152
    v_mfma_f32_16x16x32_bf16 v[144:147], v[92:95], v[76:79], v[144:147]
    ds_read_b64_tr_b16 v[70:71], v9 offset:53248
    v_mfma_f32_16x16x32_bf16 v[144:147], v[116:119], v[100:103], v[144:147]
    ds_read_b128 v[28:31], v5 offset:43008
    v_mfma_f32_16x16x32_bf16 v[148:151], v[88:91], v[80:83], v[148:151]
    ds_read_b128 v[52:55], v5 offset:44032
    v_mfma_f32_16x16x32_bf16 v[148:151], v[112:115], v[104:107], v[148:151]
    ds_read_b128 v[32:35], v5 offset:45056
    v_mfma_f32_16x16x32_bf16 v[152:155], v[92:95], v[80:83], v[152:155]
    ds_read_b128 v[56:59], v5 offset:46080
    v_mfma_f32_16x16x32_bf16 v[152:155], v[116:119], v[104:107], v[152:155]
    s_waitcnt lgkmcnt(8)
    ds_read_b128 v[36:39], v5 offset:47104
    v_mfma_f32_16x16x32_bf16 v[156:159], v[88:91], v[84:87], v[156:159]
    ds_read_b128 v[60:63], v5 offset:48128
    v_mfma_f32_16x16x32_bf16 v[156:159], v[112:115], v[108:111], v[156:159]
    v_mfma_f32_16x16x32_bf16 v[160:163], v[92:95], v[84:87], v[160:163]
    v_mfma_f32_16x16x32_bf16 v[160:163], v[116:119], v[108:111], v[160:163]
    s_waitcnt lgkmcnt(4)
    v_mfma_f32_16x16x32_bf16 v[132:135], v[40:43], v[24:27], v[132:135]
    v_mfma_f32_16x16x32_bf16 v[132:135], v[64:67], v[48:51], v[132:135]
    s_waitcnt lgkmcnt(0)
    s_barrier
    ds_read_b64_tr_b16 v[88:89], v128 offset:16384
    ds_read_b64_tr_b16 v[90:91], v128 offset:20480
    v_mfma_f32_16x16x32_bf16 v[136:139], v[44:47], v[24:27], v[136:139]
    ds_read_b128 v[72:75], v4 offset:40960
    ds_read_b64_tr_b16 v[112:113], v128 offset:24576
    v_mfma_f32_16x16x32_bf16 v[136:139], v[68:71], v[48:51], v[136:139]
    ds_read_b64_tr_b16 v[114:115], v128 offset:28672
    ds_read_b128 v[96:99], v4 offset:41984
    v_mfma_f32_16x16x32_bf16 v[140:143], v[40:43], v[28:31], v[140:143]
    ds_read_b64_tr_b16 v[92:93], v129 offset:16384
    ds_read_b64_tr_b16 v[94:95], v129 offset:20480
    v_mfma_f32_16x16x32_bf16 v[140:143], v[64:67], v[52:55], v[140:143]
    ds_read_b64_tr_b16 v[116:117], v129 offset:24576
    v_mfma_f32_16x16x32_bf16 v[144:147], v[44:47], v[28:31], v[144:147]
    ds_read_b64_tr_b16 v[118:119], v129 offset:28672
    v_mfma_f32_16x16x32_bf16 v[144:147], v[68:71], v[52:55], v[144:147]
    ds_read_b128 v[76:79], v4 offset:43008
    v_mfma_f32_16x16x32_bf16 v[148:151], v[40:43], v[32:35], v[148:151]
    ds_read_b128 v[100:103], v4 offset:44032
    v_mfma_f32_16x16x32_bf16 v[148:151], v[64:67], v[56:59], v[148:151]
    ds_read_b128 v[80:83], v4 offset:45056
    v_mfma_f32_16x16x32_bf16 v[152:155], v[44:47], v[32:35], v[152:155]
    ds_read_b128 v[104:107], v4 offset:46080
    v_mfma_f32_16x16x32_bf16 v[152:155], v[68:71], v[56:59], v[152:155]
    s_waitcnt lgkmcnt(8)
    ds_read_b128 v[84:87], v4 offset:47104
    v_mfma_f32_16x16x32_bf16 v[156:159], v[40:43], v[36:39], v[156:159]
    ds_read_b128 v[108:111], v4 offset:48128
    v_mfma_f32_16x16x32_bf16 v[156:159], v[64:67], v[60:63], v[156:159]
    v_mfma_f32_16x16x32_bf16 v[160:163], v[44:47], v[36:39], v[160:163]
    v_mfma_f32_16x16x32_bf16 v[160:163], v[68:71], v[60:63], v[160:163]
    s_waitcnt lgkmcnt(4)
    v_mfma_f32_16x16x32_bf16 v[132:135], v[88:91], v[72:75], v[132:135]
    v_mfma_f32_16x16x32_bf16 v[132:135], v[112:115], v[96:99], v[132:135]
    s_waitcnt lgkmcnt(0)
    s_barrier
    ds_read_b64_tr_b16 v[40:41], v130 offset:0
    ds_read_b64_tr_b16 v[42:43], v130 offset:4096
    v_mfma_f32_16x16x32_bf16 v[136:139], v[92:95], v[72:75], v[136:139]
    ds_read_b128 v[24:27], v4 offset:0
    ds_read_b64_tr_b16 v[64:65], v130 offset:8192
    v_mfma_f32_16x16x32_bf16 v[136:139], v[116:119], v[96:99], v[136:139]
    ds_read_b64_tr_b16 v[66:67], v130 offset:12288
    ds_read_b128 v[48:51], v4 offset:1024
    v_mfma_f32_16x16x32_bf16 v[140:143], v[88:91], v[76:79], v[140:143]
    ds_read_b64_tr_b16 v[44:45], v131 offset:0
    ds_read_b64_tr_b16 v[46:47], v131 offset:4096
    v_mfma_f32_16x16x32_bf16 v[140:143], v[112:115], v[100:103], v[140:143]
    ds_read_b64_tr_b16 v[68:69], v131 offset:8192
    v_mfma_f32_16x16x32_bf16 v[144:147], v[92:95], v[76:79], v[144:147]
    ds_read_b64_tr_b16 v[70:71], v131 offset:12288
    v_mfma_f32_16x16x32_bf16 v[144:147], v[116:119], v[100:103], v[144:147]
    ds_read_b128 v[28:31], v4 offset:2048
    v_mfma_f32_16x16x32_bf16 v[148:151], v[88:91], v[80:83], v[148:151]
    ds_read_b128 v[52:55], v4 offset:3072
    v_mfma_f32_16x16x32_bf16 v[148:151], v[112:115], v[104:107], v[148:151]
    ds_read_b128 v[32:35], v4 offset:4096
    v_mfma_f32_16x16x32_bf16 v[152:155], v[92:95], v[80:83], v[152:155]
    ds_read_b128 v[56:59], v4 offset:5120
    v_mfma_f32_16x16x32_bf16 v[152:155], v[116:119], v[104:107], v[152:155]
    s_waitcnt lgkmcnt(8)
    ds_read_b128 v[36:39], v4 offset:6144
    v_mfma_f32_16x16x32_bf16 v[156:159], v[88:91], v[84:87], v[156:159]
    ds_read_b128 v[60:63], v4 offset:7168
    v_mfma_f32_16x16x32_bf16 v[156:159], v[112:115], v[108:111], v[156:159]
    v_mfma_f32_16x16x32_bf16 v[160:163], v[92:95], v[84:87], v[160:163]
    v_mfma_f32_16x16x32_bf16 v[160:163], v[116:119], v[108:111], v[160:163]
    s_waitcnt lgkmcnt(4)
    v_mfma_f32_16x16x32_bf16 v[132:135], v[40:43], v[24:27], v[132:135]
    v_mfma_f32_16x16x32_bf16 v[132:135], v[64:67], v[48:51], v[132:135]
    s_waitcnt lgkmcnt(0)
    s_barrier
    ds_read_b64_tr_b16 v[88:89], v128 offset:40960
    ds_read_b64_tr_b16 v[90:91], v128 offset:45056
    v_mfma_f32_16x16x32_bf16 v[136:139], v[44:47], v[24:27], v[136:139]
    ds_read_b128 v[72:75], v5 offset:0
    ds_read_b64_tr_b16 v[112:113], v128 offset:49152
    v_mfma_f32_16x16x32_bf16 v[136:139], v[68:71], v[48:51], v[136:139]
    ds_read_b64_tr_b16 v[114:115], v128 offset:53248
    ds_read_b128 v[96:99], v5 offset:1024
    v_mfma_f32_16x16x32_bf16 v[140:143], v[40:43], v[28:31], v[140:143]
    ds_read_b64_tr_b16 v[92:93], v129 offset:40960
    ds_read_b64_tr_b16 v[94:95], v129 offset:45056
    v_mfma_f32_16x16x32_bf16 v[140:143], v[64:67], v[52:55], v[140:143]
    ds_read_b64_tr_b16 v[116:117], v129 offset:49152
    v_mfma_f32_16x16x32_bf16 v[144:147], v[44:47], v[28:31], v[144:147]
    ds_read_b64_tr_b16 v[118:119], v129 offset:53248
    v_mfma_f32_16x16x32_bf16 v[144:147], v[68:71], v[52:55], v[144:147]
    ds_read_b128 v[76:79], v5 offset:2048
    v_mfma_f32_16x16x32_bf16 v[148:151], v[40:43], v[32:35], v[148:151]
    ds_read_b128 v[100:103], v5 offset:3072
    v_mfma_f32_16x16x32_bf16 v[148:151], v[64:67], v[56:59], v[148:151]
    ds_read_b128 v[80:83], v5 offset:4096
    v_mfma_f32_16x16x32_bf16 v[152:155], v[44:47], v[32:35], v[152:155]
    ds_read_b128 v[104:107], v5 offset:5120
    v_mfma_f32_16x16x32_bf16 v[152:155], v[68:71], v[56:59], v[152:155]
    s_waitcnt lgkmcnt(8)
    ds_read_b128 v[84:87], v5 offset:6144
    v_mfma_f32_16x16x32_bf16 v[156:159], v[40:43], v[36:39], v[156:159]
    ds_read_b128 v[108:111], v5 offset:7168
    v_mfma_f32_16x16x32_bf16 v[156:159], v[64:67], v[60:63], v[156:159]
    v_mfma_f32_16x16x32_bf16 v[160:163], v[44:47], v[36:39], v[160:163]
    v_mfma_f32_16x16x32_bf16 v[160:163], v[68:71], v[60:63], v[160:163]
    s_waitcnt lgkmcnt(4)
    v_mfma_f32_16x16x32_bf16 v[132:135], v[88:91], v[72:75], v[132:135]
    v_mfma_f32_16x16x32_bf16 v[132:135], v[112:115], v[96:99], v[132:135]
    s_waitcnt lgkmcnt(0)
    s_barrier
    ds_read_b64_tr_b16 v[40:41], v130 offset:24576
    ds_read_b64_tr_b16 v[42:43], v130 offset:28672
    v_mfma_f32_16x16x32_bf16 v[136:139], v[92:95], v[72:75], v[136:139]
    ds_read_b128 v[24:27], v5 offset:40960
    ds_read_b64_tr_b16 v[64:65], v130 offset:32768
    v_mfma_f32_16x16x32_bf16 v[136:139], v[116:119], v[96:99], v[136:139]
    ds_read_b64_tr_b16 v[66:67], v130 offset:36864
    ds_read_b128 v[48:51], v5 offset:41984
    v_mfma_f32_16x16x32_bf16 v[140:143], v[88:91], v[76:79], v[140:143]
    ds_read_b64_tr_b16 v[44:45], v131 offset:24576
    ds_read_b64_tr_b16 v[46:47], v131 offset:28672
    v_mfma_f32_16x16x32_bf16 v[140:143], v[112:115], v[100:103], v[140:143]
    ds_read_b64_tr_b16 v[68:69], v131 offset:32768
    v_mfma_f32_16x16x32_bf16 v[144:147], v[92:95], v[76:79], v[144:147]
    ds_read_b64_tr_b16 v[70:71], v131 offset:36864
    v_mfma_f32_16x16x32_bf16 v[144:147], v[116:119], v[100:103], v[144:147]
    ds_read_b128 v[28:31], v5 offset:43008
    v_mfma_f32_16x16x32_bf16 v[148:151], v[88:91], v[80:83], v[148:151]
    ds_read_b128 v[52:55], v5 offset:44032
    v_mfma_f32_16x16x32_bf16 v[148:151], v[112:115], v[104:107], v[148:151]
    ds_read_b128 v[32:35], v5 offset:45056
    v_mfma_f32_16x16x32_bf16 v[152:155], v[92:95], v[80:83], v[152:155]
    ds_read_b128 v[56:59], v5 offset:46080
    v_mfma_f32_16x16x32_bf16 v[152:155], v[116:119], v[104:107], v[152:155]
    s_waitcnt lgkmcnt(8)
    ds_read_b128 v[36:39], v5 offset:47104
    v_mfma_f32_16x16x32_bf16 v[156:159], v[88:91], v[84:87], v[156:159]
    ds_read_b128 v[60:63], v5 offset:48128
    v_mfma_f32_16x16x32_bf16 v[156:159], v[112:115], v[108:111], v[156:159]
    v_mfma_f32_16x16x32_bf16 v[160:163], v[92:95], v[84:87], v[160:163]
    v_mfma_f32_16x16x32_bf16 v[160:163], v[116:119], v[108:111], v[160:163]
    s_waitcnt lgkmcnt(4)
    v_mfma_f32_16x16x32_bf16 v[132:135], v[40:43], v[24:27], v[132:135]
    v_mfma_f32_16x16x32_bf16 v[132:135], v[64:67], v[48:51], v[132:135]
    s_waitcnt lgkmcnt(0)
    s_barrier
    ds_read_b64_tr_b16 v[88:89], v128 offset:0
    ds_read_b64_tr_b16 v[90:91], v128 offset:4096
    v_mfma_f32_16x16x32_bf16 v[136:139], v[44:47], v[24:27], v[136:139]
    ds_read_b128 v[72:75], v4 offset:40960
    ds_read_b64_tr_b16 v[112:113], v128 offset:8192
    v_mfma_f32_16x16x32_bf16 v[136:139], v[68:71], v[48:51], v[136:139]
    ds_read_b64_tr_b16 v[114:115], v128 offset:12288
    ds_read_b128 v[96:99], v4 offset:41984
    v_mfma_f32_16x16x32_bf16 v[140:143], v[40:43], v[28:31], v[140:143]
    ds_read_b64_tr_b16 v[92:93], v129 offset:0
    ds_read_b64_tr_b16 v[94:95], v129 offset:4096
    v_mfma_f32_16x16x32_bf16 v[140:143], v[64:67], v[52:55], v[140:143]
    ds_read_b64_tr_b16 v[116:117], v129 offset:8192
    ds_read_b64_tr_b16 v[118:119], v129 offset:12288
    v_mfma_f32_16x16x32_bf16 v[144:147], v[44:47], v[28:31], v[144:147]
    ds_read_b128 v[76:79], v4 offset:43008
    v_mfma_f32_16x16x32_bf16 v[144:147], v[68:71], v[52:55], v[144:147]
    ds_read_b128 v[100:103], v4 offset:44032
    s_waitcnt lgkmcnt(9)
    v_mfma_f32_16x16x32_bf16 v[132:135], v[88:91], v[72:75], v[132:135]
    ds_read_b128 v[80:83], v4 offset:45056
    s_waitcnt lgkmcnt(7)
    v_mfma_f32_16x16x32_bf16 v[132:135], v[112:115], v[96:99], v[132:135]
    ds_read_b128 v[104:107], v4 offset:46080
    s_waitcnt lgkmcnt(6)
    v_mfma_f32_16x16x32_bf16 v[136:139], v[92:95], v[72:75], v[136:139]
    ds_read_b128 v[84:87], v4 offset:47104
    s_waitcnt lgkmcnt(5)
    v_mfma_f32_16x16x32_bf16 v[136:139], v[116:119], v[96:99], v[136:139]
    ds_read_b128 v[108:111], v4 offset:48128
    v_mfma_f32_16x16x32_bf16 v[148:151], v[40:43], v[32:35], v[148:151]
    v_mfma_f32_16x16x32_bf16 v[148:151], v[64:67], v[56:59], v[148:151]
    v_mfma_f32_16x16x32_bf16 v[152:155], v[44:47], v[32:35], v[152:155]
    v_cvt_pk_bf16_f32 v132, v132, v133
    v_cvt_pk_bf16_f32 v133, v134, v135
    v_mfma_f32_16x16x32_bf16 v[152:155], v[68:71], v[56:59], v[152:155]
    s_nop 0
    v_cvt_pk_bf16_f32 v134, v136, v137
    v_cvt_pk_bf16_f32 v135, v138, v139
    s_waitcnt lgkmcnt(5)
    v_mfma_f32_16x16x32_bf16 v[140:143], v[88:91], v[76:79], v[140:143]
    ds_write2_b64 v18, v[132:133], v[134:135] offset0:0 offset1:4
    s_waitcnt lgkmcnt(5)
    v_mfma_f32_16x16x32_bf16 v[140:143], v[112:115], v[100:103], v[140:143]
    v_mfma_f32_16x16x32_bf16 v[144:147], v[92:95], v[76:79], v[144:147]
    v_mfma_f32_16x16x32_bf16 v[144:147], v[116:119], v[100:103], v[144:147]
    v_mfma_f32_16x16x32_bf16 v[156:159], v[40:43], v[36:39], v[156:159]
    v_mfma_f32_16x16x32_bf16 v[156:159], v[64:67], v[60:63], v[156:159]
    v_mfma_f32_16x16x32_bf16 v[160:163], v[44:47], v[36:39], v[160:163]
    s_waitcnt lgkmcnt(0)
    s_barrier
    s_nop 0
    v_cvt_pk_bf16_f32 v140, v140, v141
    v_mfma_f32_16x16x32_bf16 v[160:163], v[68:71], v[60:63], v[160:163]
    v_cvt_pk_bf16_f32 v141, v142, v143
    v_cvt_pk_bf16_f32 v142, v144, v145
    v_mfma_f32_16x16x32_bf16 v[148:151], v[88:91], v[80:83], v[148:151]
    v_cvt_pk_bf16_f32 v143, v146, v147
    ds_write2_b64 v19, v[140:141], v[142:143] offset0:0 offset1:4
    v_mfma_f32_16x16x32_bf16 v[148:151], v[112:115], v[104:107], v[148:151]
    v_mfma_f32_16x16x32_bf16 v[152:155], v[92:95], v[80:83], v[152:155]
    v_mfma_f32_16x16x32_bf16 v[152:155], v[116:119], v[104:107], v[152:155]
W_4:
    s_cbranch_execz R_4
    s_nop 0
    v_mfma_f32_16x16x32_bf16 v[156:159], v[88:91], v[84:87], v[156:159]
    v_mfma_f32_16x16x32_bf16 v[156:159], v[112:115], v[108:111], v[156:159]
    v_mfma_f32_16x16x32_bf16 v[160:163], v[92:95], v[84:87], v[160:163]
    s_waitcnt lgkmcnt(0)
    s_barrier
    s_nop 0
    v_cvt_pk_bf16_f32 v148, v148, v149
    v_cvt_pk_bf16_f32 v149, v150, v151
    v_mfma_f32_16x16x32_bf16 v[160:163], v[116:119], v[108:111], v[160:163]
    v_cvt_pk_bf16_f32 v150, v152, v153
    v_cvt_pk_bf16_f32 v151, v154, v155
    ds_write2_b64 v20, v[148:149], v[150:151] offset0:0 offset1:4
    v_cvt_pk_bf16_f32 v156, v156, v157
    v_cvt_pk_bf16_f32 v157, v158, v159
    s_nop 2
    v_cvt_pk_bf16_f32 v158, v160, v161
    v_cvt_pk_bf16_f32 v159, v162, v163
    ds_write2_b64 v21, v[156:157], v[158:159] offset0:0 offset1:4
    s_waitcnt lgkmcnt(0)
    s_barrier
F_end:
    s_endpgm
F_loader:
    s_mov_b32 s48, 0x76542130
    s_mov_b32 s49, 0xfedca9b8
    s_cmp_eq_u32 s35, 1
    s_cselect_b32 s48, 0x75463021, s48
    s_cselect_b32 s49, 0xfdceba98, s49
    s_cmp_eq_u32 s35, 2
    s_cselect_b32 s48, 0x96543102, s48
    s_cselect_b32 s49, 0xfedcba87, s49
    s_cmp_eq_u32 s35, 3
    s_cselect_b32 s48, 0x76532410, s48
    s_cselect_b32 s49, 0xfedbac98, s49
    s_cmp_eq_u32 s35, 4
    s_cselect_b32 s48, 0x65743021, s48
    s_cselect_b32 s49, 0xedfcba98, s49
    s_cmp_eq_u32 s35, 5
    s_cselect_b32 s48, 0x76543102, s48
    s_cselect_b32 s49, 0xfedcb98a, s49
    s_cmp_eq_u32 s35, 6
    s_cselect_b32 s48, 0x76435210, s48
    s_cselect_b32 s49, 0xfecbda98, s49
    s_cmp_eq_u32 s35, 7
    s_cselect_b32 s48, 0x68543021, s48
    s_cselect_b32 s49, 0xfedcba97, s49
    s_setprio 0
    s_sub_u32 s3, s3, 8
    v_lshrrev_b32 v2, 3, v0
    v_and_b32 v3, 7, v0
    v_lshrrev_b32 v4, 1, v2
    v_xor_b32 v5, v3, v4
    v_xor_b32 v6, 4, v5
    v_lshlrev_b32 v5, 4, v5
    v_lshlrev_b32 v6, 4, v6
    v_lshlrev_b32 v7, 11, v2
    v_add_u32 v12, v5, v7
    v_add_u32 v13, v6, v7
    v_and_b32 v4, 1, v4
    v_lshlrev_b32 v4, 1, v4
    v_xor_b32 v8, v3, v4
    v_xor_b32 v9, 4, v8
    v_lshlrev_b32 v8, 4, v8
    v_lshlrev_b32 v9, 4, v9
    v_mul_u32_u24 v7, 6144, v2
    v_add_u32 v14, v8, v7
    v_add_u32_e64 v15, v9, v7
    s_lshl_b32 s36, s32, 18
    s_lshl_b32 s37, s3, 16
    s_add_u32 s36, s36, s37
    s_lshl_b32 s38, s33, 7
    s_mul_i32 s37, s3, 98304
    s_add_u32 s38, s38, s37
    s_sub_u32 s47, s10, s33
    s_lshl_b32 s47, s47, 7
    s_and_b32 s42, s39, 8
    s_and_b32 s43, s30, 6
    s_or_b32 s42, s42, s43
    s_and_b32 s43, s34, 0
    s_lshl_b32 s43, s43, 0
    s_xor_b32 s42, s42, s43
    s_lshl_b32 s44, s3, 12
    s_lshl_b32 s45, s3, 11
    s_waitcnt lgkmcnt(0)
    s_mov_b32 s12, s4
    s_mov_b32 s13, s5
    s_mov_b32 s14, 0x400000
    s_mov_b32 s15, 0x00020000
    s_mov_b32 s16, s6
    s_mov_b32 s17, s7
    s_mov_b32 s18, 0x600000
    s_mov_b32 s19, 0x00020000
    s_bfe_u32 s40, s48, 0x40000
    s_bitcmp1_b32 s40, 3
    s_cselect_b32 s41, s39, s42
    s_xor_b32 s40, s40, s41
    s_mul_i32 s41, s40, 393216
    s_add_u32 s41, s41, s38
    s_lshl_b32 s40, s40, 7
    s_add_u32 s40, s40, s36
    s_add_u32 m0, s44, 0
    s_add_u32 s46, s40, 0
    buffer_load_dwordx4 v12, s[12:15], s46 offen lds
    s_add_u32 m0, s45, 24576
    s_add_u32 s46, s41, 2048
    buffer_load_dwordx4 v14, s[16:19], s46 offen lds
    s_add_u32 m0, s45, 25600
    s_add_u32 s46, s41, 51200
    buffer_load_dwordx4 v15, s[16:19], s46 offen lds
    s_add_u32 m0, s45, 16384
    s_add_u32 s46, s41, 0
    s_add_u32 s46, s46, s47
    buffer_load_dwordx4 v14, s[16:19], s46 offen lds
    s_add_u32 m0, s45, 17408
    s_add_u32 s46, s41, 49152
    s_add_u32 s46, s46, s47
    s_nop 0
    buffer_load_dwordx4 v15, s[16:19], s46 offen lds
    s_add_u32 m0, s45, 32768
    s_add_u32 s46, s41, 4096
    buffer_load_dwordx4 v14, s[16:19], s46 offen lds
    s_add_u32 m0, s45, 33792
    s_add_u32 s46, s41, 53248
    buffer_load_dwordx4 v15, s[16:19], s46 offen lds
    s_add_u32 m0, s44, 1024
    s_add_u32 s46, s40, 16384
    buffer_load_dwordx4 v13, s[12:15], s46 offen lds
    s_add_u32 m0, s44, 2048
    s_add_u32 s46, s40, 32768
    buffer_load_dwordx4 v12, s[12:15], s46 offen lds
    s_add_u32 m0, s44, 3072
    s_add_u32 s46, s40, 49152
    buffer_load_dwordx4 v13, s[12:15], s46 offen lds
    s_bfe_u32 s40, s48, 0x40004
    s_bitcmp1_b32 s40, 3
    s_cselect_b32 s41, s39, s42
    s_xor_b32 s40, s40, s41
    s_mul_i32 s41, s40, 393216
    s_add_u32 s41, s41, s38
    s_lshl_b32 s40, s40, 7
    s_add_u32 s40, s40, s36
    s_add_u32 m0, s44, 40960
    s_add_u32 s46, s40, 0
    s_nop 0
    buffer_load_dwordx4 v12, s[12:15], s46 offen lds
    s_add_u32 m0, s45, 65536
    s_add_u32 s46, s41, 2048
    buffer_load_dwordx4 v14, s[16:19], s46 offen lds
    s_add_u32 m0, s45, 66560
    s_add_u32 s46, s41, 51200
    buffer_load_dwordx4 v15, s[16:19], s46 offen lds
    s_add_u32 m0, s45, 57344
    s_add_u32 s46, s41, 0
    s_add_u32 s46, s46, s47
    buffer_load_dwordx4 v14, s[16:19], s46 offen lds
    s_add_u32 m0, s45, 58368
    s_add_u32 s46, s41, 49152
    s_add_u32 s46, s46, s47
    s_nop 0
    buffer_load_dwordx4 v15, s[16:19], s46 offen lds
    s_add_u32 m0, s45, 73728
    s_add_u32 s46, s41, 4096
    buffer_load_dwordx4 v14, s[16:19], s46 offen lds
    s_add_u32 m0, s45, 74752
    s_add_u32 s46, s41, 53248
    buffer_load_dwordx4 v15, s[16:19], s46 offen lds
    s_add_u32 m0, s44, 41984
    s_add_u32 s46, s40, 16384
    buffer_load_dwordx4 v13, s[12:15], s46 offen lds
    s_waitcnt vmcnt(8)
    s_barrier
    s_add_u32 m0, s44, 43008
    s_add_u32 s46, s40, 32768
    buffer_load_dwordx4 v12, s[12:15], s46 offen lds
    s_add_u32 m0, s44, 44032
    s_add_u32 s46, s40, 49152
    buffer_load_dwordx4 v13, s[12:15], s46 offen lds
    s_bfe_u32 s40, s48, 0x40008
    s_bitcmp1_b32 s40, 3
    s_cselect_b32 s41, s39, s42
    s_xor_b32 s40, s40, s41
    s_mul_i32 s41, s40, 393216
    s_add_u32 s41, s41, s38
    s_lshl_b32 s40, s40, 7
    s_add_u32 s40, s40, s36
    s_add_u32 m0, s44, 81920
    s_add_u32 s46, s40, 0
    s_nop 0
    buffer_load_dwordx4 v12, s[12:15], s46 offen lds
    s_add_u32 m0, s45, 106496
    s_add_u32 s46, s41, 2048
    buffer_load_dwordx4 v14, s[16:19], s46 offen lds
    s_add_u32 m0, s45, 107520
    s_add_u32 s46, s41, 51200
    buffer_load_dwordx4 v15, s[16:19], s46 offen lds
    s_add_u32 m0, s45, 98304
    s_add_u32 s46, s41, 0
    s_add_u32 s46, s46, s47
    buffer_load_dwordx4 v14, s[16:19], s46 offen lds
    s_add_u32 m0, s45, 99328
    s_add_u32 s46, s41, 49152
    s_add_u32 s46, s46, s47
    s_nop 0
    buffer_load_dwordx4 v15, s[16:19], s46 offen lds
    s_add_u32 m0, s45, 114688
    s_add_u32 s46, s41, 4096
    buffer_load_dwordx4 v14, s[16:19], s46 offen lds
    s_add_u32 m0, s45, 115712
    s_add_u32 s46, s41, 53248
    buffer_load_dwordx4 v15, s[16:19], s46 offen lds
    s_add_u32 m0, s44, 82944
    s_add_u32 s46, s40, 16384
    buffer_load_dwordx4 v13, s[12:15], s46 offen lds
    s_add_u32 m0, s44, 83968
    s_add_u32 s46, s40, 32768
    buffer_load_dwordx4 v12, s[12:15], s46 offen lds
    s_add_u32 m0, s44, 84992
    s_add_u32 s46, s40, 49152
    buffer_load_dwordx4 v13, s[12:15], s46 offen lds
    s_waitcnt vmcnt(10)
    s_barrier
    s_bfe_u32 s40, s48, 0x4000c
    s_bitcmp1_b32 s40, 3
    s_cselect_b32 s41, s39, s42
    s_xor_b32 s40, s40, s41
    s_mul_i32 s41, s40, 393216
    s_add_u32 s41, s41, s38
    s_lshl_b32 s40, s40, 7
    s_add_u32 s40, s40, s36
    s_add_u32 m0, s44, 122880
    s_add_u32 s46, s40, 0
    s_nop 0
    buffer_load_dwordx4 v12, s[12:15], s46 offen lds
    s_add_u32 m0, s45, 147456
    s_add_u32 s46, s41, 2048
    buffer_load_dwordx4 v14, s[16:19], s46 offen lds
    s_add_u32 m0, s45, 148480
    s_add_u32 s46, s41, 51200
    buffer_load_dwordx4 v15, s[16:19], s46 offen lds
    s_add_u32 m0, s45, 139264
    s_add_u32 s46, s41, 0
    s_add_u32 s46, s46, s47
    buffer_load_dwordx4 v14, s[16:19], s46 offen lds
    s_add_u32 m0, s45, 140288
    s_add_u32 s46, s41, 49152
    s_add_u32 s46, s46, s47
    s_nop 0
    buffer_load_dwordx4 v15, s[16:19], s46 offen lds
    s_add_u32 m0, s45, 155648
    s_add_u32 s46, s41, 4096
    buffer_load_dwordx4 v14, s[16:19], s46 offen lds
    s_add_u32 m0, s45, 156672
    s_add_u32 s46, s41, 53248
    buffer_load_dwordx4 v15, s[16:19], s46 offen lds
    s_add_u32 m0, s44, 123904
    s_add_u32 s46, s40, 16384
    buffer_load_dwordx4 v13, s[12:15], s46 offen lds
    s_add_u32 m0, s44, 124928
    s_add_u32 s46, s40, 32768
    buffer_load_dwordx4 v12, s[12:15], s46 offen lds
    s_add_u32 m0, s44, 125952
    s_add_u32 s46, s40, 49152
    buffer_load_dwordx4 v13, s[12:15], s46 offen lds
    s_bfe_u32 s40, s48, 0x40010
    s_bitcmp1_b32 s40, 3
    s_cselect_b32 s41, s39, s42
    s_xor_b32 s40, s40, s41
    s_mul_i32 s41, s40, 393216
    s_add_u32 s41, s41, s38
    s_lshl_b32 s40, s40, 7
    s_add_u32 s40, s40, s36
    s_add_u32 m0, s44, 0
    s_add_u32 s46, s40, 0
    buffer_load_dwordx4 v12, s[12:15], s46 offen lds
    s_add_u32 m0, s45, 24576
    s_add_u32 s46, s41, 2048
    buffer_load_dwordx4 v14, s[16:19], s46 offen lds
    s_waitcnt vmcnt(12)
    s_barrier
    s_add_u32 m0, s45, 25600
    s_add_u32 s46, s41, 51200
    buffer_load_dwordx4 v15, s[16:19], s46 offen lds
    s_add_u32 m0, s45, 16384
    s_add_u32 s46, s41, 0
    s_add_u32 s46, s46, s47
    buffer_load_dwordx4 v14, s[16:19], s46 offen lds
    s_add_u32 m0, s45, 17408
    s_add_u32 s46, s41, 49152
    s_add_u32 s46, s46, s47
    s_nop 0
    buffer_load_dwordx4 v15, s[16:19], s46 offen lds
    s_add_u32 m0, s45, 32768
    s_add_u32 s46, s41, 4096
    buffer_load_dwordx4 v14, s[16:19], s46 offen lds
    s_add_u32 m0, s45, 33792
    s_add_u32 s46, s41, 53248
    buffer_load_dwordx4 v15, s[16:19], s46 offen lds
    s_add_u32 m0, s44, 1024
    s_add_u32 s46, s40, 16384
    buffer_load_dwordx4 v13, s[12:15], s46 offen lds
    s_add_u32 m0, s44, 2048
    s_add_u32 s46, s40, 32768
    buffer_load_dwordx4 v12, s[12:15], s46 offen lds
    s_add_u32 m0, s44, 3072
    s_add_u32 s46, s40, 49152
    buffer_load_dwordx4 v13, s[12:15], s46 offen lds
    s_bfe_u32 s40, s48, 0x40014
    s_bitcmp1_b32 s40, 3
    s_cselect_b32 s41, s39, s42
    s_xor_b32 s40, s40, s41
    s_mul_i32 s41, s40, 393216
    s_add_u32 s41, s41, s38
    s_lshl_b32 s40, s40, 7
    s_add_u32 s40, s40, s36
    s_add_u32 m0, s44, 40960
    s_add_u32 s46, s40, 0
    s_nop 0
    buffer_load_dwordx4 v12, s[12:15], s46 offen lds
    s_add_u32 m0, s45, 65536
    s_add_u32 s46, s41, 2048
    buffer_load_dwordx4 v14, s[16:19], s46 offen lds
    s_add_u32 m0, s45, 66560
    s_add_u32 s46, s41, 51200
    buffer_load_dwordx4 v15, s[16:19], s46 offen lds
    s_add_u32 m0, s45, 57344
    s_add_u32 s46, s41, 0
    s_add_u32 s46, s46, s47
    buffer_load_dwordx4 v14, s[16:19], s46 offen lds
    s_waitcnt vmcnt(14)
    s_barrier
    s_add_u32 m0, s45, 58368
    s_add_u32 s46, s41, 49152
    s_add_u32 s46, s46, s47
    s_nop 0
    buffer_load_dwordx4 v15, s[16:19], s46 offen lds
    s_add_u32 m0, s45, 73728
    s_add_u32 s46, s41, 4096
    buffer_load_dwordx4 v14, s[16:19], s46 offen lds
    s_add_u32 m0, s45, 74752
    s_add_u32 s46, s41, 53248
    buffer_load_dwordx4 v15, s[16:19], s46 offen lds
    s_add_u32 m0, s44, 41984
    s_add_u32 s46, s40, 16384
    buffer_load_dwordx4 v13, s[12:15], s46 offen lds
    s_add_u32 m0, s44, 43008
    s_add_u32 s46, s40, 32768
    buffer_load_dwordx4 v12, s[12:15], s46 offen lds
    s_add_u32 m0, s44, 44032
    s_add_u32 s46, s40, 49152
    buffer_load_dwordx4 v13, s[12:15], s46 offen lds
    s_bfe_u32 s40, s48, 0x40018
    s_bitcmp1_b32 s40, 3
    s_cselect_b32 s41, s39, s42
    s_xor_b32 s40, s40, s41
    s_mul_i32 s41, s40, 393216
    s_add_u32 s41, s41, s38
    s_lshl_b32 s40, s40, 7
    s_add_u32 s40, s40, s36
    s_add_u32 m0, s44, 81920
    s_add_u32 s46, s40, 0
    s_nop 0
    buffer_load_dwordx4 v12, s[12:15], s46 offen lds
    s_add_u32 m0, s45, 106496
    s_add_u32 s46, s41, 2048
    buffer_load_dwordx4 v14, s[16:19], s46 offen lds
    s_add_u32 m0, s45, 107520
    s_add_u32 s46, s41, 51200
    buffer_load_dwordx4 v15, s[16:19], s46 offen lds
    s_add_u32 m0, s45, 98304
    s_add_u32 s46, s41, 0
    s_add_u32 s46, s46, s47
    buffer_load_dwordx4 v14, s[16:19], s46 offen lds
    s_add_u32 m0, s45, 99328
    s_add_u32 s46, s41, 49152
    s_add_u32 s46, s46, s47
    buffer_load_dwordx4 v15, s[16:19], s46 offen lds
    s_add_u32 m0, s45, 114688
    s_add_u32 s46, s41, 4096
    buffer_load_dwordx4 v14, s[16:19], s46 offen lds
    s_waitcnt vmcnt(16)
    s_barrier
    s_nop 0
    s_add_u32 m0, s45, 115712
    s_add_u32 s46, s41, 53248
    buffer_load_dwordx4 v15, s[16:19], s46 offen lds
    s_add_u32 m0, s44, 82944
    s_add_u32 s46, s40, 16384
    buffer_load_dwordx4 v13, s[12:15], s46 offen lds
    s_add_u32 m0, s44, 83968
    s_add_u32 s46, s40, 32768
    buffer_load_dwordx4 v12, s[12:15], s46 offen lds
    s_add_u32 m0, s44, 84992
    s_add_u32 s46, s40, 49152
    buffer_load_dwordx4 v13, s[12:15], s46 offen lds
    s_bfe_u32 s40, s48, 0x4001c
    s_bitcmp1_b32 s40, 3
    s_cselect_b32 s41, s39, s42
    s_xor_b32 s40, s40, s41
    s_mul_i32 s41, s40, 393216
    s_add_u32 s41, s41, s38
    s_lshl_b32 s40, s40, 7
    s_add_u32 s40, s40, s36
    s_add_u32 m0, s44, 122880
    s_add_u32 s46, s40, 0
    s_nop 0
    buffer_load_dwordx4 v12, s[12:15], s46 offen lds
    s_add_u32 m0, s45, 147456
    s_add_u32 s46, s41, 2048
    buffer_load_dwordx4 v14, s[16:19], s46 offen lds
    s_add_u32 m0, s45, 148480
    s_add_u32 s46, s41, 51200
    buffer_load_dwordx4 v15, s[16:19], s46 offen lds
    s_add_u32 m0, s45, 139264
    s_add_u32 s46, s41, 0
    s_add_u32 s46, s46, s47
    buffer_load_dwordx4 v14, s[16:19], s46 offen lds
    s_add_u32 m0, s45, 140288
    s_add_u32 s46, s41, 49152
    s_add_u32 s46, s46, s47
    s_nop 0
    buffer_load_dwordx4 v15, s[16:19], s46 offen lds
    s_add_u32 m0, s45, 155648
    s_add_u32 s46, s41, 4096
    buffer_load_dwordx4 v14, s[16:19], s46 offen lds
    s_add_u32 m0, s45, 156672
    s_add_u32 s46, s41, 53248
    buffer_load_dwordx4 v15, s[16:19], s46 offen lds
    s_add_u32 m0, s44, 123904
    s_add_u32 s46, s40, 16384
    buffer_load_dwordx4 v13, s[12:15], s46 offen lds
    s_waitcnt vmcnt(18)
    s_barrier
    s_add_u32 m0, s44, 124928
    s_add_u32 s46, s40, 32768
    buffer_load_dwordx4 v12, s[12:15], s46 offen lds
    s_add_u32 m0, s44, 125952
    s_add_u32 s46, s40, 49152
    buffer_load_dwordx4 v13, s[12:15], s46 offen lds
    s_bfe_u32 s40, s49, 0x40000
    s_bitcmp1_b32 s40, 3
    s_cselect_b32 s41, s39, s42
    s_xor_b32 s40, s40, s41
    s_mul_i32 s41, s40, 393216
    s_add_u32 s41, s41, s38
    s_lshl_b32 s40, s40, 7
    s_add_u32 s40, s40, s36
    s_add_u32 m0, s44, 0
    s_add_u32 s46, s40, 0
    buffer_load_dwordx4 v12, s[12:15], s46 offen lds
    s_add_u32 m0, s45, 24576
    s_add_u32 s46, s41, 2048
    buffer_load_dwordx4 v14, s[16:19], s46 offen lds
    s_add_u32 m0, s45, 25600
    s_add_u32 s46, s41, 51200
    buffer_load_dwordx4 v15, s[16:19], s46 offen lds
    s_add_u32 m0, s45, 16384
    s_add_u32 s46, s41, 0
    s_add_u32 s46, s46, s47
    buffer_load_dwordx4 v14, s[16:19], s46 offen lds
    s_add_u32 m0, s45, 17408
    s_add_u32 s46, s41, 49152
    s_add_u32 s46, s46, s47
    s_nop 0
    buffer_load_dwordx4 v15, s[16:19], s46 offen lds
    s_add_u32 m0, s45, 32768
    s_add_u32 s46, s41, 4096
    buffer_load_dwordx4 v14, s[16:19], s46 offen lds
    s_add_u32 m0, s45, 33792
    s_add_u32 s46, s41, 53248
    buffer_load_dwordx4 v15, s[16:19], s46 offen lds
    s_add_u32 m0, s44, 1024
    s_add_u32 s46, s40, 16384
    buffer_load_dwordx4 v13, s[12:15], s46 offen lds
    s_add_u32 m0, s44, 2048
    s_add_u32 s46, s40, 32768
    buffer_load_dwordx4 v12, s[12:15], s46 offen lds
    s_add_u32 m0, s44, 3072
    s_add_u32 s46, s40, 49152
    buffer_load_dwordx4 v13, s[12:15], s46 offen lds
    s_waitcnt vmcnt(20)
    s_barrier
    s_bfe_u32 s40, s49, 0x40004
    s_bitcmp1_b32 s40, 3
    s_cselect_b32 s41, s39, s42
    s_xor_b32 s40, s40, s41
    s_mul_i32 s41, s40, 393216
    s_add_u32 s41, s41, s38
    s_lshl_b32 s40, s40, 7
    s_add_u32 s40, s40, s36
    s_add_u32 m0, s44, 40960
    s_add_u32 s46, s40, 0
    s_nop 0
    buffer_load_dwordx4 v12, s[12:15], s46 offen lds
    s_add_u32 m0, s45, 65536
    s_add_u32 s46, s41, 2048
    buffer_load_dwordx4 v14, s[16:19], s46 offen lds
    s_add_u32 m0, s45, 66560
    s_add_u32 s46, s41, 51200
    buffer_load_dwordx4 v15, s[16:19], s46 offen lds
    s_add_u32 m0, s45, 57344
    s_add_u32 s46, s41, 0
    s_add_u32 s46, s46, s47
    buffer_load_dwordx4 v14, s[16:19], s46 offen lds
    s_add_u32 m0, s45, 58368
    s_add_u32 s46, s41, 49152
    s_add_u32 s46, s46, s47
    s_nop 0
    buffer_load_dwordx4 v15, s[16:19], s46 offen lds
    s_add_u32 m0, s45, 73728
    s_add_u32 s46, s41, 4096
    buffer_load_dwordx4 v14, s[16:19], s46 offen lds
    s_add_u32 m0, s45, 74752
    s_add_u32 s46, s41, 53248
    buffer_load_dwordx4 v15, s[16:19], s46 offen lds
    s_add_u32 m0, s44, 41984
    s_add_u32 s46, s40, 16384
    buffer_load_dwordx4 v13, s[12:15], s46 offen lds
    s_add_u32 m0, s44, 43008
    s_add_u32 s46, s40, 32768
    buffer_load_dwordx4 v12, s[12:15], s46 offen lds
    s_add_u32 m0, s44, 44032
    s_add_u32 s46, s40, 49152
    buffer_load_dwordx4 v13, s[12:15], s46 offen lds
    s_mov_b32 s20, s8
    s_mov_b32 s21, s9
    s_mov_b32 s22, 0x200000
    s_mov_b32 s23, 0x00020000
    s_lshl_b32 s50, s2, 13
    s_lshl_b32 s51, s3, 11
    s_add_u32 s50, s50, s51
    v_lshlrev_b32 v104, 7, v0
    s_mov_b64 exec, 0xffff
    buffer_load_dword v112, v104, s[20:23], s50 offen
    s_mov_b64 exec, -1

    s_waitcnt vmcnt(21)
    s_barrier
    s_bfe_u32 s40, s49, 0x40008
    s_bitcmp1_b32 s40, 3
    s_cselect_b32 s41, s39, s42
    s_xor_b32 s40, s40, s41
    s_mul_i32 s41, s40, 393216
    s_add_u32 s41, s41, s38
    s_lshl_b32 s40, s40, 7
    s_add_u32 s40, s40, s36
    s_add_u32 m0, s44, 81920
    s_add_u32 s46, s40, 0
    buffer_load_dwordx4 v12, s[12:15], s46 offen lds
    s_add_u32 m0, s45, 106496
    s_add_u32 s46, s41, 2048
    buffer_load_dwordx4 v14, s[16:19], s46 offen lds
    s_add_u32 m0, s45, 107520
    s_add_u32 s46, s41, 51200
    buffer_load_dwordx4 v15, s[16:19], s46 offen lds
    s_add_u32 m0, s45, 98304
    s_add_u32 s46, s41, 0
    s_add_u32 s46, s46, s47
    buffer_load_dwordx4 v14, s[16:19], s46 offen lds
    s_add_u32 m0, s45, 99328
    s_add_u32 s46, s41, 49152
    s_add_u32 s46, s46, s47
    s_nop 0
    buffer_load_dwordx4 v15, s[16:19], s46 offen lds
    s_add_u32 m0, s45, 114688
    s_add_u32 s46, s41, 4096
    buffer_load_dwordx4 v14, s[16:19], s46 offen lds
    s_add_u32 m0, s45, 115712
    s_add_u32 s46, s41, 53248
    buffer_load_dwordx4 v15, s[16:19], s46 offen lds
    s_add_u32 m0, s44, 82944
    s_add_u32 s46, s40, 16384
    buffer_load_dwordx4 v13, s[12:15], s46 offen lds
    s_add_u32 m0, s44, 83968
    s_add_u32 s46, s40, 32768
    buffer_load_dwordx4 v12, s[12:15], s46 offen lds
    s_add_u32 m0, s44, 84992
    s_add_u32 s46, s40, 49152
    buffer_load_dwordx4 v13, s[12:15], s46 offen lds
    s_waitcnt vmcnt(21)
    s_barrier
    s_bfe_u32 s40, s49, 0x4000c
    s_bitcmp1_b32 s40, 3
    s_cselect_b32 s41, s39, s42
    s_xor_b32 s40, s40, s41
    s_mul_i32 s41, s40, 393216
    s_add_u32 s41, s41, s38
    s_lshl_b32 s40, s40, 7
    s_add_u32 s40, s40, s36
    s_add_u32 m0, s44, 122880
    s_add_u32 s46, s40, 0
    s_nop 0
    buffer_load_dwordx4 v12, s[12:15], s46 offen lds
    s_add_u32 m0, s45, 147456
    s_add_u32 s46, s41, 2048
    buffer_load_dwordx4 v14, s[16:19], s46 offen lds
    s_add_u32 m0, s45, 148480
    s_add_u32 s46, s41, 51200
    buffer_load_dwordx4 v15, s[16:19], s46 offen lds
    s_add_u32 m0, s45, 139264
    s_add_u32 s46, s41, 0
    s_add_u32 s46, s46, s47
    buffer_load_dwordx4 v14, s[16:19], s46 offen lds
    s_add_u32 m0, s45, 140288
    s_add_u32 s46, s41, 49152
    s_add_u32 s46, s46, s47
    s_nop 0
    buffer_load_dwordx4 v15, s[16:19], s46 offen lds
    s_add_u32 m0, s45, 155648
    s_add_u32 s46, s41, 4096
    buffer_load_dwordx4 v14, s[16:19], s46 offen lds
    s_add_u32 m0, s45, 156672
    s_add_u32 s46, s41, 53248
    buffer_load_dwordx4 v15, s[16:19], s46 offen lds
    s_add_u32 m0, s44, 123904
    s_add_u32 s46, s40, 16384
    buffer_load_dwordx4 v13, s[12:15], s46 offen lds
    s_add_u32 m0, s44, 124928
    s_add_u32 s46, s40, 32768
    buffer_load_dwordx4 v12, s[12:15], s46 offen lds
    s_add_u32 m0, s44, 125952
    s_add_u32 s46, s40, 49152
    buffer_load_dwordx4 v13, s[12:15], s46 offen lds
    s_waitcnt vmcnt(21)
    s_barrier
    s_bfe_u32 s40, s49, 0x40010
W_5:
    s_cbranch_execz R_5
    s_nop 0
    s_bitcmp1_b32 s40, 3
    s_cselect_b32 s41, s39, s42
    s_xor_b32 s40, s40, s41
    s_mul_i32 s41, s40, 393216
    s_add_u32 s41, s41, s38
    s_lshl_b32 s40, s40, 7
    s_add_u32 s40, s40, s36
    s_add_u32 m0, s44, 0
    s_add_u32 s46, s40, 0
    buffer_load_dwordx4 v12, s[12:15], s46 offen lds
    s_add_u32 m0, s45, 24576
    s_add_u32 s46, s41, 2048
    buffer_load_dwordx4 v14, s[16:19], s46 offen lds
    s_add_u32 m0, s45, 25600
    s_add_u32 s46, s41, 51200
    buffer_load_dwordx4 v15, s[16:19], s46 offen lds
    s_add_u32 m0, s45, 16384
    s_add_u32 s46, s41, 0
    s_add_u32 s46, s46, s47
    buffer_load_dwordx4 v14, s[16:19], s46 offen lds
    s_add_u32 m0, s45, 17408
    s_add_u32 s46, s41, 49152
    s_add_u32 s46, s46, s47
    s_nop 0
    buffer_load_dwordx4 v15, s[16:19], s46 offen lds
    s_add_u32 m0, s45, 32768
    s_add_u32 s46, s41, 4096
    buffer_load_dwordx4 v14, s[16:19], s46 offen lds
    s_add_u32 m0, s45, 33792
    s_add_u32 s46, s41, 53248
    buffer_load_dwordx4 v15, s[16:19], s46 offen lds
    s_add_u32 m0, s44, 1024
    s_add_u32 s46, s40, 16384
    buffer_load_dwordx4 v13, s[12:15], s46 offen lds
    s_add_u32 m0, s44, 2048
    s_add_u32 s46, s40, 32768
    buffer_load_dwordx4 v12, s[12:15], s46 offen lds
    s_add_u32 m0, s44, 3072
    s_add_u32 s46, s40, 49152
    buffer_load_dwordx4 v13, s[12:15], s46 offen lds
    s_waitcnt vmcnt(20)
    s_barrier
    s_bfe_u32 s40, s49, 0x40014
    s_bitcmp1_b32 s40, 3
    s_cselect_b32 s41, s39, s42
    s_xor_b32 s40, s40, s41
    s_mul_i32 s41, s40, 393216
    s_add_u32 s41, s41, s38
    s_lshl_b32 s40, s40, 7
    s_add_u32 s40, s40, s36
    s_add_u32 m0, s44, 40960
    s_add_u32 s46, s40, 0
    s_nop 0
    buffer_load_dwordx4 v12, s[12:15], s46 offen lds
    s_add_u32 m0, s45, 65536
    s_add_u32 s46, s41, 2048
    buffer_load_dwordx4 v14, s[16:19], s46 offen lds
    s_add_u32 m0, s45, 66560
    s_add_u32 s46, s41, 51200
    buffer_load_dwordx4 v15, s[16:19], s46 offen lds
    s_add_u32 m0, s45, 57344
    s_add_u32 s46, s41, 0
    s_add_u32 s46, s46, s47
    buffer_load_dwordx4 v14, s[16:19], s46 offen lds
    s_add_u32 m0, s45, 58368
    s_add_u32 s46, s41, 49152
    s_add_u32 s46, s46, s47
    s_nop 0
    buffer_load_dwordx4 v15, s[16:19], s46 offen lds
    s_add_u32 m0, s45, 73728
    s_add_u32 s46, s41, 4096
    buffer_load_dwordx4 v14, s[16:19], s46 offen lds
    s_add_u32 m0, s45, 74752
    s_add_u32 s46, s41, 53248
    buffer_load_dwordx4 v15, s[16:19], s46 offen lds
    s_add_u32 m0, s44, 41984
    s_add_u32 s46, s40, 16384
    buffer_load_dwordx4 v13, s[12:15], s46 offen lds
    s_add_u32 m0, s44, 43008
    s_add_u32 s46, s40, 32768
    buffer_load_dwordx4 v12, s[12:15], s46 offen lds
    s_add_u32 m0, s44, 44032
    s_add_u32 s46, s40, 49152
    buffer_load_dwordx4 v13, s[12:15], s46 offen lds
    v_lshlrev_b32_e64 v10, 4, v0
    s_add_u32 s68, s72, 0x900000
    s_addc_u32 s69, s73, 0
    s_mov_b32 s70, 0x18000
    s_mov_b32 s71, 0x00020000
    s_lshl_b32 s52, s32, 11
    s_add_u32 s52, s52, 65536
    s_lshl_b32 s76, s3, 2
    s_add_u32 s52, s52, s76
    s_lshl_b32 s76, s3, 9
    s_add_u32 s58, s76, 24832

    s_waitcnt vmcnt(20)
    s_barrier
    s_bfe_u32 s40, s49, 0x40018
    s_bitcmp1_b32 s40, 3
    s_cselect_b32 s41, s39, s42
    s_xor_b32 s40, s40, s41
    s_mul_i32 s41, s40, 393216
    s_add_u32 s41, s41, s38
    s_lshl_b32 s40, s40, 7
    s_add_u32 s40, s40, s36
    s_add_u32 m0, s44, 81920
    s_add_u32 s46, s40, 0
    buffer_load_dwordx4 v12, s[12:15], s46 offen lds
    s_add_u32 m0, s45, 106496
    s_add_u32 s46, s41, 2048
    buffer_load_dwordx4 v14, s[16:19], s46 offen lds
    s_add_u32 m0, s45, 107520
    s_add_u32 s46, s41, 51200
    buffer_load_dwordx4 v15, s[16:19], s46 offen lds
    s_add_u32 m0, s45, 98304
    s_add_u32 s46, s41, 0
    s_add_u32 s46, s46, s47
    buffer_load_dwordx4 v14, s[16:19], s46 offen lds
    s_add_u32 m0, s45, 99328
    s_add_u32 s46, s41, 49152
    s_add_u32 s46, s46, s47
    s_nop 0
    buffer_load_dwordx4 v15, s[16:19], s46 offen lds
    s_add_u32 m0, s45, 114688
    s_add_u32 s46, s41, 4096
    buffer_load_dwordx4 v14, s[16:19], s46 offen lds
    s_add_u32 m0, s45, 115712
    s_add_u32 s46, s41, 53248
    buffer_load_dwordx4 v15, s[16:19], s46 offen lds
    s_add_u32 m0, s44, 82944
    s_add_u32 s46, s40, 16384
    buffer_load_dwordx4 v13, s[12:15], s46 offen lds
    s_add_u32 m0, s44, 83968
    s_add_u32 s46, s40, 32768
    buffer_load_dwordx4 v12, s[12:15], s46 offen lds
    s_add_u32 m0, s44, 84992
    s_add_u32 s46, s40, 49152
    buffer_load_dwordx4 v13, s[12:15], s46 offen lds
    s_add_u32 s84, s72, 0xb00000
    s_addc_u32 s85, s73, 0
    s_mov_b32 s86, 0x30000
    s_mov_b32 s87, 0x00020000
    v_bfe_u32 v113, v0, 2, 2
    v_min_u32 v113, 2, v113
    v_lshlrev_b32 v114, 8, v113
    v_lshlrev_b32 v113, 12, v113
    v_and_b32 v112, 3, v0
    v_lshl_add_u32 v113, v112, 4, v113
    v_lshl_add_u32 v114, v112, 4, v114
    v_lshrrev_b32 v112, 4, v0
    v_mul_u32_u24 v112, 12288, v112
    v_add_u32 v113, v113, v112
    s_lshl_b32 s76, s3, 6
    s_lshl_b32 s53, s33, 8
    s_add_u32 s53, s53, s76
    s_add_u32 s76, s76, 26368
    v_add_u32 v114, s76, v114

    s_waitcnt vmcnt(20)
    s_barrier
    s_bfe_u32 s40, s49, 0x4001c
    s_bitcmp1_b32 s40, 3
    s_cselect_b32 s41, s39, s42
    s_xor_b32 s40, s40, s41
    s_mul_i32 s41, s40, 393216
    s_add_u32 s41, s41, s38
    s_lshl_b32 s40, s40, 7
    s_add_u32 s40, s40, s36
    s_add_u32 m0, s44, 122880
    s_add_u32 s46, s40, 0
    buffer_load_dwordx4 v12, s[12:15], s46 offen lds
    s_add_u32 m0, s45, 147456
    s_add_u32 s46, s41, 2048
    buffer_load_dwordx4 v14, s[16:19], s46 offen lds
    s_add_u32 m0, s45, 148480
    s_add_u32 s46, s41, 51200
    buffer_load_dwordx4 v15, s[16:19], s46 offen lds
    s_add_u32 m0, s45, 139264
    s_add_u32 s46, s41, 0
    s_add_u32 s46, s46, s47
    buffer_load_dwordx4 v14, s[16:19], s46 offen lds
    s_add_u32 m0, s45, 140288
    s_add_u32 s46, s41, 49152
    s_add_u32 s46, s46, s47
    s_nop 0
    buffer_load_dwordx4 v15, s[16:19], s46 offen lds
    s_add_u32 m0, s45, 155648
    s_add_u32 s46, s41, 4096
    buffer_load_dwordx4 v14, s[16:19], s46 offen lds
    s_add_u32 m0, s45, 156672
    s_add_u32 s46, s41, 53248
    buffer_load_dwordx4 v15, s[16:19], s46 offen lds
    s_add_u32 m0, s44, 123904
    s_add_u32 s46, s40, 16384
    buffer_load_dwordx4 v13, s[12:15], s46 offen lds
    s_add_u32 m0, s44, 124928
    s_add_u32 s46, s40, 32768
    buffer_load_dwordx4 v12, s[12:15], s46 offen lds
    s_add_u32 m0, s44, 125952
    s_add_u32 s46, s40, 49152
    buffer_load_dwordx4 v13, s[12:15], s46 offen lds
    s_add_u32 s76, s53, 0
    s_nop 0
    buffer_load_dwordx4 v[72:75], v113, s[84:87], s76 offen sc0 sc1
    s_add_u32 s76, s53, 49152
    buffer_load_dwordx4 v[76:79], v113, s[84:87], s76 offen sc0 sc1
    s_add_u32 s76, s53, 98304
    buffer_load_dwordx4 v[80:83], v113, s[84:87], s76 offen sc0 sc1
    s_add_u32 s76, s53, 147456
    buffer_load_dwordx4 v[84:87], v113, s[84:87], s76 offen sc0 sc1
    s_mov_b32 m0, s58
    s_setprio 3
    s_waitcnt vmcnt(24)
    s_barrier
    s_cmp_eq_u32 s3, 3
    s_cbranch_scc1 F_d0
    buffer_load_dword v10, s[68:71], s52 offen sc0 sc1 lds
    s_add_u32 m0, m0, 256
    s_add_u32 s52, s52, 1024
    buffer_load_dword v10, s[68:71], s52 offen sc0 sc1 lds
    s_branch F_d1
F_d0:
    s_nop 0
    s_mov_b32 m0, 24576
    s_mov_b32 s52, 0x7ff00000
    s_mov_b64 exec, 0xfff
    buffer_load_dwordx4 v10, s[84:87], s52 offen lds
    buffer_load_dwordx4 v10, s[84:87], s52 offen lds
    s_mov_b64 exec, -1
F_d1:

    s_setprio 0
    s_waitcnt vmcnt(16)
    s_barrier
    s_waitcnt vmcnt(2)
F_cs0:
    v_min3_u32 v96, v72, v76, v80
    v_min_u32 v96, v96, v84
    v_cmp_eq_u32 vcc, 0, v96
    s_cbranch_vccz F_cs1
    s_sleep 8

    s_add_u32 s76, s53, 0
    buffer_load_dwordx4 v[72:75], v113, s[84:87], s76 offen sc0 sc1
    s_add_u32 s76, s53, 49152
    buffer_load_dwordx4 v[76:79], v113, s[84:87], s76 offen sc0 sc1
    s_add_u32 s76, s53, 98304
    buffer_load_dwordx4 v[80:83], v113, s[84:87], s76 offen sc0 sc1
    s_add_u32 s76, s53, 147456
    buffer_load_dwordx4 v[84:87], v113, s[84:87], s76 offen sc0 sc1
    s_waitcnt vmcnt(0)
    s_branch F_cs0
F_cs1:
    v_add_f32 v72, v72, v76
    v_add_f32 v80, v80, v84
    v_add_f32 v73, v73, v77
    v_add_f32 v81, v81, v85
    v_add_f32 v74, v74, v78
    v_add_f32 v82, v82, v86
    v_add_f32 v75, v75, v79
    v_add_f32 v83, v83, v87
    v_add_f32 v72, v72, v80
    v_add_f32 v73, v73, v81
    v_add_f32 v74, v74, v82
    v_add_f32 v75, v75, v83
    v_mov_b32 v76, v72
    v_mov_b32 v77, v73
    v_mov_b32 v78, v74
    v_mov_b32 v79, v75
    v_permlane32_swap_b32 v72, v76
    v_permlane32_swap_b32 v73, v77
    v_permlane32_swap_b32 v74, v78
    v_permlane32_swap_b32 v75, v79
    v_add_f32 v72, v72, v76
    v_add_f32 v73, v73, v77
    v_add_f32 v74, v74, v78
    v_add_f32 v75, v75, v79
    v_mov_b32 v76, v72
    v_mov_b32 v77, v73
    v_mov_b32 v78, v74
    v_mov_b32 v79, v75
    v_permlane16_swap_b32 v72, v76
    v_permlane16_swap_b32 v73, v77
    v_permlane16_swap_b32 v74, v78
    v_permlane16_swap_b32 v75, v79
    v_add_f32 v72, v72, v76
    v_add_f32 v73, v73, v77
    v_add_f32 v74, v74, v78
    v_add_f32 v75, v75, v79
    s_mov_b64 exec, 0xfff
    ds_write_b128 v114, v[72:75]
    s_mov_b64 exec, -1
    s_waitcnt lgkmcnt(0)

    s_waitcnt vmcnt(0)
    s_barrier
    s_add_u32 s24, s72, 0x800000
    s_addc_u32 s25, s73, 0
    s_mov_b32 s26, 0x100000
    s_mov_b32 s27, 0x00020000
    s_add_u32 s12, s72, 0x400000
    s_addc_u32 s13, s73, 0
    s_mov_b32 s14, 0x400000
    s_mov_b32 s15, 0x00020000
    s_mov_b32 s16, s8
    s_mov_b32 s17, s9
    s_mov_b32 s18, 0x200000
    s_mov_b32 s19, 0x00020000
    v_lshrrev_b32 v4, 4, v0
    v_and_b32 v3, 15, v0
    v_lshlrev_b32 v6, 1, v4
    v_xor_b32 v8, v3, v6
    v_xor_b32 v9, 8, v8
    v_lshlrev_b32 v8, 4, v8
    v_lshlrev_b32 v9, 4, v9
    v_lshl_add_u32 v8, v4, 11, v8
    v_lshl_add_u32 v9, v4, 11, v9
    s_lshl_b32 s38, s29, 8
    s_lshl_b32 s45, s3, 15
    s_add_u32 s38, s38, s45
    s_lshl_b32 s45, s3, 12
    s_mul_i32 s39, s35, 4
    s_mul_i32 s40, s34, 0
    s_add_u32 s39, s39, s40
    s_and_b32 s59, s34, 3

    s_lshr_b32 s36, s3, 1
    s_and_b32 s37, s3, 1
    s_lshl_b32 s43, s36, 6
    s_lshl_b32 s42, s33, 1
    s_add_u32 s42, s42, s37
    s_mul_i32 s82, s42, 4224
    s_add_u32 s83, s82, 4096
    s_add_u32 s83, s83, s43
    s_lshl_b32 s44, s36, 11
    s_add_u32 s82, s82, s44
    s_mul_i32 s51, s42, 16*64
    s_add_u32 s51, s51, 192512
    s_lshl_b32 s42, s10, 1
    s_add_u32 s42, s42, s37
    s_lshl_b32 s50, s42, 4
    s_add_u32 s50, s50, s32
    s_lshl_b32 s50, s50, 6
    v_lshlrev_b32 v10, 4, v0
    v_lshlrev_b32 v11, 2, v0
    s_lshl_b32 s42, s3, 2
    s_add_u32 s42, s42, 24640
    v_mov_b32 v1, s42
    v_and_b32 v2, 3, v0
    v_lshlrev_b32 v2, 2, v2
    v_add_u32 v2, 24640, v2
    v_and_b32 v105, 1, v0
    v_lshlrev_b32 v105, 3, v105
    s_lshl_b32 s42, s37, 2
    s_add_u32 s42, s42, 24640
    v_add_u32 v105, s42, v105
    s_lshl_b32 s42, s37, 12
    s_add_u32 s42, s42, s44
    s_add_u32 s42, s42, 65536
    v_add_u32 v106, s42, v11
    s_lshl_b32 s42, s37, 7
    s_add_u32 s42, s42, s43
    s_add_u32 s42, s42, 27136
    v_add_u32 v107, s42, v11
    v_mul_u32_u24 v108, 64*16/4, v0
    v_mov_b32 v109, 1
    s_mov_b32 s60, 0
    s_mov_b32 s62, 0xa001024
    s_mov_b32 s63, 0x1a1e14
    s_lshl_b32 s36, s28, 2
    s_add_u32 s36, s36, s3
    s_lshl_b32 s36, s36, 15
    s_lshl_b32 s44, s3, 11
    s_lshl_b32 s50, s28, 3
    s_and_b32 s76, s29, 4-1
    s_mul_i32 s76, s76, 8/4
    s_add_u32 s50, s50, s76
    s_mul_i32 s50, s50, 64
    s_add_u32 s78, s50, 0x837000
    s_add_u32 s78, s72, s78
    s_addc_u32 s79, s73, 0
    s_setprio 3
    s_sleep 10
    s_lshr_b32 s56, s3, 1
    s_add_u32 s56, s56, 1
    ds_read_b32 v114, v105
FW_3:
    s_waitcnt lgkmcnt(0)
    v_cmp_gt_u32 vcc, s56, v114
    s_cbranch_vccz FO_4
    s_sleep 1
    ds_read_b32 v114, v105
    s_branch FW_3
FO_4:
    ds_read2st64_b32 v[12:13], v106 offset0:0 offset1:1
    ds_read2st64_b32 v[20:21], v106 offset0:32 offset1:33
    ds_read2st64_b32 v[14:15], v106 offset0:2 offset1:3
    ds_read2st64_b32 v[22:23], v106 offset0:34 offset1:35
    ds_read2st64_b32 v[16:17], v106 offset0:4 offset1:5
    ds_read2st64_b32 v[24:25], v106 offset0:36 offset1:37
    ds_read2st64_b32 v[18:19], v106 offset0:6 offset1:7
    ds_read2st64_b32 v[26:27], v106 offset0:38 offset1:39
    ds_read2st64_b32 v[28:29], v107 offset0:0 offset1:1
    s_waitcnt lgkmcnt(7)
    v_add_f32 v12, v12, v20
    buffer_atomic_add_f32 v12, v11, s[24:27], s82 offen offset:0
    v_add_f32 v13, v13, v21
    buffer_atomic_add_f32 v13, v11, s[24:27], s82 offen offset:256
    s_waitcnt lgkmcnt(5)
    v_add_f32 v14, v14, v22
    buffer_atomic_add_f32 v14, v11, s[24:27], s82 offen offset:512
    v_add_f32 v15, v15, v23
    buffer_atomic_add_f32 v15, v11, s[24:27], s82 offen offset:768
    s_waitcnt lgkmcnt(3)
    v_add_f32 v16, v16, v24
    buffer_atomic_add_f32 v16, v11, s[24:27], s82 offen offset:1024
    v_add_f32 v17, v17, v25
    buffer_atomic_add_f32 v17, v11, s[24:27], s82 offen offset:1280
    s_waitcnt lgkmcnt(1)
    v_add_f32 v18, v18, v26
    buffer_atomic_add_f32 v18, v11, s[24:27], s82 offen offset:1536
    v_add_f32 v19, v19, v27
    buffer_atomic_add_f32 v19, v11, s[24:27], s82 offen offset:1792
    s_waitcnt lgkmcnt(0)
    v_add_f32 v28, v28, v29
    s_mov_b64 exec, 0xffff
    buffer_atomic_add_f32 v28, v11, s[24:27], s83 offen
    s_mov_b64 exec, -1
    v_mov_b32 v113, 1
    s_mov_b64 exec, 1
    ds_write_b32 v1, v113 offset:32
    s_mov_b64 exec, -1
    s_add_u32 s54, s51, 0x800000
    s_add_u32 s54, s72, s54
    s_addc_u32 s55, s73, 0
    s_mov_b32 s57, 1
    s_waitcnt vmcnt(4)
    ds_read2_b32 v[102:103], v2 offset0:0 offset1:8
    ds_read_b32 v104, v2 offset:16
    s_waitcnt lgkmcnt(0)
    v_cmp_ne_u32 vcc, 3, v102
    v_cmp_eq_u32 s[42:43], 0, v103
    s_nop 0
    s_or_b64 vcc, vcc, s[42:43]
    v_cmp_gt_u32 s[42:43], 2, v104
    s_nop 0
    s_or_b64 vcc, vcc, s[42:43]
    s_waitcnt vmcnt(0)
    s_atomic_add s57, s[54:55], 0
    s_atomic_add s57, s[54:55], 256
    s_atomic_add s57, s[54:55], 512
    s_atomic_add s57, s[54:55], 768
    s_cbranch_vccnz F_pe
    s_add_u32 s41, s39, 0
    s_and_b32 s41, s41, 15
    s_xor_b32 s41, s41, s59
    s_lshl_b32 s41, s41, 17
    s_add_u32 s41, s41, s38
    s_add_u32 m0, s45, 147456
    s_add_u32 s76, s41, 0
    buffer_load_dwordx4 v8, s[16:19], s76 offen lds
    s_add_u32 m0, s45, 148480
    s_add_u32 s76, s41, 8192
    buffer_load_dwordx4 v9, s[16:19], s76 offen lds
    s_add_u32 m0, s45, 149504
    s_add_u32 s76, s41, 16384
    buffer_load_dwordx4 v8, s[16:19], s76 offen lds
    s_add_u32 m0, s45, 150528
    s_add_u32 s76, s41, 24576
    buffer_load_dwordx4 v9, s[16:19], s76 offen lds
    s_add_u32 s41, s39, 1
    s_and_b32 s41, s41, 15
    s_xor_b32 s41, s41, s59
    s_lshl_b32 s41, s41, 17
    s_add_u32 s41, s41, s38
    s_add_u32 m0, s45, 65536
    s_add_u32 s76, s41, 0
    buffer_load_dwordx4 v8, s[16:19], s76 offen lds
    s_add_u32 m0, s45, 66560
    s_add_u32 s76, s41, 8192
    buffer_load_dwordx4 v9, s[16:19], s76 offen lds
    s_add_u32 m0, s45, 67584
    s_add_u32 s76, s41, 16384
    buffer_load_dwordx4 v8, s[16:19], s76 offen lds
    s_add_u32 m0, s45, 68608
    s_add_u32 s76, s41, 24576
    buffer_load_dwordx4 v9, s[16:19], s76 offen lds
    s_add_u32 s41, s39, 2
    s_and_b32 s41, s41, 15
    s_xor_b32 s41, s41, s59
    s_lshl_b32 s41, s41, 17
    s_add_u32 s41, s41, s38
    s_add_u32 m0, s45, 0
    s_add_u32 s76, s41, 0
    s_nop 0
    buffer_load_dwordx4 v8, s[16:19], s76 offen lds
    s_add_u32 m0, s45, 1024
    s_add_u32 s76, s41, 8192
    buffer_load_dwordx4 v9, s[16:19], s76 offen lds
    s_add_u32 m0, s45, 2048
    s_add_u32 s76, s41, 16384
    buffer_load_dwordx4 v8, s[16:19], s76 offen lds
    s_add_u32 m0, s45, 3072
    s_add_u32 s76, s41, 24576
    buffer_load_dwordx4 v9, s[16:19], s76 offen lds
    s_mov_b32 s60, 3
F_pe:
    s_setprio 1
F_pr0:
    s_waitcnt vmcnt(8)
    ds_read2_b32 v[102:103], v2 offset0:0 offset1:8
    s_cmp_lt_u32 s60, 2
    s_cselect_b32 s61, 1, 3
    s_waitcnt lgkmcnt(0)
    v_cmp_le_u32 vcc, 4, v102
    s_cbranch_vccz F_pr3
    s_mov_b32 s61, 5
F_pr3:
    v_cmp_gt_u32 vcc, s61, v102
    v_cmp_gt_u32 s[42:43], 1, v103
    s_nop 0
    s_or_b64 vcc, vcc, s[42:43]
    s_cbranch_vccz F_pr2
    s_sleep 2
    s_branch F_pr0
F_pr2:
    s_cmp_lt_u32 s60, 6
    s_cbranch_scc1 F_pr4
    ds_read_b32 v102, v2 offset:16
    s_waitcnt lgkmcnt(0)
    v_cmp_gt_u32 vcc, 2, v102
    s_cbranch_vccz F_pr4
    s_sleep 2
    s_branch F_pr0
F_pr4:
    s_cmp_lg_u32 s60, 99
    s_cbranch_scc1 F_pr6
    s_waitcnt vmcnt(16)
    v_mov_b32_e64 v113, 2
    s_mov_b64 exec, 1
    ds_write_b32 v1, v113 offset:32
    s_mov_b64 exec, -1
F_pr6:
    s_add_u32 s41, s39, s60
    s_and_b32 s41, s41, 15
    s_xor_b32 s41, s41, s59
    s_lshl_b32 s41, s41, 17
    s_add_u32 s41, s41, s38
    s_lshl_b32 s76, s60, 3
    s_lshr_b64 s[42:43], s[62:63], s76
    s_and_b32 s42, s42, 0xff
    s_lshl_b32 s42, s42, 12
    s_add_u32 m0, s42, s45
    s_add_u32 s60, s60, 1
    buffer_load_dwordx4 v8, s[16:19], s41 offen lds
    s_add_u32 m0, m0, 1024
    s_add_u32 s41, s41, 8192
    buffer_load_dwordx4 v9, s[16:19], s41 offen lds
    s_add_u32 m0, m0, 1024
    s_add_u32 s41, s41, 8192
    buffer_load_dwordx4 v8, s[16:19], s41 offen lds
    s_add_u32 m0, m0, 1024
    s_add_u32 s41, s41, 8192
    buffer_load_dwordx4 v9, s[16:19], s41 offen lds
    s_cmp_ge_u32 s60, 7
    s_cbranch_scc1 F_pr1
    s_cmp_eq_u32 s61, 5
    s_cbranch_scc1 F_pr2
    s_branch F_pr0
F_pr1:
    s_cmp_lg_u32 s3, 0
    s_cbranch_scc1 F_l4
SP_5:
    s_load_dword s58, s[78:79], 0 glc
    s_waitcnt lgkmcnt(0)
    s_cmp_ge_u32 s58, 32
    s_cbranch_scc1 SD_6
    s_sleep 1
    s_branch SP_5
SD_6:
F_l6:
    v_mov_b32 v113, 3
    s_mov_b64 exec, 1
    ds_write_b32 v1, v113 offset:112
    s_mov_b64 exec, -1
    s_branch F_l5
F_l4:
    v_mov_b32 v4, 24752
    ds_read_b32 v13, v4
FW_7:
    s_waitcnt lgkmcnt(0)
    v_cmp_gt_u32_e64 vcc, 3, v13
    s_cbranch_vccz FO_8
    s_sleep 1
    ds_read_b32 v13, v4
    s_branch FW_7
FO_8:
F_l5:
    s_add_u32 s40, s39, 0
    s_and_b32 s40, s40, 15
    s_xor_b32 s40, s40, s59
    s_lshl_b32 s40, s40, 11
    s_add_u32 s40, s40, s36
    s_add_u32 m0, s44, 16384
    s_nop 0
    buffer_load_dwordx4 v10, s[12:15], s40 offen offset:0 sc1 lds
    s_add_u32 m0, s44, 16384
    s_nop 0
    buffer_load_dwordx4 v10, s[12:15], s40 offen offset:1024 sc1 lds
    s_add_u32 s40, s39, 1
    s_and_b32 s40, s40, 15
    s_xor_b32 s40, s40, s59
    s_lshl_b32 s40, s40, 11
    s_add_u32 s40, s40, s36
    s_add_u32 m0, s44, 98304
    s_nop 0
    buffer_load_dwordx4 v10, s[12:15], s40 offen offset:0 sc1 lds
    s_add_u32 m0, s44, 98304
    s_nop 0
    buffer_load_dwordx4 v10, s[12:15], s40 offen offset:1024 sc1 lds
    s_add_u32 s40, s39, 2
    s_and_b32 s40, s40, 15
    s_xor_b32 s40, s40, s59
    s_lshl_b32 s40, s40, 11
    s_add_u32 s40, s40, s36
    s_add_u32 m0, s44, 139264
    s_nop 0
    buffer_load_dwordx4 v10, s[12:15], s40 offen offset:0 sc1 lds
    s_add_u32 m0, s44, 139264
    s_nop 0
    buffer_load_dwordx4 v10, s[12:15], s40 offen offset:1024 sc1 lds
    s_waitcnt vmcnt(4)
    s_barrier
    s_add_u32 s40, s39, 3
    s_and_b32 s40, s40, 15
    s_xor_b32 s40, s40, s59
    s_lshl_b32 s40, s40, 11
    s_add_u32 s40, s40, s36
    s_add_u32 m0, s44, 57344
    s_nop 0
    buffer_load_dwordx4 v10, s[12:15], s40 offen offset:0 sc1 lds
    s_add_u32 m0, s44, 57344
    s_nop 0
    buffer_load_dwordx4 v10, s[12:15], s40 offen offset:1024 sc1 lds
    s_setprio 0
    s_waitcnt vmcnt(4)
    s_barrier
    s_add_u32 s40, s39, 4
    s_and_b32 s40, s40, 15
    s_xor_b32 s40, s40, s59
    s_lshl_b32 s40, s40, 11
    s_add_u32 s40, s40, s36
    s_add_u32 m0, s44, 16384
    s_nop 0
    buffer_load_dwordx4 v10, s[12:15], s40 offen offset:0 sc1 lds
    s_add_u32 m0, s44, 16384
    s_nop 0
    buffer_load_dwordx4 v10, s[12:15], s40 offen offset:1024 sc1 lds
    s_add_u32 s41, s39, 7
    s_and_b32 s41, s41, 15
    s_xor_b32 s41, s41, s59
    s_lshl_b32 s41, s41, 17
    s_add_u32 s41, s41, s38
    s_add_u32 m0, s45, 147456
    s_add_u32 s76, s41, 0
    buffer_load_dwordx4 v8, s[16:19], s76 offen lds
    s_add_u32 m0, s45, 148480
    s_add_u32 s76, s41, 8192
    buffer_load_dwordx4 v9, s[16:19], s76 offen lds
    s_add_u32 m0, s45, 149504
    s_add_u32 s76, s41, 16384
    buffer_load_dwordx4 v8, s[16:19], s76 offen lds
    s_add_u32 m0, s45, 150528
    s_add_u32 s76, s41, 24576
    buffer_load_dwordx4 v9, s[16:19], s76 offen lds
    s_waitcnt vmcnt(8)
    s_barrier
    s_add_u32 s40, s39, 5
    s_and_b32 s40, s40, 15
    s_xor_b32 s40, s40, s59
    s_lshl_b32 s40, s40, 11
    s_add_u32 s40, s40, s36
    s_add_u32 m0, s44, 98304
    s_nop 0
    buffer_load_dwordx4 v10, s[12:15], s40 offen offset:0 sc1 lds
    s_add_u32 m0, s44, 98304
    s_nop 0
    buffer_load_dwordx4 v10, s[12:15], s40 offen offset:1024 sc1 lds
    s_add_u32 s41, s39, 8
    s_and_b32 s41, s41, 15
    s_xor_b32 s41, s41, s59
    s_lshl_b32 s41, s41, 17
    s_add_u32 s41, s41, s38
    s_add_u32 m0, s45, 65536
    s_add_u32 s76, s41, 0
    s_nop 0
    buffer_load_dwordx4 v8, s[16:19], s76 offen lds
    s_add_u32 m0, s45, 66560
    s_add_u32 s76, s41, 8192
    buffer_load_dwordx4 v9, s[16:19], s76 offen lds
    s_add_u32 m0, s45, 67584
    s_add_u32 s76, s41, 16384
    buffer_load_dwordx4 v8, s[16:19], s76 offen lds
    s_add_u32 m0, s45, 68608
    s_add_u32 s76, s41, 24576
    buffer_load_dwordx4 v9, s[16:19], s76 offen lds
    s_waitcnt vmcnt(12)
    s_barrier
    s_add_u32 s40, s39, 6
    s_and_b32 s40, s40, 15
    s_xor_b32 s40, s40, s59
    s_lshl_b32 s40, s40, 11
    s_add_u32 s40, s40, s36
    s_add_u32 m0, s44, 139264
    s_nop 0
    buffer_load_dwordx4 v10, s[12:15], s40 offen offset:0 sc1 lds
    s_add_u32 m0, s44, 139264
    s_nop 0
    buffer_load_dwordx4 v10, s[12:15], s40 offen offset:1024 sc1 lds
    s_add_u32 s41, s39, 9
    s_and_b32 s41, s41, 15
    s_xor_b32 s41, s41, s59
    s_lshl_b32 s41, s41, 17
    s_add_u32 s41, s41, s38
    s_add_u32 m0, s45, 0
    s_add_u32 s76, s41, 0
    buffer_load_dwordx4 v8, s[16:19], s76 offen lds
    s_add_u32 m0, s45, 1024
W_6:
    s_cbranch_execz R_6
    s_nop 0
    s_add_u32 s76, s41, 8192
    buffer_load_dwordx4 v9, s[16:19], s76 offen lds
    s_add_u32 m0, s45, 2048
    s_add_u32 s76, s41, 16384
    buffer_load_dwordx4 v8, s[16:19], s76 offen lds
    s_add_u32 m0, s45, 3072
    s_add_u32 s76, s41, 24576
    buffer_load_dwordx4 v9, s[16:19], s76 offen lds
    s_waitcnt vmcnt(16)
    s_barrier
    s_add_u32 s40, s39, 7
    s_and_b32 s40, s40, 15
    s_xor_b32 s40, s40, s59
    s_lshl_b32 s40, s40, 11
    s_add_u32 s40, s40, s36
    s_add_u32 m0, s44, 57344
    s_nop 0
    buffer_load_dwordx4 v10, s[12:15], s40 offen offset:0 sc1 lds
    s_add_u32 m0, s44, 57344
    s_nop 0
    buffer_load_dwordx4 v10, s[12:15], s40 offen offset:1024 sc1 lds
    s_add_u32 s41, s39, 10
    s_and_b32 s41, s41, 15
    s_xor_b32 s41, s41, s59
    s_lshl_b32 s41, s41, 17
    s_add_u32 s41, s41, s38
    s_add_u32 m0, s45, 40960
    s_add_u32 s76, s41, 0
    s_nop 0
    buffer_load_dwordx4 v8, s[16:19], s76 offen lds
    s_add_u32 m0, s45, 41984
    s_add_u32 s76, s41, 8192
    buffer_load_dwordx4 v9, s[16:19], s76 offen lds
    s_add_u32 m0, s45, 43008
    s_add_u32 s76, s41, 16384
    buffer_load_dwordx4 v8, s[16:19], s76 offen lds
    s_add_u32 m0, s45, 44032
    s_add_u32 s76, s41, 24576
    buffer_load_dwordx4 v9, s[16:19], s76 offen lds
    s_waitcnt vmcnt(16)
    s_barrier
    s_add_u32 s40, s39, 8
    s_and_b32 s40, s40, 15
    s_xor_b32 s40, s40, s59
    s_lshl_b32 s40, s40, 11
    s_add_u32 s40, s40, s36
    s_add_u32 m0, s44, 16384
    s_nop 0
    buffer_load_dwordx4 v10, s[12:15], s40 offen offset:0 sc1 lds
    s_add_u32 m0, s44, 16384
    s_nop 0
    buffer_load_dwordx4 v10, s[12:15], s40 offen offset:1024 sc1 lds
    s_add_u32 s41, s39, 11
    s_and_b32 s41, s41, 15
    s_xor_b32 s41, s41, s59
    s_lshl_b32 s41, s41, 17
    s_add_u32 s41, s41, s38
    s_add_u32 m0, s45, 81920
    s_add_u32 s76, s41, 0
    s_nop 0
    buffer_load_dwordx4 v8, s[16:19], s76 offen lds
    s_add_u32 m0, s45, 82944
    s_add_u32 s76, s41, 8192
    buffer_load_dwordx4 v9, s[16:19], s76 offen lds
    s_add_u32 m0, s45, 83968
    s_add_u32 s76, s41, 16384
    buffer_load_dwordx4 v8, s[16:19], s76 offen lds
    s_add_u32 m0, s45, 84992
    s_add_u32 s76, s41, 24576
    buffer_load_dwordx4 v9, s[16:19], s76 offen lds
    s_waitcnt vmcnt(16)
    s_barrier
    s_add_u32 s40, s39, 9
    s_and_b32 s40, s40, 15
    s_xor_b32 s40, s40, s59
    s_lshl_b32 s40, s40, 11
    s_add_u32 s40, s40, s36
    s_add_u32 m0, s44, 98304
    s_nop 0
    buffer_load_dwordx4 v10, s[12:15], s40 offen offset:0 sc1 lds
    s_add_u32 m0, s44, 98304
    s_nop 0
    buffer_load_dwordx4 v10, s[12:15], s40 offen offset:1024 sc1 lds
    s_add_u32 s41, s39, 12
    s_and_b32 s41, s41, 15
    s_xor_b32 s41, s41, s59
    s_lshl_b32 s41, s41, 17
    s_add_u32 s41, s41, s38
    s_add_u32 m0, s45, 122880
    s_add_u32 s76, s41, 0
    s_nop 0
    buffer_load_dwordx4 v8, s[16:19], s76 offen lds
    s_add_u32 m0, s45, 123904
    s_add_u32 s76, s41, 8192
    buffer_load_dwordx4 v9, s[16:19], s76 offen lds
    s_add_u32 m0, s45, 124928
    s_add_u32 s76, s41, 16384
    buffer_load_dwordx4 v8, s[16:19], s76 offen lds
    s_add_u32 m0, s45, 125952
    s_add_u32 s76, s41, 24576
    buffer_load_dwordx4 v9, s[16:19], s76 offen lds
    s_waitcnt vmcnt(16)
    s_barrier
    s_add_u32 s40, s39, 10
    s_and_b32 s40, s40, 15
    s_xor_b32 s40, s40, s59
    s_lshl_b32 s40, s40, 11
    s_add_u32 s40, s40, s36
    s_add_u32 m0, s44, 139264
    s_nop 0
    buffer_load_dwordx4 v10, s[12:15], s40 offen offset:0 sc1 lds
    s_add_u32 m0, s44, 139264
    s_nop 0
    buffer_load_dwordx4 v10, s[12:15], s40 offen offset:1024 sc1 lds
    s_add_u32 s41, s39, 13
    s_and_b32 s41, s41, 15
    s_xor_b32 s41, s41, s59
    s_lshl_b32 s41, s41, 17
    s_add_u32 s41, s41, s38
    s_add_u32 m0, s45, 106496
    s_add_u32 s76, s41, 0
    s_nop 0
    buffer_load_dwordx4 v8, s[16:19], s76 offen lds
    s_add_u32 m0, s45, 107520
    s_add_u32 s76, s41, 8192
    buffer_load_dwordx4 v9, s[16:19], s76 offen lds
    s_add_u32 m0, s45, 108544
    s_add_u32 s76, s41, 16384
    buffer_load_dwordx4 v8, s[16:19], s76 offen lds
    s_add_u32 m0, s45, 109568
    s_add_u32 s76, s41, 24576
    buffer_load_dwordx4 v9, s[16:19], s76 offen lds
    s_waitcnt vmcnt(16)
    s_barrier
    s_add_u32 s40, s39, 11
    s_and_b32 s40, s40, 15
    s_xor_b32 s40, s40, s59
    s_lshl_b32 s40, s40, 11
    s_add_u32 s40, s40, s36
    s_add_u32 m0, s44, 57344
    s_nop 0
    buffer_load_dwordx4 v10, s[12:15], s40 offen offset:0 sc1 lds
    s_add_u32 m0, s44, 57344
    s_nop 0
    buffer_load_dwordx4 v10, s[12:15], s40 offen offset:1024 sc1 lds
    s_add_u32 s41, s39, 14
    s_and_b32 s41, s41, 15
    s_xor_b32 s41, s41, s59
    s_lshl_b32 s41, s41, 17
    s_add_u32 s41, s41, s38
    s_add_u32 m0, s45, 147456
    s_add_u32 s76, s41, 0
    s_nop 0
    buffer_load_dwordx4 v8, s[16:19], s76 offen lds
    s_add_u32 m0, s45, 148480
    s_add_u32 s76, s41, 8192
    buffer_load_dwordx4 v9, s[16:19], s76 offen lds
    s_add_u32 m0, s45, 149504
    s_add_u32 s76, s41, 16384
    buffer_load_dwordx4 v8, s[16:19], s76 offen lds
    s_add_u32 m0, s45, 150528
    s_add_u32 s76, s41, 24576
    buffer_load_dwordx4 v9, s[16:19], s76 offen lds
    s_waitcnt vmcnt(16)
    s_barrier
    s_add_u32 s40, s39, 12
    s_and_b32 s40, s40, 15
    s_xor_b32 s40, s40, s59
    s_lshl_b32 s40, s40, 11
    s_add_u32 s40, s40, s36
    s_add_u32 m0, s44, 16384
    s_nop 0
    buffer_load_dwordx4 v10, s[12:15], s40 offen offset:0 sc1 lds
    s_add_u32 m0, s44, 16384
    s_nop 0
    buffer_load_dwordx4 v10, s[12:15], s40 offen offset:1024 sc1 lds
    s_add_u32 s41, s39, 15
    s_and_b32 s41, s41, 15
    s_xor_b32 s41, s41, s59
    s_lshl_b32 s41, s41, 17
    s_add_u32 s41, s41, s38
    s_add_u32 m0, s45, 65536
    s_add_u32 s76, s41, 0
    s_nop 0
    buffer_load_dwordx4 v8, s[16:19], s76 offen lds
    s_add_u32 m0, s45, 66560
    s_add_u32 s76, s41, 8192
    buffer_load_dwordx4 v9, s[16:19], s76 offen lds
    s_add_u32 m0, s45, 67584
    s_add_u32 s76, s41, 16384
    buffer_load_dwordx4 v8, s[16:19], s76 offen lds
    s_add_u32 m0, s45, 68608
    s_add_u32 s76, s41, 24576
    buffer_load_dwordx4 v9, s[16:19], s76 offen lds
    s_waitcnt vmcnt(16)
    s_barrier
    s_add_u32 s40, s39, 13
    s_and_b32 s40, s40, 15
    s_xor_b32 s40, s40, s59
    s_lshl_b32 s40, s40, 11
    s_add_u32 s40, s40, s36
    s_add_u32 m0, s44, 98304
    s_nop 0
    buffer_load_dwordx4 v10, s[12:15], s40 offen offset:0 sc1 lds
    s_add_u32 m0, s44, 98304
    s_nop 0
    buffer_load_dwordx4 v10, s[12:15], s40 offen offset:1024 sc1 lds
    s_waitcnt vmcnt(12)
    s_barrier
    s_add_u32 s40, s39, 14
    s_and_b32 s40, s40, 15
    s_xor_b32 s40, s40, s59
    s_lshl_b32 s40, s40, 11
    s_add_u32 s40, s40, s36
    s_add_u32 m0, s44, 139264
    s_nop 0
    buffer_load_dwordx4 v10, s[12:15], s40 offen offset:0 sc1 lds
    s_add_u32 m0, s44, 139264
    s_nop 0
    buffer_load_dwordx4 v10, s[12:15], s40 offen offset:1024 sc1 lds
    s_waitcnt vmcnt(8)
    s_barrier
    s_add_u32 s40, s39, 15
    s_and_b32 s40, s40, 15
    s_xor_b32 s40, s40, s59
    s_lshl_b32 s40, s40, 11
    s_add_u32 s40, s40, s36
    s_add_u32 m0, s44, 57344
    s_nop 0
    buffer_load_dwordx4 v10, s[12:15], s40 offen offset:0 sc1 lds
    s_add_u32 m0, s44, 57344
    s_nop 0
    buffer_load_dwordx4 v10, s[12:15], s40 offen offset:1024 sc1 lds
    s_waitcnt vmcnt(4)
    s_barrier
    s_waitcnt vmcnt(2)
    s_barrier
    s_waitcnt vmcnt(0)
    s_barrier
    s_endpgm
F_aux:
    s_cbranch_execz F_w0
    s_barrier
    s_setprio 0
    s_sub_u32 s3, s3, 4
    s_and_b32 s36, s2, 3
    s_bfe_u32 s37, s2, 0x10002
    s_lshr_b32 s38, s2, 3
    v_lshlrev_b32 v3, 2, v0
    s_lshl_b32 s77, s36, 1
    s_add_u32 s77, s77, s37
    s_mul_i32 s77, s77, 114688
    s_lshl_b32 s46, s38, 12
    s_add_u32 s77, s77, s46
    s_lshl_b32 s46, s3, 10
    s_add_u32 s77, s77, s46
    s_cmp_ge_u32 s2, 224
    s_cselect_b32 s77, 0x7ff00000, s77
    v_mov_b32 v140, 0
    v_mov_b32 v141, 0
    v_mov_b32 v142, 0
    v_mov_b32 v143, 0
    s_add_u32 s12, s72, 0xa00000
    s_addc_u32 s13, s73, 0
    s_mov_b32 s14, 0xe0000
    s_mov_b32 s15, 0x00020000
    buffer_store_dwordx4 v[140:143], v2, s[12:15], s77 offen sc0 sc1
    s_add_u32 s12, s72, 0xb00000
    s_addc_u32 s13, s73, 0
    s_mov_b32 s14, 0x30000
    s_mov_b32 s15, 0x00020000
    s_lshl_b32 s47, s32, 8
    s_add_u32 s56, s47, 0x908000
    s_add_u32 s56, s72, s56
    s_addc_u32 s57, s73, 0
    s_cmp_eq_u32 s37, 0
    s_cselect_b32 s16, s62, s64
    s_cselect_b32 s17, s63, s65
    s_mov_b32 s18, 7340032
    s_mov_b32 s19, 0x00020000
    s_lshl_b32 s44, s3, 2
    s_add_u32 s44, s44, 24640
    v_mov_b32 v10, s44
    v_lshrrev_b32 v5, 4, v0
    v_mul_u32_u24 v6, 57344, v5
    v_and_b32 v7, 15, v0
    v_lshl_add_u32 v6, v7, 4, v6
    s_lshl_b32 s44, s36, 2
    s_add_u32 s44, s44, s3
    s_mul_i32 s54, s44, 458752
    s_lshl_b32 s45, s38, 8
    s_add_u32 s54, s54, s45
    s_cmp_ge_u32 s2, 224
    s_cselect_b32 s54, 0x70000000, s54
    s_lshl_b32 s55, s44, 7
    v_mov_b32 v8, 0
    s_mov_b32 s80, s66
    s_mov_b32 s81, s67
    s_mov_b32 s82, 0x700000
    s_mov_b32 s83, 0x00020000
    v_bfe_u32 v21, v0, 2, 2
    v_lshl_add_u32 v22, v5, 3, v21
    v_lshrrev_b32 v21, 1, v21
    v_and_b32 v20, 1, v5
    v_lshl_add_u32 v21, v20, 1, v21
    v_xor_b32 v21, s3, v21
    v_lshlrev_b32 v21, 5, v21
    v_lshl_add_u32 v21, v22, 7, v21
    v_and_b32 v20, 3, v0
    v_lshl_add_u32 v21, v20, 3, v21
    s_mov_b32 s44, 0x23453342
    s_lshl_b32 s89, s35, 2
    s_lshr_b32 s89, s44, s89
    s_and_b32 s89, s89, 15
    s_and_b32 s44, s89, 3
    s_mul_i32 s44, s44, 40960
    s_add_u32 s44, s44, 16384
    v_add_u32 v112, s44, v21
    v_lshlrev_b32 v113, 2, v7
    v_lshl_add_u32 v113, v5, 12, v113
    s_lshl_b32 s91, s33, 8
    s_lshl_b32 s45, s3, 6
    s_add_u32 s91, s91, s45
    s_mul_i32 s88, s32, 12288
    s_add_u32 s88, s88, s91
    s_mov_b32 exec_hi, 0xffff
    buffer_store_dword v8, v113, s[12:15], s88 offen sc0 sc1
    s_mov_b64 exec, -1
    s_getpc_b64 s[64:65]
F_cp:
    s_add_u32 s64, s64, F_co-F_cp
    s_addc_u32 s65, s65, 0
    s_branch F_cx
F_co:
    ds_read_b64_tr_b16 v[72:73], v112 offset:0
    ds_read_b64_tr_b16 v[74:75], v112 offset:512
    ds_read_b64_tr_b16 v[76:77], v112 offset:4096
    ds_read_b64_tr_b16 v[78:79], v112 offset:4608
    ds_read_b64_tr_b16 v[80:81], v112 offset:8192
    ds_read_b64_tr_b16 v[82:83], v112 offset:8704
    ds_read_b64_tr_b16 v[84:85], v112 offset:12288
    ds_read_b64_tr_b16 v[86:87], v112 offset:12800
    ds_read_b64_tr_b16 v[88:89], v112 offset:16384
    ds_read_b64_tr_b16 v[90:91], v112 offset:16896
    ds_read_b64_tr_b16 v[92:93], v112 offset:20480
    ds_read_b64_tr_b16 v[94:95], v112 offset:20992
    v_mov_b32 v108, 0x3f803f80
    v_mov_b32 v109, 0x3f803f80
    v_mov_b32 v110, 0x3f803f80
    v_mov_b32 v111, 0x3f803f80
    s_waitcnt lgkmcnt(0)
    s_swappc_b64 s[64:65], s[66:67]
    s_setprio 3
    v_mfma_f32_16x16x32_bf16 v[96:99], v[108:111], v[72:75], 0
    v_mfma_f32_16x16x32_bf16 v[100:103], v[108:111], v[80:83], 0
    v_mfma_f32_16x16x32_bf16 v[104:107], v[108:111], v[88:91], 0
    v_mfma_f32_16x16x32_bf16 v[96:99], v[108:111], v[76:79], v[96:99]
    v_mfma_f32_16x16x32_bf16 v[100:103], v[108:111], v[84:87], v[100:103]
    v_mfma_f32_16x16x32_bf16 v[104:107], v[108:111], v[92:95], v[104:107]
    s_setprio 0
    v_cmp_eq_u32 vcc, 1, v5
    s_nop 4
    v_cndmask_b32 v96, v96, v100, vcc
    v_cmp_eq_u32 vcc, 2, v5
    s_nop 1
    v_cndmask_b32 v96, v96, v104, vcc
    v_max_u32 v96, 1, v96
    s_sleep 4
    s_mov_b32 exec_hi, 0xffff
    buffer_store_dword v96, v113, s[12:15], s88 offen sc0 sc1
    s_mov_b64 exec, -1
    s_setpc_b64 s[66:67]
F_cx:
    s_cmp_eq_u32 s3, 0
    s_cbranch_scc1 F_ax0
    s_cmp_eq_u32 s3, 2
    s_cbranch_scc1 F_ax2
    s_barrier
    s_waitcnt vmcnt(0)
    s_barrier
    s_sub_u32 s45, 2, s89
    s_cmp_gt_u32 s45, 1
    s_cbranch_scc1 CB_9
    s_swappc_b64 s[66:67], s[64:65]
CB_9:
    s_barrier
    s_sub_u32 s45, 3, s89
    s_cmp_gt_u32 s45, 1
    s_cbranch_scc1 CB_10
    s_swappc_b64 s[66:67], s[64:65]
CB_10:
    s_barrier
    s_sub_u32 s45, 4, s89
    s_cmp_gt_u32 s45, 1
    s_cbranch_scc1 CB_11
    s_swappc_b64 s[66:67], s[64:65]
CB_11:
    s_barrier
    s_sub_u32 s45, 5, s89
    s_cmp_gt_u32 s45, 1
    s_cbranch_scc1 CB_12
    s_swappc_b64 s[66:67], s[64:65]
CB_12:
    s_barrier
    s_sub_u32 s45, 6, s89
    s_cmp_gt_u32 s45, 1
    s_cbranch_scc1 CB_13
    s_swappc_b64 s[66:67], s[64:65]
CB_13:
    s_cmp_eq_u32 s3, 3
    s_cbranch_scc1 IW_14
    s_mov_b64 exec, 0
    s_branch W_1
R_1:
    s_branch W_2
R_2:
    s_mov_b64 exec, -1
    s_branch IW_14e
IW_14:
    s_mov_b64 exec, 0
    s_branch W_3
R_3:
    s_branch W_4
R_4:
    s_mov_b64 exec, -1
IW_14e:
    s_barrier
    s_cmp_eq_u32 s3, 3
    s_cbranch_scc1 IW_15
    s_mov_b64 exec, 0
    s_branch W_5
R_5:
    s_branch W_6
R_6:
    s_mov_b64 exec, -1
    s_branch IW_15e
IW_15:
    s_mov_b64 exec, 0
    s_branch W_7
R_7:
    s_branch W_8
R_8:
    s_mov_b64 exec, -1
IW_15e:
    s_barrier
    s_cmp_eq_u32 s3, 3
    s_cbranch_scc1 IW_16
    s_mov_b64 exec, 0
    s_nop 0
R_9:
    s_nop 0
R_10:
    s_mov_b64 exec, -1
    s_branch IW_16e
IW_16:
    s_mov_b64 exec, 0
    s_nop 0
R_11:
    s_nop 0
R_12:
    s_mov_b64 exec, -1
IW_16e:
    s_barrier
    s_barrier
    s_barrier
    s_branch F_aj
F_ax0:
    s_lshl_b32 s44, s32, 2
    buffer_load_dword v9, v8, s[48:51], s44 offen sc0 sc1
    s_barrier
    s_waitcnt vmcnt(0)
    v_cmp_eq_u32 vcc, 0, v9
    s_cbranch_vccz F_ax0r
PL_17:
    buffer_load_dword v9, v8, s[48:51], s44 offen sc0 sc1
    s_waitcnt vmcnt(0)
    v_cmp_gt_u32 vcc, 1, v9
    s_cbranch_vccz PD_18
    s_sleep 1
    s_branch PL_17
PD_18:
F_ax0r:
    s_barrier
    s_mov_b32 s76, 1
    s_atomic_add s76, s[56:57], 0 glc
    s_sub_u32 s45, 2, s89
    s_cmp_gt_u32 s45, 1
    s_cbranch_scc1 CB_19
    s_swappc_b64 s[66:67], s[64:65]
CB_19:
    s_barrier
    s_mov_b32 s75, 0
    s_waitcnt lgkmcnt(0)
    s_cmp_lg_u32 s76, 15
    s_cbranch_scc1 F_ax0c
    s_mov_b32 s75, 1
    s_atomic_add s75, s[70:71], 64 glc
F_ax0c:
    s_sub_u32 s45, 3, s89
    s_cmp_gt_u32 s45, 1
    s_cbranch_scc1 CB_20
    s_swappc_b64 s[66:67], s[64:65]
CB_20:
    s_barrier
    s_sub_u32 s45, 4, s89
    s_cmp_gt_u32 s45, 1
    s_cbranch_scc1 CB_21
    s_swappc_b64 s[66:67], s[64:65]
CB_21:
    s_waitcnt lgkmcnt(0)
    s_cmp_lg_u32 s75, 15
    s_cbranch_scc1 F_ax0d
    v_lshlrev_b32 v9, 8, v0
    v_mov_b32 v11, 1000
    s_mov_b32 s44, 32768
    s_mov_b64 exec, 0xffff
    buffer_store_dword v11, v9, s[40:43], s44 offen sc0 sc1
    s_mov_b64 exec, -1
F_ax0d:
    s_barrier
    s_sub_u32 s45, 5, s89
    s_cmp_gt_u32 s45, 1
    s_cbranch_scc1 CB_22
    s_swappc_b64 s[66:67], s[64:65]
CB_22:
    s_barrier
    s_sub_u32 s45, 6, s89
    s_cmp_gt_u32 s45, 1
    s_cbranch_scc1 CB_23
    s_swappc_b64 s[66:67], s[64:65]
CB_23:
    s_barrier
    s_barrier
    s_barrier
    s_barrier
    s_barrier
    s_branch F_aj
F_ax2:
    s_lshl_b32 s44, s2, 10
    buffer_store_dwordx4 v[140:143], v2, s[24:27], s44 offen sc0 sc1
    s_mov_b64 exec, -1
    s_barrier
    s_waitcnt vmcnt(0)
    s_cmp_lg_u32 s2, 2
    s_cbranch_scc1 F_ax2n
    s_barrier
    s_sub_u32 s45, 2, s89
    s_cmp_gt_u32 s45, 1
    s_cbranch_scc1 CB_24
    s_swappc_b64 s[66:67], s[64:65]
CB_24:
    s_barrier
    s_sub_u32 s45, 3, s89
    s_cmp_gt_u32 s45, 1
    s_cbranch_scc1 CB_25
    s_swappc_b64 s[66:67], s[64:65]
CB_25:
    s_barrier
    s_sub_u32 s45, 4, s89
    s_cmp_gt_u32 s45, 1
    s_cbranch_scc1 CB_26
    s_swappc_b64 s[66:67], s[64:65]
CB_26:
    s_barrier
    s_sub_u32 s45, 5, s89
    s_cmp_gt_u32 s45, 1
    s_cbranch_scc1 CB_27
    s_swappc_b64 s[66:67], s[64:65]
CB_27:
    s_barrier
    s_sub_u32 s45, 6, s89
    s_cmp_gt_u32 s45, 1
    s_cbranch_scc1 CB_28
    s_swappc_b64 s[66:67], s[64:65]
CB_28:
    s_load_dword s76, s[56:57], 0 glc
    s_barrier
    s_waitcnt lgkmcnt(0)
    s_cmp_ge_u32 s76, 1000
    s_cbranch_scc1 F_ax2g
SP_29:
    s_load_dword s76, s[56:57], 0 glc
    s_waitcnt lgkmcnt(0)
    s_cmp_ge_u32 s76, 1000
    s_cbranch_scc1 SD_30
    s_sleep 2
    s_branch SP_29
SD_30:
F_ax2g:
    s_movk_i32 s44, 0
    buffer_load_dwordx4 v[16:19], v2, s[40:43], s44 offen sc0 sc1
    s_movk_i32 s44, 1024
    buffer_load_dwordx4 v[20:23], v2, s[40:43], s44 offen sc0 sc1
    s_movk_i32 s44, 2048
    buffer_load_dwordx4 v[24:27], v2, s[40:43], s44 offen sc0 sc1
    s_movk_i32 s44, 3072
    buffer_load_dwordx4 v[28:31], v2, s[40:43], s44 offen sc0 sc1
    s_movk_i32 s44, 4096
    buffer_load_dwordx4 v[32:35], v2, s[40:43], s44 offen sc0 sc1
    s_movk_i32 s44, 5120
    buffer_load_dwordx4 v[36:39], v2, s[40:43], s44 offen sc0 sc1
    s_movk_i32 s44, 6144
    buffer_load_dwordx4 v[40:43], v2, s[40:43], s44 offen sc0 sc1
    s_movk_i32 s44, 7168
    buffer_load_dwordx4 v[44:47], v2, s[40:43], s44 offen sc0 sc1
    s_mov_b32 s53, 0
    v_and_b32 v13, 7, v0
    v_lshlrev_b32 v13, 2, v13
    v_lshrrev_b32_e64 v9, 3, v0
    v_lshl_add_u32 v13, v9, 7, v13
    s_barrier
    s_waitcnt vmcnt(0)
    s_mov_b32 s58, 0x01010101
    s_mov_b32 s59, s58
    v_max3_u32 v48, v16, v17, v18
    v_med3_u32 v49, v16, v17, v18
    v_min3_u32 v50, v16, v17, v18
    v_med3_u32 v50, v49, v50, v19
    v_med3_u32 v49, v48, v49, v19
    v_max_u32 v48, v48, v19
    v_med3_u32 v50, v49, v50, v20
    v_med3_u32 v49, v48, v49, v20
    v_max_u32 v48, v48, v20
    v_med3_u32 v50, v49, v50, v21
    v_med3_u32 v49, v48, v49, v21
    v_max_u32 v48, v48, v21
    v_med3_u32 v50, v49, v50, v22
    v_med3_u32 v49, v48, v49, v22
    v_max_u32 v48, v48, v22
    v_med3_u32 v50, v49, v50, v23
    v_med3_u32 v49, v48, v49, v23
    v_max_u32 v48, v48, v23
    v_med3_u32 v50, v49, v50, v24
    v_med3_u32 v49, v48, v49, v24
    v_max_u32 v48, v48, v24
    v_med3_u32 v50, v49, v50, v25
    v_med3_u32 v49, v48, v49, v25
    v_max_u32 v48, v48, v25
    v_med3_u32 v50, v49, v50, v26
    v_med3_u32 v49, v48, v49, v26
    v_max_u32 v48, v48, v26
    v_med3_u32 v50, v49, v50, v27
    v_med3_u32 v49, v48, v49, v27
    v_max_u32 v48, v48, v27
    v_med3_u32 v50, v49, v50, v28
    v_med3_u32 v49, v48, v49, v28
    v_max_u32 v48, v48, v28
    v_med3_u32 v50, v49, v50, v29
    v_med3_u32 v49, v48, v49, v29
    v_max_u32 v48, v48, v29
    v_med3_u32 v50, v49, v50, v30
    v_med3_u32 v49, v48, v49, v30
    v_max_u32 v48, v48, v30
    v_med3_u32 v50, v49, v50, v31
    v_med3_u32 v49, v48, v49, v31
    v_max_u32 v48, v48, v31
    v_med3_u32 v50, v49, v50, v32
    v_med3_u32 v49, v48, v49, v32
    v_max_u32 v48, v48, v32
    s_barrier
    v_med3_u32 v50, v49, v50, v33
    v_med3_u32 v49, v48, v49, v33
    v_max_u32 v48, v48, v33
    v_med3_u32 v50, v49, v50, v34
    v_med3_u32 v49, v48, v49, v34
    v_max_u32 v48, v48, v34
    v_med3_u32 v50, v49, v50, v35
    v_med3_u32 v49, v48, v49, v35
    v_max_u32 v48, v48, v35
    v_med3_u32 v50, v49, v50, v36
    v_med3_u32 v49, v48, v49, v36
    v_max_u32 v48, v48, v36
    v_med3_u32 v50, v49, v50, v37
    v_med3_u32 v49, v48, v49, v37
    v_max_u32 v48, v48, v37
    v_med3_u32 v50, v49, v50, v38
    v_med3_u32 v49, v48, v49, v38
    v_max_u32 v48, v48, v38
    v_med3_u32 v50, v49, v50, v39
    v_med3_u32 v49, v48, v49, v39
    v_max_u32 v48, v48, v39
    v_med3_u32 v50, v49, v50, v40
    v_med3_u32 v49, v48, v49, v40
    v_max_u32 v48, v48, v40
    v_med3_u32 v50, v49, v50, v41
    v_med3_u32 v49, v48, v49, v41
    v_max_u32 v48, v48, v41
    v_med3_u32 v50, v49, v50, v42
    v_med3_u32 v49, v48, v49, v42
    v_max_u32 v48, v48, v42
    v_med3_u32 v50, v49, v50, v43
    v_med3_u32 v49, v48, v49, v43
    v_max_u32 v48, v48, v43
    v_med3_u32 v50, v49, v50, v44
    v_med3_u32 v49, v48, v49, v44
    v_max_u32 v48, v48, v44
    v_med3_u32 v50, v49, v50, v45
    v_med3_u32 v49, v48, v49, v45
    v_max_u32 v48, v48, v45
    v_med3_u32 v50, v49, v50, v46
    v_med3_u32 v49, v48, v49, v46
    v_max_u32 v48, v48, v46
    v_med3_u32 v50, v49, v50, v47
    v_med3_u32 v49, v48, v49, v47
    v_max_u32 v48, v48, v47
    v_mov_b32 v4, v48
    s_nop 1
    v_max_u32_dpp v4, v4, v4 row_shr:1 row_mask:0xf bank_mask:0xf bound_ctrl:0
    s_nop 1
    v_max_u32_dpp v4, v4, v4 row_shr:2 row_mask:0xf bank_mask:0xf bound_ctrl:0
    s_nop 1
    v_max_u32_dpp v4, v4, v4 row_shr:4 row_mask:0xf bank_mask:0xf bound_ctrl:0
    s_nop 1
    v_max_u32_dpp v4, v4, v4 row_shr:8 row_mask:0xf bank_mask:0xf bound_ctrl:0
    s_nop 1
    v_max_u32_dpp v4, v4, v4 row_bcast:15 row_mask:0xa bank_mask:0xf
    s_nop 1
    v_max_u32_dpp v4, v4, v4 row_bcast:31 row_mask:0xc bank_mask:0xf
    s_nop 0
    v_readlane_b32 s52, v4, 63
    s_lshl_b64 exec, s[58:59], 0
    s_nop 0
    v_mov_b32 v12, s52
    s_mov_b64 exec, -1
    v_cmp_eq_u32 vcc, s52, v48
    s_nop 1
    v_cndmask_b32 v48, v48, v49, vcc
    v_cndmask_b32 v49, v49, v50, vcc
    v_cndmask_b32 v50, v50, 0, vcc
    s_barrier
    v_mov_b32 v4, v48
    s_nop 1
    v_max_u32_dpp v4, v4, v4 row_shr:1 row_mask:0xf bank_mask:0xf bound_ctrl:0
    s_nop 1
    v_max_u32_dpp v4, v4, v4 row_shr:2 row_mask:0xf bank_mask:0xf bound_ctrl:0
    s_nop 1
    v_max_u32_dpp v4, v4, v4 row_shr:4 row_mask:0xf bank_mask:0xf bound_ctrl:0
    s_nop 1
    v_max_u32_dpp v4, v4, v4 row_shr:8 row_mask:0xf bank_mask:0xf bound_ctrl:0
    s_nop 1
    v_max_u32_dpp v4, v4, v4 row_bcast:15 row_mask:0xa bank_mask:0xf
    s_nop 1
    v_max_u32_dpp v4, v4, v4 row_bcast:31 row_mask:0xc bank_mask:0xf
    s_nop 0
    v_readlane_b32 s52, v4, 63
    s_lshl_b64 exec, s[58:59], 1
    s_nop 0
    v_mov_b32 v12, s52
    s_mov_b64 exec, -1
    v_cmp_eq_u32 vcc, s52, v48
    s_nop 1
    v_cndmask_b32 v48, v48, v49, vcc
    v_cndmask_b32 v49, v49, v50, vcc
    v_cndmask_b32 v50, v50, 0, vcc
    v_mov_b32 v4, v48
    s_nop 1
    v_max_u32_dpp v4, v4, v4 row_shr:1 row_mask:0xf bank_mask:0xf bound_ctrl:0
    s_nop 1
    v_max_u32_dpp v4, v4, v4 row_shr:2 row_mask:0xf bank_mask:0xf bound_ctrl:0
    s_nop 1
    v_max_u32_dpp v4, v4, v4 row_shr:4 row_mask:0xf bank_mask:0xf bound_ctrl:0
    s_nop 1
    v_max_u32_dpp v4, v4, v4 row_shr:8 row_mask:0xf bank_mask:0xf bound_ctrl:0
    s_nop 1
    v_max_u32_dpp v4, v4, v4 row_bcast:15 row_mask:0xa bank_mask:0xf
    s_nop 1
    v_max_u32_dpp v4, v4, v4 row_bcast:31 row_mask:0xc bank_mask:0xf
    s_nop 0
    v_readlane_b32 s52, v4, 63
    s_lshl_b64 exec, s[58:59], 2
    s_nop 0
    v_mov_b32 v12, s52
    s_mov_b64 exec, -1
    v_cmp_eq_u32 vcc, s52, v48
    s_nop 1
    v_cndmask_b32 v48, v48, v49, vcc
    v_cndmask_b32 v49, v49, v50, vcc
    v_cndmask_b32 v50, v50, 0, vcc
    v_mov_b32 v4, v48
    s_nop 1
    v_max_u32_dpp v4, v4, v4 row_shr:1 row_mask:0xf bank_mask:0xf bound_ctrl:0
    s_nop 1
    v_max_u32_dpp v4, v4, v4 row_shr:2 row_mask:0xf bank_mask:0xf bound_ctrl:0
    s_nop 1
    v_max_u32_dpp v4, v4, v4 row_shr:4 row_mask:0xf bank_mask:0xf bound_ctrl:0
    s_nop 1
    v_max_u32_dpp v4, v4, v4 row_shr:8 row_mask:0xf bank_mask:0xf bound_ctrl:0
W_7:
    s_cbranch_execz R_7
    s_nop 0
    s_nop 1
    v_max_u32_dpp v4, v4, v4 row_bcast:15 row_mask:0xa bank_mask:0xf
    s_nop 1
    v_max_u32_dpp v4, v4, v4 row_bcast:31 row_mask:0xc bank_mask:0xf
    s_nop 0
    v_readlane_b32 s52, v4, 63
    s_lshl_b64 exec, s[58:59], 3
    s_nop 0
    v_mov_b32 v12, s52
    s_mov_b64 exec, -1
    v_cmp_eq_u32 vcc, s52, v48
    s_nop 1
    v_cndmask_b32 v48, v48, v49, vcc
    v_cndmask_b32 v49, v49, v50, vcc
    v_cndmask_b32 v50, v50, 0, vcc
    v_mov_b32 v4, v48
    s_nop 1
    v_max_u32_dpp v4, v4, v4 row_shr:1 row_mask:0xf bank_mask:0xf bound_ctrl:0
    s_nop 1
    v_max_u32_dpp v4, v4, v4 row_shr:2 row_mask:0xf bank_mask:0xf bound_ctrl:0
    s_nop 1
    v_max_u32_dpp v4, v4, v4 row_shr:4 row_mask:0xf bank_mask:0xf bound_ctrl:0
    s_nop 1
    v_max_u32_dpp v4, v4, v4 row_shr:8 row_mask:0xf bank_mask:0xf bound_ctrl:0
    s_nop 1
    v_max_u32_dpp v4, v4, v4 row_bcast:15 row_mask:0xa bank_mask:0xf
    s_nop 1
    v_max_u32_dpp v4, v4, v4 row_bcast:31 row_mask:0xc bank_mask:0xf
    s_nop 0
    v_readlane_b32 s52, v4, 63
    s_lshl_b64 exec, s[58:59], 4
    s_nop 0
    v_mov_b32 v12, s52
    s_mov_b64 exec, -1
    v_cmp_eq_u32 vcc, s52, v48
    s_nop 1
    v_cndmask_b32 v48, v48, v49, vcc
    v_cndmask_b32 v49, v49, v50, vcc
    v_cndmask_b32 v50, v50, 0, vcc
    s_barrier
    v_mov_b32 v4, v48
    s_nop 1
    v_max_u32_dpp v4, v4, v4 row_shr:1 row_mask:0xf bank_mask:0xf bound_ctrl:0
    s_nop 1
    v_max_u32_dpp v4, v4, v4 row_shr:2 row_mask:0xf bank_mask:0xf bound_ctrl:0
    s_nop 1
    v_max_u32_dpp v4, v4, v4 row_shr:4 row_mask:0xf bank_mask:0xf bound_ctrl:0
    s_nop 1
    v_max_u32_dpp v4, v4, v4 row_shr:8 row_mask:0xf bank_mask:0xf bound_ctrl:0
    s_nop 1
    v_max_u32_dpp v4, v4, v4 row_bcast:15 row_mask:0xa bank_mask:0xf
    s_nop 1
    v_max_u32_dpp v4, v4, v4 row_bcast:31 row_mask:0xc bank_mask:0xf
    s_nop 0
    v_readlane_b32 s52, v4, 63
    s_lshl_b64 exec, s[58:59], 5
    s_nop 0
    v_mov_b32 v12, s52
    s_mov_b64 exec, -1
    v_cmp_eq_u32 vcc, s52, v48
    s_nop 1
    v_cndmask_b32 v48, v48, v49, vcc
    v_cndmask_b32 v49, v49, v50, vcc
    v_cndmask_b32 v50, v50, 0, vcc
    v_mov_b32 v4, v48
    s_nop 1
    v_max_u32_dpp v4, v4, v4 row_shr:1 row_mask:0xf bank_mask:0xf bound_ctrl:0
    s_nop 1
    v_max_u32_dpp v4, v4, v4 row_shr:2 row_mask:0xf bank_mask:0xf bound_ctrl:0
    s_nop 1
    v_max_u32_dpp v4, v4, v4 row_shr:4 row_mask:0xf bank_mask:0xf bound_ctrl:0
    s_nop 1
    v_max_u32_dpp v4, v4, v4 row_shr:8 row_mask:0xf bank_mask:0xf bound_ctrl:0
    s_nop 1
    v_max_u32_dpp v4, v4, v4 row_bcast:15 row_mask:0xa bank_mask:0xf
    s_nop 1
    v_max_u32_dpp v4, v4, v4 row_bcast:31 row_mask:0xc bank_mask:0xf
    s_nop 0
    v_readlane_b32 s52, v4, 63
    s_lshl_b64 exec, s[58:59], 6
    s_nop 0
    v_mov_b32 v12, s52
    s_mov_b64 exec, -1
    v_cmp_eq_u32 vcc, s52, v48
    s_nop 1
    v_cndmask_b32 v48, v48, v49, vcc
    v_cndmask_b32 v49, v49, v50, vcc
    v_cndmask_b32 v50, v50, 0, vcc
    v_mov_b32 v4, v48
    s_nop 1
    v_max_u32_dpp v4, v4, v4 row_shr:1 row_mask:0xf bank_mask:0xf bound_ctrl:0
    s_nop 1
    v_max_u32_dpp v4, v4, v4 row_shr:2 row_mask:0xf bank_mask:0xf bound_ctrl:0
    s_nop 1
    v_max_u32_dpp v4, v4, v4 row_shr:4 row_mask:0xf bank_mask:0xf bound_ctrl:0
    s_nop 1
    v_max_u32_dpp v4, v4, v4 row_shr:8 row_mask:0xf bank_mask:0xf bound_ctrl:0
    s_nop 1
    v_max_u32_dpp v4, v4, v4 row_bcast:15 row_mask:0xa bank_mask:0xf
    s_nop 1
    v_max_u32_dpp v4, v4, v4 row_bcast:31 row_mask:0xc bank_mask:0xf
    s_nop 0
    v_readlane_b32 s52, v4, 63
    s_lshl_b64 exec, s[58:59], 7
    s_nop 0
    v_mov_b32 v12, s52
    s_mov_b64 exec, -1
    v_cmp_eq_u32 vcc, 0, v48
    s_cbranch_vccz F_tk2
    s_mov_b32 s52, 0
    s_mov_b32 s45, 0
F_tk1:
    v_subrev_u32 v16, s52, v16
    v_subrev_u32 v17, s52, v17
    v_subrev_u32 v18, s52, v18
    v_subrev_u32 v19, s52, v19
    v_subrev_u32 v20, s52, v20
    v_subrev_u32 v21, s52, v21
    v_subrev_u32 v22, s52, v22
    v_subrev_u32 v23, s52, v23
    v_subrev_u32 v24, s52, v24
    v_subrev_u32 v25, s52, v25
    v_subrev_u32 v26, s52, v26
    v_subrev_u32 v27, s52, v27
    v_subrev_u32 v28, s52, v28
    v_subrev_u32 v29, s52, v29
    v_subrev_u32 v30, s52, v30
    v_subrev_u32 v31, s52, v31
    v_subrev_u32 v32, s52, v32
    v_subrev_u32 v33, s52, v33
    v_subrev_u32 v34, s52, v34
    v_subrev_u32 v35, s52, v35
    v_subrev_u32 v36, s52, v36
    v_subrev_u32 v37, s52, v37
    v_subrev_u32 v38, s52, v38
    v_subrev_u32 v39, s52, v39
    v_subrev_u32 v40, s52, v40
    v_subrev_u32 v41, s52, v41
    v_subrev_u32 v42, s52, v42
    v_subrev_u32 v43, s52, v43
    v_subrev_u32 v44, s52, v44
    v_subrev_u32 v45, s52, v45
    v_subrev_u32 v46, s52, v46
    v_subrev_u32 v47, s52, v47
    v_max3_u32 v4, v16, v17, v18
    v_max3_u32 v4, v4, v19, v20
    v_max3_u32 v4, v4, v21, v22
    v_max3_u32 v4, v4, v23, v24
    v_max3_u32 v4, v4, v25, v26
    v_max3_u32 v4, v4, v27, v28
    v_max3_u32 v4, v4, v29, v30
    v_max3_u32 v4, v4, v31, v32
    v_max3_u32 v4, v4, v33, v34
    v_max3_u32 v4, v4, v35, v36
    v_max3_u32 v4, v4, v37, v38
    v_max3_u32 v4, v4, v39, v40
    v_max3_u32 v4, v4, v41, v42
    v_max3_u32 v4, v4, v43, v44
    v_max3_u32 v4, v4, v45, v46
    v_max_u32 v4, v4, v47
    s_nop 1
    v_max_u32_dpp v4, v4, v4 row_shr:1 row_mask:0xf bank_mask:0xf bound_ctrl:0
    s_nop 1
    v_max_u32_dpp v4, v4, v4 row_shr:2 row_mask:0xf bank_mask:0xf bound_ctrl:0
    s_nop 1
    v_max_u32_dpp v4, v4, v4 row_shr:4 row_mask:0xf bank_mask:0xf bound_ctrl:0
    s_nop 1
    v_max_u32_dpp v4, v4, v4 row_shr:8 row_mask:0xf bank_mask:0xf bound_ctrl:0
    s_nop 1
    v_max_u32_dpp v4, v4, v4 row_bcast:15 row_mask:0xa bank_mask:0xf
    s_nop 1
    v_max_u32_dpp v4, v4, v4 row_bcast:31 row_mask:0xc bank_mask:0xf
    s_nop 0
    v_readlane_b32 s52, v4, 63
    s_nop 0
    s_add_u32 s53, s53, s52
    s_lshl_b64 exec, s[58:59], s45
    v_mov_b32 v12, s53
    s_mov_b64 exec, -1
    s_add_u32 s45, s45, 1
    s_cmp_lt_u32 s45, 8
    s_cbranch_scc1 F_tk1
F_tk2:
    v_or_b32 v12, 0x8000, v12
    s_mov_b32 s44, 184320
    buffer_store_dword v12, v13, s[24:27], s44 offen offset:0 sc0 sc1
    buffer_store_dword v12, v13, s[24:27], s44 offen offset:1024 sc0 sc1
    buffer_store_dword v12, v13, s[24:27], s44 offen offset:2048 sc0 sc1
    buffer_store_dword v12, v13, s[24:27], s44 offen offset:3072 sc0 sc1
    s_mov_b32 s44, 188416
    buffer_store_dword v12, v13, s[24:27], s44 offen offset:0 sc0 sc1
    buffer_store_dword v12, v13, s[24:27], s44 offen offset:1024 sc0 sc1
    buffer_store_dword v12, v13, s[24:27], s44 offen offset:2048 sc0 sc1
    buffer_store_dword v12, v13, s[24:27], s44 offen offset:3072 sc0 sc1
    s_branch F_aj
F_ax2n:
    s_barrier
    s_sub_u32 s45, 2, s89
    s_cmp_gt_u32 s45, 1
    s_cbranch_scc1 CB_31
    s_swappc_b64 s[66:67], s[64:65]
CB_31:
    s_barrier
    s_sub_u32 s45, 3, s89
    s_cmp_gt_u32 s45, 1
    s_cbranch_scc1 CB_32
    s_swappc_b64 s[66:67], s[64:65]
CB_32:
    s_barrier
    s_sub_u32 s45, 4, s89
    s_cmp_gt_u32 s45, 1
    s_cbranch_scc1 CB_33
    s_swappc_b64 s[66:67], s[64:65]
CB_33:
    s_barrier
    s_sub_u32 s45, 5, s89
    s_cmp_gt_u32 s45, 1
    s_cbranch_scc1 CB_34
    s_swappc_b64 s[66:67], s[64:65]
CB_34:
    s_barrier
    s_sub_u32 s45, 6, s89
    s_cmp_gt_u32 s45, 1
    s_cbranch_scc1 CB_35
    s_swappc_b64 s[66:67], s[64:65]
CB_35:
    s_barrier
    s_load_dword s76, s[56:57], 0 glc
    s_barrier
    s_waitcnt lgkmcnt(0)
    s_cmp_ge_u32 s76, 1000
    s_cbranch_scc1 F_ax2h
SP_36:
    s_load_dword s76, s[56:57], 0 glc
    s_waitcnt lgkmcnt(0)
    s_cmp_ge_u32 s76, 1000
    s_cbranch_scc1 SD_37
    s_sleep 8
    s_branch SP_36
SD_37:
F_ax2h:
    s_barrier
    s_barrier
    s_barrier
F_aj:
    s_add_u32 s12, s72, 0xa00000
    s_addc_u32 s13, s73, 0
    s_mov_b32 s14, 0xe0000
    s_mov_b32 s15, 0x00020000
    s_and_b32 s46, s2, 63
    s_lshl_b32 s46, s46, 7
    s_add_u32 s56, s46, 0x82d000
    s_add_u32 s56, s72, s56
    s_addc_u32 s57, s73, 0
    s_mov_b32 s58, 0x01010101
    s_mov_b32 s59, s58
    s_mov_b32 s52, 0x05040100
    s_mov_b32 s53, 0x07060302
    v_and_b32 v13, 3, v0
    v_lshlrev_b32 v13, 2, v13
    v_add_u32 v13, 24656, v13
    s_mul_i32 s78, s28, 112
    s_mul_i32 s79, s3, 28
    s_add_u32 s78, s78, s79
    s_lshl_b32 s78, s78, 11
    s_lshl_b32 s79, s29, 8
    s_add_u32 s78, s78, s79

    v_mul_u32_u24 v160, 14336, v5
    v_lshl_add_u32 v160, v7, 4, v160
    s_and_b32 s88, s3, 1
    s_lshl_b32 s88, s88, 12
    s_lshr_b32 s45, s3, 1
    s_mul_i32 s45, s45, 24576
    s_add_u32 s88, s88, s45
    v_subrev_u32 v163, 16, v13
    v_lshrrev_b32 v164, 1, v5
    v_lshlrev_b32 v164, 2, v164
    v_and_b32 v165, 7, v7
    v_xor_b32 v164, v164, v165
    v_lshlrev_b32 v164, 5, v164
    v_lshl_add_u32 v164, v7, 8, v164
    v_and_b32 v165, 1, v5
    v_lshl_add_u32 v164, v165, 4, v164
    s_lshl_b32 s45, s3, 12
    s_add_u32 s45, s45, 106496
    v_add_u32 v164, s45, v164
    s_lshl_b32 s45, s3, 2
    v_add_u32 v165, s45, v5
    v_and_b32 v165, 7, v165
    v_lshlrev_b32 v165, 5, v165
    v_xor_b32 v165, v165, v2
    s_lshl_b32 s45, s3, 10
    s_add_u32 s45, s45, 106496
    v_add_u32 v165, s45, v165
    v_add_u32_e64 v162, 16, v13
    s_barrier
    s_barrier
    s_sleep 2
    s_add_u32 s45, s54, 0
    buffer_load_dwordx4 v[72:75], v6, s[16:19], s45 offen nt
    s_add_u32 s45, s54, 7168
    buffer_load_dwordx4 v[76:79], v6, s[16:19], s45 offen nt
    s_add_u32 s45, s54, 14336
    buffer_load_dwordx4 v[80:83], v6, s[16:19], s45 offen nt
    s_add_u32 s45, s54, 21504
    buffer_load_dwordx4 v[84:87], v6, s[16:19], s45 offen nt
    s_barrier
    s_nop 0
    s_load_dwordx8 s[60:67], s[56:57], 0 glc
    s_add_u32 s45, s54, 28672
    buffer_load_dwordx4 v[88:91], v6, s[16:19], s45 offen nt
    s_add_u32 s45, s54, 35840
    buffer_load_dwordx4 v[92:95], v6, s[16:19], s45 offen nt
    s_add_u32 s45, s54, 43008
    buffer_load_dwordx4 v[96:99], v6, s[16:19], s45 offen nt
    s_add_u32 s45, s54, 50176
    buffer_load_dwordx4 v[100:103], v6, s[16:19], s45 offen nt
    s_barrier
    s_setprio 1
F_sc:
    s_waitcnt lgkmcnt(0)
    s_and_b64 s[74:75], s[60:61], s[62:63]
    s_and_b64 s[74:75], s[74:75], s[64:65]
    s_and_b64 s[74:75], s[74:75], s[66:67]
    s_and_b32 s74, s74, s75
    s_bitcmp1_b32 s74, 15
    s_cbranch_scc1 F_sd
    s_sleep 4
    s_load_dwordx8 s[60:67], s[56:57], 0 glc
    s_branch F_sc
F_sd:

    s_lshl_b64 exec, s[58:59], 0
    v_mov_b32 v4, s60
    s_lshl_b64 exec, s[58:59], 1
    v_mov_b32 v4, s61
    s_lshl_b64 exec, s[58:59], 2
    v_mov_b32 v4, s62
    s_lshl_b64 exec, s[58:59], 3
    v_mov_b32 v4, s63
    s_lshl_b64 exec, s[58:59], 4
    v_mov_b32 v4, s64
    s_lshl_b64 exec, s[58:59], 5
    v_mov_b32 v4, s65
    s_lshl_b64 exec, s[58:59], 6
    v_mov_b32 v4, s66
    s_lshl_b64 exec, s[58:59], 7
    v_mov_b32 v4, s67
    s_mov_b64 exec, -1
    s_mov_b32 s46, 65536
    v_and_b32 v4, 0x7ff, v4
    v_sub_u32 v4, 2047, v4
    v_lshlrev_b32 v9, 4, v4
    v_lshlrev_b32 v4, 11, v4
    v_lshl_add_u32 v4, v5, 4, v4

    buffer_load_dwordx4 v[64:67], v4, s[20:23], s55 offen
    buffer_load_dwordx4 v[68:71], v4, s[20:23], s55 offen offset:64
    buffer_load_dwordx2 v[14:15], v9, s[40:43], s46 offen sc0 sc1
    s_cmp_lt_u32 s2, 224
    s_cbranch_scc1 F_ag
    s_add_u32 s79, s78, 0
    buffer_load_dwordx4 v[16:19], v160, s[80:83], s79 offen nt
    s_add_u32 s79, s78, 2048
    buffer_load_dwordx4 v[20:23], v160, s[80:83], s79 offen nt
    s_add_u32 s79, s78, 4096
    buffer_load_dwordx4 v[24:27], v160, s[80:83], s79 offen nt
    s_add_u32 s79, s78, 6144
    buffer_load_dwordx4 v[28:31], v160, s[80:83], s79 offen nt
    s_add_u32 s79, s78, 8192
    buffer_load_dwordx4 v[144:147], v160, s[80:83], s79 offen nt
    s_add_u32 s79, s78, 10240
    buffer_load_dwordx4 v[148:151], v160, s[80:83], s79 offen nt
    s_add_u32 s79, s78, 12288
    buffer_load_dwordx4 v[152:155], v160, s[80:83], s79 offen nt
    s_sleep 32
    s_branch F_adown
F_ag:
    s_add_u32 s45, s54, 229376
    buffer_load_dwordx4 v[104:107], v6, s[16:19], s45 offen nt
    s_add_u32 s45, s54, 236544
    buffer_load_dwordx4 v[108:111], v6, s[16:19], s45 offen nt
    s_add_u32 s45, s54, 243712
    buffer_load_dwordx4 v[112:115], v6, s[16:19], s45 offen nt
    s_add_u32 s45, s54, 250880
    buffer_load_dwordx4 v[116:119], v6, s[16:19], s45 offen nt
    s_add_u32 s45, s54, 258048
    buffer_load_dwordx4 v[120:123], v6, s[16:19], s45 offen nt
    s_add_u32 s45, s54, 265216
    buffer_load_dwordx4 v[124:127], v6, s[16:19], s45 offen nt
    s_add_u32 s45, s54, 272384
    buffer_load_dwordx4 v[128:131], v6, s[16:19], s45 offen nt
    s_add_u32 s45, s54, 279552
    buffer_load_dwordx4 v[132:135], v6, s[16:19], s45 offen nt
    s_waitcnt vmcnt(8)
    v_lshlrev_b32 v34, 16, v64
    v_and_b32 v35, 0xffff0000, v64
    v_lshlrev_b32 v36, 16, v65
    v_and_b32 v37, 0xffff0000, v65
    v_lshlrev_b32 v38, 16, v66
    v_and_b32 v39, 0xffff0000, v66
    v_lshlrev_b32 v40, 16, v67
    v_and_b32 v41, 0xffff0000, v67
    v_lshlrev_b32 v42, 16, v68
    v_and_b32 v43, 0xffff0000, v68
    v_lshlrev_b32 v44, 16, v69
    v_and_b32 v45, 0xffff0000, v69
    v_lshlrev_b32 v46, 16, v70
    v_and_b32 v47, 0xffff0000, v70
    v_lshlrev_b32 v48, 16, v71
    v_and_b32 v49, 0xffff0000, v71
    v_add_f32 v34, v34, v14
    v_add_f32 v35, v35, v14
    v_add_f32 v36, v36, v14
    v_add_f32 v37, v37, v14
    v_add_f32 v38, v38, v14
    v_add_f32 v39, v39, v14
    v_add_f32 v40, v40, v14
    v_add_f32 v41, v41, v14
    v_add_f32 v42, v42, v14
    v_add_f32 v43, v43, v14
    v_add_f32 v44, v44, v14
    v_add_f32 v45, v45, v14
    v_add_f32 v46, v46, v14
    v_add_f32 v47, v47, v14
    v_add_f32 v48, v48, v14
    v_add_f32_e64 v49, v49, v14
    v_cvt_pk_bf16_f32 v64, v34, v35
    v_cvt_pk_bf16_f32 v65, v36, v37
    v_cvt_pk_bf16_f32 v66, v38, v39
    v_cvt_pk_bf16_f32 v67, v40, v41
    v_cvt_pk_bf16_f32 v68, v42, v43
    v_cvt_pk_bf16_f32 v69, v44, v45
    v_cvt_pk_bf16_f32 v70, v46, v47
    v_cvt_pk_bf16_f32 v71, v48, v49
    v_lshlrev_b32 v34, 16, v64
    v_and_b32 v35, 0xffff0000, v64
    v_lshlrev_b32 v36, 16, v65
    v_and_b32 v37, 0xffff0000, v65
    v_lshlrev_b32 v38, 16, v66
    v_and_b32 v39, 0xffff0000, v66
    v_lshlrev_b32 v40, 16, v67
    v_and_b32 v41, 0xffff0000, v67
    v_lshlrev_b32 v42, 16, v68
    v_and_b32 v43, 0xffff0000, v68
    v_lshlrev_b32 v44, 16, v69
    v_and_b32 v45, 0xffff0000, v69
    v_lshlrev_b32 v46, 16, v70
    v_and_b32 v47, 0xffff0000, v70
    v_lshlrev_b32 v48, 16, v71
    v_and_b32 v49, 0xffff0000, v71
    v_mul_f32 v34, v34, v15
    v_mul_f32 v35, v35, v15
    v_mul_f32 v36, v36, v15
    v_mul_f32 v37, v37, v15
    v_mul_f32 v38, v38, v15
    v_mul_f32 v39, v39, v15
    v_mul_f32 v40, v40, v15
    v_mul_f32 v41, v41, v15
    v_mul_f32 v42, v42, v15
    v_mul_f32 v43, v43, v15
    v_mul_f32 v44, v44, v15
    v_mul_f32 v45, v45, v15
    v_mul_f32 v46, v46, v15
    v_mul_f32 v47, v47, v15
    v_mul_f32 v48, v48, v15
    v_mul_f32 v49, v49, v15
    v_cvt_pk_bf16_f32 v64, v34, v35
    v_cvt_pk_bf16_f32 v65, v36, v37
    v_cvt_pk_bf16_f32 v66, v38, v39
    v_cvt_pk_bf16_f32 v67, v40, v41
    v_cvt_pk_bf16_f32 v68, v42, v43
    v_cvt_pk_bf16_f32 v69, v44, v45
    v_cvt_pk_bf16_f32 v70, v46, v47
    v_cvt_pk_bf16_f32 v71, v48, v49
    s_waitcnt vmcnt(8)
    v_perm_b32 v136, v76, v72, s52
    v_perm_b32 v137, v84, v80, s52
    v_perm_b32 v138, v92, v88, s52
    v_perm_b32 v139, v100, v96, s52
    s_nop 1
    v_mfma_f32_16x16x32_bf16 v[32:35], v[64:67], v[136:139], 0
    v_perm_b32 v140, v76, v72, s53
    v_perm_b32 v141, v84, v80, s53
    v_perm_b32 v142, v92, v88, s53
    v_perm_b32 v143, v100, v96, s53
    s_nop 1
    v_mfma_f32_16x16x32_bf16 v[36:39], v[64:67], v[140:143], 0
    v_perm_b32 v136, v77, v73, s52
    v_perm_b32 v137, v85, v81, s52
    v_perm_b32 v138, v93, v89, s52
    v_perm_b32 v139, v101, v97, s52
    s_nop 1
    v_mfma_f32_16x16x32_bf16 v[40:43], v[64:67], v[136:139], 0
    v_perm_b32 v140, v77, v73, s53
    v_perm_b32 v141, v85, v81, s53
    v_perm_b32 v142, v93, v89, s53
    v_perm_b32 v143, v101, v97, s53
    s_nop 1
    v_mfma_f32_16x16x32_bf16 v[44:47], v[64:67], v[140:143], 0
    v_perm_b32 v136, v78, v74, s52
    v_perm_b32 v137, v86, v82, s52
    v_perm_b32 v138, v94, v90, s52
    v_perm_b32 v139, v102, v98, s52
    s_nop 1
    v_mfma_f32_16x16x32_bf16 v[48:51], v[64:67], v[136:139], 0
    v_perm_b32 v140, v78, v74, s53
    v_perm_b32 v141, v86, v82, s53
    v_perm_b32 v142, v94, v90, s53
    v_perm_b32 v143, v102, v98, s53
    s_nop 1
    v_mfma_f32_16x16x32_bf16 v[52:55], v[64:67], v[140:143], 0
    v_perm_b32 v136, v79, v75, s52
    v_perm_b32 v137, v87, v83, s52
    v_perm_b32 v138, v95, v91, s52
    v_perm_b32 v139, v103, v99, s52
    s_nop 1
    v_mfma_f32_16x16x32_bf16 v[56:59], v[64:67], v[136:139], 0
    v_perm_b32 v140, v79, v75, s53
    v_perm_b32 v141, v87, v83, s53
    v_perm_b32 v142, v95, v91, s53
    v_perm_b32 v143, v103, v99, s53
    s_nop 1
    v_mfma_f32_16x16x32_bf16 v[60:63], v[64:67], v[140:143], 0
    s_waitcnt vmcnt(0)
    s_add_u32 s79, s78, 0
    s_nop 0
    buffer_load_dwordx4 v[16:19], v160, s[80:83], s79 offen nt
    s_add_u32 s79, s78, 2048
    buffer_load_dwordx4 v[20:23], v160, s[80:83], s79 offen nt
    s_add_u32 s79, s78, 4096
    buffer_load_dwordx4 v[24:27], v160, s[80:83], s79 offen nt
    s_add_u32 s79, s78, 6144
    buffer_load_dwordx4 v[28:31], v160, s[80:83], s79 offen nt
    s_add_u32 s79, s78, 8192
    buffer_load_dwordx4 v[144:147], v160, s[80:83], s79 offen nt
    s_add_u32 s79, s78, 10240
    buffer_load_dwordx4 v[148:151], v160, s[80:83], s79 offen nt
    s_add_u32 s79, s78, 12288
    buffer_load_dwordx4 v[152:155], v160, s[80:83], s79 offen nt
    v_perm_b32 v136, v108, v104, s52
    v_perm_b32 v137, v116, v112, s52
    v_perm_b32 v138, v124, v120, s52
    v_perm_b32 v139, v132, v128, s52
    s_nop 1
    v_mfma_f32_16x16x32_bf16 v[32:35], v[68:71], v[136:139], v[32:35]
    v_perm_b32 v140, v108, v104, s53
    v_perm_b32 v141, v116, v112, s53
    v_perm_b32 v142, v124, v120, s53
    v_perm_b32 v143, v132, v128, s53
    s_nop 1
    v_mfma_f32_16x16x32_bf16 v[36:39], v[68:71], v[140:143], v[36:39]
    v_perm_b32 v136, v109, v105, s52
    v_perm_b32 v137, v117, v113, s52
    v_perm_b32 v138, v125, v121, s52
    v_perm_b32 v139, v133, v129, s52
    s_nop 1
    v_mfma_f32_16x16x32_bf16 v[40:43], v[68:71], v[136:139], v[40:43]
    v_perm_b32 v140, v109, v105, s53
    v_perm_b32 v141, v117, v113, s53
    v_perm_b32 v142, v125, v121, s53
    v_perm_b32 v143, v133, v129, s53
    s_nop 1
    v_mfma_f32_16x16x32_bf16 v[44:47], v[68:71], v[140:143], v[44:47]
    v_perm_b32 v136, v110, v106, s52
    v_perm_b32 v137, v118, v114, s52
    v_perm_b32 v138, v126, v122, s52
    v_perm_b32 v139, v134, v130, s52
    s_nop 1
    v_mfma_f32_16x16x32_bf16 v[48:51], v[68:71], v[136:139], v[48:51]
    v_perm_b32 v140, v110, v106, s53
    v_perm_b32 v141, v118, v114, s53
    v_perm_b32 v142, v126, v122, s53
    v_perm_b32 v143, v134, v130, s53
    s_nop 1
    v_mfma_f32_16x16x32_bf16 v[52:55], v[68:71], v[140:143], v[52:55]
    v_perm_b32 v136, v111, v107, s52
    v_perm_b32 v137, v119, v115, s52
    v_perm_b32 v138, v127, v123, s52
    v_perm_b32 v139, v135, v131, s52
    s_nop 1
    v_mfma_f32_16x16x32_bf16 v[56:59], v[68:71], v[136:139], v[56:59]
    v_perm_b32 v140, v111, v107, s53
    v_perm_b32 v141, v119, v115, s53
    v_perm_b32 v142, v127, v123, s53
    v_perm_b32 v143, v135, v131, s53
    s_nop 1
    v_mfma_f32_16x16x32_bf16 v[60:63], v[68:71], v[140:143], v[60:63]
    v_cmp_gt_u32 vcc, 32, v0
    s_nop 1
    v_cndmask_b32 v32, v48, v32, vcc
    v_cndmask_b32 v33, v49, v33, vcc
    v_cndmask_b32 v34, v50, v34, vcc
    v_cndmask_b32 v35, v51, v35, vcc
    ds_write_b128 v164, v[32:35]
    v_cndmask_b32 v36, v52, v36, vcc
    v_cndmask_b32 v37, v53, v37, vcc
    v_cndmask_b32 v38, v54, v38, vcc
    v_cndmask_b32 v39, v55, v39, vcc
    v_xor_b32 v4, 32, v164
    ds_write_b128 v4, v[36:39]
    v_cndmask_b32 v40, v56, v40, vcc
    v_cndmask_b32 v41, v57, v41, vcc
    v_cndmask_b32 v42, v58, v42, vcc
    v_cndmask_b32 v43, v59, v43, vcc
    v_xor_b32 v4, 64, v164
    ds_write_b128 v4, v[40:43]
    v_cndmask_b32 v44, v60, v44, vcc
    v_cndmask_b32 v45, v61, v45, vcc
    v_cndmask_b32 v46, v62, v46, vcc
    v_cndmask_b32 v47, v63, v47, vcc
    v_xor_b32 v4, 96, v164
    ds_write_b128 v4, v[44:47]
    v_mov_b32 v4, 1
    s_mov_b64 exec, 1
    ds_write_b32 v10, v4 offset:16
    s_mov_b64 exec, -1
    ds_read_b32 v12, v13
FW_38:
    s_waitcnt lgkmcnt(0)
    v_cmp_gt_u32 vcc, 1, v12
    s_cbranch_vccz FO_39
    s_sleep 1
    ds_read_b32 v12, v13
    s_branch FW_38
FO_39:
    ds_read_b128 v[72:75], v165 offset:0
    ds_read_b128 v[76:79], v165 offset:4096
    ds_read_b128 v[80:83], v165 offset:8192
    ds_read_b128 v[84:87], v165 offset:12288
    s_waitcnt lgkmcnt(0)
    v_add_f32 v72, v72, v76
    v_add_f32 v80, v80, v84
    v_add_f32 v73, v73, v77
    v_add_f32 v81, v81, v85
    v_add_f32 v74, v74, v78
    v_add_f32 v82, v82, v86
    v_add_f32 v75, v75, v79
    v_add_f32 v83, v83, v87
    v_add_f32 v72, v72, v80
    v_add_f32 v73, v73, v81
    v_add_f32 v74, v74, v82
    v_add_f32 v75, v75, v83
    v_max_u32 v72, 1, v72
    v_max_u32 v74, 1, v74
    buffer_store_dwordx4 v[72:75], v2, s[12:15], s77 offen sc0 sc1
    s_lshl_b32 s44, s38, 2
    s_add_u32 s44, s44, s3
    s_mul_i32 s44, s44, 64
    s_add_u32 s44, s44, 241664
    v_mov_b32 v4, 1
    s_mov_b64 exec, 1
    buffer_atomic_add v4, v8, s[24:27], s44 offen
    s_mov_b64 exec, -1
F_adown:
    v_mov_b32 v4, 2
    s_mov_b64 exec, 1
    ds_write_b32 v10, v4 offset:16
    s_mov_b64 exec, -1
    s_mul_i32 s36, s28, 112
    s_mul_i32 s37, s3, 28
    s_add_u32 s36, s36, s37
    v_min_u32 v4, 55, v0
    v_lshlrev_b32 v4, 4, v4
    s_lshl_b32 s38, s36, 5
    s_lshr_b32 s44, s36, 5
    s_mul_i32 s44, s44, 64
    s_add_u32 s45, s36, 27
    s_lshr_b32 s45, s45, 5
    s_mul_i32 s45, s45, 64
    s_add_u32 s56, s44, 0x83b000
    s_add_u32 s56, s72, s56
    s_addc_u32 s57, s73, 0
    s_add_u32 s58, s45, 0x83b000
    s_add_u32 s58, s72, s58
    s_addc_u32 s59, s73, 0
    v_mov_b32 v156, 0
    v_mov_b32 v157, 0
    v_mov_b32 v158, 0
    v_mov_b32 v159, 0
    s_mov_b32 s48, 0xbfb8aa3b
    ds_read_b32 v12, v163
FW_40:
    s_waitcnt lgkmcnt(0)
    v_cmp_gt_u32 vcc, 3, v12
    s_cbranch_vccz FO_41
    s_sleep 2
    ds_read_b32 v12, v163
    s_branch FW_40
FO_41:
    s_add_u32 s44, s88, 32768
    v_lshlrev_b32 v9, 3, v0
    v_add_u32 v9, s44, v9
    ds_write_b64 v9, v[156:157]
    v_lshrrev_b32 v11, 1, v0
    v_mul_u32_u24 v9, 37, v11
    v_lshrrev_b32 v9, 8, v9
    v_add_u32 v11, v11, v9
    v_lshlrev_b32 v11, 1, v11
    v_and_b32 v9, 1, v0
    v_lshl_add_u32 v11, v9, 8, v11
    v_add_u32 v11, s44, v11
    v_and_b32 v9, 7, v0
    v_lshlrev_b32 v9, 6, v9
    v_lshl_add_u32 v9, v5, 4, v9
    v_add_u32 v9, s44, v9
    s_waitcnt vmcnt(2)
    s_cmp_lt_u32 s2, 224
    s_cbranch_scc1 F_dp
    s_waitcnt vmcnt(0)
F_dp:
    v_perm_b32 v72, v20, v16, s52
    v_perm_b32 v73, v28, v24, s52
    v_perm_b32 v74, v148, v144, s52
    v_perm_b32 v75, v156, v152, s52
    v_perm_b32 v76, v20, v16, s53
    v_perm_b32 v77, v28, v24, s53
    v_perm_b32 v78, v148, v144, s53
    v_perm_b32 v79, v156, v152, s53
    v_perm_b32 v80, v21, v17, s52
    v_perm_b32 v81, v29, v25, s52
    v_perm_b32 v82, v149, v145, s52
    v_perm_b32 v83, v157, v153, s52
    v_perm_b32 v84, v21, v17, s53
    v_perm_b32 v85, v29, v25, s53
    v_perm_b32 v86, v149, v145, s53
    v_perm_b32 v87, v157, v153, s53
    v_perm_b32 v88, v22, v18, s52
    v_perm_b32 v89, v30, v26, s52
    v_perm_b32 v90, v150, v146, s52
W_8:
    s_cbranch_execz R_8
    s_nop 0
    v_perm_b32 v91, v158, v154, s52
    v_perm_b32 v92, v22, v18, s53
    v_perm_b32 v93, v30, v26, s53
    v_perm_b32 v94, v150, v146, s53
    v_perm_b32 v95, v158, v154, s53
    v_perm_b32 v96, v23, v19, s52
    v_perm_b32 v97, v31, v27, s52
    v_perm_b32 v98, v151, v147, s52
    v_perm_b32 v99, v159, v155, s52
    v_perm_b32 v100, v23, v19, s53
    v_perm_b32 v101, v31, v27, s53
    v_perm_b32 v102, v151, v147, s53
    v_perm_b32 v103, v159, v155, s53
    v_and_b32 v14, 1, v5
    v_lshlrev_b32 v14, 11, v14
    v_lshl_add_u32 v14, v7, 5, v14
    v_lshrrev_b32 v15, 1, v5
    v_lshl_add_u32 v14, v15, 4, v14
    v_add_u32 v14, s44, v14
    s_lshl_b32 s45, s3, 10
    s_add_u32 s45, s45, 32768
    v_add_u32 v15, s45, v3
    v_add_u32 v13, 48, v13
    v_and_b32 v17, 31, v0
    v_lshlrev_b32 v17, 4, v17
    s_mov_b32 s80, s68
    s_mov_b32 s81, s69
    s_mov_b32 s82, 0x400000
    s_mov_b32 s83, 0x00020000
    s_lshl_b32 s46, s3, 2
    v_add_u32 v16, s46, v5
    v_lshlrev_b32 v152, 4, v7
    v_mul_u32_u24 v18, 272, v16
    v_add3_u32 v153, v152, v18, 0
    v_lshl_add_u32 v152, v16, 11, v152
    s_lshl_b32 s78, s28, 17
    s_lshl_b32 s79, s29, 8
    s_add_u32 s78, s78, s79
    s_lshl_b32 s47, s28, 6
    s_add_u32 s47, s47, s46
    s_sub_u32 s47, 2047, s47
    s_mov_b32 s77, 0
    v_mov_b32 v144, 0
    v_mov_b32 v145, 0
    v_mov_b32 v146, 0
    v_mov_b32 v147, 0
    s_and_b32 s46, s60, 0x7ff
    s_sub_u32 s46, s47, s46
    s_and_b32 s45, s46, 0xffffffcc
    s_cbranch_scc1 SD_42
    s_mov_b32 s77, 1
    s_or_b32 s45, s60, 0x4000
    v_mov_b32 v18, s45
    v_cmp_eq_u32 vcc, s46, v5
    s_sub_u32 s46, s46, 16
    s_nop 0
    v_cndmask_b32 v144, v144, v18, vcc
    v_cmp_eq_u32 vcc, s46, v5
    s_sub_u32 s46, s46, 16
    s_nop 0
    v_cndmask_b32 v145, v145, v18, vcc
    v_cmp_eq_u32 vcc, s46, v5
    s_sub_u32 s46, s46, 16
    s_nop 0
    v_cndmask_b32 v146, v146, v18, vcc
    v_cmp_eq_u32 vcc, s46, v5
    s_sub_u32 s46, s46, 16
    s_nop 0
    v_cndmask_b32 v147, v147, v18, vcc
SD_42:
    s_and_b32 s46, s61, 0x7ff
    s_sub_u32 s46, s47, s46
    s_and_b32 s45, s46, 0xffffffcc
    s_cbranch_scc1 SD_43
    s_mov_b32 s77, 1
    s_or_b32 s45, s61, 0x4800
    v_mov_b32 v18, s45
    v_cmp_eq_u32 vcc, s46, v5
    s_sub_u32 s46, s46, 16
    s_nop 0
    v_cndmask_b32 v144, v144, v18, vcc
    v_cmp_eq_u32 vcc, s46, v5
    s_sub_u32 s46, s46, 16
    s_nop 0
    v_cndmask_b32 v145, v145, v18, vcc
    v_cmp_eq_u32 vcc, s46, v5
    s_sub_u32 s46, s46, 16
    s_nop 0
    v_cndmask_b32 v146, v146, v18, vcc
    v_cmp_eq_u32 vcc, s46, v5
    s_sub_u32 s46, s46, 16
    s_nop 0
    v_cndmask_b32 v147, v147, v18, vcc
SD_43:
    s_and_b32 s46, s62, 0x7ff
    s_sub_u32 s46, s47, s46
    s_and_b32 s45, s46, 0xffffffcc
    s_cbranch_scc1 SD_44
    s_mov_b32 s77, 1
    s_or_b32 s45, s62, 0x5000
    v_mov_b32 v18, s45
    v_cmp_eq_u32 vcc, s46, v5
    s_sub_u32 s46, s46, 16
    s_nop 0
    v_cndmask_b32 v144, v144, v18, vcc
    v_cmp_eq_u32 vcc, s46, v5
    s_sub_u32 s46, s46, 16
    s_nop 0
    v_cndmask_b32 v145, v145, v18, vcc
    v_cmp_eq_u32 vcc, s46, v5
    s_sub_u32 s46, s46, 16
    s_nop 0
    v_cndmask_b32 v146, v146, v18, vcc
    v_cmp_eq_u32 vcc, s46, v5
    s_sub_u32 s46, s46, 16
    s_nop 0
    v_cndmask_b32 v147, v147, v18, vcc
SD_44:
    s_and_b32 s46, s63, 0x7ff
    s_sub_u32 s46, s47, s46
    s_and_b32 s45, s46, 0xffffffcc
    s_cbranch_scc1 SD_45
    s_mov_b32 s77, 1
    s_or_b32 s45, s63, 0x5800
    v_mov_b32 v18, s45
    v_cmp_eq_u32 vcc, s46, v5
    s_sub_u32 s46, s46, 16
    s_nop 0
    v_cndmask_b32 v144, v144, v18, vcc
    v_cmp_eq_u32 vcc, s46, v5
    s_sub_u32 s46, s46, 16
    s_nop 0
    v_cndmask_b32 v145, v145, v18, vcc
    v_cmp_eq_u32 vcc, s46, v5
    s_sub_u32 s46, s46, 16
    s_nop 0
    v_cndmask_b32 v146, v146, v18, vcc
    v_cmp_eq_u32 vcc, s46, v5
    s_sub_u32 s46, s46, 16
    s_nop 0
    v_cndmask_b32 v147, v147, v18, vcc
SD_45:
    s_and_b32 s46, s64, 0x7ff
    s_sub_u32 s46, s47, s46
    s_and_b32 s45, s46, 0xffffffcc
    s_cbranch_scc1 SD_46
    s_mov_b32 s77, 1
    s_or_b32 s45, s64, 0x6000
    v_mov_b32 v18, s45
    v_cmp_eq_u32 vcc, s46, v5
    s_sub_u32 s46, s46, 16
    s_nop 0
    v_cndmask_b32 v144, v144, v18, vcc
    v_cmp_eq_u32 vcc, s46, v5
    s_sub_u32 s46, s46, 16
    s_nop 0
    v_cndmask_b32 v145, v145, v18, vcc
    v_cmp_eq_u32 vcc, s46, v5
    s_sub_u32 s46, s46, 16
    s_nop 0
    v_cndmask_b32 v146, v146, v18, vcc
    v_cmp_eq_u32 vcc, s46, v5
    s_sub_u32 s46, s46, 16
    s_nop 0
    v_cndmask_b32 v147, v147, v18, vcc
SD_46:
    s_and_b32 s46, s65, 0x7ff
    s_sub_u32 s46, s47, s46
    s_and_b32 s45, s46, 0xffffffcc
    s_cbranch_scc1 SD_47
    s_mov_b32 s77, 1
    s_or_b32 s45, s65, 0x6800
    v_mov_b32 v18, s45
    v_cmp_eq_u32 vcc, s46, v5
    s_sub_u32 s46, s46, 16
    s_nop 0
    v_cndmask_b32 v144, v144, v18, vcc
    v_cmp_eq_u32 vcc, s46, v5
    s_sub_u32 s46, s46, 16
    s_nop 0
    v_cndmask_b32 v145, v145, v18, vcc
    v_cmp_eq_u32 vcc, s46, v5
    s_sub_u32 s46, s46, 16
    s_nop 0
    v_cndmask_b32 v146, v146, v18, vcc
    v_cmp_eq_u32 vcc, s46, v5
    s_sub_u32 s46, s46, 16
    s_nop 0
    v_cndmask_b32 v147, v147, v18, vcc
SD_47:
    s_and_b32 s46, s66, 0x7ff
    s_sub_u32 s46, s47, s46
    s_and_b32 s45, s46, 0xffffffcc
    s_cbranch_scc1 SD_48
    s_mov_b32 s77, 1
    s_or_b32 s45, s66, 0x7000
    v_mov_b32 v18, s45
    v_cmp_eq_u32 vcc, s46, v5
    s_sub_u32 s46, s46, 16
    s_nop 0
    v_cndmask_b32 v144, v144, v18, vcc
    v_cmp_eq_u32 vcc, s46, v5
    s_sub_u32 s46, s46, 16
    s_nop 0
    v_cndmask_b32 v145, v145, v18, vcc
    v_cmp_eq_u32 vcc, s46, v5
    s_sub_u32 s46, s46, 16
    s_nop 0
    v_cndmask_b32 v146, v146, v18, vcc
    v_cmp_eq_u32 vcc, s46, v5
    s_sub_u32 s46, s46, 16
    s_nop 0
    v_cndmask_b32 v147, v147, v18, vcc
SD_48:
    s_and_b32 s46, s67, 0x7ff
    s_sub_u32 s46, s47, s46
    s_and_b32 s45, s46, 0xffffffcc
    s_cbranch_scc1 SD_49
    s_mov_b32 s77, 1
    s_or_b32 s45, s67, 0x7800
    v_mov_b32 v18, s45
    v_cmp_eq_u32 vcc, s46, v5
    s_sub_u32 s46, s46, 16
    s_nop 0
    v_cndmask_b32 v144, v144, v18, vcc
    v_cmp_eq_u32 vcc, s46, v5
    s_sub_u32 s46, s46, 16
    s_nop 0
    v_cndmask_b32 v145, v145, v18, vcc
    v_cmp_eq_u32 vcc, s46, v5
    s_sub_u32 s46, s46, 16
    s_nop 0
    v_cndmask_b32 v146, v146, v18, vcc
    v_cmp_eq_u32 vcc, s46, v5
    s_sub_u32 s46, s46, 16
    s_nop 0
    v_cndmask_b32 v147, v147, v18, vcc
SD_49:
    s_cmp_eq_u32 s77, 0
    s_cbranch_scc1 F_ys1
    v_lshlrev_b32 v19, 5, v7
    v_cmp_ne_u32 s[60:61], 0, v144
    v_and_b32 v148, 0xffff0000, v144
    v_ashrrev_i32 v18, 31, v148
    v_not_b32 v18, v18
    v_or_b32 v18, 0x80000000, v18
    v_xor_b32 v148, v148, v18
    v_and_b32 v148, 0xffff0000, v148
    v_mul_f32 v148, s48, v148
    v_exp_f32 v148, v148
    s_nop 0
    v_add_f32 v148, 1.0, v148
    v_rcp_f32 v148, v148
    s_nop 0
    v_cvt_pk_bf16_f32 v148, v148, v148
    v_lshlrev_b32 v148, 16, v148
    v_bfe_u32 v144, v144, 11, 3
    v_lshl_add_u32 v144, v144, 12, v19
    v_cmp_ne_u32 s[62:63], 0, v145
    v_and_b32 v149, 0xffff0000, v145
    v_ashrrev_i32 v18, 31, v149
    v_not_b32 v18, v18
    v_or_b32 v18, 0x80000000, v18
    v_xor_b32 v149, v149, v18
    v_and_b32 v149, 0xffff0000, v149
    v_mul_f32 v149, s48, v149
    v_exp_f32 v149, v149
    s_nop 0
    v_add_f32 v149, 1.0, v149
    v_rcp_f32 v149, v149
    s_nop 0
    v_cvt_pk_bf16_f32 v149, v149, v149
    v_lshlrev_b32 v149, 16, v149
    v_bfe_u32 v145, v145, 11, 3
    v_lshl_add_u32 v145, v145, 12, v19
    v_cmp_ne_u32 s[64:65], 0, v146
    v_and_b32 v150, 0xffff0000, v146
    v_ashrrev_i32 v18, 31, v150
    v_not_b32 v18, v18
    v_or_b32 v18, 0x80000000, v18
    v_xor_b32 v150, v150, v18
    v_and_b32 v150, 0xffff0000, v150
    v_mul_f32 v150, s48, v150
    v_exp_f32 v150, v150
    s_nop 0
    v_add_f32 v150, 1.0, v150
    v_rcp_f32 v150, v150
    s_nop 0
    v_cvt_pk_bf16_f32 v150, v150, v150
    v_lshlrev_b32 v150, 16, v150
    v_bfe_u32 v146, v146, 11, 3
    v_lshl_add_u32 v146, v146, 12, v19
    v_cmp_ne_u32 s[66:67], 0, v147
    v_and_b32 v151, 0xffff0000, v147
    v_ashrrev_i32 v18, 31, v151
    v_not_b32 v18, v18
    v_or_b32 v18, 0x80000000, v18
    v_xor_b32 v151, v151, v18
    v_and_b32 v151, 0xffff0000, v151
    v_mul_f32 v151, s48, v151
    v_exp_f32 v151, v151
    s_nop 0
    v_add_f32 v151, 1.0, v151
    v_rcp_f32 v151, v151
    s_nop 0
    v_cvt_pk_bf16_f32 v151, v151, v151
    v_lshlrev_b32 v151, 16, v151
    v_bfe_u32 v147, v147, 11, 3
    v_lshl_add_u32 v147, v147, 12, v19
F_ys1:
SP_50:
    s_load_dword s74, s[56:57], 0 glc
    s_load_dword s75, s[58:59], 0 glc
    s_waitcnt lgkmcnt(0)
    s_min_u32 s74, s74, s75
    s_cmp_ge_u32 s74, 8
    s_cbranch_scc1 SD_51
    s_sleep 16
    s_branch SP_50
SD_51:
F_dl:
    s_add_u32 s45, s38, 0
    buffer_load_dwordx4 v[32:35], v4, s[12:15], s45 offen sc0 sc1
    s_add_u32 s45, s38, 114688
    buffer_load_dwordx4 v[36:39], v4, s[12:15], s45 offen sc0 sc1
    s_add_u32 s45, s38, 229376
    buffer_load_dwordx4 v[40:43], v4, s[12:15], s45 offen sc0 sc1
    s_add_u32 s45, s38, 344064
    buffer_load_dwordx4 v[44:47], v4, s[12:15], s45 offen sc0 sc1
    s_add_u32 s45, s38, 458752
    buffer_load_dwordx4 v[48:51], v4, s[12:15], s45 offen sc0 sc1
    s_add_u32 s45, s38, 573440
    buffer_load_dwordx4 v[52:55], v4, s[12:15], s45 offen sc0 sc1
    s_add_u32 s45, s38, 688128
    buffer_load_dwordx4 v[56:59], v4, s[12:15], s45 offen sc0 sc1
    s_add_u32 s45, s38, 802816
    buffer_load_dwordx4 v[60:63], v4, s[12:15], s45 offen sc0 sc1
    s_waitcnt vmcnt(0)
    s_nop 0
    v_min3_u32 v12, v32, v34, v36
    v_min3_u32 v12, v12, v38, v40
    v_min3_u32 v12, v12, v42, v44
    v_min3_u32 v12, v12, v46, v48
    v_min3_u32 v12, v12, v50, v52
    v_min3_u32 v12, v12, v54, v56
    v_min3_u32 v12, v12, v58, v60
    v_min_u32 v12, v12, v62
    v_cmp_eq_u32 vcc, 0, v12
    s_cbranch_vccz F_dm
    s_sleep 6
    s_branch F_dl
F_dm:
    v_add_f32 v32, v32, v40
    v_add_f32 v48, v48, v56
    v_add_f32 v33, v33, v41
    v_add_f32 v49, v49, v57
    v_add_f32 v34, v34, v42
    v_add_f32 v50, v50, v58
    v_add_f32 v35, v35, v43
    v_add_f32 v51, v51, v59
    v_add_f32 v32, v32, v48
    v_add_f32 v33, v33, v49
    v_add_f32 v34, v34, v50
    v_add_f32 v35, v35, v51
    v_add_f32 v36, v36, v44
    v_add_f32 v52, v52, v60
    v_add_f32 v37, v37, v45
    v_add_f32 v53, v53, v61
    v_add_f32 v38, v38, v46
    v_add_f32 v54, v54, v62
    v_add_f32 v39, v39, v47
    v_add_f32 v55, v55, v63
    v_add_f32 v36, v36, v52
    v_add_f32 v37, v37, v53
    v_add_f32 v38, v38, v54
    v_add_f32 v39, v39, v55
    v_cvt_pk_bf16_f32 v40, v32, v36
    v_cvt_pk_bf16_f32 v41, v33, v37
    v_cvt_pk_bf16_f32 v42, v34, v38
    v_cvt_pk_bf16_f32 v43, v35, v39
    v_lshlrev_b32 v32, 16, v40
    v_and_b32 v36, 0xffff0000, v40
    v_lshlrev_b32 v33, 16, v41
    v_and_b32 v37, 0xffff0000, v41
    v_lshlrev_b32 v34, 16, v42
    v_and_b32 v38, 0xffff0000, v42
    v_lshlrev_b32 v35, 16, v43
    v_and_b32 v39, 0xffff0000, v43
    v_mul_f32 v40, s48, v32
    v_mul_f32 v41, s48, v33
    v_mul_f32 v42, s48, v34
    v_mul_f32 v43, s48, v35
    v_exp_f32 v40, v40
    v_exp_f32 v41, v41
    v_exp_f32 v42, v42
    v_exp_f32 v43, v43
    v_add_f32 v40, 1.0, v40
    v_add_f32 v41, 1.0, v41
    v_add_f32 v42, 1.0, v42
    v_add_f32 v43, 1.0, v43
    v_rcp_f32 v40, v40
    v_rcp_f32 v41, v41
    v_rcp_f32 v42, v42
    v_rcp_f32 v43, v43
    v_mul_f32 v32, v32, v40
    v_mul_f32 v33, v33, v41
    v_mul_f32 v34, v34, v42
    v_mul_f32 v35, v35, v43
    v_cvt_pk_bf16_f32 v32, v32, v32
    v_cvt_pk_bf16_f32 v33, v33, v33
    v_cvt_pk_bf16_f32 v34, v34, v34
    v_cvt_pk_bf16_f32 v35, v35, v35
    v_lshlrev_b32 v32, 16, v32
    v_lshlrev_b32 v33, 16, v33
    v_lshlrev_b32 v34, 16, v34
    v_lshlrev_b32 v35, 16, v35
    v_mul_f32 v32, v32, v36
    v_mul_f32 v33, v33, v37
    v_mul_f32 v34, v34, v38
    v_mul_f32 v35, v35, v39
    v_cvt_pk_bf16_f32 v32, v32, v32
    v_cvt_pk_bf16_f32 v33, v33, v33
    v_cvt_pk_bf16_f32 v34, v34, v34
    v_cvt_pk_bf16_f32 v35, v35, v35
    v_cmp_gt_u32 vcc, 56, v0
    s_nop 0
    s_and_saveexec_b64 s[50:51], vcc
    ds_write_b16 v11, v32 offset:0
    ds_write_b16 v11, v33 offset:64
    ds_write_b16 v11, v34 offset:128
    ds_write_b16 v11, v35 offset:192
    s_mov_b64 exec, s[50:51]
    ds_read_b128 v[64:67], v9
    s_waitcnt lgkmcnt(0)
    v_mfma_f32_16x16x32_bf16 v[104:107], v[64:67], v[72:75], 0
    v_mfma_f32_16x16x32_bf16 v[108:111], v[64:67], v[76:79], 0
    v_mfma_f32_16x16x32_bf16 v[112:115], v[64:67], v[80:83], 0
    v_mfma_f32_16x16x32_bf16 v[116:119], v[64:67], v[84:87], 0
    v_mfma_f32_16x16x32_bf16 v[120:123], v[64:67], v[88:91], 0
    v_mfma_f32_16x16x32_bf16 v[124:127], v[64:67], v[92:95], 0
    v_mfma_f32_16x16x32_bf16 v[128:131], v[64:67], v[96:99], 0
    v_mfma_f32_16x16x32_bf16 v[132:135], v[64:67], v[100:103], 0
    v_cmp_gt_u32 vcc, 32, v0
    s_nop 3
    v_cndmask_b32 v32, v120, v104, vcc
    v_cndmask_b32 v33, v124, v108, vcc
    v_cndmask_b32 v34, v128, v112, vcc
    v_cndmask_b32 v35, v132, v116, vcc
    ds_write_b128 v14, v[32:35] offset:0
    v_cndmask_b32 v36, v121, v105, vcc
    v_cndmask_b32 v37, v125, v109, vcc
    v_cndmask_b32 v38, v129, v113, vcc
    v_cndmask_b32 v39, v133, v117, vcc
    ds_write_b128 v14, v[36:39] offset:512
    v_cndmask_b32 v40, v122, v106, vcc
    v_cndmask_b32 v41, v126, v110, vcc
    v_cndmask_b32 v42, v130, v114, vcc
    v_cndmask_b32 v43, v134, v118, vcc
    ds_write_b128 v14, v[40:43] offset:1024
    v_cndmask_b32 v44, v123, v107, vcc
    v_cndmask_b32 v45, v127, v111, vcc
    v_cndmask_b32 v46, v131, v115, vcc
    v_cndmask_b32 v47, v135, v119, vcc
    ds_write_b128 v14, v[44:47] offset:1536
    v_mov_b32 v4, 1
    s_mov_b64 exec, 1
    ds_write_b32 v10, v4 offset:64
    s_mov_b64 exec, -1
    s_lshl_b32 s45, s29, 7
    s_add_u32 s56, s45, 0x82a000
    s_add_u32 s56, s72, s56
    s_addc_u32 s57, s73, 0
    s_lshl_b32 s44, s3, 13
    s_lshl_b32 s50, s29, 9
    s_add_u32 s50, s50, 135168
    s_add_u32 s44, s44, s50
    s_add_u32 s45, s44, 4096
    ds_read_b32 v12, v13
FW_52:
    s_waitcnt lgkmcnt(0)
    v_cmp_gt_u32 vcc, 1, v12
    s_cbranch_vccz FO_53
    s_sleep 1
    ds_read_b32 v12, v13
    s_branch FW_52
FO_53:
    ds_read2st64_b32 v[48:49], v15 offset0:0 offset1:1
    ds_read2st64_b32 v[52:53], v15 offset0:16 offset1:17
    ds_read2st64_b32 v[56:57], v15 offset0:96 offset1:97
    ds_read2st64_b32 v[60:61], v15 offset0:112 offset1:113
    ds_read2st64_b32 v[50:51], v15 offset0:2 offset1:3
    ds_read2st64_b32 v[54:55], v15 offset0:18 offset1:19
    ds_read2st64_b32 v[58:59], v15 offset0:98 offset1:99
    ds_read2st64_b32 v[62:63], v15 offset0:114 offset1:115
    s_waitcnt lgkmcnt(4)
    v_add_f32 v48, v48, v52
    v_add_f32 v56, v56, v60
    v_add_f32 v48, v48, v56
    buffer_atomic_add_f32 v48, v3, s[24:27], s44 offen offset:0
    v_add_f32 v49, v49, v53
    v_add_f32 v57, v57, v61
    v_add_f32 v49, v49, v57
    buffer_atomic_add_f32 v49, v3, s[24:27], s44 offen offset:256
    s_waitcnt lgkmcnt(0)
    v_add_f32 v50, v50, v54
    v_add_f32 v58, v58, v62
    v_add_f32 v50, v50, v58
    buffer_atomic_add_f32 v50, v3, s[24:27], s45 offen offset:0
    v_add_f32 v51, v51, v55
    v_add_f32 v59, v59, v63
    v_add_f32 v51, v51, v59
    buffer_atomic_add_f32 v51, v3, s[24:27], s45 offen offset:256
    s_barrier
    s_barrier
    s_barrier
    s_barrier
    s_waitcnt vmcnt(0)
    s_barrier
    s_cmp_lg_u32 s3, 0
    s_cbranch_scc1 F_y0
    s_mov_b32 s76, 1
    s_atomic_add s76, s[56:57], 0
F_y0:
    s_barrier
    s_barrier
    s_barrier
    s_barrier
    s_barrier
    s_barrier
    s_cmp_lg_u32 s77, 0
    s_cbranch_scc1 F_y1
    s_barrier
    s_barrier
    s_barrier
    s_barrier
    s_barrier
F_y3:
    s_waitcnt lgkmcnt(0)
    s_setprio 3
    s_barrier
    ds_read_b128 v[16:19], v153 offset:0
    s_cmp_lg_u32 s77, 0
    s_waitcnt lgkmcnt(0)
    s_cbranch_scc1 F_ya0
F_yb0:
    buffer_store_dwordx4 v[16:19], v152, s[80:83], s78 offen sc1
    s_add_u32 s78, s78, 32768
    s_barrier
    ds_read_b128 v[20:23], v153 offset:4352
    s_cmp_lg_u32 s77, 0
    s_waitcnt lgkmcnt(0)
    s_cbranch_scc1 F_ya1
F_yb1:
    buffer_store_dwordx4 v[20:23], v152, s[80:83], s78 offen sc1
    s_add_u32 s78, s78, 32768
    s_barrier
    ds_read_b128 v[24:27], v153 offset:8704
    ds_read_b128 v[28:31], v153 offset:13056
    s_cmp_lg_u32 s77, 0
    s_waitcnt lgkmcnt(1)
    s_cbranch_scc1 F_ya2
F_yb2:
    buffer_store_dwordx4 v[24:27], v152, s[80:83], s78 offen sc1
    s_add_u32 s78, s78, 32768
    s_cmp_lg_u32 s77, 0
    s_waitcnt lgkmcnt(0)
    s_cbranch_scc1 F_ya3
F_yb3:
    buffer_store_dwordx4 v[28:31], v152, s[80:83], s78 offen sc1
    s_add_u32 s78, s78, 32768
    s_endpgm
F_y1:
    s_load_dword s58, s[56:57], 0 glc
    s_barrier
    s_barrier
    s_waitcnt lgkmcnt(0)
    s_cmp_lt_u32 s58, 32
    s_cbranch_scc1 F_y2
    s_mov_b64 exec, s[60:61]
    s_cbranch_execz YL_54
    buffer_load_dwordx4 v[72:75], v144, s[24:27], s50 offen offset:0 sc0 sc1
    buffer_load_dwordx4 v[76:79], v144, s[24:27], s50 offen offset:16 sc0 sc1
YL_54:
    s_mov_b64 exec, s[62:63]
    s_cbranch_execz YL_55
    buffer_load_dwordx4 v[80:83], v145, s[24:27], s50 offen offset:0 sc0 sc1
    buffer_load_dwordx4 v[84:87], v145, s[24:27], s50 offen offset:16 sc0 sc1
YL_55:
    s_mov_b64 exec, s[64:65]
    s_cbranch_execz YL_56
    buffer_load_dwordx4 v[88:91], v146, s[24:27], s50 offen offset:0 sc0 sc1
    buffer_load_dwordx4 v[92:95], v146, s[24:27], s50 offen offset:16 sc0 sc1
YL_56:
    s_mov_b64 exec, s[66:67]
    s_cbranch_execz YL_57
    buffer_load_dwordx4 v[96:99], v147, s[24:27], s50 offen offset:0 sc0 sc1
    buffer_load_dwordx4 v[100:103], v147, s[24:27], s50 offen offset:16 sc0 sc1
YL_57:
    s_mov_b64 exec, -1
    s_barrier
    s_barrier
    s_barrier
    s_branch F_y3
F_y2:
    s_barrier
    s_barrier
    s_barrier
SP_58:
    s_load_dword s58, s[56:57], 0 glc
    s_waitcnt lgkmcnt(0)
    s_cmp_ge_u32 s58, 32
    s_cbranch_scc1 SD_59
    s_sleep 2
    s_branch SP_58
SD_59:
    s_mov_b64 exec, s[60:61]
    s_cbranch_execz YL_60
    buffer_load_dwordx4 v[72:75], v144, s[24:27], s50 offen offset:0 sc0 sc1
    buffer_load_dwordx4 v[76:79], v144, s[24:27], s50 offen offset:16 sc0 sc1
YL_60:
    s_mov_b64 exec, s[62:63]
    s_cbranch_execz YL_61
    buffer_load_dwordx4 v[80:83], v145, s[24:27], s50 offen offset:0 sc0 sc1
    buffer_load_dwordx4 v[84:87], v145, s[24:27], s50 offen offset:16 sc0 sc1
YL_61:
    s_mov_b64 exec, s[64:65]
    s_cbranch_execz YL_62
    buffer_load_dwordx4 v[88:91], v146, s[24:27], s50 offen offset:0 sc0 sc1
    buffer_load_dwordx4 v[92:95], v146, s[24:27], s50 offen offset:16 sc0 sc1
YL_62:
    s_mov_b64 exec, s[66:67]
    s_cbranch_execz YL_63
    buffer_load_dwordx4 v[96:99], v147, s[24:27], s50 offen offset:0 sc0 sc1
    buffer_load_dwordx4 v[100:103], v147, s[24:27], s50 offen offset:16 sc0 sc1
YL_63:
    s_mov_b64 exec, -1
    s_branch F_y3
F_ya0:
    s_cmp_eq_u64 s[60:61], 0
    s_cbranch_scc1 F_yb0
    s_mov_b64 exec, s[60:61]
    v_lshlrev_b32 v32, 16, v16
    v_and_b32 v33, 0xffff0000, v16
    v_lshlrev_b32 v34, 16, v17
    v_and_b32 v35, 0xffff0000, v17
    v_lshlrev_b32 v36, 16, v18
    v_and_b32 v37, 0xffff0000, v18
    v_lshlrev_b32 v38, 16, v19
    v_and_b32 v39, 0xffff0000, v19
    s_waitcnt vmcnt(0)
    v_fmac_f32 v32, v72, v148
    v_fmac_f32 v33, v73, v148
    v_fmac_f32 v34, v74, v148
    v_fmac_f32 v35, v75, v148
    v_fmac_f32 v36, v76, v148
    v_fmac_f32 v37, v77, v148
    v_fmac_f32 v38, v78, v148
    v_fmac_f32 v39, v79, v148
    v_cvt_pk_bf16_f32 v16, v32, v33
    v_cvt_pk_bf16_f32 v17, v34, v35
    v_cvt_pk_bf16_f32 v18, v36, v37
    v_cvt_pk_bf16_f32 v19, v38, v39
    s_mov_b64 exec, -1
    s_branch F_yb0
F_ya1:
    s_cmp_eq_u64 s[62:63], 0
    s_cbranch_scc1 F_yb1
    s_mov_b64 exec, s[62:63]
    v_lshlrev_b32 v32, 16, v20
    v_and_b32 v33, 0xffff0000, v20
    v_lshlrev_b32 v34, 16, v21
    v_and_b32 v35, 0xffff0000, v21
    v_lshlrev_b32 v36, 16, v22
    v_and_b32 v37, 0xffff0000, v22
    v_lshlrev_b32 v38, 16, v23
    v_and_b32 v39, 0xffff0000, v23
    s_waitcnt vmcnt(1)
    v_fmac_f32 v32, v80, v149
    v_fmac_f32 v33, v81, v149
    v_fmac_f32 v34, v82, v149
    v_fmac_f32 v35, v83, v149
    v_fmac_f32 v36, v84, v149
    v_fmac_f32 v37, v85, v149
    v_fmac_f32 v38, v86, v149
    v_fmac_f32 v39, v87, v149
    v_cvt_pk_bf16_f32 v20, v32, v33
    v_cvt_pk_bf16_f32 v21, v34, v35
    v_cvt_pk_bf16_f32 v22, v36, v37
    v_cvt_pk_bf16_f32 v23, v38, v39
    s_mov_b64 exec, -1
    s_branch F_yb1
F_ya2:
    s_cmp_eq_u64 s[64:65], 0
    s_cbranch_scc1 F_yb2
    s_mov_b64 exec, s[64:65]
    v_lshlrev_b32 v32, 16, v24
    v_and_b32 v33, 0xffff0000, v24
    v_lshlrev_b32 v34, 16, v25
    v_and_b32 v35, 0xffff0000, v25
    v_lshlrev_b32 v36, 16, v26
    v_and_b32 v37, 0xffff0000, v26
    v_lshlrev_b32 v38, 16, v27
    v_and_b32 v39, 0xffff0000, v27
    s_waitcnt vmcnt(2)
    v_fmac_f32 v32, v88, v150
    v_fmac_f32 v33, v89, v150
    v_fmac_f32 v34, v90, v150
    v_fmac_f32 v35, v91, v150
    v_fmac_f32 v36, v92, v150
    v_fmac_f32 v37, v93, v150
    v_fmac_f32 v38, v94, v150
    v_fmac_f32 v39, v95, v150
    v_cvt_pk_bf16_f32 v24, v32, v33
    v_cvt_pk_bf16_f32 v25, v34, v35
    v_cvt_pk_bf16_f32 v26, v36, v37
    v_cvt_pk_bf16_f32 v27, v38, v39
    s_mov_b64 exec, -1
    s_branch F_yb2
F_ya3:
    s_cmp_eq_u64 s[66:67], 0
    s_cbranch_scc1 F_yb3
    s_mov_b64 exec, s[66:67]
    v_lshlrev_b32 v32, 16, v28
    v_and_b32 v33, 0xffff0000, v28
    v_lshlrev_b32 v34, 16, v29
    v_and_b32 v35, 0xffff0000, v29
    v_lshlrev_b32 v36, 16, v30
    v_and_b32 v37, 0xffff0000, v30
    v_lshlrev_b32 v38, 16, v31
    v_and_b32 v39, 0xffff0000, v31
    s_waitcnt vmcnt(3)
    v_fmac_f32 v32, v96, v151
    v_fmac_f32 v33, v97, v151
    v_fmac_f32 v34, v98, v151
    v_fmac_f32 v35, v99, v151
    v_fmac_f32 v36, v100, v151
    v_fmac_f32 v37, v101, v151
    v_fmac_f32 v38, v102, v151
    v_fmac_f32 v39, v103, v151
    v_cvt_pk_bf16_f32 v28, v32, v33
    v_cvt_pk_bf16_f32 v29, v34, v35
    v_cvt_pk_bf16_f32 v30, v36, v37
    v_cvt_pk_bf16_f32 v31, v38, v39
    s_mov_b64 exec, -1
    s_branch F_yb3
F_codeend:
.section .rodata,"a"
.p2align 6
.amdhsa_kernel parallel_sum__linear_attn_block__moe_arch_mod__prompt_kernel
  .amdhsa_next_free_vgpr 168
  .amdhsa_next_free_sgpr 96
  .amdhsa_accum_offset 168
  .amdhsa_group_segment_fixed_size 0
  .amdhsa_kernarg_size 88
  .amdhsa_user_sgpr_count 2
  .amdhsa_user_sgpr_kernarg_segment_ptr 1
  .amdhsa_system_sgpr_workgroup_id_x 1
  .amdhsa_float_denorm_mode_32 3
  .amdhsa_float_denorm_mode_16_64 3
.end_amdhsa_kernel
```

```asm
; @launch grid=(256,1,1) block=(768,1,1) lds=163840
.amdgcn_target "amdgcn-amd-amdhsa--gfx950"
.text
.globl parallel_sum__linear_attn_block__moe_arch_mod__prompt_kernel
.p2align 8
.type parallel_sum__linear_attn_block__moe_arch_mod__prompt_kernel,@function
parallel_sum__linear_attn_block__moe_arch_mod__prompt_kernel:
    s_load_dwordx4 s[4:7], s[0:1], 0
    s_load_dwordx8 s[60:67], s[0:1], 32
    s_load_dwordx2 s[72:73], s[0:1], 80
    s_load_dwordx4 s[68:71], s[0:1], 64
    s_load_dwordx2 s[8:9], s[0:1], 16
    s_cmp_ge_u32 s2, 256
    s_cbranch_scc1 F_end
    v_lshrrev_b32 v1, 6, v0
    v_and_b32 v0, 63, v0
    s_and_b32 s30, s2, 7
    v_readfirstlane_b32 s3, v1
    s_lshr_b32 s31, s2, 3
    s_and_b32 s32, s30, 1
    s_lshl_b32 s32, s32, 3
    s_and_b32 s35, s31, 7
    s_add_u32 s32, s32, s35
    s_lshr_b32 s33, s30, 1
    s_lshl_b32 s33, s33, 2
    s_lshr_b32 s34, s31, 3
    s_add_u32 s33, s33, s34
    s_lshl_b32 s28, s32, 1
    s_bfe_u32 s29, s30, 0x10001
    s_add_u32 s28, s28, s29
    s_lshl_b32 s29, s30, 2
    s_xor_b32 s29, s29, s30
    s_and_b32 s29, s29, 4
    s_add_u32 s29, s29, s34
    s_lshl_b32 s39, s29, 1
    s_xor_b32 s39, s39, 14
    s_add_u32 s10, s33, 4
    s_and_b32 s10, s10, 15
    v_lshlrev_b32 v2, 4, v0
    s_cmp_ge_u32 s3, 8
    s_cbranch_scc1 F_loader
    s_lshl_b32 s77, s32, 4
    s_add_u32 s77, s77, s33
    s_lshl_b32 s77, s77, 3
    s_add_u32 s77, s77, s3
    s_cmp_lg_u32 s3, 7
    s_cbranch_scc1 F_nt
    s_getpc_b64 s[46:47]
F_pc:
    s_sub_u32 s46, s46, F_pc-parallel_sum__linear_attn_block__moe_arch_mod__prompt_kernel
    s_subb_u32 s47, s47, 0
    s_and_b32 s44, s31, 7
    s_lshl_b32 s44, s44, 13
    v_min_u32 v60, 63, v0
    v_lshlrev_b32 v60, 7, v60
    v_add_u32 v60, s44, v60
    v_min_u32 v60, F_codeend-parallel_sum__linear_attn_block__moe_arch_mod__prompt_kernel-4, v60
    global_load_dword v161, v60, s[46:47]
F_nt:
    s_lshl_b32 s44, s77, 11
    s_waitcnt lgkmcnt(0)

    s_mov_b32 s20, s4
    s_mov_b32 s21, s5
    s_mov_b32 s22, 0x400000
    s_mov_b32 s23, 0x00020000
    buffer_load_dwordx4 v[4:7], v2, s[20:23], s44 offen
    buffer_load_dwordx4 v[8:11], v2, s[20:23], s44 offen offset:1024
    s_mov_b32 s16, s60
    s_mov_b32 s17, s61
    s_mov_b32 s18, 0x800
    s_mov_b32 s19, 0x00020000
    buffer_load_dwordx4 v[12:15], v2, s[16:19], 0 offen
    buffer_load_dwordx4 v[16:19], v2, s[16:19], 0 offen offset:1024
    s_add_u32 s24, s72, 0x800000
    s_addc_u32 s25, s73, 0
    s_mov_b32 s26, 0x100000
    s_mov_b32 s27, 0x00020000
    s_add_u32 s40, s72, 0x900000
    s_addc_u32 s41, s73, 0
    s_mov_b32 s42, 0x18000
    s_mov_b32 s43, 0x00020000
    s_mov_b32 s48, s70
    s_mov_b32 s49, s71
    s_mov_b32 s50, 0x100
    s_mov_b32 s51, 0x00020000
    v_mov_b32 v20, 0
    v_mov_b32 v21, 0
    v_mov_b32 v22, 0
    v_mov_b32 v23, 0
    s_cmp_lg_u32 s3, 5
    s_cbranch_scc1 F_a0
    s_cmp_lg_u32 s33, 0
    s_cbranch_scc1 F_a0
    s_lshl_b32 s44, s32, 8
    s_add_u32 s44, s44, 32768
    s_lshl_b32 s45, s32, 2
    s_mov_b64 exec, 0xffff
    buffer_store_dwordx4 v[20:23], v2, s[40:43], s44 offen sc0 sc1
    s_mov_b64 exec, 1
    s_waitcnt vmcnt(0)
    v_mov_b32 v24, 1
    buffer_store_dword v24, v20, s[48:51], s45 offen sc0 sc1
    s_mov_b64 exec, -1
    s_branch F_a1
F_a0:

    s_cmp_lg_u32 s3, 0
    s_cbranch_scc1 F_w2
    s_mov_b64 exec, 0
    s_branch F_k
F_w2:
    s_cmp_lg_u32 s3, 4
    s_cbranch_scc1 F_w1
    s_mov_b64 exec, 0
    s_branch F_aux
F_w0:
    s_mov_b64 exec, -1
F_w1:

    s_cmp_ge_u32 s3, 4
    s_cbranch_scc1 F_z1
    v_mov_b64 v[68:69], 0
    v_mov_b64 v[70:71], 0
    v_mov_b64 v[72:73], 0
    v_mov_b64 v[74:75], 0
    v_mov_b64 v[76:77], 0
    v_mov_b64 v[78:79], 0
    v_mov_b64 v[80:81], 0
    v_mov_b64 v[82:83], 0
    v_mov_b64 v[84:85], 0
    v_mov_b64 v[86:87], 0
    v_mov_b64 v[88:89], 0
    v_mov_b64 v[90:91], 0
    v_mov_b64 v[92:93], 0
    v_mov_b64 v[94:95], 0
    v_mov_b64 v[96:97], 0
    v_mov_b64 v[98:99], 0
    v_mov_b64 v[100:101], 0
    v_mov_b64 v[102:103], 0
    v_mov_b64 v[104:105], 0
    v_mov_b64 v[106:107], 0
    v_mov_b64 v[108:109], 0
    v_mov_b64 v[110:111], 0
    v_mov_b64 v[112:113], 0
    v_mov_b64 v[114:115], 0
    v_mov_b64 v[116:117], 0
    v_mov_b64 v[118:119], 0
    v_mov_b64 v[120:121], 0
    v_mov_b64 v[122:123], 0
    v_mov_b64 v[124:125], 0
    v_mov_b64 v[126:127], 0
    v_mov_b64 v[128:129], 0
    v_mov_b64 v[130:131], 0
    v_mov_b64 v[132:133], 0
    v_mov_b64 v[134:135], 0
    v_mov_b64 v[136:137], 0
    v_mov_b64 v[138:139], 0
    v_mov_b64 v[140:141], 0
    v_mov_b64 v[142:143], 0
    v_mov_b64 v[144:145], 0
    v_mov_b64 v[146:147], 0
    v_mov_b64 v[148:149], 0
    v_mov_b64 v[150:151], 0
    v_mov_b64 v[152:153], 0
    v_mov_b64 v[154:155], 0
    v_mov_b64 v[156:157], 0
    v_mov_b64 v[158:159], 0
    v_mov_b64 v[160:161], 0
    v_mov_b64 v[162:163], 0
F_z1:
    s_waitcnt vmcnt(0)
F_a1:

    v_lshlrev_b32 v24, 16, v4
    v_and_b32 v25, 0xffff0000, v4
    v_lshlrev_b32 v26, 16, v5
    v_and_b32 v27, 0xffff0000, v5
    v_lshlrev_b32 v28, 16, v6
    v_and_b32 v29, 0xffff0000, v6
    v_lshlrev_b32 v30, 16, v7
    v_and_b32 v31, 0xffff0000, v7
    v_lshlrev_b32 v32, 16, v8
    v_and_b32 v33, 0xffff0000, v8
    v_lshlrev_b32 v34, 16, v9
    v_and_b32 v35, 0xffff0000, v9
    v_lshlrev_b32 v36, 16, v10
    v_and_b32 v37, 0xffff0000, v10
    v_lshlrev_b32 v38, 16, v11
    v_and_b32 v39, 0xffff0000, v11
    v_add_f32 v40, v24, v25
    v_add_f32 v41, v26, v27
    v_add_f32 v42, v28, v29
    v_add_f32 v43, v30, v31
    v_add_f32 v44, v32, v33
    v_add_f32 v45, v34, v35
    v_add_f32 v46, v36, v37
    v_add_f32 v47, v38, v39
    v_add_f32 v40, v40, v44
    v_add_f32 v41, v41, v45
    v_add_f32 v42, v42, v46
    v_add_f32 v43, v43, v47
    v_add_f32 v40, v40, v42
    v_add_f32 v41, v41, v43
    v_add_f32 v40, v40, v41
    s_nop 1
    v_add_f32_dpp v40, v40, v40 row_shr:1 row_mask:0xf bank_mask:0xf bound_ctrl:0
    s_nop 1
    v_add_f32_dpp v40, v40, v40 row_shr:2 row_mask:0xf bank_mask:0xf bound_ctrl:0
    s_nop 1
    v_add_f32_dpp v40, v40, v40 row_shr:4 row_mask:0xf bank_mask:0xf bound_ctrl:0
    s_nop 1
    v_add_f32_dpp v40, v40, v40 row_shr:8 row_mask:0xf bank_mask:0xf bound_ctrl:0
    s_nop 1
    v_add_f32_dpp v40, v40, v40 row_bcast:15 row_mask:0xa bank_mask:0xf
    s_nop 1
    v_add_f32_dpp v40, v40, v40 row_bcast:31 row_mask:0xc bank_mask:0xf
    s_nop 0
    v_readlane_b32 s52, v40, 63
    v_mov_b32 v41, 0x3a800000
    s_nop 0
    v_mul_f32 v41, s52, v41
    v_sub_f32 v44, v24, v41
    v_sub_f32 v45, v25, v41
    v_sub_f32 v46, v26, v41
    v_sub_f32 v47, v27, v41
    v_sub_f32 v48, v28, v41
    v_sub_f32 v49, v29, v41
    v_sub_f32 v50, v30, v41
    v_sub_f32 v51, v31, v41
    v_sub_f32 v52, v32, v41
    v_sub_f32 v53, v33, v41
    v_sub_f32 v54, v34, v41
    v_sub_f32 v55, v35, v41
    v_sub_f32 v56, v36, v41
    v_sub_f32 v57, v37, v41
    v_sub_f32 v58, v38, v41
    v_sub_f32 v59, v39, v41
    v_mul_f32 v40, v44, v44
    v_mul_f32 v42, v45, v45
    v_fmac_f32 v40, v46, v46
    v_fmac_f32 v42, v47, v47
    v_fmac_f32 v40, v48, v48
    v_fmac_f32 v42, v49, v49
    v_fmac_f32 v40, v50, v50
    v_fmac_f32 v42, v51, v51
    v_fmac_f32 v40, v52, v52
    v_fmac_f32 v42, v53, v53
    v_fmac_f32 v40, v54, v54
    v_fmac_f32 v42, v55, v55
    v_fmac_f32 v40, v56, v56
    v_fmac_f32 v42, v57, v57
    v_fmac_f32 v40, v58, v58
    v_fmac_f32 v42, v59, v59
    v_add_f32 v40, v40, v42
    s_nop 1
    v_add_f32_dpp v40, v40, v40 row_shr:1 row_mask:0xf bank_mask:0xf bound_ctrl:0
    s_nop 1
    v_add_f32_dpp v40, v40, v40 row_shr:2 row_mask:0xf bank_mask:0xf bound_ctrl:0
    s_nop 1
    v_add_f32_dpp v40, v40, v40 row_shr:4 row_mask:0xf bank_mask:0xf bound_ctrl:0
    s_nop 1
    v_add_f32_dpp v40, v40, v40 row_shr:8 row_mask:0xf bank_mask:0xf bound_ctrl:0
    s_nop 1
    v_add_f32_dpp v40, v40, v40 row_bcast:15 row_mask:0xa bank_mask:0xf
    s_nop 1
    v_add_f32_dpp v40, v40, v40 row_bcast:31 row_mask:0xc bank_mask:0xf
    s_nop 0
    v_readlane_b32 s52, v40, 63
    v_mov_b32 v42, 0x3a800000
    s_nop 0
    v_mul_f32 v42, s52, v42
    v_cvt_pk_bf16_f32 v43, v41, v42
    v_lshlrev_b32 v41, 16, v43
    v_and_b32 v42, 0xffff0000, v43
    v_add_f32 v42, 0x3727c5ac, v42
    v_cvt_pk_bf16_f32 v42, v42, v42
    v_lshlrev_b32 v42, 16, v42
    v_sqrt_f32 v42, v42
    s_nop 0
    v_cvt_pk_bf16_f32 v42, v42, v42
    v_lshlrev_b32 v42, 16, v42
    v_rcp_f32 v42, v42
    v_sub_f32 v24, v24, v41
    v_sub_f32 v25, v25, v41
    v_sub_f32 v26, v26, v41
    v_sub_f32 v27, v27, v41
    v_sub_f32 v28, v28, v41
    v_sub_f32 v29, v29, v41
    v_sub_f32 v30, v30, v41
    v_sub_f32 v31, v31, v41
    v_sub_f32 v32, v32, v41
    v_sub_f32 v33, v33, v41
    v_sub_f32 v34, v34, v41
    v_sub_f32 v35, v35, v41
    v_sub_f32 v36, v36, v41
    v_sub_f32 v37, v37, v41
    v_sub_f32 v38, v38, v41
    v_sub_f32_e64 v39, v39, v41
    v_cvt_pk_bf16_f32 v4, v24, v25
    v_cvt_pk_bf16_f32 v5, v26, v27
    v_cvt_pk_bf16_f32 v6, v28, v29
    v_cvt_pk_bf16_f32 v7, v30, v31
    v_cvt_pk_bf16_f32 v8, v32, v33
    v_cvt_pk_bf16_f32 v9, v34, v35
    v_cvt_pk_bf16_f32 v10, v36, v37
    v_cvt_pk_bf16_f32 v11, v38, v39
    v_lshlrev_b32 v24, 16, v4
    v_and_b32 v25, 0xffff0000, v4
    v_lshlrev_b32 v26, 16, v5
    v_and_b32 v27, 0xffff0000, v5
    v_lshlrev_b32 v28, 16, v6
    v_and_b32 v29, 0xffff0000, v6
    v_lshlrev_b32 v30, 16, v7
    v_and_b32 v31, 0xffff0000, v7
    v_lshlrev_b32 v32, 16, v8
    v_and_b32 v33, 0xffff0000, v8
    v_lshlrev_b32 v34, 16, v9
    v_and_b32 v35, 0xffff0000, v9
    v_lshlrev_b32 v36, 16, v10
    v_and_b32 v37, 0xffff0000, v10
    v_lshlrev_b32 v38, 16, v11
    v_and_b32 v39, 0xffff0000, v11
    v_mul_f32 v24, v24, v42
    v_mul_f32 v25, v25, v42
    v_mul_f32 v26, v26, v42
    v_mul_f32 v27, v27, v42
    v_mul_f32 v28, v28, v42
    v_mul_f32 v29, v29, v42
    v_mul_f32 v30, v30, v42
    v_mul_f32 v31, v31, v42
    v_mul_f32 v32, v32, v42
    v_mul_f32 v33, v33, v42
    v_mul_f32 v34, v34, v42
    v_mul_f32 v35, v35, v42
    v_mul_f32 v36, v36, v42
    v_mul_f32 v37, v37, v42
    v_mul_f32 v38, v38, v42
    v_mul_f32 v39, v39, v42
    v_cvt_pk_bf16_f32 v4, v24, v25
    v_cvt_pk_bf16_f32 v5, v26, v27
    v_cvt_pk_bf16_f32 v6, v28, v29
    v_cvt_pk_bf16_f32 v7, v30, v31
    v_cvt_pk_bf16_f32 v8, v32, v33
    v_cvt_pk_bf16_f32 v9, v34, v35
    v_cvt_pk_bf16_f32 v10, v36, v37
    v_cvt_pk_bf16_f32 v11, v38, v39
    v_mov_b32 v40, 0
    v_mov_b32 v43, 0
    v_dot2_f32_bf16 v40, v4, v12, v40
    v_dot2_f32_bf16 v43, v5, v13, v43
    v_dot2_f32_bf16 v40, v6, v14, v40
    v_dot2_f32_bf16 v43, v7, v15, v43
    v_dot2_f32_bf16 v40, v8, v16, v40
    v_dot2_f32_bf16 v43, v9, v17, v43
    v_dot2_f32_bf16 v40, v10, v18, v40
    v_dot2_f32_bf16 v43, v11, v19, v43
    s_nop 2
    v_add_f32 v40, v40, v43
    s_nop 1
    v_add_f32_dpp v40, v40, v40 row_shr:1 row_mask:0xf bank_mask:0xf bound_ctrl:0
    s_nop 1
    v_add_f32_dpp v40, v40, v40 row_shr:2 row_mask:0xf bank_mask:0xf bound_ctrl:0
    s_nop 1
    v_add_f32_dpp v40, v40, v40 row_shr:4 row_mask:0xf bank_mask:0xf bound_ctrl:0
    s_nop 1
    v_add_f32_dpp v40, v40, v40 row_shr:8 row_mask:0xf bank_mask:0xf bound_ctrl:0
    s_nop 1
    v_add_f32_dpp v40, v40, v40 row_bcast:15 row_mask:0xa bank_mask:0xf
    s_nop 1
    v_add_f32_dpp v40, v40, v40 row_bcast:31 row_mask:0xc bank_mask:0xf
    s_nop 0
    v_readlane_b32 s52, v40, 63
    s_nop 1
    v_mov_b32 v44, s52
    v_cvt_pk_bf16_f32 v44, v44, v44
    v_and_b32 v44, 0xffff0000, v44
    v_ashrrev_i32 v45, 31, v44
    v_or_b32 v45, 0x80000000, v45
    v_xor_b32 v44, v44, v45
    v_and_b32 v44, 0xffff0000, v44
    s_sub_u32 s44, 2047, s77
    v_or_b32 v44, s44, v44
    v_xor_b32 v46, 0x80000000, v41
    v_mov_b32 v47, v42
    v_mul_f32 v48, 0x3fb8aa3b, v42
    s_lshl_b32 s44, s77, 2
    s_lshl_b32 s45, s77, 4
    s_add_u32 s45, s45, 65536
    v_mov_b32 v45, 0
    s_mov_b64 exec, 1
    buffer_store_dword v44, v45, s[40:43], s44 offen sc0 sc1
    buffer_store_dwordx3 v[46:48], v45, s[40:43], s45 offen sc0 sc1
    s_mov_b64 exec, -1

    s_cmp_ge_u32 s3, 4
    s_cbranch_scc1 F_aux
    s_branch F_k
.p2align 12
F_k:
    s_cbranch_execz F_w0
    s_nop 0
    s_setprio 2
    s_lshr_b32 s36, s3, 1
    s_and_b32 s37, s3, 1
    s_lshl_b32 s38, s36, 13
    s_lshl_b32 s42, s37, 1

    v_and_b32 v1, 15, v0
    v_lshrrev_b32 v2, 4, v0
    v_lshrrev_b32 v3, 1, v1
    v_xor_b32 v3, v3, v2
    v_lshlrev_b32 v3, 4, v3
    v_lshlrev_b32 v1, 7, v1
    v_add3_u32 v4, v1, v3, s38
    v_xor_b32 v5, 64, v4
    v_add_u32 v6, 81920, v4
    v_add_u32 v7, 81920, v5
    v_bfe_u32 v1, v0, 2, 2
    v_lshl_add_u32 v3, v2, 3, v1
    v_lshrrev_b32 v1, 1, v1
    v_and_b32 v2, 1, v2
    v_lshl_add_u32 v1, v2, 1, v1
    v_xor_b32 v1, s42, v1
    v_lshlrev_b32 v1, 5, v1
    v_lshl_add_u32 v1, v3, 7, v1
    v_and_b32 v2, 3, v0
    v_lshl_add_u32 v1, v2, 3, v1

    v_add_u32 v8, 16384, v1
    v_xor_b32 v9, 32, v8
    v_add_u32 v10, 81920, v8
    v_add_u32 v11, 81920, v9
    s_mov_b32 s40, 0x3f800008
    s_mov_b32 s41, s40
    s_mov_b32 s74, 0x358637bd
    s_mov_b32 s75, s74
    s_lshl_b32 s42, s36, 8
    s_add_u32 s42, s42, 24832
    v_and_or_b32 v164, v0, 48, s42
    v_and_b32 v165, 15, v0
    s_lshl_b32 s42, s37, 7
    s_add_u32 s42, s42, 26368
    v_lshl_add_u32 v165, v165, 2, s42
    s_lshl_b32 s42, s3, 12
    s_add_u32 s42, s42, 65536
    v_lshl_add_u32 v1, v0, 4, s42
    s_lshl_b32 s42, s3, 7
    s_add_u32 s42, s42, 27136
    v_and_or_b32 v2, v0, 48, s42
    s_lshl_b32 s42, s3, 2
    s_add_u32 s42, s42, 24640
    v_mov_b32_e64 v3, s42
    s_lshl_b32 s46, s28, 6
    s_lshl_b32 s78, s10, 1
    s_add_u32 s78, s78, s37
    s_lshl_b32 s79, s32, 18
    s_lshl_b32 s80, s36, 17
    s_add_u32 s79, s79, s80
    s_lshl_b32 s80, s78, 10
    s_add_u32 s79, s79, s80
    s_lshl_b32 s45, s32, 1
    s_add_u32 s45, s45, s36
    s_mul_i32 s45, s45, 8*64
    s_add_u32 s45, s45, 225280
    s_mul_i32 s82, s78, 4224
    s_add_u32 s83, s82, 4096
    s_lshl_b32 s50, s78, 4
    s_and_b32 s44, s32, 4-1
    s_mul_i32 s44, s44, 16/4
    s_add_u32 s50, s50, s44
    s_mul_i32 s50, s50, 64

    s_add_u32 s56, s50, 0x82f000
    s_add_u32 s56, s72, s56
    s_addc_u32 s57, s73, 0
    s_add_u32 s16, s72, 0x400000
    s_addc_u32 s17, s73, 0
    s_mov_b32 s18, 0x400000
    s_mov_b32 s19, 0x00020000
    s_add_u32 s68, s45, 0x800000
    s_add_u32 s68, s72, s68
    s_addc_u32 s69, s73, 0
    s_mov_b32 s76, 1
    s_barrier
    ds_read_b64_tr_b16 v[44:45], v8 offset:8192
    ds_read_b64_tr_b16 v[46:47], v8 offset:8704
    ds_read_b64_tr_b16 v[48:49], v8 offset:12288
    ds_read_b64_tr_b16 v[50:51], v8 offset:12800
    ds_read_b128 v[12:15], v4 offset:0
    ds_read_b128 v[28:31], v5 offset:0
    ds_read_b128 v[16:19], v4 offset:2048
    ds_read_b128 v[32:35], v5 offset:2048
    ds_read_b128 v[20:23], v4 offset:4096
    ds_read_b128 v[36:39], v5 offset:4096
    ds_read_b64_tr_b16 v[52:53], v9 offset:8192
    ds_read_b64_tr_b16 v[54:55], v9 offset:8704
    ds_read_b128 v[24:27], v4 offset:6144
    ds_read_b128 v[40:43], v5 offset:6144
    s_waitcnt lgkmcnt(14)
    s_mov_b32 s81, 3
F_p1:
    s_waitcnt lgkmcnt(7)
    v_mfma_f32_16x16x32_bf16 v[100:103], v[12:15], v[44:47], v[100:103]
    ds_read_b64_tr_b16 v[56:57], v9 offset:12288
    v_mfma_f32_16x16x32_bf16 v[100:103], v[28:31], v[48:51], v[100:103]
    ds_read_b64_tr_b16 v[58:59], v9 offset:12800
    v_mfma_f32_16x16x32_bf16 v[104:107], v[16:19], v[44:47], v[104:107]
    ds_read_b64_tr_b16 v[60:61], v8 offset:16384
    s_waitcnt lgkmcnt(9)
    v_mfma_f32_16x16x32_bf16 v[104:107], v[32:35], v[48:51], v[104:107]
    ds_read_b64_tr_b16 v[62:63], v8 offset:16896
    s_waitcnt lgkmcnt(9)
    v_mfma_f32_16x16x32_bf16 v[108:111], v[20:23], v[44:47], v[108:111]
    ds_read_b64_tr_b16 v[64:65], v8 offset:20480
    s_waitcnt lgkmcnt(9)
    v_mfma_f32_16x16x32_bf16 v[108:111], v[36:39], v[48:51], v[108:111]
    ds_read_b64_tr_b16 v[66:67], v8 offset:20992
    s_waitcnt lgkmcnt(7)
    v_mfma_f32_16x16x32_bf16 v[112:115], v[24:27], v[44:47], v[112:115]
    ds_read_b64_tr_b16 v[44:45], v9 offset:16384
    s_waitcnt lgkmcnt(7)
    v_mfma_f32_16x16x32_bf16 v[112:115], v[40:43], v[48:51], v[112:115]
    ds_read_b64_tr_b16 v[46:47], v9 offset:16896
    v_mfma_f32_16x16x32_bf16 v[116:119], v[12:15], v[52:55], v[116:119]
    ds_read_b64_tr_b16 v[48:49], v9 offset:20480
    s_waitcnt lgkmcnt(7)
    v_mfma_f32_16x16x32_bf16 v[116:119], v[28:31], v[56:59], v[116:119]
    ds_read_b64_tr_b16 v[50:51], v9 offset:20992
    v_mfma_f32_16x16x32_bf16 v[120:123], v[16:19], v[52:55], v[120:123]
    v_mfma_f32_16x16x32_bf16 v[120:123], v[32:35], v[56:59], v[120:123]
    v_mfma_f32_16x16x32_bf16 v[124:127], v[20:23], v[52:55], v[124:127]
    v_mfma_f32_16x16x32_bf16 v[124:127], v[36:39], v[56:59], v[124:127]
    v_mfma_f32_16x16x32_bf16 v[128:131], v[24:27], v[52:55], v[128:131]
    ds_read_b64_tr_b16 v[52:53], v8 offset:0
    v_mfma_f32_16x16x32_bf16 v[128:131], v[40:43], v[56:59], v[128:131]
    ds_read_b64_tr_b16 v[54:55], v8 offset:512
    s_waitcnt lgkmcnt(5)
    v_mfma_f32_16x16x32_bf16 v[132:135], v[12:15], v[60:63], v[132:135]
    ds_read_b64_tr_b16 v[56:57], v8 offset:4096
    v_mfma_f32_16x16x32_bf16 v[132:135], v[28:31], v[64:67], v[132:135]
    ds_read_b64_tr_b16 v[58:59], v8 offset:4608
    v_mfma_f32_16x16x32_bf16 v[136:139], v[16:19], v[60:63], v[136:139]
    v_mfma_f32_16x16x32_bf16 v[136:139], v[32:35], v[64:67], v[136:139]
    v_mfma_f32_16x16x32_bf16 v[140:143], v[20:23], v[60:63], v[140:143]
    v_mfma_f32_16x16x32_bf16 v[140:143], v[36:39], v[64:67], v[140:143]
    v_mfma_f32_16x16x32_bf16 v[144:147], v[24:27], v[60:63], v[144:147]
    ds_read_b64_tr_b16 v[60:61], v9 offset:0
    v_mfma_f32_16x16x32_bf16 v[144:147], v[40:43], v[64:67], v[144:147]
    ds_read_b64_tr_b16 v[62:63], v9 offset:512
    s_waitcnt lgkmcnt(5)
    v_mfma_f32_16x16x32_bf16 v[148:151], v[12:15], v[44:47], v[148:151]
    ds_read_b64_tr_b16 v[64:65], v9 offset:4096
    v_mfma_f32_16x16x32_bf16 v[148:151], v[28:31], v[48:51], v[148:151]
    ds_read_b64_tr_b16 v[66:67], v9 offset:4608
    v_mfma_f32_16x16x32_bf16 v[152:155], v[16:19], v[44:47], v[152:155]
    v_mfma_f32_16x16x32_bf16 v[152:155], v[32:35], v[48:51], v[152:155]
    v_mfma_f32_16x16x32_bf16 v[156:159], v[20:23], v[44:47], v[156:159]
    v_mfma_f32_16x16x32_bf16 v[156:159], v[36:39], v[48:51], v[156:159]
    s_waitcnt lgkmcnt(0)
    s_barrier
    v_mfma_f32_16x16x32_bf16 v[160:163], v[24:27], v[44:47], v[160:163]
    ds_read_b64_tr_b16 v[44:45], v8 offset:49152
    v_mfma_f32_16x16x32_bf16 v[160:163], v[40:43], v[48:51], v[160:163]
    ds_read_b64_tr_b16 v[46:47], v8 offset:49664
    v_mfma_f32_16x16x32_bf16 v[68:71], v[52:55], v[12:15], v[68:71]
    ds_read_b64_tr_b16 v[48:49], v8 offset:53248
    v_mfma_f32_16x16x32_bf16 v[68:71], v[56:59], v[28:31], v[68:71]
    ds_read_b64_tr_b16 v[50:51], v8 offset:53760
    v_mfma_f32_16x16x32_bf16 v[84:87], v[60:63], v[12:15], v[84:87]
    ds_read_b128 v[12:15], v4 offset:40960
    v_mfma_f32_16x16x32_bf16 v[84:87], v[64:67], v[28:31], v[84:87]
    ds_read_b128 v[28:31], v5 offset:40960
    v_mfma_f32_16x16x32_bf16 v[72:75], v[52:55], v[16:19], v[72:75]
    v_mfma_f32_16x16x32_bf16 v[72:75], v[56:59], v[32:35], v[72:75]
    v_mfma_f32_16x16x32_bf16 v[88:91], v[60:63], v[16:19], v[88:91]
    ds_read_b128 v[16:19], v4 offset:43008
    v_mfma_f32_16x16x32_bf16 v[88:91], v[64:67], v[32:35], v[88:91]
    ds_read_b128 v[32:35], v5 offset:43008
    v_mfma_f32_16x16x32_bf16 v[76:79], v[52:55], v[20:23], v[76:79]
    v_mfma_f32_16x16x32_bf16 v[76:79], v[56:59], v[36:39], v[76:79]
    v_mfma_f32_16x16x32_bf16 v[92:95], v[60:63], v[20:23], v[92:95]
    ds_read_b128 v[20:23], v4 offset:45056
    v_mfma_f32_16x16x32_bf16 v[92:95], v[64:67], v[36:39], v[92:95]
    ds_read_b128 v[36:39], v5 offset:45056
    v_mfma_f32_16x16x32_bf16 v[80:83], v[52:55], v[24:27], v[80:83]
    ds_read_b64_tr_b16 v[52:53], v9 offset:49152
    v_mfma_f32_16x16x32_bf16 v[80:83], v[56:59], v[40:43], v[80:83]
    ds_read_b64_tr_b16 v[54:55], v9 offset:49664
    v_mfma_f32_16x16x32_bf16 v[96:99], v[60:63], v[24:27], v[96:99]
    ds_read_b128 v[24:27], v4 offset:47104
    v_mfma_f32_16x16x32_bf16 v[96:99], v[64:67], v[40:43], v[96:99]
    ds_read_b128 v[40:43], v5 offset:47104
    s_waitcnt lgkmcnt(7)
    v_mfma_f32_16x16x32_bf16 v[100:103], v[12:15], v[44:47], v[100:103]
    ds_read_b64_tr_b16 v[56:57], v9 offset:53248
    v_mfma_f32_16x16x32_bf16 v[100:103], v[28:31], v[48:51], v[100:103]
    ds_read_b64_tr_b16 v[58:59], v9 offset:53760
    v_mfma_f32_16x16x32_bf16 v[104:107], v[16:19], v[44:47], v[104:107]
    ds_read_b64_tr_b16 v[60:61], v8 offset:57344
    s_waitcnt lgkmcnt(9)
    v_mfma_f32_16x16x32_bf16 v[104:107], v[32:35], v[48:51], v[104:107]
    ds_read_b64_tr_b16 v[62:63], v8 offset:57856
    s_waitcnt lgkmcnt(9)
    v_mfma_f32_16x16x32_bf16 v[108:111], v[20:23], v[44:47], v[108:111]
    ds_read_b64_tr_b16 v[64:65], v8 offset:61440
    s_waitcnt lgkmcnt(9)
    v_mfma_f32_16x16x32_bf16 v[108:111], v[36:39], v[48:51], v[108:111]
    ds_read_b64_tr_b16 v[66:67], v8 offset:61952
    s_waitcnt lgkmcnt(7)
    v_mfma_f32_16x16x32_bf16 v[112:115], v[24:27], v[44:47], v[112:115]
    ds_read_b64_tr_b16 v[44:45], v9 offset:57344
    s_waitcnt lgkmcnt(7)
    v_mfma_f32_16x16x32_bf16 v[112:115], v[40:43], v[48:51], v[112:115]
    ds_read_b64_tr_b16 v[46:47], v9 offset:57856
    v_mfma_f32_16x16x32_bf16 v[116:119], v[12:15], v[52:55], v[116:119]
    ds_read_b64_tr_b16 v[48:49], v9 offset:61440
    s_waitcnt lgkmcnt(7)
    v_mfma_f32_16x16x32_bf16 v[116:119], v[28:31], v[56:59], v[116:119]
    ds_read_b64_tr_b16 v[50:51], v9 offset:61952
    v_mfma_f32_16x16x32_bf16 v[120:123], v[16:19], v[52:55], v[120:123]
    v_mfma_f32_16x16x32_bf16 v[120:123], v[32:35], v[56:59], v[120:123]
    v_mfma_f32_16x16x32_bf16 v[124:127], v[20:23], v[52:55], v[124:127]
    v_mfma_f32_16x16x32_bf16 v[124:127], v[36:39], v[56:59], v[124:127]
    v_mfma_f32_16x16x32_bf16 v[128:131], v[24:27], v[52:55], v[128:131]
    ds_read_b64_tr_b16 v[52:53], v8 offset:40960
    v_mfma_f32_16x16x32_bf16 v[128:131], v[40:43], v[56:59], v[128:131]
    ds_read_b64_tr_b16 v[54:55], v8 offset:41472
    s_waitcnt lgkmcnt(5)
    v_mfma_f32_16x16x32_bf16 v[132:135], v[12:15], v[60:63], v[132:135]
    ds_read_b64_tr_b16 v[56:57], v8 offset:45056
    v_mfma_f32_16x16x32_bf16 v[132:135], v[28:31], v[64:67], v[132:135]
    ds_read_b64_tr_b16 v[58:59], v8 offset:45568
    v_mfma_f32_16x16x32_bf16 v[136:139], v[16:19], v[60:63], v[136:139]
    v_mfma_f32_16x16x32_bf16 v[136:139], v[32:35], v[64:67], v[136:139]
    v_mfma_f32_16x16x32_bf16 v[140:143], v[20:23], v[60:63], v[140:143]
    v_mfma_f32_16x16x32_bf16 v[140:143], v[36:39], v[64:67], v[140:143]
    v_mfma_f32_16x16x32_bf16 v[144:147], v[24:27], v[60:63], v[144:147]
    ds_read_b64_tr_b16 v[60:61], v9 offset:40960
    v_mfma_f32_16x16x32_bf16 v[144:147], v[40:43], v[64:67], v[144:147]
    ds_read_b64_tr_b16 v[62:63], v9 offset:41472
    s_waitcnt lgkmcnt(5)
    v_mfma_f32_16x16x32_bf16 v[148:151], v[12:15], v[44:47], v[148:151]
    ds_read_b64_tr_b16 v[64:65], v9 offset:45056
    v_mfma_f32_16x16x32_bf16 v[148:151], v[28:31], v[48:51], v[148:151]
    ds_read_b64_tr_b16 v[66:67], v9 offset:45568
    v_mfma_f32_16x16x32_bf16 v[152:155], v[16:19], v[44:47], v[152:155]
    v_mfma_f32_16x16x32_bf16 v[152:155], v[32:35], v[48:51], v[152:155]
    v_mfma_f32_16x16x32_bf16 v[156:159], v[20:23], v[44:47], v[156:159]
    v_mfma_f32_16x16x32_bf16 v[156:159], v[36:39], v[48:51], v[156:159]
    s_waitcnt lgkmcnt(0)
    s_waitcnt vmcnt(0)
    s_barrier
    v_mfma_f32_16x16x32_bf16 v[160:163], v[24:27], v[44:47], v[160:163]
    ds_read_b64_tr_b16 v[44:45], v10 offset:8192
    v_mfma_f32_16x16x32_bf16 v[160:163], v[40:43], v[48:51], v[160:163]
    ds_read_b64_tr_b16 v[46:47], v10 offset:8704
    v_mfma_f32_16x16x32_bf16 v[68:71], v[52:55], v[12:15], v[68:71]
    ds_read_b64_tr_b16 v[48:49], v10 offset:12288
    v_mfma_f32_16x16x32_bf16 v[68:71], v[56:59], v[28:31], v[68:71]
    ds_read_b64_tr_b16 v[50:51], v10 offset:12800
    v_mfma_f32_16x16x32_bf16 v[84:87], v[60:63], v[12:15], v[84:87]
    ds_read_b128 v[12:15], v6 offset:0
    v_mfma_f32_16x16x32_bf16 v[84:87], v[64:67], v[28:31], v[84:87]
    ds_read_b128 v[28:31], v7 offset:0
    v_mfma_f32_16x16x32_bf16 v[72:75], v[52:55], v[16:19], v[72:75]
    v_mfma_f32_16x16x32_bf16 v[72:75], v[56:59], v[32:35], v[72:75]
    v_mfma_f32_16x16x32_bf16 v[88:91], v[60:63], v[16:19], v[88:91]
    ds_read_b128 v[16:19], v6 offset:2048
    v_mfma_f32_16x16x32_bf16 v[88:91], v[64:67], v[32:35], v[88:91]
    ds_read_b128 v[32:35], v7 offset:2048
    v_mfma_f32_16x16x32_bf16 v[76:79], v[52:55], v[20:23], v[76:79]
    v_mfma_f32_16x16x32_bf16 v[76:79], v[56:59], v[36:39], v[76:79]
    v_mfma_f32_16x16x32_bf16 v[92:95], v[60:63], v[20:23], v[92:95]
    ds_read_b128 v[20:23], v6 offset:4096
    v_mfma_f32_16x16x32_bf16 v[92:95], v[64:67], v[36:39], v[92:95]
    ds_read_b128 v[36:39], v7 offset:4096
    v_mfma_f32_16x16x32_bf16 v[80:83], v[52:55], v[24:27], v[80:83]
    ds_read_b64_tr_b16 v[52:53], v11 offset:8192
    v_mfma_f32_16x16x32_bf16 v[80:83], v[56:59], v[40:43], v[80:83]
    ds_read_b64_tr_b16 v[54:55], v11 offset:8704
    v_mfma_f32_16x16x32_bf16 v[96:99], v[60:63], v[24:27], v[96:99]
    ds_read_b128 v[24:27], v6 offset:6144
    v_mfma_f32_16x16x32_bf16 v[96:99], v[64:67], v[40:43], v[96:99]
    ds_read_b128 v[40:43], v7 offset:6144
    s_waitcnt lgkmcnt(7)
    v_mfma_f32_16x16x32_bf16 v[100:103], v[12:15], v[44:47], v[100:103]
    ds_read_b64_tr_b16 v[56:57], v11 offset:12288
    v_mfma_f32_16x16x32_bf16 v[100:103], v[28:31], v[48:51], v[100:103]
    ds_read_b64_tr_b16 v[58:59], v11 offset:12800
    v_mfma_f32_16x16x32_bf16 v[104:107], v[16:19], v[44:47], v[104:107]
    ds_read_b64_tr_b16 v[60:61], v10 offset:16384
    s_waitcnt lgkmcnt(9)
    v_mfma_f32_16x16x32_bf16 v[104:107], v[32:35], v[48:51], v[104:107]
    ds_read_b64_tr_b16 v[62:63], v10 offset:16896
    s_waitcnt lgkmcnt(9)
    v_mfma_f32_16x16x32_bf16 v[108:111], v[20:23], v[44:47], v[108:111]
    ds_read_b64_tr_b16 v[64:65], v10 offset:20480
    s_waitcnt lgkmcnt(9)
    v_mfma_f32_16x16x32_bf16 v[108:111], v[36:39], v[48:51], v[108:111]
    ds_read_b64_tr_b16 v[66:67], v10 offset:20992
    s_waitcnt lgkmcnt(7)
    v_mfma_f32_16x16x32_bf16 v[112:115], v[24:27], v[44:47], v[112:115]
    ds_read_b64_tr_b16 v[44:45], v11 offset:16384
    s_waitcnt lgkmcnt(7)
    v_mfma_f32_16x16x32_bf16 v[112:115], v[40:43], v[48:51], v[112:115]
    ds_read_b64_tr_b16 v[46:47], v11 offset:16896
    v_mfma_f32_16x16x32_bf16 v[116:119], v[12:15], v[52:55], v[116:119]
    ds_read_b64_tr_b16 v[48:49], v11 offset:20480
    s_waitcnt lgkmcnt(7)
    v_mfma_f32_16x16x32_bf16 v[116:119], v[28:31], v[56:59], v[116:119]
    ds_read_b64_tr_b16 v[50:51], v11 offset:20992
    v_mfma_f32_16x16x32_bf16 v[120:123], v[16:19], v[52:55], v[120:123]
    v_mfma_f32_16x16x32_bf16 v[120:123], v[32:35], v[56:59], v[120:123]
    v_mfma_f32_16x16x32_bf16 v[124:127], v[20:23], v[52:55], v[124:127]
    v_mfma_f32_16x16x32_bf16 v[124:127], v[36:39], v[56:59], v[124:127]
    v_mfma_f32_16x16x32_bf16 v[128:131], v[24:27], v[52:55], v[128:131]
    ds_read_b64_tr_b16 v[52:53], v10 offset:0
    v_mfma_f32_16x16x32_bf16 v[128:131], v[40:43], v[56:59], v[128:131]
    ds_read_b64_tr_b16 v[54:55], v10 offset:512
    s_waitcnt lgkmcnt(5)
    v_mfma_f32_16x16x32_bf16 v[132:135], v[12:15], v[60:63], v[132:135]
    ds_read_b64_tr_b16 v[56:57], v10 offset:4096
    v_mfma_f32_16x16x32_bf16 v[132:135], v[28:31], v[64:67], v[132:135]
    ds_read_b64_tr_b16 v[58:59], v10 offset:4608
    v_mfma_f32_16x16x32_bf16 v[136:139], v[16:19], v[60:63], v[136:139]
    v_mfma_f32_16x16x32_bf16 v[136:139], v[32:35], v[64:67], v[136:139]
    v_mfma_f32_16x16x32_bf16 v[140:143], v[20:23], v[60:63], v[140:143]
    v_mfma_f32_16x16x32_bf16 v[140:143], v[36:39], v[64:67], v[140:143]
    v_mfma_f32_16x16x32_bf16 v[144:147], v[24:27], v[60:63], v[144:147]
    ds_read_b64_tr_b16 v[60:61], v11 offset:0
    v_mfma_f32_16x16x32_bf16 v[144:147], v[40:43], v[64:67], v[144:147]
    ds_read_b64_tr_b16 v[62:63], v11 offset:512
    s_waitcnt lgkmcnt(5)
    v_mfma_f32_16x16x32_bf16 v[148:151], v[12:15], v[44:47], v[148:151]
    ds_read_b64_tr_b16 v[64:65], v11 offset:4096
    v_mfma_f32_16x16x32_bf16 v[148:151], v[28:31], v[48:51], v[148:151]
    ds_read_b64_tr_b16 v[66:67], v11 offset:4608
    v_mfma_f32_16x16x32_bf16 v[152:155], v[16:19], v[44:47], v[152:155]
    v_mfma_f32_16x16x32_bf16 v[152:155], v[32:35], v[48:51], v[152:155]
    v_mfma_f32_16x16x32_bf16 v[156:159], v[20:23], v[44:47], v[156:159]
    v_mfma_f32_16x16x32_bf16 v[156:159], v[36:39], v[48:51], v[156:159]
    s_waitcnt lgkmcnt(0)
    s_barrier
    v_mfma_f32_16x16x32_bf16 v[160:163], v[24:27], v[44:47], v[160:163]
    ds_read_b64_tr_b16 v[44:45], v10 offset:49152
    v_mfma_f32_16x16x32_bf16 v[160:163], v[40:43], v[48:51], v[160:163]
    ds_read_b64_tr_b16 v[46:47], v10 offset:49664
    v_mfma_f32_16x16x32_bf16 v[68:71], v[52:55], v[12:15], v[68:71]
    ds_read_b64_tr_b16 v[48:49], v10 offset:53248
    v_mfma_f32_16x16x32_bf16 v[68:71], v[56:59], v[28:31], v[68:71]
    ds_read_b64_tr_b16 v[50:51], v10 offset:53760
    v_mfma_f32_16x16x32_bf16 v[84:87], v[60:63], v[12:15], v[84:87]
    ds_read_b128 v[12:15], v6 offset:40960
    v_mfma_f32_16x16x32_bf16 v[84:87], v[64:67], v[28:31], v[84:87]
    ds_read_b128 v[28:31], v7 offset:40960
    v_mfma_f32_16x16x32_bf16 v[72:75], v[52:55], v[16:19], v[72:75]
    v_mfma_f32_16x16x32_bf16 v[72:75], v[56:59], v[32:35], v[72:75]
    v_mfma_f32_16x16x32_bf16 v[88:91], v[60:63], v[16:19], v[88:91]
    ds_read_b128 v[16:19], v6 offset:43008
    v_mfma_f32_16x16x32_bf16 v[88:91], v[64:67], v[32:35], v[88:91]
    ds_read_b128 v[32:35], v7 offset:43008
    v_mfma_f32_16x16x32_bf16 v[76:79], v[52:55], v[20:23], v[76:79]
    v_mfma_f32_16x16x32_bf16 v[76:79], v[56:59], v[36:39], v[76:79]
    v_mfma_f32_16x16x32_bf16 v[92:95], v[60:63], v[20:23], v[92:95]
    ds_read_b128 v[20:23], v6 offset:45056
    v_mfma_f32_16x16x32_bf16 v[92:95], v[64:67], v[36:39], v[92:95]
    ds_read_b128 v[36:39], v7 offset:45056
    v_mfma_f32_16x16x32_bf16 v[80:83], v[52:55], v[24:27], v[80:83]
    ds_read_b64_tr_b16 v[52:53], v11 offset:49152
    v_mfma_f32_16x16x32_bf16 v[80:83], v[56:59], v[40:43], v[80:83]
    ds_read_b64_tr_b16 v[54:55], v11 offset:49664
    v_mfma_f32_16x16x32_bf16 v[96:99], v[60:63], v[24:27], v[96:99]
    ds_read_b128 v[24:27], v6 offset:47104
    v_mfma_f32_16x16x32_bf16 v[96:99], v[64:67], v[40:43], v[96:99]
    ds_read_b128 v[40:43], v7 offset:47104
    s_waitcnt lgkmcnt(7)
    v_mfma_f32_16x16x32_bf16 v[100:103], v[12:15], v[44:47], v[100:103]
    ds_read_b64_tr_b16 v[56:57], v11 offset:53248
    v_mfma_f32_16x16x32_bf16 v[100:103], v[28:31], v[48:51], v[100:103]
    ds_read_b64_tr_b16 v[58:59], v11 offset:53760
    v_mfma_f32_16x16x32_bf16 v[104:107], v[16:19], v[44:47], v[104:107]
    ds_read_b64_tr_b16 v[60:61], v10 offset:57344
    s_waitcnt lgkmcnt(9)
    v_mfma_f32_16x16x32_bf16 v[104:107], v[32:35], v[48:51], v[104:107]
    ds_read_b64_tr_b16 v[62:63], v10 offset:57856
    s_waitcnt lgkmcnt(9)
    v_mfma_f32_16x16x32_bf16 v[108:111], v[20:23], v[44:47], v[108:111]
    ds_read_b64_tr_b16 v[64:65], v10 offset:61440
    s_waitcnt lgkmcnt(9)
    v_mfma_f32_16x16x32_bf16 v[108:111], v[36:39], v[48:51], v[108:111]
    ds_read_b64_tr_b16 v[66:67], v10 offset:61952
    s_waitcnt lgkmcnt(7)
    v_mfma_f32_16x16x32_bf16 v[112:115], v[24:27], v[44:47], v[112:115]
    ds_read_b64_tr_b16 v[44:45], v11 offset:57344
    s_waitcnt lgkmcnt(7)
    v_mfma_f32_16x16x32_bf16 v[112:115], v[40:43], v[48:51], v[112:115]
    ds_read_b64_tr_b16 v[46:47], v11 offset:57856
    v_mfma_f32_16x16x32_bf16 v[116:119], v[12:15], v[52:55], v[116:119]
    ds_read_b64_tr_b16 v[48:49], v11 offset:61440
    s_waitcnt lgkmcnt(7)
    v_mfma_f32_16x16x32_bf16 v[116:119], v[28:31], v[56:59], v[116:119]
    ds_read_b64_tr_b16 v[50:51], v11 offset:61952
    v_mfma_f32_16x16x32_bf16 v[120:123], v[16:19], v[52:55], v[120:123]
    v_mfma_f32_16x16x32_bf16 v[120:123], v[32:35], v[56:59], v[120:123]
    v_mfma_f32_16x16x32_bf16 v[124:127], v[20:23], v[52:55], v[124:127]
    v_mfma_f32_16x16x32_bf16 v[124:127], v[36:39], v[56:59], v[124:127]
    v_mfma_f32_16x16x32_bf16 v[128:131], v[24:27], v[52:55], v[128:131]
    ds_read_b64_tr_b16 v[52:53], v10 offset:40960
    v_mfma_f32_16x16x32_bf16 v[128:131], v[40:43], v[56:59], v[128:131]
    ds_read_b64_tr_b16 v[54:55], v10 offset:41472
    s_waitcnt lgkmcnt(5)
    v_mfma_f32_16x16x32_bf16 v[132:135], v[12:15], v[60:63], v[132:135]
    ds_read_b64_tr_b16 v[56:57], v10 offset:45056
    v_mfma_f32_16x16x32_bf16 v[132:135], v[28:31], v[64:67], v[132:135]
    ds_read_b64_tr_b16 v[58:59], v10 offset:45568
    v_mfma_f32_16x16x32_bf16 v[136:139], v[16:19], v[60:63], v[136:139]
    v_mfma_f32_16x16x32_bf16 v[136:139], v[32:35], v[64:67], v[136:139]
    v_mfma_f32_16x16x32_bf16 v[140:143], v[20:23], v[60:63], v[140:143]
    v_mfma_f32_16x16x32_bf16 v[140:143], v[36:39], v[64:67], v[140:143]
    v_mfma_f32_16x16x32_bf16 v[144:147], v[24:27], v[60:63], v[144:147]
    ds_read_b64_tr_b16 v[60:61], v11 offset:40960
    v_mfma_f32_16x16x32_bf16 v[144:147], v[40:43], v[64:67], v[144:147]
    ds_read_b64_tr_b16 v[62:63], v11 offset:41472
    s_waitcnt lgkmcnt(5)
    v_mfma_f32_16x16x32_bf16 v[148:151], v[12:15], v[44:47], v[148:151]
    ds_read_b64_tr_b16 v[64:65], v11 offset:45056
    v_mfma_f32_16x16x32_bf16 v[148:151], v[28:31], v[48:51], v[148:151]
    ds_read_b64_tr_b16 v[66:67], v11 offset:45568
    v_mfma_f32_16x16x32_bf16 v[152:155], v[16:19], v[44:47], v[152:155]
    v_mfma_f32_16x16x32_bf16 v[152:155], v[32:35], v[48:51], v[152:155]
    v_mfma_f32_16x16x32_bf16 v[156:159], v[20:23], v[44:47], v[156:159]
    v_mfma_f32_16x16x32_bf16 v[156:159], v[36:39], v[48:51], v[156:159]
    s_waitcnt lgkmcnt(0)
    s_barrier
    v_mfma_f32_16x16x32_bf16 v[160:163], v[24:27], v[44:47], v[160:163]
    ds_read_b64_tr_b16 v[44:45], v8 offset:8192
    v_mfma_f32_16x16x32_bf16 v[160:163], v[40:43], v[48:51], v[160:163]
    ds_read_b64_tr_b16 v[46:47], v8 offset:8704
    v_mfma_f32_16x16x32_bf16 v[68:71], v[52:55], v[12:15], v[68:71]
    ds_read_b64_tr_b16 v[48:49], v8 offset:12288
    v_mfma_f32_16x16x32_bf16 v[68:71], v[56:59], v[28:31], v[68:71]
    ds_read_b64_tr_b16 v[50:51], v8 offset:12800
    v_mfma_f32_16x16x32_bf16 v[84:87], v[60:63], v[12:15], v[84:87]
    ds_read_b128 v[12:15], v4 offset:0
    v_mfma_f32_16x16x32_bf16 v[84:87], v[64:67], v[28:31], v[84:87]
    ds_read_b128 v[28:31], v5 offset:0
    v_mfma_f32_16x16x32_bf16 v[72:75], v[52:55], v[16:19], v[72:75]
    v_mfma_f32_16x16x32_bf16 v[72:75], v[56:59], v[32:35], v[72:75]
    v_mfma_f32_16x16x32_bf16 v[88:91], v[60:63], v[16:19], v[88:91]
    ds_read_b128 v[16:19], v4 offset:2048
    v_mfma_f32_16x16x32_bf16 v[88:91], v[64:67], v[32:35], v[88:91]
    ds_read_b128 v[32:35], v5 offset:2048
    v_mfma_f32_16x16x32_bf16 v[76:79], v[52:55], v[20:23], v[76:79]
    v_mfma_f32_16x16x32_bf16 v[76:79], v[56:59], v[36:39], v[76:79]
    s_sub_u32 s81, s81, 1
    s_cmp_lg_u32 s81, 0
    v_mfma_f32_16x16x32_bf16 v[92:95], v[60:63], v[20:23], v[92:95]
    ds_read_b128 v[20:23], v4 offset:4096
    v_mfma_f32_16x16x32_bf16 v[92:95], v[64:67], v[36:39], v[92:95]
    ds_read_b128 v[36:39], v5 offset:4096
    v_mfma_f32_16x16x32_bf16 v[80:83], v[52:55], v[24:27], v[80:83]
    ds_read_b64_tr_b16 v[52:53], v9 offset:8192
    v_mfma_f32_16x16x32_bf16 v[80:83], v[56:59], v[40:43], v[80:83]
    ds_read_b64_tr_b16 v[54:55], v9 offset:8704
    v_mfma_f32_16x16x32_bf16 v[96:99], v[60:63], v[24:27], v[96:99]
    ds_read_b128 v[24:27], v4 offset:6144
    v_mfma_f32_16x16x32_bf16 v[96:99], v[64:67], v[40:43], v[96:99]
    ds_read_b128 v[40:43], v5 offset:6144
    s_cbranch_scc1 F_p1
    s_waitcnt lgkmcnt(7)
    v_mfma_f32_16x16x32_bf16 v[100:103], v[12:15], v[44:47], v[100:103]
    ds_read_b64_tr_b16 v[56:57], v9 offset:12288
    v_mfma_f32_16x16x32_bf16 v[100:103], v[28:31], v[48:51], v[100:103]
    ds_read_b64_tr_b16 v[58:59], v9 offset:12800
    v_mfma_f32_16x16x32_bf16 v[104:107], v[16:19], v[44:47], v[104:107]
    ds_read_b64_tr_b16 v[60:61], v8 offset:16384
    s_waitcnt lgkmcnt(9)
    v_mfma_f32_16x16x32_bf16 v[104:107], v[32:35], v[48:51], v[104:107]
    ds_read_b64_tr_b16 v[62:63], v8 offset:16896
    s_waitcnt lgkmcnt(9)
    v_mfma_f32_16x16x32_bf16 v[108:111], v[20:23], v[44:47], v[108:111]
    ds_read_b64_tr_b16 v[64:65], v8 offset:20480
    s_waitcnt lgkmcnt(9)
    v_mfma_f32_16x16x32_bf16 v[108:111], v[36:39], v[48:51], v[108:111]
    ds_read_b64_tr_b16 v[66:67], v8 offset:20992
    s_waitcnt lgkmcnt(7)
    v_mfma_f32_16x16x32_bf16 v[112:115], v[24:27], v[44:47], v[112:115]
    ds_read_b64_tr_b16 v[44:45], v9 offset:16384
    s_waitcnt lgkmcnt(7)
    v_mfma_f32_16x16x32_bf16 v[112:115], v[40:43], v[48:51], v[112:115]
    ds_read_b64_tr_b16 v[46:47], v9 offset:16896
    v_mfma_f32_16x16x32_bf16 v[116:119], v[12:15], v[52:55], v[116:119]
    ds_read_b64_tr_b16 v[48:49], v9 offset:20480
    s_waitcnt lgkmcnt(7)
    v_mfma_f32_16x16x32_bf16 v[116:119], v[28:31], v[56:59], v[116:119]
    ds_read_b64_tr_b16 v[50:51], v9 offset:20992
    v_mfma_f32_16x16x32_bf16 v[120:123], v[16:19], v[52:55], v[120:123]
    v_mfma_f32_16x16x32_bf16 v[120:123], v[32:35], v[56:59], v[120:123]
    v_mfma_f32_16x16x32_bf16 v[124:127], v[20:23], v[52:55], v[124:127]
    v_mfma_f32_16x16x32_bf16 v[124:127], v[36:39], v[56:59], v[124:127]
    s_waitcnt lgkmcnt(0)
    s_barrier
    v_mfma_f32_16x16x32_bf16 v[128:131], v[24:27], v[52:55], v[128:131]
    ds_read_b64_tr_b16 v[52:53], v8 offset:49152
    v_mfma_f32_16x16x32_bf16 v[128:131], v[40:43], v[56:59], v[128:131]
    ds_read_b64_tr_b16 v[54:55], v8 offset:49664
    v_mfma_f32_16x16x32_bf16 v[132:135], v[12:15], v[60:63], v[132:135]
    ds_read_b64_tr_b16 v[56:57], v8 offset:53248
    v_mfma_f32_16x16x32_bf16 v[132:135], v[28:31], v[64:67], v[132:135]
    ds_read_b64_tr_b16 v[58:59], v8 offset:53760
    v_mfma_f32_16x16x32_bf16 v[148:151], v[12:15], v[44:47], v[148:151]
    ds_read_b128 v[12:15], v4 offset:40960
    v_mfma_f32_16x16x32_bf16 v[148:151], v[28:31], v[48:51], v[148:151]
    ds_read_b128 v[28:31], v5 offset:40960
    v_mfma_f32_16x16x32_bf16 v[136:139], v[16:19], v[60:63], v[136:139]
    v_mfma_f32_16x16x32_bf16 v[136:139], v[32:35], v[64:67], v[136:139]
    v_mfma_f32_16x16x32_bf16 v[152:155], v[16:19], v[44:47], v[152:155]
    ds_read_b128 v[16:19], v4 offset:43008
    v_mfma_f32_16x16x32_bf16 v[152:155], v[32:35], v[48:51], v[152:155]
    ds_read_b128 v[32:35], v5 offset:43008
    v_mfma_f32_16x16x32_bf16 v[140:143], v[20:23], v[60:63], v[140:143]
    v_mfma_f32_16x16x32_bf16 v[140:143], v[36:39], v[64:67], v[140:143]
    v_mfma_f32_16x16x32_bf16 v[156:159], v[20:23], v[44:47], v[156:159]
    ds_read_b128 v[20:23], v4 offset:45056
    v_mfma_f32_16x16x32_bf16 v[156:159], v[36:39], v[48:51], v[156:159]
    ds_read_b128 v[36:39], v5 offset:45056
    v_mfma_f32_16x16x32_bf16 v[144:147], v[24:27], v[60:63], v[144:147]
    ds_read_b64_tr_b16 v[60:61], v9 offset:49152
    v_mfma_f32_16x16x32_bf16 v[144:147], v[40:43], v[64:67], v[144:147]
    ds_read_b64_tr_b16 v[62:63], v9 offset:49664
    v_mfma_f32_16x16x32_bf16 v[160:163], v[24:27], v[44:47], v[160:163]
    ds_read_b128 v[24:27], v4 offset:47104
    v_mfma_f32_16x16x32_bf16 v[160:163], v[40:43], v[48:51], v[160:163]
    ds_read_b128 v[40:43], v5 offset:47104
    s_waitcnt lgkmcnt(7)
    v_mfma_f32_16x16x32_bf16 v[100:103], v[12:15], v[52:55], v[100:103]
    ds_read_b64_tr_b16 v[64:65], v9 offset:53248
    v_mfma_f32_16x16x32_bf16 v[100:103], v[28:31], v[56:59], v[100:103]
    ds_read_b64_tr_b16 v[66:67], v9 offset:53760
    v_mfma_f32_16x16x32_bf16 v[104:107], v[16:19], v[52:55], v[104:107]
    ds_read_b64_tr_b16 v[44:45], v8 offset:57344
    s_waitcnt lgkmcnt(9)
    v_mfma_f32_16x16x32_bf16 v[104:107], v[32:35], v[56:59], v[104:107]
    ds_read_b64_tr_b16 v[46:47], v8 offset:57856
    s_waitcnt lgkmcnt(9)
    v_mfma_f32_16x16x32_bf16 v[108:111], v[20:23], v[52:55], v[108:111]
    ds_read_b64_tr_b16 v[48:49], v8 offset:61440
    s_waitcnt lgkmcnt(9)
    v_mfma_f32_16x16x32_bf16 v[108:111], v[36:39], v[56:59], v[108:111]
    ds_read_b64_tr_b16 v[50:51], v8 offset:61952
    s_waitcnt lgkmcnt(7)
    v_mfma_f32_16x16x32_bf16 v[112:115], v[24:27], v[52:55], v[112:115]
    ds_read_b64_tr_b16 v[52:53], v9 offset:57344
    s_waitcnt lgkmcnt(7)
    v_mfma_f32_16x16x32_bf16 v[112:115], v[40:43], v[56:59], v[112:115]
    ds_read_b64_tr_b16 v[54:55], v9 offset:57856
    v_mfma_f32_16x16x32_bf16 v[116:119], v[12:15], v[60:63], v[116:119]
    ds_read_b64_tr_b16 v[56:57], v9 offset:61440
    s_waitcnt lgkmcnt(7)
    v_mfma_f32_16x16x32_bf16 v[116:119], v[28:31], v[64:67], v[116:119]
    ds_read_b64_tr_b16 v[58:59], v9 offset:61952
    v_mfma_f32_16x16x32_bf16 v[120:123], v[16:19], v[60:63], v[120:123]
    v_mfma_f32_16x16x32_bf16 v[120:123], v[32:35], v[64:67], v[120:123]
    v_mfma_f32_16x16x32_bf16 v[124:127], v[20:23], v[60:63], v[124:127]
    v_mfma_f32_16x16x32_bf16 v[124:127], v[36:39], v[64:67], v[124:127]
    s_waitcnt lgkmcnt(0)
    s_barrier
    v_mfma_f32_16x16x32_bf16 v[128:131], v[24:27], v[60:63], v[128:131]
    ds_read_b64_tr_b16 v[60:61], v10 offset:8192
    v_mfma_f32_16x16x32_bf16 v[128:131], v[40:43], v[64:67], v[128:131]
    ds_read_b64_tr_b16 v[62:63], v10 offset:8704
    v_mfma_f32_16x16x32_bf16 v[132:135], v[12:15], v[44:47], v[132:135]
    ds_read_b64_tr_b16 v[64:65], v10 offset:12288
    v_mfma_f32_16x16x32_bf16 v[132:135], v[28:31], v[48:51], v[132:135]
W_1:
    s_cbranch_execz R_1
    s_nop 0
    ds_read_b64_tr_b16 v[66:67], v10 offset:12800
    v_mfma_f32_16x16x32_bf16 v[148:151], v[12:15], v[52:55], v[148:151]
    ds_read_b128 v[12:15], v6 offset:0
    v_mfma_f32_16x16x32_bf16 v[148:151], v[28:31], v[56:59], v[148:151]
    ds_read_b128 v[28:31], v7 offset:0
    v_mfma_f32_16x16x32_bf16 v[136:139], v[16:19], v[44:47], v[136:139]
    v_mfma_f32_16x16x32_bf16 v[136:139], v[32:35], v[48:51], v[136:139]
    v_mfma_f32_16x16x32_bf16 v[152:155], v[16:19], v[52:55], v[152:155]
    ds_read_b128 v[16:19], v6 offset:2048
    v_mfma_f32_16x16x32_bf16 v[152:155], v[32:35], v[56:59], v[152:155]
    ds_read_b128 v[32:35], v7 offset:2048
    v_mfma_f32_16x16x32_bf16 v[140:143], v[20:23], v[44:47], v[140:143]
    v_mfma_f32_16x16x32_bf16 v[140:143], v[36:39], v[48:51], v[140:143]
    v_mfma_f32_16x16x32_bf16 v[156:159], v[20:23], v[52:55], v[156:159]
    ds_read_b128 v[20:23], v6 offset:4096
    v_mfma_f32_16x16x32_bf16 v[156:159], v[36:39], v[56:59], v[156:159]
    ds_read_b128 v[36:39], v7 offset:4096
    v_mfma_f32_16x16x32_bf16 v[144:147], v[24:27], v[44:47], v[144:147]
    ds_read_b64_tr_b16 v[44:45], v11 offset:8192
    v_mfma_f32_16x16x32_bf16 v[144:147], v[40:43], v[48:51], v[144:147]
    ds_read_b64_tr_b16 v[46:47], v11 offset:8704
    v_mfma_f32_16x16x32_bf16 v[160:163], v[24:27], v[52:55], v[160:163]
    ds_read_b128 v[24:27], v6 offset:6144
    v_mfma_f32_16x16x32_bf16 v[160:163], v[40:43], v[56:59], v[160:163]
    ds_read_b128 v[40:43], v7 offset:6144
    s_waitcnt lgkmcnt(7)
    v_mfma_f32_16x16x32_bf16 v[100:103], v[12:15], v[60:63], v[100:103]
    ds_read_b64_tr_b16 v[48:49], v11 offset:12288
    v_mfma_f32_16x16x32_bf16 v[100:103], v[28:31], v[64:67], v[100:103]
    ds_read_b64_tr_b16 v[50:51], v11 offset:12800
    v_mfma_f32_16x16x32_bf16 v[104:107], v[16:19], v[60:63], v[104:107]
    ds_read_b64_tr_b16 v[52:53], v10 offset:16384
    s_waitcnt lgkmcnt(9)
    v_mfma_f32_16x16x32_bf16 v[104:107], v[32:35], v[64:67], v[104:107]
    ds_read_b64_tr_b16 v[54:55], v10 offset:16896
    s_waitcnt lgkmcnt(9)
    v_mfma_f32_16x16x32_bf16 v[108:111], v[20:23], v[60:63], v[108:111]
    ds_read_b64_tr_b16 v[56:57], v10 offset:20480
    s_waitcnt lgkmcnt(9)
    v_mfma_f32_16x16x32_bf16 v[108:111], v[36:39], v[64:67], v[108:111]
    ds_read_b64_tr_b16 v[58:59], v10 offset:20992
    s_waitcnt lgkmcnt(7)
    v_mfma_f32_16x16x32_bf16 v[112:115], v[24:27], v[60:63], v[112:115]
    ds_read_b64_tr_b16 v[60:61], v11 offset:16384
    s_waitcnt lgkmcnt(7)
    v_mfma_f32_16x16x32_bf16 v[112:115], v[40:43], v[64:67], v[112:115]
    ds_read_b64_tr_b16 v[62:63], v11 offset:16896
    v_mfma_f32_16x16x32_bf16 v[116:119], v[12:15], v[44:47], v[116:119]
    ds_read_b64_tr_b16 v[64:65], v11 offset:20480
    s_waitcnt lgkmcnt(7)
    v_mfma_f32_16x16x32_bf16 v[116:119], v[28:31], v[48:51], v[116:119]
    ds_read_b64_tr_b16 v[66:67], v11 offset:20992
    v_mfma_f32_16x16x32_bf16 v[120:123], v[16:19], v[44:47], v[120:123]
    v_mfma_f32_16x16x32_bf16 v[120:123], v[32:35], v[48:51], v[120:123]
    v_mfma_f32_16x16x32_bf16 v[124:127], v[20:23], v[44:47], v[124:127]
    v_mfma_f32_16x16x32_bf16 v[124:127], v[36:39], v[48:51], v[124:127]
    s_waitcnt lgkmcnt(0)
    s_barrier
    v_mfma_f32_16x16x32_bf16 v[128:131], v[24:27], v[44:47], v[128:131]
    ds_read_b64_tr_b16 v[44:45], v10 offset:49152
    v_mfma_f32_16x16x32_bf16 v[128:131], v[40:43], v[48:51], v[128:131]
    ds_read_b64_tr_b16 v[46:47], v10 offset:49664
    v_mfma_f32_16x16x32_bf16 v[132:135], v[12:15], v[52:55], v[132:135]
    ds_read_b64_tr_b16 v[48:49], v10 offset:53248
    v_mfma_f32_16x16x32_bf16 v[132:135], v[28:31], v[56:59], v[132:135]
    ds_read_b64_tr_b16 v[50:51], v10 offset:53760
    v_mfma_f32_16x16x32_bf16 v[148:151], v[12:15], v[60:63], v[148:151]
    ds_read_b128 v[12:15], v6 offset:40960
    v_mfma_f32_16x16x32_bf16 v[148:151], v[28:31], v[64:67], v[148:151]
    ds_read_b128 v[28:31], v7 offset:40960
    v_mfma_f32_16x16x32_bf16 v[136:139], v[16:19], v[52:55], v[136:139]
    v_mfma_f32_16x16x32_bf16 v[136:139], v[32:35], v[56:59], v[136:139]
    v_mfma_f32_16x16x32_bf16 v[152:155], v[16:19], v[60:63], v[152:155]
    ds_read_b128 v[16:19], v6 offset:43008
    v_mfma_f32_16x16x32_bf16 v[152:155], v[32:35], v[64:67], v[152:155]
    ds_read_b128 v[32:35], v7 offset:43008
    v_mfma_f32_16x16x32_bf16 v[140:143], v[20:23], v[52:55], v[140:143]
    v_mfma_f32_16x16x32_bf16 v[140:143], v[36:39], v[56:59], v[140:143]
    v_mfma_f32_16x16x32_bf16 v[156:159], v[20:23], v[60:63], v[156:159]
    ds_read_b128 v[20:23], v6 offset:45056
    v_mfma_f32_16x16x32_bf16 v[156:159], v[36:39], v[64:67], v[156:159]
    ds_read_b128 v[36:39], v7 offset:45056
    v_mfma_f32_16x16x32_bf16 v[144:147], v[24:27], v[52:55], v[144:147]
    ds_read_b64_tr_b16 v[52:53], v11 offset:49152
    v_mfma_f32_16x16x32_bf16 v[144:147], v[40:43], v[56:59], v[144:147]
    ds_read_b64_tr_b16 v[54:55], v11 offset:49664
    v_mfma_f32_16x16x32_bf16 v[160:163], v[24:27], v[60:63], v[160:163]
    ds_read_b128 v[24:27], v6 offset:47104
    v_mfma_f32_16x16x32_bf16 v[160:163], v[40:43], v[64:67], v[160:163]
    ds_read_b128 v[40:43], v7 offset:47104
    s_waitcnt lgkmcnt(7)
    v_mfma_f32_16x16x32_bf16 v[100:103], v[12:15], v[44:47], v[100:103]
    ds_read_b64_tr_b16 v[56:57], v11 offset:53248
    v_mfma_f32_16x16x32_bf16 v[100:103], v[28:31], v[48:51], v[100:103]
    ds_read_b64_tr_b16 v[58:59], v11 offset:53760
    v_mfma_f32_16x16x32_bf16 v[104:107], v[16:19], v[44:47], v[104:107]
    ds_read_b64_tr_b16 v[60:61], v10 offset:57344
    s_waitcnt lgkmcnt(9)
    v_mfma_f32_16x16x32_bf16 v[104:107], v[32:35], v[48:51], v[104:107]
    ds_read_b64_tr_b16 v[62:63], v10 offset:57856
    s_waitcnt lgkmcnt(9)
    v_mfma_f32_16x16x32_bf16 v[108:111], v[20:23], v[44:47], v[108:111]
    ds_read_b64_tr_b16 v[64:65], v10 offset:61440
    s_waitcnt lgkmcnt(9)
    v_mfma_f32_16x16x32_bf16 v[108:111], v[36:39], v[48:51], v[108:111]
    ds_read_b64_tr_b16 v[66:67], v10 offset:61952
    s_waitcnt lgkmcnt(7)
    v_mfma_f32_16x16x32_bf16 v[112:115], v[24:27], v[44:47], v[112:115]
    ds_read_b64_tr_b16 v[44:45], v11 offset:57344
    s_waitcnt lgkmcnt(7)
    v_mfma_f32_16x16x32_bf16 v[112:115], v[40:43], v[48:51], v[112:115]
    ds_read_b64_tr_b16 v[46:47], v11 offset:57856
    v_mfma_f32_16x16x32_bf16 v[116:119], v[12:15], v[52:55], v[116:119]
    ds_read_b64_tr_b16 v[48:49], v11 offset:61440
    s_waitcnt lgkmcnt(7)
    v_mfma_f32_16x16x32_bf16 v[116:119], v[28:31], v[56:59], v[116:119]
    ds_read_b64_tr_b16 v[50:51], v11 offset:61952
    v_mfma_f32_16x16x32_bf16 v[120:123], v[16:19], v[52:55], v[120:123]
    v_mfma_f32_16x16x32_bf16 v[120:123], v[32:35], v[56:59], v[120:123]
    v_mfma_f32_16x16x32_bf16 v[124:127], v[20:23], v[52:55], v[124:127]
    v_mfma_f32_16x16x32_bf16 v[124:127], v[36:39], v[56:59], v[124:127]
    v_mfma_f32_16x16x32_bf16 v[128:131], v[24:27], v[52:55], v[128:131]
    ds_read2_b32 v[52:53], v165 offset0:64 offset1:64
    v_mfma_f32_16x16x32_bf16 v[128:131], v[40:43], v[56:59], v[128:131]
    ds_read2_b32 v[54:55], v165 offset0:80 offset1:80
    s_waitcnt lgkmcnt(5)
    v_mfma_f32_16x16x32_bf16 v[132:135], v[12:15], v[60:63], v[132:135]
    ds_read2_b32 v[56:57], v165 offset0:128 offset1:128
    v_mfma_f32_16x16x32_bf16 v[132:135], v[28:31], v[64:67], v[132:135]
    ds_read2_b32 v[58:59], v165 offset0:144 offset1:144
    s_waitcnt lgkmcnt(5)
    v_mfma_f32_16x16x32_bf16 v[148:151], v[12:15], v[44:47], v[148:151]
    ds_read_b128 v[12:15], v164 offset:0
    s_waitcnt lgkmcnt(5)
    v_mfma_f32_16x16x32_bf16 v[148:151], v[28:31], v[48:51], v[148:151]
    ds_read_b128 v[28:31], v164 offset:512
    v_mfma_f32_16x16x32_bf16 v[136:139], v[16:19], v[60:63], v[136:139]
    v_mfma_f32_16x16x32_bf16 v[136:139], v[32:35], v[64:67], v[136:139]
    v_mfma_f32_16x16x32_bf16 v[152:155], v[16:19], v[44:47], v[152:155]
    ds_read_b128 v[16:19], v164 offset:64
    v_mfma_f32_16x16x32_bf16 v[152:155], v[32:35], v[48:51], v[152:155]
    ds_read_b128 v[32:35], v164 offset:576
    v_mfma_f32_16x16x32_bf16 v[140:143], v[20:23], v[60:63], v[140:143]
    v_mfma_f32_16x16x32_bf16 v[140:143], v[36:39], v[64:67], v[140:143]
    v_mfma_f32_16x16x32_bf16 v[156:159], v[20:23], v[44:47], v[156:159]
    v_mfma_f32_16x16x32_bf16 v[156:159], v[36:39], v[48:51], v[156:159]
    v_mfma_f32_16x16x32_bf16 v[144:147], v[24:27], v[60:63], v[144:147]
    ds_read_b128 v[60:63], v164 offset:1024
    v_mfma_f32_16x16x32_bf16 v[144:147], v[40:43], v[64:67], v[144:147]
    ds_read_b128 v[64:67], v164 offset:1088
    v_mfma_f32_16x16x32_bf16 v[160:163], v[24:27], v[44:47], v[160:163]
    v_mfma_f32_16x16x32_bf16 v[160:163], v[40:43], v[48:51], v[160:163]
    s_mov_b32 s50, 0x10001
    s_mov_b32 s51, s50
    ds_read_b128 v[36:39], v164 offset:128
    ds_read_b128 v[40:43], v164 offset:192
    ds_read_b128 v[44:47], v164 offset:640
    ds_read_b128 v[48:51], v164 offset:704
    s_waitcnt lgkmcnt(9)
    v_pk_fma_f32 v[100:101], v[12:13], v[52:53], v[100:101]
    v_pk_fma_f32 v[102:103], v[14:15], v[52:53], v[102:103]
    s_waitcnt lgkmcnt(7)
    v_pk_fma_f32 v[104:105], v[16:17], v[52:53], v[104:105]
    v_pk_fma_f32 v[106:107], v[18:19], v[52:53], v[106:107]
    s_waitcnt lgkmcnt(5)
    v_pk_mul_f32 v[20:21], v[100:101], v[60:61]
    v_pk_mul_f32 v[22:23], v[102:103], v[62:63]
    s_waitcnt lgkmcnt(4)
    v_pk_mul_f32 v[24:25], v[104:105], v[64:65]
    v_pk_mul_f32 v[26:27], v[106:107], v[66:67]
    v_pk_fma_f32 v[100:101], v[100:101], v[28:29], s[40:41]
    v_pk_fma_f32 v[102:103], v[102:103], v[30:31], s[40:41]
    v_pk_fma_f32 v[104:105], v[104:105], v[32:33], s[40:41]
    v_pk_fma_f32 v[106:107], v[106:107], v[34:35], s[40:41]
    v_exp_f32 v20, v20 clamp
    v_exp_f32 v21, v21 clamp
    v_exp_f32 v22, v22 clamp
    v_exp_f32 v23, v23 clamp
    v_exp_f32 v24, v24 clamp
    v_exp_f32 v25, v25 clamp
    v_exp_f32 v26, v26 clamp
    v_exp_f32 v27, v27 clamp
    v_pk_add_f32 v[20:21], v[20:21], s[74:75]
    v_pk_add_f32 v[22:23], v[22:23], s[74:75]
    v_pk_add_f32 v[24:25], v[24:25], s[74:75]
    v_pk_add_f32 v[26:27], v[26:27], s[74:75]
    v_max_f32 v100, v100, v20
    v_max_f32 v101, v101, v21
    v_max_f32 v102, v102, v22
    v_max_f32 v103, v103, v23
    v_max_f32 v104, v104, v24
    v_max_f32 v105, v105, v25
    v_max_f32 v106, v106, v26
    v_max_f32 v107, v107, v27
    v_cvt_pk_bf16_f32 v100, v100, v101
    v_cvt_pk_bf16_f32 v101, v102, v103
    v_cvt_pk_bf16_f32 v102, v104, v105
    v_cvt_pk_bf16_f32 v103, v106, v107
    s_waitcnt lgkmcnt(3)
    v_pk_fma_f32 v[140:141], v[36:37], v[56:57], v[140:141]
    v_pk_fma_f32 v[142:143], v[38:39], v[56:57], v[142:143]
    s_waitcnt lgkmcnt(2)
    v_pk_fma_f32 v[144:145], v[40:41], v[56:57], v[144:145]
    v_pk_fma_f32 v[146:147], v[42:43], v[56:57], v[146:147]
    s_waitcnt lgkmcnt(1)
    v_pk_mul_f32 v[140:141], v[140:141], v[44:45]
    v_pk_mul_f32 v[142:143], v[142:143], v[46:47]
    s_waitcnt lgkmcnt(0)
    v_pk_mul_f32 v[144:145], v[144:145], v[48:49]
    v_pk_mul_f32 v[146:147], v[146:147], v[50:51]
    v_cvt_pk_bf16_f32 v140, v140, v141
    v_cvt_pk_bf16_f32 v141, v142, v143
    v_cvt_pk_bf16_f32 v142, v144, v145
    v_cvt_pk_bf16_f32 v143, v146, v147
    v_pk_fma_f32 v[156:157], v[36:37], v[58:59], v[156:157]
    v_pk_fma_f32 v[158:159], v[38:39], v[58:59], v[158:159]
    v_pk_fma_f32 v[160:161], v[40:41], v[58:59], v[160:161]
    v_pk_fma_f32 v[162:163], v[42:43], v[58:59], v[162:163]
    v_pk_mul_f32 v[156:157], v[156:157], v[44:45]
    v_pk_mul_f32 v[158:159], v[158:159], v[46:47]
    v_pk_mul_f32 v[160:161], v[160:161], v[48:49]
    v_pk_mul_f32 v[162:163], v[162:163], v[50:51]
    v_cvt_pk_bf16_f32 v156, v156, v157
    v_cvt_pk_bf16_f32 v157, v158, v159
    v_cvt_pk_bf16_f32 v158, v160, v161
    v_cvt_pk_bf16_f32 v159, v162, v163
    ds_read_b128 v[144:147], v164 offset:1152
    ds_read_b128 v[160:163], v164 offset:1216
    v_pk_fma_f32 v[132:133], v[12:13], v[56:57], v[132:133]
    v_pk_fma_f32 v[134:135], v[14:15], v[56:57], v[134:135]
    v_pk_fma_f32 v[136:137], v[16:17], v[56:57], v[136:137]
    v_pk_fma_f32 v[138:139], v[18:19], v[56:57], v[138:139]
    v_pk_mul_f32 v[132:133], v[132:133], v[28:29]
    v_pk_mul_f32 v[134:135], v[134:135], v[30:31]
    v_pk_mul_f32 v[136:137], v[136:137], v[32:33]
    v_pk_mul_f32 v[138:139], v[138:139], v[34:35]
    v_cvt_pk_bf16_f32 v132, v132, v133
    v_cvt_pk_bf16_f32 v133, v134, v135
    v_cvt_pk_bf16_f32 v134, v136, v137
    v_cvt_pk_bf16_f32 v135, v138, v139
    v_pk_fma_f32 v[148:149], v[12:13], v[58:59], v[148:149]
    v_pk_fma_f32 v[150:151], v[14:15], v[58:59], v[150:151]
    v_pk_fma_f32 v[152:153], v[16:17], v[58:59], v[152:153]
    v_pk_fma_f32 v[154:155], v[18:19], v[58:59], v[154:155]
    v_pk_mul_f32 v[148:149], v[148:149], v[28:29]
    v_pk_mul_f32 v[150:151], v[150:151], v[30:31]
    v_pk_mul_f32 v[152:153], v[152:153], v[32:33]
    v_pk_mul_f32 v[154:155], v[154:155], v[34:35]
    v_cvt_pk_bf16_f32 v148, v148, v149
    v_cvt_pk_bf16_f32 v149, v150, v151
    v_cvt_pk_bf16_f32 v150, v152, v153
    v_cvt_pk_bf16_f32 v151, v154, v155
    v_mov_b32 v56, 0x3f803f80
    v_mov_b32 v57, 0x3f803f80
    v_mov_b32 v58, 0x3f803f80
    v_mov_b32 v59, 0x3f803f80
    v_mov_b32 v164, 1
    v_mov_b32 v165, 2
    v_pk_fma_f32 v[108:109], v[36:37], v[52:53], v[108:109]
    v_pk_fma_f32 v[110:111], v[38:39], v[52:53], v[110:111]
    v_pk_fma_f32 v[112:113], v[40:41], v[52:53], v[112:113]
    v_pk_fma_f32 v[114:115], v[42:43], v[52:53], v[114:115]
    s_waitcnt lgkmcnt(1)
    v_pk_mul_f32 v[20:21], v[108:109], v[144:145]
    v_pk_mul_f32 v[22:23], v[110:111], v[146:147]
    s_waitcnt lgkmcnt(0)
    v_pk_mul_f32 v[24:25], v[112:113], v[160:161]
    v_pk_mul_f32 v[26:27], v[114:115], v[162:163]
    v_pk_fma_f32 v[108:109], v[108:109], v[44:45], s[40:41]
    v_pk_fma_f32 v[110:111], v[110:111], v[46:47], s[40:41]
    v_pk_fma_f32 v[112:113], v[112:113], v[48:49], s[40:41]
    v_pk_fma_f32 v[114:115], v[114:115], v[50:51], s[40:41]
    v_mfma_f32_16x16x32_bf16 v[136:139], v[100:103], v[132:135], 0
    v_exp_f32 v20, v20 clamp
    v_mfma_f32_16x16x32_bf16 v[152:155], v[100:103], v[148:151], 0
    v_exp_f32 v21, v21 clamp
    v_mfma_f32_16x16x32_bf16 v[104:107], v[100:103], v[56:59], 0
    v_exp_f32 v22, v22 clamp
    v_exp_f32 v23, v23 clamp
    v_exp_f32 v24, v24 clamp
    v_exp_f32 v25, v25 clamp
    v_exp_f32 v26, v26 clamp
    v_exp_f32 v27, v27 clamp
    v_pk_add_f32 v[20:21], v[20:21], s[74:75]
    v_pk_add_f32 v[22:23], v[22:23], s[74:75]
    v_pk_add_f32 v[24:25], v[24:25], s[74:75]
    v_pk_add_f32 v[26:27], v[26:27], s[74:75]
    v_max_f32 v108, v108, v20
    v_max_f32 v109, v109, v21
    v_max_f32 v110, v110, v22
    v_max_f32 v111, v111, v23
    v_max_f32 v112, v112, v24
    v_max_f32 v113, v113, v25
    v_max_f32 v114, v114, v26
    v_max_f32 v115, v115, v27
    v_cvt_pk_bf16_f32 v108, v108, v109
    v_cvt_pk_bf16_f32 v109, v110, v111
    v_cvt_pk_bf16_f32 v110, v112, v113
    v_cvt_pk_bf16_f32 v111, v114, v115
    v_pk_fma_f32 v[116:117], v[12:13], v[54:55], v[116:117]
    v_pk_fma_f32 v[118:119], v[14:15], v[54:55], v[118:119]
    v_pk_fma_f32 v[120:121], v[16:17], v[54:55], v[120:121]
    v_pk_fma_f32 v[122:123], v[18:19], v[54:55], v[122:123]
    v_pk_mul_f32 v[20:21], v[116:117], v[60:61]
    v_pk_mul_f32 v[22:23], v[118:119], v[62:63]
    v_pk_mul_f32 v[24:25], v[120:121], v[64:65]
    v_pk_mul_f32 v[26:27], v[122:123], v[66:67]
    v_pk_fma_f32 v[116:117], v[116:117], v[28:29], s[40:41]
    v_pk_fma_f32 v[118:119], v[118:119], v[30:31], s[40:41]
    v_pk_fma_f32 v[120:121], v[120:121], v[32:33], s[40:41]
    v_pk_fma_f32 v[122:123], v[122:123], v[34:35], s[40:41]
    v_mfma_f32_16x16x32_bf16 v[136:139], v[108:111], v[140:143], v[136:139]
    v_exp_f32 v20, v20 clamp
    v_mfma_f32_16x16x32_bf16 v[152:155], v[108:111], v[156:159], v[152:155]
    v_exp_f32 v21, v21 clamp
    v_mfma_f32_16x16x32_bf16 v[104:107], v[108:111], v[56:59], v[104:107]
    v_exp_f32 v22, v22 clamp
    v_exp_f32 v23, v23 clamp
    v_exp_f32 v24, v24 clamp
    v_exp_f32 v25, v25 clamp
    v_exp_f32 v26, v26 clamp
    v_exp_f32 v27, v27 clamp
    v_pk_add_f32 v[20:21], v[20:21], s[74:75]
    v_pk_add_f32 v[22:23], v[22:23], s[74:75]
    v_pk_add_f32 v[24:25], v[24:25], s[74:75]
    v_pk_add_f32 v[26:27], v[26:27], s[74:75]
    ds_write_b128 v1, v[136:139] offset:0
    ds_write_b128 v1, v[152:155] offset:1024
    s_mov_b64 exec, s[50:51]
    ds_write_b128 v2, v[104:107] offset:0
    s_mov_b64 exec, 1
    ds_write_b32 v3, v164
    s_mov_b64 exec, -1
    v_max_f32 v116, v116, v20
    v_max_f32 v117, v117, v21
    v_max_f32 v118, v118, v22
    v_max_f32 v119, v119, v23
    v_max_f32 v120, v120, v24
    v_max_f32 v121, v121, v25
    v_max_f32 v122, v122, v26
    v_max_f32_e64 v123, v123, v27
    v_cvt_pk_bf16_f32 v116, v116, v117
    v_cvt_pk_bf16_f32 v117, v118, v119
    v_cvt_pk_bf16_f32 v118, v120, v121
    v_cvt_pk_bf16_f32 v119, v122, v123
    v_pk_fma_f32 v[124:125], v[36:37], v[54:55], v[124:125]
    v_pk_fma_f32 v[126:127], v[38:39], v[54:55], v[126:127]
    v_pk_fma_f32 v[128:129], v[40:41], v[54:55], v[128:129]
    v_pk_fma_f32 v[130:131], v[42:43], v[54:55], v[130:131]
    v_pk_mul_f32 v[20:21], v[124:125], v[144:145]
    v_pk_mul_f32 v[22:23], v[126:127], v[146:147]
    v_pk_mul_f32 v[24:25], v[128:129], v[160:161]
    v_pk_mul_f32 v[26:27], v[130:131], v[162:163]
    v_pk_fma_f32 v[124:125], v[124:125], v[44:45], s[40:41]
    v_pk_fma_f32 v[126:127], v[126:127], v[46:47], s[40:41]
    v_pk_fma_f32 v[128:129], v[128:129], v[48:49], s[40:41]
    v_pk_fma_f32 v[130:131], v[130:131], v[50:51], s[40:41]
    v_mfma_f32_16x16x32_bf16 v[112:115], v[116:119], v[132:135], 0
    v_exp_f32 v20, v20 clamp
    v_mfma_f32_16x16x32_bf16 v[120:123], v[116:119], v[148:151], 0
    v_exp_f32 v21, v21 clamp
    v_mfma_f32_16x16x32_bf16 v[100:103], v[116:119], v[56:59], 0
    v_exp_f32 v22, v22 clamp
    v_exp_f32 v23, v23 clamp
    v_exp_f32 v24, v24 clamp
    v_exp_f32 v25, v25 clamp
    v_exp_f32 v26, v26 clamp
    v_exp_f32 v27, v27 clamp
    v_pk_add_f32 v[20:21], v[20:21], s[74:75]
    v_pk_add_f32 v[22:23], v[22:23], s[74:75]
    v_pk_add_f32 v[24:25], v[24:25], s[74:75]
    v_pk_add_f32 v[26:27], v[26:27], s[74:75]
    v_max_f32 v124, v124, v20
    v_max_f32 v125, v125, v21
    v_max_f32 v126, v126, v22
    v_max_f32 v127, v127, v23
    v_max_f32 v128, v128, v24
    v_max_f32 v129, v129, v25
    v_max_f32 v130, v130, v26
    v_max_f32 v131, v131, v27
    v_cvt_pk_bf16_f32 v124, v124, v125
    v_cvt_pk_bf16_f32 v125, v126, v127
    v_cvt_pk_bf16_f32 v126, v128, v129
    v_cvt_pk_bf16_f32 v127, v130, v131
    s_nop 1
    v_mfma_f32_16x16x32_bf16 v[112:115], v[124:127], v[140:143], v[112:115]
    v_mfma_f32_16x16x32_bf16 v[120:123], v[124:127], v[156:159], v[120:123]
    v_mfma_f32_16x16x32_bf16 v[100:103], v[124:127], v[56:59], v[100:103]
    ds_read_b128 v[28:31], v4 offset:0
    ds_read_b64_tr_b16 v[44:45], v8 offset:0
    ds_read_b64_tr_b16 v[46:47], v8 offset:512
    ds_read_b128 v[32:35], v4 offset:2048
    ds_read_b128 v[36:39], v4 offset:4096
    ds_read_b128 v[40:43], v4 offset:6144
    ds_write_b128 v1, v[112:115] offset:2048
    ds_write_b128 v1, v[120:123] offset:3072
    s_mov_b64 exec, s[50:51]
    ds_write_b128 v2, v[100:103] offset:64
    s_mov_b64 exec, 1
    ds_write_b32 v3, v165
    s_mov_b64 exec, -1
    ds_read_b64_tr_b16 v[48:49], v9 offset:0
    s_waitcnt lgkmcnt(8)
    ds_read_b64_tr_b16 v[50:51], v9 offset:512
    s_setprio 0
    v_and_b32 v132, 15, v0
    s_lshl_b32 s44, s36, 8
    s_add_u32 s44, s44, 24832
    v_lshl_add_u32 v132, v132, 2, s44
    v_add_u32 v133, 1024, v132
    s_lshl_b32 s44, s37, 7
    s_add_u32 s44, s44, 26368
    v_and_or_b32 v134, v0, 48, s44
    s_lshl_b32 s44, s35, 2
    s_and_b32 s47, s3, 2
    s_add_u32 s44, s44, s47
    s_lshr_b32 s44, 0xeee7eece, s44
    s_and_b32 s44, s44, 3
    s_mul_i32 s44, s44, 40960
    s_and_b32 s47, s28, 1
    s_lshl_b32 s47, s47, 13
    s_add_u32 s44, s44, s47
    s_lshl_b32 s47, s37, 6
    v_lshrrev_b32 v140, 4, v0
    v_lshlrev_b32 v140, 3, v140
    v_xor_b32 v140, s47, v140
    v_and_b32 v141, 14, v0
    v_lshlrev_b32 v141, 3, v141
    v_xor_b32 v140, v140, v141
    v_and_b32 v141, 15, v0
    v_lshlrev_b32 v141, 7, v141
    v_add3_u32 v140, v140, v141, s44
    v_xor_b32 v141, 32, v140

    s_waitcnt lgkmcnt(9)
    v_mfma_f32_16x16x32_bf16 v[68:71], v[44:47], v[28:31], v[68:71]
    ds_read_b128 v[12:15], v5 offset:0
    ds_read_b64_tr_b16 v[52:53], v8 offset:4096
    s_waitcnt lgkmcnt(10)
    v_mfma_f32_16x16x32_bf16 v[72:75], v[44:47], v[32:35], v[72:75]
    ds_read_b64_tr_b16 v[54:55], v8 offset:4608
    ds_read_b128 v[16:19], v5 offset:2048
    s_waitcnt lgkmcnt(11)
    v_mfma_f32_16x16x32_bf16 v[76:79], v[44:47], v[36:39], v[76:79]
    ds_read_b128 v[20:23], v5 offset:4096
    ds_read_b128 v[24:27], v5 offset:6144
    s_waitcnt lgkmcnt(12)
    v_mfma_f32_16x16x32_bf16 v[80:83], v[44:47], v[40:43], v[80:83]
    ds_read_b64_tr_b16 v[56:57], v9 offset:4096
    ds_read_b64_tr_b16 v[58:59], v9 offset:4608
    s_waitcnt lgkmcnt(8)
    v_mfma_f32_16x16x32_bf16 v[84:87], v[48:51], v[28:31], v[84:87]
    v_mfma_f32_16x16x32_bf16 v[88:91], v[48:51], v[32:35], v[88:91]
    v_mfma_f32_16x16x32_bf16 v[92:95], v[48:51], v[36:39], v[92:95]
    v_mfma_f32_16x16x32_bf16 v[96:99], v[48:51], v[40:43], v[96:99]
    s_waitcnt lgkmcnt(5)
    v_mfma_f32_16x16x32_bf16 v[68:71], v[52:55], v[12:15], v[68:71]
    ds_read_b128 v[28:31], v4 offset:40960
    ds_read_b64_tr_b16 v[44:45], v8 offset:40960
    s_waitcnt lgkmcnt(6)
    v_mfma_f32_16x16x32_bf16 v[72:75], v[52:55], v[16:19], v[72:75]
    ds_read_b64_tr_b16 v[46:47], v8 offset:41472
    ds_read_b128 v[32:35], v4 offset:43008
    s_waitcnt lgkmcnt(7)
    v_mfma_f32_16x16x32_bf16 v[76:79], v[52:55], v[20:23], v[76:79]
    ds_read_b128 v[36:39], v4 offset:45056
    ds_read_b128 v[40:43], v4 offset:47104
    s_waitcnt lgkmcnt(8)
    v_mfma_f32_16x16x32_bf16 v[80:83], v[52:55], v[24:27], v[80:83]
    ds_read_b64_tr_b16 v[48:49], v9 offset:40960
    ds_read_b64_tr_b16 v[50:51], v9 offset:41472
    s_waitcnt lgkmcnt(8)
    v_mfma_f32_16x16x32_bf16 v[84:87], v[56:59], v[12:15], v[84:87]
    v_mfma_f32_16x16x32_bf16 v[88:91], v[56:59], v[16:19], v[88:91]
    v_mfma_f32_16x16x32_bf16 v[92:95], v[56:59], v[20:23], v[92:95]
    v_mfma_f32_16x16x32_bf16 v[96:99], v[56:59], v[24:27], v[96:99]
    s_waitcnt lgkmcnt(5)
    v_mfma_f32_16x16x32_bf16 v[68:71], v[44:47], v[28:31], v[68:71]
    ds_read_b128 v[12:15], v5 offset:40960
    ds_read_b64_tr_b16 v[52:53], v8 offset:45056
    s_waitcnt lgkmcnt(6)
    v_mfma_f32_16x16x32_bf16 v[72:75], v[44:47], v[32:35], v[72:75]
    ds_read_b64_tr_b16 v[54:55], v8 offset:45568
    ds_read_b128 v[16:19], v5 offset:43008
    s_waitcnt lgkmcnt(7)
    v_mfma_f32_16x16x32_bf16 v[76:79], v[44:47], v[36:39], v[76:79]
    ds_read_b128 v[20:23], v5 offset:45056
    ds_read_b128 v[24:27], v5 offset:47104
    s_waitcnt lgkmcnt(8)
    v_mfma_f32_16x16x32_bf16 v[80:83], v[44:47], v[40:43], v[80:83]
    ds_read_b64_tr_b16 v[56:57], v9 offset:45056
    ds_read_b64_tr_b16 v[58:59], v9 offset:45568
    s_waitcnt lgkmcnt(8)
    v_mfma_f32_16x16x32_bf16 v[84:87], v[48:51], v[28:31], v[84:87]
    ds_read_b64 v[148:149], v140 offset:0
    ds_read_b64 v[150:151], v141 offset:0
    v_mfma_f32_16x16x32_bf16 v[88:91], v[48:51], v[32:35], v[88:91]
    ds_read_b64 v[152:153], v140 offset:2048
    ds_read_b64 v[154:155], v141 offset:2048
    v_mfma_f32_16x16x32_bf16 v[92:95], v[48:51], v[36:39], v[92:95]
    v_mfma_f32_16x16x32_bf16 v[96:99], v[48:51], v[40:43], v[96:99]
    s_waitcnt lgkmcnt(9)
    v_mfma_f32_16x16x32_bf16 v[68:71], v[52:55], v[12:15], v[68:71]
    ds_read_b128 v[28:31], v6 offset:0
    ds_read_b64_tr_b16 v[44:45], v10 offset:0
    s_waitcnt lgkmcnt(10)
    v_mfma_f32_16x16x32_bf16 v[72:75], v[52:55], v[16:19], v[72:75]
    ds_read_b64_tr_b16 v[46:47], v10 offset:512
    ds_read_b128 v[32:35], v6 offset:2048
    s_waitcnt lgkmcnt(11)
    v_mfma_f32_16x16x32_bf16 v[76:79], v[52:55], v[20:23], v[76:79]
    ds_read_b128 v[36:39], v6 offset:4096
    ds_read_b128 v[40:43], v6 offset:6144
    s_waitcnt lgkmcnt(12)
    v_mfma_f32_16x16x32_bf16 v[80:83], v[52:55], v[24:27], v[80:83]
    ds_read_b64_tr_b16 v[48:49], v11 offset:0
    ds_read_b64_tr_b16 v[50:51], v11 offset:512
    s_waitcnt lgkmcnt(12)
    v_mfma_f32_16x16x32_bf16 v[84:87], v[56:59], v[12:15], v[84:87]
    ds_read_b64 v[156:157], v140 offset:4096
    ds_read_b64 v[158:159], v141 offset:4096
    v_mfma_f32_16x16x32_bf16 v[88:91], v[56:59], v[16:19], v[88:91]
    ds_read_b64 v[160:161], v140 offset:6144
    s_waitcnt lgkmcnt(8)
    ds_read_b64 v[162:163], v141 offset:6144
    v_mfma_f32_16x16x32_bf16 v[92:95], v[56:59], v[20:23], v[92:95]
    v_mfma_f32_16x16x32_bf16 v[96:99], v[56:59], v[24:27], v[96:99]
    s_waitcnt lgkmcnt(9)
    v_mfma_f32_16x16x32_bf16 v[68:71], v[44:47], v[28:31], v[68:71]
    ds_read_b128 v[12:15], v7 offset:0
    ds_read_b64_tr_b16 v[52:53], v10 offset:4096
    s_waitcnt lgkmcnt(10)
    v_mfma_f32_16x16x32_bf16 v[72:75], v[44:47], v[32:35], v[72:75]
    ds_read_b64_tr_b16 v[54:55], v10 offset:4608
    ds_read_b128 v[16:19], v7 offset:2048
    s_waitcnt lgkmcnt(11)
    v_mfma_f32_16x16x32_bf16 v[76:79], v[44:47], v[36:39], v[76:79]
    ds_read_b128 v[20:23], v7 offset:4096
    ds_read_b128 v[24:27], v7 offset:6144
    s_waitcnt lgkmcnt(12)
    v_mfma_f32_16x16x32_bf16 v[80:83], v[44:47], v[40:43], v[80:83]
    ds_read_b64_tr_b16 v[56:57], v11 offset:4096
    ds_read_b64_tr_b16 v[58:59], v11 offset:4608
    s_waitcnt lgkmcnt(12)
    v_mfma_f32_16x16x32_bf16 v[84:87], v[48:51], v[28:31], v[84:87]
    v_mfma_f32_16x16x32_bf16 v[88:91], v[48:51], v[32:35], v[88:91]
    v_mfma_f32_16x16x32_bf16 v[92:95], v[48:51], v[36:39], v[92:95]
    v_mfma_f32_16x16x32_bf16 v[96:99], v[48:51], v[40:43], v[96:99]
    s_waitcnt lgkmcnt(5)
    v_mfma_f32_16x16x32_bf16 v[68:71], v[52:55], v[12:15], v[68:71]
    ds_read_b128 v[28:31], v6 offset:40960
    ds_read_b64_tr_b16 v[44:45], v10 offset:40960
    s_waitcnt lgkmcnt(6)
    v_mfma_f32_16x16x32_bf16 v[72:75], v[52:55], v[16:19], v[72:75]
    ds_read_b64_tr_b16 v[46:47], v10 offset:41472
    ds_read_b128 v[32:35], v6 offset:43008
    s_waitcnt lgkmcnt(7)
    v_mfma_f32_16x16x32_bf16 v[76:79], v[52:55], v[20:23], v[76:79]
    ds_read_b128 v[36:39], v6 offset:45056
    ds_read_b128 v[40:43], v6 offset:47104
    s_waitcnt lgkmcnt(8)
    v_mfma_f32_16x16x32_bf16 v[80:83], v[52:55], v[24:27], v[80:83]
    ds_read_b64_tr_b16 v[48:49], v11 offset:40960
    ds_read_b64_tr_b16 v[50:51], v11 offset:41472
    s_waitcnt lgkmcnt(8)
    v_mfma_f32_16x16x32_bf16 v[84:87], v[56:59], v[12:15], v[84:87]
    v_mfma_f32_16x16x32_bf16 v[88:91], v[56:59], v[16:19], v[88:91]
    v_mfma_f32_16x16x32_bf16 v[92:95], v[56:59], v[20:23], v[92:95]
    v_mfma_f32_16x16x32_bf16 v[96:99], v[56:59], v[24:27], v[96:99]
    s_waitcnt lgkmcnt(5)
    v_mfma_f32_16x16x32_bf16 v[68:71], v[44:47], v[28:31], v[68:71]
    ds_read_b128 v[12:15], v7 offset:40960
    ds_read_b64_tr_b16 v[52:53], v10 offset:45056
    s_waitcnt lgkmcnt(6)
    v_mfma_f32_16x16x32_bf16 v[72:75], v[44:47], v[32:35], v[72:75]
W_2:
    s_cbranch_execz R_2
    s_nop 0
    ds_read_b64_tr_b16 v[54:55], v10 offset:45568
    ds_read_b128 v[16:19], v7 offset:43008
    s_waitcnt lgkmcnt(7)
    v_mfma_f32_16x16x32_bf16 v[76:79], v[44:47], v[36:39], v[76:79]
    ds_read_b128 v[20:23], v7 offset:45056
    ds_read_b128 v[24:27], v7 offset:47104
    s_waitcnt lgkmcnt(8)
    v_mfma_f32_16x16x32_bf16 v[80:83], v[44:47], v[40:43], v[80:83]
    ds_read_b64_tr_b16 v[56:57], v11 offset:45056
    ds_read_b64_tr_b16 v[58:59], v11 offset:45568
    s_waitcnt lgkmcnt(8)
    v_mfma_f32_16x16x32_bf16 v[84:87], v[48:51], v[28:31], v[84:87]
    v_mfma_f32_16x16x32_bf16 v[88:91], v[48:51], v[32:35], v[88:91]
    v_mfma_f32_16x16x32_bf16 v[92:95], v[48:51], v[36:39], v[92:95]
    v_mfma_f32_16x16x32_bf16 v[96:99], v[48:51], v[40:43], v[96:99]
    s_waitcnt lgkmcnt(5)
    v_mfma_f32_16x16x32_bf16 v[68:71], v[52:55], v[12:15], v[68:71]
    v_mov_b32 v135, 3
    s_mov_b64 exec, 1
    ds_write_b32 v3, v135 offset:0
    s_mov_b64 exec, -1
    ds_read_b128 v[100:103], v134 offset:0
    ds_read_b128 v[104:107], v134 offset:64
    s_waitcnt lgkmcnt(7)
    v_mfma_f32_16x16x32_bf16 v[72:75], v[52:55], v[16:19], v[72:75]
    ds_read2_b32 v[108:109], v132 offset0:0 offset1:0
    ds_read2_b32 v[110:111], v132 offset0:16 offset1:16
    s_waitcnt lgkmcnt(8)
    v_mfma_f32_16x16x32_bf16 v[76:79], v[52:55], v[20:23], v[76:79]
    ds_read2_b32 v[112:113], v132 offset0:32 offset1:32
    ds_read2_b32 v[114:115], v132 offset0:48 offset1:48
    s_waitcnt lgkmcnt(9)
    v_mfma_f32_16x16x32_bf16 v[80:83], v[52:55], v[24:27], v[80:83]
    ds_read2_b32 v[124:125], v133 offset0:0 offset1:0
    ds_read2_b32 v[126:127], v133 offset0:16 offset1:16
    s_waitcnt lgkmcnt(9)
    v_mfma_f32_16x16x32_bf16 v[84:87], v[56:59], v[12:15], v[84:87]
    ds_read2_b32 v[128:129], v133 offset0:32 offset1:32
    ds_read2_b32 v[130:131], v133 offset0:48 offset1:48
    v_mfma_f32_16x16x32_bf16 v[88:91], v[56:59], v[16:19], v[88:91]
    ds_read2_b32 v[116:117], v132 offset0:128 offset1:128
    ds_read2_b32 v[118:119], v132 offset0:144 offset1:144
    v_mfma_f32_16x16x32_bf16 v[92:95], v[56:59], v[20:23], v[92:95]
    ds_read2_b32 v[120:121], v132 offset0:160 offset1:160
    ds_read2_b32 v[122:123], v132 offset0:176 offset1:176
    v_mfma_f32_16x16x32_bf16 v[96:99], v[56:59], v[24:27], v[96:99]
    s_waitcnt lgkmcnt(11)
    v_pk_fma_f32 v[68:69], v[100:101], v[108:109], v[68:69]
    v_pk_fma_f32 v[70:71], v[102:103], v[108:109], v[70:71]
    v_pk_fma_f32 v[84:85], v[104:105], v[108:109], v[84:85]
    v_pk_fma_f32 v[86:87], v[106:107], v[108:109], v[86:87]
    s_waitcnt lgkmcnt(10)
    v_pk_fma_f32 v[72:73], v[100:101], v[110:111], v[72:73]
    v_pk_fma_f32 v[74:75], v[102:103], v[110:111], v[74:75]
    v_pk_fma_f32 v[88:89], v[104:105], v[110:111], v[88:89]
    v_pk_fma_f32 v[90:91], v[106:107], v[110:111], v[90:91]
    s_waitcnt lgkmcnt(9)
    v_pk_fma_f32 v[76:77], v[100:101], v[112:113], v[76:77]
    v_pk_fma_f32 v[78:79], v[102:103], v[112:113], v[78:79]
    v_pk_fma_f32 v[92:93], v[104:105], v[112:113], v[92:93]
    v_pk_fma_f32 v[94:95], v[106:107], v[112:113], v[94:95]
    s_waitcnt lgkmcnt(8)
    v_pk_fma_f32 v[80:81], v[100:101], v[114:115], v[80:81]
    v_pk_fma_f32 v[82:83], v[102:103], v[114:115], v[82:83]
    v_pk_fma_f32 v[96:97], v[104:105], v[114:115], v[96:97]
    v_pk_fma_f32 v[98:99], v[106:107], v[114:115], v[98:99]
    s_waitcnt lgkmcnt(7)
    v_pk_mul_f32 v[12:13], v[68:69], v[124:125]
    v_pk_mul_f32 v[14:15], v[70:71], v[124:125]
    v_pk_mul_f32 v[16:17], v[84:85], v[124:125]
    v_pk_mul_f32 v[18:19], v[86:87], v[124:125]
    s_waitcnt lgkmcnt(6)
    v_pk_mul_f32 v[20:21], v[72:73], v[126:127]
    v_pk_mul_f32 v[22:23], v[74:75], v[126:127]
    v_pk_mul_f32 v[24:25], v[88:89], v[126:127]
    v_pk_mul_f32 v[26:27], v[90:91], v[126:127]
    s_waitcnt lgkmcnt(5)
    v_pk_mul_f32 v[28:29], v[76:77], v[128:129]
    v_pk_mul_f32 v[30:31], v[78:79], v[128:129]
    v_pk_mul_f32 v[32:33], v[92:93], v[128:129]
    v_pk_mul_f32 v[34:35], v[94:95], v[128:129]
    s_waitcnt lgkmcnt(4)
    v_pk_mul_f32 v[36:37], v[80:81], v[130:131]
    v_pk_mul_f32 v[38:39], v[82:83], v[130:131]
    v_pk_mul_f32 v[40:41], v[96:97], v[130:131]
    v_pk_mul_f32 v[42:43], v[98:99], v[130:131]
    s_waitcnt lgkmcnt(3)
    v_pk_fma_f32 v[68:69], v[68:69], v[116:117], s[40:41]
    v_pk_fma_f32 v[70:71], v[70:71], v[116:117], s[40:41]
    v_pk_fma_f32 v[84:85], v[84:85], v[116:117], s[40:41]
    v_pk_fma_f32 v[86:87], v[86:87], v[116:117], s[40:41]
    s_waitcnt lgkmcnt(2)
    v_pk_fma_f32 v[72:73], v[72:73], v[118:119], s[40:41]
    v_pk_fma_f32 v[74:75], v[74:75], v[118:119], s[40:41]
    v_pk_fma_f32 v[88:89], v[88:89], v[118:119], s[40:41]
    v_pk_fma_f32 v[90:91], v[90:91], v[118:119], s[40:41]
    s_waitcnt lgkmcnt(1)
    v_pk_fma_f32 v[76:77], v[76:77], v[120:121], s[40:41]
    v_pk_fma_f32 v[78:79], v[78:79], v[120:121], s[40:41]
    v_pk_fma_f32 v[92:93], v[92:93], v[120:121], s[40:41]
    v_pk_fma_f32 v[94:95], v[94:95], v[120:121], s[40:41]
    s_waitcnt lgkmcnt(0)
    v_pk_fma_f32 v[80:81], v[80:81], v[122:123], s[40:41]
    v_pk_fma_f32 v[82:83], v[82:83], v[122:123], s[40:41]
    v_pk_fma_f32 v[96:97], v[96:97], v[122:123], s[40:41]
    v_pk_fma_f32 v[98:99], v[98:99], v[122:123], s[40:41]
    v_exp_f32 v12, v12 clamp
    v_exp_f32 v13, v13 clamp
    v_exp_f32 v14, v14 clamp
    v_exp_f32 v15, v15 clamp
    v_exp_f32 v16, v16 clamp
    v_exp_f32 v17, v17 clamp
    v_exp_f32 v18, v18 clamp
    v_exp_f32 v19, v19 clamp
    v_exp_f32 v20, v20 clamp
    v_exp_f32 v21, v21 clamp
    v_exp_f32 v22, v22 clamp
    v_exp_f32 v23, v23 clamp
    v_exp_f32 v24, v24 clamp
    v_exp_f32 v25, v25 clamp
    v_exp_f32 v26, v26 clamp
    v_exp_f32 v27, v27 clamp
    v_exp_f32 v28, v28 clamp
    v_exp_f32 v29, v29 clamp
    v_exp_f32 v30, v30 clamp
    v_exp_f32 v31, v31 clamp
    v_exp_f32 v32, v32 clamp
    v_exp_f32 v33, v33 clamp
    v_exp_f32 v34, v34 clamp
    v_exp_f32 v35, v35 clamp
    v_exp_f32 v36, v36 clamp
    v_exp_f32 v37, v37 clamp
    v_exp_f32 v38, v38 clamp
    v_exp_f32 v39, v39 clamp
    v_exp_f32 v40, v40 clamp
    v_exp_f32 v41, v41 clamp
    v_exp_f32 v42, v42 clamp
    v_exp_f32 v43, v43 clamp
    v_pk_add_f32 v[12:13], v[12:13], s[74:75]
    v_pk_add_f32 v[14:15], v[14:15], s[74:75]
    v_pk_add_f32 v[16:17], v[16:17], s[74:75]
    v_pk_add_f32 v[18:19], v[18:19], s[74:75]
    v_pk_add_f32 v[20:21], v[20:21], s[74:75]
    v_pk_add_f32 v[22:23], v[22:23], s[74:75]
    v_pk_add_f32 v[24:25], v[24:25], s[74:75]
    v_pk_add_f32 v[26:27], v[26:27], s[74:75]
    v_pk_add_f32 v[28:29], v[28:29], s[74:75]
    v_pk_add_f32 v[30:31], v[30:31], s[74:75]
    v_pk_add_f32 v[32:33], v[32:33], s[74:75]
    v_pk_add_f32 v[34:35], v[34:35], s[74:75]
    v_pk_add_f32 v[36:37], v[36:37], s[74:75]
    v_pk_add_f32 v[38:39], v[38:39], s[74:75]
    v_pk_add_f32 v[40:41], v[40:41], s[74:75]
    v_pk_add_f32 v[42:43], v[42:43], s[74:75]
    v_max_f32 v68, v68, v12
    v_max_f32 v69, v69, v13
    v_max_f32 v70, v70, v14
    v_max_f32 v71, v71, v15
    v_max_f32 v84, v84, v16
    v_max_f32 v85, v85, v17
    v_max_f32 v86, v86, v18
    v_max_f32 v87, v87, v19
    v_max_f32 v72, v72, v20
    v_max_f32 v73, v73, v21
    v_max_f32 v74, v74, v22
    v_max_f32 v75, v75, v23
    v_max_f32 v88, v88, v24
    v_max_f32 v89, v89, v25
    v_max_f32 v90, v90, v26
    v_max_f32 v91, v91, v27
    v_max_f32 v76, v76, v28
    v_max_f32 v77, v77, v29
    v_max_f32 v78, v78, v30
    v_max_f32 v79, v79, v31
    v_max_f32 v92, v92, v32
    v_max_f32 v93, v93, v33
    v_max_f32 v94, v94, v34
    v_max_f32 v95, v95, v35
    v_max_f32 v80, v80, v36
    v_max_f32 v81, v81, v37
    v_max_f32 v82, v82, v38
    v_max_f32 v83, v83, v39
    v_max_f32 v96, v96, v40
    v_max_f32 v97, v97, v41
    v_max_f32 v98, v98, v42
    v_max_f32 v99, v99, v43
    v_cvt_pk_bf16_f32 v44, v68, v69
    v_cvt_pk_bf16_f32 v45, v70, v71
    v_cvt_pk_bf16_f32 v46, v84, v85
    v_cvt_pk_bf16_f32 v47, v86, v87
    v_cvt_pk_bf16_f32 v48, v72, v73
    v_cvt_pk_bf16_f32 v49, v74, v75
    v_cvt_pk_bf16_f32 v50, v88, v89
    v_cvt_pk_bf16_f32 v51, v90, v91
    v_cvt_pk_bf16_f32 v52, v76, v77
    v_cvt_pk_bf16_f32 v53, v78, v79
    v_cvt_pk_bf16_f32 v54, v92, v93
    v_cvt_pk_bf16_f32 v55, v94, v95
    v_cvt_pk_bf16_f32 v56, v80, v81
    v_cvt_pk_bf16_f32 v57, v82, v83
    v_cvt_pk_bf16_f32 v58, v96, v97
    v_cvt_pk_bf16_f32 v59, v98, v99
    s_and_b32 s44, s46, 127
    s_lshl_b32 s44, s44, 2
    s_add_u32 s44, s44, 24832
    v_and_b32 v1, 15, v0
    v_lshl_add_u32 v63, v1, 2, s44

    v_lshrrev_b32 v2, 4, v0
    v_bfe_u32 v1, v0, 2, 2
    v_lshl_add_u32 v1, v2, 2, v1
    v_and_b32 v2, 7, v1
    s_lshl_b32 s44, s3, 1
    v_xor_b32 v2, s44, v2
    v_lshlrev_b32 v2, 5, v2
    v_lshl_add_u32 v2, v1, 8, v2
    v_and_b32 v1, 3, v0
    v_lshl_add_u32 v2, v1, 3, v2
    v_add_u32 v128, 65536, v2
    v_xor_b32 v129, 32, v128
    v_add_u32 v130, 122880, v2
    v_xor_b32 v131, 32, v130
    v_lshlrev_b32_e64 v2, 2, v1
    v_add_u32 v2, 24672, v2

    ds_read2_b32 v[4:5], v63 offset0:0 offset1:0
    ds_read2_b32 v[6:7], v63 offset0:16 offset1:16
    ds_read2_b32 v[8:9], v63 offset0:32 offset1:32
    ds_read2_b32 v[10:11], v63 offset0:48 offset1:48
    ds_read2_b32 v[12:13], v63 offset0:128 offset1:128
    ds_read2_b32 v[14:15], v63 offset0:144 offset1:144
    ds_read2_b32 v[16:17], v63 offset0:160 offset1:160
    ds_read2_b32 v[18:19], v63 offset0:176 offset1:176
    v_lshlrev_b32 v60, 4, v0
    v_and_b32 v61, 48, v0
    s_setprio 2
SP_1:
    s_load_dword s58, s[56:57], 0 glc
    s_waitcnt lgkmcnt(0)
    s_cmp_ge_u32 s58, 32
    s_cbranch_scc1 SD_2
    s_sleep 1
    s_branch SP_1
SD_2:
F_kp:
    buffer_load_dwordx4 v[36:39], v61, s[24:27], s83 offen offset:0 sc0 sc1
    buffer_load_dwordx4 v[40:43], v61, s[24:27], s83 offen offset:64 sc0 sc1
    buffer_load_dwordx4 v[20:23], v60, s[24:27], s82 offen offset:0 sc0 sc1
    buffer_load_dwordx4 v[24:27], v60, s[24:27], s82 offen offset:2048 sc0 sc1
    buffer_load_dwordx4 v[28:31], v60, s[24:27], s82 offen offset:1024 sc0 sc1
    buffer_load_dwordx4 v[32:35], v60, s[24:27], s82 offen offset:3072 sc0 sc1
    v_mov_b32 v62, 4
    s_mov_b64 exec, 1
    ds_write_b32 v3, v62 offset:0
    s_mov_b64 exec, -1
    s_waitcnt vmcnt(4)
    v_cvt_pk_bf16_f32 v124, v36, v37
    v_cvt_pk_bf16_f32 v125, v38, v39
    v_cvt_pk_bf16_f32 v126, v40, v41
    v_cvt_pk_bf16_f32 v127, v42, v43
    s_nop 1
    v_mfma_f32_16x16x32_bf16 v[76:79], v[124:127], v[44:47], 0
    v_mfma_f32_16x16x32_bf16 v[88:91], v[124:127], v[48:51], 0
    v_mfma_f32_16x16x32_bf16 v[100:103], v[124:127], v[52:55], 0
    v_mfma_f32_16x16x32_bf16 v[112:115], v[124:127], v[56:59], 0
    s_waitcnt vmcnt(2)
    v_cvt_pk_bf16_f32 v116, v20, v21
    v_cvt_pk_bf16_f32 v117, v22, v23
    v_cvt_pk_bf16_f32 v118, v24, v25
    v_cvt_pk_bf16_f32 v119, v26, v27
    s_nop 1
    v_mfma_f32_16x16x32_bf16 v[68:71], v[116:119], v[44:47], 0
    v_mfma_f32_16x16x32_bf16 v[80:83], v[116:119], v[48:51], 0
    v_mfma_f32_16x16x32_bf16 v[92:95], v[116:119], v[52:55], 0
    v_mfma_f32_16x16x32_bf16 v[104:107], v[116:119], v[56:59], 0
    v_add_f32 v76, s74, v76
    v_rcp_f32 v76, v76
    s_nop 0
    v_mov_b32 v77, v76
    v_add_f32 v88, s74, v88
    v_rcp_f32 v88, v88
    s_nop 0
    v_mov_b32 v89, v88
    v_add_f32 v100, s74, v100
    v_rcp_f32 v100, v100
    s_nop 0
    v_mov_b32 v101, v100
    v_add_f32 v112, s74, v112
    v_rcp_f32 v112, v112
    s_nop 0
    v_mov_b32_e64 v113, v112
    s_waitcnt vmcnt(0)
    v_cvt_pk_bf16_f32 v120, v28, v29
    v_cvt_pk_bf16_f32 v121, v30, v31
    v_cvt_pk_bf16_f32 v122, v32, v33
    v_cvt_pk_bf16_f32 v123, v34, v35
    s_nop 1
    v_mfma_f32_16x16x32_bf16 v[72:75], v[120:123], v[44:47], 0
    v_mfma_f32_16x16x32_bf16 v[84:87], v[120:123], v[48:51], 0
    v_mfma_f32_16x16x32_bf16 v[96:99], v[120:123], v[52:55], 0
    v_mfma_f32_16x16x32_bf16 v[108:111], v[120:123], v[56:59], 0
    s_add_u32 s80, s79, 0
    v_pk_mul_f32 v[68:69], v[68:69], v[76:77]
    v_pk_mul_f32 v[70:71], v[70:71], v[76:77]
    s_nop 1
    v_pk_mul_f32 v[72:73], v[72:73], v[76:77]
    v_pk_mul_f32 v[74:75], v[74:75], v[76:77]
    v_cvt_pk_bf16_f32 v28, v68, v69
    v_cvt_pk_bf16_f32 v29, v70, v71
    v_cvt_pk_bf16_f32 v30, v72, v73
    v_cvt_pk_bf16_f32 v31, v74, v75
    buffer_store_dwordx4 v[28:31], v60, s[16:19], s80 offen sc0 sc1
    s_add_u32 s80, s79, 32768
    v_pk_mul_f32 v[80:81], v[80:81], v[88:89]
    v_pk_mul_f32 v[82:83], v[82:83], v[88:89]
    v_pk_mul_f32 v[84:85], v[84:85], v[88:89]
    v_pk_mul_f32 v[86:87], v[86:87], v[88:89]
    v_cvt_pk_bf16_f32 v32, v80, v81
    v_cvt_pk_bf16_f32 v33, v82, v83
    v_cvt_pk_bf16_f32 v34, v84, v85
    v_cvt_pk_bf16_f32 v35, v86, v87
    buffer_store_dwordx4 v[32:35], v60, s[16:19], s80 offen sc0 sc1
    s_add_u32 s80, s79, 65536
    v_pk_mul_f32 v[92:93], v[92:93], v[100:101]
    v_pk_mul_f32 v[94:95], v[94:95], v[100:101]
    v_pk_mul_f32 v[96:97], v[96:97], v[100:101]
    v_pk_mul_f32 v[98:99], v[98:99], v[100:101]
    v_cvt_pk_bf16_f32 v36, v92, v93
    v_cvt_pk_bf16_f32 v37, v94, v95
    v_cvt_pk_bf16_f32 v38, v96, v97
    v_cvt_pk_bf16_f32 v39, v98, v99
    buffer_store_dwordx4 v[36:39], v60, s[16:19], s80 offen sc0 sc1
    s_add_u32 s80, s79, 98304
    v_pk_mul_f32 v[104:105], v[104:105], v[112:113]
    v_pk_mul_f32 v[106:107], v[106:107], v[112:113]
    v_pk_mul_f32 v[108:109], v[108:109], v[112:113]
    v_pk_mul_f32 v[110:111], v[110:111], v[112:113]
    v_cvt_pk_bf16_f32 v40, v104, v105
    v_cvt_pk_bf16_f32 v41, v106, v107
    v_cvt_pk_bf16_f32 v42, v108, v109
    v_cvt_pk_bf16_f32 v43, v110, v111
    buffer_store_dwordx4 v[40:43], v60, s[16:19], s80 offen sc0 sc1
    ds_read_b32 v61, v2
    v_lshlrev_b32 v132, 16, v148
    v_and_b32 v133, 0xffff0000, v148
    v_lshlrev_b32 v134, 16, v149
    v_and_b32 v135, 0xffff0000, v149
    v_lshlrev_b32 v136, 16, v150
    v_and_b32 v137, 0xffff0000, v150
    v_lshlrev_b32 v138, 16, v151
    v_and_b32 v139, 0xffff0000, v151
    v_pk_add_f32 v[76:77], v[132:133], v[4:5]
    v_pk_add_f32 v[78:79], v[134:135], v[4:5]
    v_pk_add_f32 v[80:81], v[136:137], v[4:5]
    v_pk_add_f32 v[82:83], v[138:139], v[4:5]
    v_cvt_pk_bf16_f32 v72, v76, v77
    v_cvt_pk_bf16_f32 v73, v78, v79
    v_cvt_pk_bf16_f32 v74, v80, v81
    v_cvt_pk_bf16_f32 v75, v82, v83
    v_lshlrev_b32 v76, 16, v72
    v_and_b32 v77, 0xffff0000, v72
    v_lshlrev_b32 v78, 16, v73
    v_and_b32 v79, 0xffff0000, v73
    v_lshlrev_b32 v80, 16, v74
    v_and_b32 v81, 0xffff0000, v74
    v_lshlrev_b32 v82, 16, v75
    v_and_b32 v83, 0xffff0000, v75
    v_pk_mul_f32 v[76:77], v[76:77], v[12:13]
    v_pk_mul_f32 v[78:79], v[78:79], v[12:13]
    v_pk_mul_f32 v[80:81], v[80:81], v[12:13]
    v_pk_mul_f32 v[82:83], v[82:83], v[12:13]
    v_cvt_pk_bf16_f32 v72, v76, v77
    v_cvt_pk_bf16_f32 v73, v78, v79
    v_cvt_pk_bf16_f32 v74, v80, v81
    v_cvt_pk_bf16_f32 v75, v82, v83
    v_lshlrev_b32 v76, 16, v72
    v_and_b32 v77, 0xffff0000, v72
    v_lshlrev_b32 v78, 16, v73
    v_and_b32 v79, 0xffff0000, v73
    v_lshlrev_b32 v80, 16, v74
    v_and_b32 v81, 0xffff0000, v74
    v_lshlrev_b32 v82, 16, v75
    v_and_b32 v83, 0xffff0000, v75
    v_pk_add_f32 v[132:133], v[132:133], v[76:77]
    v_pk_add_f32 v[134:135], v[134:135], v[78:79]
    v_pk_add_f32 v[136:137], v[136:137], v[80:81]
    v_pk_add_f32 v[138:139], v[138:139], v[82:83]
    v_lshlrev_b32 v140, 16, v152
    v_and_b32 v141, 0xffff0000, v152
    v_lshlrev_b32 v142, 16, v153
    v_and_b32 v143, 0xffff0000, v153
    v_lshlrev_b32 v144, 16, v154
    v_and_b32 v145, 0xffff0000, v154
    v_lshlrev_b32 v146, 16, v155
    v_and_b32 v147, 0xffff0000, v155
    v_pk_add_f32 v[76:77], v[140:141], v[6:7]
    v_pk_add_f32 v[78:79], v[142:143], v[6:7]
    v_pk_add_f32 v[80:81], v[144:145], v[6:7]
    v_pk_add_f32 v[82:83], v[146:147], v[6:7]
    v_cvt_pk_bf16_f32 v72, v76, v77
    v_cvt_pk_bf16_f32 v73, v78, v79
    v_cvt_pk_bf16_f32 v74, v80, v81
    v_cvt_pk_bf16_f32 v75, v82, v83
    v_lshlrev_b32 v76, 16, v72
    v_and_b32 v77, 0xffff0000, v72
    v_lshlrev_b32 v78, 16, v73
    v_and_b32 v79, 0xffff0000, v73
    v_lshlrev_b32 v80, 16, v74
    v_and_b32 v81, 0xffff0000, v74
    v_lshlrev_b32 v82, 16, v75
    v_and_b32 v83, 0xffff0000, v75
    v_pk_mul_f32 v[76:77], v[76:77], v[14:15]
    v_pk_mul_f32 v[78:79], v[78:79], v[14:15]
    v_pk_mul_f32 v[80:81], v[80:81], v[14:15]
    v_pk_mul_f32 v[82:83], v[82:83], v[14:15]
    v_cvt_pk_bf16_f32 v72, v76, v77
    v_cvt_pk_bf16_f32 v73, v78, v79
    v_cvt_pk_bf16_f32 v74, v80, v81
    v_cvt_pk_bf16_f32 v75, v82, v83
    v_lshlrev_b32 v76, 16, v72
    v_and_b32 v77, 0xffff0000, v72
    v_lshlrev_b32 v78, 16, v73
    v_and_b32 v79, 0xffff0000, v73
    v_lshlrev_b32 v80, 16, v74
    v_and_b32 v81, 0xffff0000, v74
    v_lshlrev_b32 v82, 16, v75
    v_and_b32 v83, 0xffff0000, v75
    v_pk_add_f32 v[140:141], v[140:141], v[76:77]
    v_pk_add_f32 v[142:143], v[142:143], v[78:79]
    v_pk_add_f32 v[144:145], v[144:145], v[80:81]
    v_pk_add_f32 v[146:147], v[146:147], v[82:83]
    v_mov_b32_e64 v62, 5
    s_waitcnt lgkmcnt(0)
    v_cmp_gt_u32 s[70:71], 2, v61
    s_nop 0
    s_cmp_lg_u64 s[70:71], 0
    s_cbranch_scc1 F_bp0
    ds_read_b64_tr_b16 v[40:41], v130 offset:24576
    ds_read_b64_tr_b16 v[42:43], v130 offset:28672
    ds_read_b64_tr_b16 v[44:45], v131 offset:24576
    ds_read_b64_tr_b16 v[46:47], v131 offset:28672
    ds_read_b64_tr_b16 v[64:65], v130 offset:32768
    ds_read_b64_tr_b16 v[66:67], v130 offset:36864
    ds_read_b64_tr_b16 v[68:69], v131 offset:32768
    ds_read_b64_tr_b16 v[70:71], v131 offset:36864
    ds_read_b64_tr_b16 v[88:89], v128 offset:0
    ds_read_b64_tr_b16 v[90:91], v128 offset:4096
    ds_read_b64_tr_b16 v[92:93], v129 offset:0
    ds_read_b64_tr_b16 v[94:95], v129 offset:4096
    ds_read_b64_tr_b16 v[112:113], v128 offset:8192
    ds_read_b64_tr_b16 v[114:115], v128 offset:12288
    ds_read_b64_tr_b16 v[116:117], v129 offset:8192
    s_waitcnt lgkmcnt(8)
    ds_read_b64_tr_b16 v[118:119], v129 offset:12288
    v_mov_b32 v62, 6
F_bp0:
    s_waitcnt lgkmcnt(4)
    s_waitcnt vmcnt(0)
    s_atomic_add s76, s[68:69], 0
    s_atomic_add s76, s[68:69], 128
    s_atomic_add s76, s[68:69], 256
    s_atomic_add s76, s[68:69], 384
    s_mov_b64 exec, 1
    ds_write_b32 v3, v62
    s_mov_b64 exec, -1
    s_setprio 0
    v_lshlrev_b32 v148, 16, v156
    v_and_b32 v149, 0xffff0000, v156
    v_lshlrev_b32 v150, 16, v157
    v_and_b32 v151, 0xffff0000, v157
    v_lshlrev_b32 v152, 16, v158
    v_and_b32 v153, 0xffff0000, v158
    v_lshlrev_b32_e64 v154, 16, v159
    v_and_b32 v155, 0xffff0000, v159
    v_pk_add_f32 v[76:77], v[148:149], v[8:9]
    v_pk_add_f32 v[78:79], v[150:151], v[8:9]
    v_pk_add_f32 v[80:81], v[152:153], v[8:9]
    v_pk_add_f32 v[82:83], v[154:155], v[8:9]
    v_cvt_pk_bf16_f32 v72, v76, v77
    v_cvt_pk_bf16_f32 v73, v78, v79
    v_cvt_pk_bf16_f32 v74, v80, v81
    v_cvt_pk_bf16_f32 v75, v82, v83
    v_lshlrev_b32 v76, 16, v72
    v_and_b32 v77, 0xffff0000, v72
    v_lshlrev_b32 v78, 16, v73
    v_and_b32 v79, 0xffff0000, v73
    v_lshlrev_b32 v80, 16, v74
    v_and_b32 v81, 0xffff0000, v74
    v_lshlrev_b32 v82, 16, v75
    v_and_b32 v83, 0xffff0000, v75
    v_pk_mul_f32 v[76:77], v[76:77], v[16:17]
    v_pk_mul_f32 v[78:79], v[78:79], v[16:17]
    v_pk_mul_f32 v[80:81], v[80:81], v[16:17]
    v_pk_mul_f32 v[82:83], v[82:83], v[16:17]
    v_cvt_pk_bf16_f32 v72, v76, v77
    v_cvt_pk_bf16_f32 v73, v78, v79
    v_cvt_pk_bf16_f32 v74, v80, v81
    v_cvt_pk_bf16_f32 v75, v82, v83
    v_lshlrev_b32 v76, 16, v72
    v_and_b32 v77, 0xffff0000, v72
    v_lshlrev_b32 v78, 16, v73
    v_and_b32 v79, 0xffff0000, v73
    v_lshlrev_b32 v80, 16, v74
    v_and_b32 v81, 0xffff0000, v74
    v_lshlrev_b32 v82, 16, v75
    v_and_b32 v83, 0xffff0000, v75
    v_pk_add_f32 v[148:149], v[148:149], v[76:77]
    v_pk_add_f32 v[150:151], v[150:151], v[78:79]
    v_pk_add_f32 v[152:153], v[152:153], v[80:81]
    v_pk_add_f32 v[154:155], v[154:155], v[82:83]
    v_lshlrev_b32 v156, 16, v160
    v_and_b32 v157, 0xffff0000, v160
    v_lshlrev_b32 v158, 16, v161
    v_and_b32 v159, 0xffff0000, v161
    v_lshlrev_b32 v160, 16, v162
    v_and_b32 v161, 0xffff0000, v162
    v_lshlrev_b32 v162, 16, v163
    v_and_b32 v163, 0xffff0000, v163
    v_pk_add_f32 v[76:77], v[156:157], v[10:11]
    v_pk_add_f32 v[78:79], v[158:159], v[10:11]
    v_pk_add_f32 v[80:81], v[160:161], v[10:11]
    v_pk_add_f32 v[82:83], v[162:163], v[10:11]
    v_cvt_pk_bf16_f32 v72, v76, v77
    v_cvt_pk_bf16_f32 v73, v78, v79
    v_cvt_pk_bf16_f32 v74, v80, v81
    v_cvt_pk_bf16_f32 v75, v82, v83
    v_lshlrev_b32 v76, 16, v72
    v_and_b32 v77, 0xffff0000, v72
    v_lshlrev_b32 v78, 16, v73
    v_and_b32 v79, 0xffff0000, v73
    v_lshlrev_b32 v80, 16, v74
    v_and_b32 v81, 0xffff0000, v74
    v_lshlrev_b32 v82, 16, v75
    v_and_b32 v83, 0xffff0000, v75
    v_pk_mul_f32 v[76:77], v[76:77], v[18:19]
    v_pk_mul_f32 v[78:79], v[78:79], v[18:19]
    v_pk_mul_f32 v[80:81], v[80:81], v[18:19]
    v_pk_mul_f32 v[82:83], v[82:83], v[18:19]
    v_cvt_pk_bf16_f32 v72, v76, v77
    v_cvt_pk_bf16_f32 v73, v78, v79
    v_cvt_pk_bf16_f32 v74, v80, v81
    v_cvt_pk_bf16_f32 v75, v82, v83
    v_lshlrev_b32 v76, 16, v72
    v_and_b32 v77, 0xffff0000, v72
    v_lshlrev_b32 v78, 16, v73
    v_and_b32 v79, 0xffff0000, v73
    v_lshlrev_b32 v80, 16, v74
    v_and_b32 v81, 0xffff0000, v74
    v_lshlrev_b32 v82, 16, v75
    v_and_b32 v83, 0xffff0000, v75
    v_pk_add_f32 v[156:157], v[156:157], v[76:77]
    v_pk_add_f32 v[158:159], v[158:159], v[78:79]
    v_pk_add_f32 v[160:161], v[160:161], v[80:81]
    v_pk_add_f32 v[162:163], v[162:163], v[82:83]
    v_lshlrev_b32 v4, 4, v0
    v_add_u32 v5, 98304, v4
    v_add_u32 v4, 16384, v4
    v_subrev_u32 v8, 65536, v128
    v_subrev_u32 v9, 65536, v129
    v_and_b32 v1, 15, v0
    s_lshl_b32 s44, s3, 6
    s_add_u32 s44, s44, 0
    v_lshrrev_b32 v18, 4, v0
    v_lshl_add_u32 v18, v18, 3, s44
    v_mul_u32_u24 v19, 272, v1
    v_add_u32 v18, v18, v19
    v_add_u32 v19, 4352, v18
    v_add_u32 v20, 8704, v18
    v_add_u32 v21, 13056, v18

    s_setprio 2
    s_waitcnt lgkmcnt(0)
    s_cmp_eq_u64 s[70:71], 0
    s_cbranch_scc1 F_bp1
    ds_read_b32 v61, v2
FW_3:
    s_waitcnt lgkmcnt(0)
    v_cmp_gt_u32_e64 vcc, 2, v61
    s_cbranch_vccz FO_4
    s_sleep 1
    ds_read_b32 v61, v2
    s_branch FW_3
FO_4:
    ds_read_b64_tr_b16 v[40:41], v130 offset:24576
    ds_read_b64_tr_b16 v[42:43], v130 offset:28672
    ds_read_b64_tr_b16 v[44:45], v131 offset:24576
    ds_read_b64_tr_b16 v[46:47], v131 offset:28672
    ds_read_b64_tr_b16 v[64:65], v130 offset:32768
    ds_read_b64_tr_b16 v[66:67], v130 offset:36864
    ds_read_b64_tr_b16 v[68:69], v131 offset:32768
    ds_read_b64_tr_b16 v[70:71], v131 offset:36864
    ds_read_b64_tr_b16 v[88:89], v128 offset:0
    ds_read_b64_tr_b16 v[90:91], v128 offset:4096
    ds_read_b64_tr_b16 v[92:93], v129 offset:0
    ds_read_b64_tr_b16 v[94:95], v129 offset:4096
    ds_read_b64_tr_b16 v[112:113], v128 offset:8192
    ds_read_b64_tr_b16 v[114:115], v128 offset:12288
    ds_read_b64_tr_b16 v[116:117], v129 offset:8192
    s_waitcnt lgkmcnt(8)
    ds_read_b64_tr_b16 v[118:119], v129 offset:12288
    v_mov_b32 v62, 6
    s_mov_b64 exec, 1
    ds_write_b32 v3, v62 offset:0
    s_mov_b64 exec, -1
    s_waitcnt lgkmcnt(0)
F_bp1:
    s_barrier
    ds_read_b128 v[24:27], v4 offset:0
    ds_read_b128 v[48:51], v4 offset:1024
W_3:
    s_cbranch_execz R_3
    s_nop 0
    ds_read_b128 v[28:31], v4 offset:2048
    ds_read_b128 v[52:55], v4 offset:3072
    ds_read_b128 v[32:35], v4 offset:4096
    ds_read_b128 v[56:59], v4 offset:5120
    ds_read_b128 v[36:39], v4 offset:6144
    ds_read_b128 v[60:63], v4 offset:7168
    s_waitcnt lgkmcnt(7)
    v_mfma_f32_16x16x32_bf16 v[132:135], v[40:43], v[24:27], v[132:135]
    s_waitcnt lgkmcnt(6)
    v_mfma_f32_16x16x32_bf16 v[132:135], v[64:67], v[48:51], v[132:135]
    v_mfma_f32_16x16x32_bf16 v[136:139], v[44:47], v[24:27], v[136:139]
    v_mfma_f32_16x16x32_bf16 v[136:139], v[68:71], v[48:51], v[136:139]
    s_waitcnt lgkmcnt(5)
    v_mfma_f32_16x16x32_bf16 v[140:143], v[40:43], v[28:31], v[140:143]
    s_waitcnt lgkmcnt(4)
    v_mfma_f32_16x16x32_bf16 v[140:143], v[64:67], v[52:55], v[140:143]
    s_waitcnt lgkmcnt(0)
    s_barrier
    ds_read_b128 v[72:75], v5 offset:0
    ds_read_b128 v[96:99], v5 offset:1024
    v_mfma_f32_16x16x32_bf16 v[144:147], v[44:47], v[28:31], v[144:147]
    ds_read_b128 v[76:79], v5 offset:2048
    ds_read_b128 v[100:103], v5 offset:3072
    v_mfma_f32_16x16x32_bf16 v[144:147], v[68:71], v[52:55], v[144:147]
    ds_read_b128 v[80:83], v5 offset:4096
    ds_read_b128 v[104:107], v5 offset:5120
    v_mfma_f32_16x16x32_bf16 v[148:151], v[40:43], v[32:35], v[148:151]
    ds_read_b128 v[84:87], v5 offset:6144
    ds_read_b128 v[108:111], v5 offset:7168
    v_mfma_f32_16x16x32_bf16 v[148:151], v[64:67], v[56:59], v[148:151]
    v_mfma_f32_16x16x32_bf16 v[152:155], v[44:47], v[32:35], v[152:155]
    v_mfma_f32_16x16x32_bf16 v[152:155], v[68:71], v[56:59], v[152:155]
    v_mfma_f32_16x16x32_bf16 v[156:159], v[40:43], v[36:39], v[156:159]
    v_mfma_f32_16x16x32_bf16 v[156:159], v[64:67], v[60:63], v[156:159]
    v_mfma_f32_16x16x32_bf16 v[160:163], v[44:47], v[36:39], v[160:163]
    v_mfma_f32_16x16x32_bf16 v[160:163], v[68:71], v[60:63], v[160:163]
    s_waitcnt lgkmcnt(4)
    v_mfma_f32_16x16x32_bf16 v[132:135], v[88:91], v[72:75], v[132:135]
    v_mfma_f32_16x16x32_bf16 v[132:135], v[112:115], v[96:99], v[132:135]
    s_waitcnt lgkmcnt(0)
    s_barrier
    ds_read_b64_tr_b16 v[40:41], v8 offset:0
    ds_read_b64_tr_b16 v[42:43], v8 offset:4096
    v_mfma_f32_16x16x32_bf16 v[136:139], v[92:95], v[72:75], v[136:139]
    ds_read_b128 v[24:27], v5 offset:40960
    ds_read_b64_tr_b16 v[64:65], v8 offset:8192
    v_mfma_f32_16x16x32_bf16 v[136:139], v[116:119], v[96:99], v[136:139]
    ds_read_b64_tr_b16 v[66:67], v8 offset:12288
    v_mfma_f32_16x16x32_bf16 v[140:143], v[88:91], v[76:79], v[140:143]
    ds_read_b128 v[48:51], v5 offset:41984
    v_mfma_f32_16x16x32_bf16 v[140:143], v[112:115], v[100:103], v[140:143]
    ds_read_b64_tr_b16 v[44:45], v9 offset:0
    v_mfma_f32_16x16x32_bf16 v[144:147], v[92:95], v[76:79], v[144:147]
    ds_read_b64_tr_b16 v[46:47], v9 offset:4096
    v_mfma_f32_16x16x32_bf16 v[144:147], v[116:119], v[100:103], v[144:147]
    ds_read_b64_tr_b16 v[68:69], v9 offset:8192
    v_mfma_f32_16x16x32_bf16 v[148:151], v[88:91], v[80:83], v[148:151]
    ds_read_b64_tr_b16 v[70:71], v9 offset:12288
    v_mfma_f32_16x16x32_bf16 v[148:151], v[112:115], v[104:107], v[148:151]
    ds_read_b128 v[28:31], v5 offset:43008
    v_mfma_f32_16x16x32_bf16 v[152:155], v[92:95], v[80:83], v[152:155]
    ds_read_b128 v[52:55], v5 offset:44032
    v_mfma_f32_16x16x32_bf16 v[152:155], v[116:119], v[104:107], v[152:155]
    ds_read_b128 v[32:35], v5 offset:45056
    v_mfma_f32_16x16x32_bf16 v[156:159], v[88:91], v[84:87], v[156:159]
    ds_read_b128 v[56:59], v5 offset:46080
    v_mfma_f32_16x16x32_bf16 v[156:159], v[112:115], v[108:111], v[156:159]
    s_waitcnt lgkmcnt(8)
    ds_read_b128 v[36:39], v5 offset:47104
    v_mfma_f32_16x16x32_bf16 v[160:163], v[92:95], v[84:87], v[160:163]
    ds_read_b128 v[60:63], v5 offset:48128
    v_mfma_f32_16x16x32_bf16 v[160:163], v[116:119], v[108:111], v[160:163]
    s_waitcnt lgkmcnt(4)
    v_mfma_f32_16x16x32_bf16 v[132:135], v[40:43], v[24:27], v[132:135]
    v_mfma_f32_16x16x32_bf16 v[132:135], v[64:67], v[48:51], v[132:135]
    s_waitcnt lgkmcnt(0)
    s_barrier
    ds_read_b64_tr_b16 v[88:89], v8 offset:40960
    ds_read_b64_tr_b16 v[90:91], v8 offset:45056
    v_mfma_f32_16x16x32_bf16 v[136:139], v[44:47], v[24:27], v[136:139]
    ds_read_b128 v[72:75], v4 offset:40960
    ds_read_b64_tr_b16 v[112:113], v8 offset:49152
    v_mfma_f32_16x16x32_bf16 v[136:139], v[68:71], v[48:51], v[136:139]
    ds_read_b64_tr_b16 v[114:115], v8 offset:53248
    v_mfma_f32_16x16x32_bf16 v[140:143], v[40:43], v[28:31], v[140:143]
    ds_read_b128 v[96:99], v4 offset:41984
    v_mfma_f32_16x16x32_bf16 v[140:143], v[64:67], v[52:55], v[140:143]
    ds_read_b64_tr_b16 v[92:93], v9 offset:40960
    v_mfma_f32_16x16x32_bf16 v[144:147], v[44:47], v[28:31], v[144:147]
    ds_read_b64_tr_b16 v[94:95], v9 offset:45056
    v_mfma_f32_16x16x32_bf16 v[144:147], v[68:71], v[52:55], v[144:147]
    ds_read_b64_tr_b16 v[116:117], v9 offset:49152
    v_mfma_f32_16x16x32_bf16 v[148:151], v[40:43], v[32:35], v[148:151]
    ds_read_b64_tr_b16 v[118:119], v9 offset:53248
    v_mfma_f32_16x16x32_bf16 v[148:151], v[64:67], v[56:59], v[148:151]
    ds_read_b128 v[76:79], v4 offset:43008
    v_mfma_f32_16x16x32_bf16 v[152:155], v[44:47], v[32:35], v[152:155]
    ds_read_b128 v[100:103], v4 offset:44032
    v_mfma_f32_16x16x32_bf16 v[152:155], v[68:71], v[56:59], v[152:155]
    ds_read_b128 v[80:83], v4 offset:45056
    v_mfma_f32_16x16x32_bf16 v[156:159], v[40:43], v[36:39], v[156:159]
    ds_read_b128 v[104:107], v4 offset:46080
    v_mfma_f32_16x16x32_bf16 v[156:159], v[64:67], v[60:63], v[156:159]
    s_waitcnt lgkmcnt(8)
    ds_read_b128 v[84:87], v4 offset:47104
    v_mfma_f32_16x16x32_bf16 v[160:163], v[44:47], v[36:39], v[160:163]
    ds_read_b128 v[108:111], v4 offset:48128
    v_mfma_f32_16x16x32_bf16 v[160:163], v[68:71], v[60:63], v[160:163]
    s_waitcnt lgkmcnt(4)
    v_mfma_f32_16x16x32_bf16 v[132:135], v[88:91], v[72:75], v[132:135]
    v_mfma_f32_16x16x32_bf16 v[132:135], v[112:115], v[96:99], v[132:135]
    s_waitcnt lgkmcnt(0)
    s_barrier
    ds_read_b64_tr_b16 v[40:41], v128 offset:16384
    ds_read_b64_tr_b16 v[42:43], v128 offset:20480
    v_mfma_f32_16x16x32_bf16 v[136:139], v[92:95], v[72:75], v[136:139]
    ds_read_b128 v[24:27], v4 offset:0
    ds_read_b64_tr_b16 v[64:65], v128 offset:24576
    v_mfma_f32_16x16x32_bf16 v[136:139], v[116:119], v[96:99], v[136:139]
    ds_read_b64_tr_b16 v[66:67], v128 offset:28672
    v_mfma_f32_16x16x32_bf16 v[140:143], v[88:91], v[76:79], v[140:143]
    ds_read_b128 v[48:51], v4 offset:1024
    v_mfma_f32_16x16x32_bf16 v[140:143], v[112:115], v[100:103], v[140:143]
    ds_read_b64_tr_b16 v[44:45], v129 offset:16384
    v_mfma_f32_16x16x32_bf16 v[144:147], v[92:95], v[76:79], v[144:147]
    ds_read_b64_tr_b16 v[46:47], v129 offset:20480
    v_mfma_f32_16x16x32_bf16 v[144:147], v[116:119], v[100:103], v[144:147]
    ds_read_b64_tr_b16 v[68:69], v129 offset:24576
    v_mfma_f32_16x16x32_bf16 v[148:151], v[88:91], v[80:83], v[148:151]
    ds_read_b64_tr_b16 v[70:71], v129 offset:28672
    v_mfma_f32_16x16x32_bf16 v[148:151], v[112:115], v[104:107], v[148:151]
    ds_read_b128 v[28:31], v4 offset:2048
    v_mfma_f32_16x16x32_bf16 v[152:155], v[92:95], v[80:83], v[152:155]
    ds_read_b128 v[52:55], v4 offset:3072
    v_mfma_f32_16x16x32_bf16 v[152:155], v[116:119], v[104:107], v[152:155]
    ds_read_b128 v[32:35], v4 offset:4096
    v_mfma_f32_16x16x32_bf16 v[156:159], v[88:91], v[84:87], v[156:159]
    ds_read_b128 v[56:59], v4 offset:5120
    v_mfma_f32_16x16x32_bf16 v[156:159], v[112:115], v[108:111], v[156:159]
    s_waitcnt lgkmcnt(8)
    ds_read_b128 v[36:39], v4 offset:6144
    v_mfma_f32_16x16x32_bf16 v[160:163], v[92:95], v[84:87], v[160:163]
    ds_read_b128 v[60:63], v4 offset:7168
    v_mfma_f32_16x16x32_bf16 v[160:163], v[116:119], v[108:111], v[160:163]
    s_waitcnt lgkmcnt(4)
    v_mfma_f32_16x16x32_bf16 v[132:135], v[40:43], v[24:27], v[132:135]
    v_mfma_f32_16x16x32_bf16 v[132:135], v[64:67], v[48:51], v[132:135]
    s_waitcnt lgkmcnt(0)
    s_barrier
    ds_read_b64_tr_b16 v[88:89], v130 offset:0
    ds_read_b64_tr_b16 v[90:91], v130 offset:4096
    v_mfma_f32_16x16x32_bf16 v[136:139], v[44:47], v[24:27], v[136:139]
    ds_read_b128 v[72:75], v5 offset:0
    ds_read_b64_tr_b16 v[112:113], v130 offset:8192
    v_mfma_f32_16x16x32_bf16 v[136:139], v[68:71], v[48:51], v[136:139]
    ds_read_b64_tr_b16 v[114:115], v130 offset:12288
    v_mfma_f32_16x16x32_bf16 v[140:143], v[40:43], v[28:31], v[140:143]
    ds_read_b128 v[96:99], v5 offset:1024
    v_mfma_f32_16x16x32_bf16 v[140:143], v[64:67], v[52:55], v[140:143]
    ds_read_b64_tr_b16 v[92:93], v131 offset:0
    v_mfma_f32_16x16x32_bf16 v[144:147], v[44:47], v[28:31], v[144:147]
    ds_read_b64_tr_b16 v[94:95], v131 offset:4096
    v_mfma_f32_16x16x32_bf16 v[144:147], v[68:71], v[52:55], v[144:147]
    ds_read_b64_tr_b16 v[116:117], v131 offset:8192
    v_mfma_f32_16x16x32_bf16 v[148:151], v[40:43], v[32:35], v[148:151]
    ds_read_b64_tr_b16 v[118:119], v131 offset:12288
    v_mfma_f32_16x16x32_bf16 v[148:151], v[64:67], v[56:59], v[148:151]
    ds_read_b128 v[76:79], v5 offset:2048
    v_mfma_f32_16x16x32_bf16 v[152:155], v[44:47], v[32:35], v[152:155]
    ds_read_b128 v[100:103], v5 offset:3072
    v_mfma_f32_16x16x32_bf16 v[152:155], v[68:71], v[56:59], v[152:155]
    ds_read_b128 v[80:83], v5 offset:4096
    v_mfma_f32_16x16x32_bf16 v[156:159], v[40:43], v[36:39], v[156:159]
    ds_read_b128 v[104:107], v5 offset:5120
    v_mfma_f32_16x16x32_bf16 v[156:159], v[64:67], v[60:63], v[156:159]
    s_waitcnt lgkmcnt(8)
    ds_read_b128 v[84:87], v5 offset:6144
    v_mfma_f32_16x16x32_bf16 v[160:163], v[44:47], v[36:39], v[160:163]
    ds_read_b128 v[108:111], v5 offset:7168
    v_mfma_f32_16x16x32_bf16 v[160:163], v[68:71], v[60:63], v[160:163]
    s_waitcnt lgkmcnt(4)
    v_mfma_f32_16x16x32_bf16 v[132:135], v[88:91], v[72:75], v[132:135]
    v_mfma_f32_16x16x32_bf16 v[132:135], v[112:115], v[96:99], v[132:135]
    s_waitcnt lgkmcnt(0)
    s_barrier
    ds_read_b64_tr_b16 v[40:41], v128 offset:40960
    ds_read_b64_tr_b16 v[42:43], v128 offset:45056
    v_mfma_f32_16x16x32_bf16 v[136:139], v[92:95], v[72:75], v[136:139]
    ds_read_b128 v[24:27], v5 offset:40960
    ds_read_b64_tr_b16 v[64:65], v128 offset:49152
    v_mfma_f32_16x16x32_bf16 v[136:139], v[116:119], v[96:99], v[136:139]
    ds_read_b64_tr_b16 v[66:67], v128 offset:53248
    v_mfma_f32_16x16x32_bf16 v[140:143], v[88:91], v[76:79], v[140:143]
    ds_read_b128 v[48:51], v5 offset:41984
    v_mfma_f32_16x16x32_bf16 v[140:143], v[112:115], v[100:103], v[140:143]
    ds_read_b64_tr_b16 v[44:45], v129 offset:40960
    v_mfma_f32_16x16x32_bf16 v[144:147], v[92:95], v[76:79], v[144:147]
    ds_read_b64_tr_b16 v[46:47], v129 offset:45056
    v_mfma_f32_16x16x32_bf16 v[144:147], v[116:119], v[100:103], v[144:147]
    ds_read_b64_tr_b16 v[68:69], v129 offset:49152
    v_mfma_f32_16x16x32_bf16 v[148:151], v[88:91], v[80:83], v[148:151]
    ds_read_b64_tr_b16 v[70:71], v129 offset:53248
    v_mfma_f32_16x16x32_bf16 v[148:151], v[112:115], v[104:107], v[148:151]
    ds_read_b128 v[28:31], v5 offset:43008
    v_mfma_f32_16x16x32_bf16 v[152:155], v[92:95], v[80:83], v[152:155]
    ds_read_b128 v[52:55], v5 offset:44032
    v_mfma_f32_16x16x32_bf16 v[152:155], v[116:119], v[104:107], v[152:155]
    ds_read_b128 v[32:35], v5 offset:45056
    v_mfma_f32_16x16x32_bf16 v[156:159], v[88:91], v[84:87], v[156:159]
    ds_read_b128 v[56:59], v5 offset:46080
    v_mfma_f32_16x16x32_bf16 v[156:159], v[112:115], v[108:111], v[156:159]
    s_waitcnt lgkmcnt(8)
    ds_read_b128 v[36:39], v5 offset:47104
    v_mfma_f32_16x16x32_bf16 v[160:163], v[92:95], v[84:87], v[160:163]
    ds_read_b128 v[60:63], v5 offset:48128
    v_mfma_f32_16x16x32_bf16 v[160:163], v[116:119], v[108:111], v[160:163]
    s_waitcnt lgkmcnt(4)
    v_mfma_f32_16x16x32_bf16 v[132:135], v[40:43], v[24:27], v[132:135]
    v_mfma_f32_16x16x32_bf16 v[132:135], v[64:67], v[48:51], v[132:135]
    s_waitcnt lgkmcnt(0)
    s_barrier
    ds_read_b64_tr_b16 v[88:89], v130 offset:24576
    ds_read_b64_tr_b16 v[90:91], v130 offset:28672
    v_mfma_f32_16x16x32_bf16 v[136:139], v[44:47], v[24:27], v[136:139]
    ds_read_b128 v[72:75], v4 offset:40960
    ds_read_b64_tr_b16 v[112:113], v130 offset:32768
    v_mfma_f32_16x16x32_bf16 v[136:139], v[68:71], v[48:51], v[136:139]
    ds_read_b64_tr_b16 v[114:115], v130 offset:36864
    v_mfma_f32_16x16x32_bf16 v[140:143], v[40:43], v[28:31], v[140:143]
    ds_read_b128 v[96:99], v4 offset:41984
    v_mfma_f32_16x16x32_bf16 v[140:143], v[64:67], v[52:55], v[140:143]
    ds_read_b64_tr_b16 v[92:93], v131 offset:24576
    v_mfma_f32_16x16x32_bf16 v[144:147], v[44:47], v[28:31], v[144:147]
    ds_read_b64_tr_b16 v[94:95], v131 offset:28672
    v_mfma_f32_16x16x32_bf16 v[144:147], v[68:71], v[52:55], v[144:147]
    ds_read_b64_tr_b16 v[116:117], v131 offset:32768
    v_mfma_f32_16x16x32_bf16 v[148:151], v[40:43], v[32:35], v[148:151]
    ds_read_b64_tr_b16 v[118:119], v131 offset:36864
    v_mfma_f32_16x16x32_bf16 v[148:151], v[64:67], v[56:59], v[148:151]
    ds_read_b128 v[76:79], v4 offset:43008
    v_mfma_f32_16x16x32_bf16 v[152:155], v[44:47], v[32:35], v[152:155]
    ds_read_b128 v[100:103], v4 offset:44032
    v_mfma_f32_16x16x32_bf16 v[152:155], v[68:71], v[56:59], v[152:155]
    ds_read_b128 v[80:83], v4 offset:45056
    v_mfma_f32_16x16x32_bf16 v[156:159], v[40:43], v[36:39], v[156:159]
    ds_read_b128 v[104:107], v4 offset:46080
    v_mfma_f32_16x16x32_bf16 v[156:159], v[64:67], v[60:63], v[156:159]
    s_waitcnt lgkmcnt(8)
    ds_read_b128 v[84:87], v4 offset:47104
    v_mfma_f32_16x16x32_bf16 v[160:163], v[44:47], v[36:39], v[160:163]
    ds_read_b128 v[108:111], v4 offset:48128
    v_mfma_f32_16x16x32_bf16 v[160:163], v[68:71], v[60:63], v[160:163]
    s_waitcnt lgkmcnt(4)
    v_mfma_f32_16x16x32_bf16 v[132:135], v[88:91], v[72:75], v[132:135]
    v_mfma_f32_16x16x32_bf16 v[132:135], v[112:115], v[96:99], v[132:135]
    s_waitcnt lgkmcnt(0)
    s_barrier
    ds_read_b64_tr_b16 v[40:41], v128 offset:0
    ds_read_b64_tr_b16 v[42:43], v128 offset:4096
    v_mfma_f32_16x16x32_bf16 v[136:139], v[92:95], v[72:75], v[136:139]
    ds_read_b128 v[24:27], v4 offset:0
    ds_read_b64_tr_b16 v[64:65], v128 offset:8192
    v_mfma_f32_16x16x32_bf16 v[136:139], v[116:119], v[96:99], v[136:139]
    ds_read_b64_tr_b16 v[66:67], v128 offset:12288
    v_mfma_f32_16x16x32_bf16 v[140:143], v[88:91], v[76:79], v[140:143]
    ds_read_b128 v[48:51], v4 offset:1024
    v_mfma_f32_16x16x32_bf16 v[140:143], v[112:115], v[100:103], v[140:143]
    ds_read_b64_tr_b16 v[44:45], v129 offset:0
    v_mfma_f32_16x16x32_bf16 v[144:147], v[92:95], v[76:79], v[144:147]
    ds_read_b64_tr_b16 v[46:47], v129 offset:4096
    v_mfma_f32_16x16x32_bf16 v[144:147], v[116:119], v[100:103], v[144:147]
    ds_read_b64_tr_b16 v[68:69], v129 offset:8192
    v_mfma_f32_16x16x32_bf16 v[148:151], v[88:91], v[80:83], v[148:151]
    ds_read_b64_tr_b16 v[70:71], v129 offset:12288
    v_mfma_f32_16x16x32_bf16 v[148:151], v[112:115], v[104:107], v[148:151]
    ds_read_b128 v[28:31], v4 offset:2048
    v_mfma_f32_16x16x32_bf16 v[152:155], v[92:95], v[80:83], v[152:155]
    ds_read_b128 v[52:55], v4 offset:3072
    v_mfma_f32_16x16x32_bf16 v[152:155], v[116:119], v[104:107], v[152:155]
    ds_read_b128 v[32:35], v4 offset:4096
    v_mfma_f32_16x16x32_bf16 v[156:159], v[88:91], v[84:87], v[156:159]
    ds_read_b128 v[56:59], v4 offset:5120
    v_mfma_f32_16x16x32_bf16 v[156:159], v[112:115], v[108:111], v[156:159]
    s_waitcnt lgkmcnt(8)
    ds_read_b128 v[36:39], v4 offset:6144
    v_mfma_f32_16x16x32_bf16 v[160:163], v[92:95], v[84:87], v[160:163]
    ds_read_b128 v[60:63], v4 offset:7168
    v_mfma_f32_16x16x32_bf16 v[160:163], v[116:119], v[108:111], v[160:163]
    s_waitcnt lgkmcnt(4)
    v_mfma_f32_16x16x32_bf16 v[132:135], v[40:43], v[24:27], v[132:135]
    v_mfma_f32_16x16x32_bf16 v[132:135], v[64:67], v[48:51], v[132:135]
    s_waitcnt lgkmcnt(0)
    s_barrier
    ds_read_b64_tr_b16 v[88:89], v8 offset:0
    ds_read_b64_tr_b16 v[90:91], v8 offset:4096
    v_mfma_f32_16x16x32_bf16 v[136:139], v[44:47], v[24:27], v[136:139]
    ds_read_b128 v[72:75], v5 offset:0
    ds_read_b64_tr_b16 v[112:113], v8 offset:8192
    v_mfma_f32_16x16x32_bf16 v[136:139], v[68:71], v[48:51], v[136:139]
    ds_read_b64_tr_b16 v[114:115], v8 offset:12288
    v_mfma_f32_16x16x32_bf16 v[140:143], v[40:43], v[28:31], v[140:143]
    ds_read_b128 v[96:99], v5 offset:1024
    v_mfma_f32_16x16x32_bf16 v[140:143], v[64:67], v[52:55], v[140:143]
    ds_read_b64_tr_b16 v[92:93], v9 offset:0
    v_mfma_f32_16x16x32_bf16 v[144:147], v[44:47], v[28:31], v[144:147]
    ds_read_b64_tr_b16 v[94:95], v9 offset:4096
    v_mfma_f32_16x16x32_bf16 v[144:147], v[68:71], v[52:55], v[144:147]
    ds_read_b64_tr_b16 v[116:117], v9 offset:8192
    v_mfma_f32_16x16x32_bf16 v[148:151], v[40:43], v[32:35], v[148:151]
    ds_read_b64_tr_b16 v[118:119], v9 offset:12288
    v_mfma_f32_16x16x32_bf16 v[148:151], v[64:67], v[56:59], v[148:151]
    ds_read_b128 v[76:79], v5 offset:2048
    v_mfma_f32_16x16x32_bf16 v[152:155], v[44:47], v[32:35], v[152:155]
    ds_read_b128 v[100:103], v5 offset:3072
    v_mfma_f32_16x16x32_bf16 v[152:155], v[68:71], v[56:59], v[152:155]
    ds_read_b128 v[80:83], v5 offset:4096
    v_mfma_f32_16x16x32_bf16 v[156:159], v[40:43], v[36:39], v[156:159]
    ds_read_b128 v[104:107], v5 offset:5120
    v_mfma_f32_16x16x32_bf16 v[156:159], v[64:67], v[60:63], v[156:159]
    s_waitcnt lgkmcnt(8)
    ds_read_b128 v[84:87], v5 offset:6144
    v_mfma_f32_16x16x32_bf16 v[160:163], v[44:47], v[36:39], v[160:163]
    ds_read_b128 v[108:111], v5 offset:7168
    v_mfma_f32_16x16x32_bf16 v[160:163], v[68:71], v[60:63], v[160:163]
    s_waitcnt lgkmcnt(4)
    v_mfma_f32_16x16x32_bf16 v[132:135], v[88:91], v[72:75], v[132:135]
    v_mfma_f32_16x16x32_bf16 v[132:135], v[112:115], v[96:99], v[132:135]
    s_waitcnt lgkmcnt(0)
    s_barrier
    ds_read_b64_tr_b16 v[40:41], v8 offset:40960
    ds_read_b64_tr_b16 v[42:43], v8 offset:45056
    v_mfma_f32_16x16x32_bf16 v[136:139], v[92:95], v[72:75], v[136:139]
    ds_read_b128 v[24:27], v5 offset:40960
    ds_read_b64_tr_b16 v[64:65], v8 offset:49152
    v_mfma_f32_16x16x32_bf16 v[136:139], v[116:119], v[96:99], v[136:139]
    ds_read_b64_tr_b16 v[66:67], v8 offset:53248
    v_mfma_f32_16x16x32_bf16 v[140:143], v[88:91], v[76:79], v[140:143]
    ds_read_b128 v[48:51], v5 offset:41984
    v_mfma_f32_16x16x32_bf16 v[140:143], v[112:115], v[100:103], v[140:143]
    ds_read_b64_tr_b16 v[44:45], v9 offset:40960
    v_mfma_f32_16x16x32_bf16 v[144:147], v[92:95], v[76:79], v[144:147]
    ds_read_b64_tr_b16 v[46:47], v9 offset:45056
    v_mfma_f32_16x16x32_bf16 v[144:147], v[116:119], v[100:103], v[144:147]
    ds_read_b64_tr_b16 v[68:69], v9 offset:49152
    v_mfma_f32_16x16x32_bf16 v[148:151], v[88:91], v[80:83], v[148:151]
    ds_read_b64_tr_b16 v[70:71], v9 offset:53248
    v_mfma_f32_16x16x32_bf16 v[148:151], v[112:115], v[104:107], v[148:151]
    ds_read_b128 v[28:31], v5 offset:43008
    v_mfma_f32_16x16x32_bf16 v[152:155], v[92:95], v[80:83], v[152:155]
    ds_read_b128 v[52:55], v5 offset:44032
    v_mfma_f32_16x16x32_bf16 v[152:155], v[116:119], v[104:107], v[152:155]
    ds_read_b128 v[32:35], v5 offset:45056
    v_mfma_f32_16x16x32_bf16 v[156:159], v[88:91], v[84:87], v[156:159]
    ds_read_b128 v[56:59], v5 offset:46080
    v_mfma_f32_16x16x32_bf16 v[156:159], v[112:115], v[108:111], v[156:159]
    s_waitcnt lgkmcnt(8)
    ds_read_b128 v[36:39], v5 offset:47104
    v_mfma_f32_16x16x32_bf16 v[160:163], v[92:95], v[84:87], v[160:163]
    ds_read_b128 v[60:63], v5 offset:48128
    v_mfma_f32_16x16x32_bf16 v[160:163], v[116:119], v[108:111], v[160:163]
    s_waitcnt lgkmcnt(4)
    v_mfma_f32_16x16x32_bf16 v[132:135], v[40:43], v[24:27], v[132:135]
    v_mfma_f32_16x16x32_bf16 v[132:135], v[64:67], v[48:51], v[132:135]
    s_waitcnt lgkmcnt(0)
    s_barrier
    ds_read_b64_tr_b16 v[88:89], v128 offset:16384
    ds_read_b64_tr_b16 v[90:91], v128 offset:20480
    v_mfma_f32_16x16x32_bf16 v[136:139], v[44:47], v[24:27], v[136:139]
    ds_read_b128 v[72:75], v4 offset:40960
    ds_read_b64_tr_b16 v[112:113], v128 offset:24576
    v_mfma_f32_16x16x32_bf16 v[136:139], v[68:71], v[48:51], v[136:139]
    ds_read_b64_tr_b16 v[114:115], v128 offset:28672
    v_mfma_f32_16x16x32_bf16 v[140:143], v[40:43], v[28:31], v[140:143]
    ds_read_b128 v[96:99], v4 offset:41984
    v_mfma_f32_16x16x32_bf16 v[140:143], v[64:67], v[52:55], v[140:143]
    ds_read_b64_tr_b16 v[92:93], v129 offset:16384
    v_mfma_f32_16x16x32_bf16 v[144:147], v[44:47], v[28:31], v[144:147]
    ds_read_b64_tr_b16 v[94:95], v129 offset:20480
    v_mfma_f32_16x16x32_bf16 v[144:147], v[68:71], v[52:55], v[144:147]
    ds_read_b64_tr_b16 v[116:117], v129 offset:24576
    v_mfma_f32_16x16x32_bf16 v[148:151], v[40:43], v[32:35], v[148:151]
    ds_read_b64_tr_b16 v[118:119], v129 offset:28672
    v_mfma_f32_16x16x32_bf16 v[148:151], v[64:67], v[56:59], v[148:151]
    ds_read_b128 v[76:79], v4 offset:43008
    v_mfma_f32_16x16x32_bf16 v[152:155], v[44:47], v[32:35], v[152:155]
    ds_read_b128 v[100:103], v4 offset:44032
    v_mfma_f32_16x16x32_bf16 v[152:155], v[68:71], v[56:59], v[152:155]
    ds_read_b128 v[80:83], v4 offset:45056
    v_mfma_f32_16x16x32_bf16 v[156:159], v[40:43], v[36:39], v[156:159]
    ds_read_b128 v[104:107], v4 offset:46080
    v_mfma_f32_16x16x32_bf16 v[156:159], v[64:67], v[60:63], v[156:159]
    s_waitcnt lgkmcnt(8)
    ds_read_b128 v[84:87], v4 offset:47104
    v_mfma_f32_16x16x32_bf16 v[160:163], v[44:47], v[36:39], v[160:163]
    ds_read_b128 v[108:111], v4 offset:48128
    v_mfma_f32_16x16x32_bf16 v[160:163], v[68:71], v[60:63], v[160:163]
    s_waitcnt lgkmcnt(4)
    v_mfma_f32_16x16x32_bf16 v[132:135], v[88:91], v[72:75], v[132:135]
    v_mfma_f32_16x16x32_bf16 v[132:135], v[112:115], v[96:99], v[132:135]
    s_waitcnt lgkmcnt(0)
    s_barrier
    ds_read_b64_tr_b16 v[40:41], v130 offset:0
    ds_read_b64_tr_b16 v[42:43], v130 offset:4096
    v_mfma_f32_16x16x32_bf16 v[136:139], v[92:95], v[72:75], v[136:139]
    ds_read_b128 v[24:27], v4 offset:0
    ds_read_b64_tr_b16 v[64:65], v130 offset:8192
    v_mfma_f32_16x16x32_bf16 v[136:139], v[116:119], v[96:99], v[136:139]
    ds_read_b64_tr_b16 v[66:67], v130 offset:12288
    v_mfma_f32_16x16x32_bf16 v[140:143], v[88:91], v[76:79], v[140:143]
    ds_read_b128 v[48:51], v4 offset:1024
    v_mfma_f32_16x16x32_bf16 v[140:143], v[112:115], v[100:103], v[140:143]
    ds_read_b64_tr_b16 v[44:45], v131 offset:0
    v_mfma_f32_16x16x32_bf16 v[144:147], v[92:95], v[76:79], v[144:147]
    ds_read_b64_tr_b16 v[46:47], v131 offset:4096
    v_mfma_f32_16x16x32_bf16 v[144:147], v[116:119], v[100:103], v[144:147]
    ds_read_b64_tr_b16 v[68:69], v131 offset:8192
    v_mfma_f32_16x16x32_bf16 v[148:151], v[88:91], v[80:83], v[148:151]
    ds_read_b64_tr_b16 v[70:71], v131 offset:12288
    v_mfma_f32_16x16x32_bf16 v[148:151], v[112:115], v[104:107], v[148:151]
    ds_read_b128 v[28:31], v4 offset:2048
    v_mfma_f32_16x16x32_bf16 v[152:155], v[92:95], v[80:83], v[152:155]
    ds_read_b128 v[52:55], v4 offset:3072
    v_mfma_f32_16x16x32_bf16 v[152:155], v[116:119], v[104:107], v[152:155]
    ds_read_b128 v[32:35], v4 offset:4096
    v_mfma_f32_16x16x32_bf16 v[156:159], v[88:91], v[84:87], v[156:159]
    ds_read_b128 v[56:59], v4 offset:5120
    v_mfma_f32_16x16x32_bf16 v[156:159], v[112:115], v[108:111], v[156:159]
    s_waitcnt lgkmcnt(8)
    ds_read_b128 v[36:39], v4 offset:6144
    v_mfma_f32_16x16x32_bf16 v[160:163], v[92:95], v[84:87], v[160:163]
    ds_read_b128 v[60:63], v4 offset:7168
    v_mfma_f32_16x16x32_bf16 v[160:163], v[116:119], v[108:111], v[160:163]
    s_waitcnt lgkmcnt(4)
    v_mfma_f32_16x16x32_bf16 v[132:135], v[40:43], v[24:27], v[132:135]
    v_mfma_f32_16x16x32_bf16 v[132:135], v[64:67], v[48:51], v[132:135]
    s_waitcnt lgkmcnt(0)
    s_barrier
    ds_read_b64_tr_b16 v[88:89], v128 offset:40960
    ds_read_b64_tr_b16 v[90:91], v128 offset:45056
    v_mfma_f32_16x16x32_bf16 v[136:139], v[44:47], v[24:27], v[136:139]
    ds_read_b128 v[72:75], v5 offset:0
    ds_read_b64_tr_b16 v[112:113], v128 offset:49152
    v_mfma_f32_16x16x32_bf16 v[136:139], v[68:71], v[48:51], v[136:139]
    ds_read_b64_tr_b16 v[114:115], v128 offset:53248
    v_mfma_f32_16x16x32_bf16 v[140:143], v[40:43], v[28:31], v[140:143]
    ds_read_b128 v[96:99], v5 offset:1024
    v_mfma_f32_16x16x32_bf16 v[140:143], v[64:67], v[52:55], v[140:143]
    ds_read_b64_tr_b16 v[92:93], v129 offset:40960
    v_mfma_f32_16x16x32_bf16 v[144:147], v[44:47], v[28:31], v[144:147]
    ds_read_b64_tr_b16 v[94:95], v129 offset:45056
    v_mfma_f32_16x16x32_bf16 v[144:147], v[68:71], v[52:55], v[144:147]
    ds_read_b64_tr_b16 v[116:117], v129 offset:49152
    v_mfma_f32_16x16x32_bf16 v[148:151], v[40:43], v[32:35], v[148:151]
    ds_read_b64_tr_b16 v[118:119], v129 offset:53248
    v_mfma_f32_16x16x32_bf16 v[148:151], v[64:67], v[56:59], v[148:151]
    ds_read_b128 v[76:79], v5 offset:2048
    v_mfma_f32_16x16x32_bf16 v[152:155], v[44:47], v[32:35], v[152:155]
    ds_read_b128 v[100:103], v5 offset:3072
    v_mfma_f32_16x16x32_bf16 v[152:155], v[68:71], v[56:59], v[152:155]
    ds_read_b128 v[80:83], v5 offset:4096
    v_mfma_f32_16x16x32_bf16 v[156:159], v[40:43], v[36:39], v[156:159]
    ds_read_b128 v[104:107], v5 offset:5120
    v_mfma_f32_16x16x32_bf16 v[156:159], v[64:67], v[60:63], v[156:159]
    s_waitcnt lgkmcnt(8)
    ds_read_b128 v[84:87], v5 offset:6144
    v_mfma_f32_16x16x32_bf16 v[160:163], v[44:47], v[36:39], v[160:163]
    ds_read_b128 v[108:111], v5 offset:7168
    v_mfma_f32_16x16x32_bf16 v[160:163], v[68:71], v[60:63], v[160:163]
    s_waitcnt lgkmcnt(4)
    v_mfma_f32_16x16x32_bf16 v[132:135], v[88:91], v[72:75], v[132:135]
    v_mfma_f32_16x16x32_bf16 v[132:135], v[112:115], v[96:99], v[132:135]
    s_waitcnt lgkmcnt(0)
    s_barrier
    ds_read_b64_tr_b16 v[40:41], v130 offset:24576
    ds_read_b64_tr_b16 v[42:43], v130 offset:28672
    v_mfma_f32_16x16x32_bf16 v[136:139], v[92:95], v[72:75], v[136:139]
    ds_read_b128 v[24:27], v5 offset:40960
    ds_read_b64_tr_b16 v[64:65], v130 offset:32768
    v_mfma_f32_16x16x32_bf16 v[136:139], v[116:119], v[96:99], v[136:139]
    ds_read_b64_tr_b16 v[66:67], v130 offset:36864
    v_mfma_f32_16x16x32_bf16 v[140:143], v[88:91], v[76:79], v[140:143]
    ds_read_b128 v[48:51], v5 offset:41984
    v_mfma_f32_16x16x32_bf16 v[140:143], v[112:115], v[100:103], v[140:143]
    ds_read_b64_tr_b16 v[44:45], v131 offset:24576
    v_mfma_f32_16x16x32_bf16 v[144:147], v[92:95], v[76:79], v[144:147]
    ds_read_b64_tr_b16 v[46:47], v131 offset:28672
    v_mfma_f32_16x16x32_bf16 v[144:147], v[116:119], v[100:103], v[144:147]
    ds_read_b64_tr_b16 v[68:69], v131 offset:32768
    v_mfma_f32_16x16x32_bf16 v[148:151], v[88:91], v[80:83], v[148:151]
    ds_read_b64_tr_b16 v[70:71], v131 offset:36864
    v_mfma_f32_16x16x32_bf16 v[148:151], v[112:115], v[104:107], v[148:151]
    ds_read_b128 v[28:31], v5 offset:43008
    v_mfma_f32_16x16x32_bf16 v[152:155], v[92:95], v[80:83], v[152:155]
    ds_read_b128 v[52:55], v5 offset:44032
    v_mfma_f32_16x16x32_bf16 v[152:155], v[116:119], v[104:107], v[152:155]
    ds_read_b128 v[32:35], v5 offset:45056
    v_mfma_f32_16x16x32_bf16 v[156:159], v[88:91], v[84:87], v[156:159]
    ds_read_b128 v[56:59], v5 offset:46080
    v_mfma_f32_16x16x32_bf16 v[156:159], v[112:115], v[108:111], v[156:159]
    s_waitcnt lgkmcnt(8)
    ds_read_b128 v[36:39], v5 offset:47104
    v_mfma_f32_16x16x32_bf16 v[160:163], v[92:95], v[84:87], v[160:163]
    ds_read_b128 v[60:63], v5 offset:48128
    v_mfma_f32_16x16x32_bf16 v[160:163], v[116:119], v[108:111], v[160:163]
    s_waitcnt lgkmcnt(4)
    v_mfma_f32_16x16x32_bf16 v[132:135], v[40:43], v[24:27], v[132:135]
    v_mfma_f32_16x16x32_bf16 v[132:135], v[64:67], v[48:51], v[132:135]
    s_waitcnt lgkmcnt(0)
    s_barrier
    ds_read_b64_tr_b16 v[88:89], v128 offset:0
    ds_read_b64_tr_b16 v[90:91], v128 offset:4096
    v_mfma_f32_16x16x32_bf16 v[136:139], v[44:47], v[24:27], v[136:139]
    ds_read_b128 v[72:75], v4 offset:40960
    ds_read_b64_tr_b16 v[112:113], v128 offset:8192
    v_mfma_f32_16x16x32_bf16 v[136:139], v[68:71], v[48:51], v[136:139]
    ds_read_b64_tr_b16 v[114:115], v128 offset:12288
    ds_read_b128 v[96:99], v4 offset:41984
    v_mfma_f32_16x16x32_bf16 v[140:143], v[40:43], v[28:31], v[140:143]
    ds_read_b64_tr_b16 v[92:93], v129 offset:0
    ds_read_b64_tr_b16 v[94:95], v129 offset:4096
    v_mfma_f32_16x16x32_bf16 v[140:143], v[64:67], v[52:55], v[140:143]
    ds_read_b64_tr_b16 v[116:117], v129 offset:8192
    ds_read_b64_tr_b16 v[118:119], v129 offset:12288
    v_mfma_f32_16x16x32_bf16 v[144:147], v[44:47], v[28:31], v[144:147]
    ds_read_b128 v[76:79], v4 offset:43008
    v_mfma_f32_16x16x32_bf16 v[144:147], v[68:71], v[52:55], v[144:147]
    ds_read_b128 v[100:103], v4 offset:44032
    s_waitcnt lgkmcnt(9)
    v_mfma_f32_16x16x32_bf16 v[132:135], v[88:91], v[72:75], v[132:135]
    ds_read_b128 v[80:83], v4 offset:45056
    s_waitcnt lgkmcnt(7)
    v_mfma_f32_16x16x32_bf16 v[132:135], v[112:115], v[96:99], v[132:135]
    ds_read_b128 v[104:107], v4 offset:46080
    s_waitcnt lgkmcnt(6)
    v_mfma_f32_16x16x32_bf16 v[136:139], v[92:95], v[72:75], v[136:139]
    ds_read_b128 v[84:87], v4 offset:47104
    s_waitcnt lgkmcnt(5)
    v_mfma_f32_16x16x32_bf16 v[136:139], v[116:119], v[96:99], v[136:139]
    ds_read_b128 v[108:111], v4 offset:48128
    v_mfma_f32_16x16x32_bf16 v[148:151], v[40:43], v[32:35], v[148:151]
    v_mfma_f32_16x16x32_bf16 v[148:151], v[64:67], v[56:59], v[148:151]
    v_mfma_f32_16x16x32_bf16 v[152:155], v[44:47], v[32:35], v[152:155]
    v_cvt_pk_bf16_f32 v132, v132, v133
    v_cvt_pk_bf16_f32 v133, v134, v135
W_4:
    s_cbranch_execz R_4
    s_nop 0
    v_mfma_f32_16x16x32_bf16 v[152:155], v[68:71], v[56:59], v[152:155]
    s_nop 0
    v_cvt_pk_bf16_f32 v134, v136, v137
    v_cvt_pk_bf16_f32 v135, v138, v139
    s_waitcnt lgkmcnt(5)
    v_mfma_f32_16x16x32_bf16 v[140:143], v[88:91], v[76:79], v[140:143]
    ds_write2_b64 v18, v[132:133], v[134:135] offset0:0 offset1:4
    s_waitcnt lgkmcnt(5)
    v_mfma_f32_16x16x32_bf16 v[140:143], v[112:115], v[100:103], v[140:143]
    v_mfma_f32_16x16x32_bf16 v[144:147], v[92:95], v[76:79], v[144:147]
    v_mfma_f32_16x16x32_bf16 v[144:147], v[116:119], v[100:103], v[144:147]
    v_mfma_f32_16x16x32_bf16 v[156:159], v[40:43], v[36:39], v[156:159]
    v_mfma_f32_16x16x32_bf16 v[156:159], v[64:67], v[60:63], v[156:159]
    v_mfma_f32_16x16x32_bf16 v[160:163], v[44:47], v[36:39], v[160:163]
    s_waitcnt lgkmcnt(0)
    s_barrier
    s_nop 0
    v_cvt_pk_bf16_f32 v140, v140, v141
    v_mfma_f32_16x16x32_bf16 v[160:163], v[68:71], v[60:63], v[160:163]
    v_cvt_pk_bf16_f32 v141, v142, v143
    v_cvt_pk_bf16_f32 v142, v144, v145
    v_mfma_f32_16x16x32_bf16 v[148:151], v[88:91], v[80:83], v[148:151]
    v_cvt_pk_bf16_f32 v143, v146, v147
    ds_write2_b64 v19, v[140:141], v[142:143] offset0:0 offset1:4
    v_mfma_f32_16x16x32_bf16 v[148:151], v[112:115], v[104:107], v[148:151]
    v_mfma_f32_16x16x32_bf16 v[152:155], v[92:95], v[80:83], v[152:155]
    v_mfma_f32_16x16x32_bf16 v[152:155], v[116:119], v[104:107], v[152:155]
    v_mfma_f32_16x16x32_bf16 v[156:159], v[88:91], v[84:87], v[156:159]
    v_mfma_f32_16x16x32_bf16 v[156:159], v[112:115], v[108:111], v[156:159]
    v_mfma_f32_16x16x32_bf16 v[160:163], v[92:95], v[84:87], v[160:163]
    s_waitcnt lgkmcnt(0)
    s_barrier
    s_nop 0
    v_cvt_pk_bf16_f32 v148, v148, v149
    v_cvt_pk_bf16_f32 v149, v150, v151
    v_mfma_f32_16x16x32_bf16 v[160:163], v[116:119], v[108:111], v[160:163]
    v_cvt_pk_bf16_f32 v150, v152, v153
    v_cvt_pk_bf16_f32 v151, v154, v155
    ds_write2_b64 v20, v[148:149], v[150:151] offset0:0 offset1:4
    v_cvt_pk_bf16_f32 v156, v156, v157
    v_cvt_pk_bf16_f32 v157, v158, v159
    s_nop 2
    v_cvt_pk_bf16_f32 v158, v160, v161
    v_cvt_pk_bf16_f32 v159, v162, v163
    ds_write2_b64 v21, v[156:157], v[158:159] offset0:0 offset1:4
    s_waitcnt lgkmcnt(0)
    s_barrier
F_end:
    s_endpgm
F_loader:
    s_mov_b32 s48, 0x76542130
    s_mov_b32 s49, 0xfedca9b8
    s_cmp_eq_u32 s35, 1
    s_cselect_b32 s48, 0x75463021, s48
    s_cselect_b32 s49, 0xfdceba98, s49
    s_cmp_eq_u32 s35, 2
    s_cselect_b32 s48, 0x96543102, s48
    s_cselect_b32 s49, 0xfedcba87, s49
    s_cmp_eq_u32 s35, 3
    s_cselect_b32 s48, 0x76532410, s48
    s_cselect_b32 s49, 0xfedbac98, s49
    s_cmp_eq_u32 s35, 4
    s_cselect_b32 s48, 0x65743021, s48
    s_cselect_b32 s49, 0xedfcba98, s49
    s_cmp_eq_u32 s35, 5
    s_cselect_b32 s48, 0x76543102, s48
    s_cselect_b32 s49, 0xfedcb98a, s49
    s_cmp_eq_u32 s35, 6
    s_cselect_b32 s48, 0x76435210, s48
    s_cselect_b32 s49, 0xfecbda98, s49
    s_cmp_eq_u32 s35, 7
    s_cselect_b32 s48, 0x68543021, s48
    s_cselect_b32 s49, 0xfedcba97, s49
    s_setprio 0
    s_sub_u32 s3, s3, 8
    v_lshrrev_b32 v2, 3, v0
    v_and_b32 v3, 7, v0
    v_lshrrev_b32 v4, 1, v2
    v_xor_b32 v5, v3, v4
    v_xor_b32 v6, 4, v5
    v_lshlrev_b32 v5, 4, v5
    v_lshlrev_b32 v6, 4, v6
    v_lshlrev_b32 v7, 11, v2
    v_add_u32 v12, v5, v7
    v_add_u32 v13, v6, v7
    v_and_b32 v4, 1, v4
    v_lshlrev_b32 v4, 1, v4
    v_xor_b32 v8, v3, v4
    v_xor_b32 v9, 4, v8
    v_lshlrev_b32 v8, 4, v8
    v_lshlrev_b32 v9, 4, v9
    v_mul_u32_u24 v7, 6144, v2
    v_add_u32 v14, v8, v7
    v_add_u32_e64 v15, v9, v7
    s_lshl_b32 s36, s32, 18
    s_lshl_b32 s37, s3, 16
    s_add_u32 s36, s36, s37
    s_lshl_b32 s38, s33, 7
    s_mul_i32 s37, s3, 98304
    s_add_u32 s38, s38, s37
    s_sub_u32 s47, s10, s33
    s_lshl_b32 s47, s47, 7
    s_and_b32 s42, s39, 8
    s_and_b32 s43, s30, 6
    s_or_b32 s42, s42, s43
    s_and_b32 s43, s34, 0
    s_lshl_b32 s43, s43, 0
    s_xor_b32 s42, s42, s43
    s_lshl_b32 s44, s3, 12
    s_lshl_b32 s45, s3, 11
    s_waitcnt lgkmcnt(0)
    s_mov_b32 s12, s4
    s_mov_b32 s13, s5
    s_mov_b32 s14, 0x400000
    s_mov_b32 s15, 0x00020000
    s_mov_b32 s16, s6
    s_mov_b32 s17, s7
    s_mov_b32 s18, 0x600000
    s_mov_b32 s19, 0x00020000
    s_bfe_u32 s40, s48, 0x40000
    s_bitcmp1_b32 s40, 3
    s_cselect_b32 s41, s39, s42
    s_xor_b32 s40, s40, s41
    s_mul_i32 s41, s40, 393216
    s_add_u32 s41, s41, s38
    s_lshl_b32 s40, s40, 7
    s_add_u32 s40, s40, s36
    s_add_u32 m0, s44, 0
    s_add_u32 s46, s40, 0
    buffer_load_dwordx4 v12, s[12:15], s46 offen lds
    s_add_u32 m0, s45, 24576
    s_add_u32 s46, s41, 2048
    buffer_load_dwordx4 v14, s[16:19], s46 offen lds
    s_add_u32 m0, s45, 25600
    s_add_u32 s46, s41, 51200
    buffer_load_dwordx4 v15, s[16:19], s46 offen lds
    s_add_u32 m0, s45, 16384
    s_add_u32 s46, s41, 0
    s_add_u32 s46, s46, s47
    buffer_load_dwordx4 v14, s[16:19], s46 offen lds
    s_add_u32 m0, s45, 17408
    s_add_u32 s46, s41, 49152
    s_add_u32 s46, s46, s47
    s_nop 0
    buffer_load_dwordx4 v15, s[16:19], s46 offen lds
    s_add_u32 m0, s45, 32768
    s_add_u32 s46, s41, 4096
    buffer_load_dwordx4 v14, s[16:19], s46 offen lds
    s_add_u32 m0, s45, 33792
    s_add_u32 s46, s41, 53248
    buffer_load_dwordx4 v15, s[16:19], s46 offen lds
    s_add_u32 m0, s44, 1024
    s_add_u32 s46, s40, 16384
    buffer_load_dwordx4 v13, s[12:15], s46 offen lds
    s_add_u32 m0, s44, 2048
    s_add_u32 s46, s40, 32768
    buffer_load_dwordx4 v12, s[12:15], s46 offen lds
    s_add_u32 m0, s44, 3072
    s_add_u32 s46, s40, 49152
    buffer_load_dwordx4 v13, s[12:15], s46 offen lds
    s_bfe_u32 s40, s48, 0x40004
    s_bitcmp1_b32 s40, 3
    s_cselect_b32 s41, s39, s42
    s_xor_b32 s40, s40, s41
    s_mul_i32 s41, s40, 393216
    s_add_u32 s41, s41, s38
    s_lshl_b32 s40, s40, 7
    s_add_u32 s40, s40, s36
    s_add_u32 m0, s44, 40960
    s_add_u32 s46, s40, 0
    s_nop 0
    buffer_load_dwordx4 v12, s[12:15], s46 offen lds
    s_add_u32 m0, s45, 65536
    s_add_u32 s46, s41, 2048
    buffer_load_dwordx4 v14, s[16:19], s46 offen lds
    s_add_u32 m0, s45, 66560
    s_add_u32 s46, s41, 51200
    buffer_load_dwordx4 v15, s[16:19], s46 offen lds
    s_add_u32 m0, s45, 57344
    s_add_u32 s46, s41, 0
    s_add_u32 s46, s46, s47
    buffer_load_dwordx4 v14, s[16:19], s46 offen lds
    s_add_u32 m0, s45, 58368
    s_add_u32 s46, s41, 49152
    s_add_u32 s46, s46, s47
    s_nop 0
    buffer_load_dwordx4 v15, s[16:19], s46 offen lds
    s_add_u32 m0, s45, 73728
    s_add_u32 s46, s41, 4096
    buffer_load_dwordx4 v14, s[16:19], s46 offen lds
    s_add_u32 m0, s45, 74752
    s_add_u32 s46, s41, 53248
    buffer_load_dwordx4 v15, s[16:19], s46 offen lds
    s_add_u32 m0, s44, 41984
    s_add_u32 s46, s40, 16384
    buffer_load_dwordx4 v13, s[12:15], s46 offen lds
    s_waitcnt vmcnt(8)
    s_barrier
    s_add_u32 m0, s44, 43008
    s_add_u32 s46, s40, 32768
    buffer_load_dwordx4 v12, s[12:15], s46 offen lds
    s_add_u32 m0, s44, 44032
    s_add_u32 s46, s40, 49152
    buffer_load_dwordx4 v13, s[12:15], s46 offen lds
    s_bfe_u32 s40, s48, 0x40008
    s_bitcmp1_b32 s40, 3
    s_cselect_b32 s41, s39, s42
    s_xor_b32 s40, s40, s41
    s_mul_i32 s41, s40, 393216
    s_add_u32 s41, s41, s38
    s_lshl_b32 s40, s40, 7
    s_add_u32 s40, s40, s36
    s_add_u32 m0, s44, 81920
    s_add_u32 s46, s40, 0
    s_nop 0
    buffer_load_dwordx4 v12, s[12:15], s46 offen lds
    s_add_u32 m0, s45, 106496
    s_add_u32 s46, s41, 2048
    buffer_load_dwordx4 v14, s[16:19], s46 offen lds
    s_add_u32 m0, s45, 107520
    s_add_u32 s46, s41, 51200
    buffer_load_dwordx4 v15, s[16:19], s46 offen lds
    s_add_u32 m0, s45, 98304
    s_add_u32 s46, s41, 0
    s_add_u32 s46, s46, s47
    buffer_load_dwordx4 v14, s[16:19], s46 offen lds
    s_add_u32 m0, s45, 99328
    s_add_u32 s46, s41, 49152
    s_add_u32 s46, s46, s47
    s_nop 0
    buffer_load_dwordx4 v15, s[16:19], s46 offen lds
    s_add_u32 m0, s45, 114688
    s_add_u32 s46, s41, 4096
    buffer_load_dwordx4 v14, s[16:19], s46 offen lds
    s_add_u32 m0, s45, 115712
    s_add_u32 s46, s41, 53248
    buffer_load_dwordx4 v15, s[16:19], s46 offen lds
    s_add_u32 m0, s44, 82944
    s_add_u32 s46, s40, 16384
    buffer_load_dwordx4 v13, s[12:15], s46 offen lds
    s_add_u32 m0, s44, 83968
    s_add_u32 s46, s40, 32768
    buffer_load_dwordx4 v12, s[12:15], s46 offen lds
    s_add_u32 m0, s44, 84992
    s_add_u32 s46, s40, 49152
    buffer_load_dwordx4 v13, s[12:15], s46 offen lds
    s_waitcnt vmcnt(10)
    s_barrier
    s_bfe_u32 s40, s48, 0x4000c
    s_bitcmp1_b32 s40, 3
    s_cselect_b32 s41, s39, s42
    s_xor_b32 s40, s40, s41
    s_mul_i32 s41, s40, 393216
    s_add_u32 s41, s41, s38
    s_lshl_b32 s40, s40, 7
    s_add_u32 s40, s40, s36
    s_add_u32 m0, s44, 122880
    s_add_u32 s46, s40, 0
    s_nop 0
    buffer_load_dwordx4 v12, s[12:15], s46 offen lds
    s_add_u32 m0, s45, 147456
    s_add_u32 s46, s41, 2048
    buffer_load_dwordx4 v14, s[16:19], s46 offen lds
    s_add_u32 m0, s45, 148480
    s_add_u32 s46, s41, 51200
    buffer_load_dwordx4 v15, s[16:19], s46 offen lds
    s_add_u32 m0, s45, 139264
    s_add_u32 s46, s41, 0
    s_add_u32 s46, s46, s47
    buffer_load_dwordx4 v14, s[16:19], s46 offen lds
    s_add_u32 m0, s45, 140288
    s_add_u32 s46, s41, 49152
    s_add_u32 s46, s46, s47
    s_nop 0
    buffer_load_dwordx4 v15, s[16:19], s46 offen lds
    s_add_u32 m0, s45, 155648
    s_add_u32 s46, s41, 4096
    buffer_load_dwordx4 v14, s[16:19], s46 offen lds
    s_add_u32 m0, s45, 156672
    s_add_u32 s46, s41, 53248
    buffer_load_dwordx4 v15, s[16:19], s46 offen lds
    s_add_u32 m0, s44, 123904
    s_add_u32 s46, s40, 16384
    buffer_load_dwordx4 v13, s[12:15], s46 offen lds
    s_add_u32 m0, s44, 124928
    s_add_u32 s46, s40, 32768
    buffer_load_dwordx4 v12, s[12:15], s46 offen lds
    s_add_u32 m0, s44, 125952
    s_add_u32 s46, s40, 49152
    buffer_load_dwordx4 v13, s[12:15], s46 offen lds
    s_bfe_u32 s40, s48, 0x40010
    s_bitcmp1_b32 s40, 3
    s_cselect_b32 s41, s39, s42
    s_xor_b32 s40, s40, s41
    s_mul_i32 s41, s40, 393216
    s_add_u32 s41, s41, s38
    s_lshl_b32 s40, s40, 7
    s_add_u32 s40, s40, s36
    s_add_u32 m0, s44, 0
    s_add_u32 s46, s40, 0
    buffer_load_dwordx4 v12, s[12:15], s46 offen lds
    s_add_u32 m0, s45, 24576
    s_add_u32 s46, s41, 2048
    buffer_load_dwordx4 v14, s[16:19], s46 offen lds
    s_waitcnt vmcnt(12)
    s_barrier
    s_add_u32 m0, s45, 25600
    s_add_u32 s46, s41, 51200
    buffer_load_dwordx4 v15, s[16:19], s46 offen lds
    s_add_u32 m0, s45, 16384
    s_add_u32 s46, s41, 0
    s_add_u32 s46, s46, s47
    buffer_load_dwordx4 v14, s[16:19], s46 offen lds
    s_add_u32 m0, s45, 17408
    s_add_u32 s46, s41, 49152
    s_add_u32 s46, s46, s47
    s_nop 0
    buffer_load_dwordx4 v15, s[16:19], s46 offen lds
    s_add_u32 m0, s45, 32768
    s_add_u32 s46, s41, 4096
    buffer_load_dwordx4 v14, s[16:19], s46 offen lds
    s_add_u32 m0, s45, 33792
    s_add_u32 s46, s41, 53248
    buffer_load_dwordx4 v15, s[16:19], s46 offen lds
    s_add_u32 m0, s44, 1024
    s_add_u32 s46, s40, 16384
    buffer_load_dwordx4 v13, s[12:15], s46 offen lds
    s_add_u32 m0, s44, 2048
    s_add_u32 s46, s40, 32768
    buffer_load_dwordx4 v12, s[12:15], s46 offen lds
    s_add_u32 m0, s44, 3072
    s_add_u32 s46, s40, 49152
    buffer_load_dwordx4 v13, s[12:15], s46 offen lds
    s_bfe_u32 s40, s48, 0x40014
    s_bitcmp1_b32 s40, 3
    s_cselect_b32 s41, s39, s42
    s_xor_b32 s40, s40, s41
    s_mul_i32 s41, s40, 393216
    s_add_u32 s41, s41, s38
    s_lshl_b32 s40, s40, 7
    s_add_u32 s40, s40, s36
    s_add_u32 m0, s44, 40960
    s_add_u32 s46, s40, 0
    s_nop 0
    buffer_load_dwordx4 v12, s[12:15], s46 offen lds
    s_add_u32 m0, s45, 65536
    s_add_u32 s46, s41, 2048
    buffer_load_dwordx4 v14, s[16:19], s46 offen lds
    s_add_u32 m0, s45, 66560
    s_add_u32 s46, s41, 51200
    buffer_load_dwordx4 v15, s[16:19], s46 offen lds
    s_add_u32 m0, s45, 57344
    s_add_u32 s46, s41, 0
    s_add_u32 s46, s46, s47
    buffer_load_dwordx4 v14, s[16:19], s46 offen lds
    s_waitcnt vmcnt(14)
    s_barrier
    s_add_u32 m0, s45, 58368
    s_add_u32 s46, s41, 49152
    s_add_u32 s46, s46, s47
    s_nop 0
    buffer_load_dwordx4 v15, s[16:19], s46 offen lds
    s_add_u32 m0, s45, 73728
    s_add_u32 s46, s41, 4096
    buffer_load_dwordx4 v14, s[16:19], s46 offen lds
    s_add_u32 m0, s45, 74752
    s_add_u32 s46, s41, 53248
    buffer_load_dwordx4 v15, s[16:19], s46 offen lds
    s_add_u32 m0, s44, 41984
    s_add_u32 s46, s40, 16384
    buffer_load_dwordx4 v13, s[12:15], s46 offen lds
    s_add_u32 m0, s44, 43008
    s_add_u32 s46, s40, 32768
    buffer_load_dwordx4 v12, s[12:15], s46 offen lds
    s_add_u32 m0, s44, 44032
    s_add_u32 s46, s40, 49152
    buffer_load_dwordx4 v13, s[12:15], s46 offen lds
    s_bfe_u32 s40, s48, 0x40018
    s_bitcmp1_b32 s40, 3
    s_cselect_b32 s41, s39, s42
    s_xor_b32 s40, s40, s41
    s_mul_i32 s41, s40, 393216
    s_add_u32 s41, s41, s38
    s_lshl_b32 s40, s40, 7
    s_add_u32 s40, s40, s36
    s_add_u32 m0, s44, 81920
    s_add_u32 s46, s40, 0
    s_nop 0
    buffer_load_dwordx4 v12, s[12:15], s46 offen lds
    s_add_u32 m0, s45, 106496
    s_add_u32 s46, s41, 2048
    buffer_load_dwordx4 v14, s[16:19], s46 offen lds
    s_add_u32 m0, s45, 107520
    s_add_u32 s46, s41, 51200
    buffer_load_dwordx4 v15, s[16:19], s46 offen lds
    s_add_u32 m0, s45, 98304
    s_add_u32 s46, s41, 0
    s_add_u32 s46, s46, s47
    buffer_load_dwordx4 v14, s[16:19], s46 offen lds
    s_add_u32 m0, s45, 99328
    s_add_u32 s46, s41, 49152
    s_add_u32 s46, s46, s47
    buffer_load_dwordx4 v15, s[16:19], s46 offen lds
    s_add_u32 m0, s45, 114688
    s_add_u32 s46, s41, 4096
    buffer_load_dwordx4 v14, s[16:19], s46 offen lds
    s_waitcnt vmcnt(16)
    s_barrier
    s_nop 0
    s_add_u32 m0, s45, 115712
    s_add_u32 s46, s41, 53248
    buffer_load_dwordx4 v15, s[16:19], s46 offen lds
    s_add_u32 m0, s44, 82944
    s_add_u32 s46, s40, 16384
    buffer_load_dwordx4 v13, s[12:15], s46 offen lds
    s_add_u32 m0, s44, 83968
    s_add_u32 s46, s40, 32768
    buffer_load_dwordx4 v12, s[12:15], s46 offen lds
    s_add_u32 m0, s44, 84992
    s_add_u32 s46, s40, 49152
    buffer_load_dwordx4 v13, s[12:15], s46 offen lds
    s_bfe_u32 s40, s48, 0x4001c
    s_bitcmp1_b32 s40, 3
    s_cselect_b32 s41, s39, s42
    s_xor_b32 s40, s40, s41
    s_mul_i32 s41, s40, 393216
    s_add_u32 s41, s41, s38
    s_lshl_b32 s40, s40, 7
    s_add_u32 s40, s40, s36
    s_add_u32 m0, s44, 122880
    s_add_u32 s46, s40, 0
    s_nop 0
    buffer_load_dwordx4 v12, s[12:15], s46 offen lds
    s_add_u32 m0, s45, 147456
    s_add_u32 s46, s41, 2048
    buffer_load_dwordx4 v14, s[16:19], s46 offen lds
    s_add_u32 m0, s45, 148480
    s_add_u32 s46, s41, 51200
    buffer_load_dwordx4 v15, s[16:19], s46 offen lds
    s_add_u32 m0, s45, 139264
    s_add_u32 s46, s41, 0
    s_add_u32 s46, s46, s47
    buffer_load_dwordx4 v14, s[16:19], s46 offen lds
    s_add_u32 m0, s45, 140288
    s_add_u32 s46, s41, 49152
    s_add_u32 s46, s46, s47
    s_nop 0
    buffer_load_dwordx4 v15, s[16:19], s46 offen lds
    s_add_u32 m0, s45, 155648
    s_add_u32 s46, s41, 4096
    buffer_load_dwordx4 v14, s[16:19], s46 offen lds
    s_add_u32 m0, s45, 156672
    s_add_u32 s46, s41, 53248
    buffer_load_dwordx4 v15, s[16:19], s46 offen lds
    s_add_u32 m0, s44, 123904
    s_add_u32 s46, s40, 16384
    buffer_load_dwordx4 v13, s[12:15], s46 offen lds
    s_waitcnt vmcnt(18)
    s_barrier
    s_add_u32 m0, s44, 124928
    s_add_u32 s46, s40, 32768
    buffer_load_dwordx4 v12, s[12:15], s46 offen lds
    s_add_u32 m0, s44, 125952
    s_add_u32 s46, s40, 49152
    buffer_load_dwordx4 v13, s[12:15], s46 offen lds
    s_bfe_u32 s40, s49, 0x40000
    s_bitcmp1_b32 s40, 3
    s_cselect_b32 s41, s39, s42
    s_xor_b32 s40, s40, s41
    s_mul_i32 s41, s40, 393216
    s_add_u32 s41, s41, s38
    s_lshl_b32 s40, s40, 7
    s_add_u32 s40, s40, s36
    s_add_u32 m0, s44, 0
    s_add_u32 s46, s40, 0
    buffer_load_dwordx4 v12, s[12:15], s46 offen lds
    s_add_u32 m0, s45, 24576
    s_add_u32 s46, s41, 2048
    buffer_load_dwordx4 v14, s[16:19], s46 offen lds
    s_add_u32 m0, s45, 25600
    s_add_u32 s46, s41, 51200
    buffer_load_dwordx4 v15, s[16:19], s46 offen lds
    s_add_u32 m0, s45, 16384
    s_add_u32 s46, s41, 0
    s_add_u32 s46, s46, s47
    buffer_load_dwordx4 v14, s[16:19], s46 offen lds
    s_add_u32 m0, s45, 17408
    s_add_u32 s46, s41, 49152
    s_add_u32 s46, s46, s47
    s_nop 0
    buffer_load_dwordx4 v15, s[16:19], s46 offen lds
    s_add_u32 m0, s45, 32768
    s_add_u32 s46, s41, 4096
    buffer_load_dwordx4 v14, s[16:19], s46 offen lds
    s_add_u32 m0, s45, 33792
    s_add_u32 s46, s41, 53248
    buffer_load_dwordx4 v15, s[16:19], s46 offen lds
    s_add_u32 m0, s44, 1024
    s_add_u32 s46, s40, 16384
    buffer_load_dwordx4 v13, s[12:15], s46 offen lds
    s_add_u32 m0, s44, 2048
    s_add_u32 s46, s40, 32768
    buffer_load_dwordx4 v12, s[12:15], s46 offen lds
    s_add_u32 m0, s44, 3072
    s_add_u32 s46, s40, 49152
    buffer_load_dwordx4 v13, s[12:15], s46 offen lds
    s_waitcnt vmcnt(20)
    s_barrier
    s_bfe_u32 s40, s49, 0x40004
    s_bitcmp1_b32 s40, 3
    s_cselect_b32 s41, s39, s42
    s_xor_b32 s40, s40, s41
    s_mul_i32 s41, s40, 393216
    s_add_u32 s41, s41, s38
    s_lshl_b32 s40, s40, 7
    s_add_u32 s40, s40, s36
    s_add_u32 m0, s44, 40960
    s_add_u32 s46, s40, 0
    s_nop 0
    buffer_load_dwordx4 v12, s[12:15], s46 offen lds
    s_add_u32 m0, s45, 65536
    s_add_u32 s46, s41, 2048
    buffer_load_dwordx4 v14, s[16:19], s46 offen lds
    s_add_u32 m0, s45, 66560
    s_add_u32 s46, s41, 51200
    buffer_load_dwordx4 v15, s[16:19], s46 offen lds
    s_add_u32 m0, s45, 57344
    s_add_u32 s46, s41, 0
    s_add_u32 s46, s46, s47
    buffer_load_dwordx4 v14, s[16:19], s46 offen lds
    s_add_u32 m0, s45, 58368
    s_add_u32 s46, s41, 49152
    s_add_u32 s46, s46, s47
    s_nop 0
    buffer_load_dwordx4 v15, s[16:19], s46 offen lds
    s_add_u32 m0, s45, 73728
    s_add_u32 s46, s41, 4096
    buffer_load_dwordx4 v14, s[16:19], s46 offen lds
    s_add_u32 m0, s45, 74752
    s_add_u32 s46, s41, 53248
    buffer_load_dwordx4 v15, s[16:19], s46 offen lds
    s_add_u32 m0, s44, 41984
    s_add_u32 s46, s40, 16384
    buffer_load_dwordx4 v13, s[12:15], s46 offen lds
    s_add_u32 m0, s44, 43008
    s_add_u32 s46, s40, 32768
    buffer_load_dwordx4 v12, s[12:15], s46 offen lds
    s_add_u32 m0, s44, 44032
    s_add_u32 s46, s40, 49152
    buffer_load_dwordx4 v13, s[12:15], s46 offen lds
    s_mov_b32 s20, s8
    s_mov_b32 s21, s9
    s_mov_b32 s22, 0x200000
    s_mov_b32 s23, 0x00020000
    s_lshl_b32 s50, s2, 13
    s_lshl_b32 s51, s3, 11
    s_add_u32 s50, s50, s51
    v_lshlrev_b32 v104, 7, v0
    s_mov_b64 exec, 0xffff
    buffer_load_dword v112, v104, s[20:23], s50 offen
    s_mov_b64 exec, -1

    s_waitcnt vmcnt(21)
    s_barrier
    s_bfe_u32 s40, s49, 0x40008
    s_bitcmp1_b32 s40, 3
    s_cselect_b32 s41, s39, s42
    s_xor_b32 s40, s40, s41
    s_mul_i32 s41, s40, 393216
    s_add_u32 s41, s41, s38
    s_lshl_b32 s40, s40, 7
    s_add_u32 s40, s40, s36
    s_add_u32 m0, s44, 81920
    s_add_u32 s46, s40, 0
    buffer_load_dwordx4 v12, s[12:15], s46 offen lds
    s_add_u32 m0, s45, 106496
    s_add_u32 s46, s41, 2048
    buffer_load_dwordx4 v14, s[16:19], s46 offen lds
    s_add_u32 m0, s45, 107520
    s_add_u32 s46, s41, 51200
    buffer_load_dwordx4 v15, s[16:19], s46 offen lds
    s_add_u32 m0, s45, 98304
    s_add_u32 s46, s41, 0
    s_add_u32 s46, s46, s47
    buffer_load_dwordx4 v14, s[16:19], s46 offen lds
    s_add_u32 m0, s45, 99328
    s_add_u32 s46, s41, 49152
    s_add_u32 s46, s46, s47
    s_nop 0
    buffer_load_dwordx4 v15, s[16:19], s46 offen lds
    s_add_u32 m0, s45, 114688
    s_add_u32 s46, s41, 4096
    buffer_load_dwordx4 v14, s[16:19], s46 offen lds
    s_add_u32 m0, s45, 115712
    s_add_u32 s46, s41, 53248
    buffer_load_dwordx4 v15, s[16:19], s46 offen lds
    s_add_u32 m0, s44, 82944
    s_add_u32 s46, s40, 16384
    buffer_load_dwordx4 v13, s[12:15], s46 offen lds
    s_add_u32 m0, s44, 83968
    s_add_u32 s46, s40, 32768
    buffer_load_dwordx4 v12, s[12:15], s46 offen lds
    s_add_u32 m0, s44, 84992
    s_add_u32 s46, s40, 49152
    buffer_load_dwordx4 v13, s[12:15], s46 offen lds
    s_waitcnt vmcnt(21)
    s_barrier
    s_bfe_u32 s40, s49, 0x4000c
    s_bitcmp1_b32 s40, 3
    s_cselect_b32 s41, s39, s42
    s_xor_b32 s40, s40, s41
    s_mul_i32 s41, s40, 393216
    s_add_u32 s41, s41, s38
    s_lshl_b32 s40, s40, 7
    s_add_u32 s40, s40, s36
    s_add_u32 m0, s44, 122880
    s_add_u32 s46, s40, 0
    s_nop 0
    buffer_load_dwordx4 v12, s[12:15], s46 offen lds
    s_add_u32 m0, s45, 147456
    s_add_u32 s46, s41, 2048
    buffer_load_dwordx4 v14, s[16:19], s46 offen lds
    s_add_u32 m0, s45, 148480
    s_add_u32 s46, s41, 51200
    buffer_load_dwordx4 v15, s[16:19], s46 offen lds
W_5:
    s_cbranch_execz R_5
    s_nop 0
    s_add_u32 m0, s45, 139264
    s_add_u32 s46, s41, 0
    s_add_u32 s46, s46, s47
    buffer_load_dwordx4 v14, s[16:19], s46 offen lds
    s_add_u32 m0, s45, 140288
    s_add_u32 s46, s41, 49152
    s_add_u32 s46, s46, s47
    s_nop 0
    buffer_load_dwordx4 v15, s[16:19], s46 offen lds
    s_add_u32 m0, s45, 155648
    s_add_u32 s46, s41, 4096
    buffer_load_dwordx4 v14, s[16:19], s46 offen lds
    s_add_u32 m0, s45, 156672
    s_add_u32 s46, s41, 53248
    buffer_load_dwordx4 v15, s[16:19], s46 offen lds
    s_add_u32 m0, s44, 123904
    s_add_u32 s46, s40, 16384
    buffer_load_dwordx4 v13, s[12:15], s46 offen lds
    s_add_u32 m0, s44, 124928
    s_add_u32 s46, s40, 32768
    buffer_load_dwordx4 v12, s[12:15], s46 offen lds
    s_add_u32 m0, s44, 125952
    s_add_u32 s46, s40, 49152
    buffer_load_dwordx4 v13, s[12:15], s46 offen lds
    s_waitcnt vmcnt(21)
    s_barrier
    s_bfe_u32 s40, s49, 0x40010
    s_bitcmp1_b32 s40, 3
    s_cselect_b32 s41, s39, s42
    s_xor_b32 s40, s40, s41
    s_mul_i32 s41, s40, 393216
    s_add_u32 s41, s41, s38
    s_lshl_b32 s40, s40, 7
    s_add_u32 s40, s40, s36
    s_add_u32 m0, s44, 0
    s_add_u32 s46, s40, 0
    buffer_load_dwordx4 v12, s[12:15], s46 offen lds
    s_add_u32 m0, s45, 24576
    s_add_u32 s46, s41, 2048
    buffer_load_dwordx4 v14, s[16:19], s46 offen lds
    s_add_u32 m0, s45, 25600
    s_add_u32 s46, s41, 51200
    buffer_load_dwordx4 v15, s[16:19], s46 offen lds
    s_add_u32 m0, s45, 16384
    s_add_u32 s46, s41, 0
    s_add_u32 s46, s46, s47
    buffer_load_dwordx4 v14, s[16:19], s46 offen lds
    s_add_u32 m0, s45, 17408
    s_add_u32 s46, s41, 49152
    s_add_u32 s46, s46, s47
    s_nop 0
    buffer_load_dwordx4 v15, s[16:19], s46 offen lds
    s_add_u32 m0, s45, 32768
    s_add_u32 s46, s41, 4096
    buffer_load_dwordx4 v14, s[16:19], s46 offen lds
    s_add_u32 m0, s45, 33792
    s_add_u32 s46, s41, 53248
    buffer_load_dwordx4 v15, s[16:19], s46 offen lds
    s_add_u32 m0, s44, 1024
    s_add_u32 s46, s40, 16384
    buffer_load_dwordx4 v13, s[12:15], s46 offen lds
    s_add_u32 m0, s44, 2048
    s_add_u32 s46, s40, 32768
    buffer_load_dwordx4 v12, s[12:15], s46 offen lds
    s_add_u32 m0, s44, 3072
    s_add_u32 s46, s40, 49152
    buffer_load_dwordx4 v13, s[12:15], s46 offen lds
    s_waitcnt vmcnt(20)
    s_barrier
    s_bfe_u32 s40, s49, 0x40014
    s_bitcmp1_b32 s40, 3
    s_cselect_b32 s41, s39, s42
    s_xor_b32 s40, s40, s41
    s_mul_i32 s41, s40, 393216
    s_add_u32 s41, s41, s38
    s_lshl_b32 s40, s40, 7
    s_add_u32 s40, s40, s36
    s_add_u32 m0, s44, 40960
    s_add_u32 s46, s40, 0
    s_nop 0
    buffer_load_dwordx4 v12, s[12:15], s46 offen lds
    s_add_u32 m0, s45, 65536
    s_add_u32 s46, s41, 2048
    buffer_load_dwordx4 v14, s[16:19], s46 offen lds
    s_add_u32 m0, s45, 66560
    s_add_u32 s46, s41, 51200
    buffer_load_dwordx4 v15, s[16:19], s46 offen lds
    s_add_u32 m0, s45, 57344
    s_add_u32 s46, s41, 0
    s_add_u32 s46, s46, s47
    buffer_load_dwordx4 v14, s[16:19], s46 offen lds
    s_add_u32 m0, s45, 58368
    s_add_u32 s46, s41, 49152
    s_add_u32 s46, s46, s47
    s_nop 0
    buffer_load_dwordx4 v15, s[16:19], s46 offen lds
    s_add_u32 m0, s45, 73728
    s_add_u32 s46, s41, 4096
    buffer_load_dwordx4 v14, s[16:19], s46 offen lds
    s_add_u32 m0, s45, 74752
    s_add_u32 s46, s41, 53248
    buffer_load_dwordx4 v15, s[16:19], s46 offen lds
    s_add_u32 m0, s44, 41984
    s_add_u32 s46, s40, 16384
    buffer_load_dwordx4 v13, s[12:15], s46 offen lds
    s_add_u32 m0, s44, 43008
    s_add_u32 s46, s40, 32768
    buffer_load_dwordx4 v12, s[12:15], s46 offen lds
    s_add_u32 m0, s44, 44032
    s_add_u32 s46, s40, 49152
    buffer_load_dwordx4 v13, s[12:15], s46 offen lds
    v_lshlrev_b32_e64 v10, 4, v0
    s_add_u32 s68, s72, 0x900000
    s_addc_u32 s69, s73, 0
    s_mov_b32 s70, 0x18000
    s_mov_b32 s71, 0x00020000
    s_lshl_b32 s52, s32, 11
    s_add_u32 s52, s52, 65536
    s_lshl_b32 s76, s3, 2
    s_add_u32 s52, s52, s76
    s_lshl_b32 s76, s3, 9
    s_add_u32 s58, s76, 24832

    s_waitcnt vmcnt(20)
    s_barrier
    s_bfe_u32 s40, s49, 0x40018
    s_bitcmp1_b32 s40, 3
    s_cselect_b32 s41, s39, s42
    s_xor_b32 s40, s40, s41
    s_mul_i32 s41, s40, 393216
    s_add_u32 s41, s41, s38
    s_lshl_b32 s40, s40, 7
    s_add_u32 s40, s40, s36
    s_add_u32 m0, s44, 81920
    s_add_u32 s46, s40, 0
    buffer_load_dwordx4 v12, s[12:15], s46 offen lds
    s_add_u32 m0, s45, 106496
    s_add_u32 s46, s41, 2048
    buffer_load_dwordx4 v14, s[16:19], s46 offen lds
    s_add_u32 m0, s45, 107520
    s_add_u32 s46, s41, 51200
    buffer_load_dwordx4 v15, s[16:19], s46 offen lds
    s_add_u32 m0, s45, 98304
    s_add_u32 s46, s41, 0
    s_add_u32 s46, s46, s47
    buffer_load_dwordx4 v14, s[16:19], s46 offen lds
    s_add_u32 m0, s45, 99328
    s_add_u32 s46, s41, 49152
    s_add_u32 s46, s46, s47
    s_nop 0
    buffer_load_dwordx4 v15, s[16:19], s46 offen lds
    s_add_u32 m0, s45, 114688
    s_add_u32 s46, s41, 4096
    buffer_load_dwordx4 v14, s[16:19], s46 offen lds
    s_add_u32 m0, s45, 115712
    s_add_u32 s46, s41, 53248
    buffer_load_dwordx4 v15, s[16:19], s46 offen lds
    s_add_u32 m0, s44, 82944
    s_add_u32 s46, s40, 16384
    buffer_load_dwordx4 v13, s[12:15], s46 offen lds
    s_add_u32 m0, s44, 83968
    s_add_u32 s46, s40, 32768
    buffer_load_dwordx4 v12, s[12:15], s46 offen lds
    s_add_u32 m0, s44, 84992
    s_add_u32 s46, s40, 49152
    buffer_load_dwordx4 v13, s[12:15], s46 offen lds
    s_add_u32 s84, s72, 0xb00000
    s_addc_u32 s85, s73, 0
    s_mov_b32 s86, 0x30000
    s_mov_b32 s87, 0x00020000
    v_bfe_u32 v113, v0, 2, 2
    v_min_u32 v113, 2, v113
    v_lshlrev_b32 v114, 8, v113
    v_lshlrev_b32 v113, 12, v113
    v_and_b32 v112, 3, v0
    v_lshl_add_u32 v113, v112, 4, v113
    v_lshl_add_u32 v114, v112, 4, v114
    v_lshrrev_b32 v112, 4, v0
    v_mul_u32_u24 v112, 12288, v112
    v_add_u32 v113, v113, v112
    s_lshl_b32 s76, s3, 6
    s_lshl_b32 s53, s33, 8
    s_add_u32 s53, s53, s76
    s_add_u32 s76, s76, 26368
    v_add_u32 v114, s76, v114

    s_waitcnt vmcnt(20)
    s_barrier
    s_bfe_u32 s40, s49, 0x4001c
    s_bitcmp1_b32 s40, 3
    s_cselect_b32 s41, s39, s42
    s_xor_b32 s40, s40, s41
    s_mul_i32 s41, s40, 393216
    s_add_u32 s41, s41, s38
    s_lshl_b32 s40, s40, 7
    s_add_u32 s40, s40, s36
    s_add_u32 m0, s44, 122880
    s_add_u32 s46, s40, 0
    buffer_load_dwordx4 v12, s[12:15], s46 offen lds
    s_add_u32 m0, s45, 147456
    s_add_u32 s46, s41, 2048
    buffer_load_dwordx4 v14, s[16:19], s46 offen lds
    s_add_u32 m0, s45, 148480
    s_add_u32 s46, s41, 51200
    buffer_load_dwordx4 v15, s[16:19], s46 offen lds
    s_add_u32 m0, s45, 139264
    s_add_u32 s46, s41, 0
    s_add_u32 s46, s46, s47
    buffer_load_dwordx4 v14, s[16:19], s46 offen lds
    s_add_u32 m0, s45, 140288
    s_add_u32 s46, s41, 49152
    s_add_u32 s46, s46, s47
    s_nop 0
    buffer_load_dwordx4 v15, s[16:19], s46 offen lds
    s_add_u32 m0, s45, 155648
    s_add_u32 s46, s41, 4096
    buffer_load_dwordx4 v14, s[16:19], s46 offen lds
    s_add_u32 m0, s45, 156672
    s_add_u32 s46, s41, 53248
    buffer_load_dwordx4 v15, s[16:19], s46 offen lds
    s_add_u32 m0, s44, 123904
    s_add_u32 s46, s40, 16384
    buffer_load_dwordx4 v13, s[12:15], s46 offen lds
    s_add_u32 m0, s44, 124928
    s_add_u32 s46, s40, 32768
    buffer_load_dwordx4 v12, s[12:15], s46 offen lds
    s_add_u32 m0, s44, 125952
    s_add_u32 s46, s40, 49152
    buffer_load_dwordx4 v13, s[12:15], s46 offen lds
    s_add_u32 s76, s53, 0
    s_nop 0
    buffer_load_dwordx4 v[72:75], v113, s[84:87], s76 offen sc0 sc1
    s_add_u32 s76, s53, 49152
    buffer_load_dwordx4 v[76:79], v113, s[84:87], s76 offen sc0 sc1
    s_add_u32 s76, s53, 98304
    buffer_load_dwordx4 v[80:83], v113, s[84:87], s76 offen sc0 sc1
    s_add_u32 s76, s53, 147456
    buffer_load_dwordx4 v[84:87], v113, s[84:87], s76 offen sc0 sc1
    s_mov_b32 m0, s58
    s_setprio 3
    s_waitcnt vmcnt(24)
    s_barrier
    s_cmp_eq_u32 s3, 3
    s_cbranch_scc1 F_d0
    buffer_load_dword v10, s[68:71], s52 offen sc0 sc1 lds
    s_add_u32 m0, m0, 256
    s_add_u32 s52, s52, 1024
    buffer_load_dword v10, s[68:71], s52 offen sc0 sc1 lds
    s_branch F_d1
F_d0:
    s_nop 0
    s_mov_b32 m0, 24576
    s_mov_b32 s52, 0x7ff00000
    s_mov_b64 exec, 0xfff
    buffer_load_dwordx4 v10, s[84:87], s52 offen lds
    buffer_load_dwordx4 v10, s[84:87], s52 offen lds
    s_mov_b64 exec, -1
F_d1:

    s_setprio 0
    s_waitcnt vmcnt(16)
    s_barrier
    s_waitcnt vmcnt(2)
F_cs0:
    v_min3_u32 v96, v72, v76, v80
    v_min_u32 v96, v96, v84
    v_cmp_eq_u32 vcc, 0, v96
    s_cbranch_vccz F_cs1
    s_sleep 8

    s_add_u32 s76, s53, 0
    buffer_load_dwordx4 v[72:75], v113, s[84:87], s76 offen sc0 sc1
    s_add_u32 s76, s53, 49152
    buffer_load_dwordx4 v[76:79], v113, s[84:87], s76 offen sc0 sc1
    s_add_u32 s76, s53, 98304
    buffer_load_dwordx4 v[80:83], v113, s[84:87], s76 offen sc0 sc1
    s_add_u32 s76, s53, 147456
    buffer_load_dwordx4 v[84:87], v113, s[84:87], s76 offen sc0 sc1
    s_waitcnt vmcnt(0)
    s_branch F_cs0
F_cs1:
    v_add_f32 v72, v72, v76
    v_add_f32 v80, v80, v84
    v_add_f32 v73, v73, v77
    v_add_f32 v81, v81, v85
    v_add_f32 v74, v74, v78
    v_add_f32 v82, v82, v86
    v_add_f32 v75, v75, v79
    v_add_f32 v83, v83, v87
    v_add_f32 v72, v72, v80
    v_add_f32 v73, v73, v81
    v_add_f32 v74, v74, v82
    v_add_f32 v75, v75, v83
    v_mov_b32 v76, v72
    v_mov_b32 v77, v73
    v_mov_b32 v78, v74
    v_mov_b32 v79, v75
    v_permlane32_swap_b32 v72, v76
    v_permlane32_swap_b32 v73, v77
    v_permlane32_swap_b32 v74, v78
    v_permlane32_swap_b32 v75, v79
    v_add_f32 v72, v72, v76
    v_add_f32 v73, v73, v77
    v_add_f32 v74, v74, v78
    v_add_f32 v75, v75, v79
    v_mov_b32 v76, v72
    v_mov_b32 v77, v73
    v_mov_b32 v78, v74
    v_mov_b32 v79, v75
    v_permlane16_swap_b32 v72, v76
    v_permlane16_swap_b32 v73, v77
    v_permlane16_swap_b32 v74, v78
    v_permlane16_swap_b32 v75, v79
    v_add_f32 v72, v72, v76
    v_add_f32 v73, v73, v77
    v_add_f32 v74, v74, v78
    v_add_f32 v75, v75, v79
    s_mov_b64 exec, 0xfff
    ds_write_b128 v114, v[72:75]
    s_mov_b64 exec, -1
    s_waitcnt lgkmcnt(0)

    s_waitcnt vmcnt(0)
    s_barrier
    s_add_u32 s24, s72, 0x800000
    s_addc_u32 s25, s73, 0
    s_mov_b32 s26, 0x100000
    s_mov_b32 s27, 0x00020000
    s_add_u32 s12, s72, 0x400000
    s_addc_u32 s13, s73, 0
    s_mov_b32 s14, 0x400000
    s_mov_b32 s15, 0x00020000
    s_mov_b32 s16, s8
    s_mov_b32 s17, s9
    s_mov_b32 s18, 0x200000
    s_mov_b32 s19, 0x00020000
    v_lshrrev_b32 v4, 4, v0
    v_and_b32 v3, 15, v0
    v_lshlrev_b32 v6, 1, v4
    v_xor_b32 v8, v3, v6
    v_xor_b32 v9, 8, v8
    v_lshlrev_b32 v8, 4, v8
    v_lshlrev_b32 v9, 4, v9
    v_lshl_add_u32 v8, v4, 11, v8
    v_lshl_add_u32 v9, v4, 11, v9
    s_lshl_b32 s38, s29, 8
    s_lshl_b32 s45, s3, 15
    s_add_u32 s38, s38, s45
    s_lshl_b32 s45, s3, 12
    s_mul_i32 s39, s35, 4
    s_mul_i32 s40, s34, 0
    s_add_u32 s39, s39, s40
    s_and_b32 s59, s34, 3

    s_lshr_b32 s36, s3, 1
    s_and_b32 s37, s3, 1
    s_lshl_b32 s43, s36, 6
    s_lshl_b32 s42, s33, 1
    s_add_u32 s42, s42, s37
    s_mul_i32 s82, s42, 4224
    s_add_u32 s83, s82, 4096
    s_add_u32 s83, s83, s43
    s_lshl_b32 s44, s36, 11
    s_add_u32 s82, s82, s44
    s_mul_i32 s51, s42, 16*64
    s_add_u32 s51, s51, 192512
    s_lshl_b32 s42, s10, 1
    s_add_u32 s42, s42, s37
    s_lshl_b32 s50, s42, 4
    s_add_u32 s50, s50, s32
    s_lshl_b32 s50, s50, 6
    v_lshlrev_b32 v10, 4, v0
    v_lshlrev_b32 v11, 2, v0
    s_lshl_b32 s42, s3, 2
    s_add_u32 s42, s42, 24640
    v_mov_b32 v1, s42
    v_and_b32 v2, 3, v0
    v_lshlrev_b32 v2, 2, v2
    v_add_u32 v2, 24640, v2
    v_and_b32 v105, 1, v0
    v_lshlrev_b32 v105, 3, v105
    s_lshl_b32 s42, s37, 2
    s_add_u32 s42, s42, 24640
    v_add_u32 v105, s42, v105
    s_lshl_b32 s42, s37, 12
    s_add_u32 s42, s42, s44
    s_add_u32 s42, s42, 65536
    v_add_u32 v106, s42, v11
    s_lshl_b32 s42, s37, 7
    s_add_u32 s42, s42, s43
    s_add_u32 s42, s42, 27136
    v_add_u32 v107, s42, v11
    v_mul_u32_u24 v108, 64*16/4, v0
    v_mov_b32 v109, 1
    s_mov_b32 s60, 0
    s_mov_b32 s62, 0xa001024
    s_mov_b32 s63, 0x1a1e14
    s_lshl_b32 s36, s28, 2
    s_add_u32 s36, s36, s3
    s_lshl_b32 s36, s36, 15
    s_lshl_b32 s44, s3, 11
    s_lshl_b32 s50, s28, 3
    s_and_b32 s76, s29, 4-1
    s_mul_i32 s76, s76, 8/4
    s_add_u32 s50, s50, s76
    s_mul_i32 s50, s50, 64
    s_add_u32 s78, s50, 0x837000
    s_add_u32 s78, s72, s78
    s_addc_u32 s79, s73, 0
    s_setprio 3
    s_sleep 10
    s_lshr_b32 s56, s3, 1
    s_add_u32 s56, s56, 1
    ds_read_b32 v114, v105
FW_5:
    s_waitcnt lgkmcnt(0)
    v_cmp_gt_u32 vcc, s56, v114
    s_cbranch_vccz FO_6
    s_sleep 1
    ds_read_b32 v114, v105
    s_branch FW_5
FO_6:
    ds_read2st64_b32 v[12:13], v106 offset0:0 offset1:1
    ds_read2st64_b32 v[20:21], v106 offset0:32 offset1:33
    ds_read2st64_b32 v[14:15], v106 offset0:2 offset1:3
    ds_read2st64_b32 v[22:23], v106 offset0:34 offset1:35
    ds_read2st64_b32 v[16:17], v106 offset0:4 offset1:5
    ds_read2st64_b32 v[24:25], v106 offset0:36 offset1:37
    ds_read2st64_b32 v[18:19], v106 offset0:6 offset1:7
    ds_read2st64_b32 v[26:27], v106 offset0:38 offset1:39
    ds_read2st64_b32 v[28:29], v107 offset0:0 offset1:1
    s_waitcnt lgkmcnt(7)
    v_add_f32 v12, v12, v20
    buffer_atomic_add_f32 v12, v11, s[24:27], s82 offen offset:0
    v_add_f32 v13, v13, v21
    buffer_atomic_add_f32 v13, v11, s[24:27], s82 offen offset:256
    s_waitcnt lgkmcnt(5)
    v_add_f32 v14, v14, v22
    buffer_atomic_add_f32 v14, v11, s[24:27], s82 offen offset:512
    v_add_f32 v15, v15, v23
    buffer_atomic_add_f32 v15, v11, s[24:27], s82 offen offset:768
    s_waitcnt lgkmcnt(3)
    v_add_f32 v16, v16, v24
    buffer_atomic_add_f32 v16, v11, s[24:27], s82 offen offset:1024
    v_add_f32 v17, v17, v25
    buffer_atomic_add_f32 v17, v11, s[24:27], s82 offen offset:1280
    s_waitcnt lgkmcnt(1)
    v_add_f32 v18, v18, v26
    buffer_atomic_add_f32 v18, v11, s[24:27], s82 offen offset:1536
    v_add_f32 v19, v19, v27
    buffer_atomic_add_f32 v19, v11, s[24:27], s82 offen offset:1792
    s_waitcnt lgkmcnt(0)
    v_add_f32 v28, v28, v29
    s_mov_b64 exec, 0xffff
    buffer_atomic_add_f32 v28, v11, s[24:27], s83 offen
    s_mov_b64 exec, -1
    v_mov_b32 v113, 1
    s_mov_b64 exec, 1
    ds_write_b32 v1, v113 offset:32
    s_mov_b64 exec, -1
    s_add_u32 s54, s51, 0x800000
    s_add_u32 s54, s72, s54
    s_addc_u32 s55, s73, 0
    s_mov_b32 s57, 1
    s_waitcnt vmcnt(4)
    ds_read2_b32 v[102:103], v2 offset0:0 offset1:8
    ds_read_b32 v104, v2 offset:16
    s_waitcnt lgkmcnt(0)
    v_cmp_ne_u32 vcc, 3, v102
    v_cmp_eq_u32 s[42:43], 0, v103
    s_nop 0
    s_or_b64 vcc, vcc, s[42:43]
    v_cmp_gt_u32 s[42:43], 2, v104
    s_nop 0
    s_or_b64 vcc, vcc, s[42:43]
    s_waitcnt vmcnt(0)
    s_atomic_add s57, s[54:55], 0
    s_atomic_add s57, s[54:55], 256
    s_atomic_add s57, s[54:55], 512
    s_atomic_add s57, s[54:55], 768
    s_cbranch_vccnz F_pe
    s_add_u32 s41, s39, 0
    s_and_b32 s41, s41, 15
    s_xor_b32 s41, s41, s59
    s_lshl_b32 s41, s41, 17
    s_add_u32 s41, s41, s38
    s_add_u32 m0, s45, 147456
    s_add_u32 s76, s41, 0
    buffer_load_dwordx4 v8, s[16:19], s76 offen lds
    s_add_u32 m0, s45, 148480
    s_add_u32 s76, s41, 8192
    buffer_load_dwordx4 v9, s[16:19], s76 offen lds
    s_add_u32 m0, s45, 149504
    s_add_u32 s76, s41, 16384
    buffer_load_dwordx4 v8, s[16:19], s76 offen lds
    s_add_u32 m0, s45, 150528
    s_add_u32 s76, s41, 24576
    buffer_load_dwordx4 v9, s[16:19], s76 offen lds
    s_add_u32 s41, s39, 1
    s_and_b32 s41, s41, 15
    s_xor_b32 s41, s41, s59
    s_lshl_b32 s41, s41, 17
    s_add_u32 s41, s41, s38
    s_add_u32 m0, s45, 65536
    s_add_u32 s76, s41, 0
    buffer_load_dwordx4 v8, s[16:19], s76 offen lds
    s_add_u32 m0, s45, 66560
    s_add_u32 s76, s41, 8192
    buffer_load_dwordx4 v9, s[16:19], s76 offen lds
    s_add_u32 m0, s45, 67584
    s_add_u32 s76, s41, 16384
    buffer_load_dwordx4 v8, s[16:19], s76 offen lds
    s_add_u32 m0, s45, 68608
    s_add_u32 s76, s41, 24576
    buffer_load_dwordx4 v9, s[16:19], s76 offen lds
    s_add_u32 s41, s39, 2
    s_and_b32 s41, s41, 15
    s_xor_b32 s41, s41, s59
    s_lshl_b32 s41, s41, 17
    s_add_u32 s41, s41, s38
    s_add_u32 m0, s45, 0
    s_add_u32 s76, s41, 0
    s_nop 0
    buffer_load_dwordx4 v8, s[16:19], s76 offen lds
    s_add_u32 m0, s45, 1024
    s_add_u32 s76, s41, 8192
    buffer_load_dwordx4 v9, s[16:19], s76 offen lds
    s_add_u32 m0, s45, 2048
    s_add_u32 s76, s41, 16384
    buffer_load_dwordx4 v8, s[16:19], s76 offen lds
    s_add_u32 m0, s45, 3072
    s_add_u32 s76, s41, 24576
    buffer_load_dwordx4 v9, s[16:19], s76 offen lds
    s_mov_b32 s60, 3
F_pe:
    s_setprio 1
F_pr0:
    s_waitcnt vmcnt(8)
    ds_read2_b32 v[102:103], v2 offset0:0 offset1:8
    s_cmp_lt_u32 s60, 2
    s_cselect_b32 s61, 1, 3
    s_waitcnt lgkmcnt(0)
    v_cmp_le_u32 vcc, 4, v102
    s_cbranch_vccz F_pr3
    s_mov_b32 s61, 5
F_pr3:
    v_cmp_gt_u32 vcc, s61, v102
    v_cmp_gt_u32 s[42:43], 1, v103
    s_nop 0
    s_or_b64 vcc, vcc, s[42:43]
    s_cbranch_vccz F_pr2
    s_sleep 2
    s_branch F_pr0
F_pr2:
    s_cmp_lt_u32 s60, 6
    s_cbranch_scc1 F_pr4
    ds_read_b32 v102, v2 offset:16
    s_waitcnt lgkmcnt(0)
    v_cmp_gt_u32 vcc, 2, v102
    s_cbranch_vccz F_pr4
    s_sleep 2
    s_branch F_pr0
F_pr4:
    s_cmp_lg_u32 s60, 3
    s_cbranch_scc1 F_pr6
    s_waitcnt vmcnt(4)
    v_mov_b32 v113, 2
    s_mov_b64 exec, 1
    ds_write_b32 v1, v113 offset:32
    s_mov_b64 exec, -1
F_pr6:
    s_add_u32 s41, s39, s60
    s_and_b32 s41, s41, 15
    s_xor_b32 s41, s41, s59
    s_lshl_b32 s41, s41, 17
    s_add_u32 s41, s41, s38
    s_lshl_b32 s76, s60, 3
    s_lshr_b64 s[42:43], s[62:63], s76
    s_and_b32 s42, s42, 0xff
    s_lshl_b32 s42, s42, 12
    s_add_u32 m0, s42, s45
    s_add_u32 s60, s60, 1
    buffer_load_dwordx4 v8, s[16:19], s41 offen lds
    s_add_u32 m0, m0, 1024
    s_add_u32 s41, s41, 8192
    buffer_load_dwordx4 v9, s[16:19], s41 offen lds
    s_add_u32 m0, m0, 1024
    s_add_u32 s41, s41, 8192
    buffer_load_dwordx4 v8, s[16:19], s41 offen lds
    s_add_u32 m0, m0, 1024
    s_add_u32 s41, s41, 8192
    buffer_load_dwordx4 v9, s[16:19], s41 offen lds
    s_cmp_ge_u32 s60, 7
    s_cbranch_scc1 F_pr1
    s_cmp_eq_u32 s61, 5
    s_cbranch_scc1 F_pr2
    s_branch F_pr0
F_pr1:
    s_cmp_lg_u32 s3, 0
    s_cbranch_scc1 F_l4
SP_7:
    s_load_dword s58, s[78:79], 0 glc
    s_waitcnt lgkmcnt(0)
    s_cmp_ge_u32 s58, 32
    s_cbranch_scc1 SD_8
    s_sleep 1
    s_branch SP_7
SD_8:
F_l6:
    v_mov_b32 v113, 3
    s_mov_b64 exec, 1
    ds_write_b32 v1, v113 offset:112
    s_mov_b64 exec, -1
    s_branch F_l5
F_l4:
    v_mov_b32 v4, 24752
    ds_read_b32 v13, v4
FW_9:
    s_waitcnt lgkmcnt(0)
    v_cmp_gt_u32 vcc, 3, v13
    s_cbranch_vccz FO_10
    s_sleep 1
    ds_read_b32 v13, v4
    s_branch FW_9
FO_10:
F_l5:
    s_add_u32 s40, s39, 0
    s_and_b32 s40, s40, 15
    s_xor_b32 s40, s40, s59
    s_lshl_b32 s40, s40, 11
    s_add_u32 s40, s40, s36
    s_add_u32 m0, s44, 16384
    s_nop 0
    buffer_load_dwordx4 v10, s[12:15], s40 offen offset:0 sc1 lds
    s_add_u32 m0, s44, 16384
    s_nop 0
    buffer_load_dwordx4 v10, s[12:15], s40 offen offset:1024 sc1 lds
    s_add_u32 s40, s39, 1
    s_and_b32 s40, s40, 15
    s_xor_b32 s40, s40, s59
    s_lshl_b32 s40, s40, 11
    s_add_u32 s40, s40, s36
    s_add_u32 m0, s44, 98304
    s_nop 0
    buffer_load_dwordx4 v10, s[12:15], s40 offen offset:0 sc1 lds
    s_add_u32 m0, s44, 98304
    s_nop 0
    buffer_load_dwordx4 v10, s[12:15], s40 offen offset:1024 sc1 lds
    s_add_u32 s40, s39, 2
    s_and_b32 s40, s40, 15
    s_xor_b32 s40, s40, s59
    s_lshl_b32 s40, s40, 11
    s_add_u32 s40, s40, s36
    s_add_u32 m0, s44, 139264
    s_nop 0
    buffer_load_dwordx4 v10, s[12:15], s40 offen offset:0 sc1 lds
    s_add_u32 m0, s44, 139264
    s_nop 0
    buffer_load_dwordx4 v10, s[12:15], s40 offen offset:1024 sc1 lds
    ds_read_b32 v102, v2
FW_11:
    s_waitcnt lgkmcnt(0)
    v_cmp_gt_u32_e64 vcc, 6, v102
    s_cbranch_vccz FO_12
    s_sleep 1
    ds_read_b32 v102, v2
    s_branch FW_11
FO_12:
    s_add_u32 s41, s39, 7
    s_and_b32 s41, s41, 15
    s_xor_b32 s41, s41, s59
    s_lshl_b32 s41, s41, 17
    s_add_u32 s41, s41, s38
    s_add_u32 m0, s45, 147456
    s_add_u32 s76, s41, 0
    buffer_load_dwordx4 v8, s[16:19], s76 offen lds
    s_add_u32 m0, s45, 148480
    s_add_u32 s76, s41, 8192
    buffer_load_dwordx4 v9, s[16:19], s76 offen lds
    s_add_u32 m0, s45, 149504
    s_add_u32 s76, s41, 16384
    buffer_load_dwordx4 v8, s[16:19], s76 offen lds
    s_add_u32 m0, s45, 150528
    s_add_u32 s76, s41, 24576
    buffer_load_dwordx4 v9, s[16:19], s76 offen lds
    s_waitcnt vmcnt(8)
    s_barrier
    s_add_u32 s40, s39, 3
    s_and_b32 s40, s40, 15
    s_xor_b32 s40, s40, s59
    s_lshl_b32 s40, s40, 11
    s_add_u32 s40, s40, s36
    s_add_u32 m0, s44, 57344
    s_nop 0
    buffer_load_dwordx4 v10, s[12:15], s40 offen offset:0 sc1 lds
    s_add_u32 m0, s44, 57344
    s_nop 0
    buffer_load_dwordx4 v10, s[12:15], s40 offen offset:1024 sc1 lds
    s_add_u32 s41, s39, 8
    s_and_b32 s41, s41, 15
    s_xor_b32 s41, s41, s59
    s_lshl_b32 s41, s41, 17
    s_add_u32 s41, s41, s38
    s_add_u32 m0, s45, 65536
    s_add_u32 s76, s41, 0
    s_nop 0
    buffer_load_dwordx4 v8, s[16:19], s76 offen lds
    s_add_u32 m0, s45, 66560
    s_add_u32 s76, s41, 8192
    buffer_load_dwordx4 v9, s[16:19], s76 offen lds
    s_add_u32 m0, s45, 67584
    s_add_u32 s76, s41, 16384
    buffer_load_dwordx4 v8, s[16:19], s76 offen lds
    s_setprio 0
    s_waitcnt vmcnt(11)
    s_barrier
    s_add_u32 s40, s39, 4
    s_and_b32 s40, s40, 15
    s_xor_b32 s40, s40, s59
    s_lshl_b32 s40, s40, 11
    s_add_u32 s40, s40, s36
    s_add_u32 m0, s44, 16384
    s_nop 0
    buffer_load_dwordx4 v10, s[12:15], s40 offen offset:0 sc1 lds
    s_add_u32 m0, s44, 16384
W_6:
    s_cbranch_execz R_6
    s_nop 0
    s_nop 0
    buffer_load_dwordx4 v10, s[12:15], s40 offen offset:1024 sc1 lds
    s_add_u32 m0, s45, 68608
    s_add_u32 s76, s41, 24576
    buffer_load_dwordx4 v9, s[16:19], s76 offen lds
    s_waitcnt vmcnt(12)
    s_barrier
    s_add_u32 s40, s39, 5
    s_and_b32 s40, s40, 15
    s_xor_b32 s40, s40, s59
    s_lshl_b32 s40, s40, 11
    s_add_u32 s40, s40, s36
    s_add_u32 m0, s44, 98304
    s_nop 0
    buffer_load_dwordx4 v10, s[12:15], s40 offen offset:0 sc1 lds
    s_add_u32 m0, s44, 98304
    s_nop 0
    buffer_load_dwordx4 v10, s[12:15], s40 offen offset:1024 sc1 lds
    s_waitcnt vmcnt(8)
    s_barrier
    s_add_u32 s40, s39, 6
    s_and_b32 s40, s40, 15
    s_xor_b32 s40, s40, s59
    s_lshl_b32 s40, s40, 11
    s_add_u32 s40, s40, s36
    s_add_u32 m0, s44, 139264
    s_nop 0
    buffer_load_dwordx4 v10, s[12:15], s40 offen offset:0 sc1 lds
    s_add_u32 m0, s44, 139264
    s_nop 0
    buffer_load_dwordx4 v10, s[12:15], s40 offen offset:1024 sc1 lds
    s_add_u32 s41, s39, 9
    s_and_b32 s41, s41, 15
    s_xor_b32 s41, s41, s59
    s_lshl_b32 s41, s41, 17
    s_add_u32 s41, s41, s38
    s_add_u32 m0, s45, 0
    s_add_u32 s76, s41, 0
    s_nop 0
    buffer_load_dwordx4 v8, s[16:19], s76 offen lds
    s_add_u32 m0, s45, 1024
    s_add_u32 s76, s41, 8192
    buffer_load_dwordx4 v9, s[16:19], s76 offen lds
    s_add_u32 m0, s45, 2048
    s_add_u32 s76, s41, 16384
    buffer_load_dwordx4 v8, s[16:19], s76 offen lds
    s_waitcnt vmcnt(8)
    s_barrier
    s_add_u32 s40, s39, 7
    s_and_b32 s40, s40, 15
    s_xor_b32 s40, s40, s59
    s_lshl_b32 s40, s40, 11
    s_add_u32 s40, s40, s36
    s_add_u32 m0, s44, 57344
    s_nop 0
    buffer_load_dwordx4 v10, s[12:15], s40 offen offset:0 sc1 lds
    s_add_u32 m0, s44, 57344
    s_nop 0
    buffer_load_dwordx4 v10, s[12:15], s40 offen offset:1024 sc1 lds
    s_add_u32 m0, s45, 3072
    s_add_u32 s76, s41, 24576
    buffer_load_dwordx4 v9, s[16:19], s76 offen lds
    s_add_u32 s41, s39, 10
    s_and_b32 s41, s41, 15
    s_xor_b32 s41, s41, s59
    s_lshl_b32 s41, s41, 17
    s_add_u32 s41, s41, s38
    s_add_u32 m0, s45, 40960
    s_add_u32 s76, s41, 0
    buffer_load_dwordx4 v8, s[16:19], s76 offen lds
    s_add_u32 m0, s45, 41984
    s_add_u32 s76, s41, 8192
    buffer_load_dwordx4 v9, s[16:19], s76 offen lds
    s_waitcnt vmcnt(10)
    s_barrier
    s_add_u32 s40, s39, 8
    s_and_b32 s40, s40, 15
    s_xor_b32 s40, s40, s59
    s_lshl_b32 s40, s40, 11
    s_add_u32 s40, s40, s36
    s_add_u32 m0, s44, 16384
    s_nop 0
    buffer_load_dwordx4 v10, s[12:15], s40 offen offset:0 sc1 lds
    s_add_u32 m0, s44, 16384
    s_nop 0
    buffer_load_dwordx4 v10, s[12:15], s40 offen offset:1024 sc1 lds
    s_add_u32 m0, s45, 43008
    s_add_u32 s76, s41, 16384
    buffer_load_dwordx4 v8, s[16:19], s76 offen lds
    s_add_u32 m0, s45, 44032
    s_add_u32 s76, s41, 24576
    buffer_load_dwordx4 v9, s[16:19], s76 offen lds
    s_add_u32 s41, s39, 11
    s_and_b32 s41, s41, 15
    s_xor_b32 s41, s41, s59
    s_lshl_b32 s41, s41, 17
    s_add_u32 s41, s41, s38
    s_add_u32 m0, s45, 81920
    s_add_u32 s76, s41, 0
    buffer_load_dwordx4 v8, s[16:19], s76 offen lds
    s_waitcnt vmcnt(13)
    s_barrier
    s_add_u32 s40, s39, 9
    s_and_b32 s40, s40, 15
    s_xor_b32 s40, s40, s59
    s_lshl_b32 s40, s40, 11
    s_add_u32 s40, s40, s36
    s_add_u32 m0, s44, 98304
    s_nop 0
    buffer_load_dwordx4 v10, s[12:15], s40 offen offset:0 sc1 lds
    s_add_u32 m0, s44, 98304
    s_nop 0
    s_nop 0
    buffer_load_dwordx4 v10, s[12:15], s40 offen offset:1024 sc1 lds
    s_add_u32 m0, s45, 82944
    s_add_u32 s76, s41, 8192
    buffer_load_dwordx4 v9, s[16:19], s76 offen lds
    s_add_u32 m0, s45, 83968
    s_add_u32 s76, s41, 16384
    buffer_load_dwordx4 v8, s[16:19], s76 offen lds
    s_add_u32 m0, s45, 84992
    s_add_u32 s76, s41, 24576
    buffer_load_dwordx4 v9, s[16:19], s76 offen lds
    s_waitcnt vmcnt(13)
    s_barrier
    s_add_u32 s40, s39, 10
    s_and_b32 s40, s40, 15
    s_xor_b32 s40, s40, s59
    s_lshl_b32 s40, s40, 11
    s_add_u32 s40, s40, s36
    s_add_u32 m0, s44, 139264
    s_nop 0
    buffer_load_dwordx4 v10, s[12:15], s40 offen offset:0 sc1 lds
    s_add_u32 m0, s44, 139264
    s_nop 0
    buffer_load_dwordx4 v10, s[12:15], s40 offen offset:1024 sc1 lds
    s_add_u32 s41, s39, 12
    s_and_b32 s41, s41, 15
    s_xor_b32 s41, s41, s59
    s_lshl_b32 s41, s41, 17
    s_add_u32 s41, s41, s38
    s_add_u32 m0, s45, 122880
    s_add_u32 s76, s41, 0
    s_nop 0
    buffer_load_dwordx4 v8, s[16:19], s76 offen lds
    s_add_u32 m0, s45, 123904
    s_add_u32 s76, s41, 8192
    buffer_load_dwordx4 v9, s[16:19], s76 offen lds
    s_add_u32 m0, s45, 124928
    s_add_u32 s76, s41, 16384
    buffer_load_dwordx4 v8, s[16:19], s76 offen lds
    s_waitcnt vmcnt(13)
    s_barrier
    s_add_u32 s40, s39, 11
    s_and_b32 s40, s40, 15
    s_xor_b32 s40, s40, s59
    s_lshl_b32 s40, s40, 11
    s_add_u32 s40, s40, s36
    s_add_u32 m0, s44, 57344
    s_nop 0
    buffer_load_dwordx4 v10, s[12:15], s40 offen offset:0 sc1 lds
    s_add_u32 m0, s44, 57344
    s_nop 0
    buffer_load_dwordx4 v10, s[12:15], s40 offen offset:1024 sc1 lds
    s_add_u32 m0, s45, 125952
    s_add_u32 s76, s41, 24576
    buffer_load_dwordx4 v9, s[16:19], s76 offen lds
    s_add_u32 s41, s39, 13
    s_and_b32 s41, s41, 15
    s_xor_b32 s41, s41, s59
    s_lshl_b32 s41, s41, 17
    s_add_u32 s41, s41, s38
    s_add_u32 m0, s45, 106496
    s_add_u32 s76, s41, 0
    buffer_load_dwordx4 v8, s[16:19], s76 offen lds
    s_add_u32 m0, s45, 107520
    s_add_u32 s76, s41, 8192
    buffer_load_dwordx4 v9, s[16:19], s76 offen lds
    s_waitcnt vmcnt(13)
    s_barrier
    s_add_u32 s40, s39, 12
    s_and_b32 s40, s40, 15
    s_xor_b32 s40, s40, s59
    s_lshl_b32 s40, s40, 11
    s_add_u32 s40, s40, s36
    s_add_u32 m0, s44, 16384
    s_nop 0
    buffer_load_dwordx4 v10, s[12:15], s40 offen offset:0 sc1 lds
    s_add_u32 m0, s44, 16384
    s_nop 0
    buffer_load_dwordx4 v10, s[12:15], s40 offen offset:1024 sc1 lds
    s_add_u32 m0, s45, 108544
    s_add_u32 s76, s41, 16384
    buffer_load_dwordx4 v8, s[16:19], s76 offen lds
    s_add_u32 m0, s45, 109568
    s_add_u32 s76, s41, 24576
    buffer_load_dwordx4 v9, s[16:19], s76 offen lds
    s_add_u32 s41, s39, 14
    s_and_b32 s41, s41, 15
    s_xor_b32 s41, s41, s59
    s_lshl_b32 s41, s41, 17
    s_add_u32 s41, s41, s38
    s_add_u32 m0, s45, 147456
    s_add_u32 s76, s41, 0
    buffer_load_dwordx4 v8, s[16:19], s76 offen lds
    s_waitcnt vmcnt(13)
    s_barrier
    s_add_u32 s40, s39, 13
    s_and_b32 s40, s40, 15
    s_xor_b32 s40, s40, s59
    s_lshl_b32 s40, s40, 11
    s_add_u32 s40, s40, s36
    s_add_u32 m0, s44, 98304
    s_nop 0
    buffer_load_dwordx4 v10, s[12:15], s40 offen offset:0 sc1 lds
    s_add_u32 m0, s44, 98304
    s_nop 0
    s_nop 0
    buffer_load_dwordx4 v10, s[12:15], s40 offen offset:1024 sc1 lds
    s_add_u32 m0, s45, 148480
    s_add_u32 s76, s41, 8192
    buffer_load_dwordx4 v9, s[16:19], s76 offen lds
    s_add_u32 m0, s45, 149504
    s_add_u32 s76, s41, 16384
    buffer_load_dwordx4 v8, s[16:19], s76 offen lds
    s_add_u32 m0, s45, 150528
    s_add_u32 s76, s41, 24576
    buffer_load_dwordx4 v9, s[16:19], s76 offen lds
    s_waitcnt vmcnt(13)
    s_barrier
    s_add_u32 s40, s39, 14
    s_and_b32 s40, s40, 15
    s_xor_b32 s40, s40, s59
    s_lshl_b32 s40, s40, 11
    s_add_u32 s40, s40, s36
    s_add_u32 m0, s44, 139264
    s_nop 0
    buffer_load_dwordx4 v10, s[12:15], s40 offen offset:0 sc1 lds
    s_add_u32 m0, s44, 139264
    s_nop 0
    buffer_load_dwordx4 v10, s[12:15], s40 offen offset:1024 sc1 lds
    s_add_u32 s41, s39, 15
    s_and_b32 s41, s41, 15
    s_xor_b32 s41, s41, s59
    s_lshl_b32 s41, s41, 17
    s_add_u32 s41, s41, s38
    s_add_u32 m0, s45, 65536
    s_add_u32 s76, s41, 0
    buffer_load_dwordx4 v8, s[16:19], s76 offen lds
    s_add_u32 m0, s45, 66560
    s_add_u32 s76, s41, 8192
    buffer_load_dwordx4 v9, s[16:19], s76 offen lds
    s_waitcnt vmcnt(12)
    s_barrier
    s_add_u32 s40, s39, 15
    s_and_b32 s40, s40, 15
    s_xor_b32 s40, s40, s59
    s_lshl_b32 s40, s40, 11
    s_add_u32 s40, s40, s36
    s_add_u32 m0, s44, 57344
    s_nop 0
    buffer_load_dwordx4 v10, s[12:15], s40 offen offset:0 sc1 lds
    s_add_u32 m0, s44, 57344
    s_nop 0
    buffer_load_dwordx4 v10, s[12:15], s40 offen offset:1024 sc1 lds
    s_add_u32 m0, s45, 67584
    s_add_u32 s76, s41, 16384
    buffer_load_dwordx4 v8, s[16:19], s76 offen lds
    s_add_u32 m0, s45, 68608
    s_add_u32 s76, s41, 24576
    buffer_load_dwordx4 v9, s[16:19], s76 offen lds
    s_waitcnt vmcnt(11)
    s_barrier
    s_waitcnt vmcnt(6)
    s_barrier
    s_waitcnt vmcnt(0)
    s_barrier
    s_endpgm
F_aux:
    s_cbranch_execz F_w0
    s_barrier
    s_setprio 0
    s_sub_u32 s3, s3, 4
    s_and_b32 s36, s2, 3
    s_bfe_u32 s37, s2, 0x10002
    s_lshr_b32 s38, s2, 3
    v_lshlrev_b32 v3, 2, v0
    s_lshl_b32 s77, s36, 1
    s_add_u32 s77, s77, s37
    s_mul_i32 s77, s77, 114688
    s_lshl_b32 s46, s38, 12
    s_add_u32 s77, s77, s46
    s_lshl_b32 s46, s3, 10
    s_add_u32 s77, s77, s46
    s_cmp_ge_u32 s2, 224
    s_cselect_b32 s77, 0x7ff00000, s77
    v_mov_b32 v140, 0
    v_mov_b32 v141, 0
    v_mov_b32 v142, 0
    v_mov_b32 v143, 0
    s_add_u32 s12, s72, 0xa00000
    s_addc_u32 s13, s73, 0
    s_mov_b32 s14, 0xe0000
    s_mov_b32 s15, 0x00020000
    buffer_store_dwordx4 v[140:143], v2, s[12:15], s77 offen sc0 sc1
    s_add_u32 s12, s72, 0xb00000
    s_addc_u32 s13, s73, 0
    s_mov_b32 s14, 0x30000
    s_mov_b32 s15, 0x00020000
    s_lshl_b32 s47, s32, 8
    s_add_u32 s56, s47, 0x908000
    s_add_u32 s56, s72, s56
    s_addc_u32 s57, s73, 0
    s_cmp_eq_u32 s37, 0
    s_cselect_b32 s16, s62, s64
    s_cselect_b32 s17, s63, s65
    s_mov_b32 s18, 7340032
    s_mov_b32 s19, 0x00020000
    s_lshl_b32 s44, s3, 2
    s_add_u32 s44, s44, 24640
    v_mov_b32 v10, s44
    v_lshrrev_b32 v5, 4, v0
    v_mul_u32_u24 v6, 57344, v5
    v_and_b32 v7, 15, v0
    v_lshl_add_u32 v6, v7, 4, v6
    s_lshl_b32 s44, s36, 2
    s_add_u32 s44, s44, s3
    s_mul_i32 s54, s44, 458752
    s_lshl_b32 s45, s38, 8
    s_add_u32 s54, s54, s45
    s_cmp_ge_u32 s2, 224
    s_cselect_b32 s54, 0x70000000, s54
    s_lshl_b32 s55, s44, 7
    v_mov_b32 v8, 0
    s_mov_b32 s80, s66
    s_mov_b32 s81, s67
    s_mov_b32 s82, 0x700000
    s_mov_b32 s83, 0x00020000
    v_bfe_u32 v21, v0, 2, 2
    v_lshl_add_u32 v22, v5, 3, v21
    v_lshrrev_b32 v21, 1, v21
    v_and_b32 v20, 1, v5
    v_lshl_add_u32 v21, v20, 1, v21
    v_xor_b32 v21, s3, v21
    v_lshlrev_b32 v21, 5, v21
    v_lshl_add_u32 v21, v22, 7, v21
    v_and_b32 v20, 3, v0
    v_lshl_add_u32 v21, v20, 3, v21
    s_mov_b32 s44, 0x23453342
    s_lshl_b32 s89, s35, 2
    s_lshr_b32 s89, s44, s89
    s_and_b32 s89, s89, 15
    s_and_b32 s44, s89, 3
    s_mul_i32 s44, s44, 40960
    s_add_u32 s44, s44, 16384
    v_add_u32 v112, s44, v21
    v_lshlrev_b32_e64 v113, 2, v7
    v_lshl_add_u32 v113, v5, 12, v113
    s_lshl_b32 s91, s33, 8
    s_lshl_b32 s45, s3, 6
    s_add_u32 s91, s91, s45
    s_mul_i32 s88, s32, 12288
    s_add_u32 s88, s88, s91
    s_mov_b32 exec_hi, 0xffff
    buffer_store_dword v8, v113, s[12:15], s88 offen sc0 sc1
    s_mov_b64 exec, -1
    s_getpc_b64 s[64:65]
F_cp:
    s_add_u32 s64, s64, F_co-F_cp
    s_addc_u32 s65, s65, 0
    s_branch F_cx
F_co:
    ds_read_b64_tr_b16 v[72:73], v112 offset:0
    ds_read_b64_tr_b16 v[74:75], v112 offset:512
    ds_read_b64_tr_b16 v[76:77], v112 offset:4096
    ds_read_b64_tr_b16 v[78:79], v112 offset:4608
    ds_read_b64_tr_b16 v[80:81], v112 offset:8192
    ds_read_b64_tr_b16 v[82:83], v112 offset:8704
    ds_read_b64_tr_b16 v[84:85], v112 offset:12288
    ds_read_b64_tr_b16 v[86:87], v112 offset:12800
    ds_read_b64_tr_b16 v[88:89], v112 offset:16384
    ds_read_b64_tr_b16 v[90:91], v112 offset:16896
    ds_read_b64_tr_b16 v[92:93], v112 offset:20480
    ds_read_b64_tr_b16 v[94:95], v112 offset:20992
    v_mov_b32 v108, 0x3f803f80
    v_mov_b32 v109, 0x3f803f80
    v_mov_b32 v110, 0x3f803f80
    v_mov_b32 v111, 0x3f803f80
    s_waitcnt lgkmcnt(0)
    s_swappc_b64 s[64:65], s[66:67]
    s_setprio 3
    v_mfma_f32_16x16x32_bf16 v[96:99], v[108:111], v[72:75], 0
    v_mfma_f32_16x16x32_bf16 v[100:103], v[108:111], v[80:83], 0
    v_mfma_f32_16x16x32_bf16 v[104:107], v[108:111], v[88:91], 0
    v_mfma_f32_16x16x32_bf16 v[96:99], v[108:111], v[76:79], v[96:99]
    v_mfma_f32_16x16x32_bf16 v[100:103], v[108:111], v[84:87], v[100:103]
    v_mfma_f32_16x16x32_bf16 v[104:107], v[108:111], v[92:95], v[104:107]
    s_setprio 0
    v_cmp_eq_u32 vcc, 1, v5
    s_nop 4
    v_cndmask_b32 v96, v96, v100, vcc
    v_cmp_eq_u32 vcc, 2, v5
    s_nop 1
    v_cndmask_b32 v96, v96, v104, vcc
    v_max_u32 v96, 1, v96
    s_sleep 4
    s_mov_b32 exec_hi, 0xffff
    buffer_store_dword v96, v113, s[12:15], s88 offen sc0 sc1
    s_mov_b64 exec, -1
    s_setpc_b64 s[66:67]
F_cx:
    s_cmp_eq_u32 s3, 0
    s_cbranch_scc1 F_ax0
    s_cmp_eq_u32 s3, 2
    s_cbranch_scc1 F_ax2
    s_barrier
    s_waitcnt vmcnt(0)
    s_barrier
    s_sub_u32 s45, 2, s89
    s_cmp_gt_u32 s45, 1
    s_cbranch_scc1 CB_13
    s_swappc_b64 s[66:67], s[64:65]
CB_13:
    s_barrier
    s_sub_u32 s45, 3, s89
    s_cmp_gt_u32 s45, 1
    s_cbranch_scc1 CB_14
    s_swappc_b64 s[66:67], s[64:65]
CB_14:
    s_barrier
    s_sub_u32 s45, 4, s89
    s_cmp_gt_u32 s45, 1
    s_cbranch_scc1 CB_15
    s_swappc_b64 s[66:67], s[64:65]
CB_15:
    s_barrier
    s_sub_u32 s45, 5, s89
    s_cmp_gt_u32 s45, 1
    s_cbranch_scc1 CB_16
    s_swappc_b64 s[66:67], s[64:65]
CB_16:
    s_barrier
    s_sub_u32 s45, 6, s89
    s_cmp_gt_u32 s45, 1
    s_cbranch_scc1 CB_17
    s_swappc_b64 s[66:67], s[64:65]
CB_17:
    s_cmp_eq_u32 s3, 3
    s_cbranch_scc1 IW_18
    s_mov_b64 exec, 0
    s_branch W_1
R_1:
    s_branch W_2
R_2:
    s_mov_b64 exec, -1
    s_branch IW_18e
IW_18:
    s_mov_b64 exec, 0
    s_branch W_3
R_3:
    s_branch W_4
R_4:
    s_mov_b64 exec, -1
IW_18e:
    s_barrier
    s_cmp_eq_u32 s3, 3
    s_cbranch_scc1 IW_19
    s_mov_b64 exec, 0
    s_branch W_5
R_5:
    s_branch W_6
R_6:
    s_mov_b64 exec, -1
    s_branch IW_19e
IW_19:
    s_mov_b64 exec, 0
    s_branch W_7
R_7:
    s_branch W_8
R_8:
    s_mov_b64 exec, -1
IW_19e:
    s_barrier
    s_cmp_eq_u32 s3, 3
    s_cbranch_scc1 IW_20
    s_mov_b64 exec, 0
    s_nop 0
R_9:
    s_nop 0
R_10:
    s_mov_b64 exec, -1
    s_branch IW_20e
IW_20:
    s_mov_b64 exec, 0
    s_nop 0
R_11:
    s_nop 0
R_12:
    s_mov_b64 exec, -1
IW_20e:
    s_barrier
    s_barrier
    s_barrier
    s_branch F_aj
F_ax0:
    s_lshl_b32 s44, s32, 2
    buffer_load_dword v9, v8, s[48:51], s44 offen sc0 sc1
    s_barrier
    s_waitcnt vmcnt(0)
    v_cmp_eq_u32 vcc, 0, v9
    s_cbranch_vccz F_ax0r
PL_21:
    buffer_load_dword v9, v8, s[48:51], s44 offen sc0 sc1
    s_waitcnt vmcnt(0)
    v_cmp_gt_u32 vcc, 1, v9
    s_cbranch_vccz PD_22
    s_sleep 1
    s_branch PL_21
PD_22:
F_ax0r:
    s_barrier
    s_mov_b32 s76, 1
    s_atomic_add s76, s[56:57], 0 glc
    s_sub_u32 s45, 2, s89
    s_cmp_gt_u32 s45, 1
    s_cbranch_scc1 CB_23
    s_swappc_b64 s[66:67], s[64:65]
CB_23:
    s_barrier
    s_mov_b32 s75, 0
    s_waitcnt lgkmcnt(0)
    s_cmp_lg_u32 s76, 15
    s_cbranch_scc1 F_ax0c
    s_mov_b32 s75, 1
    s_atomic_add s75, s[70:71], 64 glc
F_ax0c:
    s_sub_u32 s45, 3, s89
    s_cmp_gt_u32 s45, 1
    s_cbranch_scc1 CB_24
    s_swappc_b64 s[66:67], s[64:65]
CB_24:
    s_barrier
    s_sub_u32 s45, 4, s89
    s_cmp_gt_u32 s45, 1
    s_cbranch_scc1 CB_25
    s_swappc_b64 s[66:67], s[64:65]
CB_25:
    s_waitcnt lgkmcnt(0)
    s_cmp_lg_u32 s75, 15
    s_cbranch_scc1 F_ax0d
    v_lshlrev_b32 v9, 8, v0
    v_mov_b32 v11, 1000
    s_mov_b32 s44, 32768
    s_mov_b64 exec, 0xffff
    buffer_store_dword v11, v9, s[40:43], s44 offen sc0 sc1
    s_mov_b64 exec, -1
F_ax0d:
    s_barrier
    s_sub_u32 s45, 5, s89
    s_cmp_gt_u32 s45, 1
    s_cbranch_scc1 CB_26
    s_swappc_b64 s[66:67], s[64:65]
CB_26:
    s_barrier
    s_sub_u32 s45, 6, s89
    s_cmp_gt_u32 s45, 1
    s_cbranch_scc1 CB_27
    s_swappc_b64 s[66:67], s[64:65]
CB_27:
    s_barrier
    s_barrier
    s_barrier
    s_barrier
    s_barrier
    s_branch F_aj
F_ax2:
    s_lshl_b32 s44, s2, 10
    buffer_store_dwordx4 v[140:143], v2, s[24:27], s44 offen sc0 sc1
    s_mov_b64 exec, -1
    s_barrier
    s_waitcnt vmcnt(0)
    s_cmp_lg_u32 s2, 2
    s_cbranch_scc1 F_ax2n
    s_barrier
    s_sub_u32 s45, 2, s89
    s_cmp_gt_u32 s45, 1
    s_cbranch_scc1 CB_28
    s_swappc_b64 s[66:67], s[64:65]
CB_28:
    s_barrier
    s_sub_u32 s45, 3, s89
    s_cmp_gt_u32 s45, 1
    s_cbranch_scc1 CB_29
    s_swappc_b64 s[66:67], s[64:65]
CB_29:
    s_barrier
    s_sub_u32 s45, 4, s89
    s_cmp_gt_u32 s45, 1
    s_cbranch_scc1 CB_30
    s_swappc_b64 s[66:67], s[64:65]
CB_30:
    s_barrier
    s_sub_u32 s45, 5, s89
    s_cmp_gt_u32 s45, 1
    s_cbranch_scc1 CB_31
    s_swappc_b64 s[66:67], s[64:65]
CB_31:
    s_barrier
    s_sub_u32 s45, 6, s89
    s_cmp_gt_u32 s45, 1
    s_cbranch_scc1 CB_32
    s_swappc_b64 s[66:67], s[64:65]
CB_32:
    s_load_dword s76, s[56:57], 0 glc
    s_barrier
    s_waitcnt lgkmcnt(0)
    s_cmp_ge_u32 s76, 1000
    s_cbranch_scc1 F_ax2g
SP_33:
    s_load_dword s76, s[56:57], 0 glc
    s_waitcnt lgkmcnt(0)
    s_cmp_ge_u32 s76, 1000
    s_cbranch_scc1 SD_34
    s_sleep 2
    s_branch SP_33
SD_34:
F_ax2g:
    s_movk_i32 s44, 0
    buffer_load_dwordx4 v[16:19], v2, s[40:43], s44 offen sc0 sc1
    s_movk_i32 s44, 1024
    buffer_load_dwordx4 v[20:23], v2, s[40:43], s44 offen sc0 sc1
    s_movk_i32 s44, 2048
    buffer_load_dwordx4 v[24:27], v2, s[40:43], s44 offen sc0 sc1
    s_movk_i32 s44, 3072
    buffer_load_dwordx4 v[28:31], v2, s[40:43], s44 offen sc0 sc1
    s_movk_i32 s44, 4096
    buffer_load_dwordx4 v[32:35], v2, s[40:43], s44 offen sc0 sc1
    s_movk_i32 s44, 5120
    buffer_load_dwordx4 v[36:39], v2, s[40:43], s44 offen sc0 sc1
    s_movk_i32 s44, 6144
    buffer_load_dwordx4 v[40:43], v2, s[40:43], s44 offen sc0 sc1
    s_movk_i32 s44, 7168
    buffer_load_dwordx4 v[44:47], v2, s[40:43], s44 offen sc0 sc1
    s_mov_b32 s53, 0
    v_and_b32 v13, 7, v0
    v_lshlrev_b32 v13, 2, v13
    v_lshrrev_b32_e64 v9, 3, v0
    v_lshl_add_u32 v13, v9, 7, v13
    s_barrier
    s_waitcnt vmcnt(0)
    s_mov_b32 s58, 0x01010101
    s_mov_b32 s59, s58
    v_max3_u32 v48, v16, v17, v18
    v_med3_u32 v49, v16, v17, v18
    v_min3_u32 v50, v16, v17, v18
    v_med3_u32 v50, v49, v50, v19
    v_med3_u32 v49, v48, v49, v19
    v_max_u32 v48, v48, v19
    v_med3_u32 v50, v49, v50, v20
    v_med3_u32 v49, v48, v49, v20
    v_max_u32 v48, v48, v20
    v_med3_u32 v50, v49, v50, v21
    v_med3_u32 v49, v48, v49, v21
    v_max_u32 v48, v48, v21
    v_med3_u32 v50, v49, v50, v22
    v_med3_u32 v49, v48, v49, v22
    v_max_u32 v48, v48, v22
    v_med3_u32 v50, v49, v50, v23
    v_med3_u32 v49, v48, v49, v23
    v_max_u32 v48, v48, v23
    v_med3_u32 v50, v49, v50, v24
    v_med3_u32 v49, v48, v49, v24
    v_max_u32 v48, v48, v24
    v_med3_u32 v50, v49, v50, v25
    v_med3_u32 v49, v48, v49, v25
    v_max_u32 v48, v48, v25
    v_med3_u32 v50, v49, v50, v26
    v_med3_u32 v49, v48, v49, v26
    v_max_u32 v48, v48, v26
    v_med3_u32 v50, v49, v50, v27
    v_med3_u32 v49, v48, v49, v27
    v_max_u32 v48, v48, v27
    v_med3_u32 v50, v49, v50, v28
    v_med3_u32 v49, v48, v49, v28
    v_max_u32 v48, v48, v28
    v_med3_u32 v50, v49, v50, v29
    v_med3_u32 v49, v48, v49, v29
    v_max_u32 v48, v48, v29
    v_med3_u32 v50, v49, v50, v30
    v_med3_u32 v49, v48, v49, v30
    v_max_u32 v48, v48, v30
    v_med3_u32 v50, v49, v50, v31
    v_med3_u32 v49, v48, v49, v31
    v_max_u32 v48, v48, v31
    v_med3_u32 v50, v49, v50, v32
    v_med3_u32 v49, v48, v49, v32
    v_max_u32 v48, v48, v32
    s_barrier
    v_med3_u32 v50, v49, v50, v33
    v_med3_u32 v49, v48, v49, v33
    v_max_u32 v48, v48, v33
    v_med3_u32 v50, v49, v50, v34
    v_med3_u32 v49, v48, v49, v34
    v_max_u32 v48, v48, v34
    v_med3_u32 v50, v49, v50, v35
    v_med3_u32 v49, v48, v49, v35
    v_max_u32 v48, v48, v35
    v_med3_u32 v50, v49, v50, v36
    v_med3_u32 v49, v48, v49, v36
    v_max_u32 v48, v48, v36
    v_med3_u32 v50, v49, v50, v37
    v_med3_u32 v49, v48, v49, v37
    v_max_u32 v48, v48, v37
    v_med3_u32 v50, v49, v50, v38
    v_med3_u32 v49, v48, v49, v38
    v_max_u32 v48, v48, v38
    v_med3_u32 v50, v49, v50, v39
    v_med3_u32 v49, v48, v49, v39
    v_max_u32 v48, v48, v39
    v_med3_u32 v50, v49, v50, v40
    v_med3_u32 v49, v48, v49, v40
    v_max_u32 v48, v48, v40
    v_med3_u32 v50, v49, v50, v41
    v_med3_u32 v49, v48, v49, v41
    v_max_u32 v48, v48, v41
    v_med3_u32 v50, v49, v50, v42
    v_med3_u32 v49, v48, v49, v42
    v_max_u32 v48, v48, v42
    v_med3_u32 v50, v49, v50, v43
    v_med3_u32 v49, v48, v49, v43
    v_max_u32 v48, v48, v43
    v_med3_u32 v50, v49, v50, v44
    v_med3_u32 v49, v48, v49, v44
    v_max_u32 v48, v48, v44
    v_med3_u32 v50, v49, v50, v45
    v_med3_u32 v49, v48, v49, v45
    v_max_u32 v48, v48, v45
    v_med3_u32 v50, v49, v50, v46
    v_med3_u32 v49, v48, v49, v46
    v_max_u32 v48, v48, v46
    v_med3_u32 v50, v49, v50, v47
    v_med3_u32 v49, v48, v49, v47
    v_max_u32 v48, v48, v47
    v_mov_b32 v4, v48
    s_nop 1
    v_max_u32_dpp v4, v4, v4 row_shr:1 row_mask:0xf bank_mask:0xf bound_ctrl:0
    s_nop 1
    v_max_u32_dpp v4, v4, v4 row_shr:2 row_mask:0xf bank_mask:0xf bound_ctrl:0
    s_nop 1
    v_max_u32_dpp v4, v4, v4 row_shr:4 row_mask:0xf bank_mask:0xf bound_ctrl:0
    s_nop 1
    v_max_u32_dpp v4, v4, v4 row_shr:8 row_mask:0xf bank_mask:0xf bound_ctrl:0
    s_nop 1
    v_max_u32_dpp v4, v4, v4 row_bcast:15 row_mask:0xa bank_mask:0xf
    s_nop 1
    v_max_u32_dpp v4, v4, v4 row_bcast:31 row_mask:0xc bank_mask:0xf
    s_nop 0
    v_readlane_b32 s52, v4, 63
    s_lshl_b64 exec, s[58:59], 0
    s_nop 0
    v_mov_b32 v12, s52
    s_mov_b64 exec, -1
    v_cmp_eq_u32 vcc, s52, v48
    s_nop 1
    v_cndmask_b32 v48, v48, v49, vcc
    v_cndmask_b32 v49, v49, v50, vcc
    v_cndmask_b32 v50, v50, 0, vcc
    s_barrier
    v_mov_b32 v4, v48
    s_nop 1
    v_max_u32_dpp v4, v4, v4 row_shr:1 row_mask:0xf bank_mask:0xf bound_ctrl:0
    s_nop 1
    v_max_u32_dpp v4, v4, v4 row_shr:2 row_mask:0xf bank_mask:0xf bound_ctrl:0
    s_nop 1
    v_max_u32_dpp v4, v4, v4 row_shr:4 row_mask:0xf bank_mask:0xf bound_ctrl:0
    s_nop 1
    v_max_u32_dpp v4, v4, v4 row_shr:8 row_mask:0xf bank_mask:0xf bound_ctrl:0
    s_nop 1
    v_max_u32_dpp v4, v4, v4 row_bcast:15 row_mask:0xa bank_mask:0xf
    s_nop 1
    v_max_u32_dpp v4, v4, v4 row_bcast:31 row_mask:0xc bank_mask:0xf
    s_nop 0
    v_readlane_b32 s52, v4, 63
    s_lshl_b64 exec, s[58:59], 1
    s_nop 0
    v_mov_b32 v12, s52
    s_mov_b64 exec, -1
W_7:
    s_cbranch_execz R_7
    s_nop 0
    v_cmp_eq_u32 vcc, s52, v48
    s_nop 1
    v_cndmask_b32 v48, v48, v49, vcc
    v_cndmask_b32 v49, v49, v50, vcc
    v_cndmask_b32 v50, v50, 0, vcc
    v_mov_b32 v4, v48
    s_nop 1
    v_max_u32_dpp v4, v4, v4 row_shr:1 row_mask:0xf bank_mask:0xf bound_ctrl:0
    s_nop 1
    v_max_u32_dpp v4, v4, v4 row_shr:2 row_mask:0xf bank_mask:0xf bound_ctrl:0
    s_nop 1
    v_max_u32_dpp v4, v4, v4 row_shr:4 row_mask:0xf bank_mask:0xf bound_ctrl:0
    s_nop 1
    v_max_u32_dpp v4, v4, v4 row_shr:8 row_mask:0xf bank_mask:0xf bound_ctrl:0
    s_nop 1
    v_max_u32_dpp v4, v4, v4 row_bcast:15 row_mask:0xa bank_mask:0xf
    s_nop 1
    v_max_u32_dpp v4, v4, v4 row_bcast:31 row_mask:0xc bank_mask:0xf
    s_nop 0
    v_readlane_b32 s52, v4, 63
    s_lshl_b64 exec, s[58:59], 2
    s_nop 0
    v_mov_b32 v12, s52
    s_mov_b64 exec, -1
    v_cmp_eq_u32 vcc, s52, v48
    s_nop 1
    v_cndmask_b32 v48, v48, v49, vcc
    v_cndmask_b32 v49, v49, v50, vcc
    v_cndmask_b32 v50, v50, 0, vcc
    v_mov_b32 v4, v48
    s_nop 1
    v_max_u32_dpp v4, v4, v4 row_shr:1 row_mask:0xf bank_mask:0xf bound_ctrl:0
    s_nop 1
    v_max_u32_dpp v4, v4, v4 row_shr:2 row_mask:0xf bank_mask:0xf bound_ctrl:0
    s_nop 1
    v_max_u32_dpp v4, v4, v4 row_shr:4 row_mask:0xf bank_mask:0xf bound_ctrl:0
    s_nop 1
    v_max_u32_dpp v4, v4, v4 row_shr:8 row_mask:0xf bank_mask:0xf bound_ctrl:0
    s_nop 1
    v_max_u32_dpp v4, v4, v4 row_bcast:15 row_mask:0xa bank_mask:0xf
    s_nop 1
    v_max_u32_dpp v4, v4, v4 row_bcast:31 row_mask:0xc bank_mask:0xf
    s_nop 0
    v_readlane_b32 s52, v4, 63
    s_lshl_b64 exec, s[58:59], 3
    s_nop 0
    v_mov_b32 v12, s52
    s_mov_b64 exec, -1
    v_cmp_eq_u32 vcc, s52, v48
    s_nop 1
    v_cndmask_b32 v48, v48, v49, vcc
    v_cndmask_b32 v49, v49, v50, vcc
    v_cndmask_b32 v50, v50, 0, vcc
    v_mov_b32 v4, v48
    s_nop 1
    v_max_u32_dpp v4, v4, v4 row_shr:1 row_mask:0xf bank_mask:0xf bound_ctrl:0
    s_nop 1
    v_max_u32_dpp v4, v4, v4 row_shr:2 row_mask:0xf bank_mask:0xf bound_ctrl:0
    s_nop 1
    v_max_u32_dpp v4, v4, v4 row_shr:4 row_mask:0xf bank_mask:0xf bound_ctrl:0
    s_nop 1
    v_max_u32_dpp v4, v4, v4 row_shr:8 row_mask:0xf bank_mask:0xf bound_ctrl:0
    s_nop 1
    v_max_u32_dpp v4, v4, v4 row_bcast:15 row_mask:0xa bank_mask:0xf
    s_nop 1
    v_max_u32_dpp v4, v4, v4 row_bcast:31 row_mask:0xc bank_mask:0xf
    s_nop 0
    v_readlane_b32 s52, v4, 63
    s_lshl_b64 exec, s[58:59], 4
    s_nop 0
    v_mov_b32 v12, s52
    s_mov_b64 exec, -1
    v_cmp_eq_u32 vcc, s52, v48
    s_nop 1
    v_cndmask_b32 v48, v48, v49, vcc
    v_cndmask_b32 v49, v49, v50, vcc
    v_cndmask_b32 v50, v50, 0, vcc
    s_barrier
    v_mov_b32 v4, v48
    s_nop 1
    v_max_u32_dpp v4, v4, v4 row_shr:1 row_mask:0xf bank_mask:0xf bound_ctrl:0
    s_nop 1
    v_max_u32_dpp v4, v4, v4 row_shr:2 row_mask:0xf bank_mask:0xf bound_ctrl:0
    s_nop 1
    v_max_u32_dpp v4, v4, v4 row_shr:4 row_mask:0xf bank_mask:0xf bound_ctrl:0
    s_nop 1
    v_max_u32_dpp v4, v4, v4 row_shr:8 row_mask:0xf bank_mask:0xf bound_ctrl:0
    s_nop 1
    v_max_u32_dpp v4, v4, v4 row_bcast:15 row_mask:0xa bank_mask:0xf
    s_nop 1
    v_max_u32_dpp v4, v4, v4 row_bcast:31 row_mask:0xc bank_mask:0xf
    s_nop 0
    v_readlane_b32 s52, v4, 63
    s_lshl_b64 exec, s[58:59], 5
    s_nop 0
    v_mov_b32 v12, s52
    s_mov_b64 exec, -1
    v_cmp_eq_u32 vcc, s52, v48
    s_nop 1
    v_cndmask_b32 v48, v48, v49, vcc
    v_cndmask_b32 v49, v49, v50, vcc
    v_cndmask_b32 v50, v50, 0, vcc
    v_mov_b32 v4, v48
    s_nop 1
    v_max_u32_dpp v4, v4, v4 row_shr:1 row_mask:0xf bank_mask:0xf bound_ctrl:0
    s_nop 1
    v_max_u32_dpp v4, v4, v4 row_shr:2 row_mask:0xf bank_mask:0xf bound_ctrl:0
    s_nop 1
    v_max_u32_dpp v4, v4, v4 row_shr:4 row_mask:0xf bank_mask:0xf bound_ctrl:0
    s_nop 1
    v_max_u32_dpp v4, v4, v4 row_shr:8 row_mask:0xf bank_mask:0xf bound_ctrl:0
    s_nop 1
    v_max_u32_dpp v4, v4, v4 row_bcast:15 row_mask:0xa bank_mask:0xf
    s_nop 1
    v_max_u32_dpp v4, v4, v4 row_bcast:31 row_mask:0xc bank_mask:0xf
    s_nop 0
    v_readlane_b32 s52, v4, 63
    s_lshl_b64 exec, s[58:59], 6
    s_nop 0
    v_mov_b32 v12, s52
    s_mov_b64 exec, -1
    v_cmp_eq_u32 vcc, s52, v48
    s_nop 1
    v_cndmask_b32 v48, v48, v49, vcc
    v_cndmask_b32 v49, v49, v50, vcc
    v_cndmask_b32 v50, v50, 0, vcc
    v_mov_b32 v4, v48
    s_nop 1
    v_max_u32_dpp v4, v4, v4 row_shr:1 row_mask:0xf bank_mask:0xf bound_ctrl:0
    s_nop 1
    v_max_u32_dpp v4, v4, v4 row_shr:2 row_mask:0xf bank_mask:0xf bound_ctrl:0
    s_nop 1
    v_max_u32_dpp v4, v4, v4 row_shr:4 row_mask:0xf bank_mask:0xf bound_ctrl:0
    s_nop 1
    v_max_u32_dpp v4, v4, v4 row_shr:8 row_mask:0xf bank_mask:0xf bound_ctrl:0
    s_nop 1
    v_max_u32_dpp v4, v4, v4 row_bcast:15 row_mask:0xa bank_mask:0xf
    s_nop 1
    v_max_u32_dpp v4, v4, v4 row_bcast:31 row_mask:0xc bank_mask:0xf
    s_nop 0
    v_readlane_b32 s52, v4, 63
    s_lshl_b64 exec, s[58:59], 7
    s_nop 0
    v_mov_b32 v12, s52
    s_mov_b64 exec, -1
    v_cmp_eq_u32 vcc, 0, v48
    s_cbranch_vccz F_tk2
    s_mov_b32 s52, 0
    s_mov_b32 s45, 0
F_tk1:
    v_subrev_u32 v16, s52, v16
    v_subrev_u32 v17, s52, v17
    v_subrev_u32 v18, s52, v18
    v_subrev_u32 v19, s52, v19
    v_subrev_u32 v20, s52, v20
    v_subrev_u32 v21, s52, v21
    v_subrev_u32 v22, s52, v22
    v_subrev_u32 v23, s52, v23
    v_subrev_u32 v24, s52, v24
    v_subrev_u32 v25, s52, v25
    v_subrev_u32 v26, s52, v26
    v_subrev_u32 v27, s52, v27
    v_subrev_u32 v28, s52, v28
    v_subrev_u32 v29, s52, v29
    v_subrev_u32 v30, s52, v30
    v_subrev_u32 v31, s52, v31
    v_subrev_u32 v32, s52, v32
    v_subrev_u32 v33, s52, v33
    v_subrev_u32 v34, s52, v34
    v_subrev_u32 v35, s52, v35
    v_subrev_u32 v36, s52, v36
    v_subrev_u32 v37, s52, v37
    v_subrev_u32 v38, s52, v38
    v_subrev_u32 v39, s52, v39
    v_subrev_u32 v40, s52, v40
    v_subrev_u32 v41, s52, v41
    v_subrev_u32 v42, s52, v42
    v_subrev_u32 v43, s52, v43
    v_subrev_u32 v44, s52, v44
    v_subrev_u32 v45, s52, v45
    v_subrev_u32 v46, s52, v46
    v_subrev_u32 v47, s52, v47
    v_max3_u32 v4, v16, v17, v18
    v_max3_u32 v4, v4, v19, v20
    v_max3_u32 v4, v4, v21, v22
    v_max3_u32 v4, v4, v23, v24
    v_max3_u32 v4, v4, v25, v26
    v_max3_u32 v4, v4, v27, v28
    v_max3_u32 v4, v4, v29, v30
    v_max3_u32 v4, v4, v31, v32
    v_max3_u32 v4, v4, v33, v34
    v_max3_u32 v4, v4, v35, v36
    v_max3_u32 v4, v4, v37, v38
    v_max3_u32 v4, v4, v39, v40
    v_max3_u32 v4, v4, v41, v42
    v_max3_u32 v4, v4, v43, v44
    v_max3_u32 v4, v4, v45, v46
    v_max_u32 v4, v4, v47
    s_nop 1
    v_max_u32_dpp v4, v4, v4 row_shr:1 row_mask:0xf bank_mask:0xf bound_ctrl:0
    s_nop 1
    v_max_u32_dpp v4, v4, v4 row_shr:2 row_mask:0xf bank_mask:0xf bound_ctrl:0
    s_nop 1
    v_max_u32_dpp v4, v4, v4 row_shr:4 row_mask:0xf bank_mask:0xf bound_ctrl:0
    s_nop 1
    v_max_u32_dpp v4, v4, v4 row_shr:8 row_mask:0xf bank_mask:0xf bound_ctrl:0
    s_nop 1
    v_max_u32_dpp v4, v4, v4 row_bcast:15 row_mask:0xa bank_mask:0xf
    s_nop 1
    v_max_u32_dpp v4, v4, v4 row_bcast:31 row_mask:0xc bank_mask:0xf
    s_nop 0
    v_readlane_b32 s52, v4, 63
    s_nop 0
    s_add_u32 s53, s53, s52
    s_lshl_b64 exec, s[58:59], s45
    v_mov_b32 v12, s53
    s_mov_b64 exec, -1
    s_add_u32 s45, s45, 1
    s_cmp_lt_u32 s45, 8
    s_cbranch_scc1 F_tk1
F_tk2:
    v_or_b32 v12, 0x8000, v12
    s_mov_b32 s44, 184320
    buffer_store_dword v12, v13, s[24:27], s44 offen offset:0 sc0 sc1
    buffer_store_dword v12, v13, s[24:27], s44 offen offset:1024 sc0 sc1
    buffer_store_dword v12, v13, s[24:27], s44 offen offset:2048 sc0 sc1
    buffer_store_dword v12, v13, s[24:27], s44 offen offset:3072 sc0 sc1
    s_mov_b32 s44, 188416
    buffer_store_dword v12, v13, s[24:27], s44 offen offset:0 sc0 sc1
    buffer_store_dword v12, v13, s[24:27], s44 offen offset:1024 sc0 sc1
    buffer_store_dword v12, v13, s[24:27], s44 offen offset:2048 sc0 sc1
    buffer_store_dword v12, v13, s[24:27], s44 offen offset:3072 sc0 sc1
    s_branch F_aj
F_ax2n:
    s_barrier
    s_sub_u32 s45, 2, s89
    s_cmp_gt_u32 s45, 1
    s_cbranch_scc1 CB_35
    s_swappc_b64 s[66:67], s[64:65]
CB_35:
    s_barrier
    s_sub_u32 s45, 3, s89
    s_cmp_gt_u32 s45, 1
    s_cbranch_scc1 CB_36
    s_swappc_b64 s[66:67], s[64:65]
CB_36:
    s_barrier
    s_sub_u32 s45, 4, s89
    s_cmp_gt_u32 s45, 1
    s_cbranch_scc1 CB_37
    s_swappc_b64 s[66:67], s[64:65]
CB_37:
    s_barrier
    s_sub_u32 s45, 5, s89
    s_cmp_gt_u32 s45, 1
    s_cbranch_scc1 CB_38
    s_swappc_b64 s[66:67], s[64:65]
CB_38:
    s_barrier
    s_sub_u32 s45, 6, s89
    s_cmp_gt_u32 s45, 1
    s_cbranch_scc1 CB_39
    s_swappc_b64 s[66:67], s[64:65]
CB_39:
    s_barrier
    s_load_dword s76, s[56:57], 0 glc
    s_barrier
    s_waitcnt lgkmcnt(0)
    s_cmp_ge_u32 s76, 1000
    s_cbranch_scc1 F_ax2h
SP_40:
    s_load_dword s76, s[56:57], 0 glc
    s_waitcnt lgkmcnt(0)
    s_cmp_ge_u32 s76, 1000
    s_cbranch_scc1 SD_41
    s_sleep 8
    s_branch SP_40
SD_41:
F_ax2h:
    s_barrier
    s_barrier
    s_barrier
F_aj:
    s_add_u32 s12, s72, 0xa00000
    s_addc_u32 s13, s73, 0
    s_mov_b32 s14, 0xe0000
    s_mov_b32 s15, 0x00020000
    s_and_b32 s46, s2, 63
    s_lshl_b32 s46, s46, 7
    s_add_u32 s56, s46, 0x82d000
    s_add_u32 s56, s72, s56
    s_addc_u32 s57, s73, 0
    s_mov_b32 s58, 0x01010101
    s_mov_b32 s59, s58
    s_mov_b32 s52, 0x05040100
    s_mov_b32 s53, 0x07060302
    v_and_b32 v13, 3, v0
    v_lshlrev_b32 v13, 2, v13
    v_add_u32 v13, 24656, v13
    s_mul_i32 s78, s28, 112
    s_mul_i32 s79, s3, 28
    s_add_u32 s78, s78, s79
    s_lshl_b32 s78, s78, 11
    s_lshl_b32 s79, s29, 8
    s_add_u32 s78, s78, s79

    v_mul_u32_u24 v160, 14336, v5
    v_lshl_add_u32 v160, v7, 4, v160
    s_and_b32 s88, s3, 1
    s_lshl_b32 s88, s88, 12
    s_lshr_b32 s45, s3, 1
    s_mul_i32 s45, s45, 24576
    s_add_u32 s88, s88, s45
    v_subrev_u32 v163, 16, v13
    v_lshrrev_b32 v164, 1, v5
    v_lshlrev_b32 v164, 2, v164
    v_and_b32 v165, 7, v7
    v_xor_b32 v164, v164, v165
    v_lshlrev_b32 v164, 5, v164
    v_lshl_add_u32 v164, v7, 8, v164
    v_and_b32 v165, 1, v5
    v_lshl_add_u32 v164, v165, 4, v164
    s_lshl_b32 s45, s3, 12
    s_add_u32 s45, s45, 106496
    v_add_u32 v164, s45, v164
    s_lshl_b32 s45, s3, 2
    v_add_u32 v165, s45, v5
    v_and_b32 v165, 7, v165
    v_lshlrev_b32 v165, 5, v165
    v_xor_b32 v165, v165, v2
    s_lshl_b32 s45, s3, 10
    s_add_u32 s45, s45, 106496
    v_add_u32 v165, s45, v165
    v_add_u32_e64 v162, 16, v13
    s_barrier
    s_barrier
    s_sleep 2
    s_add_u32 s45, s54, 0
    buffer_load_dwordx4 v[72:75], v6, s[16:19], s45 offen nt
    s_add_u32 s45, s54, 7168
    buffer_load_dwordx4 v[76:79], v6, s[16:19], s45 offen nt
    s_add_u32 s45, s54, 14336
    buffer_load_dwordx4 v[80:83], v6, s[16:19], s45 offen nt
    s_add_u32 s45, s54, 21504
    buffer_load_dwordx4 v[84:87], v6, s[16:19], s45 offen nt
    s_barrier
    s_nop 0
    s_load_dwordx8 s[60:67], s[56:57], 0 glc
    s_add_u32 s45, s54, 28672
    buffer_load_dwordx4 v[88:91], v6, s[16:19], s45 offen nt
    s_add_u32 s45, s54, 35840
    buffer_load_dwordx4 v[92:95], v6, s[16:19], s45 offen nt
    s_add_u32 s45, s54, 43008
    buffer_load_dwordx4 v[96:99], v6, s[16:19], s45 offen nt
    s_add_u32 s45, s54, 50176
    buffer_load_dwordx4 v[100:103], v6, s[16:19], s45 offen nt
    s_barrier
    s_setprio 1
F_sc:
    s_waitcnt lgkmcnt(0)
    s_and_b64 s[74:75], s[60:61], s[62:63]
    s_and_b64 s[74:75], s[74:75], s[64:65]
    s_and_b64 s[74:75], s[74:75], s[66:67]
    s_and_b32 s74, s74, s75
    s_bitcmp1_b32 s74, 15
    s_cbranch_scc1 F_sd
    s_sleep 4
    s_load_dwordx8 s[60:67], s[56:57], 0 glc
    s_branch F_sc
F_sd:

    s_lshl_b64 exec, s[58:59], 0
    v_mov_b32 v4, s60
    s_lshl_b64 exec, s[58:59], 1
    v_mov_b32 v4, s61
    s_lshl_b64 exec, s[58:59], 2
    v_mov_b32 v4, s62
    s_lshl_b64 exec, s[58:59], 3
    v_mov_b32 v4, s63
    s_lshl_b64 exec, s[58:59], 4
    v_mov_b32 v4, s64
    s_lshl_b64 exec, s[58:59], 5
    v_mov_b32 v4, s65
    s_lshl_b64 exec, s[58:59], 6
    v_mov_b32 v4, s66
    s_lshl_b64 exec, s[58:59], 7
    v_mov_b32 v4, s67
    s_mov_b64 exec, -1
    s_mov_b32 s46, 65536
    v_and_b32 v4, 0x7ff, v4
    v_sub_u32 v4, 2047, v4
    v_lshlrev_b32 v9, 4, v4
    v_lshlrev_b32 v4, 11, v4
    v_lshl_add_u32 v4, v5, 4, v4

    buffer_load_dwordx4 v[64:67], v4, s[20:23], s55 offen
    buffer_load_dwordx4 v[68:71], v4, s[20:23], s55 offen offset:64
    buffer_load_dwordx2 v[14:15], v9, s[40:43], s46 offen sc0 sc1
    s_cmp_lt_u32 s2, 224
    s_cbranch_scc1 F_ag
    s_add_u32 s79, s78, 0
    buffer_load_dwordx4 v[16:19], v160, s[80:83], s79 offen nt
    s_add_u32 s79, s78, 2048
    buffer_load_dwordx4 v[20:23], v160, s[80:83], s79 offen nt
    s_add_u32 s79, s78, 4096
    buffer_load_dwordx4 v[24:27], v160, s[80:83], s79 offen nt
    s_add_u32 s79, s78, 6144
    buffer_load_dwordx4 v[28:31], v160, s[80:83], s79 offen nt
    s_add_u32 s79, s78, 8192
    buffer_load_dwordx4 v[144:147], v160, s[80:83], s79 offen nt
    s_add_u32 s79, s78, 10240
    buffer_load_dwordx4 v[148:151], v160, s[80:83], s79 offen nt
    s_add_u32 s79, s78, 12288
    buffer_load_dwordx4 v[152:155], v160, s[80:83], s79 offen nt
    s_sleep 32
    s_branch F_adown
F_ag:
    s_add_u32 s45, s54, 229376
    buffer_load_dwordx4 v[104:107], v6, s[16:19], s45 offen nt
    s_add_u32 s45, s54, 236544
    buffer_load_dwordx4 v[108:111], v6, s[16:19], s45 offen nt
    s_add_u32 s45, s54, 243712
    buffer_load_dwordx4 v[112:115], v6, s[16:19], s45 offen nt
    s_add_u32 s45, s54, 250880
    buffer_load_dwordx4 v[116:119], v6, s[16:19], s45 offen nt
    s_add_u32 s45, s54, 258048
    buffer_load_dwordx4 v[120:123], v6, s[16:19], s45 offen nt
    s_add_u32 s45, s54, 265216
    buffer_load_dwordx4 v[124:127], v6, s[16:19], s45 offen nt
    s_add_u32 s45, s54, 272384
    buffer_load_dwordx4 v[128:131], v6, s[16:19], s45 offen nt
    s_add_u32 s45, s54, 279552
    buffer_load_dwordx4 v[132:135], v6, s[16:19], s45 offen nt
    s_waitcnt vmcnt(8)
    v_lshlrev_b32 v34, 16, v64
    v_and_b32 v35, 0xffff0000, v64
    v_lshlrev_b32 v36, 16, v65
    v_and_b32 v37, 0xffff0000, v65
    v_lshlrev_b32 v38, 16, v66
    v_and_b32 v39, 0xffff0000, v66
    v_lshlrev_b32 v40, 16, v67
    v_and_b32 v41, 0xffff0000, v67
    v_lshlrev_b32 v42, 16, v68
    v_and_b32 v43, 0xffff0000, v68
    v_lshlrev_b32 v44, 16, v69
    v_and_b32 v45, 0xffff0000, v69
    v_lshlrev_b32 v46, 16, v70
    v_and_b32 v47, 0xffff0000, v70
    v_lshlrev_b32 v48, 16, v71
    v_and_b32 v49, 0xffff0000, v71
    v_add_f32 v34, v34, v14
    v_add_f32 v35, v35, v14
    v_add_f32 v36, v36, v14
    v_add_f32 v37, v37, v14
    v_add_f32 v38, v38, v14
    v_add_f32 v39, v39, v14
    v_add_f32 v40, v40, v14
    v_add_f32 v41, v41, v14
    v_add_f32 v42, v42, v14
    v_add_f32 v43, v43, v14
    v_add_f32 v44, v44, v14
    v_add_f32 v45, v45, v14
    v_add_f32 v46, v46, v14
    v_add_f32 v47, v47, v14
    v_add_f32 v48, v48, v14
    v_add_f32_e64 v49, v49, v14
    v_cvt_pk_bf16_f32 v64, v34, v35
    v_cvt_pk_bf16_f32 v65, v36, v37
    v_cvt_pk_bf16_f32 v66, v38, v39
    v_cvt_pk_bf16_f32 v67, v40, v41
    v_cvt_pk_bf16_f32 v68, v42, v43
    v_cvt_pk_bf16_f32 v69, v44, v45
    v_cvt_pk_bf16_f32 v70, v46, v47
    v_cvt_pk_bf16_f32 v71, v48, v49
    v_lshlrev_b32 v34, 16, v64
    v_and_b32 v35, 0xffff0000, v64
    v_lshlrev_b32 v36, 16, v65
    v_and_b32 v37, 0xffff0000, v65
    v_lshlrev_b32 v38, 16, v66
    v_and_b32 v39, 0xffff0000, v66
    v_lshlrev_b32 v40, 16, v67
    v_and_b32 v41, 0xffff0000, v67
    v_lshlrev_b32 v42, 16, v68
    v_and_b32 v43, 0xffff0000, v68
    v_lshlrev_b32 v44, 16, v69
    v_and_b32 v45, 0xffff0000, v69
    v_lshlrev_b32 v46, 16, v70
    v_and_b32 v47, 0xffff0000, v70
    v_lshlrev_b32 v48, 16, v71
    v_and_b32 v49, 0xffff0000, v71
    v_mul_f32 v34, v34, v15
    v_mul_f32 v35, v35, v15
    v_mul_f32 v36, v36, v15
    v_mul_f32 v37, v37, v15
    v_mul_f32 v38, v38, v15
    v_mul_f32 v39, v39, v15
    v_mul_f32 v40, v40, v15
    v_mul_f32 v41, v41, v15
    v_mul_f32 v42, v42, v15
    v_mul_f32 v43, v43, v15
    v_mul_f32 v44, v44, v15
    v_mul_f32 v45, v45, v15
    v_mul_f32 v46, v46, v15
    v_mul_f32 v47, v47, v15
    v_mul_f32 v48, v48, v15
    v_mul_f32 v49, v49, v15
    v_cvt_pk_bf16_f32 v64, v34, v35
    v_cvt_pk_bf16_f32 v65, v36, v37
    v_cvt_pk_bf16_f32 v66, v38, v39
    v_cvt_pk_bf16_f32 v67, v40, v41
    v_cvt_pk_bf16_f32 v68, v42, v43
    v_cvt_pk_bf16_f32 v69, v44, v45
    v_cvt_pk_bf16_f32 v70, v46, v47
    v_cvt_pk_bf16_f32 v71, v48, v49
    s_waitcnt vmcnt(8)
    v_perm_b32 v136, v76, v72, s52
    v_perm_b32 v137, v84, v80, s52
    v_perm_b32 v138, v92, v88, s52
    v_perm_b32 v139, v100, v96, s52
    s_nop 1
    v_mfma_f32_16x16x32_bf16 v[32:35], v[64:67], v[136:139], 0
    v_perm_b32 v140, v76, v72, s53
    v_perm_b32 v141, v84, v80, s53
    v_perm_b32 v142, v92, v88, s53
    v_perm_b32 v143, v100, v96, s53
    s_nop 1
    v_mfma_f32_16x16x32_bf16 v[36:39], v[64:67], v[140:143], 0
    v_perm_b32 v136, v77, v73, s52
    v_perm_b32 v137, v85, v81, s52
    v_perm_b32 v138, v93, v89, s52
    v_perm_b32 v139, v101, v97, s52
    s_nop 1
    v_mfma_f32_16x16x32_bf16 v[40:43], v[64:67], v[136:139], 0
    v_perm_b32 v140, v77, v73, s53
    v_perm_b32 v141, v85, v81, s53
    v_perm_b32 v142, v93, v89, s53
    v_perm_b32 v143, v101, v97, s53
    s_nop 1
    v_mfma_f32_16x16x32_bf16 v[44:47], v[64:67], v[140:143], 0
    v_perm_b32 v136, v78, v74, s52
    v_perm_b32 v137, v86, v82, s52
    v_perm_b32 v138, v94, v90, s52
    v_perm_b32 v139, v102, v98, s52
    s_nop 1
    v_mfma_f32_16x16x32_bf16 v[48:51], v[64:67], v[136:139], 0
    v_perm_b32 v140, v78, v74, s53
    v_perm_b32 v141, v86, v82, s53
    v_perm_b32 v142, v94, v90, s53
    v_perm_b32 v143, v102, v98, s53
    s_nop 1
    v_mfma_f32_16x16x32_bf16 v[52:55], v[64:67], v[140:143], 0
    v_perm_b32 v136, v79, v75, s52
    v_perm_b32 v137, v87, v83, s52
    v_perm_b32 v138, v95, v91, s52
    v_perm_b32 v139, v103, v99, s52
    s_nop 1
    v_mfma_f32_16x16x32_bf16 v[56:59], v[64:67], v[136:139], 0
    v_perm_b32 v140, v79, v75, s53
    v_perm_b32 v141, v87, v83, s53
    v_perm_b32 v142, v95, v91, s53
    v_perm_b32 v143, v103, v99, s53
    s_nop 1
    v_mfma_f32_16x16x32_bf16 v[60:63], v[64:67], v[140:143], 0
    s_waitcnt vmcnt(0)
    s_add_u32 s79, s78, 0
    s_nop 0
    buffer_load_dwordx4 v[16:19], v160, s[80:83], s79 offen nt
    s_add_u32 s79, s78, 2048
    buffer_load_dwordx4 v[20:23], v160, s[80:83], s79 offen nt
    s_add_u32 s79, s78, 4096
    buffer_load_dwordx4 v[24:27], v160, s[80:83], s79 offen nt
    s_add_u32 s79, s78, 6144
    buffer_load_dwordx4 v[28:31], v160, s[80:83], s79 offen nt
    s_add_u32 s79, s78, 8192
    buffer_load_dwordx4 v[144:147], v160, s[80:83], s79 offen nt
    s_add_u32 s79, s78, 10240
    buffer_load_dwordx4 v[148:151], v160, s[80:83], s79 offen nt
    s_add_u32 s79, s78, 12288
    buffer_load_dwordx4 v[152:155], v160, s[80:83], s79 offen nt
    v_perm_b32 v136, v108, v104, s52
    v_perm_b32 v137, v116, v112, s52
    v_perm_b32 v138, v124, v120, s52
    v_perm_b32 v139, v132, v128, s52
    s_nop 1
    v_mfma_f32_16x16x32_bf16 v[32:35], v[68:71], v[136:139], v[32:35]
    v_perm_b32 v140, v108, v104, s53
    v_perm_b32 v141, v116, v112, s53
    v_perm_b32 v142, v124, v120, s53
    v_perm_b32 v143, v132, v128, s53
    s_nop 1
    v_mfma_f32_16x16x32_bf16 v[36:39], v[68:71], v[140:143], v[36:39]
    v_perm_b32 v136, v109, v105, s52
    v_perm_b32 v137, v117, v113, s52
    v_perm_b32 v138, v125, v121, s52
    v_perm_b32 v139, v133, v129, s52
    s_nop 1
    v_mfma_f32_16x16x32_bf16 v[40:43], v[68:71], v[136:139], v[40:43]
    v_perm_b32 v140, v109, v105, s53
    v_perm_b32 v141, v117, v113, s53
    v_perm_b32 v142, v125, v121, s53
    v_perm_b32 v143, v133, v129, s53
    s_nop 1
    v_mfma_f32_16x16x32_bf16 v[44:47], v[68:71], v[140:143], v[44:47]
    v_perm_b32 v136, v110, v106, s52
    v_perm_b32 v137, v118, v114, s52
    v_perm_b32 v138, v126, v122, s52
    v_perm_b32 v139, v134, v130, s52
    s_nop 1
    v_mfma_f32_16x16x32_bf16 v[48:51], v[68:71], v[136:139], v[48:51]
    v_perm_b32 v140, v110, v106, s53
    v_perm_b32 v141, v118, v114, s53
    v_perm_b32 v142, v126, v122, s53
    v_perm_b32 v143, v134, v130, s53
    s_nop 1
    v_mfma_f32_16x16x32_bf16 v[52:55], v[68:71], v[140:143], v[52:55]
    v_perm_b32 v136, v111, v107, s52
    v_perm_b32 v137, v119, v115, s52
    v_perm_b32 v138, v127, v123, s52
    v_perm_b32 v139, v135, v131, s52
    s_nop 1
    v_mfma_f32_16x16x32_bf16 v[56:59], v[68:71], v[136:139], v[56:59]
    v_perm_b32 v140, v111, v107, s53
    v_perm_b32 v141, v119, v115, s53
    v_perm_b32 v142, v127, v123, s53
    v_perm_b32 v143, v135, v131, s53
    s_nop 1
    v_mfma_f32_16x16x32_bf16 v[60:63], v[68:71], v[140:143], v[60:63]
    v_cmp_gt_u32 vcc, 32, v0
    s_nop 1
    v_cndmask_b32 v32, v48, v32, vcc
    v_cndmask_b32 v33, v49, v33, vcc
    v_cndmask_b32 v34, v50, v34, vcc
    v_cndmask_b32 v35, v51, v35, vcc
    ds_write_b128 v164, v[32:35]
    v_cndmask_b32 v36, v52, v36, vcc
    v_cndmask_b32 v37, v53, v37, vcc
    v_cndmask_b32 v38, v54, v38, vcc
    v_cndmask_b32 v39, v55, v39, vcc
    v_xor_b32 v4, 32, v164
    ds_write_b128 v4, v[36:39]
    v_cndmask_b32 v40, v56, v40, vcc
    v_cndmask_b32 v41, v57, v41, vcc
    v_cndmask_b32 v42, v58, v42, vcc
    v_cndmask_b32 v43, v59, v43, vcc
    v_xor_b32 v4, 64, v164
    ds_write_b128 v4, v[40:43]
    v_cndmask_b32 v44, v60, v44, vcc
    v_cndmask_b32 v45, v61, v45, vcc
    v_cndmask_b32 v46, v62, v46, vcc
    v_cndmask_b32 v47, v63, v47, vcc
    v_xor_b32 v4, 96, v164
    ds_write_b128 v4, v[44:47]
    v_mov_b32 v4, 1
    s_mov_b64 exec, 1
    ds_write_b32 v10, v4 offset:16
    s_mov_b64 exec, -1
    ds_read_b32 v12, v13
FW_42:
    s_waitcnt lgkmcnt(0)
    v_cmp_gt_u32 vcc, 1, v12
    s_cbranch_vccz FO_43
    s_sleep 1
    ds_read_b32 v12, v13
    s_branch FW_42
FO_43:
    ds_read_b128 v[72:75], v165 offset:0
    ds_read_b128 v[76:79], v165 offset:4096
    ds_read_b128 v[80:83], v165 offset:8192
    ds_read_b128 v[84:87], v165 offset:12288
    s_waitcnt lgkmcnt(0)
    v_add_f32 v72, v72, v76
    v_add_f32 v80, v80, v84
    v_add_f32 v73, v73, v77
    v_add_f32 v81, v81, v85
    v_add_f32 v74, v74, v78
    v_add_f32 v82, v82, v86
    v_add_f32 v75, v75, v79
    v_add_f32 v83, v83, v87
    v_add_f32 v72, v72, v80
    v_add_f32 v73, v73, v81
    v_add_f32 v74, v74, v82
    v_add_f32 v75, v75, v83
    v_max_u32 v72, 1, v72
    v_max_u32 v74, 1, v74
    buffer_store_dwordx4 v[72:75], v2, s[12:15], s77 offen sc0 sc1
    s_lshl_b32 s44, s38, 2
    s_add_u32 s44, s44, s3
    s_mul_i32 s44, s44, 64
    s_add_u32 s44, s44, 241664
    v_mov_b32 v4, 1
    s_mov_b64 exec, 1
    buffer_atomic_add v4, v8, s[24:27], s44 offen
    s_mov_b64 exec, -1
F_adown:
    v_mov_b32 v4, 2
    s_mov_b64 exec, 1
    ds_write_b32 v10, v4 offset:16
    s_mov_b64 exec, -1
    s_mul_i32 s36, s28, 112
    s_mul_i32 s37, s3, 28
    s_add_u32 s36, s36, s37
    v_min_u32 v4, 55, v0
    v_lshlrev_b32 v4, 4, v4
    s_lshl_b32 s38, s36, 5
    s_lshr_b32 s44, s36, 5
    s_mul_i32 s44, s44, 64
    s_add_u32 s45, s36, 27
    s_lshr_b32 s45, s45, 5
    s_mul_i32 s45, s45, 64
    s_add_u32 s56, s44, 0x83b000
    s_add_u32 s56, s72, s56
    s_addc_u32 s57, s73, 0
    s_add_u32 s58, s45, 0x83b000
    s_add_u32 s58, s72, s58
    s_addc_u32 s59, s73, 0
    v_mov_b32 v156, 0
    v_mov_b32 v157, 0
    v_mov_b32 v158, 0
    v_mov_b32 v159, 0
    s_mov_b32 s48, 0xbfb8aa3b
    ds_read_b32 v12, v163
FW_44:
    s_waitcnt lgkmcnt(0)
    v_cmp_gt_u32 vcc, 3, v12
    s_cbranch_vccz FO_45
    s_sleep 2
    ds_read_b32 v12, v163
    s_branch FW_44
FO_45:
    s_add_u32 s44, s88, 32768
    v_lshlrev_b32 v9, 3, v0
    v_add_u32 v9, s44, v9
    ds_write_b64 v9, v[156:157]
    v_lshrrev_b32 v11, 1, v0
    v_mul_u32_u24 v9, 37, v11
    v_lshrrev_b32 v9, 8, v9
W_8:
    s_cbranch_execz R_8
    s_nop 0
    v_add_u32 v11, v11, v9
    v_lshlrev_b32 v11, 1, v11
    v_and_b32 v9, 1, v0
    v_lshl_add_u32 v11, v9, 8, v11
    v_add_u32 v11, s44, v11
    v_and_b32 v9, 7, v0
    v_lshlrev_b32 v9, 6, v9
    v_lshl_add_u32 v9, v5, 4, v9
    v_add_u32 v9, s44, v9
    s_waitcnt vmcnt(2)
    s_cmp_lt_u32 s2, 224
    s_cbranch_scc1 F_dp
    s_waitcnt vmcnt(0)
F_dp:
    v_perm_b32 v72, v20, v16, s52
    v_perm_b32 v73, v28, v24, s52
    v_perm_b32 v74, v148, v144, s52
    v_perm_b32 v75, v156, v152, s52
    v_perm_b32 v76, v20, v16, s53
    v_perm_b32 v77, v28, v24, s53
    v_perm_b32 v78, v148, v144, s53
    v_perm_b32 v79, v156, v152, s53
    v_perm_b32 v80, v21, v17, s52
    v_perm_b32 v81, v29, v25, s52
    v_perm_b32 v82, v149, v145, s52
    v_perm_b32 v83, v157, v153, s52
    v_perm_b32 v84, v21, v17, s53
    v_perm_b32 v85, v29, v25, s53
    v_perm_b32 v86, v149, v145, s53
    v_perm_b32 v87, v157, v153, s53
    v_perm_b32 v88, v22, v18, s52
    v_perm_b32 v89, v30, v26, s52
    v_perm_b32 v90, v150, v146, s52
    v_perm_b32 v91, v158, v154, s52
    v_perm_b32 v92, v22, v18, s53
    v_perm_b32 v93, v30, v26, s53
    v_perm_b32 v94, v150, v146, s53
    v_perm_b32 v95, v158, v154, s53
    v_perm_b32 v96, v23, v19, s52
    v_perm_b32 v97, v31, v27, s52
    v_perm_b32 v98, v151, v147, s52
    v_perm_b32 v99, v159, v155, s52
    v_perm_b32 v100, v23, v19, s53
    v_perm_b32 v101, v31, v27, s53
    v_perm_b32 v102, v151, v147, s53
    v_perm_b32 v103, v159, v155, s53
    v_and_b32 v14, 1, v5
    v_lshlrev_b32 v14, 11, v14
    v_lshl_add_u32 v14, v7, 5, v14
    v_lshrrev_b32 v15, 1, v5
    v_lshl_add_u32 v14, v15, 4, v14
    v_add_u32 v14, s44, v14
    s_lshl_b32 s45, s3, 10
    s_add_u32 s45, s45, 32768
    v_add_u32 v15, s45, v3
    v_add_u32 v13, 48, v13
    v_and_b32 v17, 31, v0
    v_lshlrev_b32 v17, 4, v17
    s_mov_b32 s80, s68
    s_mov_b32 s81, s69
    s_mov_b32 s82, 0x400000
    s_mov_b32 s83, 0x00020000
    s_lshl_b32 s46, s3, 2
    v_add_u32 v16, s46, v5
    v_lshlrev_b32 v152, 4, v7
    v_mul_u32_u24 v18, 272, v16
    v_add3_u32 v153, v152, v18, 0
    v_lshl_add_u32 v152, v16, 11, v152
    s_lshl_b32 s78, s28, 17
    s_lshl_b32 s79, s29, 8
    s_add_u32 s78, s78, s79
    s_lshl_b32 s47, s28, 6
    s_add_u32 s47, s47, s46
    s_sub_u32 s47, 2047, s47
    s_mov_b32 s77, 0
    v_mov_b32 v144, 0
    v_mov_b32 v145, 0
    v_mov_b32 v146, 0
    v_mov_b32 v147, 0
    s_and_b32 s46, s60, 0x7ff
    s_sub_u32 s46, s47, s46
    s_and_b32 s45, s46, 0xffffffcc
    s_cbranch_scc1 SD_46
    s_mov_b32 s77, 1
    s_or_b32 s45, s60, 0x4000
    v_mov_b32 v18, s45
    v_cmp_eq_u32 vcc, s46, v5
    s_sub_u32 s46, s46, 16
    s_nop 0
    v_cndmask_b32 v144, v144, v18, vcc
    v_cmp_eq_u32 vcc, s46, v5
    s_sub_u32 s46, s46, 16
    s_nop 0
    v_cndmask_b32 v145, v145, v18, vcc
    v_cmp_eq_u32 vcc, s46, v5
    s_sub_u32 s46, s46, 16
    s_nop 0
    v_cndmask_b32 v146, v146, v18, vcc
    v_cmp_eq_u32 vcc, s46, v5
    s_sub_u32 s46, s46, 16
    s_nop 0
    v_cndmask_b32 v147, v147, v18, vcc
SD_46:
    s_and_b32 s46, s61, 0x7ff
    s_sub_u32 s46, s47, s46
    s_and_b32 s45, s46, 0xffffffcc
    s_cbranch_scc1 SD_47
    s_mov_b32 s77, 1
    s_or_b32 s45, s61, 0x4800
    v_mov_b32 v18, s45
    v_cmp_eq_u32 vcc, s46, v5
    s_sub_u32 s46, s46, 16
    s_nop 0
    v_cndmask_b32 v144, v144, v18, vcc
    v_cmp_eq_u32 vcc, s46, v5
    s_sub_u32 s46, s46, 16
    s_nop 0
    v_cndmask_b32 v145, v145, v18, vcc
    v_cmp_eq_u32 vcc, s46, v5
    s_sub_u32 s46, s46, 16
    s_nop 0
    v_cndmask_b32 v146, v146, v18, vcc
    v_cmp_eq_u32 vcc, s46, v5
    s_sub_u32 s46, s46, 16
    s_nop 0
    v_cndmask_b32 v147, v147, v18, vcc
SD_47:
    s_and_b32 s46, s62, 0x7ff
    s_sub_u32 s46, s47, s46
    s_and_b32 s45, s46, 0xffffffcc
    s_cbranch_scc1 SD_48
    s_mov_b32 s77, 1
    s_or_b32 s45, s62, 0x5000
    v_mov_b32 v18, s45
    v_cmp_eq_u32 vcc, s46, v5
    s_sub_u32 s46, s46, 16
    s_nop 0
    v_cndmask_b32 v144, v144, v18, vcc
    v_cmp_eq_u32 vcc, s46, v5
    s_sub_u32 s46, s46, 16
    s_nop 0
    v_cndmask_b32 v145, v145, v18, vcc
    v_cmp_eq_u32 vcc, s46, v5
    s_sub_u32 s46, s46, 16
    s_nop 0
    v_cndmask_b32 v146, v146, v18, vcc
    v_cmp_eq_u32 vcc, s46, v5
    s_sub_u32 s46, s46, 16
    s_nop 0
    v_cndmask_b32 v147, v147, v18, vcc
SD_48:
    s_and_b32 s46, s63, 0x7ff
    s_sub_u32 s46, s47, s46
    s_and_b32 s45, s46, 0xffffffcc
    s_cbranch_scc1 SD_49
    s_mov_b32 s77, 1
    s_or_b32 s45, s63, 0x5800
    v_mov_b32 v18, s45
    v_cmp_eq_u32 vcc, s46, v5
    s_sub_u32 s46, s46, 16
    s_nop 0
    v_cndmask_b32 v144, v144, v18, vcc
    v_cmp_eq_u32 vcc, s46, v5
    s_sub_u32 s46, s46, 16
    s_nop 0
    v_cndmask_b32 v145, v145, v18, vcc
    v_cmp_eq_u32 vcc, s46, v5
    s_sub_u32 s46, s46, 16
    s_nop 0
    v_cndmask_b32 v146, v146, v18, vcc
    v_cmp_eq_u32 vcc, s46, v5
    s_sub_u32 s46, s46, 16
    s_nop 0
    v_cndmask_b32 v147, v147, v18, vcc
SD_49:
    s_and_b32 s46, s64, 0x7ff
    s_sub_u32 s46, s47, s46
    s_and_b32 s45, s46, 0xffffffcc
    s_cbranch_scc1 SD_50
    s_mov_b32 s77, 1
    s_or_b32 s45, s64, 0x6000
    v_mov_b32 v18, s45
    v_cmp_eq_u32 vcc, s46, v5
    s_sub_u32 s46, s46, 16
    s_nop 0
    v_cndmask_b32 v144, v144, v18, vcc
    v_cmp_eq_u32 vcc, s46, v5
    s_sub_u32 s46, s46, 16
    s_nop 0
    v_cndmask_b32 v145, v145, v18, vcc
    v_cmp_eq_u32 vcc, s46, v5
    s_sub_u32 s46, s46, 16
    s_nop 0
    v_cndmask_b32 v146, v146, v18, vcc
    v_cmp_eq_u32 vcc, s46, v5
    s_sub_u32 s46, s46, 16
    s_nop 0
    v_cndmask_b32 v147, v147, v18, vcc
SD_50:
    s_and_b32 s46, s65, 0x7ff
    s_sub_u32 s46, s47, s46
    s_and_b32 s45, s46, 0xffffffcc
    s_cbranch_scc1 SD_51
    s_mov_b32 s77, 1
    s_or_b32 s45, s65, 0x6800
    v_mov_b32 v18, s45
    v_cmp_eq_u32 vcc, s46, v5
    s_sub_u32 s46, s46, 16
    s_nop 0
    v_cndmask_b32 v144, v144, v18, vcc
    v_cmp_eq_u32 vcc, s46, v5
    s_sub_u32 s46, s46, 16
    s_nop 0
    v_cndmask_b32 v145, v145, v18, vcc
    v_cmp_eq_u32 vcc, s46, v5
    s_sub_u32 s46, s46, 16
    s_nop 0
    v_cndmask_b32 v146, v146, v18, vcc
    v_cmp_eq_u32 vcc, s46, v5
    s_sub_u32 s46, s46, 16
    s_nop 0
    v_cndmask_b32 v147, v147, v18, vcc
SD_51:
    s_and_b32 s46, s66, 0x7ff
    s_sub_u32 s46, s47, s46
    s_and_b32 s45, s46, 0xffffffcc
    s_cbranch_scc1 SD_52
    s_mov_b32 s77, 1
    s_or_b32 s45, s66, 0x7000
    v_mov_b32 v18, s45
    v_cmp_eq_u32 vcc, s46, v5
    s_sub_u32 s46, s46, 16
    s_nop 0
    v_cndmask_b32 v144, v144, v18, vcc
    v_cmp_eq_u32 vcc, s46, v5
    s_sub_u32 s46, s46, 16
    s_nop 0
    v_cndmask_b32 v145, v145, v18, vcc
    v_cmp_eq_u32 vcc, s46, v5
    s_sub_u32 s46, s46, 16
    s_nop 0
    v_cndmask_b32 v146, v146, v18, vcc
    v_cmp_eq_u32 vcc, s46, v5
    s_sub_u32 s46, s46, 16
    s_nop 0
    v_cndmask_b32 v147, v147, v18, vcc
SD_52:
    s_and_b32 s46, s67, 0x7ff
    s_sub_u32 s46, s47, s46
    s_and_b32 s45, s46, 0xffffffcc
    s_cbranch_scc1 SD_53
    s_mov_b32 s77, 1
    s_or_b32 s45, s67, 0x7800
    v_mov_b32 v18, s45
    v_cmp_eq_u32 vcc, s46, v5
    s_sub_u32 s46, s46, 16
    s_nop 0
    v_cndmask_b32 v144, v144, v18, vcc
    v_cmp_eq_u32 vcc, s46, v5
    s_sub_u32 s46, s46, 16
    s_nop 0
    v_cndmask_b32 v145, v145, v18, vcc
    v_cmp_eq_u32 vcc, s46, v5
    s_sub_u32 s46, s46, 16
    s_nop 0
    v_cndmask_b32 v146, v146, v18, vcc
    v_cmp_eq_u32 vcc, s46, v5
    s_sub_u32 s46, s46, 16
    s_nop 0
    v_cndmask_b32 v147, v147, v18, vcc
SD_53:
    s_cmp_eq_u32 s77, 0
    s_cbranch_scc1 F_ys1
    v_lshlrev_b32 v19, 5, v7
    v_cmp_ne_u32 s[60:61], 0, v144
    v_and_b32 v148, 0xffff0000, v144
    v_ashrrev_i32 v18, 31, v148
    v_not_b32 v18, v18
    v_or_b32 v18, 0x80000000, v18
    v_xor_b32 v148, v148, v18
    v_and_b32 v148, 0xffff0000, v148
    v_mul_f32 v148, s48, v148
    v_exp_f32 v148, v148
    s_nop 0
    v_add_f32 v148, 1.0, v148
    v_rcp_f32 v148, v148
    s_nop 0
    v_cvt_pk_bf16_f32 v148, v148, v148
    v_lshlrev_b32 v148, 16, v148
    v_bfe_u32 v144, v144, 11, 3
    v_lshl_add_u32 v144, v144, 12, v19
    v_cmp_ne_u32 s[62:63], 0, v145
    v_and_b32 v149, 0xffff0000, v145
    v_ashrrev_i32 v18, 31, v149
    v_not_b32 v18, v18
    v_or_b32 v18, 0x80000000, v18
    v_xor_b32 v149, v149, v18
    v_and_b32 v149, 0xffff0000, v149
    v_mul_f32 v149, s48, v149
    v_exp_f32 v149, v149
    s_nop 0
    v_add_f32 v149, 1.0, v149
    v_rcp_f32 v149, v149
    s_nop 0
    v_cvt_pk_bf16_f32 v149, v149, v149
    v_lshlrev_b32 v149, 16, v149
    v_bfe_u32 v145, v145, 11, 3
    v_lshl_add_u32 v145, v145, 12, v19
    v_cmp_ne_u32 s[64:65], 0, v146
    v_and_b32 v150, 0xffff0000, v146
    v_ashrrev_i32 v18, 31, v150
    v_not_b32 v18, v18
    v_or_b32 v18, 0x80000000, v18
    v_xor_b32 v150, v150, v18
    v_and_b32 v150, 0xffff0000, v150
    v_mul_f32 v150, s48, v150
    v_exp_f32 v150, v150
    s_nop 0
    v_add_f32 v150, 1.0, v150
    v_rcp_f32 v150, v150
    s_nop 0
    v_cvt_pk_bf16_f32 v150, v150, v150
    v_lshlrev_b32 v150, 16, v150
    v_bfe_u32 v146, v146, 11, 3
    v_lshl_add_u32 v146, v146, 12, v19
    v_cmp_ne_u32 s[66:67], 0, v147
    v_and_b32 v151, 0xffff0000, v147
    v_ashrrev_i32 v18, 31, v151
    v_not_b32 v18, v18
    v_or_b32 v18, 0x80000000, v18
    v_xor_b32 v151, v151, v18
    v_and_b32 v151, 0xffff0000, v151
    v_mul_f32 v151, s48, v151
    v_exp_f32 v151, v151
    s_nop 0
    v_add_f32 v151, 1.0, v151
    v_rcp_f32 v151, v151
    s_nop 0
    v_cvt_pk_bf16_f32 v151, v151, v151
    v_lshlrev_b32 v151, 16, v151
    v_bfe_u32 v147, v147, 11, 3
    v_lshl_add_u32 v147, v147, 12, v19
F_ys1:
SP_54:
    s_load_dword s74, s[56:57], 0 glc
    s_load_dword s75, s[58:59], 0 glc
    s_waitcnt lgkmcnt(0)
    s_min_u32 s74, s74, s75
    s_cmp_ge_u32 s74, 8
    s_cbranch_scc1 SD_55
    s_sleep 16
    s_branch SP_54
SD_55:
F_dl:
    s_add_u32 s45, s38, 0
    buffer_load_dwordx4 v[32:35], v4, s[12:15], s45 offen sc0 sc1
    s_add_u32 s45, s38, 114688
    buffer_load_dwordx4 v[36:39], v4, s[12:15], s45 offen sc0 sc1
    s_add_u32 s45, s38, 229376
    buffer_load_dwordx4 v[40:43], v4, s[12:15], s45 offen sc0 sc1
    s_add_u32 s45, s38, 344064
    buffer_load_dwordx4 v[44:47], v4, s[12:15], s45 offen sc0 sc1
    s_add_u32 s45, s38, 458752
    buffer_load_dwordx4 v[48:51], v4, s[12:15], s45 offen sc0 sc1
    s_add_u32 s45, s38, 573440
    buffer_load_dwordx4 v[52:55], v4, s[12:15], s45 offen sc0 sc1
    s_add_u32 s45, s38, 688128
    buffer_load_dwordx4 v[56:59], v4, s[12:15], s45 offen sc0 sc1
    s_add_u32 s45, s38, 802816
    buffer_load_dwordx4 v[60:63], v4, s[12:15], s45 offen sc0 sc1
    s_waitcnt vmcnt(0)
    s_nop 0
    v_min3_u32 v12, v32, v34, v36
    v_min3_u32 v12, v12, v38, v40
    v_min3_u32 v12, v12, v42, v44
    v_min3_u32 v12, v12, v46, v48
    v_min3_u32 v12, v12, v50, v52
    v_min3_u32 v12, v12, v54, v56
    v_min3_u32 v12, v12, v58, v60
    v_min_u32 v12, v12, v62
    v_cmp_eq_u32 vcc, 0, v12
    s_cbranch_vccz F_dm
    s_sleep 6
    s_branch F_dl
F_dm:
    v_add_f32 v32, v32, v40
    v_add_f32 v48, v48, v56
    v_add_f32 v33, v33, v41
    v_add_f32 v49, v49, v57
    v_add_f32 v34, v34, v42
    v_add_f32 v50, v50, v58
    v_add_f32 v35, v35, v43
    v_add_f32 v51, v51, v59
    v_add_f32 v32, v32, v48
    v_add_f32 v33, v33, v49
    v_add_f32 v34, v34, v50
    v_add_f32 v35, v35, v51
    v_add_f32 v36, v36, v44
    v_add_f32 v52, v52, v60
    v_add_f32 v37, v37, v45
    v_add_f32 v53, v53, v61
    v_add_f32 v38, v38, v46
    v_add_f32 v54, v54, v62
    v_add_f32 v39, v39, v47
    v_add_f32 v55, v55, v63
    v_add_f32 v36, v36, v52
    v_add_f32 v37, v37, v53
    v_add_f32 v38, v38, v54
    v_add_f32 v39, v39, v55
    v_cvt_pk_bf16_f32 v40, v32, v36
    v_cvt_pk_bf16_f32 v41, v33, v37
    v_cvt_pk_bf16_f32 v42, v34, v38
    v_cvt_pk_bf16_f32 v43, v35, v39
    v_lshlrev_b32 v32, 16, v40
    v_and_b32 v36, 0xffff0000, v40
    v_lshlrev_b32 v33, 16, v41
    v_and_b32 v37, 0xffff0000, v41
    v_lshlrev_b32 v34, 16, v42
    v_and_b32 v38, 0xffff0000, v42
    v_lshlrev_b32 v35, 16, v43
    v_and_b32 v39, 0xffff0000, v43
    v_mul_f32 v40, s48, v32
    v_mul_f32 v41, s48, v33
    v_mul_f32 v42, s48, v34
    v_mul_f32 v43, s48, v35
    v_exp_f32 v40, v40
    v_exp_f32 v41, v41
    v_exp_f32 v42, v42
    v_exp_f32 v43, v43
    v_add_f32 v40, 1.0, v40
    v_add_f32 v41, 1.0, v41
    v_add_f32 v42, 1.0, v42
    v_add_f32 v43, 1.0, v43
    v_rcp_f32 v40, v40
    v_rcp_f32 v41, v41
    v_rcp_f32 v42, v42
    v_rcp_f32 v43, v43
    v_mul_f32 v32, v32, v40
    v_mul_f32 v33, v33, v41
    v_mul_f32 v34, v34, v42
    v_mul_f32 v35, v35, v43
    v_cvt_pk_bf16_f32 v32, v32, v32
    v_cvt_pk_bf16_f32 v33, v33, v33
    v_cvt_pk_bf16_f32 v34, v34, v34
    v_cvt_pk_bf16_f32 v35, v35, v35
    v_lshlrev_b32 v32, 16, v32
    v_lshlrev_b32 v33, 16, v33
    v_lshlrev_b32 v34, 16, v34
    v_lshlrev_b32 v35, 16, v35
    v_mul_f32 v32, v32, v36
    v_mul_f32 v33, v33, v37
    v_mul_f32 v34, v34, v38
    v_mul_f32 v35, v35, v39
    v_cvt_pk_bf16_f32 v32, v32, v32
    v_cvt_pk_bf16_f32 v33, v33, v33
    v_cvt_pk_bf16_f32 v34, v34, v34
    v_cvt_pk_bf16_f32 v35, v35, v35
    v_cmp_gt_u32 vcc, 56, v0
    s_nop 0
    s_and_saveexec_b64 s[50:51], vcc
    ds_write_b16 v11, v32 offset:0
    ds_write_b16 v11, v33 offset:64
    ds_write_b16 v11, v34 offset:128
    ds_write_b16 v11, v35 offset:192
    s_mov_b64 exec, s[50:51]
    ds_read_b128 v[64:67], v9
    s_waitcnt lgkmcnt(0)
    v_mfma_f32_16x16x32_bf16 v[104:107], v[64:67], v[72:75], 0
    v_mfma_f32_16x16x32_bf16 v[108:111], v[64:67], v[76:79], 0
    v_mfma_f32_16x16x32_bf16 v[112:115], v[64:67], v[80:83], 0
    v_mfma_f32_16x16x32_bf16 v[116:119], v[64:67], v[84:87], 0
    v_mfma_f32_16x16x32_bf16 v[120:123], v[64:67], v[88:91], 0
    v_mfma_f32_16x16x32_bf16 v[124:127], v[64:67], v[92:95], 0
    v_mfma_f32_16x16x32_bf16 v[128:131], v[64:67], v[96:99], 0
    v_mfma_f32_16x16x32_bf16 v[132:135], v[64:67], v[100:103], 0
    v_cmp_gt_u32 vcc, 32, v0
    s_nop 3
    v_cndmask_b32 v32, v120, v104, vcc
    v_cndmask_b32 v33, v124, v108, vcc
    v_cndmask_b32 v34, v128, v112, vcc
    v_cndmask_b32 v35, v132, v116, vcc
    ds_write_b128 v14, v[32:35] offset:0
    v_cndmask_b32 v36, v121, v105, vcc
    v_cndmask_b32 v37, v125, v109, vcc
    v_cndmask_b32 v38, v129, v113, vcc
    v_cndmask_b32 v39, v133, v117, vcc
    ds_write_b128 v14, v[36:39] offset:512
    v_cndmask_b32 v40, v122, v106, vcc
    v_cndmask_b32 v41, v126, v110, vcc
    v_cndmask_b32 v42, v130, v114, vcc
    v_cndmask_b32 v43, v134, v118, vcc
    ds_write_b128 v14, v[40:43] offset:1024
    v_cndmask_b32 v44, v123, v107, vcc
    v_cndmask_b32 v45, v127, v111, vcc
    v_cndmask_b32 v46, v131, v115, vcc
    v_cndmask_b32 v47, v135, v119, vcc
    ds_write_b128 v14, v[44:47] offset:1536
    v_mov_b32 v4, 1
    s_mov_b64 exec, 1
    ds_write_b32 v10, v4 offset:64
    s_mov_b64 exec, -1
    s_lshl_b32 s45, s29, 7
    s_add_u32 s56, s45, 0x82a000
    s_add_u32 s56, s72, s56
    s_addc_u32 s57, s73, 0
    s_lshl_b32 s44, s3, 13
    s_lshl_b32 s50, s29, 9
    s_add_u32 s50, s50, 135168
    s_add_u32 s44, s44, s50
    s_add_u32 s45, s44, 4096
    ds_read_b32 v12, v13
FW_56:
    s_waitcnt lgkmcnt(0)
    v_cmp_gt_u32 vcc, 1, v12
    s_cbranch_vccz FO_57
    s_sleep 1
    ds_read_b32 v12, v13
    s_branch FW_56
FO_57:
    ds_read2st64_b32 v[48:49], v15 offset0:0 offset1:1
    ds_read2st64_b32 v[52:53], v15 offset0:16 offset1:17
    ds_read2st64_b32 v[56:57], v15 offset0:96 offset1:97
    ds_read2st64_b32 v[60:61], v15 offset0:112 offset1:113
    ds_read2st64_b32 v[50:51], v15 offset0:2 offset1:3
    ds_read2st64_b32 v[54:55], v15 offset0:18 offset1:19
    ds_read2st64_b32 v[58:59], v15 offset0:98 offset1:99
    ds_read2st64_b32 v[62:63], v15 offset0:114 offset1:115
    s_waitcnt lgkmcnt(4)
    v_add_f32 v48, v48, v52
    v_add_f32 v56, v56, v60
    v_add_f32 v48, v48, v56
    buffer_atomic_add_f32 v48, v3, s[24:27], s44 offen offset:0
    v_add_f32 v49, v49, v53
    v_add_f32 v57, v57, v61
    v_add_f32 v49, v49, v57
    buffer_atomic_add_f32 v49, v3, s[24:27], s44 offen offset:256
    s_waitcnt lgkmcnt(0)
    v_add_f32 v50, v50, v54
    v_add_f32 v58, v58, v62
    v_add_f32 v50, v50, v58
    buffer_atomic_add_f32 v50, v3, s[24:27], s45 offen offset:0
    v_add_f32 v51, v51, v55
    v_add_f32 v59, v59, v63
    v_add_f32 v51, v51, v59
    buffer_atomic_add_f32 v51, v3, s[24:27], s45 offen offset:256
    s_barrier
    s_barrier
    s_barrier
    s_barrier
    s_waitcnt vmcnt(0)
    s_barrier
    s_cmp_lg_u32 s3, 0
    s_cbranch_scc1 F_y0
    s_mov_b32 s76, 1
    s_atomic_add s76, s[56:57], 0
F_y0:
    s_barrier
    s_barrier
    s_barrier
    s_barrier
    s_barrier
    s_barrier
    s_cmp_lg_u32 s77, 0
    s_cbranch_scc1 F_y1
    s_barrier
    s_barrier
    s_barrier
    s_barrier
    s_barrier
F_y3:
    s_waitcnt lgkmcnt(0)
    s_setprio 3
    s_barrier
    ds_read_b128 v[16:19], v153 offset:0
    s_cmp_lg_u32 s77, 0
    s_waitcnt lgkmcnt(0)
    s_cbranch_scc1 F_ya0
F_yb0:
    buffer_store_dwordx4 v[16:19], v152, s[80:83], s78 offen sc1
    s_add_u32 s78, s78, 32768
    s_barrier
    ds_read_b128 v[20:23], v153 offset:4352
    s_cmp_lg_u32 s77, 0
    s_waitcnt lgkmcnt(0)
    s_cbranch_scc1 F_ya1
F_yb1:
    buffer_store_dwordx4 v[20:23], v152, s[80:83], s78 offen sc1
    s_add_u32 s78, s78, 32768
    s_barrier
    ds_read_b128 v[24:27], v153 offset:8704
    ds_read_b128 v[28:31], v153 offset:13056
    s_cmp_lg_u32 s77, 0
    s_waitcnt lgkmcnt(1)
    s_cbranch_scc1 F_ya2
F_yb2:
    buffer_store_dwordx4 v[24:27], v152, s[80:83], s78 offen sc1
    s_add_u32 s78, s78, 32768
    s_cmp_lg_u32 s77, 0
    s_waitcnt lgkmcnt(0)
    s_cbranch_scc1 F_ya3
F_yb3:
    buffer_store_dwordx4 v[28:31], v152, s[80:83], s78 offen sc1
    s_add_u32 s78, s78, 32768
    s_endpgm
F_y1:
    s_load_dword s58, s[56:57], 0 glc
    s_barrier
    s_barrier
    s_waitcnt lgkmcnt(0)
    s_cmp_lt_u32 s58, 32
    s_cbranch_scc1 F_y2
    s_mov_b64 exec, s[60:61]
    s_cbranch_execz YL_58
    buffer_load_dwordx4 v[72:75], v144, s[24:27], s50 offen offset:0 sc0 sc1
    buffer_load_dwordx4 v[76:79], v144, s[24:27], s50 offen offset:16 sc0 sc1
YL_58:
    s_mov_b64 exec, s[62:63]
    s_cbranch_execz YL_59
    buffer_load_dwordx4 v[80:83], v145, s[24:27], s50 offen offset:0 sc0 sc1
    buffer_load_dwordx4 v[84:87], v145, s[24:27], s50 offen offset:16 sc0 sc1
YL_59:
    s_mov_b64 exec, s[64:65]
    s_cbranch_execz YL_60
    buffer_load_dwordx4 v[88:91], v146, s[24:27], s50 offen offset:0 sc0 sc1
    buffer_load_dwordx4 v[92:95], v146, s[24:27], s50 offen offset:16 sc0 sc1
YL_60:
    s_mov_b64 exec, s[66:67]
    s_cbranch_execz YL_61
    buffer_load_dwordx4 v[96:99], v147, s[24:27], s50 offen offset:0 sc0 sc1
    buffer_load_dwordx4 v[100:103], v147, s[24:27], s50 offen offset:16 sc0 sc1
YL_61:
    s_mov_b64 exec, -1
    s_barrier
    s_barrier
    s_barrier
    s_branch F_y3
F_y2:
    s_barrier
    s_barrier
    s_barrier
SP_62:
    s_load_dword s58, s[56:57], 0 glc
    s_waitcnt lgkmcnt(0)
    s_cmp_ge_u32 s58, 32
    s_cbranch_scc1 SD_63
    s_sleep 2
    s_branch SP_62
SD_63:
    s_mov_b64 exec, s[60:61]
    s_cbranch_execz YL_64
    buffer_load_dwordx4 v[72:75], v144, s[24:27], s50 offen offset:0 sc0 sc1
    buffer_load_dwordx4 v[76:79], v144, s[24:27], s50 offen offset:16 sc0 sc1
YL_64:
    s_mov_b64 exec, s[62:63]
    s_cbranch_execz YL_65
    buffer_load_dwordx4 v[80:83], v145, s[24:27], s50 offen offset:0 sc0 sc1
    buffer_load_dwordx4 v[84:87], v145, s[24:27], s50 offen offset:16 sc0 sc1
YL_65:
    s_mov_b64 exec, s[64:65]
    s_cbranch_execz YL_66
    buffer_load_dwordx4 v[88:91], v146, s[24:27], s50 offen offset:0 sc0 sc1
    buffer_load_dwordx4 v[92:95], v146, s[24:27], s50 offen offset:16 sc0 sc1
YL_66:
    s_mov_b64 exec, s[66:67]
    s_cbranch_execz YL_67
    buffer_load_dwordx4 v[96:99], v147, s[24:27], s50 offen offset:0 sc0 sc1
    buffer_load_dwordx4 v[100:103], v147, s[24:27], s50 offen offset:16 sc0 sc1
YL_67:
    s_mov_b64 exec, -1
    s_branch F_y3
F_ya0:
    s_cmp_eq_u64 s[60:61], 0
    s_cbranch_scc1 F_yb0
    s_mov_b64 exec, s[60:61]
    v_lshlrev_b32 v32, 16, v16
    v_and_b32 v33, 0xffff0000, v16
    v_lshlrev_b32 v34, 16, v17
    v_and_b32 v35, 0xffff0000, v17
    v_lshlrev_b32 v36, 16, v18
    v_and_b32 v37, 0xffff0000, v18
    v_lshlrev_b32 v38, 16, v19
    v_and_b32 v39, 0xffff0000, v19
    s_waitcnt vmcnt(0)
    v_fmac_f32 v32, v72, v148
    v_fmac_f32 v33, v73, v148
    v_fmac_f32 v34, v74, v148
    v_fmac_f32 v35, v75, v148
    v_fmac_f32 v36, v76, v148
    v_fmac_f32 v37, v77, v148
    v_fmac_f32 v38, v78, v148
    v_fmac_f32 v39, v79, v148
    v_cvt_pk_bf16_f32 v16, v32, v33
    v_cvt_pk_bf16_f32 v17, v34, v35
    v_cvt_pk_bf16_f32 v18, v36, v37
    v_cvt_pk_bf16_f32 v19, v38, v39
    s_mov_b64 exec, -1
    s_branch F_yb0
F_ya1:
    s_cmp_eq_u64 s[62:63], 0
    s_cbranch_scc1 F_yb1
    s_mov_b64 exec, s[62:63]
    v_lshlrev_b32 v32, 16, v20
    v_and_b32 v33, 0xffff0000, v20
    v_lshlrev_b32 v34, 16, v21
    v_and_b32 v35, 0xffff0000, v21
    v_lshlrev_b32 v36, 16, v22
    v_and_b32 v37, 0xffff0000, v22
    v_lshlrev_b32 v38, 16, v23
    v_and_b32 v39, 0xffff0000, v23
    s_waitcnt vmcnt(1)
    v_fmac_f32 v32, v80, v149
    v_fmac_f32 v33, v81, v149
    v_fmac_f32 v34, v82, v149
    v_fmac_f32 v35, v83, v149
    v_fmac_f32 v36, v84, v149
    v_fmac_f32 v37, v85, v149
    v_fmac_f32 v38, v86, v149
    v_fmac_f32 v39, v87, v149
    v_cvt_pk_bf16_f32 v20, v32, v33
    v_cvt_pk_bf16_f32 v21, v34, v35
    v_cvt_pk_bf16_f32 v22, v36, v37
    v_cvt_pk_bf16_f32 v23, v38, v39
    s_mov_b64 exec, -1
    s_branch F_yb1
F_ya2:
    s_cmp_eq_u64 s[64:65], 0
    s_cbranch_scc1 F_yb2
    s_mov_b64 exec, s[64:65]
    v_lshlrev_b32 v32, 16, v24
    v_and_b32 v33, 0xffff0000, v24
    v_lshlrev_b32 v34, 16, v25
    v_and_b32 v35, 0xffff0000, v25
    v_lshlrev_b32 v36, 16, v26
    v_and_b32 v37, 0xffff0000, v26
    v_lshlrev_b32 v38, 16, v27
    v_and_b32 v39, 0xffff0000, v27
    s_waitcnt vmcnt(2)
    v_fmac_f32 v32, v88, v150
    v_fmac_f32 v33, v89, v150
    v_fmac_f32 v34, v90, v150
    v_fmac_f32 v35, v91, v150
    v_fmac_f32 v36, v92, v150
    v_fmac_f32 v37, v93, v150
    v_fmac_f32 v38, v94, v150
    v_fmac_f32 v39, v95, v150
    v_cvt_pk_bf16_f32 v24, v32, v33
    v_cvt_pk_bf16_f32 v25, v34, v35
    v_cvt_pk_bf16_f32 v26, v36, v37
    v_cvt_pk_bf16_f32 v27, v38, v39
    s_mov_b64 exec, -1
    s_branch F_yb2
F_ya3:
    s_cmp_eq_u64 s[66:67], 0
    s_cbranch_scc1 F_yb3
    s_mov_b64 exec, s[66:67]
    v_lshlrev_b32 v32, 16, v28
    v_and_b32 v33, 0xffff0000, v28
    v_lshlrev_b32 v34, 16, v29
    v_and_b32 v35, 0xffff0000, v29
    v_lshlrev_b32 v36, 16, v30
    v_and_b32 v37, 0xffff0000, v30
    v_lshlrev_b32 v38, 16, v31
    v_and_b32 v39, 0xffff0000, v31
    s_waitcnt vmcnt(3)
    v_fmac_f32 v32, v96, v151
    v_fmac_f32 v33, v97, v151
    v_fmac_f32 v34, v98, v151
    v_fmac_f32 v35, v99, v151
    v_fmac_f32 v36, v100, v151
    v_fmac_f32 v37, v101, v151
    v_fmac_f32 v38, v102, v151
    v_fmac_f32 v39, v103, v151
    v_cvt_pk_bf16_f32 v28, v32, v33
    v_cvt_pk_bf16_f32 v29, v34, v35
    v_cvt_pk_bf16_f32 v30, v36, v37
    v_cvt_pk_bf16_f32 v31, v38, v39
    s_mov_b64 exec, -1
    s_branch F_yb3
F_codeend:
.section .rodata,"a"
.p2align 6
.amdhsa_kernel parallel_sum__linear_attn_block__moe_arch_mod__prompt_kernel
  .amdhsa_next_free_vgpr 168
  .amdhsa_next_free_sgpr 96
  .amdhsa_accum_offset 168
  .amdhsa_group_segment_fixed_size 0
  .amdhsa_kernarg_size 88
  .amdhsa_user_sgpr_count 2
  .amdhsa_user_sgpr_kernarg_segment_ptr 1
  .amdhsa_system_sgpr_workgroup_id_x 1
  .amdhsa_float_denorm_mode_32 3
  .amdhsa_float_denorm_mode_16_64 3
.end_amdhsa_kernel
```

```asm
; @launch grid=(256,1,1) block=(768,1,1) lds=163840
.amdgcn_target "amdgcn-amd-amdhsa--gfx950"
.text
.globl parallel_sum__linear_attn_block__moe_arch_mod__prompt_kernel
.p2align 8
.type parallel_sum__linear_attn_block__moe_arch_mod__prompt_kernel,@function
parallel_sum__linear_attn_block__moe_arch_mod__prompt_kernel:
    s_load_dwordx4 s[4:7], s[0:1], 0
    s_load_dwordx8 s[60:67], s[0:1], 32
    s_load_dwordx2 s[72:73], s[0:1], 80
    s_load_dwordx4 s[68:71], s[0:1], 64
    s_load_dwordx2 s[8:9], s[0:1], 16
    s_cmp_ge_u32 s2, 256
    s_cbranch_scc1 F_end
    v_lshrrev_b32 v1, 6, v0
    v_and_b32 v0, 63, v0
    s_and_b32 s30, s2, 7
    v_readfirstlane_b32 s3, v1
    s_lshr_b32 s31, s2, 3
    s_and_b32 s32, s30, 1
    s_lshl_b32 s32, s32, 3
    s_and_b32 s35, s31, 7
    s_add_u32 s32, s32, s35
    s_lshr_b32 s33, s30, 1
    s_lshl_b32 s33, s33, 2
    s_lshr_b32 s34, s31, 3
    s_xor_b32 s34, s34, 0
    s_add_u32 s33, s33, s34
    s_lshl_b32 s28, s32, 1
    s_bfe_u32 s29, s30, 0x10001
    s_add_u32 s28, s28, s29
    s_lshl_b32 s29, s30, 2
    s_xor_b32 s29, s29, s30
    s_and_b32 s29, s29, 4
    s_add_u32 s29, s29, s34
    s_lshl_b32 s39, s29, 1
    s_xor_b32 s39, s39, 14
    s_add_u32 s10, s33, 4
    s_and_b32 s10, s10, 15
    v_lshlrev_b32 v2, 4, v0
    s_cmp_ge_u32 s3, 8
    s_cbranch_scc1 F_loader
    s_lshl_b32 s77, s32, 4
    s_add_u32 s77, s77, s33
    s_lshl_b32 s77, s77, 3
    s_add_u32 s77, s77, s3
    s_cmp_lg_u32 s3, 7
    s_cbranch_scc1 F_nt
    s_getpc_b64 s[46:47]
F_pc:
    s_sub_u32 s46, s46, F_pc-parallel_sum__linear_attn_block__moe_arch_mod__prompt_kernel
    s_subb_u32 s47, s47, 0
    s_and_b32 s44, s31, 7
    s_lshl_b32 s44, s44, 13
    v_min_u32 v60, 63, v0
    v_lshlrev_b32 v60, 7, v60
    v_add_u32_e64 v60, s44, v60
    v_min_u32 v60, F_codeend-parallel_sum__linear_attn_block__moe_arch_mod__prompt_kernel-4, v60
    global_load_dword v161, v60, s[46:47]
F_nt:
    s_lshl_b32 s44, s77, 11
    s_waitcnt lgkmcnt(0)

    s_mov_b32 s20, s4
    s_mov_b32 s21, s5
    s_mov_b32 s22, 0x400000
    s_mov_b32 s23, 0x00020000
    buffer_load_dwordx4 v[4:7], v2, s[20:23], s44 offen
    buffer_load_dwordx4 v[8:11], v2, s[20:23], s44 offen offset:1024
    s_mov_b32 s16, s60
    s_mov_b32 s17, s61
    s_mov_b32 s18, 0x800
    s_mov_b32 s19, 0x00020000
    buffer_load_dwordx4 v[12:15], v2, s[16:19], 0 offen
    buffer_load_dwordx4 v[16:19], v2, s[16:19], 0 offen offset:1024
    s_add_u32 s24, s72, 0x800000
    s_addc_u32 s25, s73, 0
    s_mov_b32 s26, 0x100000
    s_mov_b32 s27, 0x00020000
    s_add_u32 s40, s72, 0x900000
    s_addc_u32 s41, s73, 0
    s_mov_b32 s42, 0x18000
    s_mov_b32 s43, 0x00020000
    s_mov_b32 s48, s70
    s_mov_b32 s49, s71
    s_mov_b32 s50, 0x100
    s_mov_b32 s51, 0x00020000
    v_mov_b32 v20, 0
    v_mov_b32 v21, 0
    v_mov_b32 v22, 0
    v_mov_b32 v23, 0
    s_cmp_lg_u32 s3, 5
    s_cbranch_scc1 F_a0
    s_cmp_lg_u32 s33, 0
    s_cbranch_scc1 F_a0
    s_lshl_b32 s44, s32, 8
    s_add_u32 s44, s44, 32768
    s_lshl_b32 s45, s32, 2
    s_mov_b64 exec, 0xffff
    buffer_store_dwordx4 v[20:23], v2, s[40:43], s44 offen sc0 sc1
    s_mov_b64 exec, 1
    s_waitcnt vmcnt(0)
    v_mov_b32 v24, 1
    buffer_store_dword v24, v20, s[48:51], s45 offen sc0 sc1
    s_mov_b64 exec, -1
    s_branch F_a1
F_a0:

    s_cmp_ge_u32 s3, 4
    s_cbranch_scc1 F_z1
    v_mov_b64 v[68:69], 0
    v_mov_b64 v[70:71], 0
    v_mov_b64 v[72:73], 0
    v_mov_b64 v[74:75], 0
    v_mov_b64 v[76:77], 0
    v_mov_b64 v[78:79], 0
    v_mov_b64 v[80:81], 0
    v_mov_b64 v[82:83], 0
    v_mov_b64 v[84:85], 0
    v_mov_b64 v[86:87], 0
    v_mov_b64 v[88:89], 0
    v_mov_b64 v[90:91], 0
    v_mov_b64 v[92:93], 0
    v_mov_b64 v[94:95], 0
    v_mov_b64 v[96:97], 0
    v_mov_b64 v[98:99], 0
    v_mov_b64 v[100:101], 0
    v_mov_b64 v[102:103], 0
    v_mov_b64 v[104:105], 0
    v_mov_b64 v[106:107], 0
    v_mov_b64 v[108:109], 0
    v_mov_b64 v[110:111], 0
    v_mov_b64 v[112:113], 0
    v_mov_b64 v[114:115], 0
    v_mov_b64 v[116:117], 0
    v_mov_b64 v[118:119], 0
    v_mov_b64 v[120:121], 0
    v_mov_b64 v[122:123], 0
    v_mov_b64 v[124:125], 0
    v_mov_b64 v[126:127], 0
    v_mov_b64 v[128:129], 0
    v_mov_b64 v[130:131], 0
    v_mov_b64 v[132:133], 0
    v_mov_b64 v[134:135], 0
    v_mov_b64 v[136:137], 0
    v_mov_b64 v[138:139], 0
    v_mov_b64 v[140:141], 0
    v_mov_b64 v[142:143], 0
    v_mov_b64 v[144:145], 0
    v_mov_b64 v[146:147], 0
    v_mov_b64 v[148:149], 0
    v_mov_b64 v[150:151], 0
    v_mov_b64 v[152:153], 0
    v_mov_b64 v[154:155], 0
    v_mov_b64 v[156:157], 0
    v_mov_b64 v[158:159], 0
    v_mov_b64 v[160:161], 0
    v_mov_b64 v[162:163], 0
F_z1:
    s_waitcnt vmcnt(0)
F_a1:

    v_lshlrev_b32 v24, 16, v4
    v_and_b32 v25, 0xffff0000, v4
    v_lshlrev_b32 v26, 16, v5
    v_and_b32 v27, 0xffff0000, v5
    v_lshlrev_b32 v28, 16, v6
    v_and_b32 v29, 0xffff0000, v6
    v_lshlrev_b32 v30, 16, v7
    v_and_b32 v31, 0xffff0000, v7
    v_lshlrev_b32 v32, 16, v8
    v_and_b32 v33, 0xffff0000, v8
    v_lshlrev_b32 v34, 16, v9
    v_and_b32 v35, 0xffff0000, v9
    v_lshlrev_b32 v36, 16, v10
    v_and_b32 v37, 0xffff0000, v10
    v_lshlrev_b32 v38, 16, v11
    v_and_b32 v39, 0xffff0000, v11
    v_add_f32 v40, v24, v25
    v_add_f32 v41, v26, v27
    v_add_f32 v42, v28, v29
    v_add_f32 v43, v30, v31
    v_add_f32 v44, v32, v33
    v_add_f32 v45, v34, v35
    v_add_f32 v46, v36, v37
    v_add_f32 v47, v38, v39
    v_add_f32 v40, v40, v44
    v_add_f32 v41, v41, v45
    v_add_f32 v42, v42, v46
    v_add_f32 v43, v43, v47
    v_add_f32 v40, v40, v42
    v_add_f32 v41, v41, v43
    v_add_f32 v40, v40, v41
    s_nop 1
    v_add_f32_dpp v40, v40, v40 row_shr:1 row_mask:0xf bank_mask:0xf bound_ctrl:0
    s_nop 1
    v_add_f32_dpp v40, v40, v40 row_shr:2 row_mask:0xf bank_mask:0xf bound_ctrl:0
    s_nop 1
    v_add_f32_dpp v40, v40, v40 row_shr:4 row_mask:0xf bank_mask:0xf bound_ctrl:0
    s_nop 1
    v_add_f32_dpp v40, v40, v40 row_shr:8 row_mask:0xf bank_mask:0xf bound_ctrl:0
    s_nop 1
    v_add_f32_dpp v40, v40, v40 row_bcast:15 row_mask:0xa bank_mask:0xf
    s_nop 1
    v_add_f32_dpp v40, v40, v40 row_bcast:31 row_mask:0xc bank_mask:0xf
    s_nop 0
    v_readlane_b32 s52, v40, 63
    v_mov_b32 v41, 0x3a800000
    s_nop 0
    v_mul_f32 v41, s52, v41
    v_sub_f32 v44, v24, v41
    v_sub_f32 v45, v25, v41
    v_sub_f32 v46, v26, v41
    v_sub_f32 v47, v27, v41
    v_sub_f32 v48, v28, v41
    v_sub_f32 v49, v29, v41
    v_sub_f32 v50, v30, v41
    v_sub_f32 v51, v31, v41
    v_sub_f32 v52, v32, v41
    v_sub_f32 v53, v33, v41
    v_sub_f32 v54, v34, v41
    v_sub_f32 v55, v35, v41
    v_sub_f32 v56, v36, v41
    v_sub_f32 v57, v37, v41
    v_sub_f32 v58, v38, v41
    v_sub_f32 v59, v39, v41
    v_mul_f32 v40, v44, v44
    v_mul_f32 v42, v45, v45
    v_fmac_f32 v40, v46, v46
    v_fmac_f32 v42, v47, v47
    v_fmac_f32 v40, v48, v48
    v_fmac_f32 v42, v49, v49
    v_fmac_f32 v40, v50, v50
    v_fmac_f32 v42, v51, v51
    v_fmac_f32 v40, v52, v52
    v_fmac_f32 v42, v53, v53
    v_fmac_f32 v40, v54, v54
    v_fmac_f32 v42, v55, v55
    v_fmac_f32 v40, v56, v56
    v_fmac_f32 v42, v57, v57
    v_fmac_f32 v40, v58, v58
    v_fmac_f32 v42, v59, v59
    v_add_f32 v40, v40, v42
    s_nop 1
    v_add_f32_dpp v40, v40, v40 row_shr:1 row_mask:0xf bank_mask:0xf bound_ctrl:0
    s_nop 1
    v_add_f32_dpp v40, v40, v40 row_shr:2 row_mask:0xf bank_mask:0xf bound_ctrl:0
    s_nop 1
    v_add_f32_dpp v40, v40, v40 row_shr:4 row_mask:0xf bank_mask:0xf bound_ctrl:0
    s_nop 1
    v_add_f32_dpp v40, v40, v40 row_shr:8 row_mask:0xf bank_mask:0xf bound_ctrl:0
    s_nop 1
    v_add_f32_dpp v40, v40, v40 row_bcast:15 row_mask:0xa bank_mask:0xf
    s_nop 1
    v_add_f32_dpp v40, v40, v40 row_bcast:31 row_mask:0xc bank_mask:0xf
    s_nop 0
    v_readlane_b32 s52, v40, 63
    v_mov_b32 v42, 0x3a800000
    s_nop 0
    v_mul_f32 v42, s52, v42
    v_cvt_pk_bf16_f32 v43, v41, v42
    v_lshlrev_b32 v41, 16, v43
    v_and_b32 v42, 0xffff0000, v43
    v_add_f32 v42, 0x3727c5ac, v42
    v_cvt_pk_bf16_f32 v42, v42, v42
    v_lshlrev_b32 v42, 16, v42
    v_sqrt_f32 v42, v42
    s_nop 0
    v_cvt_pk_bf16_f32 v42, v42, v42
    v_lshlrev_b32 v42, 16, v42
    v_rcp_f32 v42, v42
    v_sub_f32 v24, v24, v41
    v_sub_f32 v25, v25, v41
    v_sub_f32 v26, v26, v41
    v_sub_f32 v27, v27, v41
    v_sub_f32 v28, v28, v41
    v_sub_f32 v29, v29, v41
    v_sub_f32 v30, v30, v41
    v_sub_f32 v31, v31, v41
    v_sub_f32 v32, v32, v41
    v_sub_f32 v33, v33, v41
    v_sub_f32 v34, v34, v41
    v_sub_f32 v35, v35, v41
    v_sub_f32 v36, v36, v41
    v_sub_f32 v37, v37, v41
    v_sub_f32 v38, v38, v41
    v_sub_f32 v39, v39, v41
    v_cvt_pk_bf16_f32 v4, v24, v25
    v_cvt_pk_bf16_f32 v5, v26, v27
    v_cvt_pk_bf16_f32 v6, v28, v29
    v_cvt_pk_bf16_f32 v7, v30, v31
    v_cvt_pk_bf16_f32 v8, v32, v33
    v_cvt_pk_bf16_f32 v9, v34, v35
    v_cvt_pk_bf16_f32 v10, v36, v37
    v_cvt_pk_bf16_f32 v11, v38, v39
    v_lshlrev_b32 v24, 16, v4
    v_and_b32 v25, 0xffff0000, v4
    v_lshlrev_b32 v26, 16, v5
    v_and_b32 v27, 0xffff0000, v5
    v_lshlrev_b32 v28, 16, v6
    v_and_b32 v29, 0xffff0000, v6
    v_lshlrev_b32 v30, 16, v7
    v_and_b32 v31, 0xffff0000, v7
    v_lshlrev_b32 v32, 16, v8
    v_and_b32 v33, 0xffff0000, v8
    v_lshlrev_b32 v34, 16, v9
    v_and_b32 v35, 0xffff0000, v9
    v_lshlrev_b32 v36, 16, v10
    v_and_b32 v37, 0xffff0000, v10
    v_lshlrev_b32 v38, 16, v11
    v_and_b32 v39, 0xffff0000, v11
    v_mul_f32 v24, v24, v42
    v_mul_f32 v25, v25, v42
    v_mul_f32 v26, v26, v42
    v_mul_f32 v27, v27, v42
    v_mul_f32 v28, v28, v42
    v_mul_f32 v29, v29, v42
    v_mul_f32 v30, v30, v42
    v_mul_f32 v31, v31, v42
    v_mul_f32 v32, v32, v42
    v_mul_f32 v33, v33, v42
    v_mul_f32 v34, v34, v42
    v_mul_f32 v35, v35, v42
    v_mul_f32 v36, v36, v42
    v_mul_f32 v37, v37, v42
    v_mul_f32 v38, v38, v42
    v_mul_f32 v39, v39, v42
    v_cvt_pk_bf16_f32 v4, v24, v25
    v_cvt_pk_bf16_f32 v5, v26, v27
    v_cvt_pk_bf16_f32 v6, v28, v29
    v_cvt_pk_bf16_f32 v7, v30, v31
    v_cvt_pk_bf16_f32 v8, v32, v33
    v_cvt_pk_bf16_f32 v9, v34, v35
    v_cvt_pk_bf16_f32 v10, v36, v37
    v_cvt_pk_bf16_f32 v11, v38, v39
    v_mov_b32 v40, 0
    v_mov_b32 v43, 0
    v_dot2_f32_bf16 v40, v4, v12, v40
    v_dot2_f32_bf16 v43, v5, v13, v43
    v_dot2_f32_bf16 v40, v6, v14, v40
    v_dot2_f32_bf16 v43, v7, v15, v43
    v_dot2_f32_bf16 v40, v8, v16, v40
    v_dot2_f32_bf16 v43, v9, v17, v43
    v_dot2_f32_bf16 v40, v10, v18, v40
    v_dot2_f32_bf16 v43, v11, v19, v43
    s_nop 2
    v_add_f32 v40, v40, v43
    s_nop 1
    v_add_f32_dpp v40, v40, v40 row_shr:1 row_mask:0xf bank_mask:0xf bound_ctrl:0
    s_nop 1
    v_add_f32_dpp v40, v40, v40 row_shr:2 row_mask:0xf bank_mask:0xf bound_ctrl:0
    s_nop 1
    v_add_f32_dpp v40, v40, v40 row_shr:4 row_mask:0xf bank_mask:0xf bound_ctrl:0
    s_nop 1
    v_add_f32_dpp v40, v40, v40 row_shr:8 row_mask:0xf bank_mask:0xf bound_ctrl:0
    s_nop 1
    v_add_f32_dpp v40, v40, v40 row_bcast:15 row_mask:0xa bank_mask:0xf
    s_nop 1
    v_add_f32_dpp v40, v40, v40 row_bcast:31 row_mask:0xc bank_mask:0xf
    s_nop 0
    v_readlane_b32 s52, v40, 63
    s_nop 1
    v_mov_b32 v44, s52
    v_cvt_pk_bf16_f32 v44, v44, v44
    v_and_b32 v44, 0xffff0000, v44
    v_ashrrev_i32 v45, 31, v44
    v_or_b32 v45, 0x80000000, v45
    v_xor_b32 v44, v44, v45
    v_and_b32 v44, 0xffff0000, v44
    s_sub_u32 s44, 2047, s77
    v_or_b32 v44, s44, v44
    v_xor_b32 v46, 0x80000000, v41
    v_mov_b32 v47, v42
    v_mul_f32 v48, 0x3fb8aa3b, v42
    s_lshl_b32 s44, s77, 2
    s_lshl_b32 s45, s77, 4
    s_add_u32 s45, s45, 65536
    v_mov_b32 v45, 0
    s_mov_b64 exec, 1
    buffer_store_dword v44, v45, s[40:43], s44 offen sc0 sc1
    buffer_store_dwordx3 v[46:48], v45, s[40:43], s45 offen sc0 sc1
    s_mov_b64 exec, -1

    s_cmp_ge_u32 s3, 4
    s_cbranch_scc1 F_aux
    s_branch F_k
.p2align 12
F_k:
    s_setprio 2
    s_lshr_b32 s36, s3, 1
    s_and_b32 s37, s3, 1
    s_lshl_b32 s38, s36, 13
    s_lshl_b32 s42, s37, 1

    v_and_b32 v1, 15, v0
    v_lshrrev_b32 v2, 4, v0
    v_lshrrev_b32 v3, 1, v1
    v_xor_b32 v3, v3, v2
    v_lshlrev_b32 v3, 4, v3
    v_lshlrev_b32 v1, 7, v1
    v_add3_u32 v4, v1, v3, s38
    v_xor_b32 v5, 64, v4
    v_add_u32 v6, 81920, v4
    v_add_u32 v7, 81920, v5
    v_bfe_u32 v1, v0, 2, 2
    v_lshl_add_u32 v3, v2, 3, v1
    v_lshrrev_b32 v1, 1, v1
    v_and_b32 v2, 1, v2
    v_lshl_add_u32 v1, v2, 1, v1
    v_xor_b32 v1, s42, v1
    v_lshlrev_b32 v1, 5, v1
    v_lshl_add_u32 v1, v3, 7, v1
    v_and_b32 v2, 3, v0
    v_lshl_add_u32 v1, v2, 3, v1

    v_add_u32 v8, 16384, v1
    v_xor_b32 v9, 32, v8
    v_add_u32 v10, 81920, v8
    v_add_u32 v11, 81920, v9
    s_mov_b32 s40, 0x3f800008
    s_mov_b32 s41, s40
    s_mov_b32 s74, 0x358637bd
    s_mov_b32 s75, s74
    s_lshl_b32 s42, s36, 8
    s_add_u32 s42, s42, 24832
    v_and_or_b32 v164, v0, 48, s42
    v_and_b32 v165, 15, v0
    s_lshl_b32 s42, s37, 7
    s_add_u32 s42, s42, 26368
    v_lshl_add_u32 v165, v165, 2, s42
    s_lshl_b32 s42, s3, 12
    s_add_u32 s42, s42, 65536
    v_lshl_add_u32 v1, v0, 4, s42
    s_lshl_b32 s42, s3, 7
    s_add_u32 s42, s42, 27136
    v_and_or_b32 v2, v0, 48, s42
    s_lshl_b32 s42, s3, 2
    s_add_u32 s42, s42, 24640
    v_mov_b32_e64 v3, s42
    s_lshl_b32 s46, s28, 6
    s_lshl_b32 s78, s10, 1
    s_add_u32 s78, s78, s37
    s_lshl_b32 s79, s32, 18
    s_lshl_b32 s80, s36, 17
    s_add_u32 s79, s79, s80
    s_lshl_b32 s80, s78, 10
    s_add_u32 s79, s79, s80
    s_lshl_b32 s45, s32, 1
    s_add_u32 s45, s45, s36
    s_mul_i32 s45, s45, 8*64
    s_add_u32 s45, s45, 225280
    s_mul_i32 s82, s78, 4224
    s_add_u32 s83, s82, 4096
    s_lshl_b32 s50, s78, 4
    s_and_b32 s44, s32, 4-1
    s_mul_i32 s44, s44, 16/4
    s_add_u32 s50, s50, s44
    s_mul_i32 s50, s50, 64

    s_add_u32 s56, s50, 0x82f000
    s_add_u32 s56, s72, s56
    s_addc_u32 s57, s73, 0
    s_add_u32 s16, s72, 0x400000
    s_addc_u32 s17, s73, 0
    s_mov_b32 s18, 0x400000
    s_mov_b32 s19, 0x00020000
    s_add_u32 s68, s45, 0x800000
    s_add_u32 s68, s72, s68
    s_addc_u32 s69, s73, 0
    s_mov_b32 s76, 1
    s_barrier
    ds_read_b64_tr_b16 v[44:45], v8 offset:8192
    ds_read_b64_tr_b16 v[46:47], v8 offset:8704
    ds_read_b64_tr_b16 v[48:49], v8 offset:12288
    ds_read_b64_tr_b16 v[50:51], v8 offset:12800
    ds_read_b128 v[12:15], v4 offset:0
    ds_read_b128 v[28:31], v5 offset:0
    ds_read_b128 v[16:19], v4 offset:2048
    ds_read_b128 v[32:35], v5 offset:2048
    ds_read_b128 v[20:23], v4 offset:4096
    ds_read_b128 v[36:39], v5 offset:4096
    ds_read_b64_tr_b16 v[52:53], v9 offset:8192
    ds_read_b64_tr_b16 v[54:55], v9 offset:8704
    ds_read_b128 v[24:27], v4 offset:6144
    ds_read_b128 v[40:43], v5 offset:6144
    s_waitcnt lgkmcnt(14)
    s_mov_b32 s81, 3
F_p1:
    s_waitcnt lgkmcnt(7)
    v_mfma_f32_16x16x32_bf16 v[100:103], v[12:15], v[44:47], v[100:103]
    ds_read_b64_tr_b16 v[56:57], v9 offset:12288
    v_mfma_f32_16x16x32_bf16 v[100:103], v[28:31], v[48:51], v[100:103]
    ds_read_b64_tr_b16 v[58:59], v9 offset:12800
    v_mfma_f32_16x16x32_bf16 v[104:107], v[16:19], v[44:47], v[104:107]
    ds_read_b64_tr_b16 v[60:61], v8 offset:16384
    s_waitcnt lgkmcnt(9)
    v_mfma_f32_16x16x32_bf16 v[104:107], v[32:35], v[48:51], v[104:107]
    ds_read_b64_tr_b16 v[62:63], v8 offset:16896
    s_waitcnt lgkmcnt(9)
    v_mfma_f32_16x16x32_bf16 v[108:111], v[20:23], v[44:47], v[108:111]
    ds_read_b64_tr_b16 v[64:65], v8 offset:20480
    s_waitcnt lgkmcnt(9)
    v_mfma_f32_16x16x32_bf16 v[108:111], v[36:39], v[48:51], v[108:111]
    ds_read_b64_tr_b16 v[66:67], v8 offset:20992
    s_waitcnt lgkmcnt(7)
    v_mfma_f32_16x16x32_bf16 v[112:115], v[24:27], v[44:47], v[112:115]
    ds_read_b64_tr_b16 v[44:45], v9 offset:16384
    s_waitcnt lgkmcnt(7)
    v_mfma_f32_16x16x32_bf16 v[112:115], v[40:43], v[48:51], v[112:115]
    ds_read_b64_tr_b16 v[46:47], v9 offset:16896
    v_mfma_f32_16x16x32_bf16 v[116:119], v[12:15], v[52:55], v[116:119]
    ds_read_b64_tr_b16 v[48:49], v9 offset:20480
    s_waitcnt lgkmcnt(7)
    v_mfma_f32_16x16x32_bf16 v[116:119], v[28:31], v[56:59], v[116:119]
    ds_read_b64_tr_b16 v[50:51], v9 offset:20992
    v_mfma_f32_16x16x32_bf16 v[120:123], v[16:19], v[52:55], v[120:123]
    v_mfma_f32_16x16x32_bf16 v[120:123], v[32:35], v[56:59], v[120:123]
    v_mfma_f32_16x16x32_bf16 v[124:127], v[20:23], v[52:55], v[124:127]
    v_mfma_f32_16x16x32_bf16 v[124:127], v[36:39], v[56:59], v[124:127]
    v_mfma_f32_16x16x32_bf16 v[128:131], v[24:27], v[52:55], v[128:131]
    ds_read_b64_tr_b16 v[52:53], v8 offset:0
    v_mfma_f32_16x16x32_bf16 v[128:131], v[40:43], v[56:59], v[128:131]
    ds_read_b64_tr_b16 v[54:55], v8 offset:512
    s_waitcnt lgkmcnt(5)
    v_mfma_f32_16x16x32_bf16 v[132:135], v[12:15], v[60:63], v[132:135]
    ds_read_b64_tr_b16 v[56:57], v8 offset:4096
    v_mfma_f32_16x16x32_bf16 v[132:135], v[28:31], v[64:67], v[132:135]
    ds_read_b64_tr_b16 v[58:59], v8 offset:4608
    v_mfma_f32_16x16x32_bf16 v[136:139], v[16:19], v[60:63], v[136:139]
    v_mfma_f32_16x16x32_bf16 v[136:139], v[32:35], v[64:67], v[136:139]
    v_mfma_f32_16x16x32_bf16 v[140:143], v[20:23], v[60:63], v[140:143]
    v_mfma_f32_16x16x32_bf16 v[140:143], v[36:39], v[64:67], v[140:143]
    v_mfma_f32_16x16x32_bf16 v[144:147], v[24:27], v[60:63], v[144:147]
    ds_read_b64_tr_b16 v[60:61], v9 offset:0
    v_mfma_f32_16x16x32_bf16 v[144:147], v[40:43], v[64:67], v[144:147]
    ds_read_b64_tr_b16 v[62:63], v9 offset:512
    s_waitcnt lgkmcnt(5)
    v_mfma_f32_16x16x32_bf16 v[148:151], v[12:15], v[44:47], v[148:151]
    ds_read_b64_tr_b16 v[64:65], v9 offset:4096
    v_mfma_f32_16x16x32_bf16 v[148:151], v[28:31], v[48:51], v[148:151]
    ds_read_b64_tr_b16 v[66:67], v9 offset:4608
    v_mfma_f32_16x16x32_bf16 v[152:155], v[16:19], v[44:47], v[152:155]
    v_mfma_f32_16x16x32_bf16 v[152:155], v[32:35], v[48:51], v[152:155]
    v_mfma_f32_16x16x32_bf16 v[156:159], v[20:23], v[44:47], v[156:159]
    v_mfma_f32_16x16x32_bf16 v[156:159], v[36:39], v[48:51], v[156:159]
    s_waitcnt lgkmcnt(0)
    s_barrier
    v_mfma_f32_16x16x32_bf16 v[160:163], v[24:27], v[44:47], v[160:163]
    ds_read_b64_tr_b16 v[44:45], v8 offset:49152
    v_mfma_f32_16x16x32_bf16 v[160:163], v[40:43], v[48:51], v[160:163]
    ds_read_b64_tr_b16 v[46:47], v8 offset:49664
    v_mfma_f32_16x16x32_bf16 v[68:71], v[52:55], v[12:15], v[68:71]
    ds_read_b64_tr_b16 v[48:49], v8 offset:53248
    v_mfma_f32_16x16x32_bf16 v[68:71], v[56:59], v[28:31], v[68:71]
    ds_read_b64_tr_b16 v[50:51], v8 offset:53760
    v_mfma_f32_16x16x32_bf16 v[84:87], v[60:63], v[12:15], v[84:87]
    ds_read_b128 v[12:15], v4 offset:40960
    v_mfma_f32_16x16x32_bf16 v[84:87], v[64:67], v[28:31], v[84:87]
    ds_read_b128 v[28:31], v5 offset:40960
    v_mfma_f32_16x16x32_bf16 v[72:75], v[52:55], v[16:19], v[72:75]
    v_mfma_f32_16x16x32_bf16 v[72:75], v[56:59], v[32:35], v[72:75]
    v_mfma_f32_16x16x32_bf16 v[88:91], v[60:63], v[16:19], v[88:91]
    ds_read_b128 v[16:19], v4 offset:43008
    v_mfma_f32_16x16x32_bf16 v[88:91], v[64:67], v[32:35], v[88:91]
    ds_read_b128 v[32:35], v5 offset:43008
    v_mfma_f32_16x16x32_bf16 v[76:79], v[52:55], v[20:23], v[76:79]
    v_mfma_f32_16x16x32_bf16 v[76:79], v[56:59], v[36:39], v[76:79]
    v_mfma_f32_16x16x32_bf16 v[92:95], v[60:63], v[20:23], v[92:95]
    ds_read_b128 v[20:23], v4 offset:45056
    v_mfma_f32_16x16x32_bf16 v[92:95], v[64:67], v[36:39], v[92:95]
    ds_read_b128 v[36:39], v5 offset:45056
    v_mfma_f32_16x16x32_bf16 v[80:83], v[52:55], v[24:27], v[80:83]
    ds_read_b64_tr_b16 v[52:53], v9 offset:49152
    v_mfma_f32_16x16x32_bf16 v[80:83], v[56:59], v[40:43], v[80:83]
    ds_read_b64_tr_b16 v[54:55], v9 offset:49664
    v_mfma_f32_16x16x32_bf16 v[96:99], v[60:63], v[24:27], v[96:99]
    ds_read_b128 v[24:27], v4 offset:47104
    v_mfma_f32_16x16x32_bf16 v[96:99], v[64:67], v[40:43], v[96:99]
    ds_read_b128 v[40:43], v5 offset:47104
    s_waitcnt lgkmcnt(7)
    v_mfma_f32_16x16x32_bf16 v[100:103], v[12:15], v[44:47], v[100:103]
    ds_read_b64_tr_b16 v[56:57], v9 offset:53248
    v_mfma_f32_16x16x32_bf16 v[100:103], v[28:31], v[48:51], v[100:103]
    ds_read_b64_tr_b16 v[58:59], v9 offset:53760
    v_mfma_f32_16x16x32_bf16 v[104:107], v[16:19], v[44:47], v[104:107]
    ds_read_b64_tr_b16 v[60:61], v8 offset:57344
    s_waitcnt lgkmcnt(9)
    v_mfma_f32_16x16x32_bf16 v[104:107], v[32:35], v[48:51], v[104:107]
    ds_read_b64_tr_b16 v[62:63], v8 offset:57856
    s_waitcnt lgkmcnt(9)
    v_mfma_f32_16x16x32_bf16 v[108:111], v[20:23], v[44:47], v[108:111]
    ds_read_b64_tr_b16 v[64:65], v8 offset:61440
    s_waitcnt lgkmcnt(9)
    v_mfma_f32_16x16x32_bf16 v[108:111], v[36:39], v[48:51], v[108:111]
    ds_read_b64_tr_b16 v[66:67], v8 offset:61952
    s_waitcnt lgkmcnt(7)
    v_mfma_f32_16x16x32_bf16 v[112:115], v[24:27], v[44:47], v[112:115]
    ds_read_b64_tr_b16 v[44:45], v9 offset:57344
    s_waitcnt lgkmcnt(7)
    v_mfma_f32_16x16x32_bf16 v[112:115], v[40:43], v[48:51], v[112:115]
    ds_read_b64_tr_b16 v[46:47], v9 offset:57856
    v_mfma_f32_16x16x32_bf16 v[116:119], v[12:15], v[52:55], v[116:119]
    ds_read_b64_tr_b16 v[48:49], v9 offset:61440
    s_waitcnt lgkmcnt(7)
    v_mfma_f32_16x16x32_bf16 v[116:119], v[28:31], v[56:59], v[116:119]
    ds_read_b64_tr_b16 v[50:51], v9 offset:61952
    v_mfma_f32_16x16x32_bf16 v[120:123], v[16:19], v[52:55], v[120:123]
    v_mfma_f32_16x16x32_bf16 v[120:123], v[32:35], v[56:59], v[120:123]
    v_mfma_f32_16x16x32_bf16 v[124:127], v[20:23], v[52:55], v[124:127]
    v_mfma_f32_16x16x32_bf16 v[124:127], v[36:39], v[56:59], v[124:127]
    v_mfma_f32_16x16x32_bf16 v[128:131], v[24:27], v[52:55], v[128:131]
    ds_read_b64_tr_b16 v[52:53], v8 offset:40960
    v_mfma_f32_16x16x32_bf16 v[128:131], v[40:43], v[56:59], v[128:131]
    ds_read_b64_tr_b16 v[54:55], v8 offset:41472
    s_waitcnt lgkmcnt(5)
    v_mfma_f32_16x16x32_bf16 v[132:135], v[12:15], v[60:63], v[132:135]
    ds_read_b64_tr_b16 v[56:57], v8 offset:45056
    v_mfma_f32_16x16x32_bf16 v[132:135], v[28:31], v[64:67], v[132:135]
    ds_read_b64_tr_b16 v[58:59], v8 offset:45568
    v_mfma_f32_16x16x32_bf16 v[136:139], v[16:19], v[60:63], v[136:139]
    v_mfma_f32_16x16x32_bf16 v[136:139], v[32:35], v[64:67], v[136:139]
    v_mfma_f32_16x16x32_bf16 v[140:143], v[20:23], v[60:63], v[140:143]
    v_mfma_f32_16x16x32_bf16 v[140:143], v[36:39], v[64:67], v[140:143]
    v_mfma_f32_16x16x32_bf16 v[144:147], v[24:27], v[60:63], v[144:147]
    ds_read_b64_tr_b16 v[60:61], v9 offset:40960
    v_mfma_f32_16x16x32_bf16 v[144:147], v[40:43], v[64:67], v[144:147]
    ds_read_b64_tr_b16 v[62:63], v9 offset:41472
    s_waitcnt lgkmcnt(5)
    v_mfma_f32_16x16x32_bf16 v[148:151], v[12:15], v[44:47], v[148:151]
    ds_read_b64_tr_b16 v[64:65], v9 offset:45056
    v_mfma_f32_16x16x32_bf16 v[148:151], v[28:31], v[48:51], v[148:151]
    ds_read_b64_tr_b16 v[66:67], v9 offset:45568
    v_mfma_f32_16x16x32_bf16 v[152:155], v[16:19], v[44:47], v[152:155]
    v_mfma_f32_16x16x32_bf16 v[152:155], v[32:35], v[48:51], v[152:155]
    v_mfma_f32_16x16x32_bf16 v[156:159], v[20:23], v[44:47], v[156:159]
    v_mfma_f32_16x16x32_bf16 v[156:159], v[36:39], v[48:51], v[156:159]
    s_waitcnt lgkmcnt(0)
    s_waitcnt vmcnt(0)
    s_barrier
    v_mfma_f32_16x16x32_bf16 v[160:163], v[24:27], v[44:47], v[160:163]
    ds_read_b64_tr_b16 v[44:45], v10 offset:8192
    v_mfma_f32_16x16x32_bf16 v[160:163], v[40:43], v[48:51], v[160:163]
    ds_read_b64_tr_b16 v[46:47], v10 offset:8704
    v_mfma_f32_16x16x32_bf16 v[68:71], v[52:55], v[12:15], v[68:71]
    ds_read_b64_tr_b16 v[48:49], v10 offset:12288
    v_mfma_f32_16x16x32_bf16 v[68:71], v[56:59], v[28:31], v[68:71]
    ds_read_b64_tr_b16 v[50:51], v10 offset:12800
    v_mfma_f32_16x16x32_bf16 v[84:87], v[60:63], v[12:15], v[84:87]
    ds_read_b128 v[12:15], v6 offset:0
    v_mfma_f32_16x16x32_bf16 v[84:87], v[64:67], v[28:31], v[84:87]
    ds_read_b128 v[28:31], v7 offset:0
    v_mfma_f32_16x16x32_bf16 v[72:75], v[52:55], v[16:19], v[72:75]
    v_mfma_f32_16x16x32_bf16 v[72:75], v[56:59], v[32:35], v[72:75]
    v_mfma_f32_16x16x32_bf16 v[88:91], v[60:63], v[16:19], v[88:91]
    ds_read_b128 v[16:19], v6 offset:2048
    v_mfma_f32_16x16x32_bf16 v[88:91], v[64:67], v[32:35], v[88:91]
    ds_read_b128 v[32:35], v7 offset:2048
    v_mfma_f32_16x16x32_bf16 v[76:79], v[52:55], v[20:23], v[76:79]
    v_mfma_f32_16x16x32_bf16 v[76:79], v[56:59], v[36:39], v[76:79]
    v_mfma_f32_16x16x32_bf16 v[92:95], v[60:63], v[20:23], v[92:95]
    ds_read_b128 v[20:23], v6 offset:4096
    v_mfma_f32_16x16x32_bf16 v[92:95], v[64:67], v[36:39], v[92:95]
    ds_read_b128 v[36:39], v7 offset:4096
    v_mfma_f32_16x16x32_bf16 v[80:83], v[52:55], v[24:27], v[80:83]
    ds_read_b64_tr_b16 v[52:53], v11 offset:8192
    v_mfma_f32_16x16x32_bf16 v[80:83], v[56:59], v[40:43], v[80:83]
    ds_read_b64_tr_b16 v[54:55], v11 offset:8704
    v_mfma_f32_16x16x32_bf16 v[96:99], v[60:63], v[24:27], v[96:99]
    ds_read_b128 v[24:27], v6 offset:6144
    v_mfma_f32_16x16x32_bf16 v[96:99], v[64:67], v[40:43], v[96:99]
    ds_read_b128 v[40:43], v7 offset:6144
    s_waitcnt lgkmcnt(7)
    v_mfma_f32_16x16x32_bf16 v[100:103], v[12:15], v[44:47], v[100:103]
    ds_read_b64_tr_b16 v[56:57], v11 offset:12288
    v_mfma_f32_16x16x32_bf16 v[100:103], v[28:31], v[48:51], v[100:103]
    ds_read_b64_tr_b16 v[58:59], v11 offset:12800
    v_mfma_f32_16x16x32_bf16 v[104:107], v[16:19], v[44:47], v[104:107]
    ds_read_b64_tr_b16 v[60:61], v10 offset:16384
    s_waitcnt lgkmcnt(9)
    v_mfma_f32_16x16x32_bf16 v[104:107], v[32:35], v[48:51], v[104:107]
    ds_read_b64_tr_b16 v[62:63], v10 offset:16896
    s_waitcnt lgkmcnt(9)
    v_mfma_f32_16x16x32_bf16 v[108:111], v[20:23], v[44:47], v[108:111]
    ds_read_b64_tr_b16 v[64:65], v10 offset:20480
    s_waitcnt lgkmcnt(9)
    v_mfma_f32_16x16x32_bf16 v[108:111], v[36:39], v[48:51], v[108:111]
    ds_read_b64_tr_b16 v[66:67], v10 offset:20992
    s_waitcnt lgkmcnt(7)
    v_mfma_f32_16x16x32_bf16 v[112:115], v[24:27], v[44:47], v[112:115]
    ds_read_b64_tr_b16 v[44:45], v11 offset:16384
    s_waitcnt lgkmcnt(7)
    v_mfma_f32_16x16x32_bf16 v[112:115], v[40:43], v[48:51], v[112:115]
    ds_read_b64_tr_b16 v[46:47], v11 offset:16896
    v_mfma_f32_16x16x32_bf16 v[116:119], v[12:15], v[52:55], v[116:119]
    ds_read_b64_tr_b16 v[48:49], v11 offset:20480
    s_waitcnt lgkmcnt(7)
    v_mfma_f32_16x16x32_bf16 v[116:119], v[28:31], v[56:59], v[116:119]
    ds_read_b64_tr_b16 v[50:51], v11 offset:20992
    v_mfma_f32_16x16x32_bf16 v[120:123], v[16:19], v[52:55], v[120:123]
    v_mfma_f32_16x16x32_bf16 v[120:123], v[32:35], v[56:59], v[120:123]
    v_mfma_f32_16x16x32_bf16 v[124:127], v[20:23], v[52:55], v[124:127]
    v_mfma_f32_16x16x32_bf16 v[124:127], v[36:39], v[56:59], v[124:127]
    v_mfma_f32_16x16x32_bf16 v[128:131], v[24:27], v[52:55], v[128:131]
    ds_read_b64_tr_b16 v[52:53], v10 offset:0
    v_mfma_f32_16x16x32_bf16 v[128:131], v[40:43], v[56:59], v[128:131]
    ds_read_b64_tr_b16 v[54:55], v10 offset:512
    s_waitcnt lgkmcnt(5)
    v_mfma_f32_16x16x32_bf16 v[132:135], v[12:15], v[60:63], v[132:135]
    ds_read_b64_tr_b16 v[56:57], v10 offset:4096
    v_mfma_f32_16x16x32_bf16 v[132:135], v[28:31], v[64:67], v[132:135]
    ds_read_b64_tr_b16 v[58:59], v10 offset:4608
    v_mfma_f32_16x16x32_bf16 v[136:139], v[16:19], v[60:63], v[136:139]
    v_mfma_f32_16x16x32_bf16 v[136:139], v[32:35], v[64:67], v[136:139]
    v_mfma_f32_16x16x32_bf16 v[140:143], v[20:23], v[60:63], v[140:143]
    v_mfma_f32_16x16x32_bf16 v[140:143], v[36:39], v[64:67], v[140:143]
    v_mfma_f32_16x16x32_bf16 v[144:147], v[24:27], v[60:63], v[144:147]
    ds_read_b64_tr_b16 v[60:61], v11 offset:0
    v_mfma_f32_16x16x32_bf16 v[144:147], v[40:43], v[64:67], v[144:147]
    ds_read_b64_tr_b16 v[62:63], v11 offset:512
    s_waitcnt lgkmcnt(5)
    v_mfma_f32_16x16x32_bf16 v[148:151], v[12:15], v[44:47], v[148:151]
    ds_read_b64_tr_b16 v[64:65], v11 offset:4096
    v_mfma_f32_16x16x32_bf16 v[148:151], v[28:31], v[48:51], v[148:151]
    ds_read_b64_tr_b16 v[66:67], v11 offset:4608
    v_mfma_f32_16x16x32_bf16 v[152:155], v[16:19], v[44:47], v[152:155]
    v_mfma_f32_16x16x32_bf16 v[152:155], v[32:35], v[48:51], v[152:155]
    v_mfma_f32_16x16x32_bf16 v[156:159], v[20:23], v[44:47], v[156:159]
    v_mfma_f32_16x16x32_bf16 v[156:159], v[36:39], v[48:51], v[156:159]
    s_waitcnt lgkmcnt(0)
    s_barrier
    v_mfma_f32_16x16x32_bf16 v[160:163], v[24:27], v[44:47], v[160:163]
    ds_read_b64_tr_b16 v[44:45], v10 offset:49152
    v_mfma_f32_16x16x32_bf16 v[160:163], v[40:43], v[48:51], v[160:163]
    ds_read_b64_tr_b16 v[46:47], v10 offset:49664
    v_mfma_f32_16x16x32_bf16 v[68:71], v[52:55], v[12:15], v[68:71]
    ds_read_b64_tr_b16 v[48:49], v10 offset:53248
    v_mfma_f32_16x16x32_bf16 v[68:71], v[56:59], v[28:31], v[68:71]
    ds_read_b64_tr_b16 v[50:51], v10 offset:53760
    v_mfma_f32_16x16x32_bf16 v[84:87], v[60:63], v[12:15], v[84:87]
    ds_read_b128 v[12:15], v6 offset:40960
    v_mfma_f32_16x16x32_bf16 v[84:87], v[64:67], v[28:31], v[84:87]
    ds_read_b128 v[28:31], v7 offset:40960
    v_mfma_f32_16x16x32_bf16 v[72:75], v[52:55], v[16:19], v[72:75]
    v_mfma_f32_16x16x32_bf16 v[72:75], v[56:59], v[32:35], v[72:75]
    v_mfma_f32_16x16x32_bf16 v[88:91], v[60:63], v[16:19], v[88:91]
    ds_read_b128 v[16:19], v6 offset:43008
    v_mfma_f32_16x16x32_bf16 v[88:91], v[64:67], v[32:35], v[88:91]
    ds_read_b128 v[32:35], v7 offset:43008
    v_mfma_f32_16x16x32_bf16 v[76:79], v[52:55], v[20:23], v[76:79]
    v_mfma_f32_16x16x32_bf16 v[76:79], v[56:59], v[36:39], v[76:79]
    v_mfma_f32_16x16x32_bf16 v[92:95], v[60:63], v[20:23], v[92:95]
    ds_read_b128 v[20:23], v6 offset:45056
    v_mfma_f32_16x16x32_bf16 v[92:95], v[64:67], v[36:39], v[92:95]
    ds_read_b128 v[36:39], v7 offset:45056
    v_mfma_f32_16x16x32_bf16 v[80:83], v[52:55], v[24:27], v[80:83]
    ds_read_b64_tr_b16 v[52:53], v11 offset:49152
    v_mfma_f32_16x16x32_bf16 v[80:83], v[56:59], v[40:43], v[80:83]
    ds_read_b64_tr_b16 v[54:55], v11 offset:49664
    v_mfma_f32_16x16x32_bf16 v[96:99], v[60:63], v[24:27], v[96:99]
    ds_read_b128 v[24:27], v6 offset:47104
    v_mfma_f32_16x16x32_bf16 v[96:99], v[64:67], v[40:43], v[96:99]
    ds_read_b128 v[40:43], v7 offset:47104
    s_waitcnt lgkmcnt(7)
    v_mfma_f32_16x16x32_bf16 v[100:103], v[12:15], v[44:47], v[100:103]
    ds_read_b64_tr_b16 v[56:57], v11 offset:53248
    v_mfma_f32_16x16x32_bf16 v[100:103], v[28:31], v[48:51], v[100:103]
    ds_read_b64_tr_b16 v[58:59], v11 offset:53760
    v_mfma_f32_16x16x32_bf16 v[104:107], v[16:19], v[44:47], v[104:107]
    ds_read_b64_tr_b16 v[60:61], v10 offset:57344
    s_waitcnt lgkmcnt(9)
    v_mfma_f32_16x16x32_bf16 v[104:107], v[32:35], v[48:51], v[104:107]
    ds_read_b64_tr_b16 v[62:63], v10 offset:57856
    s_waitcnt lgkmcnt(9)
    v_mfma_f32_16x16x32_bf16 v[108:111], v[20:23], v[44:47], v[108:111]
    ds_read_b64_tr_b16 v[64:65], v10 offset:61440
    s_waitcnt lgkmcnt(9)
    v_mfma_f32_16x16x32_bf16 v[108:111], v[36:39], v[48:51], v[108:111]
    ds_read_b64_tr_b16 v[66:67], v10 offset:61952
    s_waitcnt lgkmcnt(7)
    v_mfma_f32_16x16x32_bf16 v[112:115], v[24:27], v[44:47], v[112:115]
    ds_read_b64_tr_b16 v[44:45], v11 offset:57344
    s_waitcnt lgkmcnt(7)
    v_mfma_f32_16x16x32_bf16 v[112:115], v[40:43], v[48:51], v[112:115]
    ds_read_b64_tr_b16 v[46:47], v11 offset:57856
    v_mfma_f32_16x16x32_bf16 v[116:119], v[12:15], v[52:55], v[116:119]
    ds_read_b64_tr_b16 v[48:49], v11 offset:61440
    s_waitcnt lgkmcnt(7)
    v_mfma_f32_16x16x32_bf16 v[116:119], v[28:31], v[56:59], v[116:119]
    ds_read_b64_tr_b16 v[50:51], v11 offset:61952
    v_mfma_f32_16x16x32_bf16 v[120:123], v[16:19], v[52:55], v[120:123]
    v_mfma_f32_16x16x32_bf16 v[120:123], v[32:35], v[56:59], v[120:123]
    v_mfma_f32_16x16x32_bf16 v[124:127], v[20:23], v[52:55], v[124:127]
    v_mfma_f32_16x16x32_bf16 v[124:127], v[36:39], v[56:59], v[124:127]
    v_mfma_f32_16x16x32_bf16 v[128:131], v[24:27], v[52:55], v[128:131]
    ds_read_b64_tr_b16 v[52:53], v10 offset:40960
    v_mfma_f32_16x16x32_bf16 v[128:131], v[40:43], v[56:59], v[128:131]
    ds_read_b64_tr_b16 v[54:55], v10 offset:41472
    s_waitcnt lgkmcnt(5)
    v_mfma_f32_16x16x32_bf16 v[132:135], v[12:15], v[60:63], v[132:135]
    ds_read_b64_tr_b16 v[56:57], v10 offset:45056
    v_mfma_f32_16x16x32_bf16 v[132:135], v[28:31], v[64:67], v[132:135]
    ds_read_b64_tr_b16 v[58:59], v10 offset:45568
    v_mfma_f32_16x16x32_bf16 v[136:139], v[16:19], v[60:63], v[136:139]
    v_mfma_f32_16x16x32_bf16 v[136:139], v[32:35], v[64:67], v[136:139]
    v_mfma_f32_16x16x32_bf16 v[140:143], v[20:23], v[60:63], v[140:143]
    v_mfma_f32_16x16x32_bf16 v[140:143], v[36:39], v[64:67], v[140:143]
    v_mfma_f32_16x16x32_bf16 v[144:147], v[24:27], v[60:63], v[144:147]
    ds_read_b64_tr_b16 v[60:61], v11 offset:40960
    v_mfma_f32_16x16x32_bf16 v[144:147], v[40:43], v[64:67], v[144:147]
    ds_read_b64_tr_b16 v[62:63], v11 offset:41472
    s_waitcnt lgkmcnt(5)
    v_mfma_f32_16x16x32_bf16 v[148:151], v[12:15], v[44:47], v[148:151]
    ds_read_b64_tr_b16 v[64:65], v11 offset:45056
    v_mfma_f32_16x16x32_bf16 v[148:151], v[28:31], v[48:51], v[148:151]
    ds_read_b64_tr_b16 v[66:67], v11 offset:45568
    v_mfma_f32_16x16x32_bf16 v[152:155], v[16:19], v[44:47], v[152:155]
    v_mfma_f32_16x16x32_bf16 v[152:155], v[32:35], v[48:51], v[152:155]
    v_mfma_f32_16x16x32_bf16 v[156:159], v[20:23], v[44:47], v[156:159]
    v_mfma_f32_16x16x32_bf16 v[156:159], v[36:39], v[48:51], v[156:159]
    s_waitcnt lgkmcnt(0)
    s_barrier
    v_mfma_f32_16x16x32_bf16 v[160:163], v[24:27], v[44:47], v[160:163]
    ds_read_b64_tr_b16 v[44:45], v8 offset:8192
    v_mfma_f32_16x16x32_bf16 v[160:163], v[40:43], v[48:51], v[160:163]
    ds_read_b64_tr_b16 v[46:47], v8 offset:8704
    v_mfma_f32_16x16x32_bf16 v[68:71], v[52:55], v[12:15], v[68:71]
    ds_read_b64_tr_b16 v[48:49], v8 offset:12288
    v_mfma_f32_16x16x32_bf16 v[68:71], v[56:59], v[28:31], v[68:71]
    ds_read_b64_tr_b16 v[50:51], v8 offset:12800
    v_mfma_f32_16x16x32_bf16 v[84:87], v[60:63], v[12:15], v[84:87]
    ds_read_b128 v[12:15], v4 offset:0
    v_mfma_f32_16x16x32_bf16 v[84:87], v[64:67], v[28:31], v[84:87]
    ds_read_b128 v[28:31], v5 offset:0
    v_mfma_f32_16x16x32_bf16 v[72:75], v[52:55], v[16:19], v[72:75]
    v_mfma_f32_16x16x32_bf16 v[72:75], v[56:59], v[32:35], v[72:75]
    v_mfma_f32_16x16x32_bf16 v[88:91], v[60:63], v[16:19], v[88:91]
    ds_read_b128 v[16:19], v4 offset:2048
    v_mfma_f32_16x16x32_bf16 v[88:91], v[64:67], v[32:35], v[88:91]
    ds_read_b128 v[32:35], v5 offset:2048
    v_mfma_f32_16x16x32_bf16 v[76:79], v[52:55], v[20:23], v[76:79]
    v_mfma_f32_16x16x32_bf16 v[76:79], v[56:59], v[36:39], v[76:79]
    s_sub_u32 s81, s81, 1
    s_cmp_lg_u32 s81, 0
    v_mfma_f32_16x16x32_bf16 v[92:95], v[60:63], v[20:23], v[92:95]
    ds_read_b128 v[20:23], v4 offset:4096
    v_mfma_f32_16x16x32_bf16 v[92:95], v[64:67], v[36:39], v[92:95]
    ds_read_b128 v[36:39], v5 offset:4096
    v_mfma_f32_16x16x32_bf16 v[80:83], v[52:55], v[24:27], v[80:83]
    ds_read_b64_tr_b16 v[52:53], v9 offset:8192
    v_mfma_f32_16x16x32_bf16 v[80:83], v[56:59], v[40:43], v[80:83]
    ds_read_b64_tr_b16 v[54:55], v9 offset:8704
    v_mfma_f32_16x16x32_bf16 v[96:99], v[60:63], v[24:27], v[96:99]
    ds_read_b128 v[24:27], v4 offset:6144
    v_mfma_f32_16x16x32_bf16 v[96:99], v[64:67], v[40:43], v[96:99]
    ds_read_b128 v[40:43], v5 offset:6144
    s_cbranch_scc1 F_p1
    s_waitcnt lgkmcnt(7)
    v_mfma_f32_16x16x32_bf16 v[100:103], v[12:15], v[44:47], v[100:103]
    ds_read_b64_tr_b16 v[56:57], v9 offset:12288
    v_mfma_f32_16x16x32_bf16 v[100:103], v[28:31], v[48:51], v[100:103]
    ds_read_b64_tr_b16 v[58:59], v9 offset:12800
    v_mfma_f32_16x16x32_bf16 v[104:107], v[16:19], v[44:47], v[104:107]
    ds_read_b64_tr_b16 v[60:61], v8 offset:16384
    s_waitcnt lgkmcnt(9)
    v_mfma_f32_16x16x32_bf16 v[104:107], v[32:35], v[48:51], v[104:107]
    ds_read_b64_tr_b16 v[62:63], v8 offset:16896
    s_waitcnt lgkmcnt(9)
    v_mfma_f32_16x16x32_bf16 v[108:111], v[20:23], v[44:47], v[108:111]
    ds_read_b64_tr_b16 v[64:65], v8 offset:20480
    s_waitcnt lgkmcnt(9)
    v_mfma_f32_16x16x32_bf16 v[108:111], v[36:39], v[48:51], v[108:111]
    ds_read_b64_tr_b16 v[66:67], v8 offset:20992
    s_waitcnt lgkmcnt(7)
    v_mfma_f32_16x16x32_bf16 v[112:115], v[24:27], v[44:47], v[112:115]
    ds_read_b64_tr_b16 v[44:45], v9 offset:16384
    s_waitcnt lgkmcnt(7)
    v_mfma_f32_16x16x32_bf16 v[112:115], v[40:43], v[48:51], v[112:115]
    ds_read_b64_tr_b16 v[46:47], v9 offset:16896
    v_mfma_f32_16x16x32_bf16 v[116:119], v[12:15], v[52:55], v[116:119]
    ds_read_b64_tr_b16 v[48:49], v9 offset:20480
    s_waitcnt lgkmcnt(7)
    v_mfma_f32_16x16x32_bf16 v[116:119], v[28:31], v[56:59], v[116:119]
    ds_read_b64_tr_b16 v[50:51], v9 offset:20992
    v_mfma_f32_16x16x32_bf16 v[120:123], v[16:19], v[52:55], v[120:123]
    v_mfma_f32_16x16x32_bf16 v[120:123], v[32:35], v[56:59], v[120:123]
    v_mfma_f32_16x16x32_bf16 v[124:127], v[20:23], v[52:55], v[124:127]
    v_mfma_f32_16x16x32_bf16 v[124:127], v[36:39], v[56:59], v[124:127]
    s_waitcnt lgkmcnt(0)
    s_barrier
    v_mfma_f32_16x16x32_bf16 v[128:131], v[24:27], v[52:55], v[128:131]
    ds_read_b64_tr_b16 v[52:53], v8 offset:49152
    v_mfma_f32_16x16x32_bf16 v[128:131], v[40:43], v[56:59], v[128:131]
    ds_read_b64_tr_b16 v[54:55], v8 offset:49664
    v_mfma_f32_16x16x32_bf16 v[132:135], v[12:15], v[60:63], v[132:135]
    ds_read_b64_tr_b16 v[56:57], v8 offset:53248
    v_mfma_f32_16x16x32_bf16 v[132:135], v[28:31], v[64:67], v[132:135]
    ds_read_b64_tr_b16 v[58:59], v8 offset:53760
    v_mfma_f32_16x16x32_bf16 v[148:151], v[12:15], v[44:47], v[148:151]
    ds_read_b128 v[12:15], v4 offset:40960
    v_mfma_f32_16x16x32_bf16 v[148:151], v[28:31], v[48:51], v[148:151]
    ds_read_b128 v[28:31], v5 offset:40960
    v_mfma_f32_16x16x32_bf16 v[136:139], v[16:19], v[60:63], v[136:139]
    v_mfma_f32_16x16x32_bf16 v[136:139], v[32:35], v[64:67], v[136:139]
    v_mfma_f32_16x16x32_bf16 v[152:155], v[16:19], v[44:47], v[152:155]
    ds_read_b128 v[16:19], v4 offset:43008
    v_mfma_f32_16x16x32_bf16 v[152:155], v[32:35], v[48:51], v[152:155]
    ds_read_b128 v[32:35], v5 offset:43008
    v_mfma_f32_16x16x32_bf16 v[140:143], v[20:23], v[60:63], v[140:143]
    v_mfma_f32_16x16x32_bf16 v[140:143], v[36:39], v[64:67], v[140:143]
    v_mfma_f32_16x16x32_bf16 v[156:159], v[20:23], v[44:47], v[156:159]
    ds_read_b128 v[20:23], v4 offset:45056
    v_mfma_f32_16x16x32_bf16 v[156:159], v[36:39], v[48:51], v[156:159]
    ds_read_b128 v[36:39], v5 offset:45056
    v_mfma_f32_16x16x32_bf16 v[144:147], v[24:27], v[60:63], v[144:147]
    ds_read_b64_tr_b16 v[60:61], v9 offset:49152
    v_mfma_f32_16x16x32_bf16 v[144:147], v[40:43], v[64:67], v[144:147]
    ds_read_b64_tr_b16 v[62:63], v9 offset:49664
    v_mfma_f32_16x16x32_bf16 v[160:163], v[24:27], v[44:47], v[160:163]
    ds_read_b128 v[24:27], v4 offset:47104
    v_mfma_f32_16x16x32_bf16 v[160:163], v[40:43], v[48:51], v[160:163]
    ds_read_b128 v[40:43], v5 offset:47104
    s_waitcnt lgkmcnt(7)
    v_mfma_f32_16x16x32_bf16 v[100:103], v[12:15], v[52:55], v[100:103]
    ds_read_b64_tr_b16 v[64:65], v9 offset:53248
    v_mfma_f32_16x16x32_bf16 v[100:103], v[28:31], v[56:59], v[100:103]
    ds_read_b64_tr_b16 v[66:67], v9 offset:53760
    v_mfma_f32_16x16x32_bf16 v[104:107], v[16:19], v[52:55], v[104:107]
    ds_read_b64_tr_b16 v[44:45], v8 offset:57344
    s_waitcnt lgkmcnt(9)
    v_mfma_f32_16x16x32_bf16 v[104:107], v[32:35], v[56:59], v[104:107]
    ds_read_b64_tr_b16 v[46:47], v8 offset:57856
    s_waitcnt lgkmcnt(9)
    v_mfma_f32_16x16x32_bf16 v[108:111], v[20:23], v[52:55], v[108:111]
    ds_read_b64_tr_b16 v[48:49], v8 offset:61440
    s_waitcnt lgkmcnt(9)
    v_mfma_f32_16x16x32_bf16 v[108:111], v[36:39], v[56:59], v[108:111]
    ds_read_b64_tr_b16 v[50:51], v8 offset:61952
    s_waitcnt lgkmcnt(7)
    v_mfma_f32_16x16x32_bf16 v[112:115], v[24:27], v[52:55], v[112:115]
    ds_read_b64_tr_b16 v[52:53], v9 offset:57344
    s_waitcnt lgkmcnt(7)
    v_mfma_f32_16x16x32_bf16 v[112:115], v[40:43], v[56:59], v[112:115]
    ds_read_b64_tr_b16 v[54:55], v9 offset:57856
    v_mfma_f32_16x16x32_bf16 v[116:119], v[12:15], v[60:63], v[116:119]
    ds_read_b64_tr_b16 v[56:57], v9 offset:61440
    s_waitcnt lgkmcnt(7)
    v_mfma_f32_16x16x32_bf16 v[116:119], v[28:31], v[64:67], v[116:119]
    ds_read_b64_tr_b16 v[58:59], v9 offset:61952
    v_mfma_f32_16x16x32_bf16 v[120:123], v[16:19], v[60:63], v[120:123]
    v_mfma_f32_16x16x32_bf16 v[120:123], v[32:35], v[64:67], v[120:123]
    v_mfma_f32_16x16x32_bf16 v[124:127], v[20:23], v[60:63], v[124:127]
    v_mfma_f32_16x16x32_bf16 v[124:127], v[36:39], v[64:67], v[124:127]
    s_waitcnt lgkmcnt(0)
    s_barrier
    v_mfma_f32_16x16x32_bf16 v[128:131], v[24:27], v[60:63], v[128:131]
    ds_read_b64_tr_b16 v[60:61], v10 offset:8192
    v_mfma_f32_16x16x32_bf16 v[128:131], v[40:43], v[64:67], v[128:131]
    ds_read_b64_tr_b16 v[62:63], v10 offset:8704
    v_mfma_f32_16x16x32_bf16 v[132:135], v[12:15], v[44:47], v[132:135]
    ds_read_b64_tr_b16 v[64:65], v10 offset:12288
    v_mfma_f32_16x16x32_bf16 v[132:135], v[28:31], v[48:51], v[132:135]
    ds_read_b64_tr_b16 v[66:67], v10 offset:12800
W_1:
    s_cbranch_execz R_1
    s_nop 0
    v_mfma_f32_16x16x32_bf16 v[148:151], v[12:15], v[52:55], v[148:151]
    ds_read_b128 v[12:15], v6 offset:0
    v_mfma_f32_16x16x32_bf16 v[148:151], v[28:31], v[56:59], v[148:151]
    ds_read_b128 v[28:31], v7 offset:0
    v_mfma_f32_16x16x32_bf16 v[136:139], v[16:19], v[44:47], v[136:139]
    v_mfma_f32_16x16x32_bf16 v[136:139], v[32:35], v[48:51], v[136:139]
    v_mfma_f32_16x16x32_bf16 v[152:155], v[16:19], v[52:55], v[152:155]
    ds_read_b128 v[16:19], v6 offset:2048
    v_mfma_f32_16x16x32_bf16 v[152:155], v[32:35], v[56:59], v[152:155]
    ds_read_b128 v[32:35], v7 offset:2048
    v_mfma_f32_16x16x32_bf16 v[140:143], v[20:23], v[44:47], v[140:143]
    v_mfma_f32_16x16x32_bf16 v[140:143], v[36:39], v[48:51], v[140:143]
    v_mfma_f32_16x16x32_bf16 v[156:159], v[20:23], v[52:55], v[156:159]
    ds_read_b128 v[20:23], v6 offset:4096
    v_mfma_f32_16x16x32_bf16 v[156:159], v[36:39], v[56:59], v[156:159]
    ds_read_b128 v[36:39], v7 offset:4096
    v_mfma_f32_16x16x32_bf16 v[144:147], v[24:27], v[44:47], v[144:147]
    ds_read_b64_tr_b16 v[44:45], v11 offset:8192
    v_mfma_f32_16x16x32_bf16 v[144:147], v[40:43], v[48:51], v[144:147]
    ds_read_b64_tr_b16 v[46:47], v11 offset:8704
    v_mfma_f32_16x16x32_bf16 v[160:163], v[24:27], v[52:55], v[160:163]
    ds_read_b128 v[24:27], v6 offset:6144
    v_mfma_f32_16x16x32_bf16 v[160:163], v[40:43], v[56:59], v[160:163]
    ds_read_b128 v[40:43], v7 offset:6144
    s_waitcnt lgkmcnt(7)
    v_mfma_f32_16x16x32_bf16 v[100:103], v[12:15], v[60:63], v[100:103]
    ds_read_b64_tr_b16 v[48:49], v11 offset:12288
    v_mfma_f32_16x16x32_bf16 v[100:103], v[28:31], v[64:67], v[100:103]
    ds_read_b64_tr_b16 v[50:51], v11 offset:12800
    v_mfma_f32_16x16x32_bf16 v[104:107], v[16:19], v[60:63], v[104:107]
    ds_read_b64_tr_b16 v[52:53], v10 offset:16384
    s_waitcnt lgkmcnt(9)
    v_mfma_f32_16x16x32_bf16 v[104:107], v[32:35], v[64:67], v[104:107]
    ds_read_b64_tr_b16 v[54:55], v10 offset:16896
    s_waitcnt lgkmcnt(9)
    v_mfma_f32_16x16x32_bf16 v[108:111], v[20:23], v[60:63], v[108:111]
    ds_read_b64_tr_b16 v[56:57], v10 offset:20480
    s_waitcnt lgkmcnt(9)
    v_mfma_f32_16x16x32_bf16 v[108:111], v[36:39], v[64:67], v[108:111]
    ds_read_b64_tr_b16 v[58:59], v10 offset:20992
    s_waitcnt lgkmcnt(7)
    v_mfma_f32_16x16x32_bf16 v[112:115], v[24:27], v[60:63], v[112:115]
    ds_read_b64_tr_b16 v[60:61], v11 offset:16384
    s_waitcnt lgkmcnt(7)
    v_mfma_f32_16x16x32_bf16 v[112:115], v[40:43], v[64:67], v[112:115]
    ds_read_b64_tr_b16 v[62:63], v11 offset:16896
    v_mfma_f32_16x16x32_bf16 v[116:119], v[12:15], v[44:47], v[116:119]
    ds_read_b64_tr_b16 v[64:65], v11 offset:20480
    s_waitcnt lgkmcnt(7)
    v_mfma_f32_16x16x32_bf16 v[116:119], v[28:31], v[48:51], v[116:119]
    ds_read_b64_tr_b16 v[66:67], v11 offset:20992
    v_mfma_f32_16x16x32_bf16 v[120:123], v[16:19], v[44:47], v[120:123]
    v_mfma_f32_16x16x32_bf16 v[120:123], v[32:35], v[48:51], v[120:123]
    v_mfma_f32_16x16x32_bf16 v[124:127], v[20:23], v[44:47], v[124:127]
    v_mfma_f32_16x16x32_bf16 v[124:127], v[36:39], v[48:51], v[124:127]
    s_waitcnt lgkmcnt(0)
    s_barrier
    v_mfma_f32_16x16x32_bf16 v[128:131], v[24:27], v[44:47], v[128:131]
    ds_read_b64_tr_b16 v[44:45], v10 offset:49152
    v_mfma_f32_16x16x32_bf16 v[128:131], v[40:43], v[48:51], v[128:131]
    ds_read_b64_tr_b16 v[46:47], v10 offset:49664
    v_mfma_f32_16x16x32_bf16 v[132:135], v[12:15], v[52:55], v[132:135]
    ds_read_b64_tr_b16 v[48:49], v10 offset:53248
    v_mfma_f32_16x16x32_bf16 v[132:135], v[28:31], v[56:59], v[132:135]
    ds_read_b64_tr_b16 v[50:51], v10 offset:53760
    v_mfma_f32_16x16x32_bf16 v[148:151], v[12:15], v[60:63], v[148:151]
    ds_read_b128 v[12:15], v6 offset:40960
    v_mfma_f32_16x16x32_bf16 v[148:151], v[28:31], v[64:67], v[148:151]
    ds_read_b128 v[28:31], v7 offset:40960
    v_mfma_f32_16x16x32_bf16 v[136:139], v[16:19], v[52:55], v[136:139]
    v_mfma_f32_16x16x32_bf16 v[136:139], v[32:35], v[56:59], v[136:139]
    v_mfma_f32_16x16x32_bf16 v[152:155], v[16:19], v[60:63], v[152:155]
    ds_read_b128 v[16:19], v6 offset:43008
    v_mfma_f32_16x16x32_bf16 v[152:155], v[32:35], v[64:67], v[152:155]
    ds_read_b128 v[32:35], v7 offset:43008
    v_mfma_f32_16x16x32_bf16 v[140:143], v[20:23], v[52:55], v[140:143]
    v_mfma_f32_16x16x32_bf16 v[140:143], v[36:39], v[56:59], v[140:143]
    v_mfma_f32_16x16x32_bf16 v[156:159], v[20:23], v[60:63], v[156:159]
    ds_read_b128 v[20:23], v6 offset:45056
    v_mfma_f32_16x16x32_bf16 v[156:159], v[36:39], v[64:67], v[156:159]
    ds_read_b128 v[36:39], v7 offset:45056
    v_mfma_f32_16x16x32_bf16 v[144:147], v[24:27], v[52:55], v[144:147]
    ds_read_b64_tr_b16 v[52:53], v11 offset:49152
    v_mfma_f32_16x16x32_bf16 v[144:147], v[40:43], v[56:59], v[144:147]
    ds_read_b64_tr_b16 v[54:55], v11 offset:49664
    v_mfma_f32_16x16x32_bf16 v[160:163], v[24:27], v[60:63], v[160:163]
    ds_read_b128 v[24:27], v6 offset:47104
    v_mfma_f32_16x16x32_bf16 v[160:163], v[40:43], v[64:67], v[160:163]
    ds_read_b128 v[40:43], v7 offset:47104
    s_waitcnt lgkmcnt(7)
    v_mfma_f32_16x16x32_bf16 v[100:103], v[12:15], v[44:47], v[100:103]
    ds_read_b64_tr_b16 v[56:57], v11 offset:53248
    v_mfma_f32_16x16x32_bf16 v[100:103], v[28:31], v[48:51], v[100:103]
    ds_read_b64_tr_b16 v[58:59], v11 offset:53760
    v_mfma_f32_16x16x32_bf16 v[104:107], v[16:19], v[44:47], v[104:107]
    ds_read_b64_tr_b16 v[60:61], v10 offset:57344
    s_waitcnt lgkmcnt(9)
    v_mfma_f32_16x16x32_bf16 v[104:107], v[32:35], v[48:51], v[104:107]
    ds_read_b64_tr_b16 v[62:63], v10 offset:57856
    s_waitcnt lgkmcnt(9)
    v_mfma_f32_16x16x32_bf16 v[108:111], v[20:23], v[44:47], v[108:111]
    ds_read_b64_tr_b16 v[64:65], v10 offset:61440
    s_waitcnt lgkmcnt(9)
    v_mfma_f32_16x16x32_bf16 v[108:111], v[36:39], v[48:51], v[108:111]
    ds_read_b64_tr_b16 v[66:67], v10 offset:61952
    s_waitcnt lgkmcnt(7)
    v_mfma_f32_16x16x32_bf16 v[112:115], v[24:27], v[44:47], v[112:115]
    ds_read_b64_tr_b16 v[44:45], v11 offset:57344
    s_waitcnt lgkmcnt(7)
    v_mfma_f32_16x16x32_bf16 v[112:115], v[40:43], v[48:51], v[112:115]
    ds_read_b64_tr_b16 v[46:47], v11 offset:57856
    v_mfma_f32_16x16x32_bf16 v[116:119], v[12:15], v[52:55], v[116:119]
    ds_read_b64_tr_b16 v[48:49], v11 offset:61440
    s_waitcnt lgkmcnt(7)
    v_mfma_f32_16x16x32_bf16 v[116:119], v[28:31], v[56:59], v[116:119]
    ds_read_b64_tr_b16 v[50:51], v11 offset:61952
    v_mfma_f32_16x16x32_bf16 v[120:123], v[16:19], v[52:55], v[120:123]
    v_mfma_f32_16x16x32_bf16 v[120:123], v[32:35], v[56:59], v[120:123]
    v_mfma_f32_16x16x32_bf16 v[124:127], v[20:23], v[52:55], v[124:127]
    v_mfma_f32_16x16x32_bf16 v[124:127], v[36:39], v[56:59], v[124:127]
    v_mfma_f32_16x16x32_bf16 v[128:131], v[24:27], v[52:55], v[128:131]
    ds_read2_b32 v[52:53], v165 offset0:64 offset1:64
    v_mfma_f32_16x16x32_bf16 v[128:131], v[40:43], v[56:59], v[128:131]
    ds_read2_b32 v[54:55], v165 offset0:80 offset1:80
    s_waitcnt lgkmcnt(5)
    v_mfma_f32_16x16x32_bf16 v[132:135], v[12:15], v[60:63], v[132:135]
    ds_read2_b32 v[56:57], v165 offset0:128 offset1:128
    v_mfma_f32_16x16x32_bf16 v[132:135], v[28:31], v[64:67], v[132:135]
    ds_read2_b32 v[58:59], v165 offset0:144 offset1:144
    s_waitcnt lgkmcnt(5)
    v_mfma_f32_16x16x32_bf16 v[148:151], v[12:15], v[44:47], v[148:151]
    ds_read_b128 v[12:15], v164 offset:0
    s_waitcnt lgkmcnt(5)
    v_mfma_f32_16x16x32_bf16 v[148:151], v[28:31], v[48:51], v[148:151]
    ds_read_b128 v[28:31], v164 offset:512
    v_mfma_f32_16x16x32_bf16 v[136:139], v[16:19], v[60:63], v[136:139]
    v_mfma_f32_16x16x32_bf16 v[136:139], v[32:35], v[64:67], v[136:139]
    v_mfma_f32_16x16x32_bf16 v[152:155], v[16:19], v[44:47], v[152:155]
    ds_read_b128 v[16:19], v164 offset:64
    v_mfma_f32_16x16x32_bf16 v[152:155], v[32:35], v[48:51], v[152:155]
    ds_read_b128 v[32:35], v164 offset:576
    v_mfma_f32_16x16x32_bf16 v[140:143], v[20:23], v[60:63], v[140:143]
    v_mfma_f32_16x16x32_bf16 v[140:143], v[36:39], v[64:67], v[140:143]
    v_mfma_f32_16x16x32_bf16 v[156:159], v[20:23], v[44:47], v[156:159]
    v_mfma_f32_16x16x32_bf16 v[156:159], v[36:39], v[48:51], v[156:159]
    v_mfma_f32_16x16x32_bf16 v[144:147], v[24:27], v[60:63], v[144:147]
    ds_read_b128 v[60:63], v164 offset:1024
    v_mfma_f32_16x16x32_bf16 v[144:147], v[40:43], v[64:67], v[144:147]
    ds_read_b128 v[64:67], v164 offset:1088
    v_mfma_f32_16x16x32_bf16 v[160:163], v[24:27], v[44:47], v[160:163]
    v_mfma_f32_16x16x32_bf16 v[160:163], v[40:43], v[48:51], v[160:163]
    s_mov_b32 s50, 0x10001
    s_mov_b32 s51, s50
    ds_read_b128 v[36:39], v164 offset:128
    ds_read_b128 v[40:43], v164 offset:192
    ds_read_b128 v[44:47], v164 offset:640
    ds_read_b128 v[48:51], v164 offset:704
    s_waitcnt lgkmcnt(9)
    v_pk_fma_f32 v[100:101], v[12:13], v[52:53], v[100:101]
    v_pk_fma_f32 v[102:103], v[14:15], v[52:53], v[102:103]
    s_waitcnt lgkmcnt(7)
    v_pk_fma_f32 v[104:105], v[16:17], v[52:53], v[104:105]
    v_pk_fma_f32 v[106:107], v[18:19], v[52:53], v[106:107]
    s_waitcnt lgkmcnt(5)
    v_pk_mul_f32 v[20:21], v[100:101], v[60:61]
    v_pk_mul_f32 v[22:23], v[102:103], v[62:63]
    s_waitcnt lgkmcnt(4)
    v_pk_mul_f32 v[24:25], v[104:105], v[64:65]
    v_pk_mul_f32 v[26:27], v[106:107], v[66:67]
    v_pk_fma_f32 v[100:101], v[100:101], v[28:29], s[40:41]
    v_pk_fma_f32 v[102:103], v[102:103], v[30:31], s[40:41]
    v_pk_fma_f32 v[104:105], v[104:105], v[32:33], s[40:41]
    v_pk_fma_f32 v[106:107], v[106:107], v[34:35], s[40:41]
    v_exp_f32 v20, v20 clamp
    v_exp_f32 v21, v21 clamp
    v_exp_f32 v22, v22 clamp
    v_exp_f32 v23, v23 clamp
    v_exp_f32 v24, v24 clamp
    v_exp_f32 v25, v25 clamp
    v_exp_f32 v26, v26 clamp
    v_exp_f32 v27, v27 clamp
    v_pk_add_f32 v[20:21], v[20:21], s[74:75]
    v_pk_add_f32 v[22:23], v[22:23], s[74:75]
    v_pk_add_f32 v[24:25], v[24:25], s[74:75]
    v_pk_add_f32 v[26:27], v[26:27], s[74:75]
    v_max_f32 v100, v100, v20
    v_max_f32 v101, v101, v21
    v_max_f32 v102, v102, v22
    v_max_f32 v103, v103, v23
    v_max_f32 v104, v104, v24
    v_max_f32 v105, v105, v25
    v_max_f32 v106, v106, v26
    v_max_f32 v107, v107, v27
    v_cvt_pk_bf16_f32 v100, v100, v101
    v_cvt_pk_bf16_f32 v101, v102, v103
    v_cvt_pk_bf16_f32 v102, v104, v105
    v_cvt_pk_bf16_f32 v103, v106, v107
    s_waitcnt lgkmcnt(3)
    v_pk_fma_f32 v[140:141], v[36:37], v[56:57], v[140:141]
    v_pk_fma_f32 v[142:143], v[38:39], v[56:57], v[142:143]
    s_waitcnt lgkmcnt(2)
    v_pk_fma_f32 v[144:145], v[40:41], v[56:57], v[144:145]
    v_pk_fma_f32 v[146:147], v[42:43], v[56:57], v[146:147]
    s_waitcnt lgkmcnt(1)
    v_pk_mul_f32 v[140:141], v[140:141], v[44:45]
    v_pk_mul_f32 v[142:143], v[142:143], v[46:47]
    s_waitcnt lgkmcnt(0)
    v_pk_mul_f32 v[144:145], v[144:145], v[48:49]
    v_pk_mul_f32 v[146:147], v[146:147], v[50:51]
    v_cvt_pk_bf16_f32 v140, v140, v141
    v_cvt_pk_bf16_f32 v141, v142, v143
    v_cvt_pk_bf16_f32 v142, v144, v145
    v_cvt_pk_bf16_f32 v143, v146, v147
    v_pk_fma_f32 v[156:157], v[36:37], v[58:59], v[156:157]
    v_pk_fma_f32 v[158:159], v[38:39], v[58:59], v[158:159]
    v_pk_fma_f32 v[160:161], v[40:41], v[58:59], v[160:161]
    v_pk_fma_f32 v[162:163], v[42:43], v[58:59], v[162:163]
    v_pk_mul_f32 v[156:157], v[156:157], v[44:45]
    v_pk_mul_f32 v[158:159], v[158:159], v[46:47]
    v_pk_mul_f32 v[160:161], v[160:161], v[48:49]
    v_pk_mul_f32 v[162:163], v[162:163], v[50:51]
    v_cvt_pk_bf16_f32 v156, v156, v157
    v_cvt_pk_bf16_f32 v157, v158, v159
    v_cvt_pk_bf16_f32 v158, v160, v161
    v_cvt_pk_bf16_f32 v159, v162, v163
    ds_read_b128 v[144:147], v164 offset:1152
    ds_read_b128 v[160:163], v164 offset:1216
    v_pk_fma_f32 v[132:133], v[12:13], v[56:57], v[132:133]
    v_pk_fma_f32 v[134:135], v[14:15], v[56:57], v[134:135]
    v_pk_fma_f32 v[136:137], v[16:17], v[56:57], v[136:137]
    v_pk_fma_f32 v[138:139], v[18:19], v[56:57], v[138:139]
    v_pk_mul_f32 v[132:133], v[132:133], v[28:29]
    v_pk_mul_f32 v[134:135], v[134:135], v[30:31]
    v_pk_mul_f32 v[136:137], v[136:137], v[32:33]
    v_pk_mul_f32 v[138:139], v[138:139], v[34:35]
    v_cvt_pk_bf16_f32 v132, v132, v133
    v_cvt_pk_bf16_f32 v133, v134, v135
    v_cvt_pk_bf16_f32 v134, v136, v137
    v_cvt_pk_bf16_f32 v135, v138, v139
    v_pk_fma_f32 v[148:149], v[12:13], v[58:59], v[148:149]
    v_pk_fma_f32 v[150:151], v[14:15], v[58:59], v[150:151]
    v_pk_fma_f32 v[152:153], v[16:17], v[58:59], v[152:153]
    v_pk_fma_f32 v[154:155], v[18:19], v[58:59], v[154:155]
    v_pk_mul_f32 v[148:149], v[148:149], v[28:29]
    v_pk_mul_f32 v[150:151], v[150:151], v[30:31]
    v_pk_mul_f32 v[152:153], v[152:153], v[32:33]
    v_pk_mul_f32 v[154:155], v[154:155], v[34:35]
    v_cvt_pk_bf16_f32 v148, v148, v149
    v_cvt_pk_bf16_f32 v149, v150, v151
    v_cvt_pk_bf16_f32 v150, v152, v153
    v_cvt_pk_bf16_f32 v151, v154, v155
    v_mov_b32 v56, 0x3f803f80
    v_mov_b32 v57, 0x3f803f80
    v_mov_b32 v58, 0x3f803f80
    v_mov_b32 v59, 0x3f803f80
    v_mov_b32 v164, 1
    v_mov_b32 v165, 2
    v_pk_fma_f32 v[108:109], v[36:37], v[52:53], v[108:109]
    v_pk_fma_f32 v[110:111], v[38:39], v[52:53], v[110:111]
    v_pk_fma_f32 v[112:113], v[40:41], v[52:53], v[112:113]
    v_pk_fma_f32 v[114:115], v[42:43], v[52:53], v[114:115]
    s_waitcnt lgkmcnt(1)
    v_pk_mul_f32 v[20:21], v[108:109], v[144:145]
    v_pk_mul_f32 v[22:23], v[110:111], v[146:147]
    s_waitcnt lgkmcnt(0)
    v_pk_mul_f32 v[24:25], v[112:113], v[160:161]
    v_pk_mul_f32 v[26:27], v[114:115], v[162:163]
    v_pk_fma_f32 v[108:109], v[108:109], v[44:45], s[40:41]
    v_pk_fma_f32 v[110:111], v[110:111], v[46:47], s[40:41]
    v_pk_fma_f32 v[112:113], v[112:113], v[48:49], s[40:41]
    v_pk_fma_f32 v[114:115], v[114:115], v[50:51], s[40:41]
    v_mfma_f32_16x16x32_bf16 v[136:139], v[100:103], v[132:135], 0
    v_exp_f32 v20, v20 clamp
    v_mfma_f32_16x16x32_bf16 v[152:155], v[100:103], v[148:151], 0
    v_exp_f32 v21, v21 clamp
    v_mfma_f32_16x16x32_bf16 v[104:107], v[100:103], v[56:59], 0
    v_exp_f32 v22, v22 clamp
    v_exp_f32 v23, v23 clamp
    v_exp_f32 v24, v24 clamp
    v_exp_f32 v25, v25 clamp
    v_exp_f32 v26, v26 clamp
    v_exp_f32 v27, v27 clamp
    v_pk_add_f32 v[20:21], v[20:21], s[74:75]
    v_pk_add_f32 v[22:23], v[22:23], s[74:75]
    v_pk_add_f32 v[24:25], v[24:25], s[74:75]
    v_pk_add_f32 v[26:27], v[26:27], s[74:75]
    v_max_f32 v108, v108, v20
    v_max_f32 v109, v109, v21
    v_max_f32 v110, v110, v22
    v_max_f32 v111, v111, v23
    v_max_f32 v112, v112, v24
    v_max_f32 v113, v113, v25
    v_max_f32 v114, v114, v26
    v_max_f32 v115, v115, v27
    v_cvt_pk_bf16_f32 v108, v108, v109
    v_cvt_pk_bf16_f32 v109, v110, v111
    v_cvt_pk_bf16_f32 v110, v112, v113
    v_cvt_pk_bf16_f32 v111, v114, v115
    v_pk_fma_f32 v[116:117], v[12:13], v[54:55], v[116:117]
    v_pk_fma_f32 v[118:119], v[14:15], v[54:55], v[118:119]
    v_pk_fma_f32 v[120:121], v[16:17], v[54:55], v[120:121]
    v_pk_fma_f32 v[122:123], v[18:19], v[54:55], v[122:123]
    v_pk_mul_f32 v[20:21], v[116:117], v[60:61]
    v_pk_mul_f32 v[22:23], v[118:119], v[62:63]
    v_pk_mul_f32 v[24:25], v[120:121], v[64:65]
    v_pk_mul_f32 v[26:27], v[122:123], v[66:67]
    v_pk_fma_f32 v[116:117], v[116:117], v[28:29], s[40:41]
    v_pk_fma_f32 v[118:119], v[118:119], v[30:31], s[40:41]
    v_pk_fma_f32 v[120:121], v[120:121], v[32:33], s[40:41]
    v_pk_fma_f32 v[122:123], v[122:123], v[34:35], s[40:41]
    v_mfma_f32_16x16x32_bf16 v[136:139], v[108:111], v[140:143], v[136:139]
    v_exp_f32 v20, v20 clamp
    v_mfma_f32_16x16x32_bf16 v[152:155], v[108:111], v[156:159], v[152:155]
    v_exp_f32 v21, v21 clamp
    v_mfma_f32_16x16x32_bf16 v[104:107], v[108:111], v[56:59], v[104:107]
    v_exp_f32 v22, v22 clamp
    v_exp_f32 v23, v23 clamp
    v_exp_f32 v24, v24 clamp
    v_exp_f32 v25, v25 clamp
    v_exp_f32 v26, v26 clamp
    v_exp_f32 v27, v27 clamp
    v_pk_add_f32 v[20:21], v[20:21], s[74:75]
    v_pk_add_f32 v[22:23], v[22:23], s[74:75]
    v_pk_add_f32 v[24:25], v[24:25], s[74:75]
    v_pk_add_f32 v[26:27], v[26:27], s[74:75]
    ds_write_b128 v1, v[136:139] offset:0
    ds_write_b128 v1, v[152:155] offset:1024
    s_mov_b64 exec, s[50:51]
    ds_write_b128 v2, v[104:107] offset:0
    s_mov_b64 exec, 1
    ds_write_b32 v3, v164
    s_mov_b64 exec, -1
    v_max_f32 v116, v116, v20
    v_max_f32 v117, v117, v21
    v_max_f32 v118, v118, v22
    v_max_f32 v119, v119, v23
    v_max_f32 v120, v120, v24
    v_max_f32 v121, v121, v25
    v_max_f32 v122, v122, v26
    v_max_f32_e64 v123, v123, v27
    v_cvt_pk_bf16_f32 v116, v116, v117
    v_cvt_pk_bf16_f32 v117, v118, v119
    v_cvt_pk_bf16_f32 v118, v120, v121
    v_cvt_pk_bf16_f32 v119, v122, v123
    v_pk_fma_f32 v[124:125], v[36:37], v[54:55], v[124:125]
    v_pk_fma_f32 v[126:127], v[38:39], v[54:55], v[126:127]
    v_pk_fma_f32 v[128:129], v[40:41], v[54:55], v[128:129]
    v_pk_fma_f32 v[130:131], v[42:43], v[54:55], v[130:131]
    v_pk_mul_f32 v[20:21], v[124:125], v[144:145]
    v_pk_mul_f32 v[22:23], v[126:127], v[146:147]
    v_pk_mul_f32 v[24:25], v[128:129], v[160:161]
    v_pk_mul_f32 v[26:27], v[130:131], v[162:163]
    v_pk_fma_f32 v[124:125], v[124:125], v[44:45], s[40:41]
    v_pk_fma_f32 v[126:127], v[126:127], v[46:47], s[40:41]
    v_pk_fma_f32 v[128:129], v[128:129], v[48:49], s[40:41]
    v_pk_fma_f32 v[130:131], v[130:131], v[50:51], s[40:41]
    v_mfma_f32_16x16x32_bf16 v[112:115], v[116:119], v[132:135], 0
    v_exp_f32 v20, v20 clamp
    v_mfma_f32_16x16x32_bf16 v[120:123], v[116:119], v[148:151], 0
    v_exp_f32 v21, v21 clamp
    v_mfma_f32_16x16x32_bf16 v[100:103], v[116:119], v[56:59], 0
    v_exp_f32 v22, v22 clamp
    v_exp_f32 v23, v23 clamp
    v_exp_f32 v24, v24 clamp
    v_exp_f32 v25, v25 clamp
    v_exp_f32 v26, v26 clamp
    v_exp_f32 v27, v27 clamp
    v_pk_add_f32 v[20:21], v[20:21], s[74:75]
    v_pk_add_f32 v[22:23], v[22:23], s[74:75]
    v_pk_add_f32 v[24:25], v[24:25], s[74:75]
    v_pk_add_f32 v[26:27], v[26:27], s[74:75]
    v_max_f32 v124, v124, v20
    v_max_f32 v125, v125, v21
    v_max_f32 v126, v126, v22
    v_max_f32 v127, v127, v23
    v_max_f32 v128, v128, v24
    v_max_f32 v129, v129, v25
    v_max_f32 v130, v130, v26
    v_max_f32 v131, v131, v27
    v_cvt_pk_bf16_f32 v124, v124, v125
    v_cvt_pk_bf16_f32 v125, v126, v127
    v_cvt_pk_bf16_f32 v126, v128, v129
    v_cvt_pk_bf16_f32 v127, v130, v131
    s_nop 1
    v_mfma_f32_16x16x32_bf16 v[112:115], v[124:127], v[140:143], v[112:115]
    v_mfma_f32_16x16x32_bf16 v[120:123], v[124:127], v[156:159], v[120:123]
    v_mfma_f32_16x16x32_bf16 v[100:103], v[124:127], v[56:59], v[100:103]
    ds_read_b128 v[28:31], v4 offset:0
    ds_read_b64_tr_b16 v[44:45], v8 offset:0
    ds_read_b64_tr_b16 v[46:47], v8 offset:512
    ds_read_b128 v[32:35], v4 offset:2048
    ds_read_b128 v[36:39], v4 offset:4096
    ds_read_b128 v[40:43], v4 offset:6144
    ds_write_b128 v1, v[112:115] offset:2048
    ds_write_b128 v1, v[120:123] offset:3072
    s_mov_b64 exec, s[50:51]
    ds_write_b128 v2, v[100:103] offset:64
    s_mov_b64 exec, 1
    ds_write_b32 v3, v165
    s_mov_b64 exec, -1
    ds_read_b64_tr_b16 v[48:49], v9 offset:0
    s_waitcnt lgkmcnt(8)
    ds_read_b64_tr_b16 v[50:51], v9 offset:512
    s_setprio 0
    v_and_b32 v132, 15, v0
    s_lshl_b32 s44, s36, 8
    s_add_u32 s44, s44, 24832
    v_lshl_add_u32 v132, v132, 2, s44
    v_add_u32 v133, 1024, v132
    s_lshl_b32 s44, s37, 7
    s_add_u32 s44, s44, 26368
    v_and_or_b32 v134, v0, 48, s44
    s_lshl_b32 s44, s35, 2
    s_and_b32 s47, s3, 2
    s_add_u32 s44, s44, s47
    s_lshr_b32 s44, 0xeee7eece, s44
    s_and_b32 s44, s44, 3
    s_mul_i32 s44, s44, 40960
    s_and_b32 s47, s28, 1
    s_lshl_b32 s47, s47, 13
    s_add_u32 s44, s44, s47
    s_lshl_b32 s47, s37, 6
    v_lshrrev_b32 v140, 4, v0
    v_lshlrev_b32 v140, 3, v140
    v_xor_b32 v140, s47, v140
    v_and_b32 v141, 14, v0
    v_lshlrev_b32 v141, 3, v141
    v_xor_b32 v140, v140, v141
    v_and_b32 v141, 15, v0
    v_lshlrev_b32 v141, 7, v141
    v_add3_u32 v140, v140, v141, s44
    v_xor_b32 v141, 32, v140

    s_waitcnt lgkmcnt(9)
    v_mfma_f32_16x16x32_bf16 v[68:71], v[44:47], v[28:31], v[68:71]
    ds_read_b128 v[12:15], v5 offset:0
    ds_read_b64_tr_b16 v[52:53], v8 offset:4096
    s_waitcnt lgkmcnt(10)
    v_mfma_f32_16x16x32_bf16 v[72:75], v[44:47], v[32:35], v[72:75]
    ds_read_b64_tr_b16 v[54:55], v8 offset:4608
    ds_read_b128 v[16:19], v5 offset:2048
    s_waitcnt lgkmcnt(11)
    v_mfma_f32_16x16x32_bf16 v[76:79], v[44:47], v[36:39], v[76:79]
    ds_read_b128 v[20:23], v5 offset:4096
    ds_read_b128 v[24:27], v5 offset:6144
    s_waitcnt lgkmcnt(12)
    v_mfma_f32_16x16x32_bf16 v[80:83], v[44:47], v[40:43], v[80:83]
    ds_read_b64_tr_b16 v[56:57], v9 offset:4096
    ds_read_b64_tr_b16 v[58:59], v9 offset:4608
    s_waitcnt lgkmcnt(8)
    v_mfma_f32_16x16x32_bf16 v[84:87], v[48:51], v[28:31], v[84:87]
    v_mfma_f32_16x16x32_bf16 v[88:91], v[48:51], v[32:35], v[88:91]
    v_mfma_f32_16x16x32_bf16 v[92:95], v[48:51], v[36:39], v[92:95]
    v_mfma_f32_16x16x32_bf16 v[96:99], v[48:51], v[40:43], v[96:99]
    s_waitcnt lgkmcnt(5)
    v_mfma_f32_16x16x32_bf16 v[68:71], v[52:55], v[12:15], v[68:71]
    ds_read_b128 v[28:31], v4 offset:40960
    ds_read_b64_tr_b16 v[44:45], v8 offset:40960
    s_waitcnt lgkmcnt(6)
    v_mfma_f32_16x16x32_bf16 v[72:75], v[52:55], v[16:19], v[72:75]
    ds_read_b64_tr_b16 v[46:47], v8 offset:41472
    ds_read_b128 v[32:35], v4 offset:43008
    s_waitcnt lgkmcnt(7)
    v_mfma_f32_16x16x32_bf16 v[76:79], v[52:55], v[20:23], v[76:79]
    ds_read_b128 v[36:39], v4 offset:45056
    ds_read_b128 v[40:43], v4 offset:47104
    s_waitcnt lgkmcnt(8)
    v_mfma_f32_16x16x32_bf16 v[80:83], v[52:55], v[24:27], v[80:83]
    ds_read_b64_tr_b16 v[48:49], v9 offset:40960
    ds_read_b64_tr_b16 v[50:51], v9 offset:41472
    s_waitcnt lgkmcnt(8)
    v_mfma_f32_16x16x32_bf16 v[84:87], v[56:59], v[12:15], v[84:87]
    v_mfma_f32_16x16x32_bf16 v[88:91], v[56:59], v[16:19], v[88:91]
    v_mfma_f32_16x16x32_bf16 v[92:95], v[56:59], v[20:23], v[92:95]
    v_mfma_f32_16x16x32_bf16 v[96:99], v[56:59], v[24:27], v[96:99]
    s_waitcnt lgkmcnt(5)
    v_mfma_f32_16x16x32_bf16 v[68:71], v[44:47], v[28:31], v[68:71]
    ds_read_b128 v[12:15], v5 offset:40960
    ds_read_b64_tr_b16 v[52:53], v8 offset:45056
    s_waitcnt lgkmcnt(6)
    v_mfma_f32_16x16x32_bf16 v[72:75], v[44:47], v[32:35], v[72:75]
    ds_read_b64_tr_b16 v[54:55], v8 offset:45568
    ds_read_b128 v[16:19], v5 offset:43008
    s_waitcnt lgkmcnt(7)
    v_mfma_f32_16x16x32_bf16 v[76:79], v[44:47], v[36:39], v[76:79]
    ds_read_b128 v[20:23], v5 offset:45056
    ds_read_b128 v[24:27], v5 offset:47104
    s_waitcnt lgkmcnt(8)
    v_mfma_f32_16x16x32_bf16 v[80:83], v[44:47], v[40:43], v[80:83]
    ds_read_b64_tr_b16 v[56:57], v9 offset:45056
    ds_read_b64_tr_b16 v[58:59], v9 offset:45568
    s_waitcnt lgkmcnt(8)
    v_mfma_f32_16x16x32_bf16 v[84:87], v[48:51], v[28:31], v[84:87]
    ds_read_b64 v[148:149], v140 offset:0
    ds_read_b64 v[150:151], v141 offset:0
    v_mfma_f32_16x16x32_bf16 v[88:91], v[48:51], v[32:35], v[88:91]
    ds_read_b64 v[152:153], v140 offset:2048
    ds_read_b64 v[154:155], v141 offset:2048
    v_mfma_f32_16x16x32_bf16 v[92:95], v[48:51], v[36:39], v[92:95]
    v_mfma_f32_16x16x32_bf16 v[96:99], v[48:51], v[40:43], v[96:99]
    s_waitcnt lgkmcnt(9)
    v_mfma_f32_16x16x32_bf16 v[68:71], v[52:55], v[12:15], v[68:71]
    ds_read_b128 v[28:31], v6 offset:0
    ds_read_b64_tr_b16 v[44:45], v10 offset:0
    s_waitcnt lgkmcnt(10)
    v_mfma_f32_16x16x32_bf16 v[72:75], v[52:55], v[16:19], v[72:75]
    ds_read_b64_tr_b16 v[46:47], v10 offset:512
    ds_read_b128 v[32:35], v6 offset:2048
    s_waitcnt lgkmcnt(11)
    v_mfma_f32_16x16x32_bf16 v[76:79], v[52:55], v[20:23], v[76:79]
    ds_read_b128 v[36:39], v6 offset:4096
    ds_read_b128 v[40:43], v6 offset:6144
    s_waitcnt lgkmcnt(12)
    v_mfma_f32_16x16x32_bf16 v[80:83], v[52:55], v[24:27], v[80:83]
    ds_read_b64_tr_b16 v[48:49], v11 offset:0
    ds_read_b64_tr_b16 v[50:51], v11 offset:512
    s_waitcnt lgkmcnt(12)
    v_mfma_f32_16x16x32_bf16 v[84:87], v[56:59], v[12:15], v[84:87]
    ds_read_b64 v[156:157], v140 offset:4096
    ds_read_b64 v[158:159], v141 offset:4096
    v_mfma_f32_16x16x32_bf16 v[88:91], v[56:59], v[16:19], v[88:91]
    ds_read_b64 v[160:161], v140 offset:6144
    s_waitcnt lgkmcnt(8)
    ds_read_b64 v[162:163], v141 offset:6144
    v_mfma_f32_16x16x32_bf16 v[92:95], v[56:59], v[20:23], v[92:95]
    v_mfma_f32_16x16x32_bf16 v[96:99], v[56:59], v[24:27], v[96:99]
    s_waitcnt lgkmcnt(9)
    v_mfma_f32_16x16x32_bf16 v[68:71], v[44:47], v[28:31], v[68:71]
    ds_read_b128 v[12:15], v7 offset:0
    ds_read_b64_tr_b16 v[52:53], v10 offset:4096
    s_waitcnt lgkmcnt(10)
    v_mfma_f32_16x16x32_bf16 v[72:75], v[44:47], v[32:35], v[72:75]
    ds_read_b64_tr_b16 v[54:55], v10 offset:4608
    ds_read_b128 v[16:19], v7 offset:2048
    s_waitcnt lgkmcnt(11)
    v_mfma_f32_16x16x32_bf16 v[76:79], v[44:47], v[36:39], v[76:79]
    ds_read_b128 v[20:23], v7 offset:4096
    ds_read_b128 v[24:27], v7 offset:6144
    s_waitcnt lgkmcnt(12)
    v_mfma_f32_16x16x32_bf16 v[80:83], v[44:47], v[40:43], v[80:83]
    ds_read_b64_tr_b16 v[56:57], v11 offset:4096
    ds_read_b64_tr_b16 v[58:59], v11 offset:4608
    s_waitcnt lgkmcnt(12)
    v_mfma_f32_16x16x32_bf16 v[84:87], v[48:51], v[28:31], v[84:87]
    v_mfma_f32_16x16x32_bf16 v[88:91], v[48:51], v[32:35], v[88:91]
    v_mfma_f32_16x16x32_bf16 v[92:95], v[48:51], v[36:39], v[92:95]
    v_mfma_f32_16x16x32_bf16 v[96:99], v[48:51], v[40:43], v[96:99]
    s_waitcnt lgkmcnt(5)
    v_mfma_f32_16x16x32_bf16 v[68:71], v[52:55], v[12:15], v[68:71]
    ds_read_b128 v[28:31], v6 offset:40960
    ds_read_b64_tr_b16 v[44:45], v10 offset:40960
    s_waitcnt lgkmcnt(6)
    v_mfma_f32_16x16x32_bf16 v[72:75], v[52:55], v[16:19], v[72:75]
    ds_read_b64_tr_b16 v[46:47], v10 offset:41472
    ds_read_b128 v[32:35], v6 offset:43008
    s_waitcnt lgkmcnt(7)
    v_mfma_f32_16x16x32_bf16 v[76:79], v[52:55], v[20:23], v[76:79]
    ds_read_b128 v[36:39], v6 offset:45056
    ds_read_b128 v[40:43], v6 offset:47104
    s_waitcnt lgkmcnt(8)
    v_mfma_f32_16x16x32_bf16 v[80:83], v[52:55], v[24:27], v[80:83]
    ds_read_b64_tr_b16 v[48:49], v11 offset:40960
    ds_read_b64_tr_b16 v[50:51], v11 offset:41472
    s_waitcnt lgkmcnt(8)
    v_mfma_f32_16x16x32_bf16 v[84:87], v[56:59], v[12:15], v[84:87]
    v_mfma_f32_16x16x32_bf16 v[88:91], v[56:59], v[16:19], v[88:91]
    v_mfma_f32_16x16x32_bf16 v[92:95], v[56:59], v[20:23], v[92:95]
    v_mfma_f32_16x16x32_bf16 v[96:99], v[56:59], v[24:27], v[96:99]
    s_waitcnt lgkmcnt(5)
    v_mfma_f32_16x16x32_bf16 v[68:71], v[44:47], v[28:31], v[68:71]
    ds_read_b128 v[12:15], v7 offset:40960
    ds_read_b64_tr_b16 v[52:53], v10 offset:45056
    s_waitcnt lgkmcnt(6)
    v_mfma_f32_16x16x32_bf16 v[72:75], v[44:47], v[32:35], v[72:75]
    ds_read_b64_tr_b16 v[54:55], v10 offset:45568
W_2:
    s_cbranch_execz R_2
    s_nop 0
    ds_read_b128 v[16:19], v7 offset:43008
    s_waitcnt lgkmcnt(7)
    v_mfma_f32_16x16x32_bf16 v[76:79], v[44:47], v[36:39], v[76:79]
    ds_read_b128 v[20:23], v7 offset:45056
    ds_read_b128 v[24:27], v7 offset:47104
    s_waitcnt lgkmcnt(8)
    v_mfma_f32_16x16x32_bf16 v[80:83], v[44:47], v[40:43], v[80:83]
    ds_read_b64_tr_b16 v[56:57], v11 offset:45056
    ds_read_b64_tr_b16 v[58:59], v11 offset:45568
    s_waitcnt lgkmcnt(8)
    v_mfma_f32_16x16x32_bf16 v[84:87], v[48:51], v[28:31], v[84:87]
    v_mfma_f32_16x16x32_bf16 v[88:91], v[48:51], v[32:35], v[88:91]
    v_mfma_f32_16x16x32_bf16 v[92:95], v[48:51], v[36:39], v[92:95]
    v_mfma_f32_16x16x32_bf16 v[96:99], v[48:51], v[40:43], v[96:99]
    s_waitcnt lgkmcnt(5)
    v_mfma_f32_16x16x32_bf16 v[68:71], v[52:55], v[12:15], v[68:71]
    v_mov_b32 v135, 3
    s_mov_b64 exec, 1
    ds_write_b32 v3, v135 offset:0
    s_mov_b64 exec, -1
    ds_read_b128 v[100:103], v134 offset:0
    ds_read_b128 v[104:107], v134 offset:64
    s_waitcnt lgkmcnt(7)
    v_mfma_f32_16x16x32_bf16 v[72:75], v[52:55], v[16:19], v[72:75]
    ds_read2_b32 v[108:109], v132 offset0:0 offset1:0
    ds_read2_b32 v[110:111], v132 offset0:16 offset1:16
    s_waitcnt lgkmcnt(8)
    v_mfma_f32_16x16x32_bf16 v[76:79], v[52:55], v[20:23], v[76:79]
    ds_read2_b32 v[112:113], v132 offset0:32 offset1:32
    ds_read2_b32 v[114:115], v132 offset0:48 offset1:48
    s_waitcnt lgkmcnt(9)
    v_mfma_f32_16x16x32_bf16 v[80:83], v[52:55], v[24:27], v[80:83]
    ds_read2_b32 v[124:125], v133 offset0:0 offset1:0
    ds_read2_b32 v[126:127], v133 offset0:16 offset1:16
    s_waitcnt lgkmcnt(9)
    v_mfma_f32_16x16x32_bf16 v[84:87], v[56:59], v[12:15], v[84:87]
    ds_read2_b32 v[128:129], v133 offset0:32 offset1:32
    ds_read2_b32 v[130:131], v133 offset0:48 offset1:48
    v_mfma_f32_16x16x32_bf16 v[88:91], v[56:59], v[16:19], v[88:91]
    ds_read2_b32 v[116:117], v132 offset0:128 offset1:128
    ds_read2_b32 v[118:119], v132 offset0:144 offset1:144
    v_mfma_f32_16x16x32_bf16 v[92:95], v[56:59], v[20:23], v[92:95]
    ds_read2_b32 v[120:121], v132 offset0:160 offset1:160
    ds_read2_b32 v[122:123], v132 offset0:176 offset1:176
    v_mfma_f32_16x16x32_bf16 v[96:99], v[56:59], v[24:27], v[96:99]
    s_waitcnt lgkmcnt(11)
    v_pk_fma_f32 v[68:69], v[100:101], v[108:109], v[68:69]
    v_pk_fma_f32 v[70:71], v[102:103], v[108:109], v[70:71]
    v_pk_fma_f32 v[84:85], v[104:105], v[108:109], v[84:85]
    v_pk_fma_f32 v[86:87], v[106:107], v[108:109], v[86:87]
    s_waitcnt lgkmcnt(10)
    v_pk_fma_f32 v[72:73], v[100:101], v[110:111], v[72:73]
    v_pk_fma_f32 v[74:75], v[102:103], v[110:111], v[74:75]
    v_pk_fma_f32 v[88:89], v[104:105], v[110:111], v[88:89]
    v_pk_fma_f32 v[90:91], v[106:107], v[110:111], v[90:91]
    s_waitcnt lgkmcnt(9)
    v_pk_fma_f32 v[76:77], v[100:101], v[112:113], v[76:77]
    v_pk_fma_f32 v[78:79], v[102:103], v[112:113], v[78:79]
    v_pk_fma_f32 v[92:93], v[104:105], v[112:113], v[92:93]
    v_pk_fma_f32 v[94:95], v[106:107], v[112:113], v[94:95]
    s_waitcnt lgkmcnt(8)
    v_pk_fma_f32 v[80:81], v[100:101], v[114:115], v[80:81]
    v_pk_fma_f32 v[82:83], v[102:103], v[114:115], v[82:83]
    v_pk_fma_f32 v[96:97], v[104:105], v[114:115], v[96:97]
    v_pk_fma_f32 v[98:99], v[106:107], v[114:115], v[98:99]
    s_waitcnt lgkmcnt(7)
    v_pk_mul_f32 v[12:13], v[68:69], v[124:125]
    v_pk_mul_f32 v[14:15], v[70:71], v[124:125]
    v_pk_mul_f32 v[16:17], v[84:85], v[124:125]
    v_pk_mul_f32 v[18:19], v[86:87], v[124:125]
    s_waitcnt lgkmcnt(6)
    v_pk_mul_f32 v[20:21], v[72:73], v[126:127]
    v_pk_mul_f32 v[22:23], v[74:75], v[126:127]
    v_pk_mul_f32 v[24:25], v[88:89], v[126:127]
    v_pk_mul_f32 v[26:27], v[90:91], v[126:127]
    s_waitcnt lgkmcnt(5)
    v_pk_mul_f32 v[28:29], v[76:77], v[128:129]
    v_pk_mul_f32 v[30:31], v[78:79], v[128:129]
    v_pk_mul_f32 v[32:33], v[92:93], v[128:129]
    v_pk_mul_f32 v[34:35], v[94:95], v[128:129]
    s_waitcnt lgkmcnt(4)
    v_pk_mul_f32 v[36:37], v[80:81], v[130:131]
    v_pk_mul_f32 v[38:39], v[82:83], v[130:131]
    v_pk_mul_f32 v[40:41], v[96:97], v[130:131]
    v_pk_mul_f32 v[42:43], v[98:99], v[130:131]
    s_waitcnt lgkmcnt(3)
    v_pk_fma_f32 v[68:69], v[68:69], v[116:117], s[40:41]
    v_pk_fma_f32 v[70:71], v[70:71], v[116:117], s[40:41]
    v_pk_fma_f32 v[84:85], v[84:85], v[116:117], s[40:41]
    v_pk_fma_f32 v[86:87], v[86:87], v[116:117], s[40:41]
    s_waitcnt lgkmcnt(2)
    v_pk_fma_f32 v[72:73], v[72:73], v[118:119], s[40:41]
    v_pk_fma_f32 v[74:75], v[74:75], v[118:119], s[40:41]
    v_pk_fma_f32 v[88:89], v[88:89], v[118:119], s[40:41]
    v_pk_fma_f32 v[90:91], v[90:91], v[118:119], s[40:41]
    s_waitcnt lgkmcnt(1)
    v_pk_fma_f32 v[76:77], v[76:77], v[120:121], s[40:41]
    v_pk_fma_f32 v[78:79], v[78:79], v[120:121], s[40:41]
    v_pk_fma_f32 v[92:93], v[92:93], v[120:121], s[40:41]
    v_pk_fma_f32 v[94:95], v[94:95], v[120:121], s[40:41]
    s_waitcnt lgkmcnt(0)
    v_pk_fma_f32 v[80:81], v[80:81], v[122:123], s[40:41]
    v_pk_fma_f32 v[82:83], v[82:83], v[122:123], s[40:41]
    v_pk_fma_f32 v[96:97], v[96:97], v[122:123], s[40:41]
    v_pk_fma_f32 v[98:99], v[98:99], v[122:123], s[40:41]
    v_exp_f32 v12, v12 clamp
    v_exp_f32 v13, v13 clamp
    v_exp_f32 v14, v14 clamp
    v_exp_f32 v15, v15 clamp
    v_exp_f32 v16, v16 clamp
    v_exp_f32 v17, v17 clamp
    v_exp_f32 v18, v18 clamp
    v_exp_f32 v19, v19 clamp
    v_exp_f32 v20, v20 clamp
    v_exp_f32 v21, v21 clamp
    v_exp_f32 v22, v22 clamp
    v_exp_f32 v23, v23 clamp
    v_exp_f32 v24, v24 clamp
    v_exp_f32 v25, v25 clamp
    v_exp_f32 v26, v26 clamp
    v_exp_f32 v27, v27 clamp
    v_exp_f32 v28, v28 clamp
    v_exp_f32 v29, v29 clamp
    v_exp_f32 v30, v30 clamp
    v_exp_f32 v31, v31 clamp
    v_exp_f32 v32, v32 clamp
    v_exp_f32 v33, v33 clamp
    v_exp_f32 v34, v34 clamp
    v_exp_f32 v35, v35 clamp
    v_exp_f32 v36, v36 clamp
    v_exp_f32 v37, v37 clamp
    v_exp_f32 v38, v38 clamp
    v_exp_f32 v39, v39 clamp
    v_exp_f32 v40, v40 clamp
    v_exp_f32 v41, v41 clamp
    v_exp_f32 v42, v42 clamp
    v_exp_f32 v43, v43 clamp
    v_pk_add_f32 v[12:13], v[12:13], s[74:75]
    v_pk_add_f32 v[14:15], v[14:15], s[74:75]
    v_pk_add_f32 v[16:17], v[16:17], s[74:75]
    v_pk_add_f32 v[18:19], v[18:19], s[74:75]
    v_pk_add_f32 v[20:21], v[20:21], s[74:75]
    v_pk_add_f32 v[22:23], v[22:23], s[74:75]
    v_pk_add_f32 v[24:25], v[24:25], s[74:75]
    v_pk_add_f32 v[26:27], v[26:27], s[74:75]
    v_pk_add_f32 v[28:29], v[28:29], s[74:75]
    v_pk_add_f32 v[30:31], v[30:31], s[74:75]
    v_pk_add_f32 v[32:33], v[32:33], s[74:75]
    v_pk_add_f32 v[34:35], v[34:35], s[74:75]
    v_pk_add_f32 v[36:37], v[36:37], s[74:75]
    v_pk_add_f32 v[38:39], v[38:39], s[74:75]
    v_pk_add_f32 v[40:41], v[40:41], s[74:75]
    v_pk_add_f32 v[42:43], v[42:43], s[74:75]
    v_max_f32 v68, v68, v12
    v_max_f32 v69, v69, v13
    v_max_f32 v70, v70, v14
    v_max_f32 v71, v71, v15
    v_max_f32 v84, v84, v16
    v_max_f32 v85, v85, v17
    v_max_f32 v86, v86, v18
    v_max_f32 v87, v87, v19
    v_max_f32 v72, v72, v20
    v_max_f32 v73, v73, v21
    v_max_f32 v74, v74, v22
    v_max_f32 v75, v75, v23
    v_max_f32 v88, v88, v24
    v_max_f32 v89, v89, v25
    v_max_f32 v90, v90, v26
    v_max_f32 v91, v91, v27
    v_max_f32 v76, v76, v28
    v_max_f32 v77, v77, v29
    v_max_f32 v78, v78, v30
    v_max_f32 v79, v79, v31
    v_max_f32 v92, v92, v32
    v_max_f32 v93, v93, v33
    v_max_f32 v94, v94, v34
    v_max_f32 v95, v95, v35
    v_max_f32 v80, v80, v36
    v_max_f32 v81, v81, v37
    v_max_f32 v82, v82, v38
    v_max_f32 v83, v83, v39
    v_max_f32 v96, v96, v40
    v_max_f32 v97, v97, v41
    v_max_f32 v98, v98, v42
    v_max_f32 v99, v99, v43
    v_cvt_pk_bf16_f32 v44, v68, v69
    v_cvt_pk_bf16_f32 v45, v70, v71
    v_cvt_pk_bf16_f32 v46, v84, v85
    v_cvt_pk_bf16_f32 v47, v86, v87
    v_cvt_pk_bf16_f32 v48, v72, v73
    v_cvt_pk_bf16_f32 v49, v74, v75
    v_cvt_pk_bf16_f32 v50, v88, v89
    v_cvt_pk_bf16_f32 v51, v90, v91
    v_cvt_pk_bf16_f32 v52, v76, v77
    v_cvt_pk_bf16_f32 v53, v78, v79
    v_cvt_pk_bf16_f32 v54, v92, v93
    v_cvt_pk_bf16_f32 v55, v94, v95
    v_cvt_pk_bf16_f32 v56, v80, v81
    v_cvt_pk_bf16_f32 v57, v82, v83
    v_cvt_pk_bf16_f32 v58, v96, v97
    v_cvt_pk_bf16_f32 v59, v98, v99
    s_and_b32 s44, s46, 127
    s_lshl_b32 s44, s44, 2
    s_add_u32 s44, s44, 24832
    v_and_b32 v1, 15, v0
    v_lshl_add_u32 v63, v1, 2, s44

    v_lshrrev_b32 v2, 4, v0
    v_bfe_u32 v1, v0, 2, 2
    v_lshl_add_u32 v1, v2, 2, v1
    v_and_b32 v2, 7, v1
    s_lshl_b32 s44, s3, 1
    v_xor_b32 v2, s44, v2
    v_lshlrev_b32 v2, 5, v2
    v_lshl_add_u32 v2, v1, 8, v2
    v_and_b32 v1, 3, v0
    v_lshl_add_u32 v2, v1, 3, v2
    v_add_u32 v128, 65536, v2
    v_xor_b32 v129, 32, v128
    v_add_u32 v130, 122880, v2
    v_xor_b32 v131, 32, v130
    v_lshlrev_b32 v2, 2, v1
    v_add_u32 v2, 24640, v2
    s_lshl_b32 s44, s37, 10
    s_add_u32 s44, s44, 139264
    v_lshl_add_u32 v64, v0, 4, s44

    ds_read2_b32 v[4:5], v63 offset0:0 offset1:0
    ds_read2_b32 v[6:7], v63 offset0:16 offset1:16
    ds_read2_b32 v[8:9], v63 offset0:32 offset1:32
    ds_read2_b32 v[10:11], v63 offset0:48 offset1:48
    ds_read2_b32 v[12:13], v63 offset0:128 offset1:128
    ds_read2_b32 v[14:15], v63 offset0:144 offset1:144
    ds_read2_b32 v[16:17], v63 offset0:160 offset1:160
    ds_read2_b32 v[18:19], v63 offset0:176 offset1:176
    v_lshlrev_b32 v60, 4, v0
    v_and_b32 v61, 48, v0
    s_setprio 2
SP_1:
    s_load_dword s58, s[56:57], 0 glc
    s_waitcnt lgkmcnt(0)
    s_cmp_ge_u32 s58, 32
    s_cbranch_scc1 SD_2
    s_sleep 2
    s_branch SP_1
SD_2:
F_kp:
    buffer_load_dwordx4 v[36:39], v61, s[24:27], s83 offen offset:0 sc0 sc1
    buffer_load_dwordx4 v[40:43], v61, s[24:27], s83 offen offset:64 sc0 sc1
    buffer_load_dwordx4 v[20:23], v60, s[24:27], s82 offen offset:0 sc0 sc1
    buffer_load_dwordx4 v[24:27], v60, s[24:27], s82 offen offset:2048 sc0 sc1
    buffer_load_dwordx4 v[28:31], v60, s[24:27], s82 offen offset:1024 sc0 sc1
    buffer_load_dwordx4 v[32:35], v60, s[24:27], s82 offen offset:3072 sc0 sc1
    v_mov_b32 v62, 4
    s_mov_b64 exec, 1
    ds_write_b32 v3, v62 offset:0
    s_mov_b64 exec, -1
    s_waitcnt vmcnt(4)
    v_cvt_pk_bf16_f32 v124, v36, v37
    v_cvt_pk_bf16_f32 v125, v38, v39
    v_cvt_pk_bf16_f32 v126, v40, v41
    v_cvt_pk_bf16_f32 v127, v42, v43
    s_nop 1
    v_mfma_f32_16x16x32_bf16 v[76:79], v[124:127], v[44:47], 0
    v_mfma_f32_16x16x32_bf16 v[88:91], v[124:127], v[48:51], 0
    v_mfma_f32_16x16x32_bf16 v[100:103], v[124:127], v[52:55], 0
    v_mfma_f32_16x16x32_bf16 v[112:115], v[124:127], v[56:59], 0
    s_waitcnt vmcnt(2)
    v_cvt_pk_bf16_f32 v116, v20, v21
    v_cvt_pk_bf16_f32 v117, v22, v23
    v_cvt_pk_bf16_f32 v118, v24, v25
    v_cvt_pk_bf16_f32 v119, v26, v27
    s_nop 1
    v_mfma_f32_16x16x32_bf16 v[68:71], v[116:119], v[44:47], 0
    v_mfma_f32_16x16x32_bf16 v[80:83], v[116:119], v[48:51], 0
    v_mfma_f32_16x16x32_bf16 v[92:95], v[116:119], v[52:55], 0
    v_mfma_f32_16x16x32_bf16 v[104:107], v[116:119], v[56:59], 0
    v_add_f32 v76, s74, v76
    v_rcp_f32 v76, v76
    s_nop 0
    v_mov_b32 v77, v76
    v_add_f32 v88, s74, v88
    v_rcp_f32 v88, v88
    s_nop 0
    v_mov_b32 v89, v88
    v_add_f32 v100, s74, v100
    v_rcp_f32 v100, v100
    s_nop 0
    v_mov_b32 v101, v100
    v_add_f32 v112, s74, v112
    v_rcp_f32 v112, v112
    s_nop 0
    v_mov_b32_e64 v113, v112
    s_waitcnt vmcnt(0)
    v_cvt_pk_bf16_f32 v120, v28, v29
    v_cvt_pk_bf16_f32 v121, v30, v31
    v_cvt_pk_bf16_f32 v122, v32, v33
    v_cvt_pk_bf16_f32 v123, v34, v35
    s_nop 1
    v_mfma_f32_16x16x32_bf16 v[72:75], v[120:123], v[44:47], 0
    v_mfma_f32_16x16x32_bf16 v[84:87], v[120:123], v[48:51], 0
    v_mfma_f32_16x16x32_bf16 v[96:99], v[120:123], v[52:55], 0
    v_mfma_f32_16x16x32_bf16 v[108:111], v[120:123], v[56:59], 0
    s_add_u32 s80, s79, 0
    v_pk_mul_f32 v[68:69], v[68:69], v[76:77]
    v_pk_mul_f32 v[70:71], v[70:71], v[76:77]
    s_nop 1
    v_pk_mul_f32 v[72:73], v[72:73], v[76:77]
    v_pk_mul_f32 v[74:75], v[74:75], v[76:77]
    v_cvt_pk_bf16_f32 v28, v68, v69
    v_cvt_pk_bf16_f32 v29, v70, v71
    v_cvt_pk_bf16_f32 v30, v72, v73
    v_cvt_pk_bf16_f32 v31, v74, v75
    buffer_store_dwordx4 v[28:31], v60, s[16:19], s80 offen sc0 sc1
    s_add_u32 s80, s79, 32768
    v_pk_mul_f32 v[80:81], v[80:81], v[88:89]
    v_pk_mul_f32 v[82:83], v[82:83], v[88:89]
    v_pk_mul_f32 v[84:85], v[84:85], v[88:89]
    v_pk_mul_f32 v[86:87], v[86:87], v[88:89]
    v_cvt_pk_bf16_f32 v32, v80, v81
    v_cvt_pk_bf16_f32 v33, v82, v83
    v_cvt_pk_bf16_f32 v34, v84, v85
    v_cvt_pk_bf16_f32 v35, v86, v87
    buffer_store_dwordx4 v[32:35], v60, s[16:19], s80 offen sc0 sc1
    s_add_u32 s80, s79, 65536
    v_pk_mul_f32 v[92:93], v[92:93], v[100:101]
    v_pk_mul_f32 v[94:95], v[94:95], v[100:101]
    v_pk_mul_f32 v[96:97], v[96:97], v[100:101]
    v_pk_mul_f32 v[98:99], v[98:99], v[100:101]
    v_cvt_pk_bf16_f32 v36, v92, v93
    v_cvt_pk_bf16_f32 v37, v94, v95
    v_cvt_pk_bf16_f32 v38, v96, v97
    v_cvt_pk_bf16_f32 v39, v98, v99
    buffer_store_dwordx4 v[36:39], v60, s[16:19], s80 offen sc0 sc1
    s_add_u32 s80, s79, 98304
    v_pk_mul_f32 v[104:105], v[104:105], v[112:113]
    v_pk_mul_f32 v[106:107], v[106:107], v[112:113]
    v_pk_mul_f32 v[108:109], v[108:109], v[112:113]
    v_pk_mul_f32 v[110:111], v[110:111], v[112:113]
    v_cvt_pk_bf16_f32 v40, v104, v105
    v_cvt_pk_bf16_f32 v41, v106, v107
    v_cvt_pk_bf16_f32 v42, v108, v109
    v_cvt_pk_bf16_f32 v43, v110, v111
    buffer_store_dwordx4 v[40:43], v60, s[16:19], s80 offen sc0 sc1
    ds_read2_b32 v[66:67], v2 offset0:0 offset1:8
    v_lshlrev_b32 v132, 16, v148
    v_and_b32 v133, 0xffff0000, v148
    v_lshlrev_b32 v134, 16, v149
    v_and_b32 v135, 0xffff0000, v149
    v_lshlrev_b32 v136, 16, v150
    v_and_b32 v137, 0xffff0000, v150
    v_lshlrev_b32 v138, 16, v151
    v_and_b32 v139, 0xffff0000, v151
    v_pk_add_f32 v[76:77], v[132:133], v[4:5]
    v_pk_add_f32 v[78:79], v[134:135], v[4:5]
    v_pk_add_f32 v[80:81], v[136:137], v[4:5]
    v_pk_add_f32 v[82:83], v[138:139], v[4:5]
    v_cvt_pk_bf16_f32 v72, v76, v77
    v_cvt_pk_bf16_f32 v73, v78, v79
    v_cvt_pk_bf16_f32 v74, v80, v81
    v_cvt_pk_bf16_f32 v75, v82, v83
    v_lshlrev_b32 v76, 16, v72
    v_and_b32 v77, 0xffff0000, v72
    v_lshlrev_b32 v78, 16, v73
    v_and_b32 v79, 0xffff0000, v73
    v_lshlrev_b32 v80, 16, v74
    v_and_b32 v81, 0xffff0000, v74
    v_lshlrev_b32 v82, 16, v75
    v_and_b32 v83, 0xffff0000, v75
    v_pk_mul_f32 v[76:77], v[76:77], v[12:13]
    v_pk_mul_f32 v[78:79], v[78:79], v[12:13]
    v_pk_mul_f32 v[80:81], v[80:81], v[12:13]
    v_pk_mul_f32 v[82:83], v[82:83], v[12:13]
    v_cvt_pk_bf16_f32 v72, v76, v77
    v_cvt_pk_bf16_f32 v73, v78, v79
    v_cvt_pk_bf16_f32 v74, v80, v81
    v_cvt_pk_bf16_f32 v75, v82, v83
    v_lshlrev_b32 v76, 16, v72
    v_and_b32 v77, 0xffff0000, v72
    v_lshlrev_b32 v78, 16, v73
    v_and_b32 v79, 0xffff0000, v73
    v_lshlrev_b32 v80, 16, v74
    v_and_b32 v81, 0xffff0000, v74
    v_lshlrev_b32 v82, 16, v75
    v_and_b32 v83, 0xffff0000, v75
    v_pk_add_f32 v[132:133], v[132:133], v[76:77]
    v_pk_add_f32 v[134:135], v[134:135], v[78:79]
    v_pk_add_f32 v[136:137], v[136:137], v[80:81]
    v_pk_add_f32 v[138:139], v[138:139], v[82:83]
    v_mov_b32 v62, 5
    s_and_b32 s44, s28, 1
    s_cmp_lg_u32 s44, s36
    s_waitcnt lgkmcnt(0)
    v_cmp_gt_u32 s[70:71], 2, v67
    s_cbranch_scc1 F_oa1
    v_cmp_gt_u32 vcc, 3, v66
    s_cbranch_vccz F_oa0

    ds_read_b32 v66, v2
FW_3:
    s_waitcnt lgkmcnt(0)
    v_cmp_gt_u32 vcc, 3, v66
    s_cbranch_vccz FO_4
    s_sleep 1
    ds_read_b32 v66, v2
    s_branch FW_3
FO_4:
F_oa0:
    ds_write_b128 v64, v[28:31] offset:0
    ds_write_b128 v64, v[32:35] offset:2048
    ds_write_b128 v64, v[36:39] offset:4096
    ds_write_b128 v64, v[40:43] offset:6144
F_oa1:
    s_cmp_lg_u64 s[70:71], 0
    s_cbranch_scc1 F_bp0
    ds_read_b64_tr_b16 v[40:41], v130 offset:24576
    ds_read_b64_tr_b16 v[42:43], v130 offset:28672
    ds_read_b64_tr_b16 v[44:45], v131 offset:24576
    ds_read_b64_tr_b16 v[46:47], v131 offset:28672
    ds_read_b64_tr_b16 v[64:65], v130 offset:32768
    ds_read_b64_tr_b16 v[66:67], v130 offset:36864
    ds_read_b64_tr_b16 v[68:69], v131 offset:32768
    ds_read_b64_tr_b16 v[70:71], v131 offset:36864
    ds_read_b64_tr_b16 v[88:89], v128 offset:0
    ds_read_b64_tr_b16 v[90:91], v128 offset:4096
    ds_read_b64_tr_b16 v[92:93], v129 offset:0
    s_waitcnt lgkmcnt(8)
    s_nop 0
    ds_read_b64_tr_b16 v[94:95], v129 offset:4096
    ds_read_b64_tr_b16 v[112:113], v128 offset:8192
    ds_read_b64_tr_b16 v[114:115], v128 offset:12288
    ds_read_b64_tr_b16 v[116:117], v129 offset:8192
    ds_read_b64_tr_b16 v[118:119], v129 offset:12288
F_bp0:
    s_waitcnt lgkmcnt(4)
    s_waitcnt vmcnt(0)
    s_atomic_add s76, s[68:69], 0
    s_atomic_add s76, s[68:69], 128
    s_atomic_add s76, s[68:69], 256
    s_atomic_add s76, s[68:69], 384
    s_mov_b64 exec, 1
    ds_write_b32 v3, v62
    s_mov_b64 exec, -1
    s_setprio 0
    v_lshlrev_b32 v140, 16, v152
    v_and_b32 v141, 0xffff0000, v152
    v_lshlrev_b32 v142, 16, v153
    v_and_b32 v143, 0xffff0000, v153
    v_lshlrev_b32 v144, 16, v154
    v_and_b32 v145, 0xffff0000, v154
    v_lshlrev_b32_e64 v146, 16, v155
    v_and_b32 v147, 0xffff0000, v155
    v_pk_add_f32 v[76:77], v[140:141], v[6:7]
    v_pk_add_f32 v[78:79], v[142:143], v[6:7]
    v_pk_add_f32 v[80:81], v[144:145], v[6:7]
    v_pk_add_f32 v[82:83], v[146:147], v[6:7]
    v_cvt_pk_bf16_f32 v72, v76, v77
    v_cvt_pk_bf16_f32 v73, v78, v79
    v_cvt_pk_bf16_f32 v74, v80, v81
    v_cvt_pk_bf16_f32 v75, v82, v83
    v_lshlrev_b32 v76, 16, v72
    v_and_b32 v77, 0xffff0000, v72
    v_lshlrev_b32 v78, 16, v73
    v_and_b32 v79, 0xffff0000, v73
    v_lshlrev_b32 v80, 16, v74
    v_and_b32 v81, 0xffff0000, v74
    v_lshlrev_b32 v82, 16, v75
    v_and_b32 v83, 0xffff0000, v75
    v_pk_mul_f32 v[76:77], v[76:77], v[14:15]
    v_pk_mul_f32 v[78:79], v[78:79], v[14:15]
    v_pk_mul_f32 v[80:81], v[80:81], v[14:15]
    v_pk_mul_f32 v[82:83], v[82:83], v[14:15]
    v_cvt_pk_bf16_f32 v72, v76, v77
    v_cvt_pk_bf16_f32 v73, v78, v79
    v_cvt_pk_bf16_f32 v74, v80, v81
    v_cvt_pk_bf16_f32 v75, v82, v83
    v_lshlrev_b32 v76, 16, v72
    v_and_b32 v77, 0xffff0000, v72
    v_lshlrev_b32 v78, 16, v73
    v_and_b32 v79, 0xffff0000, v73
    v_lshlrev_b32 v80, 16, v74
    v_and_b32 v81, 0xffff0000, v74
    v_lshlrev_b32 v82, 16, v75
    v_and_b32 v83, 0xffff0000, v75
    v_pk_add_f32 v[140:141], v[140:141], v[76:77]
    v_pk_add_f32 v[142:143], v[142:143], v[78:79]
    v_pk_add_f32 v[144:145], v[144:145], v[80:81]
    v_pk_add_f32 v[146:147], v[146:147], v[82:83]
    v_lshlrev_b32 v148, 16, v156
    v_and_b32 v149, 0xffff0000, v156
    v_lshlrev_b32 v150, 16, v157
    v_and_b32 v151, 0xffff0000, v157
    v_lshlrev_b32 v152, 16, v158
    v_and_b32 v153, 0xffff0000, v158
    v_lshlrev_b32 v154, 16, v159
    v_and_b32 v155, 0xffff0000, v159
    v_pk_add_f32 v[76:77], v[148:149], v[8:9]
    v_pk_add_f32 v[78:79], v[150:151], v[8:9]
    v_pk_add_f32 v[80:81], v[152:153], v[8:9]
    v_pk_add_f32 v[82:83], v[154:155], v[8:9]
    v_cvt_pk_bf16_f32 v72, v76, v77
    v_cvt_pk_bf16_f32 v73, v78, v79
    v_cvt_pk_bf16_f32 v74, v80, v81
    v_cvt_pk_bf16_f32 v75, v82, v83
    v_lshlrev_b32 v76, 16, v72
    v_and_b32 v77, 0xffff0000, v72
    v_lshlrev_b32 v78, 16, v73
    v_and_b32 v79, 0xffff0000, v73
    v_lshlrev_b32 v80, 16, v74
    v_and_b32 v81, 0xffff0000, v74
    v_lshlrev_b32 v82, 16, v75
    v_and_b32 v83, 0xffff0000, v75
    v_pk_mul_f32 v[76:77], v[76:77], v[16:17]
    v_pk_mul_f32 v[78:79], v[78:79], v[16:17]
    v_pk_mul_f32 v[80:81], v[80:81], v[16:17]
    v_pk_mul_f32 v[82:83], v[82:83], v[16:17]
    v_cvt_pk_bf16_f32 v72, v76, v77
    v_cvt_pk_bf16_f32 v73, v78, v79
    v_cvt_pk_bf16_f32 v74, v80, v81
    v_cvt_pk_bf16_f32 v75, v82, v83
    v_lshlrev_b32 v76, 16, v72
    v_and_b32 v77, 0xffff0000, v72
    v_lshlrev_b32 v78, 16, v73
    v_and_b32 v79, 0xffff0000, v73
    v_lshlrev_b32 v80, 16, v74
    v_and_b32 v81, 0xffff0000, v74
    v_lshlrev_b32 v82, 16, v75
    v_and_b32 v83, 0xffff0000, v75
    v_pk_add_f32 v[148:149], v[148:149], v[76:77]
    v_pk_add_f32 v[150:151], v[150:151], v[78:79]
    v_pk_add_f32 v[152:153], v[152:153], v[80:81]
    v_pk_add_f32 v[154:155], v[154:155], v[82:83]
    v_lshlrev_b32 v156, 16, v160
    v_and_b32 v157, 0xffff0000, v160
    v_lshlrev_b32 v158, 16, v161
    v_and_b32 v159, 0xffff0000, v161
    v_lshlrev_b32 v160, 16, v162
    v_and_b32 v161, 0xffff0000, v162
    v_lshlrev_b32 v162, 16, v163
    v_and_b32 v163, 0xffff0000, v163
    v_pk_add_f32 v[76:77], v[156:157], v[10:11]
    v_pk_add_f32 v[78:79], v[158:159], v[10:11]
    v_pk_add_f32 v[80:81], v[160:161], v[10:11]
    v_pk_add_f32 v[82:83], v[162:163], v[10:11]
    v_cvt_pk_bf16_f32 v72, v76, v77
    v_cvt_pk_bf16_f32 v73, v78, v79
    v_cvt_pk_bf16_f32 v74, v80, v81
    v_cvt_pk_bf16_f32 v75, v82, v83
    v_lshlrev_b32 v76, 16, v72
    v_and_b32 v77, 0xffff0000, v72
    v_lshlrev_b32 v78, 16, v73
    v_and_b32 v79, 0xffff0000, v73
    v_lshlrev_b32 v80, 16, v74
    v_and_b32 v81, 0xffff0000, v74
    v_lshlrev_b32 v82, 16, v75
    v_and_b32 v83, 0xffff0000, v75
    v_pk_mul_f32 v[76:77], v[76:77], v[18:19]
    v_pk_mul_f32 v[78:79], v[78:79], v[18:19]
    v_pk_mul_f32 v[80:81], v[80:81], v[18:19]
    v_pk_mul_f32 v[82:83], v[82:83], v[18:19]
    v_cvt_pk_bf16_f32 v72, v76, v77
    v_cvt_pk_bf16_f32 v73, v78, v79
    v_cvt_pk_bf16_f32 v74, v80, v81
    v_cvt_pk_bf16_f32 v75, v82, v83
    v_lshlrev_b32 v76, 16, v72
    v_and_b32 v77, 0xffff0000, v72
    v_lshlrev_b32 v78, 16, v73
    v_and_b32 v79, 0xffff0000, v73
    v_lshlrev_b32 v80, 16, v74
    v_and_b32 v81, 0xffff0000, v74
    v_lshlrev_b32 v82, 16, v75
    v_and_b32 v83, 0xffff0000, v75
    v_pk_add_f32 v[156:157], v[156:157], v[76:77]
    v_pk_add_f32 v[158:159], v[158:159], v[78:79]
    v_pk_add_f32 v[160:161], v[160:161], v[80:81]
    v_pk_add_f32 v[162:163], v[162:163], v[82:83]
    v_lshlrev_b32 v4, 4, v0
    v_add_u32 v5, 98304, v4
    v_add_u32 v4, 16384, v4
    v_subrev_u32 v8, 65536, v128
    v_subrev_u32 v9, 65536, v129
    v_and_b32 v1, 15, v0
    s_lshl_b32 s44, s3, 6
    s_add_u32 s44, s44, 0
    v_lshrrev_b32 v18, 4, v0
    v_lshl_add_u32 v18, v18, 3, s44
    v_mul_u32_u24 v19, 272, v1
    v_add_u32 v18, v18, v19
    v_add_u32 v19, 4352, v18
    v_add_u32 v20, 8704, v18
    v_add_u32 v21, 13056, v18

    s_setprio 2
    s_cmp_eq_u64 s[70:71], 0
    s_cbranch_scc1 F_bp1
    v_add_u32 v60, 32, v2
    ds_read_b32 v61, v60
FW_5:
    s_waitcnt lgkmcnt(0)
    v_cmp_gt_u32_e64 vcc, 2, v61
    s_cbranch_vccz FO_6
    s_sleep 1
    ds_read_b32 v61, v60
    s_branch FW_5
FO_6:
    ds_read_b64_tr_b16 v[40:41], v130 offset:24576
    ds_read_b64_tr_b16 v[42:43], v130 offset:28672
    ds_read_b64_tr_b16 v[44:45], v131 offset:24576
    ds_read_b64_tr_b16 v[46:47], v131 offset:28672
    ds_read_b64_tr_b16 v[64:65], v130 offset:32768
    ds_read_b64_tr_b16 v[66:67], v130 offset:36864
    ds_read_b64_tr_b16 v[68:69], v131 offset:32768
    ds_read_b64_tr_b16 v[70:71], v131 offset:36864
    ds_read_b64_tr_b16 v[88:89], v128 offset:0
    ds_read_b64_tr_b16 v[90:91], v128 offset:4096
    ds_read_b64_tr_b16 v[92:93], v129 offset:0
W_3:
    s_cbranch_execz R_3
    s_nop 0
    ds_read_b64_tr_b16 v[94:95], v129 offset:4096
    ds_read_b64_tr_b16 v[112:113], v128 offset:8192
    ds_read_b64_tr_b16 v[114:115], v128 offset:12288
    ds_read_b64_tr_b16 v[116:117], v129 offset:8192
    s_waitcnt lgkmcnt(8)
    ds_read_b64_tr_b16 v[118:119], v129 offset:12288
F_bp1:
    ds_read_b32 v22, v2
FW_7:
    s_waitcnt lgkmcnt(0)
    v_cmp_gt_u32 vcc, 5, v22
    s_cbranch_vccz FO_8
    s_sleep 1
    ds_read_b32 v22, v2
    s_branch FW_7
FO_8:
    ds_read_b128 v[24:27], v5 offset:40960
    ds_read_b128 v[48:51], v5 offset:41984
    ds_read_b128 v[28:31], v5 offset:43008
    ds_read_b128 v[52:55], v5 offset:44032
    ds_read_b128 v[32:35], v5 offset:45056
    ds_read_b128 v[56:59], v5 offset:46080
    ds_read_b128 v[36:39], v5 offset:47104
    ds_read_b128 v[60:63], v5 offset:48128
    v_mov_b32_e64 v22, 7
    s_mov_b64 exec, 1
    ds_write_b32 v3, v22 offset:0
    s_mov_b64 exec, -1
    s_waitcnt lgkmcnt(8)
    v_mfma_f32_16x16x32_bf16 v[132:135], v[40:43], v[24:27], v[132:135]
    s_waitcnt lgkmcnt(7)
    v_mfma_f32_16x16x32_bf16 v[132:135], v[64:67], v[48:51], v[132:135]
    v_mfma_f32_16x16x32_bf16 v[136:139], v[44:47], v[24:27], v[136:139]
    v_mfma_f32_16x16x32_bf16 v[136:139], v[68:71], v[48:51], v[136:139]
    s_waitcnt lgkmcnt(6)
    v_mfma_f32_16x16x32_bf16 v[140:143], v[40:43], v[28:31], v[140:143]
    s_waitcnt lgkmcnt(5)
    v_mfma_f32_16x16x32_bf16 v[140:143], v[64:67], v[52:55], v[140:143]
    v_mfma_f32_16x16x32_bf16 v[144:147], v[44:47], v[28:31], v[144:147]
    v_mfma_f32_16x16x32_bf16 v[144:147], v[68:71], v[52:55], v[144:147]
    s_waitcnt lgkmcnt(4)
    v_mfma_f32_16x16x32_bf16 v[148:151], v[40:43], v[32:35], v[148:151]
    s_waitcnt lgkmcnt(3)
    v_mfma_f32_16x16x32_bf16 v[148:151], v[64:67], v[56:59], v[148:151]
    v_mfma_f32_16x16x32_bf16 v[152:155], v[44:47], v[32:35], v[152:155]
    v_mfma_f32_16x16x32_bf16 v[152:155], v[68:71], v[56:59], v[152:155]
    s_waitcnt lgkmcnt(2)
    v_mfma_f32_16x16x32_bf16 v[156:159], v[40:43], v[36:39], v[156:159]
    s_waitcnt lgkmcnt(1)
    v_mfma_f32_16x16x32_bf16 v[156:159], v[64:67], v[60:63], v[156:159]
    v_mfma_f32_16x16x32_bf16 v[160:163], v[44:47], v[36:39], v[160:163]
    v_mfma_f32_16x16x32_bf16 v[160:163], v[68:71], v[60:63], v[160:163]
    ds_read_b64_tr_b16 v[40:41], v8 offset:0
    ds_read_b64_tr_b16 v[42:43], v8 offset:4096
    ds_read_b64_tr_b16 v[44:45], v9 offset:0
    ds_read_b64_tr_b16 v[46:47], v9 offset:4096
    ds_read_b64_tr_b16 v[64:65], v8 offset:8192
    ds_read_b64_tr_b16 v[66:67], v8 offset:12288
    ds_read_b64_tr_b16 v[68:69], v9 offset:8192
    ds_read_b64_tr_b16 v[70:71], v9 offset:12288
    s_waitcnt lgkmcnt(0)
    s_barrier
    ds_read_b128 v[72:75], v4 offset:0
    ds_read_b128 v[96:99], v4 offset:1024
    ds_read_b128 v[76:79], v4 offset:2048
    ds_read_b128 v[100:103], v4 offset:3072
    ds_read_b128 v[80:83], v4 offset:4096
    ds_read_b128 v[104:107], v4 offset:5120
    ds_read_b128 v[84:87], v4 offset:6144
    ds_read_b128 v[108:111], v4 offset:7168
    s_waitcnt lgkmcnt(7)
    v_mfma_f32_16x16x32_bf16 v[132:135], v[88:91], v[72:75], v[132:135]
    s_waitcnt lgkmcnt(6)
    v_mfma_f32_16x16x32_bf16 v[132:135], v[112:115], v[96:99], v[132:135]
    v_mfma_f32_16x16x32_bf16 v[136:139], v[92:95], v[72:75], v[136:139]
    v_mfma_f32_16x16x32_bf16 v[136:139], v[116:119], v[96:99], v[136:139]
    s_waitcnt lgkmcnt(5)
    v_mfma_f32_16x16x32_bf16 v[140:143], v[88:91], v[76:79], v[140:143]
    s_waitcnt lgkmcnt(4)
    v_mfma_f32_16x16x32_bf16 v[140:143], v[112:115], v[100:103], v[140:143]
    s_waitcnt lgkmcnt(0)
    s_barrier
    ds_read_b128 v[24:27], v5 offset:0
    ds_read_b128 v[48:51], v5 offset:1024
    v_mfma_f32_16x16x32_bf16 v[144:147], v[92:95], v[76:79], v[144:147]
    ds_read_b128 v[28:31], v5 offset:2048
    ds_read_b128 v[52:55], v5 offset:3072
    v_mfma_f32_16x16x32_bf16 v[144:147], v[116:119], v[100:103], v[144:147]
    ds_read_b128 v[32:35], v5 offset:4096
    ds_read_b128 v[56:59], v5 offset:5120
    v_mfma_f32_16x16x32_bf16 v[148:151], v[88:91], v[80:83], v[148:151]
    ds_read_b128 v[36:39], v5 offset:6144
    ds_read_b128 v[60:63], v5 offset:7168
    v_mfma_f32_16x16x32_bf16 v[148:151], v[112:115], v[104:107], v[148:151]
    v_mfma_f32_16x16x32_bf16 v[152:155], v[92:95], v[80:83], v[152:155]
    v_mfma_f32_16x16x32_bf16 v[152:155], v[116:119], v[104:107], v[152:155]
    v_mfma_f32_16x16x32_bf16 v[156:159], v[88:91], v[84:87], v[156:159]
    v_mfma_f32_16x16x32_bf16 v[156:159], v[112:115], v[108:111], v[156:159]
    v_mfma_f32_16x16x32_bf16 v[160:163], v[92:95], v[84:87], v[160:163]
    v_mfma_f32_16x16x32_bf16 v[160:163], v[116:119], v[108:111], v[160:163]
    s_waitcnt lgkmcnt(4)
    v_mfma_f32_16x16x32_bf16 v[132:135], v[40:43], v[24:27], v[132:135]
    v_mfma_f32_16x16x32_bf16 v[132:135], v[64:67], v[48:51], v[132:135]
    s_waitcnt lgkmcnt(0)
    s_barrier
    ds_read_b64_tr_b16 v[88:89], v8 offset:40960
    ds_read_b64_tr_b16 v[90:91], v8 offset:45056
    v_mfma_f32_16x16x32_bf16 v[136:139], v[44:47], v[24:27], v[136:139]
    ds_read_b128 v[72:75], v5 offset:40960
    ds_read_b64_tr_b16 v[112:113], v8 offset:49152
    v_mfma_f32_16x16x32_bf16 v[136:139], v[68:71], v[48:51], v[136:139]
    ds_read_b64_tr_b16 v[114:115], v8 offset:53248
    v_mfma_f32_16x16x32_bf16 v[140:143], v[40:43], v[28:31], v[140:143]
    ds_read_b128 v[96:99], v5 offset:41984
    v_mfma_f32_16x16x32_bf16 v[140:143], v[64:67], v[52:55], v[140:143]
    ds_read_b64_tr_b16 v[92:93], v9 offset:40960
    v_mfma_f32_16x16x32_bf16 v[144:147], v[44:47], v[28:31], v[144:147]
    ds_read_b64_tr_b16 v[94:95], v9 offset:45056
    v_mfma_f32_16x16x32_bf16 v[144:147], v[68:71], v[52:55], v[144:147]
    ds_read_b64_tr_b16 v[116:117], v9 offset:49152
    v_mfma_f32_16x16x32_bf16 v[148:151], v[40:43], v[32:35], v[148:151]
    ds_read_b64_tr_b16 v[118:119], v9 offset:53248
    v_mfma_f32_16x16x32_bf16 v[148:151], v[64:67], v[56:59], v[148:151]
    ds_read_b128 v[76:79], v5 offset:43008
    v_mfma_f32_16x16x32_bf16 v[152:155], v[44:47], v[32:35], v[152:155]
    ds_read_b128 v[100:103], v5 offset:44032
    v_mfma_f32_16x16x32_bf16 v[152:155], v[68:71], v[56:59], v[152:155]
    ds_read_b128 v[80:83], v5 offset:45056
    v_mfma_f32_16x16x32_bf16 v[156:159], v[40:43], v[36:39], v[156:159]
    ds_read_b128 v[104:107], v5 offset:46080
    v_mfma_f32_16x16x32_bf16 v[156:159], v[64:67], v[60:63], v[156:159]
    s_waitcnt lgkmcnt(8)
    ds_read_b128 v[84:87], v5 offset:47104
    v_mfma_f32_16x16x32_bf16 v[160:163], v[44:47], v[36:39], v[160:163]
    ds_read_b128 v[108:111], v5 offset:48128
    v_mfma_f32_16x16x32_bf16 v[160:163], v[68:71], v[60:63], v[160:163]
    s_waitcnt lgkmcnt(4)
    v_mfma_f32_16x16x32_bf16 v[132:135], v[88:91], v[72:75], v[132:135]
    v_mfma_f32_16x16x32_bf16 v[132:135], v[112:115], v[96:99], v[132:135]
    s_waitcnt lgkmcnt(0)
    s_barrier
    ds_read_b64_tr_b16 v[40:41], v128 offset:16384
    ds_read_b64_tr_b16 v[42:43], v128 offset:20480
    v_mfma_f32_16x16x32_bf16 v[136:139], v[92:95], v[72:75], v[136:139]
    ds_read_b128 v[24:27], v4 offset:40960
    ds_read_b64_tr_b16 v[64:65], v128 offset:24576
    v_mfma_f32_16x16x32_bf16 v[136:139], v[116:119], v[96:99], v[136:139]
    ds_read_b64_tr_b16 v[66:67], v128 offset:28672
    v_mfma_f32_16x16x32_bf16 v[140:143], v[88:91], v[76:79], v[140:143]
    ds_read_b128 v[48:51], v4 offset:41984
    v_mfma_f32_16x16x32_bf16 v[140:143], v[112:115], v[100:103], v[140:143]
    ds_read_b64_tr_b16 v[44:45], v129 offset:16384
    v_mfma_f32_16x16x32_bf16 v[144:147], v[92:95], v[76:79], v[144:147]
    ds_read_b64_tr_b16 v[46:47], v129 offset:20480
    v_mfma_f32_16x16x32_bf16 v[144:147], v[116:119], v[100:103], v[144:147]
    ds_read_b64_tr_b16 v[68:69], v129 offset:24576
    v_mfma_f32_16x16x32_bf16 v[148:151], v[88:91], v[80:83], v[148:151]
    ds_read_b64_tr_b16 v[70:71], v129 offset:28672
    v_mfma_f32_16x16x32_bf16 v[148:151], v[112:115], v[104:107], v[148:151]
    ds_read_b128 v[28:31], v4 offset:43008
    v_mfma_f32_16x16x32_bf16 v[152:155], v[92:95], v[80:83], v[152:155]
    ds_read_b128 v[52:55], v4 offset:44032
    v_mfma_f32_16x16x32_bf16 v[152:155], v[116:119], v[104:107], v[152:155]
    ds_read_b128 v[32:35], v4 offset:45056
    v_mfma_f32_16x16x32_bf16 v[156:159], v[88:91], v[84:87], v[156:159]
    ds_read_b128 v[56:59], v4 offset:46080
    v_mfma_f32_16x16x32_bf16 v[156:159], v[112:115], v[108:111], v[156:159]
    s_waitcnt lgkmcnt(8)
    ds_read_b128 v[36:39], v4 offset:47104
    v_mfma_f32_16x16x32_bf16 v[160:163], v[92:95], v[84:87], v[160:163]
    ds_read_b128 v[60:63], v4 offset:48128
    v_mfma_f32_16x16x32_bf16 v[160:163], v[116:119], v[108:111], v[160:163]
    s_waitcnt lgkmcnt(4)
    v_mfma_f32_16x16x32_bf16 v[132:135], v[40:43], v[24:27], v[132:135]
    v_mfma_f32_16x16x32_bf16 v[132:135], v[64:67], v[48:51], v[132:135]
    s_waitcnt lgkmcnt(0)
    s_barrier
    ds_read_b64_tr_b16 v[88:89], v130 offset:0
    ds_read_b64_tr_b16 v[90:91], v130 offset:4096
    v_mfma_f32_16x16x32_bf16 v[136:139], v[44:47], v[24:27], v[136:139]
    ds_read_b128 v[72:75], v4 offset:0
    ds_read_b64_tr_b16 v[112:113], v130 offset:8192
    v_mfma_f32_16x16x32_bf16 v[136:139], v[68:71], v[48:51], v[136:139]
    ds_read_b64_tr_b16 v[114:115], v130 offset:12288
    v_mfma_f32_16x16x32_bf16 v[140:143], v[40:43], v[28:31], v[140:143]
    ds_read_b128 v[96:99], v4 offset:1024
    v_mfma_f32_16x16x32_bf16 v[140:143], v[64:67], v[52:55], v[140:143]
    ds_read_b64_tr_b16 v[92:93], v131 offset:0
    v_mfma_f32_16x16x32_bf16 v[144:147], v[44:47], v[28:31], v[144:147]
    ds_read_b64_tr_b16 v[94:95], v131 offset:4096
    v_mfma_f32_16x16x32_bf16 v[144:147], v[68:71], v[52:55], v[144:147]
    ds_read_b64_tr_b16 v[116:117], v131 offset:8192
    v_mfma_f32_16x16x32_bf16 v[148:151], v[40:43], v[32:35], v[148:151]
    ds_read_b64_tr_b16 v[118:119], v131 offset:12288
    v_mfma_f32_16x16x32_bf16 v[148:151], v[64:67], v[56:59], v[148:151]
    ds_read_b128 v[76:79], v4 offset:2048
    v_mfma_f32_16x16x32_bf16 v[152:155], v[44:47], v[32:35], v[152:155]
    ds_read_b128 v[100:103], v4 offset:3072
    v_mfma_f32_16x16x32_bf16 v[152:155], v[68:71], v[56:59], v[152:155]
    ds_read_b128 v[80:83], v4 offset:4096
    v_mfma_f32_16x16x32_bf16 v[156:159], v[40:43], v[36:39], v[156:159]
    ds_read_b128 v[104:107], v4 offset:5120
    v_mfma_f32_16x16x32_bf16 v[156:159], v[64:67], v[60:63], v[156:159]
    s_waitcnt lgkmcnt(8)
    ds_read_b128 v[84:87], v4 offset:6144
    v_mfma_f32_16x16x32_bf16 v[160:163], v[44:47], v[36:39], v[160:163]
    ds_read_b128 v[108:111], v4 offset:7168
    v_mfma_f32_16x16x32_bf16 v[160:163], v[68:71], v[60:63], v[160:163]
    s_waitcnt lgkmcnt(4)
    v_mfma_f32_16x16x32_bf16 v[132:135], v[88:91], v[72:75], v[132:135]
    v_mfma_f32_16x16x32_bf16 v[132:135], v[112:115], v[96:99], v[132:135]
    s_waitcnt lgkmcnt(0)
    s_barrier
    ds_read_b64_tr_b16 v[40:41], v128 offset:40960
    ds_read_b64_tr_b16 v[42:43], v128 offset:45056
    v_mfma_f32_16x16x32_bf16 v[136:139], v[92:95], v[72:75], v[136:139]
    ds_read_b128 v[24:27], v5 offset:0
    ds_read_b64_tr_b16 v[64:65], v128 offset:49152
    v_mfma_f32_16x16x32_bf16 v[136:139], v[116:119], v[96:99], v[136:139]
    ds_read_b64_tr_b16 v[66:67], v128 offset:53248
    v_mfma_f32_16x16x32_bf16 v[140:143], v[88:91], v[76:79], v[140:143]
    ds_read_b128 v[48:51], v5 offset:1024
    v_mfma_f32_16x16x32_bf16 v[140:143], v[112:115], v[100:103], v[140:143]
    ds_read_b64_tr_b16 v[44:45], v129 offset:40960
    v_mfma_f32_16x16x32_bf16 v[144:147], v[92:95], v[76:79], v[144:147]
    ds_read_b64_tr_b16 v[46:47], v129 offset:45056
    v_mfma_f32_16x16x32_bf16 v[144:147], v[116:119], v[100:103], v[144:147]
    ds_read_b64_tr_b16 v[68:69], v129 offset:49152
    v_mfma_f32_16x16x32_bf16 v[148:151], v[88:91], v[80:83], v[148:151]
    ds_read_b64_tr_b16 v[70:71], v129 offset:53248
    v_mfma_f32_16x16x32_bf16 v[148:151], v[112:115], v[104:107], v[148:151]
    ds_read_b128 v[28:31], v5 offset:2048
    v_mfma_f32_16x16x32_bf16 v[152:155], v[92:95], v[80:83], v[152:155]
    ds_read_b128 v[52:55], v5 offset:3072
    v_mfma_f32_16x16x32_bf16 v[152:155], v[116:119], v[104:107], v[152:155]
    ds_read_b128 v[32:35], v5 offset:4096
    v_mfma_f32_16x16x32_bf16 v[156:159], v[88:91], v[84:87], v[156:159]
    ds_read_b128 v[56:59], v5 offset:5120
    v_mfma_f32_16x16x32_bf16 v[156:159], v[112:115], v[108:111], v[156:159]
    s_waitcnt lgkmcnt(8)
    ds_read_b128 v[36:39], v5 offset:6144
    v_mfma_f32_16x16x32_bf16 v[160:163], v[92:95], v[84:87], v[160:163]
    ds_read_b128 v[60:63], v5 offset:7168
    v_mfma_f32_16x16x32_bf16 v[160:163], v[116:119], v[108:111], v[160:163]
    s_waitcnt lgkmcnt(4)
    v_mfma_f32_16x16x32_bf16 v[132:135], v[40:43], v[24:27], v[132:135]
    v_mfma_f32_16x16x32_bf16 v[132:135], v[64:67], v[48:51], v[132:135]
    s_waitcnt lgkmcnt(0)
    s_barrier
    ds_read_b64_tr_b16 v[88:89], v130 offset:24576
    ds_read_b64_tr_b16 v[90:91], v130 offset:28672
    v_mfma_f32_16x16x32_bf16 v[136:139], v[44:47], v[24:27], v[136:139]
    ds_read_b128 v[72:75], v5 offset:40960
    ds_read_b64_tr_b16 v[112:113], v130 offset:32768
    v_mfma_f32_16x16x32_bf16 v[136:139], v[68:71], v[48:51], v[136:139]
    ds_read_b64_tr_b16 v[114:115], v130 offset:36864
    v_mfma_f32_16x16x32_bf16 v[140:143], v[40:43], v[28:31], v[140:143]
    ds_read_b128 v[96:99], v5 offset:41984
    v_mfma_f32_16x16x32_bf16 v[140:143], v[64:67], v[52:55], v[140:143]
    ds_read_b64_tr_b16 v[92:93], v131 offset:24576
    v_mfma_f32_16x16x32_bf16 v[144:147], v[44:47], v[28:31], v[144:147]
    ds_read_b64_tr_b16 v[94:95], v131 offset:28672
    v_mfma_f32_16x16x32_bf16 v[144:147], v[68:71], v[52:55], v[144:147]
    ds_read_b64_tr_b16 v[116:117], v131 offset:32768
    v_mfma_f32_16x16x32_bf16 v[148:151], v[40:43], v[32:35], v[148:151]
    ds_read_b64_tr_b16 v[118:119], v131 offset:36864
    v_mfma_f32_16x16x32_bf16 v[148:151], v[64:67], v[56:59], v[148:151]
    ds_read_b128 v[76:79], v5 offset:43008
    v_mfma_f32_16x16x32_bf16 v[152:155], v[44:47], v[32:35], v[152:155]
    ds_read_b128 v[100:103], v5 offset:44032
    v_mfma_f32_16x16x32_bf16 v[152:155], v[68:71], v[56:59], v[152:155]
    ds_read_b128 v[80:83], v5 offset:45056
    v_mfma_f32_16x16x32_bf16 v[156:159], v[40:43], v[36:39], v[156:159]
    ds_read_b128 v[104:107], v5 offset:46080
    v_mfma_f32_16x16x32_bf16 v[156:159], v[64:67], v[60:63], v[156:159]
    s_waitcnt lgkmcnt(8)
    ds_read_b128 v[84:87], v5 offset:47104
    v_mfma_f32_16x16x32_bf16 v[160:163], v[44:47], v[36:39], v[160:163]
    ds_read_b128 v[108:111], v5 offset:48128
    v_mfma_f32_16x16x32_bf16 v[160:163], v[68:71], v[60:63], v[160:163]
    s_waitcnt lgkmcnt(4)
    v_mfma_f32_16x16x32_bf16 v[132:135], v[88:91], v[72:75], v[132:135]
    v_mfma_f32_16x16x32_bf16 v[132:135], v[112:115], v[96:99], v[132:135]
    s_waitcnt lgkmcnt(0)
    s_barrier
    ds_read_b64_tr_b16 v[40:41], v128 offset:0
    ds_read_b64_tr_b16 v[42:43], v128 offset:4096
    v_mfma_f32_16x16x32_bf16 v[136:139], v[92:95], v[72:75], v[136:139]
    ds_read_b128 v[24:27], v4 offset:40960
    ds_read_b64_tr_b16 v[64:65], v128 offset:8192
    v_mfma_f32_16x16x32_bf16 v[136:139], v[116:119], v[96:99], v[136:139]
    ds_read_b64_tr_b16 v[66:67], v128 offset:12288
    v_mfma_f32_16x16x32_bf16 v[140:143], v[88:91], v[76:79], v[140:143]
    ds_read_b128 v[48:51], v4 offset:41984
    v_mfma_f32_16x16x32_bf16 v[140:143], v[112:115], v[100:103], v[140:143]
    ds_read_b64_tr_b16 v[44:45], v129 offset:0
    v_mfma_f32_16x16x32_bf16 v[144:147], v[92:95], v[76:79], v[144:147]
    ds_read_b64_tr_b16 v[46:47], v129 offset:4096
    v_mfma_f32_16x16x32_bf16 v[144:147], v[116:119], v[100:103], v[144:147]
    ds_read_b64_tr_b16 v[68:69], v129 offset:8192
    v_mfma_f32_16x16x32_bf16 v[148:151], v[88:91], v[80:83], v[148:151]
    ds_read_b64_tr_b16 v[70:71], v129 offset:12288
    v_mfma_f32_16x16x32_bf16 v[148:151], v[112:115], v[104:107], v[148:151]
    ds_read_b128 v[28:31], v4 offset:43008
    v_mfma_f32_16x16x32_bf16 v[152:155], v[92:95], v[80:83], v[152:155]
    ds_read_b128 v[52:55], v4 offset:44032
    v_mfma_f32_16x16x32_bf16 v[152:155], v[116:119], v[104:107], v[152:155]
    ds_read_b128 v[32:35], v4 offset:45056
    v_mfma_f32_16x16x32_bf16 v[156:159], v[88:91], v[84:87], v[156:159]
    ds_read_b128 v[56:59], v4 offset:46080
    v_mfma_f32_16x16x32_bf16 v[156:159], v[112:115], v[108:111], v[156:159]
    s_waitcnt lgkmcnt(8)
    ds_read_b128 v[36:39], v4 offset:47104
    v_mfma_f32_16x16x32_bf16 v[160:163], v[92:95], v[84:87], v[160:163]
    ds_read_b128 v[60:63], v4 offset:48128
    v_mfma_f32_16x16x32_bf16 v[160:163], v[116:119], v[108:111], v[160:163]
    s_waitcnt lgkmcnt(4)
    v_mfma_f32_16x16x32_bf16 v[132:135], v[40:43], v[24:27], v[132:135]
    v_mfma_f32_16x16x32_bf16 v[132:135], v[64:67], v[48:51], v[132:135]
    s_waitcnt lgkmcnt(0)
    s_barrier
    ds_read_b64_tr_b16 v[88:89], v8 offset:0
    ds_read_b64_tr_b16 v[90:91], v8 offset:4096
    v_mfma_f32_16x16x32_bf16 v[136:139], v[44:47], v[24:27], v[136:139]
    ds_read_b128 v[72:75], v4 offset:0
    ds_read_b64_tr_b16 v[112:113], v8 offset:8192
    v_mfma_f32_16x16x32_bf16 v[136:139], v[68:71], v[48:51], v[136:139]
    ds_read_b64_tr_b16 v[114:115], v8 offset:12288
    v_mfma_f32_16x16x32_bf16 v[140:143], v[40:43], v[28:31], v[140:143]
    ds_read_b128 v[96:99], v4 offset:1024
    v_mfma_f32_16x16x32_bf16 v[140:143], v[64:67], v[52:55], v[140:143]
    ds_read_b64_tr_b16 v[92:93], v9 offset:0
    v_mfma_f32_16x16x32_bf16 v[144:147], v[44:47], v[28:31], v[144:147]
    ds_read_b64_tr_b16 v[94:95], v9 offset:4096
    v_mfma_f32_16x16x32_bf16 v[144:147], v[68:71], v[52:55], v[144:147]
    ds_read_b64_tr_b16 v[116:117], v9 offset:8192
    v_mfma_f32_16x16x32_bf16 v[148:151], v[40:43], v[32:35], v[148:151]
    ds_read_b64_tr_b16 v[118:119], v9 offset:12288
    v_mfma_f32_16x16x32_bf16 v[148:151], v[64:67], v[56:59], v[148:151]
    ds_read_b128 v[76:79], v4 offset:2048
    v_mfma_f32_16x16x32_bf16 v[152:155], v[44:47], v[32:35], v[152:155]
    ds_read_b128 v[100:103], v4 offset:3072
    v_mfma_f32_16x16x32_bf16 v[152:155], v[68:71], v[56:59], v[152:155]
    ds_read_b128 v[80:83], v4 offset:4096
    v_mfma_f32_16x16x32_bf16 v[156:159], v[40:43], v[36:39], v[156:159]
    ds_read_b128 v[104:107], v4 offset:5120
    v_mfma_f32_16x16x32_bf16 v[156:159], v[64:67], v[60:63], v[156:159]
    s_waitcnt lgkmcnt(8)
    ds_read_b128 v[84:87], v4 offset:6144
    v_mfma_f32_16x16x32_bf16 v[160:163], v[44:47], v[36:39], v[160:163]
    ds_read_b128 v[108:111], v4 offset:7168
    v_mfma_f32_16x16x32_bf16 v[160:163], v[68:71], v[60:63], v[160:163]
    s_waitcnt lgkmcnt(4)
    v_mfma_f32_16x16x32_bf16 v[132:135], v[88:91], v[72:75], v[132:135]
    v_mfma_f32_16x16x32_bf16 v[132:135], v[112:115], v[96:99], v[132:135]
    s_waitcnt lgkmcnt(0)
    s_barrier
    ds_read_b64_tr_b16 v[40:41], v8 offset:40960
    ds_read_b64_tr_b16 v[42:43], v8 offset:45056
    v_mfma_f32_16x16x32_bf16 v[136:139], v[92:95], v[72:75], v[136:139]
    ds_read_b128 v[24:27], v5 offset:0
    ds_read_b64_tr_b16 v[64:65], v8 offset:49152
    v_mfma_f32_16x16x32_bf16 v[136:139], v[116:119], v[96:99], v[136:139]
    ds_read_b64_tr_b16 v[66:67], v8 offset:53248
    v_mfma_f32_16x16x32_bf16 v[140:143], v[88:91], v[76:79], v[140:143]
    ds_read_b128 v[48:51], v5 offset:1024
    v_mfma_f32_16x16x32_bf16 v[140:143], v[112:115], v[100:103], v[140:143]
    ds_read_b64_tr_b16 v[44:45], v9 offset:40960
    v_mfma_f32_16x16x32_bf16 v[144:147], v[92:95], v[76:79], v[144:147]
    ds_read_b64_tr_b16 v[46:47], v9 offset:45056
    v_mfma_f32_16x16x32_bf16 v[144:147], v[116:119], v[100:103], v[144:147]
    ds_read_b64_tr_b16 v[68:69], v9 offset:49152
    v_mfma_f32_16x16x32_bf16 v[148:151], v[88:91], v[80:83], v[148:151]
    ds_read_b64_tr_b16 v[70:71], v9 offset:53248
    v_mfma_f32_16x16x32_bf16 v[148:151], v[112:115], v[104:107], v[148:151]
    ds_read_b128 v[28:31], v5 offset:2048
    v_mfma_f32_16x16x32_bf16 v[152:155], v[92:95], v[80:83], v[152:155]
    ds_read_b128 v[52:55], v5 offset:3072
    v_mfma_f32_16x16x32_bf16 v[152:155], v[116:119], v[104:107], v[152:155]
    ds_read_b128 v[32:35], v5 offset:4096
    v_mfma_f32_16x16x32_bf16 v[156:159], v[88:91], v[84:87], v[156:159]
    ds_read_b128 v[56:59], v5 offset:5120
    v_mfma_f32_16x16x32_bf16 v[156:159], v[112:115], v[108:111], v[156:159]
    s_waitcnt lgkmcnt(8)
    ds_read_b128 v[36:39], v5 offset:6144
    v_mfma_f32_16x16x32_bf16 v[160:163], v[92:95], v[84:87], v[160:163]
    ds_read_b128 v[60:63], v5 offset:7168
    v_mfma_f32_16x16x32_bf16 v[160:163], v[116:119], v[108:111], v[160:163]
    s_waitcnt lgkmcnt(4)
    v_mfma_f32_16x16x32_bf16 v[132:135], v[40:43], v[24:27], v[132:135]
    v_mfma_f32_16x16x32_bf16 v[132:135], v[64:67], v[48:51], v[132:135]
    s_waitcnt lgkmcnt(0)
    s_barrier
    ds_read_b64_tr_b16 v[88:89], v128 offset:16384
    ds_read_b64_tr_b16 v[90:91], v128 offset:20480
    v_mfma_f32_16x16x32_bf16 v[136:139], v[44:47], v[24:27], v[136:139]
    ds_read_b128 v[72:75], v5 offset:40960
    ds_read_b64_tr_b16 v[112:113], v128 offset:24576
    v_mfma_f32_16x16x32_bf16 v[136:139], v[68:71], v[48:51], v[136:139]
    ds_read_b64_tr_b16 v[114:115], v128 offset:28672
    v_mfma_f32_16x16x32_bf16 v[140:143], v[40:43], v[28:31], v[140:143]
    ds_read_b128 v[96:99], v5 offset:41984
    v_mfma_f32_16x16x32_bf16 v[140:143], v[64:67], v[52:55], v[140:143]
    ds_read_b64_tr_b16 v[92:93], v129 offset:16384
    v_mfma_f32_16x16x32_bf16 v[144:147], v[44:47], v[28:31], v[144:147]
    ds_read_b64_tr_b16 v[94:95], v129 offset:20480
    v_mfma_f32_16x16x32_bf16 v[144:147], v[68:71], v[52:55], v[144:147]
    ds_read_b64_tr_b16 v[116:117], v129 offset:24576
    v_mfma_f32_16x16x32_bf16 v[148:151], v[40:43], v[32:35], v[148:151]
    ds_read_b64_tr_b16 v[118:119], v129 offset:28672
    v_mfma_f32_16x16x32_bf16 v[148:151], v[64:67], v[56:59], v[148:151]
    ds_read_b128 v[76:79], v5 offset:43008
    v_mfma_f32_16x16x32_bf16 v[152:155], v[44:47], v[32:35], v[152:155]
    ds_read_b128 v[100:103], v5 offset:44032
    v_mfma_f32_16x16x32_bf16 v[152:155], v[68:71], v[56:59], v[152:155]
    ds_read_b128 v[80:83], v5 offset:45056
    v_mfma_f32_16x16x32_bf16 v[156:159], v[40:43], v[36:39], v[156:159]
    ds_read_b128 v[104:107], v5 offset:46080
    v_mfma_f32_16x16x32_bf16 v[156:159], v[64:67], v[60:63], v[156:159]
    s_waitcnt lgkmcnt(8)
    ds_read_b128 v[84:87], v5 offset:47104
    v_mfma_f32_16x16x32_bf16 v[160:163], v[44:47], v[36:39], v[160:163]
    ds_read_b128 v[108:111], v5 offset:48128
    v_mfma_f32_16x16x32_bf16 v[160:163], v[68:71], v[60:63], v[160:163]
    s_waitcnt lgkmcnt(4)
    v_mfma_f32_16x16x32_bf16 v[132:135], v[88:91], v[72:75], v[132:135]
    v_mfma_f32_16x16x32_bf16 v[132:135], v[112:115], v[96:99], v[132:135]
    s_waitcnt lgkmcnt(0)
    s_barrier
    ds_read_b64_tr_b16 v[40:41], v130 offset:0
    ds_read_b64_tr_b16 v[42:43], v130 offset:4096
    v_mfma_f32_16x16x32_bf16 v[136:139], v[92:95], v[72:75], v[136:139]
    ds_read_b128 v[24:27], v4 offset:40960
    ds_read_b64_tr_b16 v[64:65], v130 offset:8192
    v_mfma_f32_16x16x32_bf16 v[136:139], v[116:119], v[96:99], v[136:139]
    ds_read_b64_tr_b16 v[66:67], v130 offset:12288
    v_mfma_f32_16x16x32_bf16 v[140:143], v[88:91], v[76:79], v[140:143]
    ds_read_b128 v[48:51], v4 offset:41984
    v_mfma_f32_16x16x32_bf16 v[140:143], v[112:115], v[100:103], v[140:143]
    ds_read_b64_tr_b16 v[44:45], v131 offset:0
    v_mfma_f32_16x16x32_bf16 v[144:147], v[92:95], v[76:79], v[144:147]
    ds_read_b64_tr_b16 v[46:47], v131 offset:4096
    v_mfma_f32_16x16x32_bf16 v[144:147], v[116:119], v[100:103], v[144:147]
    ds_read_b64_tr_b16 v[68:69], v131 offset:8192
    v_mfma_f32_16x16x32_bf16 v[148:151], v[88:91], v[80:83], v[148:151]
    ds_read_b64_tr_b16 v[70:71], v131 offset:12288
    v_mfma_f32_16x16x32_bf16 v[148:151], v[112:115], v[104:107], v[148:151]
    ds_read_b128 v[28:31], v4 offset:43008
    v_mfma_f32_16x16x32_bf16 v[152:155], v[92:95], v[80:83], v[152:155]
    ds_read_b128 v[52:55], v4 offset:44032
    v_mfma_f32_16x16x32_bf16 v[152:155], v[116:119], v[104:107], v[152:155]
    ds_read_b128 v[32:35], v4 offset:45056
    v_mfma_f32_16x16x32_bf16 v[156:159], v[88:91], v[84:87], v[156:159]
    ds_read_b128 v[56:59], v4 offset:46080
    v_mfma_f32_16x16x32_bf16 v[156:159], v[112:115], v[108:111], v[156:159]
    s_waitcnt lgkmcnt(8)
    ds_read_b128 v[36:39], v4 offset:47104
    v_mfma_f32_16x16x32_bf16 v[160:163], v[92:95], v[84:87], v[160:163]
    ds_read_b128 v[60:63], v4 offset:48128
    v_mfma_f32_16x16x32_bf16 v[160:163], v[116:119], v[108:111], v[160:163]
    s_waitcnt lgkmcnt(4)
    v_mfma_f32_16x16x32_bf16 v[132:135], v[40:43], v[24:27], v[132:135]
    v_mfma_f32_16x16x32_bf16 v[132:135], v[64:67], v[48:51], v[132:135]
    s_waitcnt lgkmcnt(0)
    s_barrier
    ds_read_b64_tr_b16 v[88:89], v128 offset:40960
    ds_read_b64_tr_b16 v[90:91], v128 offset:45056
    v_mfma_f32_16x16x32_bf16 v[136:139], v[44:47], v[24:27], v[136:139]
    ds_read_b128 v[72:75], v4 offset:0
    ds_read_b64_tr_b16 v[112:113], v128 offset:49152
    v_mfma_f32_16x16x32_bf16 v[136:139], v[68:71], v[48:51], v[136:139]
    ds_read_b64_tr_b16 v[114:115], v128 offset:53248
    v_mfma_f32_16x16x32_bf16 v[140:143], v[40:43], v[28:31], v[140:143]
    ds_read_b128 v[96:99], v4 offset:1024
    v_mfma_f32_16x16x32_bf16 v[140:143], v[64:67], v[52:55], v[140:143]
    ds_read_b64_tr_b16 v[92:93], v129 offset:40960
    v_mfma_f32_16x16x32_bf16 v[144:147], v[44:47], v[28:31], v[144:147]
    ds_read_b64_tr_b16 v[94:95], v129 offset:45056
    v_mfma_f32_16x16x32_bf16 v[144:147], v[68:71], v[52:55], v[144:147]
    ds_read_b64_tr_b16 v[116:117], v129 offset:49152
    v_mfma_f32_16x16x32_bf16 v[148:151], v[40:43], v[32:35], v[148:151]
    ds_read_b64_tr_b16 v[118:119], v129 offset:53248
    v_mfma_f32_16x16x32_bf16 v[148:151], v[64:67], v[56:59], v[148:151]
    ds_read_b128 v[76:79], v4 offset:2048
    v_mfma_f32_16x16x32_bf16 v[152:155], v[44:47], v[32:35], v[152:155]
    ds_read_b128 v[100:103], v4 offset:3072
    v_mfma_f32_16x16x32_bf16 v[152:155], v[68:71], v[56:59], v[152:155]
    ds_read_b128 v[80:83], v4 offset:4096
    v_mfma_f32_16x16x32_bf16 v[156:159], v[40:43], v[36:39], v[156:159]
    ds_read_b128 v[104:107], v4 offset:5120
    v_mfma_f32_16x16x32_bf16 v[156:159], v[64:67], v[60:63], v[156:159]
    s_waitcnt lgkmcnt(8)
    ds_read_b128 v[84:87], v4 offset:6144
    v_mfma_f32_16x16x32_bf16 v[160:163], v[44:47], v[36:39], v[160:163]
    ds_read_b128 v[108:111], v4 offset:7168
    v_mfma_f32_16x16x32_bf16 v[160:163], v[68:71], v[60:63], v[160:163]
    s_waitcnt lgkmcnt(4)
    v_mfma_f32_16x16x32_bf16 v[132:135], v[88:91], v[72:75], v[132:135]
    v_mfma_f32_16x16x32_bf16 v[132:135], v[112:115], v[96:99], v[132:135]
    s_waitcnt lgkmcnt(0)
    s_barrier
    ds_read_b64_tr_b16 v[40:41], v130 offset:24576
    ds_read_b64_tr_b16 v[42:43], v130 offset:28672
    v_mfma_f32_16x16x32_bf16 v[136:139], v[92:95], v[72:75], v[136:139]
    ds_read_b128 v[24:27], v5 offset:0
    ds_read_b64_tr_b16 v[64:65], v130 offset:32768
    v_mfma_f32_16x16x32_bf16 v[136:139], v[116:119], v[96:99], v[136:139]
    ds_read_b64_tr_b16 v[66:67], v130 offset:36864
    v_mfma_f32_16x16x32_bf16 v[140:143], v[88:91], v[76:79], v[140:143]
    ds_read_b128 v[48:51], v5 offset:1024
    v_mfma_f32_16x16x32_bf16 v[140:143], v[112:115], v[100:103], v[140:143]
    ds_read_b64_tr_b16 v[44:45], v131 offset:24576
    v_mfma_f32_16x16x32_bf16 v[144:147], v[92:95], v[76:79], v[144:147]
    ds_read_b64_tr_b16 v[46:47], v131 offset:28672
    v_mfma_f32_16x16x32_bf16 v[144:147], v[116:119], v[100:103], v[144:147]
    ds_read_b64_tr_b16 v[68:69], v131 offset:32768
    v_mfma_f32_16x16x32_bf16 v[148:151], v[88:91], v[80:83], v[148:151]
    ds_read_b64_tr_b16 v[70:71], v131 offset:36864
    v_mfma_f32_16x16x32_bf16 v[148:151], v[112:115], v[104:107], v[148:151]
    ds_read_b128 v[28:31], v5 offset:2048
    v_mfma_f32_16x16x32_bf16 v[152:155], v[92:95], v[80:83], v[152:155]
    ds_read_b128 v[52:55], v5 offset:3072
    v_mfma_f32_16x16x32_bf16 v[152:155], v[116:119], v[104:107], v[152:155]
    ds_read_b128 v[32:35], v5 offset:4096
    v_mfma_f32_16x16x32_bf16 v[156:159], v[88:91], v[84:87], v[156:159]
    ds_read_b128 v[56:59], v5 offset:5120
    v_mfma_f32_16x16x32_bf16 v[156:159], v[112:115], v[108:111], v[156:159]
    s_waitcnt lgkmcnt(8)
    ds_read_b128 v[36:39], v5 offset:6144
    v_mfma_f32_16x16x32_bf16 v[160:163], v[92:95], v[84:87], v[160:163]
    ds_read_b128 v[60:63], v5 offset:7168
    v_mfma_f32_16x16x32_bf16 v[160:163], v[116:119], v[108:111], v[160:163]
    s_waitcnt lgkmcnt(4)
    v_mfma_f32_16x16x32_bf16 v[132:135], v[40:43], v[24:27], v[132:135]
    v_mfma_f32_16x16x32_bf16 v[132:135], v[64:67], v[48:51], v[132:135]
    s_waitcnt lgkmcnt(0)
    s_barrier
    ds_read_b64_tr_b16 v[88:89], v128 offset:0
    ds_read_b64_tr_b16 v[90:91], v128 offset:4096
    v_mfma_f32_16x16x32_bf16 v[136:139], v[44:47], v[24:27], v[136:139]
    ds_read_b128 v[72:75], v5 offset:40960
    ds_read_b64_tr_b16 v[112:113], v128 offset:8192
    v_mfma_f32_16x16x32_bf16 v[136:139], v[68:71], v[48:51], v[136:139]
    ds_read_b64_tr_b16 v[114:115], v128 offset:12288
    ds_read_b128 v[96:99], v5 offset:41984
    v_mfma_f32_16x16x32_bf16 v[140:143], v[40:43], v[28:31], v[140:143]
    ds_read_b64_tr_b16 v[92:93], v129 offset:0
    ds_read_b64_tr_b16 v[94:95], v129 offset:4096
    v_mfma_f32_16x16x32_bf16 v[140:143], v[64:67], v[52:55], v[140:143]
    ds_read_b64_tr_b16 v[116:117], v129 offset:8192
    ds_read_b64_tr_b16 v[118:119], v129 offset:12288
    v_mfma_f32_16x16x32_bf16 v[144:147], v[44:47], v[28:31], v[144:147]
W_4:
    s_cbranch_execz R_4
    s_nop 0
    ds_read_b128 v[76:79], v5 offset:43008
    v_mfma_f32_16x16x32_bf16 v[144:147], v[68:71], v[52:55], v[144:147]
    ds_read_b128 v[100:103], v5 offset:44032
    s_waitcnt lgkmcnt(9)
    v_mfma_f32_16x16x32_bf16 v[132:135], v[88:91], v[72:75], v[132:135]
    ds_read_b128 v[80:83], v5 offset:45056
    s_waitcnt lgkmcnt(7)
    v_mfma_f32_16x16x32_bf16 v[132:135], v[112:115], v[96:99], v[132:135]
    ds_read_b128 v[104:107], v5 offset:46080
    s_waitcnt lgkmcnt(6)
    v_mfma_f32_16x16x32_bf16 v[136:139], v[92:95], v[72:75], v[136:139]
    ds_read_b128 v[84:87], v5 offset:47104
    s_waitcnt lgkmcnt(5)
    v_mfma_f32_16x16x32_bf16 v[136:139], v[116:119], v[96:99], v[136:139]
    ds_read_b128 v[108:111], v5 offset:48128
    v_mfma_f32_16x16x32_bf16 v[148:151], v[40:43], v[32:35], v[148:151]
    v_mfma_f32_16x16x32_bf16 v[148:151], v[64:67], v[56:59], v[148:151]
    v_mfma_f32_16x16x32_bf16 v[152:155], v[44:47], v[32:35], v[152:155]
    v_cvt_pk_bf16_f32 v132, v132, v133
    v_cvt_pk_bf16_f32 v133, v134, v135
    v_mfma_f32_16x16x32_bf16 v[152:155], v[68:71], v[56:59], v[152:155]
    s_nop 0
    v_cvt_pk_bf16_f32 v134, v136, v137
    v_cvt_pk_bf16_f32 v135, v138, v139
    s_waitcnt lgkmcnt(5)
    v_mfma_f32_16x16x32_bf16 v[140:143], v[88:91], v[76:79], v[140:143]
    ds_write2_b64 v18, v[132:133], v[134:135] offset0:0 offset1:4
    s_waitcnt lgkmcnt(5)
    v_mfma_f32_16x16x32_bf16 v[140:143], v[112:115], v[100:103], v[140:143]
    v_mfma_f32_16x16x32_bf16 v[144:147], v[92:95], v[76:79], v[144:147]
    v_mfma_f32_16x16x32_bf16 v[144:147], v[116:119], v[100:103], v[144:147]
    v_mfma_f32_16x16x32_bf16 v[156:159], v[40:43], v[36:39], v[156:159]
    v_mfma_f32_16x16x32_bf16 v[156:159], v[64:67], v[60:63], v[156:159]
    v_mfma_f32_16x16x32_bf16 v[160:163], v[44:47], v[36:39], v[160:163]
    s_waitcnt lgkmcnt(0)
    s_barrier
    s_nop 0
    v_cvt_pk_bf16_f32 v140, v140, v141
    v_mfma_f32_16x16x32_bf16 v[160:163], v[68:71], v[60:63], v[160:163]
    v_cvt_pk_bf16_f32 v141, v142, v143
    v_cvt_pk_bf16_f32 v142, v144, v145
    v_mfma_f32_16x16x32_bf16 v[148:151], v[88:91], v[80:83], v[148:151]
    v_cvt_pk_bf16_f32 v143, v146, v147
    ds_write2_b64 v19, v[140:141], v[142:143] offset0:0 offset1:4
    v_mfma_f32_16x16x32_bf16 v[148:151], v[112:115], v[104:107], v[148:151]
    v_mfma_f32_16x16x32_bf16 v[152:155], v[92:95], v[80:83], v[152:155]
    v_mfma_f32_16x16x32_bf16 v[152:155], v[116:119], v[104:107], v[152:155]
    v_mfma_f32_16x16x32_bf16 v[156:159], v[88:91], v[84:87], v[156:159]
    v_mfma_f32_16x16x32_bf16 v[156:159], v[112:115], v[108:111], v[156:159]
    v_mfma_f32_16x16x32_bf16 v[160:163], v[92:95], v[84:87], v[160:163]
    s_waitcnt lgkmcnt(0)
    s_barrier
    s_nop 0
    v_cvt_pk_bf16_f32 v148, v148, v149
    v_cvt_pk_bf16_f32 v149, v150, v151
    v_mfma_f32_16x16x32_bf16 v[160:163], v[116:119], v[108:111], v[160:163]
    v_cvt_pk_bf16_f32 v150, v152, v153
    v_cvt_pk_bf16_f32 v151, v154, v155
    ds_write2_b64 v20, v[148:149], v[150:151] offset0:0 offset1:4
    v_cvt_pk_bf16_f32 v156, v156, v157
    v_cvt_pk_bf16_f32 v157, v158, v159
    s_nop 2
    v_cvt_pk_bf16_f32 v158, v160, v161
    v_cvt_pk_bf16_f32 v159, v162, v163
    ds_write2_b64 v21, v[156:157], v[158:159] offset0:0 offset1:4
    s_waitcnt lgkmcnt(0)
    s_barrier
F_end:
    s_endpgm
F_loader:
    s_mov_b32 s48, 0x76542130
    s_mov_b32 s49, 0xfedca9b8
    s_cmp_eq_u32 s35, 1
    s_cselect_b32 s48, 0x75463021, s48
    s_cselect_b32 s49, 0xfdceba98, s49
    s_cmp_eq_u32 s35, 2
    s_cselect_b32 s48, 0x96543102, s48
    s_cselect_b32 s49, 0xfedcba87, s49
    s_cmp_eq_u32 s35, 3
    s_cselect_b32 s48, 0x76532410, s48
    s_cselect_b32 s49, 0xfedbac98, s49
    s_cmp_eq_u32 s35, 4
    s_cselect_b32 s48, 0x65743021, s48
    s_cselect_b32 s49, 0xedfcba98, s49
    s_cmp_eq_u32 s35, 5
    s_cselect_b32 s48, 0x76543102, s48
    s_cselect_b32 s49, 0xfedcb98a, s49
    s_cmp_eq_u32 s35, 6
    s_cselect_b32 s48, 0x76435210, s48
    s_cselect_b32 s49, 0xfecbda98, s49
    s_cmp_eq_u32 s35, 7
    s_cselect_b32 s48, 0x68543021, s48
    s_cselect_b32 s49, 0xfedcba97, s49
    s_setprio 0
    s_sub_u32 s3, s3, 8
    v_lshrrev_b32 v2, 3, v0
    v_and_b32 v3, 7, v0
    v_lshrrev_b32 v4, 1, v2
    v_xor_b32 v5, v3, v4
    v_xor_b32 v6, 4, v5
    v_lshlrev_b32 v5, 4, v5
    v_lshlrev_b32 v6, 4, v6
    v_lshlrev_b32 v7, 11, v2
    v_add_u32 v12, v5, v7
    v_add_u32 v13, v6, v7
    v_and_b32 v4, 1, v4
    v_lshlrev_b32 v4, 1, v4
    v_xor_b32 v8, v3, v4
    v_xor_b32 v9, 4, v8
    v_lshlrev_b32 v8, 4, v8
    v_lshlrev_b32 v9, 4, v9
    v_mul_u32_u24 v7, 6144, v2
    v_add_u32 v14, v8, v7
    v_add_u32_e64 v15, v9, v7
    s_lshl_b32 s36, s32, 18
    s_lshl_b32 s37, s3, 16
    s_add_u32 s36, s36, s37
    s_lshl_b32 s38, s33, 7
    s_mul_i32 s37, s3, 98304
    s_add_u32 s38, s38, s37
    s_sub_u32 s47, s10, s33
    s_lshl_b32 s47, s47, 7
    s_and_b32 s42, s39, 8
    s_and_b32 s43, s30, 6
    s_or_b32 s42, s42, s43
    s_and_b32 s43, s34, 0
    s_lshl_b32 s43, s43, 0
    s_xor_b32 s42, s42, s43
    s_lshl_b32 s44, s3, 12
    s_lshl_b32 s45, s3, 11
    s_waitcnt lgkmcnt(0)
    s_mov_b32 s12, s4
    s_mov_b32 s13, s5
    s_mov_b32 s14, 0x400000
    s_mov_b32 s15, 0x00020000
    s_mov_b32 s16, s6
    s_mov_b32 s17, s7
    s_mov_b32 s18, 0x600000
    s_mov_b32 s19, 0x00020000
    s_bfe_u32 s40, s48, 0x40000
    s_bitcmp1_b32 s40, 3
    s_cselect_b32 s41, s39, s42
    s_xor_b32 s40, s40, s41
    s_mul_i32 s41, s40, 393216
    s_add_u32 s41, s41, s38
    s_lshl_b32 s40, s40, 7
    s_add_u32 s40, s40, s36
    s_add_u32 m0, s44, 0
    s_add_u32 s46, s40, 0
    buffer_load_dwordx4 v12, s[12:15], s46 offen lds
    s_add_u32 m0, s45, 24576
    s_add_u32 s46, s41, 2048
    buffer_load_dwordx4 v14, s[16:19], s46 offen lds
    s_add_u32 m0, s45, 25600
    s_add_u32 s46, s41, 51200
    buffer_load_dwordx4 v15, s[16:19], s46 offen lds
    s_add_u32 m0, s45, 16384
    s_add_u32 s46, s41, 0
    s_add_u32 s46, s46, s47
    buffer_load_dwordx4 v14, s[16:19], s46 offen lds
    s_add_u32 m0, s45, 17408
    s_add_u32 s46, s41, 49152
    s_add_u32 s46, s46, s47
    s_nop 0
    buffer_load_dwordx4 v15, s[16:19], s46 offen lds
    s_add_u32 m0, s45, 32768
    s_add_u32 s46, s41, 4096
    buffer_load_dwordx4 v14, s[16:19], s46 offen lds
    s_add_u32 m0, s45, 33792
    s_add_u32 s46, s41, 53248
    buffer_load_dwordx4 v15, s[16:19], s46 offen lds
    s_add_u32 m0, s44, 1024
    s_add_u32 s46, s40, 16384
    buffer_load_dwordx4 v13, s[12:15], s46 offen lds
    s_add_u32 m0, s44, 2048
    s_add_u32 s46, s40, 32768
    buffer_load_dwordx4 v12, s[12:15], s46 offen lds
    s_add_u32 m0, s44, 3072
    s_add_u32 s46, s40, 49152
    buffer_load_dwordx4 v13, s[12:15], s46 offen lds
    s_bfe_u32 s40, s48, 0x40004
    s_bitcmp1_b32 s40, 3
    s_cselect_b32 s41, s39, s42
    s_xor_b32 s40, s40, s41
    s_mul_i32 s41, s40, 393216
    s_add_u32 s41, s41, s38
    s_lshl_b32 s40, s40, 7
    s_add_u32 s40, s40, s36
    s_add_u32 m0, s44, 40960
    s_add_u32 s46, s40, 0
    s_nop 0
    buffer_load_dwordx4 v12, s[12:15], s46 offen lds
    s_add_u32 m0, s45, 65536
    s_add_u32 s46, s41, 2048
    buffer_load_dwordx4 v14, s[16:19], s46 offen lds
    s_add_u32 m0, s45, 66560
    s_add_u32 s46, s41, 51200
    buffer_load_dwordx4 v15, s[16:19], s46 offen lds
    s_add_u32 m0, s45, 57344
    s_add_u32 s46, s41, 0
    s_add_u32 s46, s46, s47
    buffer_load_dwordx4 v14, s[16:19], s46 offen lds
    s_add_u32 m0, s45, 58368
    s_add_u32 s46, s41, 49152
    s_add_u32 s46, s46, s47
    s_nop 0
    buffer_load_dwordx4 v15, s[16:19], s46 offen lds
    s_add_u32 m0, s45, 73728
    s_add_u32 s46, s41, 4096
    buffer_load_dwordx4 v14, s[16:19], s46 offen lds
    s_add_u32 m0, s45, 74752
    s_add_u32 s46, s41, 53248
    buffer_load_dwordx4 v15, s[16:19], s46 offen lds
    s_add_u32 m0, s44, 41984
    s_add_u32 s46, s40, 16384
    buffer_load_dwordx4 v13, s[12:15], s46 offen lds
    s_waitcnt vmcnt(8)
    s_barrier
    s_add_u32 m0, s44, 43008
    s_add_u32 s46, s40, 32768
    buffer_load_dwordx4 v12, s[12:15], s46 offen lds
    s_add_u32 m0, s44, 44032
    s_add_u32 s46, s40, 49152
    buffer_load_dwordx4 v13, s[12:15], s46 offen lds
    s_bfe_u32 s40, s48, 0x40008
    s_bitcmp1_b32 s40, 3
    s_cselect_b32 s41, s39, s42
    s_xor_b32 s40, s40, s41
    s_mul_i32 s41, s40, 393216
    s_add_u32 s41, s41, s38
    s_lshl_b32 s40, s40, 7
    s_add_u32 s40, s40, s36
    s_add_u32 m0, s44, 81920
    s_add_u32 s46, s40, 0
    s_nop 0
    buffer_load_dwordx4 v12, s[12:15], s46 offen lds
    s_add_u32 m0, s45, 106496
    s_add_u32 s46, s41, 2048
    buffer_load_dwordx4 v14, s[16:19], s46 offen lds
    s_add_u32 m0, s45, 107520
    s_add_u32 s46, s41, 51200
    buffer_load_dwordx4 v15, s[16:19], s46 offen lds
    s_add_u32 m0, s45, 98304
    s_add_u32 s46, s41, 0
    s_add_u32 s46, s46, s47
    buffer_load_dwordx4 v14, s[16:19], s46 offen lds
    s_add_u32 m0, s45, 99328
    s_add_u32 s46, s41, 49152
    s_add_u32 s46, s46, s47
    s_nop 0
    buffer_load_dwordx4 v15, s[16:19], s46 offen lds
    s_add_u32 m0, s45, 114688
    s_add_u32 s46, s41, 4096
    buffer_load_dwordx4 v14, s[16:19], s46 offen lds
    s_add_u32 m0, s45, 115712
    s_add_u32 s46, s41, 53248
    buffer_load_dwordx4 v15, s[16:19], s46 offen lds
    s_add_u32 m0, s44, 82944
    s_add_u32 s46, s40, 16384
    buffer_load_dwordx4 v13, s[12:15], s46 offen lds
    s_add_u32 m0, s44, 83968
    s_add_u32 s46, s40, 32768
    buffer_load_dwordx4 v12, s[12:15], s46 offen lds
    s_add_u32 m0, s44, 84992
    s_add_u32 s46, s40, 49152
    buffer_load_dwordx4 v13, s[12:15], s46 offen lds
    s_waitcnt vmcnt(10)
    s_barrier
    s_bfe_u32 s40, s48, 0x4000c
    s_bitcmp1_b32 s40, 3
    s_cselect_b32 s41, s39, s42
    s_xor_b32 s40, s40, s41
    s_mul_i32 s41, s40, 393216
    s_add_u32 s41, s41, s38
    s_lshl_b32 s40, s40, 7
    s_add_u32 s40, s40, s36
    s_add_u32 m0, s44, 122880
    s_add_u32 s46, s40, 0
    s_nop 0
    buffer_load_dwordx4 v12, s[12:15], s46 offen lds
    s_add_u32 m0, s45, 147456
    s_add_u32 s46, s41, 2048
    buffer_load_dwordx4 v14, s[16:19], s46 offen lds
    s_add_u32 m0, s45, 148480
    s_add_u32 s46, s41, 51200
    buffer_load_dwordx4 v15, s[16:19], s46 offen lds
    s_add_u32 m0, s45, 139264
    s_add_u32 s46, s41, 0
    s_add_u32 s46, s46, s47
    buffer_load_dwordx4 v14, s[16:19], s46 offen lds
    s_add_u32 m0, s45, 140288
    s_add_u32 s46, s41, 49152
    s_add_u32 s46, s46, s47
    s_nop 0
    buffer_load_dwordx4 v15, s[16:19], s46 offen lds
    s_add_u32 m0, s45, 155648
    s_add_u32 s46, s41, 4096
    buffer_load_dwordx4 v14, s[16:19], s46 offen lds
    s_add_u32 m0, s45, 156672
    s_add_u32 s46, s41, 53248
    buffer_load_dwordx4 v15, s[16:19], s46 offen lds
    s_add_u32 m0, s44, 123904
    s_add_u32 s46, s40, 16384
    buffer_load_dwordx4 v13, s[12:15], s46 offen lds
    s_add_u32 m0, s44, 124928
    s_add_u32 s46, s40, 32768
    buffer_load_dwordx4 v12, s[12:15], s46 offen lds
    s_add_u32 m0, s44, 125952
    s_add_u32 s46, s40, 49152
    buffer_load_dwordx4 v13, s[12:15], s46 offen lds
    s_bfe_u32 s40, s48, 0x40010
    s_bitcmp1_b32 s40, 3
    s_cselect_b32 s41, s39, s42
    s_xor_b32 s40, s40, s41
    s_mul_i32 s41, s40, 393216
    s_add_u32 s41, s41, s38
    s_lshl_b32 s40, s40, 7
    s_add_u32 s40, s40, s36
    s_add_u32 m0, s44, 0
    s_add_u32 s46, s40, 0
    buffer_load_dwordx4 v12, s[12:15], s46 offen lds
    s_add_u32 m0, s45, 24576
    s_add_u32 s46, s41, 2048
    buffer_load_dwordx4 v14, s[16:19], s46 offen lds
    s_waitcnt vmcnt(12)
    s_barrier
    s_add_u32 m0, s45, 25600
    s_add_u32 s46, s41, 51200
    buffer_load_dwordx4 v15, s[16:19], s46 offen lds
    s_add_u32 m0, s45, 16384
    s_add_u32 s46, s41, 0
    s_add_u32 s46, s46, s47
    buffer_load_dwordx4 v14, s[16:19], s46 offen lds
    s_add_u32 m0, s45, 17408
    s_add_u32 s46, s41, 49152
    s_add_u32 s46, s46, s47
    s_nop 0
    buffer_load_dwordx4 v15, s[16:19], s46 offen lds
    s_add_u32 m0, s45, 32768
    s_add_u32 s46, s41, 4096
    buffer_load_dwordx4 v14, s[16:19], s46 offen lds
    s_add_u32 m0, s45, 33792
    s_add_u32 s46, s41, 53248
    buffer_load_dwordx4 v15, s[16:19], s46 offen lds
    s_add_u32 m0, s44, 1024
    s_add_u32 s46, s40, 16384
    buffer_load_dwordx4 v13, s[12:15], s46 offen lds
    s_add_u32 m0, s44, 2048
    s_add_u32 s46, s40, 32768
    buffer_load_dwordx4 v12, s[12:15], s46 offen lds
    s_add_u32 m0, s44, 3072
    s_add_u32 s46, s40, 49152
    buffer_load_dwordx4 v13, s[12:15], s46 offen lds
    s_bfe_u32 s40, s48, 0x40014
    s_bitcmp1_b32 s40, 3
    s_cselect_b32 s41, s39, s42
    s_xor_b32 s40, s40, s41
    s_mul_i32 s41, s40, 393216
    s_add_u32 s41, s41, s38
    s_lshl_b32 s40, s40, 7
    s_add_u32 s40, s40, s36
    s_add_u32 m0, s44, 40960
    s_add_u32 s46, s40, 0
    s_nop 0
    buffer_load_dwordx4 v12, s[12:15], s46 offen lds
    s_add_u32 m0, s45, 65536
    s_add_u32 s46, s41, 2048
    buffer_load_dwordx4 v14, s[16:19], s46 offen lds
    s_add_u32 m0, s45, 66560
    s_add_u32 s46, s41, 51200
    buffer_load_dwordx4 v15, s[16:19], s46 offen lds
    s_add_u32 m0, s45, 57344
    s_add_u32 s46, s41, 0
    s_add_u32 s46, s46, s47
    buffer_load_dwordx4 v14, s[16:19], s46 offen lds
    s_waitcnt vmcnt(14)
    s_barrier
    s_add_u32 m0, s45, 58368
    s_add_u32 s46, s41, 49152
    s_add_u32 s46, s46, s47
    s_nop 0
    buffer_load_dwordx4 v15, s[16:19], s46 offen lds
    s_add_u32 m0, s45, 73728
    s_add_u32 s46, s41, 4096
    buffer_load_dwordx4 v14, s[16:19], s46 offen lds
    s_add_u32 m0, s45, 74752
    s_add_u32 s46, s41, 53248
    buffer_load_dwordx4 v15, s[16:19], s46 offen lds
    s_add_u32 m0, s44, 41984
    s_add_u32 s46, s40, 16384
    buffer_load_dwordx4 v13, s[12:15], s46 offen lds
    s_add_u32 m0, s44, 43008
    s_add_u32 s46, s40, 32768
    buffer_load_dwordx4 v12, s[12:15], s46 offen lds
    s_add_u32 m0, s44, 44032
    s_add_u32 s46, s40, 49152
    buffer_load_dwordx4 v13, s[12:15], s46 offen lds
    s_bfe_u32 s40, s48, 0x40018
    s_bitcmp1_b32 s40, 3
    s_cselect_b32 s41, s39, s42
    s_xor_b32 s40, s40, s41
    s_mul_i32 s41, s40, 393216
    s_add_u32 s41, s41, s38
    s_lshl_b32 s40, s40, 7
    s_add_u32 s40, s40, s36
    s_add_u32 m0, s44, 81920
    s_add_u32 s46, s40, 0
    s_nop 0
    buffer_load_dwordx4 v12, s[12:15], s46 offen lds
    s_add_u32 m0, s45, 106496
    s_add_u32 s46, s41, 2048
    buffer_load_dwordx4 v14, s[16:19], s46 offen lds
    s_add_u32 m0, s45, 107520
    s_add_u32 s46, s41, 51200
    buffer_load_dwordx4 v15, s[16:19], s46 offen lds
    s_add_u32 m0, s45, 98304
    s_add_u32 s46, s41, 0
    s_add_u32 s46, s46, s47
    buffer_load_dwordx4 v14, s[16:19], s46 offen lds
    s_add_u32 m0, s45, 99328
    s_add_u32 s46, s41, 49152
    s_add_u32 s46, s46, s47
    buffer_load_dwordx4 v15, s[16:19], s46 offen lds
    s_add_u32 m0, s45, 114688
    s_add_u32 s46, s41, 4096
    buffer_load_dwordx4 v14, s[16:19], s46 offen lds
    s_waitcnt vmcnt(16)
    s_barrier
    s_nop 0
    s_add_u32 m0, s45, 115712
    s_add_u32 s46, s41, 53248
    buffer_load_dwordx4 v15, s[16:19], s46 offen lds
    s_add_u32 m0, s44, 82944
    s_add_u32 s46, s40, 16384
    buffer_load_dwordx4 v13, s[12:15], s46 offen lds
    s_add_u32 m0, s44, 83968
    s_add_u32 s46, s40, 32768
    buffer_load_dwordx4 v12, s[12:15], s46 offen lds
    s_add_u32 m0, s44, 84992
    s_add_u32 s46, s40, 49152
    buffer_load_dwordx4 v13, s[12:15], s46 offen lds
    s_bfe_u32 s40, s48, 0x4001c
    s_bitcmp1_b32 s40, 3
    s_cselect_b32 s41, s39, s42
    s_xor_b32 s40, s40, s41
    s_mul_i32 s41, s40, 393216
    s_add_u32 s41, s41, s38
    s_lshl_b32 s40, s40, 7
    s_add_u32 s40, s40, s36
    s_add_u32 m0, s44, 122880
    s_add_u32 s46, s40, 0
    s_nop 0
    buffer_load_dwordx4 v12, s[12:15], s46 offen lds
    s_add_u32 m0, s45, 147456
    s_add_u32 s46, s41, 2048
    buffer_load_dwordx4 v14, s[16:19], s46 offen lds
    s_add_u32 m0, s45, 148480
    s_add_u32 s46, s41, 51200
    buffer_load_dwordx4 v15, s[16:19], s46 offen lds
    s_add_u32 m0, s45, 139264
    s_add_u32 s46, s41, 0
    s_add_u32 s46, s46, s47
    buffer_load_dwordx4 v14, s[16:19], s46 offen lds
    s_add_u32 m0, s45, 140288
    s_add_u32 s46, s41, 49152
    s_add_u32 s46, s46, s47
    s_nop 0
    buffer_load_dwordx4 v15, s[16:19], s46 offen lds
    s_add_u32 m0, s45, 155648
    s_add_u32 s46, s41, 4096
    buffer_load_dwordx4 v14, s[16:19], s46 offen lds
    s_add_u32 m0, s45, 156672
    s_add_u32 s46, s41, 53248
    buffer_load_dwordx4 v15, s[16:19], s46 offen lds
    s_add_u32 m0, s44, 123904
    s_add_u32 s46, s40, 16384
    buffer_load_dwordx4 v13, s[12:15], s46 offen lds
    s_waitcnt vmcnt(18)
    s_barrier
    s_add_u32 m0, s44, 124928
    s_add_u32 s46, s40, 32768
    buffer_load_dwordx4 v12, s[12:15], s46 offen lds
    s_add_u32 m0, s44, 125952
    s_add_u32 s46, s40, 49152
    buffer_load_dwordx4 v13, s[12:15], s46 offen lds
    s_bfe_u32 s40, s49, 0x40000
    s_bitcmp1_b32 s40, 3
    s_cselect_b32 s41, s39, s42
    s_xor_b32 s40, s40, s41
    s_mul_i32 s41, s40, 393216
    s_add_u32 s41, s41, s38
    s_lshl_b32 s40, s40, 7
    s_add_u32 s40, s40, s36
    s_add_u32 m0, s44, 0
    s_add_u32 s46, s40, 0
    buffer_load_dwordx4 v12, s[12:15], s46 offen lds
    s_add_u32 m0, s45, 24576
    s_add_u32 s46, s41, 2048
    buffer_load_dwordx4 v14, s[16:19], s46 offen lds
    s_add_u32 m0, s45, 25600
    s_add_u32 s46, s41, 51200
    buffer_load_dwordx4 v15, s[16:19], s46 offen lds
    s_add_u32 m0, s45, 16384
    s_add_u32 s46, s41, 0
    s_add_u32 s46, s46, s47
    buffer_load_dwordx4 v14, s[16:19], s46 offen lds
    s_add_u32 m0, s45, 17408
    s_add_u32 s46, s41, 49152
    s_add_u32 s46, s46, s47
    s_nop 0
    buffer_load_dwordx4 v15, s[16:19], s46 offen lds
    s_add_u32 m0, s45, 32768
    s_add_u32 s46, s41, 4096
    buffer_load_dwordx4 v14, s[16:19], s46 offen lds
    s_add_u32 m0, s45, 33792
    s_add_u32 s46, s41, 53248
    buffer_load_dwordx4 v15, s[16:19], s46 offen lds
    s_add_u32 m0, s44, 1024
    s_add_u32 s46, s40, 16384
    buffer_load_dwordx4 v13, s[12:15], s46 offen lds
    s_add_u32 m0, s44, 2048
    s_add_u32 s46, s40, 32768
    buffer_load_dwordx4 v12, s[12:15], s46 offen lds
    s_add_u32 m0, s44, 3072
    s_add_u32 s46, s40, 49152
    buffer_load_dwordx4 v13, s[12:15], s46 offen lds
    s_waitcnt vmcnt(20)
    s_barrier
    s_bfe_u32 s40, s49, 0x40004
    s_bitcmp1_b32 s40, 3
    s_cselect_b32 s41, s39, s42
    s_xor_b32 s40, s40, s41
    s_mul_i32 s41, s40, 393216
    s_add_u32 s41, s41, s38
    s_lshl_b32 s40, s40, 7
    s_add_u32 s40, s40, s36
    s_add_u32 m0, s44, 40960
    s_add_u32 s46, s40, 0
    s_nop 0
    buffer_load_dwordx4 v12, s[12:15], s46 offen lds
    s_add_u32 m0, s45, 65536
    s_add_u32 s46, s41, 2048
    buffer_load_dwordx4 v14, s[16:19], s46 offen lds
    s_add_u32 m0, s45, 66560
    s_add_u32 s46, s41, 51200
    buffer_load_dwordx4 v15, s[16:19], s46 offen lds
    s_add_u32 m0, s45, 57344
    s_add_u32 s46, s41, 0
    s_add_u32 s46, s46, s47
    buffer_load_dwordx4 v14, s[16:19], s46 offen lds
    s_add_u32 m0, s45, 58368
    s_add_u32 s46, s41, 49152
    s_add_u32 s46, s46, s47
    s_nop 0
    buffer_load_dwordx4 v15, s[16:19], s46 offen lds
    s_add_u32 m0, s45, 73728
    s_add_u32 s46, s41, 4096
    buffer_load_dwordx4 v14, s[16:19], s46 offen lds
    s_add_u32 m0, s45, 74752
    s_add_u32 s46, s41, 53248
    buffer_load_dwordx4 v15, s[16:19], s46 offen lds
    s_add_u32 m0, s44, 41984
    s_add_u32 s46, s40, 16384
    buffer_load_dwordx4 v13, s[12:15], s46 offen lds
    s_add_u32 m0, s44, 43008
    s_add_u32 s46, s40, 32768
    buffer_load_dwordx4 v12, s[12:15], s46 offen lds
    s_add_u32 m0, s44, 44032
    s_add_u32 s46, s40, 49152
    buffer_load_dwordx4 v13, s[12:15], s46 offen lds
    s_mov_b32 s20, s8
    s_mov_b32 s21, s9
    s_mov_b32 s22, 0x200000
    s_mov_b32 s23, 0x00020000
    s_lshl_b32 s50, s2, 13
    s_lshl_b32 s51, s3, 11
    s_add_u32 s50, s50, s51
    v_lshlrev_b32 v104, 7, v0
    s_mov_b64 exec, 0xffff
    buffer_load_dword v160, v104, s[20:23], s50 offen
    s_mov_b64 exec, -1

    s_waitcnt vmcnt(21)
    s_barrier
    s_bfe_u32 s40, s49, 0x40008
    s_bitcmp1_b32 s40, 3
    s_cselect_b32 s41, s39, s42
    s_xor_b32 s40, s40, s41
    s_mul_i32 s41, s40, 393216
    s_add_u32 s41, s41, s38
    s_lshl_b32 s40, s40, 7
    s_add_u32 s40, s40, s36
    s_add_u32 m0, s44, 81920
    s_add_u32 s46, s40, 0
    buffer_load_dwordx4 v12, s[12:15], s46 offen lds
    s_add_u32 m0, s45, 106496
    s_add_u32 s46, s41, 2048
    buffer_load_dwordx4 v14, s[16:19], s46 offen lds
    s_add_u32 m0, s45, 107520
    s_add_u32 s46, s41, 51200
    buffer_load_dwordx4 v15, s[16:19], s46 offen lds
    s_add_u32 m0, s45, 98304
    s_add_u32 s46, s41, 0
    s_add_u32 s46, s46, s47
    buffer_load_dwordx4 v14, s[16:19], s46 offen lds
    s_add_u32 m0, s45, 99328
    s_add_u32 s46, s41, 49152
    s_add_u32 s46, s46, s47
    s_nop 0
    buffer_load_dwordx4 v15, s[16:19], s46 offen lds
    s_add_u32 m0, s45, 114688
    s_add_u32 s46, s41, 4096
    buffer_load_dwordx4 v14, s[16:19], s46 offen lds
    s_add_u32 m0, s45, 115712
    s_add_u32 s46, s41, 53248
    buffer_load_dwordx4 v15, s[16:19], s46 offen lds
    s_add_u32 m0, s44, 82944
    s_add_u32 s46, s40, 16384
    buffer_load_dwordx4 v13, s[12:15], s46 offen lds
    s_add_u32 m0, s44, 83968
    s_add_u32 s46, s40, 32768
    buffer_load_dwordx4 v12, s[12:15], s46 offen lds
W_5:
    s_cbranch_execz R_5
    s_nop 0
    s_add_u32 m0, s44, 84992
    s_add_u32 s46, s40, 49152
    buffer_load_dwordx4 v13, s[12:15], s46 offen lds
    s_waitcnt vmcnt(21)
    s_barrier
    s_bfe_u32 s40, s49, 0x4000c
    s_bitcmp1_b32 s40, 3
    s_cselect_b32 s41, s39, s42
    s_xor_b32 s40, s40, s41
    s_mul_i32 s41, s40, 393216
    s_add_u32 s41, s41, s38
    s_lshl_b32 s40, s40, 7
    s_add_u32 s40, s40, s36
    s_add_u32 m0, s44, 122880
    s_add_u32 s46, s40, 0
    s_nop 0
    buffer_load_dwordx4 v12, s[12:15], s46 offen lds
    s_add_u32 m0, s45, 147456
    s_add_u32 s46, s41, 2048
    buffer_load_dwordx4 v14, s[16:19], s46 offen lds
    s_add_u32 m0, s45, 148480
    s_add_u32 s46, s41, 51200
    buffer_load_dwordx4 v15, s[16:19], s46 offen lds
    s_add_u32 m0, s45, 139264
    s_add_u32 s46, s41, 0
    s_add_u32 s46, s46, s47
    buffer_load_dwordx4 v14, s[16:19], s46 offen lds
    s_add_u32 m0, s45, 140288
    s_add_u32 s46, s41, 49152
    s_add_u32 s46, s46, s47
    s_nop 0
    buffer_load_dwordx4 v15, s[16:19], s46 offen lds
    s_add_u32 m0, s45, 155648
    s_add_u32 s46, s41, 4096
    buffer_load_dwordx4 v14, s[16:19], s46 offen lds
    s_add_u32 m0, s45, 156672
    s_add_u32 s46, s41, 53248
    buffer_load_dwordx4 v15, s[16:19], s46 offen lds
    s_add_u32 m0, s44, 123904
    s_add_u32 s46, s40, 16384
    buffer_load_dwordx4 v13, s[12:15], s46 offen lds
    s_add_u32 m0, s44, 124928
    s_add_u32 s46, s40, 32768
    buffer_load_dwordx4 v12, s[12:15], s46 offen lds
    s_add_u32 m0, s44, 125952
    s_add_u32 s46, s40, 49152
    buffer_load_dwordx4 v13, s[12:15], s46 offen lds
    s_waitcnt vmcnt(21)
    s_barrier
    s_bfe_u32 s40, s49, 0x40010
    s_bitcmp1_b32 s40, 3
    s_cselect_b32 s41, s39, s42
    s_xor_b32 s40, s40, s41
    s_mul_i32 s41, s40, 393216
    s_add_u32 s41, s41, s38
    s_lshl_b32 s40, s40, 7
    s_add_u32 s40, s40, s36
    s_add_u32 m0, s44, 0
    s_add_u32 s46, s40, 0
    buffer_load_dwordx4 v12, s[12:15], s46 offen lds
    s_add_u32 m0, s45, 24576
    s_add_u32 s46, s41, 2048
    buffer_load_dwordx4 v14, s[16:19], s46 offen lds
    s_add_u32 m0, s45, 25600
    s_add_u32 s46, s41, 51200
    buffer_load_dwordx4 v15, s[16:19], s46 offen lds
    s_add_u32 m0, s45, 16384
    s_add_u32 s46, s41, 0
    s_add_u32 s46, s46, s47
    buffer_load_dwordx4 v14, s[16:19], s46 offen lds
    s_add_u32 m0, s45, 17408
    s_add_u32 s46, s41, 49152
    s_add_u32 s46, s46, s47
    s_nop 0
    buffer_load_dwordx4 v15, s[16:19], s46 offen lds
    s_add_u32 m0, s45, 32768
    s_add_u32 s46, s41, 4096
    buffer_load_dwordx4 v14, s[16:19], s46 offen lds
    s_add_u32 m0, s45, 33792
    s_add_u32 s46, s41, 53248
    buffer_load_dwordx4 v15, s[16:19], s46 offen lds
    s_add_u32 m0, s44, 1024
    s_add_u32 s46, s40, 16384
    buffer_load_dwordx4 v13, s[12:15], s46 offen lds
    s_add_u32 m0, s44, 2048
    s_add_u32 s46, s40, 32768
    buffer_load_dwordx4 v12, s[12:15], s46 offen lds
    s_add_u32 m0, s44, 3072
    s_add_u32 s46, s40, 49152
    buffer_load_dwordx4 v13, s[12:15], s46 offen lds
    s_waitcnt vmcnt(20)
    s_barrier
    s_bfe_u32 s40, s49, 0x40014
    s_bitcmp1_b32 s40, 3
    s_cselect_b32 s41, s39, s42
    s_xor_b32 s40, s40, s41
    s_mul_i32 s41, s40, 393216
    s_add_u32 s41, s41, s38
    s_lshl_b32 s40, s40, 7
    s_add_u32 s40, s40, s36
    s_add_u32 m0, s44, 40960
    s_add_u32 s46, s40, 0
    s_nop 0
    buffer_load_dwordx4 v12, s[12:15], s46 offen lds
    s_add_u32 m0, s45, 65536
    s_add_u32 s46, s41, 2048
    buffer_load_dwordx4 v14, s[16:19], s46 offen lds
    s_add_u32 m0, s45, 66560
    s_add_u32 s46, s41, 51200
    buffer_load_dwordx4 v15, s[16:19], s46 offen lds
    s_add_u32 m0, s45, 57344
    s_add_u32 s46, s41, 0
    s_add_u32 s46, s46, s47
    buffer_load_dwordx4 v14, s[16:19], s46 offen lds
    s_add_u32 m0, s45, 58368
    s_add_u32 s46, s41, 49152
    s_add_u32 s46, s46, s47
    s_nop 0
    buffer_load_dwordx4 v15, s[16:19], s46 offen lds
    s_add_u32 m0, s45, 73728
    s_add_u32 s46, s41, 4096
    buffer_load_dwordx4 v14, s[16:19], s46 offen lds
    s_add_u32 m0, s45, 74752
    s_add_u32 s46, s41, 53248
    buffer_load_dwordx4 v15, s[16:19], s46 offen lds
    s_add_u32 m0, s44, 41984
    s_add_u32 s46, s40, 16384
    buffer_load_dwordx4 v13, s[12:15], s46 offen lds
    s_add_u32 m0, s44, 43008
    s_add_u32 s46, s40, 32768
    buffer_load_dwordx4 v12, s[12:15], s46 offen lds
    s_add_u32 m0, s44, 44032
    s_add_u32 s46, s40, 49152
    buffer_load_dwordx4 v13, s[12:15], s46 offen lds
    v_lshlrev_b32_e64 v10, 4, v0
    s_add_u32 s68, s72, 0x900000
    s_addc_u32 s69, s73, 0
    s_mov_b32 s70, 0x18000
    s_mov_b32 s71, 0x00020000
    s_lshl_b32 s52, s32, 11
    s_add_u32 s52, s52, 65536
    s_lshl_b32 s76, s3, 2
    s_add_u32 s52, s52, s76
    s_lshl_b32 s76, s3, 9
    s_add_u32 s58, s76, 24832

    s_waitcnt vmcnt(20)
    s_barrier
    s_bfe_u32 s40, s49, 0x40018
    s_bitcmp1_b32 s40, 3
    s_cselect_b32 s41, s39, s42
    s_xor_b32 s40, s40, s41
    s_mul_i32 s41, s40, 393216
    s_add_u32 s41, s41, s38
    s_lshl_b32 s40, s40, 7
    s_add_u32 s40, s40, s36
    s_add_u32 m0, s44, 81920
    s_add_u32 s46, s40, 0
    buffer_load_dwordx4 v12, s[12:15], s46 offen lds
    s_add_u32 m0, s45, 106496
    s_add_u32 s46, s41, 2048
    buffer_load_dwordx4 v14, s[16:19], s46 offen lds
    s_add_u32 m0, s45, 107520
    s_add_u32 s46, s41, 51200
    buffer_load_dwordx4 v15, s[16:19], s46 offen lds
    s_add_u32 m0, s45, 98304
    s_add_u32 s46, s41, 0
    s_add_u32 s46, s46, s47
    buffer_load_dwordx4 v14, s[16:19], s46 offen lds
    s_add_u32 m0, s45, 99328
    s_add_u32 s46, s41, 49152
    s_add_u32 s46, s46, s47
    s_nop 0
    buffer_load_dwordx4 v15, s[16:19], s46 offen lds
    s_add_u32 m0, s45, 114688
    s_add_u32 s46, s41, 4096
    buffer_load_dwordx4 v14, s[16:19], s46 offen lds
    s_add_u32 m0, s45, 115712
    s_add_u32 s46, s41, 53248
    buffer_load_dwordx4 v15, s[16:19], s46 offen lds
    s_add_u32 m0, s44, 82944
    s_add_u32 s46, s40, 16384
    buffer_load_dwordx4 v13, s[12:15], s46 offen lds
    s_add_u32 m0, s44, 83968
    s_add_u32 s46, s40, 32768
    buffer_load_dwordx4 v12, s[12:15], s46 offen lds
    s_add_u32 m0, s44, 84992
    s_add_u32 s46, s40, 49152
    buffer_load_dwordx4 v13, s[12:15], s46 offen lds
    s_add_u32 s84, s72, 0xb00000
    s_addc_u32 s85, s73, 0
    s_mov_b32 s86, 0x30000
    s_mov_b32 s87, 0x00020000
    v_bfe_u32 v113, v0, 2, 2
    v_min_u32 v113, 2, v113
    v_lshlrev_b32 v114, 8, v113
    v_lshlrev_b32 v113, 12, v113
    v_and_b32 v112, 3, v0
    v_lshl_add_u32 v113, v112, 4, v113
    v_lshl_add_u32 v114, v112, 4, v114
    v_lshrrev_b32 v112, 4, v0
    v_mul_u32_u24 v112, 12288, v112
    v_add_u32 v113, v113, v112
    s_lshl_b32 s76, s3, 6
    s_lshl_b32 s53, s33, 8
    s_add_u32 s53, s53, s76
    s_add_u32 s76, s76, 26368
    v_add_u32 v114, s76, v114

    s_waitcnt vmcnt(20)
    s_barrier
    s_bfe_u32 s40, s49, 0x4001c
    s_bitcmp1_b32 s40, 3
    s_cselect_b32 s41, s39, s42
    s_xor_b32 s40, s40, s41
    s_mul_i32 s41, s40, 393216
    s_add_u32 s41, s41, s38
    s_lshl_b32 s40, s40, 7
    s_add_u32 s40, s40, s36
    s_add_u32 m0, s44, 122880
    s_add_u32 s46, s40, 0
    buffer_load_dwordx4 v12, s[12:15], s46 offen lds
    s_add_u32 m0, s45, 147456
    s_add_u32 s46, s41, 2048
    buffer_load_dwordx4 v14, s[16:19], s46 offen lds
    s_add_u32 m0, s45, 148480
    s_add_u32 s46, s41, 51200
    buffer_load_dwordx4 v15, s[16:19], s46 offen lds
    s_add_u32 m0, s45, 139264
    s_add_u32 s46, s41, 0
    s_add_u32 s46, s46, s47
    buffer_load_dwordx4 v14, s[16:19], s46 offen lds
    s_add_u32 m0, s45, 140288
    s_add_u32 s46, s41, 49152
    s_add_u32 s46, s46, s47
    s_nop 0
    buffer_load_dwordx4 v15, s[16:19], s46 offen lds
    s_add_u32 m0, s45, 155648
    s_add_u32 s46, s41, 4096
    buffer_load_dwordx4 v14, s[16:19], s46 offen lds
    s_add_u32 m0, s45, 156672
    s_add_u32 s46, s41, 53248
    buffer_load_dwordx4 v15, s[16:19], s46 offen lds
    s_add_u32 m0, s44, 123904
    s_add_u32 s46, s40, 16384
    buffer_load_dwordx4 v13, s[12:15], s46 offen lds
    s_add_u32 m0, s44, 124928
    s_add_u32 s46, s40, 32768
    buffer_load_dwordx4 v12, s[12:15], s46 offen lds
    s_add_u32 m0, s44, 125952
    s_add_u32 s46, s40, 49152
    buffer_load_dwordx4 v13, s[12:15], s46 offen lds
    s_add_u32 s76, s53, 0
    s_nop 0
    buffer_load_dwordx4 v[72:75], v113, s[84:87], s76 offen sc0 sc1
    s_add_u32 s76, s53, 49152
    buffer_load_dwordx4 v[76:79], v113, s[84:87], s76 offen sc0 sc1
    s_add_u32 s76, s53, 98304
    buffer_load_dwordx4 v[80:83], v113, s[84:87], s76 offen sc0 sc1
    s_add_u32 s76, s53, 147456
    buffer_load_dwordx4 v[84:87], v113, s[84:87], s76 offen sc0 sc1
    s_mov_b32 m0, s58
    s_setprio 3
    s_waitcnt vmcnt(24)
    s_barrier
    s_cmp_eq_u32 s3, 3
    s_cbranch_scc1 F_d0
    buffer_load_dword v10, s[68:71], s52 offen sc0 sc1 lds
    s_add_u32 m0, m0, 256
    s_add_u32 s52, s52, 1024
    buffer_load_dword v10, s[68:71], s52 offen sc0 sc1 lds
    s_branch F_d1
F_d0:
    s_nop 0
    s_mov_b32 m0, 24576
    s_mov_b32 s52, 0x7ff00000
    s_mov_b64 exec, 0xfff
    buffer_load_dwordx4 v10, s[84:87], s52 offen lds
    buffer_load_dwordx4 v10, s[84:87], s52 offen lds
    s_mov_b64 exec, -1
F_d1:

    s_setprio 0
    s_waitcnt vmcnt(16)
    s_barrier
    s_waitcnt vmcnt(2)
F_cs0:
    v_min3_u32 v96, v72, v76, v80
    v_min_u32 v96, v96, v84
    v_cmp_eq_u32 vcc, 0, v96
    s_cbranch_vccz F_cs1
    s_sleep 8

    s_add_u32 s76, s53, 0
    buffer_load_dwordx4 v[72:75], v113, s[84:87], s76 offen sc0 sc1
    s_add_u32 s76, s53, 49152
    buffer_load_dwordx4 v[76:79], v113, s[84:87], s76 offen sc0 sc1
    s_add_u32 s76, s53, 98304
    buffer_load_dwordx4 v[80:83], v113, s[84:87], s76 offen sc0 sc1
    s_add_u32 s76, s53, 147456
    buffer_load_dwordx4 v[84:87], v113, s[84:87], s76 offen sc0 sc1
    s_waitcnt vmcnt(0)
    s_branch F_cs0
F_cs1:
    v_add_f32 v72, v72, v76
    v_add_f32 v80, v80, v84
    v_add_f32 v73, v73, v77
    v_add_f32 v81, v81, v85
    v_add_f32 v74, v74, v78
    v_add_f32 v82, v82, v86
    v_add_f32 v75, v75, v79
    v_add_f32 v83, v83, v87
    v_add_f32 v72, v72, v80
    v_add_f32 v73, v73, v81
    v_add_f32 v74, v74, v82
    v_add_f32 v75, v75, v83
    v_mov_b32 v76, v72
    v_mov_b32 v77, v73
    v_mov_b32 v78, v74
    v_mov_b32 v79, v75
    v_permlane32_swap_b32 v72, v76
    v_permlane32_swap_b32 v73, v77
    v_permlane32_swap_b32 v74, v78
    v_permlane32_swap_b32 v75, v79
    v_add_f32 v72, v72, v76
    v_add_f32 v73, v73, v77
    v_add_f32 v74, v74, v78
    v_add_f32 v75, v75, v79
    v_mov_b32 v76, v72
    v_mov_b32 v77, v73
    v_mov_b32 v78, v74
    v_mov_b32 v79, v75
    v_permlane16_swap_b32 v72, v76
    v_permlane16_swap_b32 v73, v77
    v_permlane16_swap_b32 v74, v78
    v_permlane16_swap_b32 v75, v79
    v_add_f32 v72, v72, v76
    v_add_f32 v73, v73, v77
    v_add_f32 v74, v74, v78
    v_add_f32 v75, v75, v79
    s_mov_b64 exec, 0xfff
    ds_write_b128 v114, v[72:75]
    s_mov_b64 exec, -1
    s_waitcnt lgkmcnt(0)

    s_waitcnt vmcnt(0)
    s_barrier
    s_add_u32 s24, s72, 0x800000
    s_addc_u32 s25, s73, 0
    s_mov_b32 s26, 0x100000
    s_mov_b32 s27, 0x00020000
    s_add_u32 s12, s72, 0x400000
    s_addc_u32 s13, s73, 0
    s_mov_b32 s14, 0x400000
    s_mov_b32 s15, 0x00020000
    s_mov_b32 s16, s8
    s_mov_b32 s17, s9
    s_mov_b32 s18, 0x200000
    s_mov_b32 s19, 0x00020000
    v_lshrrev_b32 v4, 4, v0
    v_and_b32 v3, 15, v0
    v_lshlrev_b32 v6, 1, v4
    v_xor_b32 v8, v3, v6
    v_xor_b32 v9, 8, v8
    v_lshlrev_b32 v8, 4, v8
    v_lshlrev_b32_e64 v9, 4, v9
    v_lshl_add_u32 v8, v4, 11, v8
    v_lshl_add_u32 v9, v4, 11, v9
    s_lshl_b32 s38, s29, 8
    s_lshl_b32 s45, s3, 15
    s_add_u32 s38, s38, s45
    s_lshl_b32 s45, s3, 12

    s_mov_b32 s48, 0x76543210
    s_mov_b32 s49, 0xfedcba98
    s_bitcmp1_b32 0x92, s35
    s_cselect_b32 s48, 0xba983210, s48
    s_cselect_b32 s49, 0x7654fedc, s49
    s_bitcmp1_b32 0x24, s35
    s_cselect_b32 s48, 0xfedc3210, s48
    s_cselect_b32 s49, 0xba987654, s49
    s_lshr_b32 s36, s3, 1
    s_and_b32 s37, s3, 1
    s_lshl_b32 s43, s36, 6
    s_lshl_b32 s42, s33, 1
    s_add_u32 s42, s42, s37
    s_mul_i32 s82, s42, 4224
    s_add_u32 s83, s82, 4096
    s_add_u32 s83, s83, s43
    s_lshl_b32 s44, s36, 11
    s_add_u32 s82, s82, s44
    s_mul_i32 s51, s42, 16*64
    s_add_u32 s51, s51, 192512
    s_lshl_b32 s42, s10, 1
    s_add_u32 s42, s42, s37
    s_lshl_b32 s50, s42, 4
    s_add_u32 s50, s50, s32
    s_lshl_b32 s50, s50, 6
    v_lshlrev_b32 v10, 4, v0
    v_lshlrev_b32 v11, 2, v0
    s_lshl_b32 s42, s3, 2
    s_add_u32 s42, s42, 24640
    v_mov_b32 v1, s42
    v_and_b32 v2, 3, v0
    v_lshlrev_b32 v2, 2, v2
    v_add_u32 v2, 24640, v2
    v_and_b32 v105, 1, v0
    v_lshlrev_b32 v105, 3, v105
    s_lshl_b32 s42, s37, 2
    s_add_u32 s42, s42, 24640
    v_add_u32 v105, s42, v105
    s_lshl_b32 s42, s37, 12
    s_add_u32 s42, s42, s44
    s_add_u32 s42, s42, 65536
    v_add_u32 v106, s42, v11
    s_lshl_b32 s42, s37, 7
    s_add_u32 s42, s42, s43
    s_add_u32 s42, s42, 27136
    v_add_u32 v107, s42, v11
    v_mul_u32_u24 v108, 64*16/4, v0
    v_mov_b32 v109, 1
    s_mov_b32 s60, 0
    s_mov_b32 s62, 0xa001024
    s_mov_b32 s63, 0x1a1e14
    s_lshl_b32 s36, s28, 2
    s_add_u32 s36, s36, s3
    s_lshl_b32 s36, s36, 15
    s_lshl_b32 s44, s3, 11
    s_lshl_b32 s50, s28, 3
    s_and_b32 s76, s29, 4-1
    s_mul_i32 s76, s76, 8/4
    s_add_u32 s50, s50, s76
    s_mul_i32 s50, s50, 64
    s_add_u32 s78, s50, 0x837000
    s_add_u32 s78, s72, s78
    s_addc_u32 s79, s73, 0
    s_setprio 3
    s_sleep 10
    s_lshr_b32 s56, s3, 1
    s_add_u32 s56, s56, 1
    ds_read_b32 v114, v105
FW_9:
    s_waitcnt lgkmcnt(0)
    v_cmp_gt_u32 vcc, s56, v114
    s_cbranch_vccz FO_10
    s_sleep 1
    ds_read_b32 v114, v105
    s_branch FW_9
FO_10:
    ds_read2st64_b32 v[12:13], v106 offset0:0 offset1:1
    ds_read2st64_b32 v[20:21], v106 offset0:32 offset1:33
    ds_read2st64_b32 v[14:15], v106 offset0:2 offset1:3
    ds_read2st64_b32 v[22:23], v106 offset0:34 offset1:35
    ds_read2st64_b32 v[16:17], v106 offset0:4 offset1:5
    ds_read2st64_b32 v[24:25], v106 offset0:36 offset1:37
    ds_read2st64_b32 v[18:19], v106 offset0:6 offset1:7
    ds_read2st64_b32 v[26:27], v106 offset0:38 offset1:39
    ds_read2st64_b32 v[28:29], v107 offset0:0 offset1:1
    s_waitcnt lgkmcnt(7)
    v_add_f32 v12, v12, v20
    buffer_atomic_add_f32 v12, v11, s[24:27], s82 offen offset:0
    v_add_f32 v13, v13, v21
    buffer_atomic_add_f32 v13, v11, s[24:27], s82 offen offset:256
    s_waitcnt lgkmcnt(5)
    v_add_f32 v14, v14, v22
    buffer_atomic_add_f32 v14, v11, s[24:27], s82 offen offset:512
    v_add_f32 v15, v15, v23
    buffer_atomic_add_f32 v15, v11, s[24:27], s82 offen offset:768
    s_waitcnt lgkmcnt(3)
    v_add_f32 v16, v16, v24
    buffer_atomic_add_f32 v16, v11, s[24:27], s82 offen offset:1024
    v_add_f32 v17, v17, v25
    buffer_atomic_add_f32 v17, v11, s[24:27], s82 offen offset:1280
    s_waitcnt lgkmcnt(1)
    v_add_f32 v18, v18, v26
    buffer_atomic_add_f32 v18, v11, s[24:27], s82 offen offset:1536
    v_add_f32 v19, v19, v27
    buffer_atomic_add_f32 v19, v11, s[24:27], s82 offen offset:1792
    s_waitcnt lgkmcnt(0)
    v_add_f32 v28, v28, v29
    s_mov_b64 exec, 0xffff
    buffer_atomic_add_f32 v28, v11, s[24:27], s83 offen
    s_mov_b64 exec, -1
    v_mov_b32 v113, 1
    s_mov_b64 exec, 1
    ds_write_b32 v1, v113 offset:32
    s_mov_b64 exec, -1
    s_add_u32 s54, s51, 0x800000
    s_add_u32 s54, s72, s54
    s_addc_u32 s55, s73, 0
    s_mov_b32 s57, 1
    s_waitcnt vmcnt(4)
    ds_read2_b32 v[102:103], v2 offset0:0 offset1:8
    ds_read_b32 v104, v2 offset:16
    s_waitcnt lgkmcnt(0)
    v_cmp_ne_u32 vcc, 3, v102
    v_cmp_eq_u32 s[42:43], 0, v103
    s_nop 0
    s_or_b64 vcc, vcc, s[42:43]
    v_cmp_gt_u32 s[42:43], 2, v104
    s_nop 0
    s_or_b64 vcc, vcc, s[42:43]
    s_waitcnt vmcnt(0)
    s_atomic_add s57, s[54:55], 0
    s_atomic_add s57, s[54:55], 256
    s_atomic_add s57, s[54:55], 512
    s_atomic_add s57, s[54:55], 768
    s_cbranch_vccnz F_pe
    s_bfe_u32 s41, s48, 0x40000
    s_xor_b32 s41, s41, s10
    s_lshl_b32 s41, s41, 17
    s_add_u32 s41, s41, s38
    s_add_u32 m0, s45, 147456
    s_add_u32 s76, s41, 0
    buffer_load_dwordx4 v8, s[16:19], s76 offen lds
    s_add_u32 m0, s45, 148480
    s_add_u32 s76, s41, 8192
    buffer_load_dwordx4 v9, s[16:19], s76 offen lds
    s_add_u32 m0, s45, 149504
    s_add_u32 s76, s41, 16384
    buffer_load_dwordx4 v8, s[16:19], s76 offen lds
    s_add_u32 m0, s45, 150528
    s_add_u32 s76, s41, 24576
    buffer_load_dwordx4 v9, s[16:19], s76 offen lds
    s_bfe_u32 s41, s48, 0x40004
    s_xor_b32 s41, s41, s10
    s_lshl_b32 s41, s41, 17
    s_add_u32 s41, s41, s38
    s_add_u32 m0, s45, 65536
    s_add_u32 s76, s41, 0
    buffer_load_dwordx4 v8, s[16:19], s76 offen lds
    s_add_u32 m0, s45, 66560
    s_add_u32 s76, s41, 8192
    buffer_load_dwordx4 v9, s[16:19], s76 offen lds
    s_add_u32 m0, s45, 67584
    s_add_u32 s76, s41, 16384
    buffer_load_dwordx4 v8, s[16:19], s76 offen lds
    s_add_u32 m0, s45, 68608
    s_add_u32 s76, s41, 24576
    buffer_load_dwordx4 v9, s[16:19], s76 offen lds
    s_mov_b32 s60, 2
F_pe:
    s_setprio 1
F_pr0:
    s_waitcnt vmcnt(8)
    ds_read2_b32 v[102:103], v2 offset0:0 offset1:8
    s_cmp_lt_u32 s60, 2
    s_cselect_b32 s61, 1, 3
    s_waitcnt lgkmcnt(0)
    v_cmp_le_u32 vcc, 4, v102
    s_cbranch_vccz F_pr3
    s_mov_b32 s61, 5
F_pr3:
    v_cmp_gt_u32 vcc, s61, v102
    v_cmp_gt_u32 s[42:43], 1, v103
    s_nop 0
    s_or_b64 vcc, vcc, s[42:43]
    s_cbranch_vccz F_pr2
    s_sleep 2
    s_branch F_pr0
F_pr2:
    s_cmp_lt_u32 s60, 6
    s_cbranch_scc1 F_pr4
    ds_read_b32 v102, v2 offset:16
    s_waitcnt lgkmcnt(0)
    v_cmp_gt_u32 vcc, 2, v102
    s_cbranch_vccz F_pr4
    s_sleep 2
    s_branch F_pr0
F_pr4:
    s_cmp_lg_u32 s60, 4
    s_cbranch_scc1 F_pr6
    s_waitcnt vmcnt(4)
    v_mov_b32_e64 v113, 2
    s_mov_b64 exec, 1
    ds_write_b32 v1, v113 offset:32
    s_mov_b64 exec, -1
F_pr6:
    s_lshl_b32 s41, s60, 2
    s_lshr_b32 s41, s48, s41
    s_and_b32 s41, s41, 15
    s_xor_b32 s41, s41, s10
    s_lshl_b32 s41, s41, 17
    s_add_u32 s41, s41, s38
    s_lshl_b32 s76, s60, 3
    s_lshr_b64 s[42:43], s[62:63], s76
    s_and_b32 s42, s42, 0xff
    s_lshl_b32 s42, s42, 12
    s_add_u32 m0, s42, s45
    s_add_u32 s60, s60, 1
    buffer_load_dwordx4 v8, s[16:19], s41 offen lds
    s_add_u32 m0, m0, 1024
    s_add_u32 s41, s41, 8192
    buffer_load_dwordx4 v9, s[16:19], s41 offen lds
    s_add_u32 m0, m0, 1024
    s_add_u32 s41, s41, 8192
    buffer_load_dwordx4 v8, s[16:19], s41 offen lds
    s_add_u32 m0, m0, 1024
    s_add_u32 s41, s41, 8192
    buffer_load_dwordx4 v9, s[16:19], s41 offen lds
    s_cmp_ge_u32 s60, 7
    s_cbranch_scc1 F_pr1
    s_cmp_eq_u32 s61, 5
    s_cbranch_scc1 F_pr2
    s_branch F_pr0
F_pr1:
    s_cmp_lg_u32 s3, 0
    s_cbranch_scc1 F_l4
SP_11:
    s_load_dword s58, s[78:79], 0 glc
    s_waitcnt lgkmcnt(0)
    s_cmp_ge_u32 s58, 32
    s_cbranch_scc1 SD_12
    s_sleep 1
    s_branch SP_11
SD_12:
F_l6:
    v_mov_b32 v113, 3
    s_mov_b64 exec, 1
    ds_write_b32 v1, v113 offset:112
    s_mov_b64 exec, -1
    s_branch F_l5
F_l4:
    v_mov_b32 v4, 24752
    ds_read_b32 v13, v4
FW_13:
    s_waitcnt lgkmcnt(0)
    v_cmp_gt_u32 vcc, 3, v13
    s_cbranch_vccz FO_14
    s_sleep 1
    ds_read_b32 v13, v4
    s_branch FW_13
FO_14:
F_l5:
    s_bfe_u32 s40, s48, 0x40004
    s_xor_b32 s40, s40, s10
    s_lshl_b32 s40, s40, 11
    s_add_u32 s40, s40, s36
    s_add_u32 m0, s44, 16384
    s_nop 0
    buffer_load_dwordx4 v10, s[12:15], s40 offen offset:0 sc1 lds
    s_add_u32 m0, s44, 16384
    s_nop 0
    buffer_load_dwordx4 v10, s[12:15], s40 offen offset:1024 sc1 lds
    s_bfe_u32 s40, s48, 0x40008
    s_xor_b32 s40, s40, s10
    s_lshl_b32 s40, s40, 11
    s_add_u32 s40, s40, s36
    s_add_u32 m0, s44, 98304
    s_nop 0
    buffer_load_dwordx4 v10, s[12:15], s40 offen offset:0 sc1 lds
    s_add_u32 m0, s44, 98304
    s_nop 0
    buffer_load_dwordx4 v10, s[12:15], s40 offen offset:1024 sc1 lds
    ds_read_b32 v102, v2
FW_15:
    s_waitcnt lgkmcnt(0)
    v_cmp_gt_u32_e64 vcc, 7, v102
    s_cbranch_vccz FO_16
    s_sleep 1
    ds_read_b32 v102, v2
    s_branch FW_15
FO_16:
    s_bfe_u32 s40, s48, 0x4000c
    s_xor_b32 s40, s40, s10
    s_lshl_b32 s40, s40, 11
    s_add_u32 s40, s40, s36
    s_add_u32 m0, s44, 139264
    s_nop 0
    buffer_load_dwordx4 v10, s[12:15], s40 offen offset:0 sc1 lds
    s_add_u32 m0, s44, 139264
    s_nop 0
    buffer_load_dwordx4 v10, s[12:15], s40 offen offset:1024 sc1 lds
    s_bfe_u32 s41, s48, 0x4001c
    s_xor_b32 s41, s41, s10
    s_lshl_b32 s41, s41, 17
    s_add_u32 s41, s41, s38
    s_add_u32 m0, s45, 147456
    s_add_u32 s76, s41, 0
    buffer_load_dwordx4 v8, s[16:19], s76 offen lds
    s_add_u32 m0, s45, 148480
    s_add_u32 s76, s41, 8192
    buffer_load_dwordx4 v9, s[16:19], s76 offen lds
    s_add_u32 m0, s45, 149504
    s_add_u32 s76, s41, 16384
    buffer_load_dwordx4 v8, s[16:19], s76 offen lds
    s_add_u32 m0, s45, 150528
    s_add_u32 s76, s41, 24576
    buffer_load_dwordx4 v9, s[16:19], s76 offen lds
    s_waitcnt vmcnt(8)
    s_barrier
    s_bfe_u32 s40, s48, 0x40010
    s_xor_b32 s40, s40, s10
    s_lshl_b32 s40, s40, 11
    s_add_u32 s40, s40, s36
    s_add_u32 m0, s44, 57344
    s_nop 0
    buffer_load_dwordx4 v10, s[12:15], s40 offen offset:0 sc1 lds
    s_add_u32 m0, s44, 57344
    s_nop 0
    buffer_load_dwordx4 v10, s[12:15], s40 offen offset:1024 sc1 lds
    s_bfe_u32 s41, s49, 0x40000
    s_xor_b32 s41, s41, s10
    s_lshl_b32 s41, s41, 17
    s_add_u32 s41, s41, s38
    s_add_u32 m0, s45, 65536
    s_add_u32 s76, s41, 0
    buffer_load_dwordx4 v8, s[16:19], s76 offen lds
    s_add_u32 m0, s45, 66560
    s_add_u32 s76, s41, 8192
    buffer_load_dwordx4 v9, s[16:19], s76 offen lds
W_6:
    s_cbranch_execz R_6
    s_nop 0
    s_setprio 0
    s_waitcnt vmcnt(10)
    s_barrier
    s_bfe_u32 s40, s48, 0x40014
    s_xor_b32 s40, s40, s10
    s_lshl_b32 s40, s40, 11
    s_add_u32 s40, s40, s36
    s_add_u32 m0, s44, 16384
    s_nop 0
    buffer_load_dwordx4 v10, s[12:15], s40 offen offset:0 sc1 lds
    s_add_u32 m0, s44, 16384
    s_nop 0
    s_nop 0
    buffer_load_dwordx4 v10, s[12:15], s40 offen offset:1024 sc1 lds
    s_add_u32 m0, s45, 67584
    s_add_u32 s76, s41, 16384
    buffer_load_dwordx4 v8, s[16:19], s76 offen lds
    s_add_u32 m0, s45, 68608
    s_add_u32 s76, s41, 24576
    buffer_load_dwordx4 v9, s[16:19], s76 offen lds
    s_bfe_u32 s41, s49, 0x40004
    s_xor_b32 s41, s41, s10
    s_lshl_b32 s41, s41, 17
    s_add_u32 s41, s41, s38
    s_add_u32 m0, s45, 0
    s_add_u32 s76, s41, 0
    buffer_load_dwordx4 v8, s[16:19], s76 offen lds
    s_waitcnt vmcnt(13)
    s_barrier
    s_bfe_u32 s40, s48, 0x40018
    s_xor_b32 s40, s40, s10
    s_lshl_b32 s40, s40, 11
    s_add_u32 s40, s40, s36
    s_add_u32 m0, s44, 98304
    s_nop 0
    buffer_load_dwordx4 v10, s[12:15], s40 offen offset:0 sc1 lds
    s_add_u32 m0, s44, 98304
    s_nop 0
    buffer_load_dwordx4 v10, s[12:15], s40 offen offset:1024 sc1 lds
    s_add_u32 m0, s45, 1024
    s_add_u32 s76, s41, 8192
    buffer_load_dwordx4 v9, s[16:19], s76 offen lds
    s_add_u32 m0, s45, 2048
    s_add_u32 s76, s41, 16384
    buffer_load_dwordx4 v8, s[16:19], s76 offen lds
    s_add_u32 m0, s45, 3072
    s_add_u32 s76, s41, 24576
    buffer_load_dwordx4 v9, s[16:19], s76 offen lds
    s_waitcnt vmcnt(12)
    s_barrier
    s_bfe_u32 s40, s48, 0x4001c
    s_xor_b32 s40, s40, s10
    s_lshl_b32 s40, s40, 11
    s_add_u32 s40, s40, s36
    s_add_u32 m0, s44, 139264
    s_nop 0
    buffer_load_dwordx4 v10, s[12:15], s40 offen offset:0 sc1 lds
    s_add_u32 m0, s44, 139264
    s_nop 0
    buffer_load_dwordx4 v10, s[12:15], s40 offen offset:1024 sc1 lds
    s_bfe_u32 s41, s49, 0x40008
    s_xor_b32 s41, s41, s10
    s_lshl_b32 s41, s41, 17
    s_add_u32 s41, s41, s38
    s_add_u32 m0, s45, 40960
    s_add_u32 s76, s41, 0
    s_nop 0
    buffer_load_dwordx4 v8, s[16:19], s76 offen lds
    s_add_u32 m0, s45, 41984
    s_add_u32 s76, s41, 8192
    buffer_load_dwordx4 v9, s[16:19], s76 offen lds
    s_add_u32 m0, s45, 43008
    s_add_u32 s76, s41, 16384
    buffer_load_dwordx4 v8, s[16:19], s76 offen lds
    s_waitcnt vmcnt(13)
    s_barrier
    s_bfe_u32 s40, s49, 0x40000
    s_xor_b32 s40, s40, s10
    s_lshl_b32 s40, s40, 11
    s_add_u32 s40, s40, s36
    s_add_u32 m0, s44, 57344
    s_nop 0
    buffer_load_dwordx4 v10, s[12:15], s40 offen offset:0 sc1 lds
    s_add_u32 m0, s44, 57344
    s_nop 0
    s_nop 0
    buffer_load_dwordx4 v10, s[12:15], s40 offen offset:1024 sc1 lds
    s_add_u32 m0, s45, 44032
    s_add_u32 s76, s41, 24576
    buffer_load_dwordx4 v9, s[16:19], s76 offen lds
    s_bfe_u32 s41, s49, 0x4000c
    s_xor_b32 s41, s41, s10
    s_lshl_b32 s41, s41, 17
    s_add_u32 s41, s41, s38
    s_add_u32 m0, s45, 81920
    s_add_u32 s76, s41, 0
    buffer_load_dwordx4 v8, s[16:19], s76 offen lds
    s_add_u32 m0, s45, 82944
    s_add_u32 s76, s41, 8192
    buffer_load_dwordx4 v9, s[16:19], s76 offen lds
    s_waitcnt vmcnt(13)
    s_barrier
    s_bfe_u32 s40, s49, 0x40004
    s_xor_b32 s40, s40, s10
    s_lshl_b32 s40, s40, 11
    s_add_u32 s40, s40, s36
    s_add_u32 m0, s44, 16384
    s_nop 0
    buffer_load_dwordx4 v10, s[12:15], s40 offen offset:0 sc1 lds
    s_add_u32 m0, s44, 16384
    s_nop 0
    s_nop 0
    buffer_load_dwordx4 v10, s[12:15], s40 offen offset:1024 sc1 lds
    s_add_u32 m0, s45, 83968
    s_add_u32 s76, s41, 16384
    buffer_load_dwordx4 v8, s[16:19], s76 offen lds
    s_add_u32 m0, s45, 84992
    s_add_u32 s76, s41, 24576
    buffer_load_dwordx4 v9, s[16:19], s76 offen lds
    s_bfe_u32 s41, s49, 0x40010
    s_xor_b32 s41, s41, s10
    s_lshl_b32 s41, s41, 17
    s_add_u32 s41, s41, s38
    s_add_u32 m0, s45, 122880
    s_add_u32 s76, s41, 0
    buffer_load_dwordx4 v8, s[16:19], s76 offen lds
    s_waitcnt vmcnt(13)
    s_barrier
    s_bfe_u32 s40, s49, 0x40008
    s_xor_b32 s40, s40, s10
    s_lshl_b32 s40, s40, 11
    s_add_u32 s40, s40, s36
    s_add_u32 m0, s44, 98304
    s_nop 0
    buffer_load_dwordx4 v10, s[12:15], s40 offen offset:0 sc1 lds
    s_add_u32 m0, s44, 98304
    s_nop 0
    s_nop 0
    buffer_load_dwordx4 v10, s[12:15], s40 offen offset:1024 sc1 lds
    s_add_u32 m0, s45, 123904
    s_add_u32 s76, s41, 8192
    buffer_load_dwordx4 v9, s[16:19], s76 offen lds
    s_add_u32 m0, s45, 124928
    s_add_u32 s76, s41, 16384
    buffer_load_dwordx4 v8, s[16:19], s76 offen lds
    s_add_u32 m0, s45, 125952
    s_add_u32 s76, s41, 24576
    buffer_load_dwordx4 v9, s[16:19], s76 offen lds
    s_waitcnt vmcnt(13)
    s_barrier
    s_bfe_u32 s40, s49, 0x4000c
    s_xor_b32 s40, s40, s10
    s_lshl_b32 s40, s40, 11
    s_add_u32 s40, s40, s36
    s_add_u32 m0, s44, 139264
    s_nop 0
    buffer_load_dwordx4 v10, s[12:15], s40 offen offset:0 sc1 lds
    s_add_u32 m0, s44, 139264
    s_nop 0
    buffer_load_dwordx4 v10, s[12:15], s40 offen offset:1024 sc1 lds
    s_bfe_u32 s41, s49, 0x40014
    s_xor_b32 s41, s41, s10
    s_lshl_b32 s41, s41, 17
    s_add_u32 s41, s41, s38
    s_add_u32 m0, s45, 106496
    s_add_u32 s76, s41, 0
    s_nop 0
    buffer_load_dwordx4 v8, s[16:19], s76 offen lds
    s_add_u32 m0, s45, 107520
    s_add_u32 s76, s41, 8192
    buffer_load_dwordx4 v9, s[16:19], s76 offen lds
    s_add_u32 m0, s45, 108544
    s_add_u32 s76, s41, 16384
    buffer_load_dwordx4 v8, s[16:19], s76 offen lds
    s_waitcnt vmcnt(13)
    s_barrier
    s_bfe_u32 s40, s49, 0x40010
    s_xor_b32 s40, s40, s10
    s_lshl_b32 s40, s40, 11
    s_add_u32 s40, s40, s36
    s_add_u32 m0, s44, 57344
    s_nop 0
    buffer_load_dwordx4 v10, s[12:15], s40 offen offset:0 sc1 lds
    s_add_u32 m0, s44, 57344
    s_nop 0
    s_nop 0
    buffer_load_dwordx4 v10, s[12:15], s40 offen offset:1024 sc1 lds
    s_add_u32 m0, s45, 109568
    s_add_u32 s76, s41, 24576
    buffer_load_dwordx4 v9, s[16:19], s76 offen lds
    s_bfe_u32 s41, s49, 0x40018
    s_xor_b32 s41, s41, s10
    s_lshl_b32 s41, s41, 17
    s_add_u32 s41, s41, s38
    s_add_u32 m0, s45, 147456
    s_add_u32 s76, s41, 0
    buffer_load_dwordx4 v8, s[16:19], s76 offen lds
    s_add_u32 m0, s45, 148480
    s_add_u32 s76, s41, 8192
    buffer_load_dwordx4 v9, s[16:19], s76 offen lds
    s_waitcnt vmcnt(13)
    s_barrier
    s_bfe_u32 s40, s49, 0x40014
    s_xor_b32 s40, s40, s10
    s_lshl_b32 s40, s40, 11
    s_add_u32 s40, s40, s36
    s_add_u32 m0, s44, 16384
    s_nop 0
    buffer_load_dwordx4 v10, s[12:15], s40 offen offset:0 sc1 lds
    s_add_u32 m0, s44, 16384
    s_nop 0
    s_nop 0
    buffer_load_dwordx4 v10, s[12:15], s40 offen offset:1024 sc1 lds
    s_add_u32 m0, s45, 149504
    s_add_u32 s76, s41, 16384
    buffer_load_dwordx4 v8, s[16:19], s76 offen lds
    s_add_u32 m0, s45, 150528
    s_add_u32 s76, s41, 24576
    buffer_load_dwordx4 v9, s[16:19], s76 offen lds
    s_bfe_u32 s41, s49, 0x4001c
    s_xor_b32 s41, s41, s10
    s_lshl_b32 s41, s41, 17
    s_add_u32 s41, s41, s38
    s_add_u32 m0, s45, 65536
    s_add_u32 s76, s41, 0
    buffer_load_dwordx4 v8, s[16:19], s76 offen lds
    s_waitcnt vmcnt(13)
    s_barrier
    s_bfe_u32 s40, s49, 0x40018
    s_xor_b32 s40, s40, s10
    s_lshl_b32 s40, s40, 11
    s_add_u32 s40, s40, s36
    s_add_u32 m0, s44, 98304
    s_nop 0
    buffer_load_dwordx4 v10, s[12:15], s40 offen offset:0 sc1 lds
    s_add_u32 m0, s44, 98304
    s_nop 0
    s_nop 0
    buffer_load_dwordx4 v10, s[12:15], s40 offen offset:1024 sc1 lds
    s_add_u32 m0, s45, 66560
    s_add_u32 s76, s41, 8192
    buffer_load_dwordx4 v9, s[16:19], s76 offen lds
    s_add_u32 m0, s45, 67584
    s_add_u32 s76, s41, 16384
    buffer_load_dwordx4 v8, s[16:19], s76 offen lds
    s_add_u32 m0, s45, 68608
    s_add_u32 s76, s41, 24576
    buffer_load_dwordx4 v9, s[16:19], s76 offen lds
    s_waitcnt vmcnt(13)
    s_barrier
    s_bfe_u32 s40, s49, 0x4001c
    s_xor_b32 s40, s40, s10
    s_lshl_b32 s40, s40, 11
    s_add_u32 s40, s40, s36
    s_add_u32 m0, s44, 139264
    s_nop 0
    buffer_load_dwordx4 v10, s[12:15], s40 offen offset:0 sc1 lds
    s_add_u32 m0, s44, 139264
    s_nop 0
    buffer_load_dwordx4 v10, s[12:15], s40 offen offset:1024 sc1 lds
    s_waitcnt vmcnt(10)
    s_barrier
    s_waitcnt vmcnt(5)
    s_barrier
    s_waitcnt vmcnt(0)
    s_barrier
    s_endpgm
F_aux:
    s_barrier
    s_setprio 0
    s_sub_u32 s3, s3, 4
    s_add_u32 s11, s33, 4
    s_lshr_b32 s11, s11, 3
    s_sub_u32 s11, s33, s11
    s_lshl_b32 s11, s11, 4
    s_add_u32 s11, s11, s32
    s_and_b32 s36, s33, 7
    s_cmp_eq_u32 s36, 3
    s_cselect_b32 s11, 255, s11
    s_and_b32 s36, s11, 3
    s_bfe_u32 s37, s11, 0x10002
    s_lshr_b32 s38, s11, 3
    v_lshlrev_b32 v3, 2, v0
    s_lshl_b32 s77, s36, 1
    s_add_u32 s77, s77, s37
    s_mul_i32 s77, s77, 114688
    s_lshl_b32 s46, s38, 12
    s_add_u32 s77, s77, s46
    s_lshl_b32 s46, s3, 10
    s_add_u32 s77, s77, s46
    s_cmp_ge_u32 s11, 224
    s_cselect_b32 s77, 0x7ff00000, s77
    v_mov_b32 v140, 0
    v_mov_b32 v141, 0
    v_mov_b32 v142, 0
    v_mov_b32 v143, 0
    s_add_u32 s12, s72, 0xa00000
    s_addc_u32 s13, s73, 0
    s_mov_b32 s14, 0xe0000
    s_mov_b32 s15, 0x00020000
    buffer_store_dwordx4 v[140:143], v2, s[12:15], s77 offen sc0 sc1
    s_add_u32 s12, s72, 0xb00000
    s_addc_u32 s13, s73, 0
    s_mov_b32 s14, 0x30000
    s_mov_b32 s15, 0x00020000
    s_lshl_b32 s47, s32, 8
    s_add_u32 s56, s47, 0x908000
    s_add_u32 s56, s72, s56
    s_addc_u32 s57, s73, 0
    s_cmp_eq_u32 s37, 0
    s_cselect_b32 s16, s62, s64
    s_cselect_b32 s17, s63, s65
    s_mov_b32 s18, 7340032
    s_mov_b32 s19, 0x00020000
    s_lshl_b32 s44, s3, 2
    s_add_u32 s44, s44, 24640
    v_mov_b32 v10, s44
    v_lshrrev_b32 v5, 4, v0
    v_mul_u32_u24 v6, 57344, v5
    v_and_b32 v7, 15, v0
    v_lshl_add_u32 v6, v7, 4, v6
    s_lshl_b32 s44, s36, 2
    s_add_u32 s44, s44, s3
    s_mul_i32 s54, s44, 458752
    s_lshl_b32 s45, s38, 8
    s_add_u32 s54, s54, s45
    s_cmp_ge_u32 s11, 224
    s_cselect_b32 s54, 0x70000000, s54
    s_lshl_b32 s55, s44, 7
    v_mov_b32 v8, 0
    s_mov_b32 s80, s66
    s_mov_b32 s81, s67
    s_mov_b32 s82, 0x700000
    s_mov_b32 s83, 0x00020000
    v_bfe_u32 v21, v0, 2, 2
    v_lshl_add_u32 v22, v5, 3, v21
    v_lshrrev_b32 v21, 1, v21
    v_and_b32 v20, 1, v5
    v_lshl_add_u32 v21, v20, 1, v21
    v_xor_b32 v21, s3, v21
    v_lshlrev_b32 v21, 5, v21
    v_lshl_add_u32 v21, v22, 7, v21
    v_and_b32 v20, 3, v0
    v_lshl_add_u32 v21, v20, 3, v21
    s_mov_b32 s44, 0x23453342
    s_lshl_b32 s89, s35, 2
    s_lshr_b32 s89, s44, s89
    s_and_b32 s89, s89, 15
    s_and_b32 s44, s89, 3
    s_mul_i32 s44, s44, 40960
    s_add_u32 s44, s44, 16384
    v_add_u32 v112, s44, v21
    v_lshlrev_b32 v113, 2, v7
    v_lshl_add_u32 v113, v5, 12, v113
    s_lshl_b32 s91, s33, 8
    s_lshl_b32 s45, s3, 6
    s_add_u32 s91, s91, s45
    s_mul_i32 s88, s32, 12288
    s_add_u32 s88, s88, s91
    s_mov_b32 exec_hi, 0xffff
    buffer_store_dword v8, v113, s[12:15], s88 offen sc0 sc1
    s_mov_b64 exec, -1
    s_getpc_b64 s[64:65]
F_cp:
    s_add_u32 s64, s64, F_co-F_cp
    s_addc_u32 s65, s65, 0
    s_branch F_cx
F_co:
    ds_read_b64_tr_b16 v[72:73], v112 offset:0
    ds_read_b64_tr_b16 v[74:75], v112 offset:512
    ds_read_b64_tr_b16 v[76:77], v112 offset:4096
    ds_read_b64_tr_b16 v[78:79], v112 offset:4608
    ds_read_b64_tr_b16 v[80:81], v112 offset:8192
    ds_read_b64_tr_b16 v[82:83], v112 offset:8704
    ds_read_b64_tr_b16 v[84:85], v112 offset:12288
    ds_read_b64_tr_b16 v[86:87], v112 offset:12800
    ds_read_b64_tr_b16 v[88:89], v112 offset:16384
    ds_read_b64_tr_b16 v[90:91], v112 offset:16896
    ds_read_b64_tr_b16 v[92:93], v112 offset:20480
    ds_read_b64_tr_b16 v[94:95], v112 offset:20992
    v_mov_b32 v108, 0x3f803f80
    v_mov_b32 v109, 0x3f803f80
    v_mov_b32 v110, 0x3f803f80
    v_mov_b32 v111, 0x3f803f80
    s_waitcnt lgkmcnt(0)
    s_swappc_b64 s[64:65], s[66:67]
    s_setprio 3
    v_mfma_f32_16x16x32_bf16 v[96:99], v[108:111], v[72:75], 0
    v_mfma_f32_16x16x32_bf16 v[100:103], v[108:111], v[80:83], 0
    v_mfma_f32_16x16x32_bf16 v[104:107], v[108:111], v[88:91], 0
    v_mfma_f32_16x16x32_bf16 v[96:99], v[108:111], v[76:79], v[96:99]
    v_mfma_f32_16x16x32_bf16 v[100:103], v[108:111], v[84:87], v[100:103]
    v_mfma_f32_16x16x32_bf16 v[104:107], v[108:111], v[92:95], v[104:107]
    s_setprio 0
    v_cmp_eq_u32 vcc, 1, v5
    s_nop 4
    v_cndmask_b32 v96, v96, v100, vcc
    v_cmp_eq_u32 vcc, 2, v5
    s_nop 1
    v_cndmask_b32 v96, v96, v104, vcc
    v_max_u32 v96, 1, v96
    s_sleep 4
    s_mov_b32 exec_hi, 0xffff
    buffer_store_dword v96, v113, s[12:15], s88 offen sc0 sc1
    s_mov_b64 exec, -1
    s_setpc_b64 s[66:67]
F_cx:
    s_cmp_eq_u32 s3, 0
    s_cbranch_scc1 F_ax0
    s_cmp_eq_u32 s3, 2
    s_cbranch_scc1 F_ax2
    s_barrier
    s_waitcnt vmcnt(0)
    s_barrier
    s_sub_u32 s45, 2, s89
    s_cmp_gt_u32 s45, 1
    s_cbranch_scc1 CB_17
    s_swappc_b64 s[66:67], s[64:65]
CB_17:
    s_barrier
    s_sub_u32 s45, 3, s89
    s_cmp_gt_u32 s45, 1
    s_cbranch_scc1 CB_18
    s_swappc_b64 s[66:67], s[64:65]
CB_18:
    s_barrier
    s_sub_u32 s45, 4, s89
    s_cmp_gt_u32 s45, 1
    s_cbranch_scc1 CB_19
    s_swappc_b64 s[66:67], s[64:65]
CB_19:
    s_barrier
    s_sub_u32 s45, 5, s89
    s_cmp_gt_u32 s45, 1
    s_cbranch_scc1 CB_20
    s_swappc_b64 s[66:67], s[64:65]
CB_20:
    s_barrier
    s_sub_u32 s45, 6, s89
    s_cmp_gt_u32 s45, 1
    s_cbranch_scc1 CB_21
    s_swappc_b64 s[66:67], s[64:65]
CB_21:
    s_cmp_eq_u32 s3, 3
    s_cbranch_scc1 IW_22
    s_mov_b64 exec, 0
    s_branch W_1
R_1:
    s_branch W_2
R_2:
    s_mov_b64 exec, -1
    s_branch IW_22e
IW_22:
    s_mov_b64 exec, 0
    s_branch W_3
R_3:
    s_branch W_4
R_4:
    s_mov_b64 exec, -1
IW_22e:
    s_barrier
    s_cmp_eq_u32 s3, 3
    s_cbranch_scc1 IW_23
    s_mov_b64 exec, 0
    s_branch W_5
R_5:
    s_branch W_6
R_6:
    s_mov_b64 exec, -1
    s_branch IW_23e
IW_23:
    s_mov_b64 exec, 0
    s_branch W_7
R_7:
    s_branch W_8
R_8:
    s_mov_b64 exec, -1
IW_23e:
    s_barrier
    s_cmp_eq_u32 s3, 3
    s_cbranch_scc1 IW_24
    s_mov_b64 exec, 0
    s_nop 0
R_9:
    s_nop 0
R_10:
    s_mov_b64 exec, -1
    s_branch IW_24e
IW_24:
    s_mov_b64 exec, 0
    s_nop 0
R_11:
    s_nop 0
R_12:
    s_mov_b64 exec, -1
IW_24e:
    s_barrier
    s_barrier
    s_barrier
    s_branch F_aj
F_ax0:
    s_lshl_b32 s44, s32, 2
    buffer_load_dword v9, v8, s[48:51], s44 offen sc0 sc1
    s_barrier
    s_waitcnt vmcnt(0)
    v_cmp_eq_u32 vcc, 0, v9
    s_cbranch_vccz F_ax0r
PL_25:
    buffer_load_dword v9, v8, s[48:51], s44 offen sc0 sc1
    s_waitcnt vmcnt(0)
    v_cmp_gt_u32 vcc, 1, v9
    s_cbranch_vccz PD_26
    s_sleep 1
    s_branch PL_25
PD_26:
F_ax0r:
    s_barrier
    s_mov_b32 s76, 1
    s_atomic_add s76, s[56:57], 0 glc
    s_sub_u32 s45, 2, s89
    s_cmp_gt_u32 s45, 1
    s_cbranch_scc1 CB_27
    s_swappc_b64 s[66:67], s[64:65]
CB_27:
    s_barrier
    s_mov_b32 s75, 0
    s_waitcnt lgkmcnt(0)
    s_cmp_lg_u32 s76, 15
    s_cbranch_scc1 F_ax0c
    s_mov_b32 s75, 1
    s_atomic_add s75, s[70:71], 64 glc
F_ax0c:
    s_sub_u32 s45, 3, s89
    s_cmp_gt_u32 s45, 1
    s_cbranch_scc1 CB_28
    s_swappc_b64 s[66:67], s[64:65]
CB_28:
    s_barrier
    s_sub_u32 s45, 4, s89
    s_cmp_gt_u32 s45, 1
    s_cbranch_scc1 CB_29
    s_swappc_b64 s[66:67], s[64:65]
CB_29:
    s_waitcnt lgkmcnt(0)
    s_cmp_lg_u32 s75, 15
    s_cbranch_scc1 F_ax0d
    v_lshlrev_b32 v9, 8, v0
    v_mov_b32 v11, 1000
    s_mov_b32 s44, 32768
    s_mov_b64 exec, 0xffff
    buffer_store_dword v11, v9, s[40:43], s44 offen sc0 sc1
    s_mov_b64 exec, -1
F_ax0d:
    s_barrier
    s_sub_u32 s45, 5, s89
    s_cmp_gt_u32 s45, 1
    s_cbranch_scc1 CB_30
    s_swappc_b64 s[66:67], s[64:65]
CB_30:
    s_barrier
    s_sub_u32 s45, 6, s89
    s_cmp_gt_u32 s45, 1
    s_cbranch_scc1 CB_31
    s_swappc_b64 s[66:67], s[64:65]
CB_31:
    s_barrier
    s_barrier
    s_barrier
    s_barrier
    s_barrier
    s_branch F_aj
F_ax2:
    s_lshl_b32 s44, s2, 10
    buffer_store_dwordx4 v[140:143], v2, s[24:27], s44 offen sc0 sc1
    s_mov_b64 exec, -1
    s_barrier
    s_waitcnt vmcnt(0)
    s_cmp_lg_u32 s2, 16
    s_cbranch_scc1 F_ax2n
    s_barrier
    s_sub_u32 s45, 2, s89
    s_cmp_gt_u32 s45, 1
    s_cbranch_scc1 CB_32
    s_swappc_b64 s[66:67], s[64:65]
CB_32:
    s_barrier
    s_sub_u32 s45, 3, s89
    s_cmp_gt_u32 s45, 1
    s_cbranch_scc1 CB_33
    s_swappc_b64 s[66:67], s[64:65]
CB_33:
    s_barrier
    s_sub_u32 s45, 4, s89
    s_cmp_gt_u32 s45, 1
    s_cbranch_scc1 CB_34
    s_swappc_b64 s[66:67], s[64:65]
CB_34:
    s_barrier
    s_sub_u32 s45, 5, s89
    s_cmp_gt_u32 s45, 1
    s_cbranch_scc1 CB_35
    s_swappc_b64 s[66:67], s[64:65]
CB_35:
    s_barrier
    s_sub_u32 s45, 6, s89
    s_cmp_gt_u32 s45, 1
    s_cbranch_scc1 CB_36
    s_swappc_b64 s[66:67], s[64:65]
CB_36:
    s_load_dword s76, s[56:57], 0 glc
    s_barrier
    s_waitcnt lgkmcnt(0)
    s_cmp_ge_u32 s76, 1000
    s_cbranch_scc1 F_ax2g
SP_37:
    s_load_dword s76, s[56:57], 0 glc
    s_waitcnt lgkmcnt(0)
    s_cmp_ge_u32 s76, 1000
    s_cbranch_scc1 SD_38
    s_sleep 2
    s_branch SP_37
SD_38:
F_ax2g:
    s_movk_i32 s44, 0
    buffer_load_dwordx4 v[16:19], v2, s[40:43], s44 offen sc0 sc1
    s_movk_i32 s44, 1024
    buffer_load_dwordx4 v[20:23], v2, s[40:43], s44 offen sc0 sc1
    s_movk_i32 s44, 2048
    buffer_load_dwordx4 v[24:27], v2, s[40:43], s44 offen sc0 sc1
    s_movk_i32 s44, 3072
    buffer_load_dwordx4 v[28:31], v2, s[40:43], s44 offen sc0 sc1
    s_movk_i32 s44, 4096
    buffer_load_dwordx4 v[32:35], v2, s[40:43], s44 offen sc0 sc1
    s_movk_i32 s44, 5120
    buffer_load_dwordx4 v[36:39], v2, s[40:43], s44 offen sc0 sc1
    s_movk_i32 s44, 6144
    buffer_load_dwordx4 v[40:43], v2, s[40:43], s44 offen sc0 sc1
    s_movk_i32 s44, 7168
    buffer_load_dwordx4 v[44:47], v2, s[40:43], s44 offen sc0 sc1
    s_mov_b32 s53, 0
    v_and_b32 v13, 7, v0
    v_lshlrev_b32 v13, 2, v13
    v_lshrrev_b32_e64 v9, 3, v0
    v_lshl_add_u32 v13, v9, 7, v13
    s_barrier
    s_waitcnt vmcnt(0)
    s_mov_b32 s58, 0x01010101
    s_mov_b32 s59, s58
    v_max3_u32 v48, v16, v17, v18
    v_med3_u32 v49, v16, v17, v18
    v_min3_u32 v50, v16, v17, v18
    v_med3_u32 v50, v49, v50, v19
    v_med3_u32 v49, v48, v49, v19
    v_max_u32 v48, v48, v19
    v_med3_u32 v50, v49, v50, v20
    v_med3_u32 v49, v48, v49, v20
    v_max_u32 v48, v48, v20
    v_med3_u32 v50, v49, v50, v21
    v_med3_u32 v49, v48, v49, v21
    v_max_u32 v48, v48, v21
    v_med3_u32 v50, v49, v50, v22
    v_med3_u32 v49, v48, v49, v22
    v_max_u32 v48, v48, v22
    v_med3_u32 v50, v49, v50, v23
    v_med3_u32 v49, v48, v49, v23
    v_max_u32 v48, v48, v23
    v_med3_u32 v50, v49, v50, v24
    v_med3_u32 v49, v48, v49, v24
    v_max_u32 v48, v48, v24
    v_med3_u32 v50, v49, v50, v25
    v_med3_u32 v49, v48, v49, v25
    v_max_u32 v48, v48, v25
    v_med3_u32 v50, v49, v50, v26
    v_med3_u32 v49, v48, v49, v26
    v_max_u32 v48, v48, v26
    v_med3_u32 v50, v49, v50, v27
    v_med3_u32 v49, v48, v49, v27
    v_max_u32 v48, v48, v27
    v_med3_u32 v50, v49, v50, v28
    v_med3_u32 v49, v48, v49, v28
    v_max_u32 v48, v48, v28
    v_med3_u32 v50, v49, v50, v29
    v_med3_u32 v49, v48, v49, v29
    v_max_u32 v48, v48, v29
    v_med3_u32 v50, v49, v50, v30
    v_med3_u32 v49, v48, v49, v30
    v_max_u32 v48, v48, v30
    v_med3_u32 v50, v49, v50, v31
    v_med3_u32 v49, v48, v49, v31
    v_max_u32 v48, v48, v31
    v_med3_u32 v50, v49, v50, v32
    v_med3_u32 v49, v48, v49, v32
    v_max_u32 v48, v48, v32
    s_barrier
    v_med3_u32 v50, v49, v50, v33
    v_med3_u32 v49, v48, v49, v33
    v_max_u32 v48, v48, v33
    v_med3_u32 v50, v49, v50, v34
    v_med3_u32 v49, v48, v49, v34
    v_max_u32 v48, v48, v34
    v_med3_u32 v50, v49, v50, v35
    v_med3_u32 v49, v48, v49, v35
    v_max_u32 v48, v48, v35
    v_med3_u32 v50, v49, v50, v36
    v_med3_u32 v49, v48, v49, v36
    v_max_u32 v48, v48, v36
    v_med3_u32 v50, v49, v50, v37
    v_med3_u32 v49, v48, v49, v37
    v_max_u32 v48, v48, v37
    v_med3_u32 v50, v49, v50, v38
    v_med3_u32 v49, v48, v49, v38
    v_max_u32 v48, v48, v38
    v_med3_u32 v50, v49, v50, v39
    v_med3_u32 v49, v48, v49, v39
    v_max_u32 v48, v48, v39
    v_med3_u32 v50, v49, v50, v40
    v_med3_u32 v49, v48, v49, v40
    v_max_u32 v48, v48, v40
    v_med3_u32 v50, v49, v50, v41
    v_med3_u32 v49, v48, v49, v41
    v_max_u32 v48, v48, v41
    v_med3_u32 v50, v49, v50, v42
    v_med3_u32 v49, v48, v49, v42
    v_max_u32 v48, v48, v42
    v_med3_u32 v50, v49, v50, v43
    v_med3_u32 v49, v48, v49, v43
    v_max_u32 v48, v48, v43
    v_med3_u32 v50, v49, v50, v44
    v_med3_u32 v49, v48, v49, v44
    v_max_u32 v48, v48, v44
    v_med3_u32 v50, v49, v50, v45
    v_med3_u32 v49, v48, v49, v45
    v_max_u32 v48, v48, v45
    v_med3_u32 v50, v49, v50, v46
    v_med3_u32 v49, v48, v49, v46
    v_max_u32 v48, v48, v46
    v_med3_u32 v50, v49, v50, v47
    v_med3_u32 v49, v48, v49, v47
    v_max_u32 v48, v48, v47
    v_mov_b32 v4, v48
    s_nop 1
    v_max_u32_dpp v4, v4, v4 row_shr:1 row_mask:0xf bank_mask:0xf bound_ctrl:0
    s_nop 1
    v_max_u32_dpp v4, v4, v4 row_shr:2 row_mask:0xf bank_mask:0xf bound_ctrl:0
    s_nop 1
    v_max_u32_dpp v4, v4, v4 row_shr:4 row_mask:0xf bank_mask:0xf bound_ctrl:0
    s_nop 1
    v_max_u32_dpp v4, v4, v4 row_shr:8 row_mask:0xf bank_mask:0xf bound_ctrl:0
    s_nop 1
    v_max_u32_dpp v4, v4, v4 row_bcast:15 row_mask:0xa bank_mask:0xf
    s_nop 1
    v_max_u32_dpp v4, v4, v4 row_bcast:31 row_mask:0xc bank_mask:0xf
    s_nop 0
    v_readlane_b32 s52, v4, 63
    s_lshl_b64 exec, s[58:59], 0
    s_nop 0
    v_mov_b32 v12, s52
    s_mov_b64 exec, -1
    v_cmp_eq_u32 vcc, s52, v48
    s_nop 1
    v_cndmask_b32 v48, v48, v49, vcc
    v_cndmask_b32 v49, v49, v50, vcc
    v_cndmask_b32 v50, v50, 0, vcc
    s_barrier
    v_mov_b32 v4, v48
    s_nop 1
    v_max_u32_dpp v4, v4, v4 row_shr:1 row_mask:0xf bank_mask:0xf bound_ctrl:0
    s_nop 1
    v_max_u32_dpp v4, v4, v4 row_shr:2 row_mask:0xf bank_mask:0xf bound_ctrl:0
W_7:
    s_cbranch_execz R_7
    s_nop 0
    s_nop 1
    v_max_u32_dpp v4, v4, v4 row_shr:4 row_mask:0xf bank_mask:0xf bound_ctrl:0
    s_nop 1
    v_max_u32_dpp v4, v4, v4 row_shr:8 row_mask:0xf bank_mask:0xf bound_ctrl:0
    s_nop 1
    v_max_u32_dpp v4, v4, v4 row_bcast:15 row_mask:0xa bank_mask:0xf
    s_nop 1
    v_max_u32_dpp v4, v4, v4 row_bcast:31 row_mask:0xc bank_mask:0xf
    s_nop 0
    v_readlane_b32 s52, v4, 63
    s_lshl_b64 exec, s[58:59], 1
    s_nop 0
    v_mov_b32 v12, s52
    s_mov_b64 exec, -1
    v_cmp_eq_u32 vcc, s52, v48
    s_nop 1
    v_cndmask_b32 v48, v48, v49, vcc
    v_cndmask_b32 v49, v49, v50, vcc
    v_cndmask_b32 v50, v50, 0, vcc
    v_mov_b32 v4, v48
    s_nop 1
    v_max_u32_dpp v4, v4, v4 row_shr:1 row_mask:0xf bank_mask:0xf bound_ctrl:0
    s_nop 1
    v_max_u32_dpp v4, v4, v4 row_shr:2 row_mask:0xf bank_mask:0xf bound_ctrl:0
    s_nop 1
    v_max_u32_dpp v4, v4, v4 row_shr:4 row_mask:0xf bank_mask:0xf bound_ctrl:0
    s_nop 1
    v_max_u32_dpp v4, v4, v4 row_shr:8 row_mask:0xf bank_mask:0xf bound_ctrl:0
    s_nop 1
    v_max_u32_dpp v4, v4, v4 row_bcast:15 row_mask:0xa bank_mask:0xf
    s_nop 1
    v_max_u32_dpp v4, v4, v4 row_bcast:31 row_mask:0xc bank_mask:0xf
    s_nop 0
    v_readlane_b32 s52, v4, 63
    s_lshl_b64 exec, s[58:59], 2
    s_nop 0
    v_mov_b32 v12, s52
    s_mov_b64 exec, -1
    v_cmp_eq_u32 vcc, s52, v48
    s_nop 1
    v_cndmask_b32 v48, v48, v49, vcc
    v_cndmask_b32 v49, v49, v50, vcc
    v_cndmask_b32 v50, v50, 0, vcc
    v_mov_b32 v4, v48
    s_nop 1
    v_max_u32_dpp v4, v4, v4 row_shr:1 row_mask:0xf bank_mask:0xf bound_ctrl:0
    s_nop 1
    v_max_u32_dpp v4, v4, v4 row_shr:2 row_mask:0xf bank_mask:0xf bound_ctrl:0
    s_nop 1
    v_max_u32_dpp v4, v4, v4 row_shr:4 row_mask:0xf bank_mask:0xf bound_ctrl:0
    s_nop 1
    v_max_u32_dpp v4, v4, v4 row_shr:8 row_mask:0xf bank_mask:0xf bound_ctrl:0
    s_nop 1
    v_max_u32_dpp v4, v4, v4 row_bcast:15 row_mask:0xa bank_mask:0xf
    s_nop 1
    v_max_u32_dpp v4, v4, v4 row_bcast:31 row_mask:0xc bank_mask:0xf
    s_nop 0
    v_readlane_b32 s52, v4, 63
    s_lshl_b64 exec, s[58:59], 3
    s_nop 0
    v_mov_b32 v12, s52
    s_mov_b64 exec, -1
    v_cmp_eq_u32 vcc, s52, v48
    s_nop 1
    v_cndmask_b32 v48, v48, v49, vcc
    v_cndmask_b32 v49, v49, v50, vcc
    v_cndmask_b32 v50, v50, 0, vcc
    v_mov_b32 v4, v48
    s_nop 1
    v_max_u32_dpp v4, v4, v4 row_shr:1 row_mask:0xf bank_mask:0xf bound_ctrl:0
    s_nop 1
    v_max_u32_dpp v4, v4, v4 row_shr:2 row_mask:0xf bank_mask:0xf bound_ctrl:0
    s_nop 1
    v_max_u32_dpp v4, v4, v4 row_shr:4 row_mask:0xf bank_mask:0xf bound_ctrl:0
    s_nop 1
    v_max_u32_dpp v4, v4, v4 row_shr:8 row_mask:0xf bank_mask:0xf bound_ctrl:0
    s_nop 1
    v_max_u32_dpp v4, v4, v4 row_bcast:15 row_mask:0xa bank_mask:0xf
    s_nop 1
    v_max_u32_dpp v4, v4, v4 row_bcast:31 row_mask:0xc bank_mask:0xf
    s_nop 0
    v_readlane_b32 s52, v4, 63
    s_lshl_b64 exec, s[58:59], 4
    s_nop 0
    v_mov_b32 v12, s52
    s_mov_b64 exec, -1
    v_cmp_eq_u32 vcc, s52, v48
    s_nop 1
    v_cndmask_b32 v48, v48, v49, vcc
    v_cndmask_b32 v49, v49, v50, vcc
    v_cndmask_b32 v50, v50, 0, vcc
    s_barrier
    v_mov_b32 v4, v48
    s_nop 1
    v_max_u32_dpp v4, v4, v4 row_shr:1 row_mask:0xf bank_mask:0xf bound_ctrl:0
    s_nop 1
    v_max_u32_dpp v4, v4, v4 row_shr:2 row_mask:0xf bank_mask:0xf bound_ctrl:0
    s_nop 1
    v_max_u32_dpp v4, v4, v4 row_shr:4 row_mask:0xf bank_mask:0xf bound_ctrl:0
    s_nop 1
    v_max_u32_dpp v4, v4, v4 row_shr:8 row_mask:0xf bank_mask:0xf bound_ctrl:0
    s_nop 1
    v_max_u32_dpp v4, v4, v4 row_bcast:15 row_mask:0xa bank_mask:0xf
    s_nop 1
    v_max_u32_dpp v4, v4, v4 row_bcast:31 row_mask:0xc bank_mask:0xf
    s_nop 0
    v_readlane_b32 s52, v4, 63
    s_lshl_b64 exec, s[58:59], 5
    s_nop 0
    v_mov_b32 v12, s52
    s_mov_b64 exec, -1
    v_cmp_eq_u32 vcc, s52, v48
    s_nop 1
    v_cndmask_b32 v48, v48, v49, vcc
    v_cndmask_b32 v49, v49, v50, vcc
    v_cndmask_b32 v50, v50, 0, vcc
    v_mov_b32 v4, v48
    s_nop 1
    v_max_u32_dpp v4, v4, v4 row_shr:1 row_mask:0xf bank_mask:0xf bound_ctrl:0
    s_nop 1
    v_max_u32_dpp v4, v4, v4 row_shr:2 row_mask:0xf bank_mask:0xf bound_ctrl:0
    s_nop 1
    v_max_u32_dpp v4, v4, v4 row_shr:4 row_mask:0xf bank_mask:0xf bound_ctrl:0
    s_nop 1
    v_max_u32_dpp v4, v4, v4 row_shr:8 row_mask:0xf bank_mask:0xf bound_ctrl:0
    s_nop 1
    v_max_u32_dpp v4, v4, v4 row_bcast:15 row_mask:0xa bank_mask:0xf
    s_nop 1
    v_max_u32_dpp v4, v4, v4 row_bcast:31 row_mask:0xc bank_mask:0xf
    s_nop 0
    v_readlane_b32 s52, v4, 63
    s_lshl_b64 exec, s[58:59], 6
    s_nop 0
    v_mov_b32 v12, s52
    s_mov_b64 exec, -1
    v_cmp_eq_u32 vcc, s52, v48
    s_nop 1
    v_cndmask_b32 v48, v48, v49, vcc
    v_cndmask_b32 v49, v49, v50, vcc
    v_cndmask_b32 v50, v50, 0, vcc
    v_mov_b32 v4, v48
    s_nop 1
    v_max_u32_dpp v4, v4, v4 row_shr:1 row_mask:0xf bank_mask:0xf bound_ctrl:0
    s_nop 1
    v_max_u32_dpp v4, v4, v4 row_shr:2 row_mask:0xf bank_mask:0xf bound_ctrl:0
    s_nop 1
    v_max_u32_dpp v4, v4, v4 row_shr:4 row_mask:0xf bank_mask:0xf bound_ctrl:0
    s_nop 1
    v_max_u32_dpp v4, v4, v4 row_shr:8 row_mask:0xf bank_mask:0xf bound_ctrl:0
    s_nop 1
    v_max_u32_dpp v4, v4, v4 row_bcast:15 row_mask:0xa bank_mask:0xf
    s_nop 1
    v_max_u32_dpp v4, v4, v4 row_bcast:31 row_mask:0xc bank_mask:0xf
    s_nop 0
    v_readlane_b32 s52, v4, 63
    s_lshl_b64 exec, s[58:59], 7
    s_nop 0
    v_mov_b32 v12, s52
    s_mov_b64 exec, -1
    v_cmp_eq_u32 vcc, 0, v48
    s_cbranch_vccz F_tk2
    s_mov_b32 s52, 0
    s_mov_b32 s45, 0
F_tk1:
    v_subrev_u32 v16, s52, v16
    v_subrev_u32 v17, s52, v17
    v_subrev_u32 v18, s52, v18
    v_subrev_u32 v19, s52, v19
    v_subrev_u32 v20, s52, v20
    v_subrev_u32 v21, s52, v21
    v_subrev_u32 v22, s52, v22
    v_subrev_u32 v23, s52, v23
    v_subrev_u32 v24, s52, v24
    v_subrev_u32 v25, s52, v25
    v_subrev_u32 v26, s52, v26
    v_subrev_u32 v27, s52, v27
    v_subrev_u32 v28, s52, v28
    v_subrev_u32 v29, s52, v29
    v_subrev_u32 v30, s52, v30
    v_subrev_u32 v31, s52, v31
    v_subrev_u32 v32, s52, v32
    v_subrev_u32 v33, s52, v33
    v_subrev_u32 v34, s52, v34
    v_subrev_u32 v35, s52, v35
    v_subrev_u32 v36, s52, v36
    v_subrev_u32 v37, s52, v37
    v_subrev_u32 v38, s52, v38
    v_subrev_u32 v39, s52, v39
    v_subrev_u32 v40, s52, v40
    v_subrev_u32 v41, s52, v41
    v_subrev_u32 v42, s52, v42
    v_subrev_u32 v43, s52, v43
    v_subrev_u32 v44, s52, v44
    v_subrev_u32 v45, s52, v45
    v_subrev_u32 v46, s52, v46
    v_subrev_u32 v47, s52, v47
    v_max3_u32 v4, v16, v17, v18
    v_max3_u32 v4, v4, v19, v20
    v_max3_u32 v4, v4, v21, v22
    v_max3_u32 v4, v4, v23, v24
    v_max3_u32 v4, v4, v25, v26
    v_max3_u32 v4, v4, v27, v28
    v_max3_u32 v4, v4, v29, v30
    v_max3_u32 v4, v4, v31, v32
    v_max3_u32 v4, v4, v33, v34
    v_max3_u32 v4, v4, v35, v36
    v_max3_u32 v4, v4, v37, v38
    v_max3_u32 v4, v4, v39, v40
    v_max3_u32 v4, v4, v41, v42
    v_max3_u32 v4, v4, v43, v44
    v_max3_u32 v4, v4, v45, v46
    v_max_u32 v4, v4, v47
    s_nop 1
    v_max_u32_dpp v4, v4, v4 row_shr:1 row_mask:0xf bank_mask:0xf bound_ctrl:0
    s_nop 1
    v_max_u32_dpp v4, v4, v4 row_shr:2 row_mask:0xf bank_mask:0xf bound_ctrl:0
    s_nop 1
    v_max_u32_dpp v4, v4, v4 row_shr:4 row_mask:0xf bank_mask:0xf bound_ctrl:0
    s_nop 1
    v_max_u32_dpp v4, v4, v4 row_shr:8 row_mask:0xf bank_mask:0xf bound_ctrl:0
    s_nop 1
    v_max_u32_dpp v4, v4, v4 row_bcast:15 row_mask:0xa bank_mask:0xf
    s_nop 1
    v_max_u32_dpp v4, v4, v4 row_bcast:31 row_mask:0xc bank_mask:0xf
    s_nop 0
    v_readlane_b32 s52, v4, 63
    s_nop 0
    s_add_u32 s53, s53, s52
    s_lshl_b64 exec, s[58:59], s45
    v_mov_b32 v12, s53
    s_mov_b64 exec, -1
    s_add_u32 s45, s45, 1
    s_cmp_lt_u32 s45, 8
    s_cbranch_scc1 F_tk1
F_tk2:
    v_or_b32 v12, 0x8000, v12
    s_mov_b32 s44, 184320
    buffer_store_dword v12, v13, s[24:27], s44 offen offset:0 sc0 sc1
    buffer_store_dword v12, v13, s[24:27], s44 offen offset:1024 sc0 sc1
    buffer_store_dword v12, v13, s[24:27], s44 offen offset:2048 sc0 sc1
    buffer_store_dword v12, v13, s[24:27], s44 offen offset:3072 sc0 sc1
    s_mov_b32 s44, 188416
    buffer_store_dword v12, v13, s[24:27], s44 offen offset:0 sc0 sc1
    buffer_store_dword v12, v13, s[24:27], s44 offen offset:1024 sc0 sc1
    buffer_store_dword v12, v13, s[24:27], s44 offen offset:2048 sc0 sc1
    buffer_store_dword v12, v13, s[24:27], s44 offen offset:3072 sc0 sc1
    s_branch F_aj
F_ax2n:
    s_barrier
    s_sub_u32 s45, 2, s89
    s_cmp_gt_u32 s45, 1
    s_cbranch_scc1 CB_39
    s_swappc_b64 s[66:67], s[64:65]
CB_39:
    s_barrier
    s_sub_u32 s45, 3, s89
    s_cmp_gt_u32 s45, 1
    s_cbranch_scc1 CB_40
    s_swappc_b64 s[66:67], s[64:65]
CB_40:
    s_barrier
    s_sub_u32 s45, 4, s89
    s_cmp_gt_u32 s45, 1
    s_cbranch_scc1 CB_41
    s_swappc_b64 s[66:67], s[64:65]
CB_41:
    s_barrier
    s_sub_u32 s45, 5, s89
    s_cmp_gt_u32 s45, 1
    s_cbranch_scc1 CB_42
    s_swappc_b64 s[66:67], s[64:65]
CB_42:
    s_barrier
    s_sub_u32 s45, 6, s89
    s_cmp_gt_u32 s45, 1
    s_cbranch_scc1 CB_43
    s_swappc_b64 s[66:67], s[64:65]
CB_43:
    s_barrier
    s_load_dword s76, s[56:57], 0 glc
    s_barrier
    s_waitcnt lgkmcnt(0)
    s_cmp_ge_u32 s76, 1000
    s_cbranch_scc1 F_ax2h
SP_44:
    s_load_dword s76, s[56:57], 0 glc
    s_waitcnt lgkmcnt(0)
    s_cmp_ge_u32 s76, 1000
    s_cbranch_scc1 SD_45
    s_sleep 8
    s_branch SP_44
SD_45:
F_ax2h:
    s_barrier
    s_barrier
    s_barrier
F_aj:
    s_add_u32 s12, s72, 0xa00000
    s_addc_u32 s13, s73, 0
    s_mov_b32 s14, 0xe0000
    s_mov_b32 s15, 0x00020000
    s_and_b32 s46, s2, 63
    s_lshl_b32 s46, s46, 7
    s_add_u32 s56, s46, 0x82d000
    s_add_u32 s56, s72, s56
    s_addc_u32 s57, s73, 0
    s_mov_b32 s58, 0x01010101
    s_mov_b32 s59, s58
    s_mov_b32 s52, 0x05040100
    s_mov_b32 s53, 0x07060302
    v_and_b32 v13, 3, v0
    v_lshlrev_b32 v13, 2, v13
    v_add_u32 v13, 24656, v13
    s_mul_i32 s78, s28, 112
    s_mul_i32 s79, s3, 28
    s_add_u32 s78, s78, s79
    s_lshl_b32 s78, s78, 11
    s_lshl_b32 s79, s29, 8
    s_add_u32 s78, s78, s79

    v_mul_u32_u24 v160, 14336, v5
    v_lshl_add_u32 v160, v7, 4, v160
    s_and_b32 s88, s3, 1
    s_lshl_b32 s88, s88, 12
    s_lshr_b32 s45, s3, 1
    s_mul_i32 s45, s45, 24576
    s_add_u32 s88, s88, s45
    v_subrev_u32 v163, 16, v13
    v_lshrrev_b32 v164, 1, v5
    v_lshlrev_b32 v164, 2, v164
    v_and_b32 v165, 7, v7
    v_xor_b32 v164, v164, v165
    v_lshlrev_b32 v164, 5, v164
    v_lshl_add_u32 v164, v7, 8, v164
    v_and_b32 v165, 1, v5
    v_lshl_add_u32 v164, v165, 4, v164
    s_lshl_b32 s45, s3, 12
    s_add_u32 s45, s45, 106496
    v_add_u32 v164, s45, v164
    s_lshl_b32 s45, s3, 2
    v_add_u32 v165, s45, v5
    v_and_b32 v165, 7, v165
    v_lshlrev_b32 v165, 5, v165
    v_xor_b32 v165, v165, v2
    s_lshl_b32 s45, s3, 10
    s_add_u32 s45, s45, 106496
    v_add_u32 v165, s45, v165
    v_add_u32_e64 v162, 16, v13
    s_barrier
    s_barrier
    s_sleep 2
    s_add_u32 s45, s54, 0
    buffer_load_dwordx4 v[72:75], v6, s[16:19], s45 offen nt
    s_add_u32 s45, s54, 7168
    buffer_load_dwordx4 v[76:79], v6, s[16:19], s45 offen nt
    s_add_u32 s45, s54, 14336
    buffer_load_dwordx4 v[80:83], v6, s[16:19], s45 offen nt
    s_add_u32 s45, s54, 21504
    buffer_load_dwordx4 v[84:87], v6, s[16:19], s45 offen nt
    s_add_u32 s45, s54, 28672
    buffer_load_dwordx4 v[88:91], v6, s[16:19], s45 offen nt
    s_barrier
    s_nop 0
    s_load_dwordx8 s[60:67], s[56:57], 0 glc
    s_add_u32 s45, s54, 35840
    buffer_load_dwordx4 v[92:95], v6, s[16:19], s45 offen nt
    s_add_u32 s45, s54, 43008
    buffer_load_dwordx4 v[96:99], v6, s[16:19], s45 offen nt
    s_add_u32 s45, s54, 50176
    buffer_load_dwordx4 v[100:103], v6, s[16:19], s45 offen nt
    s_add_u32 s45, s54, 229376
    buffer_load_dwordx4 v[104:107], v6, s[16:19], s45 offen nt
    s_add_u32 s45, s54, 236544
    buffer_load_dwordx4 v[108:111], v6, s[16:19], s45 offen nt
    s_barrier
    s_setprio 1
F_sc:
    s_waitcnt lgkmcnt(0)
    s_and_b64 s[74:75], s[60:61], s[62:63]
    s_and_b64 s[74:75], s[74:75], s[64:65]
    s_and_b64 s[74:75], s[74:75], s[66:67]
    s_and_b32 s74, s74, s75
    s_bitcmp1_b32 s74, 15
    s_cbranch_scc1 F_sd
    s_sleep 4
    s_load_dwordx8 s[60:67], s[56:57], 0 glc
    s_branch F_sc
F_sd:

    s_lshl_b64 exec, s[58:59], 0
    v_mov_b32 v4, s60
    s_lshl_b64 exec, s[58:59], 1
    v_mov_b32 v4, s61
    s_lshl_b64 exec, s[58:59], 2
    v_mov_b32 v4, s62
    s_lshl_b64 exec, s[58:59], 3
    v_mov_b32 v4, s63
    s_lshl_b64 exec, s[58:59], 4
    v_mov_b32 v4, s64
    s_lshl_b64 exec, s[58:59], 5
    v_mov_b32 v4, s65
    s_lshl_b64 exec, s[58:59], 6
    v_mov_b32 v4, s66
    s_lshl_b64 exec, s[58:59], 7
    v_mov_b32 v4, s67
    s_mov_b64 exec, -1
    s_mov_b32 s46, 65536
    v_and_b32 v4, 0x7ff, v4
    v_sub_u32 v4, 2047, v4
    v_lshlrev_b32 v9, 4, v4
    v_lshlrev_b32 v4, 11, v4
    v_lshl_add_u32 v4, v5, 4, v4

    buffer_load_dwordx4 v[64:67], v4, s[20:23], s55 offen
    buffer_load_dwordx4 v[68:71], v4, s[20:23], s55 offen offset:64
    buffer_load_dwordx2 v[14:15], v9, s[40:43], s46 offen sc0 sc1
    s_cmp_lt_u32 s11, 224
    s_cbranch_scc1 F_ag
    s_add_u32 s79, s78, 0
    buffer_load_dwordx4 v[16:19], v160, s[80:83], s79 offen nt
    s_add_u32 s79, s78, 2048
    buffer_load_dwordx4 v[20:23], v160, s[80:83], s79 offen nt
    s_add_u32 s79, s78, 4096
    buffer_load_dwordx4 v[24:27], v160, s[80:83], s79 offen nt
    s_add_u32 s79, s78, 6144
    buffer_load_dwordx4 v[28:31], v160, s[80:83], s79 offen nt
    s_add_u32 s79, s78, 8192
    buffer_load_dwordx4 v[144:147], v160, s[80:83], s79 offen nt
    s_add_u32 s79, s78, 10240
    buffer_load_dwordx4 v[148:151], v160, s[80:83], s79 offen nt
    s_add_u32 s79, s78, 12288
    buffer_load_dwordx4 v[152:155], v160, s[80:83], s79 offen nt
    s_sleep 32
    s_branch F_adown
F_ag:
    s_add_u32 s45, s54, 243712
    buffer_load_dwordx4 v[112:115], v6, s[16:19], s45 offen nt
    s_add_u32 s45, s54, 250880
    buffer_load_dwordx4 v[116:119], v6, s[16:19], s45 offen nt
    s_add_u32 s45, s54, 258048
    buffer_load_dwordx4 v[120:123], v6, s[16:19], s45 offen nt
    s_add_u32 s45, s54, 265216
    buffer_load_dwordx4 v[124:127], v6, s[16:19], s45 offen nt
    s_add_u32 s45, s54, 272384
    buffer_load_dwordx4 v[128:131], v6, s[16:19], s45 offen nt
    s_add_u32 s45, s54, 279552
    buffer_load_dwordx4 v[132:135], v6, s[16:19], s45 offen nt
    s_waitcnt vmcnt(6)
    v_lshlrev_b32 v34, 16, v64
    v_and_b32 v35, 0xffff0000, v64
    v_lshlrev_b32 v36, 16, v65
    v_and_b32 v37, 0xffff0000, v65
    v_lshlrev_b32 v38, 16, v66
    v_and_b32 v39, 0xffff0000, v66
    v_lshlrev_b32 v40, 16, v67
    v_and_b32 v41, 0xffff0000, v67
    v_lshlrev_b32 v42, 16, v68
    v_and_b32 v43, 0xffff0000, v68
    v_lshlrev_b32 v44, 16, v69
    v_and_b32 v45, 0xffff0000, v69
    v_lshlrev_b32 v46, 16, v70
    v_and_b32 v47, 0xffff0000, v70
    v_lshlrev_b32 v48, 16, v71
    v_and_b32 v49, 0xffff0000, v71
    v_add_f32 v34, v34, v14
    v_add_f32 v35, v35, v14
    v_add_f32 v36, v36, v14
    v_add_f32 v37, v37, v14
    v_add_f32 v38, v38, v14
    v_add_f32 v39, v39, v14
    v_add_f32 v40, v40, v14
    v_add_f32 v41, v41, v14
    v_add_f32 v42, v42, v14
    v_add_f32 v43, v43, v14
    v_add_f32 v44, v44, v14
    v_add_f32 v45, v45, v14
    v_add_f32 v46, v46, v14
    v_add_f32 v47, v47, v14
    v_add_f32 v48, v48, v14
    v_add_f32_e64 v49, v49, v14
    v_cvt_pk_bf16_f32 v64, v34, v35
    v_cvt_pk_bf16_f32 v65, v36, v37
    v_cvt_pk_bf16_f32 v66, v38, v39
    v_cvt_pk_bf16_f32 v67, v40, v41
    v_cvt_pk_bf16_f32 v68, v42, v43
    v_cvt_pk_bf16_f32 v69, v44, v45
    v_cvt_pk_bf16_f32 v70, v46, v47
    v_cvt_pk_bf16_f32 v71, v48, v49
    v_lshlrev_b32 v34, 16, v64
    v_and_b32 v35, 0xffff0000, v64
    v_lshlrev_b32 v36, 16, v65
    v_and_b32 v37, 0xffff0000, v65
    v_lshlrev_b32 v38, 16, v66
    v_and_b32 v39, 0xffff0000, v66
    v_lshlrev_b32 v40, 16, v67
    v_and_b32 v41, 0xffff0000, v67
    v_lshlrev_b32 v42, 16, v68
    v_and_b32 v43, 0xffff0000, v68
    v_lshlrev_b32 v44, 16, v69
    v_and_b32 v45, 0xffff0000, v69
    v_lshlrev_b32 v46, 16, v70
    v_and_b32 v47, 0xffff0000, v70
    v_lshlrev_b32 v48, 16, v71
    v_and_b32 v49, 0xffff0000, v71
    v_mul_f32 v34, v34, v15
    v_mul_f32 v35, v35, v15
    v_mul_f32 v36, v36, v15
    v_mul_f32 v37, v37, v15
    v_mul_f32 v38, v38, v15
    v_mul_f32 v39, v39, v15
    v_mul_f32 v40, v40, v15
    v_mul_f32 v41, v41, v15
    v_mul_f32 v42, v42, v15
    v_mul_f32 v43, v43, v15
    v_mul_f32 v44, v44, v15
    v_mul_f32 v45, v45, v15
    v_mul_f32 v46, v46, v15
    v_mul_f32 v47, v47, v15
    v_mul_f32 v48, v48, v15
    v_mul_f32 v49, v49, v15
    v_cvt_pk_bf16_f32 v64, v34, v35
    v_cvt_pk_bf16_f32 v65, v36, v37
    v_cvt_pk_bf16_f32 v66, v38, v39
    v_cvt_pk_bf16_f32 v67, v40, v41
    v_cvt_pk_bf16_f32 v68, v42, v43
    v_cvt_pk_bf16_f32 v69, v44, v45
    v_cvt_pk_bf16_f32 v70, v46, v47
    v_cvt_pk_bf16_f32 v71, v48, v49
    s_waitcnt vmcnt(8)
    v_perm_b32 v136, v76, v72, s52
    v_perm_b32 v137, v84, v80, s52
    v_perm_b32 v138, v92, v88, s52
    v_perm_b32 v139, v100, v96, s52
    s_nop 1
    v_mfma_f32_16x16x32_bf16 v[32:35], v[64:67], v[136:139], 0
    v_perm_b32 v140, v76, v72, s53
    v_perm_b32 v141, v84, v80, s53
    v_perm_b32 v142, v92, v88, s53
    v_perm_b32 v143, v100, v96, s53
    s_nop 1
    v_mfma_f32_16x16x32_bf16 v[36:39], v[64:67], v[140:143], 0
    v_perm_b32 v136, v77, v73, s52
    v_perm_b32 v137, v85, v81, s52
    v_perm_b32 v138, v93, v89, s52
    v_perm_b32 v139, v101, v97, s52
    s_nop 1
    v_mfma_f32_16x16x32_bf16 v[40:43], v[64:67], v[136:139], 0
    v_perm_b32 v140, v77, v73, s53
    v_perm_b32 v141, v85, v81, s53
    v_perm_b32 v142, v93, v89, s53
    v_perm_b32 v143, v101, v97, s53
    s_nop 1
    v_mfma_f32_16x16x32_bf16 v[44:47], v[64:67], v[140:143], 0
    v_perm_b32 v136, v78, v74, s52
    v_perm_b32 v137, v86, v82, s52
    v_perm_b32 v138, v94, v90, s52
    v_perm_b32 v139, v102, v98, s52
    s_nop 1
    v_mfma_f32_16x16x32_bf16 v[48:51], v[64:67], v[136:139], 0
    v_perm_b32 v140, v78, v74, s53
    v_perm_b32 v141, v86, v82, s53
    v_perm_b32 v142, v94, v90, s53
    v_perm_b32 v143, v102, v98, s53
    s_nop 1
    v_mfma_f32_16x16x32_bf16 v[52:55], v[64:67], v[140:143], 0
    v_perm_b32 v136, v79, v75, s52
    v_perm_b32 v137, v87, v83, s52
    v_perm_b32 v138, v95, v91, s52
    v_perm_b32 v139, v103, v99, s52
    s_nop 1
    v_mfma_f32_16x16x32_bf16 v[56:59], v[64:67], v[136:139], 0
    v_perm_b32 v140, v79, v75, s53
    v_perm_b32 v141, v87, v83, s53
    v_perm_b32 v142, v95, v91, s53
    v_perm_b32 v143, v103, v99, s53
    s_nop 1
    v_mfma_f32_16x16x32_bf16 v[60:63], v[64:67], v[140:143], 0
    s_waitcnt vmcnt(0)
    s_add_u32 s79, s78, 0
    s_nop 0
    buffer_load_dwordx4 v[16:19], v160, s[80:83], s79 offen nt
    s_add_u32 s79, s78, 2048
    buffer_load_dwordx4 v[20:23], v160, s[80:83], s79 offen nt
    s_add_u32 s79, s78, 4096
    buffer_load_dwordx4 v[24:27], v160, s[80:83], s79 offen nt
    s_add_u32 s79, s78, 6144
    buffer_load_dwordx4 v[28:31], v160, s[80:83], s79 offen nt
    s_add_u32 s79, s78, 8192
    buffer_load_dwordx4 v[144:147], v160, s[80:83], s79 offen nt
    s_add_u32 s79, s78, 10240
    buffer_load_dwordx4 v[148:151], v160, s[80:83], s79 offen nt
    s_add_u32 s79, s78, 12288
    buffer_load_dwordx4 v[152:155], v160, s[80:83], s79 offen nt
    v_perm_b32 v136, v108, v104, s52
    v_perm_b32 v137, v116, v112, s52
    v_perm_b32 v138, v124, v120, s52
    v_perm_b32 v139, v132, v128, s52
    s_nop 1
    v_mfma_f32_16x16x32_bf16 v[32:35], v[68:71], v[136:139], v[32:35]
    v_perm_b32 v140, v108, v104, s53
    v_perm_b32 v141, v116, v112, s53
    v_perm_b32 v142, v124, v120, s53
    v_perm_b32 v143, v132, v128, s53
    s_nop 1
    v_mfma_f32_16x16x32_bf16 v[36:39], v[68:71], v[140:143], v[36:39]
    v_perm_b32 v136, v109, v105, s52
    v_perm_b32 v137, v117, v113, s52
    v_perm_b32 v138, v125, v121, s52
    v_perm_b32 v139, v133, v129, s52
    s_nop 1
    v_mfma_f32_16x16x32_bf16 v[40:43], v[68:71], v[136:139], v[40:43]
    v_perm_b32 v140, v109, v105, s53
    v_perm_b32 v141, v117, v113, s53
    v_perm_b32 v142, v125, v121, s53
    v_perm_b32 v143, v133, v129, s53
    s_nop 1
    v_mfma_f32_16x16x32_bf16 v[44:47], v[68:71], v[140:143], v[44:47]
    v_perm_b32 v136, v110, v106, s52
    v_perm_b32 v137, v118, v114, s52
    v_perm_b32 v138, v126, v122, s52
    v_perm_b32 v139, v134, v130, s52
    s_nop 1
    v_mfma_f32_16x16x32_bf16 v[48:51], v[68:71], v[136:139], v[48:51]
    v_perm_b32 v140, v110, v106, s53
    v_perm_b32 v141, v118, v114, s53
    v_perm_b32 v142, v126, v122, s53
    v_perm_b32 v143, v134, v130, s53
    s_nop 1
    v_mfma_f32_16x16x32_bf16 v[52:55], v[68:71], v[140:143], v[52:55]
    v_perm_b32 v136, v111, v107, s52
    v_perm_b32 v137, v119, v115, s52
    v_perm_b32 v138, v127, v123, s52
    v_perm_b32 v139, v135, v131, s52
    s_nop 1
    v_mfma_f32_16x16x32_bf16 v[56:59], v[68:71], v[136:139], v[56:59]
    v_perm_b32 v140, v111, v107, s53
    v_perm_b32 v141, v119, v115, s53
    v_perm_b32 v142, v127, v123, s53
    v_perm_b32 v143, v135, v131, s53
    s_nop 1
    v_mfma_f32_16x16x32_bf16 v[60:63], v[68:71], v[140:143], v[60:63]
    v_cmp_gt_u32 vcc, 32, v0
    s_nop 1
    v_cndmask_b32 v32, v48, v32, vcc
    v_cndmask_b32 v33, v49, v33, vcc
    v_cndmask_b32 v34, v50, v34, vcc
    v_cndmask_b32 v35, v51, v35, vcc
    ds_write_b128 v164, v[32:35]
    v_cndmask_b32 v36, v52, v36, vcc
    v_cndmask_b32 v37, v53, v37, vcc
    v_cndmask_b32 v38, v54, v38, vcc
    v_cndmask_b32 v39, v55, v39, vcc
    v_xor_b32 v4, 32, v164
    ds_write_b128 v4, v[36:39]
    v_cndmask_b32 v40, v56, v40, vcc
    v_cndmask_b32 v41, v57, v41, vcc
    v_cndmask_b32 v42, v58, v42, vcc
    v_cndmask_b32 v43, v59, v43, vcc
    v_xor_b32 v4, 64, v164
    ds_write_b128 v4, v[40:43]
    v_cndmask_b32 v44, v60, v44, vcc
    v_cndmask_b32 v45, v61, v45, vcc
    v_cndmask_b32 v46, v62, v46, vcc
    v_cndmask_b32 v47, v63, v47, vcc
    v_xor_b32 v4, 96, v164
    ds_write_b128 v4, v[44:47]
    v_mov_b32 v4, 1
    s_mov_b64 exec, 1
    ds_write_b32 v10, v4 offset:16
    s_mov_b64 exec, -1
    ds_read_b32 v12, v13
FW_46:
    s_waitcnt lgkmcnt(0)
    v_cmp_gt_u32 vcc, 1, v12
    s_cbranch_vccz FO_47
    s_sleep 1
    ds_read_b32 v12, v13
    s_branch FW_46
FO_47:
    ds_read_b128 v[72:75], v165 offset:0
    ds_read_b128 v[76:79], v165 offset:4096
    ds_read_b128 v[80:83], v165 offset:8192
    ds_read_b128 v[84:87], v165 offset:12288
    s_waitcnt lgkmcnt(0)
    v_add_f32 v72, v72, v76
    v_add_f32 v80, v80, v84
    v_add_f32 v73, v73, v77
    v_add_f32 v81, v81, v85
    v_add_f32 v74, v74, v78
    v_add_f32 v82, v82, v86
    v_add_f32 v75, v75, v79
    v_add_f32 v83, v83, v87
    v_add_f32 v72, v72, v80
    v_add_f32 v73, v73, v81
    v_add_f32 v74, v74, v82
    v_add_f32 v75, v75, v83
    v_max_u32 v72, 1, v72
    v_max_u32 v74, 1, v74
    buffer_store_dwordx4 v[72:75], v2, s[12:15], s77 offen sc0 sc1
    s_lshl_b32 s44, s38, 2
    s_add_u32 s44, s44, s3
    s_mul_i32 s44, s44, 64
    s_add_u32 s44, s44, 241664
    v_mov_b32 v4, 1
    s_mov_b64 exec, 1
    buffer_atomic_add v4, v8, s[24:27], s44 offen
    s_mov_b64 exec, -1
F_adown:
    v_mov_b32 v4, 2
    s_mov_b64 exec, 1
    ds_write_b32 v10, v4 offset:16
    s_mov_b64 exec, -1
    s_mul_i32 s36, s28, 112
    s_mul_i32 s37, s3, 28
    s_add_u32 s36, s36, s37
    v_min_u32 v4, 55, v0
    v_lshlrev_b32 v4, 4, v4
    s_lshl_b32 s38, s36, 5
    s_lshr_b32 s44, s36, 5
    s_mul_i32 s44, s44, 64
    s_add_u32 s45, s36, 27
    s_lshr_b32 s45, s45, 5
    s_mul_i32 s45, s45, 64
    s_add_u32 s56, s44, 0x83b000
    s_add_u32 s56, s72, s56
    s_addc_u32 s57, s73, 0
    s_add_u32 s58, s45, 0x83b000
    s_add_u32 s58, s72, s58
    s_addc_u32 s59, s73, 0
    v_mov_b32 v156, 0
    v_mov_b32 v157, 0
    v_mov_b32 v158, 0
    v_mov_b32 v159, 0
    s_mov_b32 s48, 0xbfb8aa3b
    ds_read_b32 v12, v163
FW_48:
W_8:
    s_cbranch_execz R_8
    s_nop 0
    s_waitcnt lgkmcnt(0)
    v_cmp_gt_u32 vcc, 3, v12
    s_cbranch_vccz FO_49
    s_sleep 2
    ds_read_b32 v12, v163
    s_branch FW_48
FO_49:
    s_add_u32 s44, s88, 32768
    v_lshlrev_b32 v9, 3, v0
    v_add_u32 v9, s44, v9
    ds_write_b64 v9, v[156:157]
    v_lshrrev_b32 v11, 1, v0
    v_mul_u32_u24 v9, 37, v11
    v_lshrrev_b32 v9, 8, v9
    v_add_u32 v11, v11, v9
    v_lshlrev_b32 v11, 1, v11
    v_and_b32 v9, 1, v0
    v_lshl_add_u32 v11, v9, 8, v11
    v_add_u32 v11, s44, v11
    v_and_b32 v9, 7, v0
    v_lshlrev_b32 v9, 6, v9
    v_lshl_add_u32 v9, v5, 4, v9
    v_add_u32 v9, s44, v9
    s_waitcnt vmcnt(2)
    s_cmp_lt_u32 s11, 224
    s_cbranch_scc1 F_dp
    s_waitcnt vmcnt(0)
F_dp:
    v_perm_b32 v72, v20, v16, s52
    v_perm_b32 v73, v28, v24, s52
    v_perm_b32 v74, v148, v144, s52
    v_perm_b32 v75, v156, v152, s52
    v_perm_b32 v76, v20, v16, s53
    v_perm_b32 v77, v28, v24, s53
    v_perm_b32 v78, v148, v144, s53
    v_perm_b32 v79, v156, v152, s53
    v_perm_b32 v80, v21, v17, s52
    v_perm_b32 v81, v29, v25, s52
    v_perm_b32 v82, v149, v145, s52
    v_perm_b32 v83, v157, v153, s52
    v_perm_b32 v84, v21, v17, s53
    v_perm_b32 v85, v29, v25, s53
    v_perm_b32 v86, v149, v145, s53
    v_perm_b32 v87, v157, v153, s53
    v_perm_b32 v88, v22, v18, s52
    v_perm_b32 v89, v30, v26, s52
    v_perm_b32 v90, v150, v146, s52
    v_perm_b32 v91, v158, v154, s52
    v_perm_b32 v92, v22, v18, s53
    v_perm_b32 v93, v30, v26, s53
    v_perm_b32 v94, v150, v146, s53
    v_perm_b32 v95, v158, v154, s53
    v_perm_b32 v96, v23, v19, s52
    v_perm_b32 v97, v31, v27, s52
    v_perm_b32 v98, v151, v147, s52
    v_perm_b32 v99, v159, v155, s52
    v_perm_b32 v100, v23, v19, s53
    v_perm_b32 v101, v31, v27, s53
    v_perm_b32 v102, v151, v147, s53
    v_perm_b32 v103, v159, v155, s53
    v_and_b32 v14, 1, v5
    v_lshlrev_b32 v14, 11, v14
    v_lshl_add_u32 v14, v7, 5, v14
    v_lshrrev_b32 v15, 1, v5
    v_lshl_add_u32 v14, v15, 4, v14
    v_add_u32 v14, s44, v14
    s_lshl_b32 s45, s3, 10
    s_add_u32 s45, s45, 32768
    v_add_u32 v15, s45, v3
    v_add_u32 v13, 48, v13
    v_and_b32 v17, 31, v0
    v_lshlrev_b32 v17, 4, v17
    s_mov_b32 s80, s68
    s_mov_b32 s81, s69
    s_mov_b32 s82, 0x400000
    s_mov_b32 s83, 0x00020000
    s_lshl_b32 s46, s3, 2
    v_add_u32 v16, s46, v5
    v_lshlrev_b32 v152, 4, v7
    v_mul_u32_u24 v18, 272, v16
    v_add3_u32 v153, v152, v18, 0
    v_lshl_add_u32 v152, v16, 11, v152
    s_lshl_b32 s78, s28, 17
    s_lshl_b32 s79, s29, 8
    s_add_u32 s78, s78, s79
    s_lshl_b32 s47, s28, 6
    s_add_u32 s47, s47, s46
    s_sub_u32 s47, 2047, s47
    s_mov_b32 s77, 0
    v_mov_b32 v144, 0
    v_mov_b32 v145, 0
    v_mov_b32 v146, 0
    v_mov_b32 v147, 0
    s_and_b32 s46, s60, 0x7ff
    s_sub_u32 s46, s47, s46
    s_and_b32 s45, s46, 0xffffffcc
    s_cbranch_scc1 SD_50
    s_mov_b32 s77, 1
    s_or_b32 s45, s60, 0x4000
    v_mov_b32 v18, s45
    v_cmp_eq_u32 vcc, s46, v5
    s_sub_u32 s46, s46, 16
    s_nop 0
    v_cndmask_b32 v144, v144, v18, vcc
    v_cmp_eq_u32 vcc, s46, v5
    s_sub_u32 s46, s46, 16
    s_nop 0
    v_cndmask_b32 v145, v145, v18, vcc
    v_cmp_eq_u32 vcc, s46, v5
    s_sub_u32 s46, s46, 16
    s_nop 0
    v_cndmask_b32 v146, v146, v18, vcc
    v_cmp_eq_u32 vcc, s46, v5
    s_sub_u32 s46, s46, 16
    s_nop 0
    v_cndmask_b32 v147, v147, v18, vcc
SD_50:
    s_and_b32 s46, s61, 0x7ff
    s_sub_u32 s46, s47, s46
    s_and_b32 s45, s46, 0xffffffcc
    s_cbranch_scc1 SD_51
    s_mov_b32 s77, 1
    s_or_b32 s45, s61, 0x4800
    v_mov_b32 v18, s45
    v_cmp_eq_u32 vcc, s46, v5
    s_sub_u32 s46, s46, 16
    s_nop 0
    v_cndmask_b32 v144, v144, v18, vcc
    v_cmp_eq_u32 vcc, s46, v5
    s_sub_u32 s46, s46, 16
    s_nop 0
    v_cndmask_b32 v145, v145, v18, vcc
    v_cmp_eq_u32 vcc, s46, v5
    s_sub_u32 s46, s46, 16
    s_nop 0
    v_cndmask_b32 v146, v146, v18, vcc
    v_cmp_eq_u32 vcc, s46, v5
    s_sub_u32 s46, s46, 16
    s_nop 0
    v_cndmask_b32 v147, v147, v18, vcc
SD_51:
    s_and_b32 s46, s62, 0x7ff
    s_sub_u32 s46, s47, s46
    s_and_b32 s45, s46, 0xffffffcc
    s_cbranch_scc1 SD_52
    s_mov_b32 s77, 1
    s_or_b32 s45, s62, 0x5000
    v_mov_b32 v18, s45
    v_cmp_eq_u32 vcc, s46, v5
    s_sub_u32 s46, s46, 16
    s_nop 0
    v_cndmask_b32 v144, v144, v18, vcc
    v_cmp_eq_u32 vcc, s46, v5
    s_sub_u32 s46, s46, 16
    s_nop 0
    v_cndmask_b32 v145, v145, v18, vcc
    v_cmp_eq_u32 vcc, s46, v5
    s_sub_u32 s46, s46, 16
    s_nop 0
    v_cndmask_b32 v146, v146, v18, vcc
    v_cmp_eq_u32 vcc, s46, v5
    s_sub_u32 s46, s46, 16
    s_nop 0
    v_cndmask_b32 v147, v147, v18, vcc
SD_52:
    s_and_b32 s46, s63, 0x7ff
    s_sub_u32 s46, s47, s46
    s_and_b32 s45, s46, 0xffffffcc
    s_cbranch_scc1 SD_53
    s_mov_b32 s77, 1
    s_or_b32 s45, s63, 0x5800
    v_mov_b32 v18, s45
    v_cmp_eq_u32 vcc, s46, v5
    s_sub_u32 s46, s46, 16
    s_nop 0
    v_cndmask_b32 v144, v144, v18, vcc
    v_cmp_eq_u32 vcc, s46, v5
    s_sub_u32 s46, s46, 16
    s_nop 0
    v_cndmask_b32 v145, v145, v18, vcc
    v_cmp_eq_u32 vcc, s46, v5
    s_sub_u32 s46, s46, 16
    s_nop 0
    v_cndmask_b32 v146, v146, v18, vcc
    v_cmp_eq_u32 vcc, s46, v5
    s_sub_u32 s46, s46, 16
    s_nop 0
    v_cndmask_b32 v147, v147, v18, vcc
SD_53:
    s_and_b32 s46, s64, 0x7ff
    s_sub_u32 s46, s47, s46
    s_and_b32 s45, s46, 0xffffffcc
    s_cbranch_scc1 SD_54
    s_mov_b32 s77, 1
    s_or_b32 s45, s64, 0x6000
    v_mov_b32 v18, s45
    v_cmp_eq_u32 vcc, s46, v5
    s_sub_u32 s46, s46, 16
    s_nop 0
    v_cndmask_b32 v144, v144, v18, vcc
    v_cmp_eq_u32 vcc, s46, v5
    s_sub_u32 s46, s46, 16
    s_nop 0
    v_cndmask_b32 v145, v145, v18, vcc
    v_cmp_eq_u32 vcc, s46, v5
    s_sub_u32 s46, s46, 16
    s_nop 0
    v_cndmask_b32 v146, v146, v18, vcc
    v_cmp_eq_u32 vcc, s46, v5
    s_sub_u32 s46, s46, 16
    s_nop 0
    v_cndmask_b32 v147, v147, v18, vcc
SD_54:
    s_and_b32 s46, s65, 0x7ff
    s_sub_u32 s46, s47, s46
    s_and_b32 s45, s46, 0xffffffcc
    s_cbranch_scc1 SD_55
    s_mov_b32 s77, 1
    s_or_b32 s45, s65, 0x6800
    v_mov_b32 v18, s45
    v_cmp_eq_u32 vcc, s46, v5
    s_sub_u32 s46, s46, 16
    s_nop 0
    v_cndmask_b32 v144, v144, v18, vcc
    v_cmp_eq_u32 vcc, s46, v5
    s_sub_u32 s46, s46, 16
    s_nop 0
    v_cndmask_b32 v145, v145, v18, vcc
    v_cmp_eq_u32 vcc, s46, v5
    s_sub_u32 s46, s46, 16
    s_nop 0
    v_cndmask_b32 v146, v146, v18, vcc
    v_cmp_eq_u32 vcc, s46, v5
    s_sub_u32 s46, s46, 16
    s_nop 0
    v_cndmask_b32 v147, v147, v18, vcc
SD_55:
    s_and_b32 s46, s66, 0x7ff
    s_sub_u32 s46, s47, s46
    s_and_b32 s45, s46, 0xffffffcc
    s_cbranch_scc1 SD_56
    s_mov_b32 s77, 1
    s_or_b32 s45, s66, 0x7000
    v_mov_b32 v18, s45
    v_cmp_eq_u32 vcc, s46, v5
    s_sub_u32 s46, s46, 16
    s_nop 0
    v_cndmask_b32 v144, v144, v18, vcc
    v_cmp_eq_u32 vcc, s46, v5
    s_sub_u32 s46, s46, 16
    s_nop 0
    v_cndmask_b32 v145, v145, v18, vcc
    v_cmp_eq_u32 vcc, s46, v5
    s_sub_u32 s46, s46, 16
    s_nop 0
    v_cndmask_b32 v146, v146, v18, vcc
    v_cmp_eq_u32 vcc, s46, v5
    s_sub_u32 s46, s46, 16
    s_nop 0
    v_cndmask_b32 v147, v147, v18, vcc
SD_56:
    s_and_b32 s46, s67, 0x7ff
    s_sub_u32 s46, s47, s46
    s_and_b32 s45, s46, 0xffffffcc
    s_cbranch_scc1 SD_57
    s_mov_b32 s77, 1
    s_or_b32 s45, s67, 0x7800
    v_mov_b32 v18, s45
    v_cmp_eq_u32 vcc, s46, v5
    s_sub_u32 s46, s46, 16
    s_nop 0
    v_cndmask_b32 v144, v144, v18, vcc
    v_cmp_eq_u32 vcc, s46, v5
    s_sub_u32 s46, s46, 16
    s_nop 0
    v_cndmask_b32 v145, v145, v18, vcc
    v_cmp_eq_u32 vcc, s46, v5
    s_sub_u32 s46, s46, 16
    s_nop 0
    v_cndmask_b32 v146, v146, v18, vcc
    v_cmp_eq_u32 vcc, s46, v5
    s_sub_u32 s46, s46, 16
    s_nop 0
    v_cndmask_b32 v147, v147, v18, vcc
SD_57:
    s_cmp_eq_u32 s77, 0
    s_cbranch_scc1 F_ys1
    v_lshlrev_b32 v19, 5, v7
    v_cmp_ne_u32 s[60:61], 0, v144
    v_and_b32 v148, 0xffff0000, v144
    v_ashrrev_i32 v18, 31, v148
    v_not_b32 v18, v18
    v_or_b32 v18, 0x80000000, v18
    v_xor_b32 v148, v148, v18
    v_and_b32 v148, 0xffff0000, v148
    v_mul_f32 v148, s48, v148
    v_exp_f32 v148, v148
    s_nop 0
    v_add_f32 v148, 1.0, v148
    v_rcp_f32 v148, v148
    s_nop 0
    v_cvt_pk_bf16_f32 v148, v148, v148
    v_lshlrev_b32 v148, 16, v148
    v_bfe_u32 v144, v144, 11, 3
    v_lshl_add_u32 v144, v144, 12, v19
    v_cmp_ne_u32 s[62:63], 0, v145
    v_and_b32 v149, 0xffff0000, v145
    v_ashrrev_i32 v18, 31, v149
    v_not_b32 v18, v18
    v_or_b32 v18, 0x80000000, v18
    v_xor_b32 v149, v149, v18
    v_and_b32 v149, 0xffff0000, v149
    v_mul_f32 v149, s48, v149
    v_exp_f32 v149, v149
    s_nop 0
    v_add_f32 v149, 1.0, v149
    v_rcp_f32 v149, v149
    s_nop 0
    v_cvt_pk_bf16_f32 v149, v149, v149
    v_lshlrev_b32 v149, 16, v149
    v_bfe_u32 v145, v145, 11, 3
    v_lshl_add_u32 v145, v145, 12, v19
    v_cmp_ne_u32 s[64:65], 0, v146
    v_and_b32 v150, 0xffff0000, v146
    v_ashrrev_i32 v18, 31, v150
    v_not_b32 v18, v18
    v_or_b32 v18, 0x80000000, v18
    v_xor_b32 v150, v150, v18
    v_and_b32 v150, 0xffff0000, v150
    v_mul_f32 v150, s48, v150
    v_exp_f32 v150, v150
    s_nop 0
    v_add_f32 v150, 1.0, v150
    v_rcp_f32 v150, v150
    s_nop 0
    v_cvt_pk_bf16_f32 v150, v150, v150
    v_lshlrev_b32 v150, 16, v150
    v_bfe_u32 v146, v146, 11, 3
    v_lshl_add_u32 v146, v146, 12, v19
    v_cmp_ne_u32 s[66:67], 0, v147
    v_and_b32 v151, 0xffff0000, v147
    v_ashrrev_i32 v18, 31, v151
    v_not_b32 v18, v18
    v_or_b32 v18, 0x80000000, v18
    v_xor_b32 v151, v151, v18
    v_and_b32 v151, 0xffff0000, v151
    v_mul_f32 v151, s48, v151
    v_exp_f32 v151, v151
    s_nop 0
    v_add_f32 v151, 1.0, v151
    v_rcp_f32 v151, v151
    s_nop 0
    v_cvt_pk_bf16_f32 v151, v151, v151
    v_lshlrev_b32 v151, 16, v151
    v_bfe_u32 v147, v147, 11, 3
    v_lshl_add_u32 v147, v147, 12, v19
F_ys1:
SP_58:
    s_load_dword s74, s[56:57], 0 glc
    s_load_dword s75, s[58:59], 0 glc
    s_waitcnt lgkmcnt(0)
    s_min_u32 s74, s74, s75
    s_cmp_ge_u32 s74, 8
    s_cbranch_scc1 SD_59
    s_sleep 16
    s_branch SP_58
SD_59:
F_dl:
    s_add_u32 s45, s38, 0
    buffer_load_dwordx4 v[32:35], v4, s[12:15], s45 offen sc0 sc1
    s_add_u32 s45, s38, 114688
    buffer_load_dwordx4 v[36:39], v4, s[12:15], s45 offen sc0 sc1
    s_add_u32 s45, s38, 229376
    buffer_load_dwordx4 v[40:43], v4, s[12:15], s45 offen sc0 sc1
    s_add_u32 s45, s38, 344064
    buffer_load_dwordx4 v[44:47], v4, s[12:15], s45 offen sc0 sc1
    s_add_u32 s45, s38, 458752
    buffer_load_dwordx4 v[48:51], v4, s[12:15], s45 offen sc0 sc1
    s_add_u32 s45, s38, 573440
    buffer_load_dwordx4 v[52:55], v4, s[12:15], s45 offen sc0 sc1
    s_add_u32 s45, s38, 688128
    buffer_load_dwordx4 v[56:59], v4, s[12:15], s45 offen sc0 sc1
    s_add_u32 s45, s38, 802816
    buffer_load_dwordx4 v[60:63], v4, s[12:15], s45 offen sc0 sc1
    s_waitcnt vmcnt(0)
    s_nop 0
    v_min3_u32 v12, v32, v34, v36
    v_min3_u32 v12, v12, v38, v40
    v_min3_u32 v12, v12, v42, v44
    v_min3_u32 v12, v12, v46, v48
    v_min3_u32 v12, v12, v50, v52
    v_min3_u32 v12, v12, v54, v56
    v_min3_u32 v12, v12, v58, v60
    v_min_u32 v12, v12, v62
    v_cmp_eq_u32 vcc, 0, v12
    s_cbranch_vccz F_dm
    s_sleep 6
    s_branch F_dl
F_dm:
    v_add_f32 v32, v32, v40
    v_add_f32 v48, v48, v56
    v_add_f32 v33, v33, v41
    v_add_f32 v49, v49, v57
    v_add_f32 v34, v34, v42
    v_add_f32 v50, v50, v58
    v_add_f32 v35, v35, v43
    v_add_f32 v51, v51, v59
    v_add_f32 v32, v32, v48
    v_add_f32 v33, v33, v49
    v_add_f32 v34, v34, v50
    v_add_f32 v35, v35, v51
    v_add_f32 v36, v36, v44
    v_add_f32 v52, v52, v60
    v_add_f32 v37, v37, v45
    v_add_f32 v53, v53, v61
    v_add_f32 v38, v38, v46
    v_add_f32 v54, v54, v62
    v_add_f32 v39, v39, v47
    v_add_f32 v55, v55, v63
    v_add_f32 v36, v36, v52
    v_add_f32 v37, v37, v53
    v_add_f32 v38, v38, v54
    v_add_f32 v39, v39, v55
    v_cvt_pk_bf16_f32 v40, v32, v36
    v_cvt_pk_bf16_f32 v41, v33, v37
    v_cvt_pk_bf16_f32 v42, v34, v38
    v_cvt_pk_bf16_f32 v43, v35, v39
    v_lshlrev_b32 v32, 16, v40
    v_and_b32 v36, 0xffff0000, v40
    v_lshlrev_b32 v33, 16, v41
    v_and_b32 v37, 0xffff0000, v41
    v_lshlrev_b32 v34, 16, v42
    v_and_b32 v38, 0xffff0000, v42
    v_lshlrev_b32 v35, 16, v43
    v_and_b32 v39, 0xffff0000, v43
    v_mul_f32 v40, s48, v32
    v_mul_f32 v41, s48, v33
    v_mul_f32 v42, s48, v34
    v_mul_f32 v43, s48, v35
    v_exp_f32 v40, v40
    v_exp_f32 v41, v41
    v_exp_f32 v42, v42
    v_exp_f32 v43, v43
    v_add_f32 v40, 1.0, v40
    v_add_f32 v41, 1.0, v41
    v_add_f32 v42, 1.0, v42
    v_add_f32 v43, 1.0, v43
    v_rcp_f32 v40, v40
    v_rcp_f32 v41, v41
    v_rcp_f32 v42, v42
    v_rcp_f32 v43, v43
    v_mul_f32 v32, v32, v40
    v_mul_f32 v33, v33, v41
    v_mul_f32 v34, v34, v42
    v_mul_f32 v35, v35, v43
    v_cvt_pk_bf16_f32 v32, v32, v32
    v_cvt_pk_bf16_f32 v33, v33, v33
    v_cvt_pk_bf16_f32 v34, v34, v34
    v_cvt_pk_bf16_f32 v35, v35, v35
    v_lshlrev_b32 v32, 16, v32
    v_lshlrev_b32 v33, 16, v33
    v_lshlrev_b32 v34, 16, v34
    v_lshlrev_b32 v35, 16, v35
    v_mul_f32 v32, v32, v36
    v_mul_f32 v33, v33, v37
    v_mul_f32 v34, v34, v38
    v_mul_f32 v35, v35, v39
    v_cvt_pk_bf16_f32 v32, v32, v32
    v_cvt_pk_bf16_f32 v33, v33, v33
    v_cvt_pk_bf16_f32 v34, v34, v34
    v_cvt_pk_bf16_f32 v35, v35, v35
    v_cmp_gt_u32 vcc, 56, v0
    s_nop 0
    s_and_saveexec_b64 s[50:51], vcc
    ds_write_b16 v11, v32 offset:0
    ds_write_b16 v11, v33 offset:64
    ds_write_b16 v11, v34 offset:128
    ds_write_b16 v11, v35 offset:192
    s_mov_b64 exec, s[50:51]
    ds_read_b128 v[64:67], v9
    s_waitcnt lgkmcnt(0)
    v_mfma_f32_16x16x32_bf16 v[104:107], v[64:67], v[72:75], 0
    v_mfma_f32_16x16x32_bf16 v[108:111], v[64:67], v[76:79], 0
    v_mfma_f32_16x16x32_bf16 v[112:115], v[64:67], v[80:83], 0
    v_mfma_f32_16x16x32_bf16 v[116:119], v[64:67], v[84:87], 0
    v_mfma_f32_16x16x32_bf16 v[120:123], v[64:67], v[88:91], 0
    v_mfma_f32_16x16x32_bf16 v[124:127], v[64:67], v[92:95], 0
    v_mfma_f32_16x16x32_bf16 v[128:131], v[64:67], v[96:99], 0
    v_mfma_f32_16x16x32_bf16 v[132:135], v[64:67], v[100:103], 0
    v_cmp_gt_u32 vcc, 32, v0
    s_nop 3
    v_cndmask_b32 v32, v120, v104, vcc
    v_cndmask_b32 v33, v124, v108, vcc
    v_cndmask_b32 v34, v128, v112, vcc
    v_cndmask_b32 v35, v132, v116, vcc
    ds_write_b128 v14, v[32:35] offset:0
    v_cndmask_b32 v36, v121, v105, vcc
    v_cndmask_b32 v37, v125, v109, vcc
    v_cndmask_b32 v38, v129, v113, vcc
    v_cndmask_b32 v39, v133, v117, vcc
    ds_write_b128 v14, v[36:39] offset:512
    v_cndmask_b32 v40, v122, v106, vcc
    v_cndmask_b32 v41, v126, v110, vcc
    v_cndmask_b32 v42, v130, v114, vcc
    v_cndmask_b32 v43, v134, v118, vcc
    ds_write_b128 v14, v[40:43] offset:1024
    v_cndmask_b32 v44, v123, v107, vcc
    v_cndmask_b32 v45, v127, v111, vcc
    v_cndmask_b32 v46, v131, v115, vcc
    v_cndmask_b32 v47, v135, v119, vcc
    ds_write_b128 v14, v[44:47] offset:1536
    v_mov_b32 v4, 1
    s_mov_b64 exec, 1
    ds_write_b32 v10, v4 offset:64
    s_mov_b64 exec, -1
    s_lshl_b32 s45, s29, 7
    s_add_u32 s56, s45, 0x82a000
    s_add_u32 s56, s72, s56
    s_addc_u32 s57, s73, 0
    s_lshl_b32 s44, s3, 13
    s_lshl_b32 s50, s29, 9
    s_add_u32 s50, s50, 135168
    s_add_u32 s44, s44, s50
    s_add_u32 s45, s44, 4096
    ds_read_b32 v12, v13
FW_60:
    s_waitcnt lgkmcnt(0)
    v_cmp_gt_u32 vcc, 1, v12
    s_cbranch_vccz FO_61
    s_sleep 1
    ds_read_b32 v12, v13
    s_branch FW_60
FO_61:
    ds_read2st64_b32 v[48:49], v15 offset0:0 offset1:1
    ds_read2st64_b32 v[52:53], v15 offset0:16 offset1:17
    ds_read2st64_b32 v[56:57], v15 offset0:96 offset1:97
    ds_read2st64_b32 v[60:61], v15 offset0:112 offset1:113
    ds_read2st64_b32 v[50:51], v15 offset0:2 offset1:3
    ds_read2st64_b32 v[54:55], v15 offset0:18 offset1:19
    ds_read2st64_b32 v[58:59], v15 offset0:98 offset1:99
    ds_read2st64_b32 v[62:63], v15 offset0:114 offset1:115
    s_waitcnt lgkmcnt(4)
    v_add_f32 v48, v48, v52
    v_add_f32 v56, v56, v60
    v_add_f32 v48, v48, v56
    buffer_atomic_add_f32 v48, v3, s[24:27], s44 offen offset:0
    v_add_f32 v49, v49, v53
    v_add_f32 v57, v57, v61
    v_add_f32 v49, v49, v57
    buffer_atomic_add_f32 v49, v3, s[24:27], s44 offen offset:256
    s_waitcnt lgkmcnt(0)
    v_add_f32 v50, v50, v54
    v_add_f32 v58, v58, v62
    v_add_f32 v50, v50, v58
    buffer_atomic_add_f32 v50, v3, s[24:27], s45 offen offset:0
    v_add_f32 v51, v51, v55
    v_add_f32 v59, v59, v63
    v_add_f32 v51, v51, v59
    buffer_atomic_add_f32 v51, v3, s[24:27], s45 offen offset:256
    s_barrier
    s_barrier
    s_barrier
    s_barrier
    s_waitcnt vmcnt(0)
    s_barrier
    s_cmp_lg_u32 s3, 0
    s_cbranch_scc1 F_y0
    s_mov_b32 s76, 1
    s_atomic_add s76, s[56:57], 0
F_y0:
    s_barrier
    s_barrier
    s_barrier
    s_barrier
    s_cmp_lg_u32 s77, 0
    s_cbranch_scc1 F_y1
    s_barrier
    s_barrier
    s_barrier
    s_barrier
    s_barrier
    s_barrier
F_y3:
    s_waitcnt lgkmcnt(0)
    s_setprio 3
    s_barrier
    ds_read_b128 v[16:19], v153 offset:0
    s_cmp_lg_u32 s77, 0
    s_waitcnt lgkmcnt(0)
    s_cbranch_scc1 F_ya0
F_yb0:
    buffer_store_dwordx4 v[16:19], v152, s[80:83], s78 offen sc1
    s_add_u32 s78, s78, 32768
    s_barrier
    ds_read_b128 v[20:23], v153 offset:4352
    s_cmp_lg_u32 s77, 0
    s_waitcnt lgkmcnt(0)
    s_cbranch_scc1 F_ya1
F_yb1:
    buffer_store_dwordx4 v[20:23], v152, s[80:83], s78 offen sc1
    s_add_u32 s78, s78, 32768
    s_barrier
    ds_read_b128 v[24:27], v153 offset:8704
    ds_read_b128 v[28:31], v153 offset:13056
    s_cmp_lg_u32 s77, 0
    s_waitcnt lgkmcnt(1)
    s_cbranch_scc1 F_ya2
F_yb2:
    buffer_store_dwordx4 v[24:27], v152, s[80:83], s78 offen sc1
    s_add_u32 s78, s78, 32768
    s_cmp_lg_u32 s77, 0
    s_waitcnt lgkmcnt(0)
    s_cbranch_scc1 F_ya3
F_yb3:
    buffer_store_dwordx4 v[28:31], v152, s[80:83], s78 offen sc1
    s_add_u32 s78, s78, 32768
    s_endpgm
F_y1:
    s_load_dword s58, s[56:57], 0 glc
    s_barrier
    s_barrier
    s_waitcnt lgkmcnt(0)
    s_cmp_lt_u32 s58, 32
    s_cbranch_scc1 F_y2
    s_mov_b64 exec, s[60:61]
    s_cbranch_execz YL_62
    buffer_load_dwordx4 v[72:75], v144, s[24:27], s50 offen offset:0 sc0 sc1
    buffer_load_dwordx4 v[76:79], v144, s[24:27], s50 offen offset:16 sc0 sc1
YL_62:
    s_mov_b64 exec, s[62:63]
    s_cbranch_execz YL_63
    buffer_load_dwordx4 v[80:83], v145, s[24:27], s50 offen offset:0 sc0 sc1
    buffer_load_dwordx4 v[84:87], v145, s[24:27], s50 offen offset:16 sc0 sc1
YL_63:
    s_mov_b64 exec, s[64:65]
    s_cbranch_execz YL_64
    buffer_load_dwordx4 v[88:91], v146, s[24:27], s50 offen offset:0 sc0 sc1
    buffer_load_dwordx4 v[92:95], v146, s[24:27], s50 offen offset:16 sc0 sc1
YL_64:
    s_mov_b64 exec, s[66:67]
    s_cbranch_execz YL_65
    buffer_load_dwordx4 v[96:99], v147, s[24:27], s50 offen offset:0 sc0 sc1
    buffer_load_dwordx4 v[100:103], v147, s[24:27], s50 offen offset:16 sc0 sc1
YL_65:
    s_mov_b64 exec, -1
    s_barrier
    s_barrier
    s_barrier
    s_barrier
    s_branch F_y3
F_y2:
    s_barrier
    s_barrier
    s_barrier
    s_barrier
SP_66:
    s_load_dword s58, s[56:57], 0 glc
    s_waitcnt lgkmcnt(0)
    s_cmp_ge_u32 s58, 32
    s_cbranch_scc1 SD_67
    s_sleep 2
    s_branch SP_66
SD_67:
    s_mov_b64 exec, s[60:61]
    s_cbranch_execz YL_68
    buffer_load_dwordx4 v[72:75], v144, s[24:27], s50 offen offset:0 sc0 sc1
    buffer_load_dwordx4 v[76:79], v144, s[24:27], s50 offen offset:16 sc0 sc1
YL_68:
    s_mov_b64 exec, s[62:63]
    s_cbranch_execz YL_69
    buffer_load_dwordx4 v[80:83], v145, s[24:27], s50 offen offset:0 sc0 sc1
    buffer_load_dwordx4 v[84:87], v145, s[24:27], s50 offen offset:16 sc0 sc1
YL_69:
    s_mov_b64 exec, s[64:65]
    s_cbranch_execz YL_70
    buffer_load_dwordx4 v[88:91], v146, s[24:27], s50 offen offset:0 sc0 sc1
    buffer_load_dwordx4 v[92:95], v146, s[24:27], s50 offen offset:16 sc0 sc1
YL_70:
    s_mov_b64 exec, s[66:67]
    s_cbranch_execz YL_71
    buffer_load_dwordx4 v[96:99], v147, s[24:27], s50 offen offset:0 sc0 sc1
    buffer_load_dwordx4 v[100:103], v147, s[24:27], s50 offen offset:16 sc0 sc1
YL_71:
    s_mov_b64 exec, -1
    s_branch F_y3
F_ya0:
    s_cmp_eq_u64 s[60:61], 0
    s_cbranch_scc1 F_yb0
    s_mov_b64 exec, s[60:61]
    v_lshlrev_b32 v32, 16, v16
    v_and_b32 v33, 0xffff0000, v16
    v_lshlrev_b32 v34, 16, v17
    v_and_b32 v35, 0xffff0000, v17
    v_lshlrev_b32 v36, 16, v18
    v_and_b32 v37, 0xffff0000, v18
    v_lshlrev_b32 v38, 16, v19
    v_and_b32 v39, 0xffff0000, v19
    s_waitcnt vmcnt(0)
    v_fmac_f32 v32, v72, v148
    v_fmac_f32 v33, v73, v148
    v_fmac_f32 v34, v74, v148
    v_fmac_f32 v35, v75, v148
    v_fmac_f32 v36, v76, v148
    v_fmac_f32 v37, v77, v148
    v_fmac_f32 v38, v78, v148
    v_fmac_f32 v39, v79, v148
    v_cvt_pk_bf16_f32 v16, v32, v33
    v_cvt_pk_bf16_f32 v17, v34, v35
    v_cvt_pk_bf16_f32 v18, v36, v37
    v_cvt_pk_bf16_f32 v19, v38, v39
    s_mov_b64 exec, -1
    s_branch F_yb0
F_ya1:
    s_cmp_eq_u64 s[62:63], 0
    s_cbranch_scc1 F_yb1
    s_mov_b64 exec, s[62:63]
    v_lshlrev_b32 v32, 16, v20
    v_and_b32 v33, 0xffff0000, v20
    v_lshlrev_b32 v34, 16, v21
    v_and_b32 v35, 0xffff0000, v21
    v_lshlrev_b32 v36, 16, v22
    v_and_b32 v37, 0xffff0000, v22
    v_lshlrev_b32 v38, 16, v23
    v_and_b32 v39, 0xffff0000, v23
    s_waitcnt vmcnt(1)
    v_fmac_f32 v32, v80, v149
    v_fmac_f32 v33, v81, v149
    v_fmac_f32 v34, v82, v149
    v_fmac_f32 v35, v83, v149
    v_fmac_f32 v36, v84, v149
    v_fmac_f32 v37, v85, v149
    v_fmac_f32 v38, v86, v149
    v_fmac_f32 v39, v87, v149
    v_cvt_pk_bf16_f32 v20, v32, v33
    v_cvt_pk_bf16_f32 v21, v34, v35
    v_cvt_pk_bf16_f32 v22, v36, v37
    v_cvt_pk_bf16_f32 v23, v38, v39
    s_mov_b64 exec, -1
    s_branch F_yb1
F_ya2:
    s_cmp_eq_u64 s[64:65], 0
    s_cbranch_scc1 F_yb2
    s_mov_b64 exec, s[64:65]
    v_lshlrev_b32 v32, 16, v24
    v_and_b32 v33, 0xffff0000, v24
    v_lshlrev_b32 v34, 16, v25
    v_and_b32 v35, 0xffff0000, v25
    v_lshlrev_b32 v36, 16, v26
    v_and_b32 v37, 0xffff0000, v26
    v_lshlrev_b32 v38, 16, v27
    v_and_b32 v39, 0xffff0000, v27
    s_waitcnt vmcnt(2)
    v_fmac_f32 v32, v88, v150
    v_fmac_f32 v33, v89, v150
    v_fmac_f32 v34, v90, v150
    v_fmac_f32 v35, v91, v150
    v_fmac_f32 v36, v92, v150
    v_fmac_f32 v37, v93, v150
    v_fmac_f32 v38, v94, v150
    v_fmac_f32 v39, v95, v150
    v_cvt_pk_bf16_f32 v24, v32, v33
    v_cvt_pk_bf16_f32 v25, v34, v35
    v_cvt_pk_bf16_f32 v26, v36, v37
    v_cvt_pk_bf16_f32 v27, v38, v39
    s_mov_b64 exec, -1
    s_branch F_yb2
F_ya3:
    s_cmp_eq_u64 s[66:67], 0
    s_cbranch_scc1 F_yb3
    s_mov_b64 exec, s[66:67]
    v_lshlrev_b32 v32, 16, v28
    v_and_b32 v33, 0xffff0000, v28
    v_lshlrev_b32 v34, 16, v29
    v_and_b32 v35, 0xffff0000, v29
    v_lshlrev_b32 v36, 16, v30
    v_and_b32 v37, 0xffff0000, v30
    v_lshlrev_b32 v38, 16, v31
    v_and_b32 v39, 0xffff0000, v31
    s_waitcnt vmcnt(3)
    v_fmac_f32 v32, v96, v151
    v_fmac_f32 v33, v97, v151
    v_fmac_f32 v34, v98, v151
    v_fmac_f32 v35, v99, v151
    v_fmac_f32 v36, v100, v151
    v_fmac_f32 v37, v101, v151
    v_fmac_f32 v38, v102, v151
    v_fmac_f32 v39, v103, v151
    v_cvt_pk_bf16_f32 v28, v32, v33
    v_cvt_pk_bf16_f32 v29, v34, v35
    v_cvt_pk_bf16_f32 v30, v36, v37
    v_cvt_pk_bf16_f32 v31, v38, v39
    s_mov_b64 exec, -1
    s_branch F_yb3
F_codeend:
.section .rodata,"a"
.p2align 6
.amdhsa_kernel parallel_sum__linear_attn_block__moe_arch_mod__prompt_kernel
  .amdhsa_next_free_vgpr 168
  .amdhsa_next_free_sgpr 96
  .amdhsa_accum_offset 168
  .amdhsa_group_segment_fixed_size 0
  .amdhsa_kernarg_size 88
  .amdhsa_user_sgpr_count 2
  .amdhsa_user_sgpr_kernarg_segment_ptr 1
  .amdhsa_system_sgpr_workgroup_id_x 1
  .amdhsa_float_denorm_mode_32 3
  .amdhsa_float_denorm_mode_16_64 3
.end_amdhsa_kernel
```

```asm
; @launch grid=(256,1,1) block=(768,1,1) lds=163840
.amdgcn_target "amdgcn-amd-amdhsa--gfx950"
.text
.globl parallel_sum__linear_attn_block__moe_arch_mod__prompt_kernel
.p2align 8
.type parallel_sum__linear_attn_block__moe_arch_mod__prompt_kernel,@function
parallel_sum__linear_attn_block__moe_arch_mod__prompt_kernel:
    s_load_dwordx4 s[4:7], s[0:1], 0
    s_load_dwordx8 s[60:67], s[0:1], 32
    s_load_dwordx2 s[72:73], s[0:1], 80
    s_load_dwordx4 s[68:71], s[0:1], 64
    s_load_dwordx2 s[8:9], s[0:1], 16
    s_cmp_ge_u32 s2, 256
    s_cbranch_scc1 F_end
    v_lshrrev_b32 v1, 6, v0
    v_and_b32 v0, 63, v0
    s_and_b32 s30, s2, 7
    v_readfirstlane_b32 s3, v1
    s_lshr_b32 s31, s2, 3
    s_and_b32 s32, s30, 1
    s_lshl_b32 s32, s32, 3
    s_and_b32 s35, s31, 7
    s_add_u32 s32, s32, s35
    s_lshr_b32 s33, s30, 1
    s_lshl_b32 s33, s33, 2
    s_lshr_b32 s34, s31, 3
    s_xor_b32 s34, s34, 0
    s_add_u32 s33, s33, s34
    s_lshl_b32 s28, s32, 1
    s_bfe_u32 s29, s30, 0x10001
    s_add_u32 s28, s28, s29
    s_lshl_b32 s29, s30, 2
    s_xor_b32 s29, s29, s30
    s_and_b32 s29, s29, 4
    s_add_u32 s29, s29, s34
    s_lshl_b32 s39, s29, 1
    s_xor_b32 s39, s39, 14
    s_add_u32 s10, s33, 4
    s_and_b32 s10, s10, 15
    v_lshlrev_b32 v2, 4, v0
    s_cmp_ge_u32 s3, 8
    s_cbranch_scc1 F_loader
    s_lshl_b32 s77, s32, 4
    s_add_u32 s77, s77, s33
    s_lshl_b32 s77, s77, 3
    s_add_u32 s77, s77, s3
    s_cmp_lg_u32 s3, 7
    s_cbranch_scc1 F_nt
    s_getpc_b64 s[46:47]
F_pc:
    s_sub_u32 s46, s46, F_pc-parallel_sum__linear_attn_block__moe_arch_mod__prompt_kernel
    s_subb_u32 s47, s47, 0
    s_and_b32 s44, s31, 7
    s_lshl_b32 s44, s44, 13
    v_min_u32 v60, 63, v0
    v_lshlrev_b32 v60, 7, v60
    v_add_u32_e64 v60, s44, v60
    v_min_u32 v60, F_codeend-parallel_sum__linear_attn_block__moe_arch_mod__prompt_kernel-4, v60
    global_load_dword v161, v60, s[46:47]
F_nt:
    s_lshl_b32 s44, s77, 11
    s_waitcnt lgkmcnt(0)

    s_mov_b32 s20, s4
    s_mov_b32 s21, s5
    s_mov_b32 s22, 0x400000
    s_mov_b32 s23, 0x00020000
    buffer_load_dwordx4 v[4:7], v2, s[20:23], s44 offen
    buffer_load_dwordx4 v[8:11], v2, s[20:23], s44 offen offset:1024
    s_mov_b32 s16, s60
    s_mov_b32 s17, s61
    s_mov_b32 s18, 0x800
    s_mov_b32 s19, 0x00020000
    buffer_load_dwordx4 v[12:15], v2, s[16:19], 0 offen
    buffer_load_dwordx4 v[16:19], v2, s[16:19], 0 offen offset:1024
    s_add_u32 s24, s72, 0x800000
    s_addc_u32 s25, s73, 0
    s_mov_b32 s26, 0x100000
    s_mov_b32 s27, 0x00020000
    s_add_u32 s40, s72, 0x900000
    s_addc_u32 s41, s73, 0
    s_mov_b32 s42, 0x18000
    s_mov_b32 s43, 0x00020000
    s_mov_b32 s48, s70
    s_mov_b32 s49, s71
    s_mov_b32 s50, 0x100
    s_mov_b32 s51, 0x00020000
    v_mov_b32 v20, 0
    v_mov_b32 v21, 0
    v_mov_b32 v22, 0
    v_mov_b32 v23, 0
    s_cmp_lg_u32 s3, 5
    s_cbranch_scc1 F_a0
    s_cmp_lg_u32 s33, 0
    s_cbranch_scc1 F_a0
    s_lshl_b32 s44, s32, 8
    s_add_u32 s44, s44, 32768
    s_lshl_b32 s45, s32, 2
    s_mov_b64 exec, 0xffff
    buffer_store_dwordx4 v[20:23], v2, s[40:43], s44 offen sc0 sc1
    s_mov_b64 exec, 1
    s_waitcnt vmcnt(0)
    v_mov_b32 v24, 1
    buffer_store_dword v24, v20, s[48:51], s45 offen sc0 sc1
    s_mov_b64 exec, -1
    s_branch F_a1
F_a0:

    s_cmp_ge_u32 s3, 4
    s_cbranch_scc1 F_z1
    v_mov_b64 v[68:69], 0
    v_mov_b64 v[70:71], 0
    v_mov_b64 v[72:73], 0
    v_mov_b64 v[74:75], 0
    v_mov_b64 v[76:77], 0
    v_mov_b64 v[78:79], 0
    v_mov_b64 v[80:81], 0
    v_mov_b64 v[82:83], 0
    v_mov_b64 v[84:85], 0
    v_mov_b64 v[86:87], 0
    v_mov_b64 v[88:89], 0
    v_mov_b64 v[90:91], 0
    v_mov_b64 v[92:93], 0
    v_mov_b64 v[94:95], 0
    v_mov_b64 v[96:97], 0
    v_mov_b64 v[98:99], 0
    v_mov_b64 v[100:101], 0
    v_mov_b64 v[102:103], 0
    v_mov_b64 v[104:105], 0
    v_mov_b64 v[106:107], 0
    v_mov_b64 v[108:109], 0
    v_mov_b64 v[110:111], 0
    v_mov_b64 v[112:113], 0
    v_mov_b64 v[114:115], 0
    v_mov_b64 v[116:117], 0
    v_mov_b64 v[118:119], 0
    v_mov_b64 v[120:121], 0
    v_mov_b64 v[122:123], 0
    v_mov_b64 v[124:125], 0
    v_mov_b64 v[126:127], 0
    v_mov_b64 v[128:129], 0
    v_mov_b64 v[130:131], 0
    v_mov_b64 v[132:133], 0
    v_mov_b64 v[134:135], 0
    v_mov_b64 v[136:137], 0
    v_mov_b64 v[138:139], 0
    v_mov_b64 v[140:141], 0
    v_mov_b64 v[142:143], 0
    v_mov_b64 v[144:145], 0
    v_mov_b64 v[146:147], 0
    v_mov_b64 v[148:149], 0
    v_mov_b64 v[150:151], 0
    v_mov_b64 v[152:153], 0
    v_mov_b64 v[154:155], 0
    v_mov_b64 v[156:157], 0
    v_mov_b64 v[158:159], 0
    v_mov_b64 v[160:161], 0
    v_mov_b64 v[162:163], 0
F_z1:
    s_waitcnt vmcnt(0)
F_a1:

    v_lshlrev_b32 v24, 16, v4
    v_and_b32 v25, 0xffff0000, v4
    v_lshlrev_b32 v26, 16, v5
    v_and_b32 v27, 0xffff0000, v5
    v_lshlrev_b32 v28, 16, v6
    v_and_b32 v29, 0xffff0000, v6
    v_lshlrev_b32 v30, 16, v7
    v_and_b32 v31, 0xffff0000, v7
    v_lshlrev_b32 v32, 16, v8
    v_and_b32 v33, 0xffff0000, v8
    v_lshlrev_b32 v34, 16, v9
    v_and_b32 v35, 0xffff0000, v9
    v_lshlrev_b32 v36, 16, v10
    v_and_b32 v37, 0xffff0000, v10
    v_lshlrev_b32 v38, 16, v11
    v_and_b32 v39, 0xffff0000, v11
    v_add_f32 v40, v24, v25
    v_add_f32 v41, v26, v27
    v_add_f32 v42, v28, v29
    v_add_f32 v43, v30, v31
    v_add_f32 v44, v32, v33
    v_add_f32 v45, v34, v35
    v_add_f32 v46, v36, v37
    v_add_f32 v47, v38, v39
    v_add_f32 v40, v40, v44
    v_add_f32 v41, v41, v45
    v_add_f32 v42, v42, v46
    v_add_f32 v43, v43, v47
    v_add_f32 v40, v40, v42
    v_add_f32 v41, v41, v43
    v_add_f32 v40, v40, v41
    s_nop 1
    v_add_f32_dpp v40, v40, v40 row_shr:1 row_mask:0xf bank_mask:0xf bound_ctrl:0
    s_nop 1
    v_add_f32_dpp v40, v40, v40 row_shr:2 row_mask:0xf bank_mask:0xf bound_ctrl:0
    s_nop 1
    v_add_f32_dpp v40, v40, v40 row_shr:4 row_mask:0xf bank_mask:0xf bound_ctrl:0
    s_nop 1
    v_add_f32_dpp v40, v40, v40 row_shr:8 row_mask:0xf bank_mask:0xf bound_ctrl:0
    s_nop 1
    v_add_f32_dpp v40, v40, v40 row_bcast:15 row_mask:0xa bank_mask:0xf
    s_nop 1
    v_add_f32_dpp v40, v40, v40 row_bcast:31 row_mask:0xc bank_mask:0xf
    s_nop 0
    v_readlane_b32 s52, v40, 63
    v_mov_b32 v41, 0x3a800000
    s_nop 0
    v_mul_f32 v41, s52, v41
    v_sub_f32 v44, v24, v41
    v_sub_f32 v45, v25, v41
    v_sub_f32 v46, v26, v41
    v_sub_f32 v47, v27, v41
    v_sub_f32 v48, v28, v41
    v_sub_f32 v49, v29, v41
    v_sub_f32 v50, v30, v41
    v_sub_f32 v51, v31, v41
    v_sub_f32 v52, v32, v41
    v_sub_f32 v53, v33, v41
    v_sub_f32 v54, v34, v41
    v_sub_f32 v55, v35, v41
    v_sub_f32 v56, v36, v41
    v_sub_f32 v57, v37, v41
    v_sub_f32 v58, v38, v41
    v_sub_f32 v59, v39, v41
    v_mul_f32 v40, v44, v44
    v_mul_f32 v42, v45, v45
    v_fmac_f32 v40, v46, v46
    v_fmac_f32 v42, v47, v47
    v_fmac_f32 v40, v48, v48
    v_fmac_f32 v42, v49, v49
    v_fmac_f32 v40, v50, v50
    v_fmac_f32 v42, v51, v51
    v_fmac_f32 v40, v52, v52
    v_fmac_f32 v42, v53, v53
    v_fmac_f32 v40, v54, v54
    v_fmac_f32 v42, v55, v55
    v_fmac_f32 v40, v56, v56
    v_fmac_f32 v42, v57, v57
    v_fmac_f32 v40, v58, v58
    v_fmac_f32 v42, v59, v59
    v_add_f32 v40, v40, v42
    s_nop 1
    v_add_f32_dpp v40, v40, v40 row_shr:1 row_mask:0xf bank_mask:0xf bound_ctrl:0
    s_nop 1
    v_add_f32_dpp v40, v40, v40 row_shr:2 row_mask:0xf bank_mask:0xf bound_ctrl:0
    s_nop 1
    v_add_f32_dpp v40, v40, v40 row_shr:4 row_mask:0xf bank_mask:0xf bound_ctrl:0
    s_nop 1
    v_add_f32_dpp v40, v40, v40 row_shr:8 row_mask:0xf bank_mask:0xf bound_ctrl:0
    s_nop 1
    v_add_f32_dpp v40, v40, v40 row_bcast:15 row_mask:0xa bank_mask:0xf
    s_nop 1
    v_add_f32_dpp v40, v40, v40 row_bcast:31 row_mask:0xc bank_mask:0xf
    s_nop 0
    v_readlane_b32 s52, v40, 63
    v_mov_b32 v42, 0x3a800000
    s_nop 0
    v_mul_f32 v42, s52, v42
    v_cvt_pk_bf16_f32 v43, v41, v42
    v_lshlrev_b32 v41, 16, v43
    v_and_b32 v42, 0xffff0000, v43
    v_add_f32 v42, 0x3727c5ac, v42
    v_cvt_pk_bf16_f32 v42, v42, v42
    v_lshlrev_b32 v42, 16, v42
    v_sqrt_f32 v42, v42
    s_nop 0
    v_cvt_pk_bf16_f32 v42, v42, v42
    v_lshlrev_b32 v42, 16, v42
    v_rcp_f32 v42, v42
    v_sub_f32 v24, v24, v41
    v_sub_f32 v25, v25, v41
    v_sub_f32 v26, v26, v41
    v_sub_f32 v27, v27, v41
    v_sub_f32 v28, v28, v41
    v_sub_f32 v29, v29, v41
    v_sub_f32 v30, v30, v41
    v_sub_f32 v31, v31, v41
    v_sub_f32 v32, v32, v41
    v_sub_f32 v33, v33, v41
    v_sub_f32 v34, v34, v41
    v_sub_f32 v35, v35, v41
    v_sub_f32 v36, v36, v41
    v_sub_f32 v37, v37, v41
    v_sub_f32 v38, v38, v41
    v_sub_f32 v39, v39, v41
    v_cvt_pk_bf16_f32 v4, v24, v25
    v_cvt_pk_bf16_f32 v5, v26, v27
    v_cvt_pk_bf16_f32 v6, v28, v29
    v_cvt_pk_bf16_f32 v7, v30, v31
    v_cvt_pk_bf16_f32 v8, v32, v33
    v_cvt_pk_bf16_f32 v9, v34, v35
    v_cvt_pk_bf16_f32 v10, v36, v37
    v_cvt_pk_bf16_f32 v11, v38, v39
    v_lshlrev_b32 v24, 16, v4
    v_and_b32 v25, 0xffff0000, v4
    v_lshlrev_b32 v26, 16, v5
    v_and_b32 v27, 0xffff0000, v5
    v_lshlrev_b32 v28, 16, v6
    v_and_b32 v29, 0xffff0000, v6
    v_lshlrev_b32 v30, 16, v7
    v_and_b32 v31, 0xffff0000, v7
    v_lshlrev_b32 v32, 16, v8
    v_and_b32 v33, 0xffff0000, v8
    v_lshlrev_b32 v34, 16, v9
    v_and_b32 v35, 0xffff0000, v9
    v_lshlrev_b32 v36, 16, v10
    v_and_b32 v37, 0xffff0000, v10
    v_lshlrev_b32 v38, 16, v11
    v_and_b32 v39, 0xffff0000, v11
    v_mul_f32 v24, v24, v42
    v_mul_f32 v25, v25, v42
    v_mul_f32 v26, v26, v42
    v_mul_f32 v27, v27, v42
    v_mul_f32 v28, v28, v42
    v_mul_f32 v29, v29, v42
    v_mul_f32 v30, v30, v42
    v_mul_f32 v31, v31, v42
    v_mul_f32 v32, v32, v42
    v_mul_f32 v33, v33, v42
    v_mul_f32 v34, v34, v42
    v_mul_f32 v35, v35, v42
    v_mul_f32 v36, v36, v42
    v_mul_f32 v37, v37, v42
    v_mul_f32 v38, v38, v42
    v_mul_f32 v39, v39, v42
    v_cvt_pk_bf16_f32 v4, v24, v25
    v_cvt_pk_bf16_f32 v5, v26, v27
    v_cvt_pk_bf16_f32 v6, v28, v29
    v_cvt_pk_bf16_f32 v7, v30, v31
    v_cvt_pk_bf16_f32 v8, v32, v33
    v_cvt_pk_bf16_f32 v9, v34, v35
    v_cvt_pk_bf16_f32 v10, v36, v37
    v_cvt_pk_bf16_f32 v11, v38, v39
    v_mov_b32 v40, 0
    v_mov_b32 v43, 0
    v_dot2_f32_bf16 v40, v4, v12, v40
    v_dot2_f32_bf16 v43, v5, v13, v43
    v_dot2_f32_bf16 v40, v6, v14, v40
    v_dot2_f32_bf16 v43, v7, v15, v43
    v_dot2_f32_bf16 v40, v8, v16, v40
    v_dot2_f32_bf16 v43, v9, v17, v43
    v_dot2_f32_bf16 v40, v10, v18, v40
    v_dot2_f32_bf16 v43, v11, v19, v43
    s_nop 2
    v_add_f32 v40, v40, v43
    s_nop 1
    v_add_f32_dpp v40, v40, v40 row_shr:1 row_mask:0xf bank_mask:0xf bound_ctrl:0
    s_nop 1
    v_add_f32_dpp v40, v40, v40 row_shr:2 row_mask:0xf bank_mask:0xf bound_ctrl:0
    s_nop 1
    v_add_f32_dpp v40, v40, v40 row_shr:4 row_mask:0xf bank_mask:0xf bound_ctrl:0
    s_nop 1
    v_add_f32_dpp v40, v40, v40 row_shr:8 row_mask:0xf bank_mask:0xf bound_ctrl:0
    s_nop 1
    v_add_f32_dpp v40, v40, v40 row_bcast:15 row_mask:0xa bank_mask:0xf
    s_nop 1
    v_add_f32_dpp v40, v40, v40 row_bcast:31 row_mask:0xc bank_mask:0xf
    s_nop 0
    v_readlane_b32 s52, v40, 63
    s_nop 1
    v_mov_b32 v44, s52
    v_cvt_pk_bf16_f32 v44, v44, v44
    v_and_b32 v44, 0xffff0000, v44
    v_ashrrev_i32 v45, 31, v44
    v_or_b32 v45, 0x80000000, v45
    v_xor_b32 v44, v44, v45
    v_and_b32 v44, 0xffff0000, v44
    s_sub_u32 s44, 2047, s77
    v_or_b32 v44, s44, v44
    v_xor_b32 v46, 0x80000000, v41
    v_mov_b32 v47, v42
    v_mul_f32 v48, 0x3fb8aa3b, v42
    s_lshl_b32 s44, s77, 2
    s_lshl_b32 s45, s77, 4
    s_add_u32 s45, s45, 65536
    v_mov_b32 v45, 0
    s_mov_b64 exec, 1
    buffer_store_dword v44, v45, s[40:43], s44 offen sc0 sc1
    buffer_store_dwordx3 v[46:48], v45, s[40:43], s45 offen sc0 sc1
    s_mov_b64 exec, -1

    s_cmp_ge_u32 s3, 4
    s_cbranch_scc1 F_aux
    s_branch F_k
.p2align 12
F_k:
    s_setprio 2
    s_lshr_b32 s36, s3, 1
    s_and_b32 s37, s3, 1
    s_lshl_b32 s38, s36, 13
    s_lshl_b32 s42, s37, 1

    v_and_b32 v1, 15, v0
    v_lshrrev_b32 v2, 4, v0
    v_lshrrev_b32 v3, 1, v1
    v_xor_b32 v3, v3, v2
    v_lshlrev_b32 v3, 4, v3
    v_lshlrev_b32 v1, 7, v1
    v_add3_u32 v4, v1, v3, s38
    v_xor_b32 v5, 64, v4
    v_add_u32 v6, 81920, v4
    v_add_u32 v7, 81920, v5
    v_bfe_u32 v1, v0, 2, 2
    v_lshl_add_u32 v3, v2, 3, v1
    v_lshrrev_b32 v1, 1, v1
    v_and_b32 v2, 1, v2
    v_lshl_add_u32 v1, v2, 1, v1
    v_xor_b32 v1, s42, v1
    v_lshlrev_b32 v1, 5, v1
    v_lshl_add_u32 v1, v3, 7, v1
    v_and_b32 v2, 3, v0
    v_lshl_add_u32 v1, v2, 3, v1

    v_add_u32 v8, 16384, v1
    v_xor_b32 v9, 32, v8
    v_add_u32 v10, 81920, v8
    v_add_u32 v11, 81920, v9
    s_mov_b32 s40, 0x3f800008
    s_mov_b32 s41, s40
    s_mov_b32 s74, 0x358637bd
    s_mov_b32 s75, s74
    s_lshl_b32 s42, s36, 8
    s_add_u32 s42, s42, 24832
    v_and_or_b32 v164, v0, 48, s42
    v_and_b32 v165, 15, v0
    s_lshl_b32 s42, s37, 7
    s_add_u32 s42, s42, 26368
    v_lshl_add_u32 v165, v165, 2, s42
    s_lshl_b32 s42, s3, 12
    s_add_u32 s42, s42, 65536
    v_lshl_add_u32 v1, v0, 4, s42
    s_lshl_b32 s42, s3, 7
    s_add_u32 s42, s42, 27136
    v_and_or_b32 v2, v0, 48, s42
    s_lshl_b32 s42, s3, 2
    s_add_u32 s42, s42, 24640
    v_mov_b32_e64 v3, s42
    s_lshl_b32 s46, s28, 6
    s_lshl_b32 s78, s10, 1
    s_add_u32 s78, s78, s37
    s_lshl_b32 s79, s32, 18
    s_lshl_b32 s80, s36, 17
    s_add_u32 s79, s79, s80
    s_lshl_b32 s80, s78, 10
    s_add_u32 s79, s79, s80
    s_lshl_b32 s45, s32, 1
    s_add_u32 s45, s45, s36
    s_mul_i32 s45, s45, 8*64
    s_add_u32 s45, s45, 225280
    s_mul_i32 s82, s78, 4224
    s_add_u32 s83, s82, 4096
    s_lshl_b32 s50, s78, 4
    s_and_b32 s44, s32, 4-1
    s_mul_i32 s44, s44, 16/4
    s_add_u32 s50, s50, s44
    s_mul_i32 s50, s50, 64

    s_add_u32 s56, s50, 0x82f000
    s_add_u32 s56, s72, s56
    s_addc_u32 s57, s73, 0
    s_add_u32 s16, s72, 0x400000
    s_addc_u32 s17, s73, 0
    s_mov_b32 s18, 0x400000
    s_mov_b32 s19, 0x00020000
    s_add_u32 s68, s45, 0x800000
    s_add_u32 s68, s72, s68
    s_addc_u32 s69, s73, 0
    s_mov_b32 s76, 1
    s_barrier
    ds_read_b64_tr_b16 v[44:45], v8 offset:8192
    ds_read_b64_tr_b16 v[46:47], v8 offset:8704
    ds_read_b64_tr_b16 v[48:49], v8 offset:12288
    ds_read_b64_tr_b16 v[50:51], v8 offset:12800
    ds_read_b128 v[12:15], v4 offset:0
    ds_read_b128 v[28:31], v5 offset:0
    ds_read_b128 v[16:19], v4 offset:2048
    ds_read_b128 v[32:35], v5 offset:2048
    ds_read_b128 v[20:23], v4 offset:4096
    ds_read_b128 v[36:39], v5 offset:4096
    ds_read_b64_tr_b16 v[52:53], v9 offset:8192
    ds_read_b64_tr_b16 v[54:55], v9 offset:8704
    ds_read_b128 v[24:27], v4 offset:6144
    ds_read_b128 v[40:43], v5 offset:6144
    s_waitcnt lgkmcnt(14)
    s_mov_b32 s81, 3
F_p1:
    s_waitcnt lgkmcnt(7)
    v_mfma_f32_16x16x32_bf16 v[100:103], v[12:15], v[44:47], v[100:103]
    ds_read_b64_tr_b16 v[56:57], v9 offset:12288
    v_mfma_f32_16x16x32_bf16 v[100:103], v[28:31], v[48:51], v[100:103]
    ds_read_b64_tr_b16 v[58:59], v9 offset:12800
    v_mfma_f32_16x16x32_bf16 v[104:107], v[16:19], v[44:47], v[104:107]
    ds_read_b64_tr_b16 v[60:61], v8 offset:16384
    s_waitcnt lgkmcnt(9)
    v_mfma_f32_16x16x32_bf16 v[104:107], v[32:35], v[48:51], v[104:107]
    ds_read_b64_tr_b16 v[62:63], v8 offset:16896
    s_waitcnt lgkmcnt(9)
    v_mfma_f32_16x16x32_bf16 v[108:111], v[20:23], v[44:47], v[108:111]
    ds_read_b64_tr_b16 v[64:65], v8 offset:20480
    s_waitcnt lgkmcnt(9)
    v_mfma_f32_16x16x32_bf16 v[108:111], v[36:39], v[48:51], v[108:111]
    ds_read_b64_tr_b16 v[66:67], v8 offset:20992
    s_waitcnt lgkmcnt(7)
    v_mfma_f32_16x16x32_bf16 v[112:115], v[24:27], v[44:47], v[112:115]
    ds_read_b64_tr_b16 v[44:45], v9 offset:16384
    s_waitcnt lgkmcnt(7)
    v_mfma_f32_16x16x32_bf16 v[112:115], v[40:43], v[48:51], v[112:115]
    ds_read_b64_tr_b16 v[46:47], v9 offset:16896
    v_mfma_f32_16x16x32_bf16 v[116:119], v[12:15], v[52:55], v[116:119]
    ds_read_b64_tr_b16 v[48:49], v9 offset:20480
    s_waitcnt lgkmcnt(7)
    v_mfma_f32_16x16x32_bf16 v[116:119], v[28:31], v[56:59], v[116:119]
    ds_read_b64_tr_b16 v[50:51], v9 offset:20992
    v_mfma_f32_16x16x32_bf16 v[120:123], v[16:19], v[52:55], v[120:123]
    v_mfma_f32_16x16x32_bf16 v[120:123], v[32:35], v[56:59], v[120:123]
    v_mfma_f32_16x16x32_bf16 v[124:127], v[20:23], v[52:55], v[124:127]
    v_mfma_f32_16x16x32_bf16 v[124:127], v[36:39], v[56:59], v[124:127]
    v_mfma_f32_16x16x32_bf16 v[128:131], v[24:27], v[52:55], v[128:131]
    ds_read_b64_tr_b16 v[52:53], v8 offset:0
    v_mfma_f32_16x16x32_bf16 v[128:131], v[40:43], v[56:59], v[128:131]
    ds_read_b64_tr_b16 v[54:55], v8 offset:512
    s_waitcnt lgkmcnt(5)
    v_mfma_f32_16x16x32_bf16 v[132:135], v[12:15], v[60:63], v[132:135]
    ds_read_b64_tr_b16 v[56:57], v8 offset:4096
    v_mfma_f32_16x16x32_bf16 v[132:135], v[28:31], v[64:67], v[132:135]
    ds_read_b64_tr_b16 v[58:59], v8 offset:4608
    v_mfma_f32_16x16x32_bf16 v[136:139], v[16:19], v[60:63], v[136:139]
    v_mfma_f32_16x16x32_bf16 v[136:139], v[32:35], v[64:67], v[136:139]
    v_mfma_f32_16x16x32_bf16 v[140:143], v[20:23], v[60:63], v[140:143]
    v_mfma_f32_16x16x32_bf16 v[140:143], v[36:39], v[64:67], v[140:143]
    v_mfma_f32_16x16x32_bf16 v[144:147], v[24:27], v[60:63], v[144:147]
    ds_read_b64_tr_b16 v[60:61], v9 offset:0
    v_mfma_f32_16x16x32_bf16 v[144:147], v[40:43], v[64:67], v[144:147]
    ds_read_b64_tr_b16 v[62:63], v9 offset:512
    s_waitcnt lgkmcnt(5)
    v_mfma_f32_16x16x32_bf16 v[148:151], v[12:15], v[44:47], v[148:151]
    ds_read_b64_tr_b16 v[64:65], v9 offset:4096
    v_mfma_f32_16x16x32_bf16 v[148:151], v[28:31], v[48:51], v[148:151]
    ds_read_b64_tr_b16 v[66:67], v9 offset:4608
    v_mfma_f32_16x16x32_bf16 v[152:155], v[16:19], v[44:47], v[152:155]
    v_mfma_f32_16x16x32_bf16 v[152:155], v[32:35], v[48:51], v[152:155]
    v_mfma_f32_16x16x32_bf16 v[156:159], v[20:23], v[44:47], v[156:159]
    v_mfma_f32_16x16x32_bf16 v[156:159], v[36:39], v[48:51], v[156:159]
    s_waitcnt lgkmcnt(0)
    s_barrier
    v_mfma_f32_16x16x32_bf16 v[160:163], v[24:27], v[44:47], v[160:163]
    ds_read_b64_tr_b16 v[44:45], v8 offset:49152
    v_mfma_f32_16x16x32_bf16 v[160:163], v[40:43], v[48:51], v[160:163]
    ds_read_b64_tr_b16 v[46:47], v8 offset:49664
    v_mfma_f32_16x16x32_bf16 v[68:71], v[52:55], v[12:15], v[68:71]
    ds_read_b64_tr_b16 v[48:49], v8 offset:53248
    v_mfma_f32_16x16x32_bf16 v[68:71], v[56:59], v[28:31], v[68:71]
    ds_read_b64_tr_b16 v[50:51], v8 offset:53760
    v_mfma_f32_16x16x32_bf16 v[84:87], v[60:63], v[12:15], v[84:87]
    ds_read_b128 v[12:15], v4 offset:40960
    v_mfma_f32_16x16x32_bf16 v[84:87], v[64:67], v[28:31], v[84:87]
    ds_read_b128 v[28:31], v5 offset:40960
    v_mfma_f32_16x16x32_bf16 v[72:75], v[52:55], v[16:19], v[72:75]
    v_mfma_f32_16x16x32_bf16 v[72:75], v[56:59], v[32:35], v[72:75]
    v_mfma_f32_16x16x32_bf16 v[88:91], v[60:63], v[16:19], v[88:91]
    ds_read_b128 v[16:19], v4 offset:43008
    v_mfma_f32_16x16x32_bf16 v[88:91], v[64:67], v[32:35], v[88:91]
    ds_read_b128 v[32:35], v5 offset:43008
    v_mfma_f32_16x16x32_bf16 v[76:79], v[52:55], v[20:23], v[76:79]
    v_mfma_f32_16x16x32_bf16 v[76:79], v[56:59], v[36:39], v[76:79]
    v_mfma_f32_16x16x32_bf16 v[92:95], v[60:63], v[20:23], v[92:95]
    ds_read_b128 v[20:23], v4 offset:45056
    v_mfma_f32_16x16x32_bf16 v[92:95], v[64:67], v[36:39], v[92:95]
    ds_read_b128 v[36:39], v5 offset:45056
    v_mfma_f32_16x16x32_bf16 v[80:83], v[52:55], v[24:27], v[80:83]
    ds_read_b64_tr_b16 v[52:53], v9 offset:49152
    v_mfma_f32_16x16x32_bf16 v[80:83], v[56:59], v[40:43], v[80:83]
    ds_read_b64_tr_b16 v[54:55], v9 offset:49664
    v_mfma_f32_16x16x32_bf16 v[96:99], v[60:63], v[24:27], v[96:99]
    ds_read_b128 v[24:27], v4 offset:47104
    v_mfma_f32_16x16x32_bf16 v[96:99], v[64:67], v[40:43], v[96:99]
    ds_read_b128 v[40:43], v5 offset:47104
    s_waitcnt lgkmcnt(7)
    v_mfma_f32_16x16x32_bf16 v[100:103], v[12:15], v[44:47], v[100:103]
    ds_read_b64_tr_b16 v[56:57], v9 offset:53248
    v_mfma_f32_16x16x32_bf16 v[100:103], v[28:31], v[48:51], v[100:103]
    ds_read_b64_tr_b16 v[58:59], v9 offset:53760
    v_mfma_f32_16x16x32_bf16 v[104:107], v[16:19], v[44:47], v[104:107]
    ds_read_b64_tr_b16 v[60:61], v8 offset:57344
    s_waitcnt lgkmcnt(9)
    v_mfma_f32_16x16x32_bf16 v[104:107], v[32:35], v[48:51], v[104:107]
    ds_read_b64_tr_b16 v[62:63], v8 offset:57856
    s_waitcnt lgkmcnt(9)
    v_mfma_f32_16x16x32_bf16 v[108:111], v[20:23], v[44:47], v[108:111]
    ds_read_b64_tr_b16 v[64:65], v8 offset:61440
    s_waitcnt lgkmcnt(9)
    v_mfma_f32_16x16x32_bf16 v[108:111], v[36:39], v[48:51], v[108:111]
    ds_read_b64_tr_b16 v[66:67], v8 offset:61952
    s_waitcnt lgkmcnt(7)
    v_mfma_f32_16x16x32_bf16 v[112:115], v[24:27], v[44:47], v[112:115]
    ds_read_b64_tr_b16 v[44:45], v9 offset:57344
    s_waitcnt lgkmcnt(7)
    v_mfma_f32_16x16x32_bf16 v[112:115], v[40:43], v[48:51], v[112:115]
    ds_read_b64_tr_b16 v[46:47], v9 offset:57856
    v_mfma_f32_16x16x32_bf16 v[116:119], v[12:15], v[52:55], v[116:119]
    ds_read_b64_tr_b16 v[48:49], v9 offset:61440
    s_waitcnt lgkmcnt(7)
    v_mfma_f32_16x16x32_bf16 v[116:119], v[28:31], v[56:59], v[116:119]
    ds_read_b64_tr_b16 v[50:51], v9 offset:61952
    v_mfma_f32_16x16x32_bf16 v[120:123], v[16:19], v[52:55], v[120:123]
    v_mfma_f32_16x16x32_bf16 v[120:123], v[32:35], v[56:59], v[120:123]
    v_mfma_f32_16x16x32_bf16 v[124:127], v[20:23], v[52:55], v[124:127]
    v_mfma_f32_16x16x32_bf16 v[124:127], v[36:39], v[56:59], v[124:127]
    v_mfma_f32_16x16x32_bf16 v[128:131], v[24:27], v[52:55], v[128:131]
    ds_read_b64_tr_b16 v[52:53], v8 offset:40960
    v_mfma_f32_16x16x32_bf16 v[128:131], v[40:43], v[56:59], v[128:131]
    ds_read_b64_tr_b16 v[54:55], v8 offset:41472
    s_waitcnt lgkmcnt(5)
    v_mfma_f32_16x16x32_bf16 v[132:135], v[12:15], v[60:63], v[132:135]
    ds_read_b64_tr_b16 v[56:57], v8 offset:45056
    v_mfma_f32_16x16x32_bf16 v[132:135], v[28:31], v[64:67], v[132:135]
    ds_read_b64_tr_b16 v[58:59], v8 offset:45568
    v_mfma_f32_16x16x32_bf16 v[136:139], v[16:19], v[60:63], v[136:139]
    v_mfma_f32_16x16x32_bf16 v[136:139], v[32:35], v[64:67], v[136:139]
    v_mfma_f32_16x16x32_bf16 v[140:143], v[20:23], v[60:63], v[140:143]
    v_mfma_f32_16x16x32_bf16 v[140:143], v[36:39], v[64:67], v[140:143]
    v_mfma_f32_16x16x32_bf16 v[144:147], v[24:27], v[60:63], v[144:147]
    ds_read_b64_tr_b16 v[60:61], v9 offset:40960
    v_mfma_f32_16x16x32_bf16 v[144:147], v[40:43], v[64:67], v[144:147]
    ds_read_b64_tr_b16 v[62:63], v9 offset:41472
    s_waitcnt lgkmcnt(5)
    v_mfma_f32_16x16x32_bf16 v[148:151], v[12:15], v[44:47], v[148:151]
    ds_read_b64_tr_b16 v[64:65], v9 offset:45056
    v_mfma_f32_16x16x32_bf16 v[148:151], v[28:31], v[48:51], v[148:151]
    ds_read_b64_tr_b16 v[66:67], v9 offset:45568
    v_mfma_f32_16x16x32_bf16 v[152:155], v[16:19], v[44:47], v[152:155]
    v_mfma_f32_16x16x32_bf16 v[152:155], v[32:35], v[48:51], v[152:155]
    v_mfma_f32_16x16x32_bf16 v[156:159], v[20:23], v[44:47], v[156:159]
    v_mfma_f32_16x16x32_bf16 v[156:159], v[36:39], v[48:51], v[156:159]
    s_waitcnt lgkmcnt(0)
    s_waitcnt vmcnt(0)
    s_barrier
    v_mfma_f32_16x16x32_bf16 v[160:163], v[24:27], v[44:47], v[160:163]
    ds_read_b64_tr_b16 v[44:45], v10 offset:8192
    v_mfma_f32_16x16x32_bf16 v[160:163], v[40:43], v[48:51], v[160:163]
    ds_read_b64_tr_b16 v[46:47], v10 offset:8704
    v_mfma_f32_16x16x32_bf16 v[68:71], v[52:55], v[12:15], v[68:71]
    ds_read_b64_tr_b16 v[48:49], v10 offset:12288
    v_mfma_f32_16x16x32_bf16 v[68:71], v[56:59], v[28:31], v[68:71]
    ds_read_b64_tr_b16 v[50:51], v10 offset:12800
    v_mfma_f32_16x16x32_bf16 v[84:87], v[60:63], v[12:15], v[84:87]
    ds_read_b128 v[12:15], v6 offset:0
    v_mfma_f32_16x16x32_bf16 v[84:87], v[64:67], v[28:31], v[84:87]
    ds_read_b128 v[28:31], v7 offset:0
    v_mfma_f32_16x16x32_bf16 v[72:75], v[52:55], v[16:19], v[72:75]
    v_mfma_f32_16x16x32_bf16 v[72:75], v[56:59], v[32:35], v[72:75]
    v_mfma_f32_16x16x32_bf16 v[88:91], v[60:63], v[16:19], v[88:91]
    ds_read_b128 v[16:19], v6 offset:2048
    v_mfma_f32_16x16x32_bf16 v[88:91], v[64:67], v[32:35], v[88:91]
    ds_read_b128 v[32:35], v7 offset:2048
    v_mfma_f32_16x16x32_bf16 v[76:79], v[52:55], v[20:23], v[76:79]
    v_mfma_f32_16x16x32_bf16 v[76:79], v[56:59], v[36:39], v[76:79]
    v_mfma_f32_16x16x32_bf16 v[92:95], v[60:63], v[20:23], v[92:95]
    ds_read_b128 v[20:23], v6 offset:4096
    v_mfma_f32_16x16x32_bf16 v[92:95], v[64:67], v[36:39], v[92:95]
    ds_read_b128 v[36:39], v7 offset:4096
    v_mfma_f32_16x16x32_bf16 v[80:83], v[52:55], v[24:27], v[80:83]
    ds_read_b64_tr_b16 v[52:53], v11 offset:8192
    v_mfma_f32_16x16x32_bf16 v[80:83], v[56:59], v[40:43], v[80:83]
    ds_read_b64_tr_b16 v[54:55], v11 offset:8704
    v_mfma_f32_16x16x32_bf16 v[96:99], v[60:63], v[24:27], v[96:99]
    ds_read_b128 v[24:27], v6 offset:6144
    v_mfma_f32_16x16x32_bf16 v[96:99], v[64:67], v[40:43], v[96:99]
    ds_read_b128 v[40:43], v7 offset:6144
    s_waitcnt lgkmcnt(7)
    v_mfma_f32_16x16x32_bf16 v[100:103], v[12:15], v[44:47], v[100:103]
    ds_read_b64_tr_b16 v[56:57], v11 offset:12288
    v_mfma_f32_16x16x32_bf16 v[100:103], v[28:31], v[48:51], v[100:103]
    ds_read_b64_tr_b16 v[58:59], v11 offset:12800
    v_mfma_f32_16x16x32_bf16 v[104:107], v[16:19], v[44:47], v[104:107]
    ds_read_b64_tr_b16 v[60:61], v10 offset:16384
    s_waitcnt lgkmcnt(9)
    v_mfma_f32_16x16x32_bf16 v[104:107], v[32:35], v[48:51], v[104:107]
    ds_read_b64_tr_b16 v[62:63], v10 offset:16896
    s_waitcnt lgkmcnt(9)
    v_mfma_f32_16x16x32_bf16 v[108:111], v[20:23], v[44:47], v[108:111]
    ds_read_b64_tr_b16 v[64:65], v10 offset:20480
    s_waitcnt lgkmcnt(9)
    v_mfma_f32_16x16x32_bf16 v[108:111], v[36:39], v[48:51], v[108:111]
    ds_read_b64_tr_b16 v[66:67], v10 offset:20992
    s_waitcnt lgkmcnt(7)
    v_mfma_f32_16x16x32_bf16 v[112:115], v[24:27], v[44:47], v[112:115]
    ds_read_b64_tr_b16 v[44:45], v11 offset:16384
    s_waitcnt lgkmcnt(7)
    v_mfma_f32_16x16x32_bf16 v[112:115], v[40:43], v[48:51], v[112:115]
    ds_read_b64_tr_b16 v[46:47], v11 offset:16896
    v_mfma_f32_16x16x32_bf16 v[116:119], v[12:15], v[52:55], v[116:119]
    ds_read_b64_tr_b16 v[48:49], v11 offset:20480
    s_waitcnt lgkmcnt(7)
    v_mfma_f32_16x16x32_bf16 v[116:119], v[28:31], v[56:59], v[116:119]
    ds_read_b64_tr_b16 v[50:51], v11 offset:20992
    v_mfma_f32_16x16x32_bf16 v[120:123], v[16:19], v[52:55], v[120:123]
    v_mfma_f32_16x16x32_bf16 v[120:123], v[32:35], v[56:59], v[120:123]
    v_mfma_f32_16x16x32_bf16 v[124:127], v[20:23], v[52:55], v[124:127]
    v_mfma_f32_16x16x32_bf16 v[124:127], v[36:39], v[56:59], v[124:127]
    v_mfma_f32_16x16x32_bf16 v[128:131], v[24:27], v[52:55], v[128:131]
    ds_read_b64_tr_b16 v[52:53], v10 offset:0
    v_mfma_f32_16x16x32_bf16 v[128:131], v[40:43], v[56:59], v[128:131]
    ds_read_b64_tr_b16 v[54:55], v10 offset:512
    s_waitcnt lgkmcnt(5)
    v_mfma_f32_16x16x32_bf16 v[132:135], v[12:15], v[60:63], v[132:135]
    ds_read_b64_tr_b16 v[56:57], v10 offset:4096
    v_mfma_f32_16x16x32_bf16 v[132:135], v[28:31], v[64:67], v[132:135]
    ds_read_b64_tr_b16 v[58:59], v10 offset:4608
    v_mfma_f32_16x16x32_bf16 v[136:139], v[16:19], v[60:63], v[136:139]
    v_mfma_f32_16x16x32_bf16 v[136:139], v[32:35], v[64:67], v[136:139]
    v_mfma_f32_16x16x32_bf16 v[140:143], v[20:23], v[60:63], v[140:143]
    v_mfma_f32_16x16x32_bf16 v[140:143], v[36:39], v[64:67], v[140:143]
    v_mfma_f32_16x16x32_bf16 v[144:147], v[24:27], v[60:63], v[144:147]
    ds_read_b64_tr_b16 v[60:61], v11 offset:0
    v_mfma_f32_16x16x32_bf16 v[144:147], v[40:43], v[64:67], v[144:147]
    ds_read_b64_tr_b16 v[62:63], v11 offset:512
    s_waitcnt lgkmcnt(5)
    v_mfma_f32_16x16x32_bf16 v[148:151], v[12:15], v[44:47], v[148:151]
    ds_read_b64_tr_b16 v[64:65], v11 offset:4096
    v_mfma_f32_16x16x32_bf16 v[148:151], v[28:31], v[48:51], v[148:151]
    ds_read_b64_tr_b16 v[66:67], v11 offset:4608
    v_mfma_f32_16x16x32_bf16 v[152:155], v[16:19], v[44:47], v[152:155]
    v_mfma_f32_16x16x32_bf16 v[152:155], v[32:35], v[48:51], v[152:155]
    v_mfma_f32_16x16x32_bf16 v[156:159], v[20:23], v[44:47], v[156:159]
    v_mfma_f32_16x16x32_bf16 v[156:159], v[36:39], v[48:51], v[156:159]
    s_waitcnt lgkmcnt(0)
    s_barrier
    v_mfma_f32_16x16x32_bf16 v[160:163], v[24:27], v[44:47], v[160:163]
    ds_read_b64_tr_b16 v[44:45], v10 offset:49152
    v_mfma_f32_16x16x32_bf16 v[160:163], v[40:43], v[48:51], v[160:163]
    ds_read_b64_tr_b16 v[46:47], v10 offset:49664
    v_mfma_f32_16x16x32_bf16 v[68:71], v[52:55], v[12:15], v[68:71]
    ds_read_b64_tr_b16 v[48:49], v10 offset:53248
    v_mfma_f32_16x16x32_bf16 v[68:71], v[56:59], v[28:31], v[68:71]
    ds_read_b64_tr_b16 v[50:51], v10 offset:53760
    v_mfma_f32_16x16x32_bf16 v[84:87], v[60:63], v[12:15], v[84:87]
    ds_read_b128 v[12:15], v6 offset:40960
    v_mfma_f32_16x16x32_bf16 v[84:87], v[64:67], v[28:31], v[84:87]
    ds_read_b128 v[28:31], v7 offset:40960
    v_mfma_f32_16x16x32_bf16 v[72:75], v[52:55], v[16:19], v[72:75]
    v_mfma_f32_16x16x32_bf16 v[72:75], v[56:59], v[32:35], v[72:75]
    v_mfma_f32_16x16x32_bf16 v[88:91], v[60:63], v[16:19], v[88:91]
    ds_read_b128 v[16:19], v6 offset:43008
    v_mfma_f32_16x16x32_bf16 v[88:91], v[64:67], v[32:35], v[88:91]
    ds_read_b128 v[32:35], v7 offset:43008
    v_mfma_f32_16x16x32_bf16 v[76:79], v[52:55], v[20:23], v[76:79]
    v_mfma_f32_16x16x32_bf16 v[76:79], v[56:59], v[36:39], v[76:79]
    v_mfma_f32_16x16x32_bf16 v[92:95], v[60:63], v[20:23], v[92:95]
    ds_read_b128 v[20:23], v6 offset:45056
    v_mfma_f32_16x16x32_bf16 v[92:95], v[64:67], v[36:39], v[92:95]
    ds_read_b128 v[36:39], v7 offset:45056
    v_mfma_f32_16x16x32_bf16 v[80:83], v[52:55], v[24:27], v[80:83]
    ds_read_b64_tr_b16 v[52:53], v11 offset:49152
    v_mfma_f32_16x16x32_bf16 v[80:83], v[56:59], v[40:43], v[80:83]
    ds_read_b64_tr_b16 v[54:55], v11 offset:49664
    v_mfma_f32_16x16x32_bf16 v[96:99], v[60:63], v[24:27], v[96:99]
    ds_read_b128 v[24:27], v6 offset:47104
    v_mfma_f32_16x16x32_bf16 v[96:99], v[64:67], v[40:43], v[96:99]
    ds_read_b128 v[40:43], v7 offset:47104
    s_waitcnt lgkmcnt(7)
    v_mfma_f32_16x16x32_bf16 v[100:103], v[12:15], v[44:47], v[100:103]
    ds_read_b64_tr_b16 v[56:57], v11 offset:53248
    v_mfma_f32_16x16x32_bf16 v[100:103], v[28:31], v[48:51], v[100:103]
    ds_read_b64_tr_b16 v[58:59], v11 offset:53760
    v_mfma_f32_16x16x32_bf16 v[104:107], v[16:19], v[44:47], v[104:107]
    ds_read_b64_tr_b16 v[60:61], v10 offset:57344
    s_waitcnt lgkmcnt(9)
    v_mfma_f32_16x16x32_bf16 v[104:107], v[32:35], v[48:51], v[104:107]
    ds_read_b64_tr_b16 v[62:63], v10 offset:57856
    s_waitcnt lgkmcnt(9)
    v_mfma_f32_16x16x32_bf16 v[108:111], v[20:23], v[44:47], v[108:111]
    ds_read_b64_tr_b16 v[64:65], v10 offset:61440
    s_waitcnt lgkmcnt(9)
    v_mfma_f32_16x16x32_bf16 v[108:111], v[36:39], v[48:51], v[108:111]
    ds_read_b64_tr_b16 v[66:67], v10 offset:61952
    s_waitcnt lgkmcnt(7)
    v_mfma_f32_16x16x32_bf16 v[112:115], v[24:27], v[44:47], v[112:115]
    ds_read_b64_tr_b16 v[44:45], v11 offset:57344
    s_waitcnt lgkmcnt(7)
    v_mfma_f32_16x16x32_bf16 v[112:115], v[40:43], v[48:51], v[112:115]
    ds_read_b64_tr_b16 v[46:47], v11 offset:57856
    v_mfma_f32_16x16x32_bf16 v[116:119], v[12:15], v[52:55], v[116:119]
    ds_read_b64_tr_b16 v[48:49], v11 offset:61440
    s_waitcnt lgkmcnt(7)
    v_mfma_f32_16x16x32_bf16 v[116:119], v[28:31], v[56:59], v[116:119]
    ds_read_b64_tr_b16 v[50:51], v11 offset:61952
    v_mfma_f32_16x16x32_bf16 v[120:123], v[16:19], v[52:55], v[120:123]
    v_mfma_f32_16x16x32_bf16 v[120:123], v[32:35], v[56:59], v[120:123]
    v_mfma_f32_16x16x32_bf16 v[124:127], v[20:23], v[52:55], v[124:127]
    v_mfma_f32_16x16x32_bf16 v[124:127], v[36:39], v[56:59], v[124:127]
    v_mfma_f32_16x16x32_bf16 v[128:131], v[24:27], v[52:55], v[128:131]
    ds_read_b64_tr_b16 v[52:53], v10 offset:40960
    v_mfma_f32_16x16x32_bf16 v[128:131], v[40:43], v[56:59], v[128:131]
    ds_read_b64_tr_b16 v[54:55], v10 offset:41472
    s_waitcnt lgkmcnt(5)
    v_mfma_f32_16x16x32_bf16 v[132:135], v[12:15], v[60:63], v[132:135]
    ds_read_b64_tr_b16 v[56:57], v10 offset:45056
    v_mfma_f32_16x16x32_bf16 v[132:135], v[28:31], v[64:67], v[132:135]
    ds_read_b64_tr_b16 v[58:59], v10 offset:45568
    v_mfma_f32_16x16x32_bf16 v[136:139], v[16:19], v[60:63], v[136:139]
    v_mfma_f32_16x16x32_bf16 v[136:139], v[32:35], v[64:67], v[136:139]
    v_mfma_f32_16x16x32_bf16 v[140:143], v[20:23], v[60:63], v[140:143]
    v_mfma_f32_16x16x32_bf16 v[140:143], v[36:39], v[64:67], v[140:143]
    v_mfma_f32_16x16x32_bf16 v[144:147], v[24:27], v[60:63], v[144:147]
    ds_read_b64_tr_b16 v[60:61], v11 offset:40960
    v_mfma_f32_16x16x32_bf16 v[144:147], v[40:43], v[64:67], v[144:147]
    ds_read_b64_tr_b16 v[62:63], v11 offset:41472
    s_waitcnt lgkmcnt(5)
    v_mfma_f32_16x16x32_bf16 v[148:151], v[12:15], v[44:47], v[148:151]
    ds_read_b64_tr_b16 v[64:65], v11 offset:45056
    v_mfma_f32_16x16x32_bf16 v[148:151], v[28:31], v[48:51], v[148:151]
    ds_read_b64_tr_b16 v[66:67], v11 offset:45568
    v_mfma_f32_16x16x32_bf16 v[152:155], v[16:19], v[44:47], v[152:155]
    v_mfma_f32_16x16x32_bf16 v[152:155], v[32:35], v[48:51], v[152:155]
    v_mfma_f32_16x16x32_bf16 v[156:159], v[20:23], v[44:47], v[156:159]
    v_mfma_f32_16x16x32_bf16 v[156:159], v[36:39], v[48:51], v[156:159]
    s_waitcnt lgkmcnt(0)
    s_barrier
    v_mfma_f32_16x16x32_bf16 v[160:163], v[24:27], v[44:47], v[160:163]
    ds_read_b64_tr_b16 v[44:45], v8 offset:8192
    v_mfma_f32_16x16x32_bf16 v[160:163], v[40:43], v[48:51], v[160:163]
    ds_read_b64_tr_b16 v[46:47], v8 offset:8704
    v_mfma_f32_16x16x32_bf16 v[68:71], v[52:55], v[12:15], v[68:71]
    ds_read_b64_tr_b16 v[48:49], v8 offset:12288
    v_mfma_f32_16x16x32_bf16 v[68:71], v[56:59], v[28:31], v[68:71]
    ds_read_b64_tr_b16 v[50:51], v8 offset:12800
    v_mfma_f32_16x16x32_bf16 v[84:87], v[60:63], v[12:15], v[84:87]
    ds_read_b128 v[12:15], v4 offset:0
    v_mfma_f32_16x16x32_bf16 v[84:87], v[64:67], v[28:31], v[84:87]
    ds_read_b128 v[28:31], v5 offset:0
    v_mfma_f32_16x16x32_bf16 v[72:75], v[52:55], v[16:19], v[72:75]
    v_mfma_f32_16x16x32_bf16 v[72:75], v[56:59], v[32:35], v[72:75]
    v_mfma_f32_16x16x32_bf16 v[88:91], v[60:63], v[16:19], v[88:91]
    ds_read_b128 v[16:19], v4 offset:2048
    v_mfma_f32_16x16x32_bf16 v[88:91], v[64:67], v[32:35], v[88:91]
    ds_read_b128 v[32:35], v5 offset:2048
    v_mfma_f32_16x16x32_bf16 v[76:79], v[52:55], v[20:23], v[76:79]
    v_mfma_f32_16x16x32_bf16 v[76:79], v[56:59], v[36:39], v[76:79]
    s_sub_u32 s81, s81, 1
    s_cmp_lg_u32 s81, 0
    v_mfma_f32_16x16x32_bf16 v[92:95], v[60:63], v[20:23], v[92:95]
    ds_read_b128 v[20:23], v4 offset:4096
    v_mfma_f32_16x16x32_bf16 v[92:95], v[64:67], v[36:39], v[92:95]
    ds_read_b128 v[36:39], v5 offset:4096
    v_mfma_f32_16x16x32_bf16 v[80:83], v[52:55], v[24:27], v[80:83]
    ds_read_b64_tr_b16 v[52:53], v9 offset:8192
    v_mfma_f32_16x16x32_bf16 v[80:83], v[56:59], v[40:43], v[80:83]
    ds_read_b64_tr_b16 v[54:55], v9 offset:8704
    v_mfma_f32_16x16x32_bf16 v[96:99], v[60:63], v[24:27], v[96:99]
    ds_read_b128 v[24:27], v4 offset:6144
    v_mfma_f32_16x16x32_bf16 v[96:99], v[64:67], v[40:43], v[96:99]
    ds_read_b128 v[40:43], v5 offset:6144
    s_cbranch_scc1 F_p1
    s_waitcnt lgkmcnt(7)
    v_mfma_f32_16x16x32_bf16 v[100:103], v[12:15], v[44:47], v[100:103]
    ds_read_b64_tr_b16 v[56:57], v9 offset:12288
    v_mfma_f32_16x16x32_bf16 v[100:103], v[28:31], v[48:51], v[100:103]
    ds_read_b64_tr_b16 v[58:59], v9 offset:12800
    v_mfma_f32_16x16x32_bf16 v[104:107], v[16:19], v[44:47], v[104:107]
    ds_read_b64_tr_b16 v[60:61], v8 offset:16384
    s_waitcnt lgkmcnt(9)
    v_mfma_f32_16x16x32_bf16 v[104:107], v[32:35], v[48:51], v[104:107]
    ds_read_b64_tr_b16 v[62:63], v8 offset:16896
    s_waitcnt lgkmcnt(9)
    v_mfma_f32_16x16x32_bf16 v[108:111], v[20:23], v[44:47], v[108:111]
    ds_read_b64_tr_b16 v[64:65], v8 offset:20480
    s_waitcnt lgkmcnt(9)
    v_mfma_f32_16x16x32_bf16 v[108:111], v[36:39], v[48:51], v[108:111]
    ds_read_b64_tr_b16 v[66:67], v8 offset:20992
    s_waitcnt lgkmcnt(7)
    v_mfma_f32_16x16x32_bf16 v[112:115], v[24:27], v[44:47], v[112:115]
    ds_read_b64_tr_b16 v[44:45], v9 offset:16384
    s_waitcnt lgkmcnt(7)
    v_mfma_f32_16x16x32_bf16 v[112:115], v[40:43], v[48:51], v[112:115]
    ds_read_b64_tr_b16 v[46:47], v9 offset:16896
    v_mfma_f32_16x16x32_bf16 v[116:119], v[12:15], v[52:55], v[116:119]
    ds_read_b64_tr_b16 v[48:49], v9 offset:20480
    s_waitcnt lgkmcnt(7)
    v_mfma_f32_16x16x32_bf16 v[116:119], v[28:31], v[56:59], v[116:119]
    ds_read_b64_tr_b16 v[50:51], v9 offset:20992
    v_mfma_f32_16x16x32_bf16 v[120:123], v[16:19], v[52:55], v[120:123]
    v_mfma_f32_16x16x32_bf16 v[120:123], v[32:35], v[56:59], v[120:123]
    v_mfma_f32_16x16x32_bf16 v[124:127], v[20:23], v[52:55], v[124:127]
    v_mfma_f32_16x16x32_bf16 v[124:127], v[36:39], v[56:59], v[124:127]
    s_waitcnt lgkmcnt(0)
    s_barrier
    v_mfma_f32_16x16x32_bf16 v[128:131], v[24:27], v[52:55], v[128:131]
    ds_read_b64_tr_b16 v[52:53], v8 offset:49152
    v_mfma_f32_16x16x32_bf16 v[128:131], v[40:43], v[56:59], v[128:131]
    ds_read_b64_tr_b16 v[54:55], v8 offset:49664
    v_mfma_f32_16x16x32_bf16 v[132:135], v[12:15], v[60:63], v[132:135]
    ds_read_b64_tr_b16 v[56:57], v8 offset:53248
    v_mfma_f32_16x16x32_bf16 v[132:135], v[28:31], v[64:67], v[132:135]
    ds_read_b64_tr_b16 v[58:59], v8 offset:53760
    v_mfma_f32_16x16x32_bf16 v[148:151], v[12:15], v[44:47], v[148:151]
    ds_read_b128 v[12:15], v4 offset:40960
    v_mfma_f32_16x16x32_bf16 v[148:151], v[28:31], v[48:51], v[148:151]
    ds_read_b128 v[28:31], v5 offset:40960
    v_mfma_f32_16x16x32_bf16 v[136:139], v[16:19], v[60:63], v[136:139]
    v_mfma_f32_16x16x32_bf16 v[136:139], v[32:35], v[64:67], v[136:139]
    v_mfma_f32_16x16x32_bf16 v[152:155], v[16:19], v[44:47], v[152:155]
    ds_read_b128 v[16:19], v4 offset:43008
    v_mfma_f32_16x16x32_bf16 v[152:155], v[32:35], v[48:51], v[152:155]
    ds_read_b128 v[32:35], v5 offset:43008
    v_mfma_f32_16x16x32_bf16 v[140:143], v[20:23], v[60:63], v[140:143]
    v_mfma_f32_16x16x32_bf16 v[140:143], v[36:39], v[64:67], v[140:143]
    v_mfma_f32_16x16x32_bf16 v[156:159], v[20:23], v[44:47], v[156:159]
    ds_read_b128 v[20:23], v4 offset:45056
    v_mfma_f32_16x16x32_bf16 v[156:159], v[36:39], v[48:51], v[156:159]
    ds_read_b128 v[36:39], v5 offset:45056
    v_mfma_f32_16x16x32_bf16 v[144:147], v[24:27], v[60:63], v[144:147]
    ds_read_b64_tr_b16 v[60:61], v9 offset:49152
    v_mfma_f32_16x16x32_bf16 v[144:147], v[40:43], v[64:67], v[144:147]
    ds_read_b64_tr_b16 v[62:63], v9 offset:49664
    v_mfma_f32_16x16x32_bf16 v[160:163], v[24:27], v[44:47], v[160:163]
    ds_read_b128 v[24:27], v4 offset:47104
    v_mfma_f32_16x16x32_bf16 v[160:163], v[40:43], v[48:51], v[160:163]
    ds_read_b128 v[40:43], v5 offset:47104
    s_waitcnt lgkmcnt(7)
    v_mfma_f32_16x16x32_bf16 v[100:103], v[12:15], v[52:55], v[100:103]
    ds_read_b64_tr_b16 v[64:65], v9 offset:53248
    v_mfma_f32_16x16x32_bf16 v[100:103], v[28:31], v[56:59], v[100:103]
    ds_read_b64_tr_b16 v[66:67], v9 offset:53760
    v_mfma_f32_16x16x32_bf16 v[104:107], v[16:19], v[52:55], v[104:107]
    ds_read_b64_tr_b16 v[44:45], v8 offset:57344
    s_waitcnt lgkmcnt(9)
    v_mfma_f32_16x16x32_bf16 v[104:107], v[32:35], v[56:59], v[104:107]
    ds_read_b64_tr_b16 v[46:47], v8 offset:57856
    s_waitcnt lgkmcnt(9)
    v_mfma_f32_16x16x32_bf16 v[108:111], v[20:23], v[52:55], v[108:111]
    ds_read_b64_tr_b16 v[48:49], v8 offset:61440
    s_waitcnt lgkmcnt(9)
    v_mfma_f32_16x16x32_bf16 v[108:111], v[36:39], v[56:59], v[108:111]
    ds_read_b64_tr_b16 v[50:51], v8 offset:61952
    s_waitcnt lgkmcnt(7)
    v_mfma_f32_16x16x32_bf16 v[112:115], v[24:27], v[52:55], v[112:115]
    ds_read_b64_tr_b16 v[52:53], v9 offset:57344
    s_waitcnt lgkmcnt(7)
    v_mfma_f32_16x16x32_bf16 v[112:115], v[40:43], v[56:59], v[112:115]
    ds_read_b64_tr_b16 v[54:55], v9 offset:57856
    v_mfma_f32_16x16x32_bf16 v[116:119], v[12:15], v[60:63], v[116:119]
    ds_read_b64_tr_b16 v[56:57], v9 offset:61440
    s_waitcnt lgkmcnt(7)
    v_mfma_f32_16x16x32_bf16 v[116:119], v[28:31], v[64:67], v[116:119]
    ds_read_b64_tr_b16 v[58:59], v9 offset:61952
    v_mfma_f32_16x16x32_bf16 v[120:123], v[16:19], v[60:63], v[120:123]
    v_mfma_f32_16x16x32_bf16 v[120:123], v[32:35], v[64:67], v[120:123]
    v_mfma_f32_16x16x32_bf16 v[124:127], v[20:23], v[60:63], v[124:127]
    v_mfma_f32_16x16x32_bf16 v[124:127], v[36:39], v[64:67], v[124:127]
    s_waitcnt lgkmcnt(0)
    s_barrier
    v_mfma_f32_16x16x32_bf16 v[128:131], v[24:27], v[60:63], v[128:131]
    ds_read_b64_tr_b16 v[60:61], v10 offset:8192
    v_mfma_f32_16x16x32_bf16 v[128:131], v[40:43], v[64:67], v[128:131]
    ds_read_b64_tr_b16 v[62:63], v10 offset:8704
    v_mfma_f32_16x16x32_bf16 v[132:135], v[12:15], v[44:47], v[132:135]
    ds_read_b64_tr_b16 v[64:65], v10 offset:12288
    v_mfma_f32_16x16x32_bf16 v[132:135], v[28:31], v[48:51], v[132:135]
    ds_read_b64_tr_b16 v[66:67], v10 offset:12800
W_1:
    s_cbranch_execz R_1
    s_nop 0
    v_mfma_f32_16x16x32_bf16 v[148:151], v[12:15], v[52:55], v[148:151]
    ds_read_b128 v[12:15], v6 offset:0
    v_mfma_f32_16x16x32_bf16 v[148:151], v[28:31], v[56:59], v[148:151]
    ds_read_b128 v[28:31], v7 offset:0
    v_mfma_f32_16x16x32_bf16 v[136:139], v[16:19], v[44:47], v[136:139]
    v_mfma_f32_16x16x32_bf16 v[136:139], v[32:35], v[48:51], v[136:139]
    v_mfma_f32_16x16x32_bf16 v[152:155], v[16:19], v[52:55], v[152:155]
    ds_read_b128 v[16:19], v6 offset:2048
    v_mfma_f32_16x16x32_bf16 v[152:155], v[32:35], v[56:59], v[152:155]
    ds_read_b128 v[32:35], v7 offset:2048
    v_mfma_f32_16x16x32_bf16 v[140:143], v[20:23], v[44:47], v[140:143]
    v_mfma_f32_16x16x32_bf16 v[140:143], v[36:39], v[48:51], v[140:143]
    v_mfma_f32_16x16x32_bf16 v[156:159], v[20:23], v[52:55], v[156:159]
    ds_read_b128 v[20:23], v6 offset:4096
    v_mfma_f32_16x16x32_bf16 v[156:159], v[36:39], v[56:59], v[156:159]
    ds_read_b128 v[36:39], v7 offset:4096
    v_mfma_f32_16x16x32_bf16 v[144:147], v[24:27], v[44:47], v[144:147]
    ds_read_b64_tr_b16 v[44:45], v11 offset:8192
    v_mfma_f32_16x16x32_bf16 v[144:147], v[40:43], v[48:51], v[144:147]
    ds_read_b64_tr_b16 v[46:47], v11 offset:8704
    v_mfma_f32_16x16x32_bf16 v[160:163], v[24:27], v[52:55], v[160:163]
    ds_read_b128 v[24:27], v6 offset:6144
    v_mfma_f32_16x16x32_bf16 v[160:163], v[40:43], v[56:59], v[160:163]
    ds_read_b128 v[40:43], v7 offset:6144
    s_waitcnt lgkmcnt(7)
    v_mfma_f32_16x16x32_bf16 v[100:103], v[12:15], v[60:63], v[100:103]
    ds_read_b64_tr_b16 v[48:49], v11 offset:12288
    v_mfma_f32_16x16x32_bf16 v[100:103], v[28:31], v[64:67], v[100:103]
    ds_read_b64_tr_b16 v[50:51], v11 offset:12800
    v_mfma_f32_16x16x32_bf16 v[104:107], v[16:19], v[60:63], v[104:107]
    ds_read_b64_tr_b16 v[52:53], v10 offset:16384
    s_waitcnt lgkmcnt(9)
    v_mfma_f32_16x16x32_bf16 v[104:107], v[32:35], v[64:67], v[104:107]
    ds_read_b64_tr_b16 v[54:55], v10 offset:16896
    s_waitcnt lgkmcnt(9)
    v_mfma_f32_16x16x32_bf16 v[108:111], v[20:23], v[60:63], v[108:111]
    ds_read_b64_tr_b16 v[56:57], v10 offset:20480
    s_waitcnt lgkmcnt(9)
    v_mfma_f32_16x16x32_bf16 v[108:111], v[36:39], v[64:67], v[108:111]
    ds_read_b64_tr_b16 v[58:59], v10 offset:20992
    s_waitcnt lgkmcnt(7)
    v_mfma_f32_16x16x32_bf16 v[112:115], v[24:27], v[60:63], v[112:115]
    ds_read_b64_tr_b16 v[60:61], v11 offset:16384
    s_waitcnt lgkmcnt(7)
    v_mfma_f32_16x16x32_bf16 v[112:115], v[40:43], v[64:67], v[112:115]
    ds_read_b64_tr_b16 v[62:63], v11 offset:16896
    v_mfma_f32_16x16x32_bf16 v[116:119], v[12:15], v[44:47], v[116:119]
    ds_read_b64_tr_b16 v[64:65], v11 offset:20480
    s_waitcnt lgkmcnt(7)
    v_mfma_f32_16x16x32_bf16 v[116:119], v[28:31], v[48:51], v[116:119]
    ds_read_b64_tr_b16 v[66:67], v11 offset:20992
    v_mfma_f32_16x16x32_bf16 v[120:123], v[16:19], v[44:47], v[120:123]
    v_mfma_f32_16x16x32_bf16 v[120:123], v[32:35], v[48:51], v[120:123]
    v_mfma_f32_16x16x32_bf16 v[124:127], v[20:23], v[44:47], v[124:127]
    v_mfma_f32_16x16x32_bf16 v[124:127], v[36:39], v[48:51], v[124:127]
    s_waitcnt lgkmcnt(0)
    s_barrier
    v_mfma_f32_16x16x32_bf16 v[128:131], v[24:27], v[44:47], v[128:131]
    ds_read_b64_tr_b16 v[44:45], v10 offset:49152
    v_mfma_f32_16x16x32_bf16 v[128:131], v[40:43], v[48:51], v[128:131]
    ds_read_b64_tr_b16 v[46:47], v10 offset:49664
    v_mfma_f32_16x16x32_bf16 v[132:135], v[12:15], v[52:55], v[132:135]
    ds_read_b64_tr_b16 v[48:49], v10 offset:53248
    v_mfma_f32_16x16x32_bf16 v[132:135], v[28:31], v[56:59], v[132:135]
    ds_read_b64_tr_b16 v[50:51], v10 offset:53760
    v_mfma_f32_16x16x32_bf16 v[148:151], v[12:15], v[60:63], v[148:151]
    ds_read_b128 v[12:15], v6 offset:40960
    v_mfma_f32_16x16x32_bf16 v[148:151], v[28:31], v[64:67], v[148:151]
    ds_read_b128 v[28:31], v7 offset:40960
    v_mfma_f32_16x16x32_bf16 v[136:139], v[16:19], v[52:55], v[136:139]
    v_mfma_f32_16x16x32_bf16 v[136:139], v[32:35], v[56:59], v[136:139]
    v_mfma_f32_16x16x32_bf16 v[152:155], v[16:19], v[60:63], v[152:155]
    ds_read_b128 v[16:19], v6 offset:43008
    v_mfma_f32_16x16x32_bf16 v[152:155], v[32:35], v[64:67], v[152:155]
    ds_read_b128 v[32:35], v7 offset:43008
    v_mfma_f32_16x16x32_bf16 v[140:143], v[20:23], v[52:55], v[140:143]
    v_mfma_f32_16x16x32_bf16 v[140:143], v[36:39], v[56:59], v[140:143]
    v_mfma_f32_16x16x32_bf16 v[156:159], v[20:23], v[60:63], v[156:159]
    ds_read_b128 v[20:23], v6 offset:45056
    v_mfma_f32_16x16x32_bf16 v[156:159], v[36:39], v[64:67], v[156:159]
    ds_read_b128 v[36:39], v7 offset:45056
    v_mfma_f32_16x16x32_bf16 v[144:147], v[24:27], v[52:55], v[144:147]
    ds_read_b64_tr_b16 v[52:53], v11 offset:49152
    v_mfma_f32_16x16x32_bf16 v[144:147], v[40:43], v[56:59], v[144:147]
    ds_read_b64_tr_b16 v[54:55], v11 offset:49664
    v_mfma_f32_16x16x32_bf16 v[160:163], v[24:27], v[60:63], v[160:163]
    ds_read_b128 v[24:27], v6 offset:47104
    v_mfma_f32_16x16x32_bf16 v[160:163], v[40:43], v[64:67], v[160:163]
    ds_read_b128 v[40:43], v7 offset:47104
    s_waitcnt lgkmcnt(7)
    v_mfma_f32_16x16x32_bf16 v[100:103], v[12:15], v[44:47], v[100:103]
    ds_read_b64_tr_b16 v[56:57], v11 offset:53248
    v_mfma_f32_16x16x32_bf16 v[100:103], v[28:31], v[48:51], v[100:103]
    ds_read_b64_tr_b16 v[58:59], v11 offset:53760
    v_mfma_f32_16x16x32_bf16 v[104:107], v[16:19], v[44:47], v[104:107]
    ds_read_b64_tr_b16 v[60:61], v10 offset:57344
    s_waitcnt lgkmcnt(9)
    v_mfma_f32_16x16x32_bf16 v[104:107], v[32:35], v[48:51], v[104:107]
    ds_read_b64_tr_b16 v[62:63], v10 offset:57856
    s_waitcnt lgkmcnt(9)
    v_mfma_f32_16x16x32_bf16 v[108:111], v[20:23], v[44:47], v[108:111]
    ds_read_b64_tr_b16 v[64:65], v10 offset:61440
    s_waitcnt lgkmcnt(9)
    v_mfma_f32_16x16x32_bf16 v[108:111], v[36:39], v[48:51], v[108:111]
    ds_read_b64_tr_b16 v[66:67], v10 offset:61952
    s_waitcnt lgkmcnt(7)
    v_mfma_f32_16x16x32_bf16 v[112:115], v[24:27], v[44:47], v[112:115]
    ds_read_b64_tr_b16 v[44:45], v11 offset:57344
    s_waitcnt lgkmcnt(7)
    v_mfma_f32_16x16x32_bf16 v[112:115], v[40:43], v[48:51], v[112:115]
    ds_read_b64_tr_b16 v[46:47], v11 offset:57856
    v_mfma_f32_16x16x32_bf16 v[116:119], v[12:15], v[52:55], v[116:119]
    ds_read_b64_tr_b16 v[48:49], v11 offset:61440
    s_waitcnt lgkmcnt(7)
    v_mfma_f32_16x16x32_bf16 v[116:119], v[28:31], v[56:59], v[116:119]
    ds_read_b64_tr_b16 v[50:51], v11 offset:61952
    v_mfma_f32_16x16x32_bf16 v[120:123], v[16:19], v[52:55], v[120:123]
    v_mfma_f32_16x16x32_bf16 v[120:123], v[32:35], v[56:59], v[120:123]
    v_mfma_f32_16x16x32_bf16 v[124:127], v[20:23], v[52:55], v[124:127]
    v_mfma_f32_16x16x32_bf16 v[124:127], v[36:39], v[56:59], v[124:127]
    v_mfma_f32_16x16x32_bf16 v[128:131], v[24:27], v[52:55], v[128:131]
    ds_read2_b32 v[52:53], v165 offset0:64 offset1:64
    v_mfma_f32_16x16x32_bf16 v[128:131], v[40:43], v[56:59], v[128:131]
    ds_read2_b32 v[54:55], v165 offset0:80 offset1:80
    s_waitcnt lgkmcnt(5)
    v_mfma_f32_16x16x32_bf16 v[132:135], v[12:15], v[60:63], v[132:135]
    ds_read2_b32 v[56:57], v165 offset0:128 offset1:128
    v_mfma_f32_16x16x32_bf16 v[132:135], v[28:31], v[64:67], v[132:135]
    ds_read2_b32 v[58:59], v165 offset0:144 offset1:144
    s_waitcnt lgkmcnt(5)
    v_mfma_f32_16x16x32_bf16 v[148:151], v[12:15], v[44:47], v[148:151]
    ds_read_b128 v[12:15], v164 offset:0
    s_waitcnt lgkmcnt(5)
    v_mfma_f32_16x16x32_bf16 v[148:151], v[28:31], v[48:51], v[148:151]
    ds_read_b128 v[28:31], v164 offset:512
    v_mfma_f32_16x16x32_bf16 v[136:139], v[16:19], v[60:63], v[136:139]
    v_mfma_f32_16x16x32_bf16 v[136:139], v[32:35], v[64:67], v[136:139]
    v_mfma_f32_16x16x32_bf16 v[152:155], v[16:19], v[44:47], v[152:155]
    ds_read_b128 v[16:19], v164 offset:64
    v_mfma_f32_16x16x32_bf16 v[152:155], v[32:35], v[48:51], v[152:155]
    ds_read_b128 v[32:35], v164 offset:576
    v_mfma_f32_16x16x32_bf16 v[140:143], v[20:23], v[60:63], v[140:143]
    v_mfma_f32_16x16x32_bf16 v[140:143], v[36:39], v[64:67], v[140:143]
    v_mfma_f32_16x16x32_bf16 v[156:159], v[20:23], v[44:47], v[156:159]
    v_mfma_f32_16x16x32_bf16 v[156:159], v[36:39], v[48:51], v[156:159]
    v_mfma_f32_16x16x32_bf16 v[144:147], v[24:27], v[60:63], v[144:147]
    ds_read_b128 v[60:63], v164 offset:1024
    v_mfma_f32_16x16x32_bf16 v[144:147], v[40:43], v[64:67], v[144:147]
    ds_read_b128 v[64:67], v164 offset:1088
    v_mfma_f32_16x16x32_bf16 v[160:163], v[24:27], v[44:47], v[160:163]
    v_mfma_f32_16x16x32_bf16 v[160:163], v[40:43], v[48:51], v[160:163]
    s_mov_b32 s50, 0x10001
    s_mov_b32 s51, s50
    ds_read_b128 v[36:39], v164 offset:128
    ds_read_b128 v[40:43], v164 offset:192
    ds_read_b128 v[44:47], v164 offset:640
    ds_read_b128 v[48:51], v164 offset:704
    s_waitcnt lgkmcnt(9)
    v_pk_fma_f32 v[100:101], v[12:13], v[52:53], v[100:101]
    v_pk_fma_f32 v[102:103], v[14:15], v[52:53], v[102:103]
    s_waitcnt lgkmcnt(7)
    v_pk_fma_f32 v[104:105], v[16:17], v[52:53], v[104:105]
    v_pk_fma_f32 v[106:107], v[18:19], v[52:53], v[106:107]
    s_waitcnt lgkmcnt(5)
    v_pk_mul_f32 v[20:21], v[100:101], v[60:61]
    v_pk_mul_f32 v[22:23], v[102:103], v[62:63]
    s_waitcnt lgkmcnt(4)
    v_pk_mul_f32 v[24:25], v[104:105], v[64:65]
    v_pk_mul_f32 v[26:27], v[106:107], v[66:67]
    v_pk_fma_f32 v[100:101], v[100:101], v[28:29], s[40:41]
    v_pk_fma_f32 v[102:103], v[102:103], v[30:31], s[40:41]
    v_pk_fma_f32 v[104:105], v[104:105], v[32:33], s[40:41]
    v_pk_fma_f32 v[106:107], v[106:107], v[34:35], s[40:41]
    v_exp_f32 v20, v20 clamp
    v_exp_f32 v21, v21 clamp
    v_exp_f32 v22, v22 clamp
    v_exp_f32 v23, v23 clamp
    v_exp_f32 v24, v24 clamp
    v_exp_f32 v25, v25 clamp
    v_exp_f32 v26, v26 clamp
    v_exp_f32 v27, v27 clamp
    v_pk_add_f32 v[20:21], v[20:21], s[74:75]
    v_pk_add_f32 v[22:23], v[22:23], s[74:75]
    v_pk_add_f32 v[24:25], v[24:25], s[74:75]
    v_pk_add_f32 v[26:27], v[26:27], s[74:75]
    v_max_f32 v100, v100, v20
    v_max_f32 v101, v101, v21
    v_max_f32 v102, v102, v22
    v_max_f32 v103, v103, v23
    v_max_f32 v104, v104, v24
    v_max_f32 v105, v105, v25
    v_max_f32 v106, v106, v26
    v_max_f32 v107, v107, v27
    v_cvt_pk_bf16_f32 v100, v100, v101
    v_cvt_pk_bf16_f32 v101, v102, v103
    v_cvt_pk_bf16_f32 v102, v104, v105
    v_cvt_pk_bf16_f32 v103, v106, v107
    s_waitcnt lgkmcnt(3)
    v_pk_fma_f32 v[140:141], v[36:37], v[56:57], v[140:141]
    v_pk_fma_f32 v[142:143], v[38:39], v[56:57], v[142:143]
    s_waitcnt lgkmcnt(2)
    v_pk_fma_f32 v[144:145], v[40:41], v[56:57], v[144:145]
    v_pk_fma_f32 v[146:147], v[42:43], v[56:57], v[146:147]
    s_waitcnt lgkmcnt(1)
    v_pk_mul_f32 v[140:141], v[140:141], v[44:45]
    v_pk_mul_f32 v[142:143], v[142:143], v[46:47]
    s_waitcnt lgkmcnt(0)
    v_pk_mul_f32 v[144:145], v[144:145], v[48:49]
    v_pk_mul_f32 v[146:147], v[146:147], v[50:51]
    v_cvt_pk_bf16_f32 v140, v140, v141
    v_cvt_pk_bf16_f32 v141, v142, v143
    v_cvt_pk_bf16_f32 v142, v144, v145
    v_cvt_pk_bf16_f32 v143, v146, v147
    v_pk_fma_f32 v[156:157], v[36:37], v[58:59], v[156:157]
    v_pk_fma_f32 v[158:159], v[38:39], v[58:59], v[158:159]
    v_pk_fma_f32 v[160:161], v[40:41], v[58:59], v[160:161]
    v_pk_fma_f32 v[162:163], v[42:43], v[58:59], v[162:163]
    v_pk_mul_f32 v[156:157], v[156:157], v[44:45]
    v_pk_mul_f32 v[158:159], v[158:159], v[46:47]
    v_pk_mul_f32 v[160:161], v[160:161], v[48:49]
    v_pk_mul_f32 v[162:163], v[162:163], v[50:51]
    v_cvt_pk_bf16_f32 v156, v156, v157
    v_cvt_pk_bf16_f32 v157, v158, v159
    v_cvt_pk_bf16_f32 v158, v160, v161
    v_cvt_pk_bf16_f32 v159, v162, v163
    ds_read_b128 v[144:147], v164 offset:1152
    ds_read_b128 v[160:163], v164 offset:1216
    v_pk_fma_f32 v[132:133], v[12:13], v[56:57], v[132:133]
    v_pk_fma_f32 v[134:135], v[14:15], v[56:57], v[134:135]
    v_pk_fma_f32 v[136:137], v[16:17], v[56:57], v[136:137]
    v_pk_fma_f32 v[138:139], v[18:19], v[56:57], v[138:139]
    v_pk_mul_f32 v[132:133], v[132:133], v[28:29]
    v_pk_mul_f32 v[134:135], v[134:135], v[30:31]
    v_pk_mul_f32 v[136:137], v[136:137], v[32:33]
    v_pk_mul_f32 v[138:139], v[138:139], v[34:35]
    v_cvt_pk_bf16_f32 v132, v132, v133
    v_cvt_pk_bf16_f32 v133, v134, v135
    v_cvt_pk_bf16_f32 v134, v136, v137
    v_cvt_pk_bf16_f32 v135, v138, v139
    v_pk_fma_f32 v[148:149], v[12:13], v[58:59], v[148:149]
    v_pk_fma_f32 v[150:151], v[14:15], v[58:59], v[150:151]
    v_pk_fma_f32 v[152:153], v[16:17], v[58:59], v[152:153]
    v_pk_fma_f32 v[154:155], v[18:19], v[58:59], v[154:155]
    v_pk_mul_f32 v[148:149], v[148:149], v[28:29]
    v_pk_mul_f32 v[150:151], v[150:151], v[30:31]
    v_pk_mul_f32 v[152:153], v[152:153], v[32:33]
    v_pk_mul_f32 v[154:155], v[154:155], v[34:35]
    v_cvt_pk_bf16_f32 v148, v148, v149
    v_cvt_pk_bf16_f32 v149, v150, v151
    v_cvt_pk_bf16_f32 v150, v152, v153
    v_cvt_pk_bf16_f32 v151, v154, v155
    v_mov_b32 v56, 0x3f803f80
    v_mov_b32 v57, 0x3f803f80
    v_mov_b32 v58, 0x3f803f80
    v_mov_b32 v59, 0x3f803f80
    v_mov_b32 v164, 1
    v_mov_b32 v165, 2
    v_pk_fma_f32 v[108:109], v[36:37], v[52:53], v[108:109]
    v_pk_fma_f32 v[110:111], v[38:39], v[52:53], v[110:111]
    v_pk_fma_f32 v[112:113], v[40:41], v[52:53], v[112:113]
    v_pk_fma_f32 v[114:115], v[42:43], v[52:53], v[114:115]
    s_waitcnt lgkmcnt(1)
    v_pk_mul_f32 v[20:21], v[108:109], v[144:145]
    v_pk_mul_f32 v[22:23], v[110:111], v[146:147]
    s_waitcnt lgkmcnt(0)
    v_pk_mul_f32 v[24:25], v[112:113], v[160:161]
    v_pk_mul_f32 v[26:27], v[114:115], v[162:163]
    v_pk_fma_f32 v[108:109], v[108:109], v[44:45], s[40:41]
    v_pk_fma_f32 v[110:111], v[110:111], v[46:47], s[40:41]
    v_pk_fma_f32 v[112:113], v[112:113], v[48:49], s[40:41]
    v_pk_fma_f32 v[114:115], v[114:115], v[50:51], s[40:41]
    v_mfma_f32_16x16x32_bf16 v[136:139], v[100:103], v[132:135], 0
    v_exp_f32 v20, v20 clamp
    v_mfma_f32_16x16x32_bf16 v[152:155], v[100:103], v[148:151], 0
    v_exp_f32 v21, v21 clamp
    v_mfma_f32_16x16x32_bf16 v[104:107], v[100:103], v[56:59], 0
    v_exp_f32 v22, v22 clamp
    v_exp_f32 v23, v23 clamp
    v_exp_f32 v24, v24 clamp
    v_exp_f32 v25, v25 clamp
    v_exp_f32 v26, v26 clamp
    v_exp_f32 v27, v27 clamp
    v_pk_add_f32 v[20:21], v[20:21], s[74:75]
    v_pk_add_f32 v[22:23], v[22:23], s[74:75]
    v_pk_add_f32 v[24:25], v[24:25], s[74:75]
    v_pk_add_f32 v[26:27], v[26:27], s[74:75]
    v_max_f32 v108, v108, v20
    v_max_f32 v109, v109, v21
    v_max_f32 v110, v110, v22
    v_max_f32 v111, v111, v23
    v_max_f32 v112, v112, v24
    v_max_f32 v113, v113, v25
    v_max_f32 v114, v114, v26
    v_max_f32 v115, v115, v27
    v_cvt_pk_bf16_f32 v108, v108, v109
    v_cvt_pk_bf16_f32 v109, v110, v111
    v_cvt_pk_bf16_f32 v110, v112, v113
    v_cvt_pk_bf16_f32 v111, v114, v115
    v_pk_fma_f32 v[116:117], v[12:13], v[54:55], v[116:117]
    v_pk_fma_f32 v[118:119], v[14:15], v[54:55], v[118:119]
    v_pk_fma_f32 v[120:121], v[16:17], v[54:55], v[120:121]
    v_pk_fma_f32 v[122:123], v[18:19], v[54:55], v[122:123]
    v_pk_mul_f32 v[20:21], v[116:117], v[60:61]
    v_pk_mul_f32 v[22:23], v[118:119], v[62:63]
    v_pk_mul_f32 v[24:25], v[120:121], v[64:65]
    v_pk_mul_f32 v[26:27], v[122:123], v[66:67]
    v_pk_fma_f32 v[116:117], v[116:117], v[28:29], s[40:41]
    v_pk_fma_f32 v[118:119], v[118:119], v[30:31], s[40:41]
    v_pk_fma_f32 v[120:121], v[120:121], v[32:33], s[40:41]
    v_pk_fma_f32 v[122:123], v[122:123], v[34:35], s[40:41]
    v_mfma_f32_16x16x32_bf16 v[136:139], v[108:111], v[140:143], v[136:139]
    v_exp_f32 v20, v20 clamp
    v_mfma_f32_16x16x32_bf16 v[152:155], v[108:111], v[156:159], v[152:155]
    v_exp_f32 v21, v21 clamp
    v_mfma_f32_16x16x32_bf16 v[104:107], v[108:111], v[56:59], v[104:107]
    v_exp_f32 v22, v22 clamp
    v_exp_f32 v23, v23 clamp
    v_exp_f32 v24, v24 clamp
    v_exp_f32 v25, v25 clamp
    v_exp_f32 v26, v26 clamp
    v_exp_f32 v27, v27 clamp
    v_pk_add_f32 v[20:21], v[20:21], s[74:75]
    v_pk_add_f32 v[22:23], v[22:23], s[74:75]
    v_pk_add_f32 v[24:25], v[24:25], s[74:75]
    v_pk_add_f32 v[26:27], v[26:27], s[74:75]
    ds_write_b128 v1, v[136:139] offset:0
    ds_write_b128 v1, v[152:155] offset:1024
    s_mov_b64 exec, s[50:51]
    ds_write_b128 v2, v[104:107] offset:0
    s_mov_b64 exec, 1
    ds_write_b32 v3, v164
    s_mov_b64 exec, -1
    v_max_f32 v116, v116, v20
    v_max_f32 v117, v117, v21
    v_max_f32 v118, v118, v22
    v_max_f32 v119, v119, v23
    v_max_f32 v120, v120, v24
    v_max_f32 v121, v121, v25
    v_max_f32 v122, v122, v26
    v_max_f32_e64 v123, v123, v27
    v_cvt_pk_bf16_f32 v116, v116, v117
    v_cvt_pk_bf16_f32 v117, v118, v119
    v_cvt_pk_bf16_f32 v118, v120, v121
    v_cvt_pk_bf16_f32 v119, v122, v123
    v_pk_fma_f32 v[124:125], v[36:37], v[54:55], v[124:125]
    v_pk_fma_f32 v[126:127], v[38:39], v[54:55], v[126:127]
    v_pk_fma_f32 v[128:129], v[40:41], v[54:55], v[128:129]
    v_pk_fma_f32 v[130:131], v[42:43], v[54:55], v[130:131]
    v_pk_mul_f32 v[20:21], v[124:125], v[144:145]
    v_pk_mul_f32 v[22:23], v[126:127], v[146:147]
    v_pk_mul_f32 v[24:25], v[128:129], v[160:161]
    v_pk_mul_f32 v[26:27], v[130:131], v[162:163]
    v_pk_fma_f32 v[124:125], v[124:125], v[44:45], s[40:41]
    v_pk_fma_f32 v[126:127], v[126:127], v[46:47], s[40:41]
    v_pk_fma_f32 v[128:129], v[128:129], v[48:49], s[40:41]
    v_pk_fma_f32 v[130:131], v[130:131], v[50:51], s[40:41]
    v_mfma_f32_16x16x32_bf16 v[112:115], v[116:119], v[132:135], 0
    v_exp_f32 v20, v20 clamp
    v_mfma_f32_16x16x32_bf16 v[120:123], v[116:119], v[148:151], 0
    v_exp_f32 v21, v21 clamp
    v_mfma_f32_16x16x32_bf16 v[100:103], v[116:119], v[56:59], 0
    v_exp_f32 v22, v22 clamp
    v_exp_f32 v23, v23 clamp
    v_exp_f32 v24, v24 clamp
    v_exp_f32 v25, v25 clamp
    v_exp_f32 v26, v26 clamp
    v_exp_f32 v27, v27 clamp
    v_pk_add_f32 v[20:21], v[20:21], s[74:75]
    v_pk_add_f32 v[22:23], v[22:23], s[74:75]
    v_pk_add_f32 v[24:25], v[24:25], s[74:75]
    v_pk_add_f32 v[26:27], v[26:27], s[74:75]
    v_max_f32 v124, v124, v20
    v_max_f32 v125, v125, v21
    v_max_f32 v126, v126, v22
    v_max_f32 v127, v127, v23
    v_max_f32 v128, v128, v24
    v_max_f32 v129, v129, v25
    v_max_f32 v130, v130, v26
    v_max_f32 v131, v131, v27
    v_cvt_pk_bf16_f32 v124, v124, v125
    v_cvt_pk_bf16_f32 v125, v126, v127
    v_cvt_pk_bf16_f32 v126, v128, v129
    v_cvt_pk_bf16_f32 v127, v130, v131
    s_nop 1
    v_mfma_f32_16x16x32_bf16 v[112:115], v[124:127], v[140:143], v[112:115]
    v_mfma_f32_16x16x32_bf16 v[120:123], v[124:127], v[156:159], v[120:123]
    v_mfma_f32_16x16x32_bf16 v[100:103], v[124:127], v[56:59], v[100:103]
    ds_read_b64_tr_b16 v[44:45], v8 offset:0
    ds_read_b64_tr_b16 v[46:47], v8 offset:512
    ds_read_b128 v[12:15], v4 offset:0
    ds_read_b64_tr_b16 v[52:53], v8 offset:4096
    ds_read_b64_tr_b16 v[54:55], v8 offset:4608
    ds_read_b128 v[28:31], v5 offset:0
    ds_write_b128 v1, v[112:115] offset:2048
    ds_write_b128 v1, v[120:123] offset:3072
    s_mov_b64 exec, s[50:51]
    ds_write_b128 v2, v[100:103] offset:64
    s_mov_b64 exec, 1
    ds_write_b32 v3, v165
    s_mov_b64 exec, -1
    ds_read_b64_tr_b16 v[48:49], v9 offset:0
    s_waitcnt lgkmcnt(8)
    ds_read_b64_tr_b16 v[50:51], v9 offset:512
    ds_read_b64_tr_b16 v[56:57], v9 offset:4096
    ds_read_b64_tr_b16 v[58:59], v9 offset:4608
    ds_read_b128 v[16:19], v4 offset:2048
    s_setprio 0
    v_and_b32 v60, 15, v0
    s_lshl_b32 s44, s36, 8
    s_add_u32 s44, s44, 24832
    v_lshl_add_u32 v60, v60, 2, s44
    v_add_u32 v61, 1024, v60
    s_lshl_b32 s44, s37, 7
    s_add_u32 s44, s44, 26368
    v_and_or_b32 v62, v0, 48, s44
    s_lshl_b32 s44, s35, 2
    s_and_b32 s47, s3, 2
    s_add_u32 s44, s44, s47
    s_lshr_b32 s44, 0xeee7eece, s44
    s_and_b32 s44, s44, 3
    s_mul_i32 s44, s44, 40960
    s_and_b32 s47, s28, 1
    s_lshl_b32 s47, s47, 13
    s_add_u32 s44, s44, s47
    s_lshl_b32 s47, s37, 6
    v_lshrrev_b32 v63, 4, v0
    v_lshlrev_b32 v63, 3, v63
    v_xor_b32 v63, s47, v63
    v_and_b32 v64, 14, v0
    v_lshlrev_b32 v64, 3, v64
    v_xor_b32 v63, v63, v64
    v_and_b32 v64, 15, v0
    v_lshlrev_b32 v64, 7, v64
    v_add3_u32 v63, v63, v64, s44
    v_xor_b32 v64, 32, v63

    s_waitcnt lgkmcnt(0)
    v_mfma_f32_16x16x32_bf16 v[68:71], v[44:47], v[12:15], v[68:71]
    ds_read_b128 v[32:35], v5 offset:2048
    ds_read_b128 v[20:23], v4 offset:4096
    v_mfma_f32_16x16x32_bf16 v[68:71], v[52:55], v[28:31], v[68:71]
    ds_read_b128 v[36:39], v5 offset:4096
    v_mfma_f32_16x16x32_bf16 v[84:87], v[48:51], v[12:15], v[84:87]
    ds_read_b128 v[24:27], v4 offset:6144
    ds_read_b128 v[40:43], v5 offset:6144
    v_mfma_f32_16x16x32_bf16 v[84:87], v[56:59], v[28:31], v[84:87]
    ds_read_b64_tr_b16 v[132:133], v8 offset:40960
    v_mfma_f32_16x16x32_bf16 v[72:75], v[44:47], v[16:19], v[72:75]
    ds_read_b64_tr_b16 v[134:135], v8 offset:41472
    ds_read_b128 v[100:103], v4 offset:40960
    s_waitcnt lgkmcnt(7)
    v_mfma_f32_16x16x32_bf16 v[72:75], v[52:55], v[32:35], v[72:75]
    ds_read_b64_tr_b16 v[140:141], v8 offset:45056
    v_mfma_f32_16x16x32_bf16 v[88:91], v[48:51], v[16:19], v[88:91]
    ds_read_b64_tr_b16 v[142:143], v8 offset:45568
    ds_read_b128 v[116:119], v5 offset:40960
    v_mfma_f32_16x16x32_bf16 v[88:91], v[56:59], v[32:35], v[88:91]
    ds_read_b64_tr_b16 v[136:137], v9 offset:40960
    s_waitcnt lgkmcnt(7)
    v_mfma_f32_16x16x32_bf16 v[76:79], v[44:47], v[20:23], v[76:79]
    ds_read_b64_tr_b16 v[138:139], v9 offset:41472
    ds_read_b64_tr_b16 v[144:145], v9 offset:45056
    v_mfma_f32_16x16x32_bf16 v[76:79], v[52:55], v[36:39], v[76:79]
    ds_read_b64_tr_b16 v[146:147], v9 offset:45568
    v_mfma_f32_16x16x32_bf16 v[92:95], v[48:51], v[20:23], v[92:95]
    ds_read_b128 v[104:107], v4 offset:43008
    ds_read_b128 v[120:123], v5 offset:43008
    v_mfma_f32_16x16x32_bf16 v[92:95], v[56:59], v[36:39], v[92:95]
    ds_read_b128 v[108:111], v4 offset:45056
    v_mfma_f32_16x16x32_bf16 v[80:83], v[44:47], v[24:27], v[80:83]
    ds_read_b128 v[124:127], v5 offset:45056
    ds_read_b128 v[112:115], v4 offset:47104
    s_waitcnt lgkmcnt(8)
    v_mfma_f32_16x16x32_bf16 v[80:83], v[52:55], v[40:43], v[80:83]
    ds_read_b128 v[128:131], v5 offset:47104
    v_mfma_f32_16x16x32_bf16 v[96:99], v[48:51], v[24:27], v[96:99]
    ds_read_b64_tr_b16 v[44:45], v10 offset:0
    ds_read_b64_tr_b16 v[46:47], v10 offset:512
    v_mfma_f32_16x16x32_bf16 v[96:99], v[56:59], v[40:43], v[96:99]
    ds_read_b128 v[12:15], v6 offset:0
    v_mfma_f32_16x16x32_bf16 v[68:71], v[132:135], v[100:103], v[68:71]
    ds_read_b64_tr_b16 v[52:53], v10 offset:4096
    ds_read_b64_tr_b16 v[54:55], v10 offset:4608
    s_waitcnt lgkmcnt(8)
    v_mfma_f32_16x16x32_bf16 v[68:71], v[140:143], v[116:119], v[68:71]
    ds_read_b128 v[28:31], v7 offset:0
    v_mfma_f32_16x16x32_bf16 v[84:87], v[136:139], v[100:103], v[84:87]
    ds_read_b64_tr_b16 v[48:49], v11 offset:0
    ds_read_b64_tr_b16 v[50:51], v11 offset:512
    v_mfma_f32_16x16x32_bf16 v[84:87], v[144:147], v[116:119], v[84:87]
    ds_read_b64_tr_b16 v[56:57], v11 offset:4096
    v_mfma_f32_16x16x32_bf16 v[72:75], v[132:135], v[104:107], v[72:75]
    ds_read_b64_tr_b16 v[58:59], v11 offset:4608
    ds_read_b128 v[16:19], v6 offset:2048
    s_waitcnt lgkmcnt(8)
    v_mfma_f32_16x16x32_bf16 v[72:75], v[140:143], v[120:123], v[72:75]
    ds_read_b128 v[32:35], v7 offset:2048
    v_mfma_f32_16x16x32_bf16 v[88:91], v[136:139], v[104:107], v[88:91]
    ds_read_b128 v[100:103], v6 offset:40960
    ds_read_b128 v[116:119], v7 offset:40960
    v_mfma_f32_16x16x32_bf16 v[88:91], v[144:147], v[120:123], v[88:91]
    ds_read_b128 v[104:107], v6 offset:43008
    v_mfma_f32_16x16x32_bf16 v[76:79], v[132:135], v[108:111], v[76:79]
    ds_read_b128 v[120:123], v7 offset:43008
    ds_read_b128 v[20:23], v6 offset:4096
    s_waitcnt lgkmcnt(8)
    v_mfma_f32_16x16x32_bf16 v[76:79], v[140:143], v[124:127], v[76:79]
    ds_read2_b32 v[66:67], v61 offset0:0 offset1:0
    v_mfma_f32_16x16x32_bf16 v[92:95], v[136:139], v[108:111], v[92:95]
    ds_read2_b32 v[164:165], v61 offset0:16 offset1:16
    ds_read_b128 v[36:39], v7 offset:4096
    v_mfma_f32_16x16x32_bf16 v[92:95], v[144:147], v[124:127], v[92:95]
    ds_read_b128 v[24:27], v6 offset:6144
    v_mfma_f32_16x16x32_bf16 v[80:83], v[132:135], v[112:115], v[80:83]
    ds_read_b64_tr_b16 v[132:133], v10 offset:40960
    ds_read_b64_tr_b16 v[134:135], v10 offset:41472
    s_waitcnt lgkmcnt(8)
    v_mfma_f32_16x16x32_bf16 v[80:83], v[140:143], v[128:131], v[80:83]
    ds_read_b64_tr_b16 v[140:141], v10 offset:45056
    v_mfma_f32_16x16x32_bf16 v[96:99], v[136:139], v[112:115], v[96:99]
    ds_read_b64_tr_b16 v[142:143], v10 offset:45568
    ds_read_b64_tr_b16 v[136:137], v11 offset:40960
    v_mfma_f32_16x16x32_bf16 v[96:99], v[144:147], v[128:131], v[96:99]
    ds_read_b64_tr_b16 v[138:139], v11 offset:41472
    v_mfma_f32_16x16x32_bf16 v[68:71], v[44:47], v[12:15], v[68:71]
    ds_read_b64_tr_b16 v[144:145], v11 offset:45056
    ds_read_b64_tr_b16 v[146:147], v11 offset:45568
    s_waitcnt lgkmcnt(8)
    v_mfma_f32_16x16x32_bf16 v[68:71], v[52:55], v[28:31], v[68:71]
    ds_read_b128 v[40:43], v7 offset:6144
    v_mfma_f32_16x16x32_bf16 v[84:87], v[48:51], v[12:15], v[84:87]
    ds_read_b128 v[12:15], v62 offset:0
    ds_read_b128 v[108:111], v6 offset:45056
    v_mfma_f32_16x16x32_bf16 v[84:87], v[56:59], v[28:31], v[84:87]
    ds_read2_b32 v[28:29], v60 offset0:0 offset1:0
    v_mfma_f32_16x16x32_bf16 v[72:75], v[44:47], v[16:19], v[72:75]
    ds_read2_b32 v[30:31], v60 offset0:16 offset1:16
    ds_read_b128 v[124:127], v7 offset:45056
    s_waitcnt lgkmcnt(8)
    v_mfma_f32_16x16x32_bf16 v[72:75], v[52:55], v[32:35], v[72:75]
    ds_read_b128 v[112:115], v6 offset:47104
    v_mfma_f32_16x16x32_bf16 v[88:91], v[48:51], v[16:19], v[88:91]
    ds_read_b128 v[16:19], v62 offset:64
    ds_read_b128 v[128:131], v7 offset:47104
    v_mfma_f32_16x16x32_bf16 v[88:91], v[56:59], v[32:35], v[88:91]
    ds_read2_b32 v[32:33], v60 offset0:128 offset1:128
    ds_read2_b32 v[34:35], v60 offset0:144 offset1:144
    v_mfma_f32_16x16x32_bf16 v[68:71], v[132:135], v[100:103], v[68:71]
    ds_read_b64 v[148:149], v63 offset:0
    ds_read_b64 v[150:151], v64 offset:0
    s_waitcnt lgkmcnt(9)
    v_mfma_f32_16x16x32_bf16 v[68:71], v[140:143], v[116:119], v[68:71]
    ds_read_b64 v[152:153], v63 offset:2048
    v_mfma_f32_16x16x32_bf16 v[84:87], v[136:139], v[100:103], v[84:87]
    ds_read_b64 v[154:155], v64 offset:2048
    ds_read_b64 v[156:157], v63 offset:4096
    v_mfma_f32_16x16x32_bf16 v[84:87], v[144:147], v[116:119], v[84:87]
    ds_read_b64 v[158:159], v64 offset:4096
    v_mfma_f32_16x16x32_bf16 v[72:75], v[132:135], v[104:107], v[72:75]
    ds_read_b64 v[160:161], v63 offset:6144
    ds_read_b64 v[162:163], v64 offset:6144
    v_mov_b32_e64 v65, 3
    s_mov_b64 exec, 1
    s_waitcnt lgkmcnt(8)
    ds_write_b32 v3, v65 offset:0
W_2:
    s_cbranch_execz R_2
    s_nop 0
    s_mov_b64 exec, -1
    s_waitcnt lgkmcnt(9)
    v_mfma_f32_16x16x32_bf16 v[72:75], v[140:143], v[120:123], v[72:75]
    v_mfma_f32_16x16x32_bf16 v[88:91], v[136:139], v[104:107], v[88:91]
    v_mfma_f32_16x16x32_bf16 v[88:91], v[144:147], v[120:123], v[88:91]
    v_pk_fma_f32 v[68:69], v[12:13], v[28:29], v[68:69]
    v_pk_fma_f32 v[70:71], v[14:15], v[28:29], v[70:71]
    v_pk_fma_f32 v[84:85], v[16:17], v[28:29], v[84:85]
    v_pk_fma_f32 v[86:87], v[18:19], v[28:29], v[86:87]
    s_nop 1
    v_pk_fma_f32 v[72:73], v[12:13], v[30:31], v[72:73]
    v_pk_fma_f32 v[74:75], v[14:15], v[30:31], v[74:75]
    v_pk_fma_f32 v[88:89], v[16:17], v[30:31], v[88:89]
    v_pk_fma_f32 v[90:91], v[18:19], v[30:31], v[90:91]
    v_pk_mul_f32 v[100:101], v[68:69], v[66:67]
    v_pk_mul_f32 v[102:103], v[70:71], v[66:67]
    v_pk_mul_f32 v[104:105], v[84:85], v[66:67]
    v_pk_mul_f32 v[106:107], v[86:87], v[66:67]
    v_pk_mul_f32 v[116:117], v[72:73], v[164:165]
    v_pk_mul_f32 v[118:119], v[74:75], v[164:165]
    v_pk_mul_f32 v[120:121], v[88:89], v[164:165]
    v_pk_mul_f32 v[122:123], v[90:91], v[164:165]
    v_pk_fma_f32 v[68:69], v[68:69], v[32:33], s[40:41]
    v_pk_fma_f32 v[70:71], v[70:71], v[32:33], s[40:41]
    v_pk_fma_f32 v[84:85], v[84:85], v[32:33], s[40:41]
    v_pk_fma_f32 v[86:87], v[86:87], v[32:33], s[40:41]
    v_pk_fma_f32 v[72:73], v[72:73], v[34:35], s[40:41]
    v_pk_fma_f32 v[74:75], v[74:75], v[34:35], s[40:41]
    v_pk_fma_f32 v[88:89], v[88:89], v[34:35], s[40:41]
    v_pk_fma_f32 v[90:91], v[90:91], v[34:35], s[40:41]
    v_mfma_f32_16x16x32_bf16 v[76:79], v[44:47], v[20:23], v[76:79]
    v_exp_f32 v100, v100 clamp
    ds_read2_b32 v[28:29], v60 offset0:32 offset1:32
    v_mfma_f32_16x16x32_bf16 v[76:79], v[52:55], v[36:39], v[76:79]
    v_exp_f32 v101, v101 clamp
    ds_read2_b32 v[30:31], v60 offset0:48 offset1:48
    v_mfma_f32_16x16x32_bf16 v[92:95], v[48:51], v[20:23], v[92:95]
    v_exp_f32 v102, v102 clamp
    ds_read2_b32 v[66:67], v61 offset0:32 offset1:32
    v_mfma_f32_16x16x32_bf16 v[92:95], v[56:59], v[36:39], v[92:95]
    v_exp_f32 v103, v103 clamp
    ds_read2_b32 v[164:165], v61 offset0:48 offset1:48
    v_mfma_f32_16x16x32_bf16 v[80:83], v[44:47], v[24:27], v[80:83]
    v_exp_f32 v104, v104 clamp
    ds_read2_b32 v[32:33], v60 offset0:160 offset1:160
    s_waitcnt lgkmcnt(5)
    v_mfma_f32_16x16x32_bf16 v[80:83], v[52:55], v[40:43], v[80:83]
    v_exp_f32 v105, v105 clamp
    ds_read2_b32 v[34:35], v60 offset0:176 offset1:176
    v_mfma_f32_16x16x32_bf16 v[96:99], v[48:51], v[24:27], v[96:99]
    v_exp_f32 v106, v106 clamp
    v_mfma_f32_16x16x32_bf16 v[96:99], v[56:59], v[40:43], v[96:99]
    v_exp_f32 v107, v107 clamp
    v_mfma_f32_16x16x32_bf16 v[76:79], v[132:135], v[108:111], v[76:79]
    v_exp_f32 v116, v116 clamp
    v_mfma_f32_16x16x32_bf16 v[76:79], v[140:143], v[124:127], v[76:79]
    v_exp_f32 v117, v117 clamp
    v_mfma_f32_16x16x32_bf16 v[92:95], v[136:139], v[108:111], v[92:95]
    v_exp_f32 v118, v118 clamp
    v_mfma_f32_16x16x32_bf16 v[92:95], v[144:147], v[124:127], v[92:95]
    v_exp_f32 v119, v119 clamp
    v_mfma_f32_16x16x32_bf16 v[80:83], v[132:135], v[112:115], v[80:83]
    v_exp_f32 v120, v120 clamp
    v_mfma_f32_16x16x32_bf16 v[80:83], v[140:143], v[128:131], v[80:83]
    v_exp_f32 v121, v121 clamp
    v_mfma_f32_16x16x32_bf16 v[96:99], v[136:139], v[112:115], v[96:99]
    v_exp_f32 v122, v122 clamp
    v_mfma_f32_16x16x32_bf16 v[96:99], v[144:147], v[128:131], v[96:99]
    v_exp_f32 v123, v123 clamp
    v_pk_add_f32 v[100:101], v[100:101], s[74:75]
    v_pk_add_f32 v[102:103], v[102:103], s[74:75]
    v_pk_add_f32 v[104:105], v[104:105], s[74:75]
    v_pk_add_f32 v[106:107], v[106:107], s[74:75]
    v_pk_add_f32 v[116:117], v[116:117], s[74:75]
    v_pk_add_f32 v[118:119], v[118:119], s[74:75]
    v_pk_add_f32 v[120:121], v[120:121], s[74:75]
    v_pk_add_f32 v[122:123], v[122:123], s[74:75]
    v_max_f32 v68, v68, v100
    v_max_f32 v69, v69, v101
    v_max_f32 v70, v70, v102
    v_max_f32 v71, v71, v103
    v_max_f32 v84, v84, v104
    v_max_f32 v85, v85, v105
    v_max_f32 v86, v86, v106
    v_max_f32 v87, v87, v107
    v_max_f32 v72, v72, v116
    v_max_f32 v73, v73, v117
    v_max_f32 v74, v74, v118
    v_max_f32 v75, v75, v119
    v_max_f32 v88, v88, v120
    v_max_f32 v89, v89, v121
    v_max_f32 v90, v90, v122
    v_max_f32_e64 v91, v91, v123
    v_cvt_pk_bf16_f32 v44, v68, v69
    v_cvt_pk_bf16_f32 v45, v70, v71
    v_cvt_pk_bf16_f32 v46, v84, v85
    v_cvt_pk_bf16_f32 v47, v86, v87
    v_cvt_pk_bf16_f32 v48, v72, v73
    v_cvt_pk_bf16_f32 v49, v74, v75
    v_cvt_pk_bf16_f32 v50, v88, v89
    v_cvt_pk_bf16_f32 v51, v90, v91
    s_waitcnt lgkmcnt(5)
    v_pk_fma_f32 v[76:77], v[12:13], v[28:29], v[76:77]
    v_pk_fma_f32 v[78:79], v[14:15], v[28:29], v[78:79]
    v_pk_fma_f32 v[92:93], v[16:17], v[28:29], v[92:93]
    v_pk_fma_f32 v[94:95], v[18:19], v[28:29], v[94:95]
    s_waitcnt lgkmcnt(4)
    v_pk_fma_f32 v[80:81], v[12:13], v[30:31], v[80:81]
    v_pk_fma_f32 v[82:83], v[14:15], v[30:31], v[82:83]
    v_pk_fma_f32 v[96:97], v[16:17], v[30:31], v[96:97]
    v_pk_fma_f32 v[98:99], v[18:19], v[30:31], v[98:99]
    s_waitcnt lgkmcnt(3)
    v_pk_mul_f32 v[108:109], v[76:77], v[66:67]
    v_pk_mul_f32 v[110:111], v[78:79], v[66:67]
    v_pk_mul_f32 v[112:113], v[92:93], v[66:67]
    v_pk_mul_f32 v[114:115], v[94:95], v[66:67]
    s_waitcnt lgkmcnt(2)
    v_pk_mul_f32 v[124:125], v[80:81], v[164:165]
    v_pk_mul_f32 v[126:127], v[82:83], v[164:165]
    v_pk_mul_f32 v[128:129], v[96:97], v[164:165]
    v_pk_mul_f32 v[130:131], v[98:99], v[164:165]
    s_waitcnt lgkmcnt(1)
    v_pk_fma_f32 v[76:77], v[76:77], v[32:33], s[40:41]
    v_pk_fma_f32 v[78:79], v[78:79], v[32:33], s[40:41]
    v_pk_fma_f32 v[92:93], v[92:93], v[32:33], s[40:41]
    v_pk_fma_f32 v[94:95], v[94:95], v[32:33], s[40:41]
    s_waitcnt lgkmcnt(0)
    v_pk_fma_f32 v[80:81], v[80:81], v[34:35], s[40:41]
    v_pk_fma_f32 v[82:83], v[82:83], v[34:35], s[40:41]
    v_pk_fma_f32 v[96:97], v[96:97], v[34:35], s[40:41]
    v_pk_fma_f32 v[98:99], v[98:99], v[34:35], s[40:41]
    v_exp_f32 v108, v108 clamp
    v_exp_f32 v109, v109 clamp
    v_exp_f32 v110, v110 clamp
    v_exp_f32 v111, v111 clamp
    v_exp_f32 v112, v112 clamp
    v_exp_f32 v113, v113 clamp
    v_exp_f32 v114, v114 clamp
    v_exp_f32 v115, v115 clamp
    v_exp_f32 v124, v124 clamp
    v_exp_f32 v125, v125 clamp
    v_exp_f32 v126, v126 clamp
    v_exp_f32 v127, v127 clamp
    v_exp_f32 v128, v128 clamp
    v_exp_f32 v129, v129 clamp
    v_exp_f32 v130, v130 clamp
    v_exp_f32 v131, v131 clamp
    v_pk_add_f32 v[108:109], v[108:109], s[74:75]
    v_pk_add_f32 v[110:111], v[110:111], s[74:75]
    v_pk_add_f32 v[112:113], v[112:113], s[74:75]
    v_pk_add_f32 v[114:115], v[114:115], s[74:75]
    v_pk_add_f32 v[124:125], v[124:125], s[74:75]
    v_pk_add_f32 v[126:127], v[126:127], s[74:75]
    v_pk_add_f32 v[128:129], v[128:129], s[74:75]
    v_pk_add_f32 v[130:131], v[130:131], s[74:75]
    v_max_f32 v76, v76, v108
    v_max_f32 v77, v77, v109
    v_max_f32 v78, v78, v110
    v_max_f32 v79, v79, v111
    v_max_f32 v92, v92, v112
    v_max_f32 v93, v93, v113
    v_max_f32 v94, v94, v114
    v_max_f32 v95, v95, v115
    v_max_f32 v80, v80, v124
    v_max_f32 v81, v81, v125
    v_max_f32 v82, v82, v126
    v_max_f32 v83, v83, v127
    v_max_f32 v96, v96, v128
    v_max_f32 v97, v97, v129
    v_max_f32 v98, v98, v130
    v_max_f32 v99, v99, v131
    v_cvt_pk_bf16_f32 v52, v76, v77
    v_cvt_pk_bf16_f32 v53, v78, v79
    v_cvt_pk_bf16_f32 v54, v92, v93
    v_cvt_pk_bf16_f32 v55, v94, v95
    v_cvt_pk_bf16_f32 v56, v80, v81
    v_cvt_pk_bf16_f32 v57, v82, v83
    v_cvt_pk_bf16_f32 v58, v96, v97
    v_cvt_pk_bf16_f32 v59, v98, v99
    s_and_b32 s44, s46, 127
    s_lshl_b32 s44, s44, 2
    s_add_u32 s44, s44, 24832
    v_and_b32 v1, 15, v0
    v_lshl_add_u32 v63, v1, 2, s44

    v_lshrrev_b32 v2, 4, v0
    v_bfe_u32 v1, v0, 2, 2
    v_lshl_add_u32 v1, v2, 2, v1
    v_and_b32 v2, 7, v1
    s_lshl_b32 s44, s3, 1
    v_xor_b32 v2, s44, v2
    v_lshlrev_b32 v2, 5, v2
    v_lshl_add_u32 v2, v1, 8, v2
    v_and_b32 v1, 3, v0
    v_lshl_add_u32 v2, v1, 3, v2
    v_add_u32 v128, 65536, v2
    v_xor_b32 v129, 32, v128
    v_add_u32 v130, 122880, v2
    v_xor_b32 v131, 32, v130
    v_lshlrev_b32 v2, 2, v1
    v_add_u32 v2, 24640, v2
    s_lshl_b32 s44, s37, 10
    s_add_u32 s44, s44, 139264
    v_lshl_add_u32 v64, v0, 4, s44

    ds_read2_b32 v[4:5], v63 offset0:0 offset1:0
    ds_read2_b32 v[6:7], v63 offset0:16 offset1:16
    ds_read2_b32 v[8:9], v63 offset0:32 offset1:32
    ds_read2_b32 v[10:11], v63 offset0:48 offset1:48
    ds_read2_b32 v[12:13], v63 offset0:128 offset1:128
    ds_read2_b32 v[14:15], v63 offset0:144 offset1:144
    ds_read2_b32 v[16:17], v63 offset0:160 offset1:160
    ds_read2_b32 v[18:19], v63 offset0:176 offset1:176
    v_lshlrev_b32 v60, 4, v0
    v_and_b32 v61, 48, v0
    s_setprio 2
SP_1:
    s_load_dword s58, s[56:57], 0 glc
    s_waitcnt lgkmcnt(0)
    s_cmp_ge_u32 s58, 32
    s_cbranch_scc1 SD_2
    s_sleep 2
    s_branch SP_1
SD_2:
F_kp:
    buffer_load_dwordx4 v[36:39], v61, s[24:27], s83 offen offset:0 sc0 sc1
    buffer_load_dwordx4 v[40:43], v61, s[24:27], s83 offen offset:64 sc0 sc1
    buffer_load_dwordx4 v[20:23], v60, s[24:27], s82 offen offset:0 sc0 sc1
    buffer_load_dwordx4 v[24:27], v60, s[24:27], s82 offen offset:2048 sc0 sc1
    buffer_load_dwordx4 v[28:31], v60, s[24:27], s82 offen offset:1024 sc0 sc1
    buffer_load_dwordx4 v[32:35], v60, s[24:27], s82 offen offset:3072 sc0 sc1
    v_mov_b32 v62, 4
    s_mov_b64 exec, 1
    ds_write_b32 v3, v62 offset:0
    s_mov_b64 exec, -1
    s_waitcnt vmcnt(4)
    v_cvt_pk_bf16_f32 v124, v36, v37
    v_cvt_pk_bf16_f32 v125, v38, v39
    v_cvt_pk_bf16_f32 v126, v40, v41
    v_cvt_pk_bf16_f32 v127, v42, v43
    s_nop 1
    v_mfma_f32_16x16x32_bf16 v[76:79], v[124:127], v[44:47], 0
    v_mfma_f32_16x16x32_bf16 v[88:91], v[124:127], v[48:51], 0
    v_mfma_f32_16x16x32_bf16 v[100:103], v[124:127], v[52:55], 0
    v_mfma_f32_16x16x32_bf16 v[112:115], v[124:127], v[56:59], 0
    s_waitcnt vmcnt(2)
    v_cvt_pk_bf16_f32 v116, v20, v21
    v_cvt_pk_bf16_f32 v117, v22, v23
    v_cvt_pk_bf16_f32 v118, v24, v25
    v_cvt_pk_bf16_f32 v119, v26, v27
    s_nop 1
    v_mfma_f32_16x16x32_bf16 v[68:71], v[116:119], v[44:47], 0
    v_mfma_f32_16x16x32_bf16 v[80:83], v[116:119], v[48:51], 0
    v_mfma_f32_16x16x32_bf16 v[92:95], v[116:119], v[52:55], 0
    v_mfma_f32_16x16x32_bf16 v[104:107], v[116:119], v[56:59], 0
    v_add_f32 v76, s74, v76
    v_rcp_f32 v76, v76
    s_nop 0
    v_mov_b32 v77, v76
    v_add_f32 v88, s74, v88
    v_rcp_f32 v88, v88
    s_nop 0
    v_mov_b32 v89, v88
    v_add_f32 v100, s74, v100
    v_rcp_f32 v100, v100
    s_nop 0
    v_mov_b32 v101, v100
    v_add_f32 v112, s74, v112
    v_rcp_f32 v112, v112
    s_nop 0
    v_mov_b32_e64 v113, v112
    s_waitcnt vmcnt(0)
    v_cvt_pk_bf16_f32 v120, v28, v29
    v_cvt_pk_bf16_f32 v121, v30, v31
    v_cvt_pk_bf16_f32 v122, v32, v33
    v_cvt_pk_bf16_f32 v123, v34, v35
    s_nop 1
    v_mfma_f32_16x16x32_bf16 v[72:75], v[120:123], v[44:47], 0
    v_mfma_f32_16x16x32_bf16 v[84:87], v[120:123], v[48:51], 0
    v_mfma_f32_16x16x32_bf16 v[96:99], v[120:123], v[52:55], 0
    v_mfma_f32_16x16x32_bf16 v[108:111], v[120:123], v[56:59], 0
    s_add_u32 s80, s79, 0
    v_pk_mul_f32 v[68:69], v[68:69], v[76:77]
    v_pk_mul_f32 v[70:71], v[70:71], v[76:77]
    s_nop 1
    v_pk_mul_f32 v[72:73], v[72:73], v[76:77]
    v_pk_mul_f32 v[74:75], v[74:75], v[76:77]
    v_cvt_pk_bf16_f32 v28, v68, v69
    v_cvt_pk_bf16_f32 v29, v70, v71
    v_cvt_pk_bf16_f32 v30, v72, v73
    v_cvt_pk_bf16_f32 v31, v74, v75
    buffer_store_dwordx4 v[28:31], v60, s[16:19], s80 offen sc0 sc1
    s_add_u32 s80, s79, 32768
    v_pk_mul_f32 v[80:81], v[80:81], v[88:89]
    v_pk_mul_f32 v[82:83], v[82:83], v[88:89]
    v_pk_mul_f32 v[84:85], v[84:85], v[88:89]
    v_pk_mul_f32 v[86:87], v[86:87], v[88:89]
    v_cvt_pk_bf16_f32 v32, v80, v81
    v_cvt_pk_bf16_f32 v33, v82, v83
    v_cvt_pk_bf16_f32 v34, v84, v85
    v_cvt_pk_bf16_f32 v35, v86, v87
    buffer_store_dwordx4 v[32:35], v60, s[16:19], s80 offen sc0 sc1
    s_add_u32 s80, s79, 65536
    v_pk_mul_f32 v[92:93], v[92:93], v[100:101]
    v_pk_mul_f32 v[94:95], v[94:95], v[100:101]
    v_pk_mul_f32 v[96:97], v[96:97], v[100:101]
    v_pk_mul_f32 v[98:99], v[98:99], v[100:101]
    v_cvt_pk_bf16_f32 v36, v92, v93
    v_cvt_pk_bf16_f32 v37, v94, v95
    v_cvt_pk_bf16_f32 v38, v96, v97
    v_cvt_pk_bf16_f32 v39, v98, v99
    buffer_store_dwordx4 v[36:39], v60, s[16:19], s80 offen sc0 sc1
    s_add_u32 s80, s79, 98304
    v_pk_mul_f32 v[104:105], v[104:105], v[112:113]
    v_pk_mul_f32 v[106:107], v[106:107], v[112:113]
    v_pk_mul_f32 v[108:109], v[108:109], v[112:113]
    v_pk_mul_f32 v[110:111], v[110:111], v[112:113]
    v_cvt_pk_bf16_f32 v40, v104, v105
    v_cvt_pk_bf16_f32 v41, v106, v107
    v_cvt_pk_bf16_f32 v42, v108, v109
    v_cvt_pk_bf16_f32 v43, v110, v111
    buffer_store_dwordx4 v[40:43], v60, s[16:19], s80 offen sc0 sc1
    ds_read2_b32 v[66:67], v2 offset0:0 offset1:8
    v_lshlrev_b32 v132, 16, v148
    v_and_b32 v133, 0xffff0000, v148
    v_lshlrev_b32 v134, 16, v149
    v_and_b32 v135, 0xffff0000, v149
    v_lshlrev_b32 v136, 16, v150
    v_and_b32 v137, 0xffff0000, v150
    v_lshlrev_b32 v138, 16, v151
    v_and_b32 v139, 0xffff0000, v151
    v_pk_add_f32 v[76:77], v[132:133], v[4:5]
    v_pk_add_f32 v[78:79], v[134:135], v[4:5]
    v_pk_add_f32 v[80:81], v[136:137], v[4:5]
    v_pk_add_f32 v[82:83], v[138:139], v[4:5]
    v_cvt_pk_bf16_f32 v72, v76, v77
    v_cvt_pk_bf16_f32 v73, v78, v79
    v_cvt_pk_bf16_f32 v74, v80, v81
    v_cvt_pk_bf16_f32 v75, v82, v83
    v_lshlrev_b32 v76, 16, v72
    v_and_b32 v77, 0xffff0000, v72
    v_lshlrev_b32 v78, 16, v73
    v_and_b32 v79, 0xffff0000, v73
    v_lshlrev_b32 v80, 16, v74
    v_and_b32 v81, 0xffff0000, v74
    v_lshlrev_b32 v82, 16, v75
    v_and_b32 v83, 0xffff0000, v75
    v_pk_mul_f32 v[76:77], v[76:77], v[12:13]
    v_pk_mul_f32 v[78:79], v[78:79], v[12:13]
    v_pk_mul_f32 v[80:81], v[80:81], v[12:13]
    v_pk_mul_f32 v[82:83], v[82:83], v[12:13]
    v_cvt_pk_bf16_f32 v72, v76, v77
    v_cvt_pk_bf16_f32 v73, v78, v79
    v_cvt_pk_bf16_f32 v74, v80, v81
    v_cvt_pk_bf16_f32 v75, v82, v83
    v_lshlrev_b32 v76, 16, v72
    v_and_b32 v77, 0xffff0000, v72
    v_lshlrev_b32 v78, 16, v73
    v_and_b32 v79, 0xffff0000, v73
    v_lshlrev_b32 v80, 16, v74
    v_and_b32 v81, 0xffff0000, v74
    v_lshlrev_b32 v82, 16, v75
    v_and_b32 v83, 0xffff0000, v75
    v_pk_add_f32 v[132:133], v[132:133], v[76:77]
    v_pk_add_f32 v[134:135], v[134:135], v[78:79]
    v_pk_add_f32 v[136:137], v[136:137], v[80:81]
    v_pk_add_f32 v[138:139], v[138:139], v[82:83]
    v_mov_b32 v62, 5
    s_and_b32 s44, s28, 1
    s_cmp_lg_u32 s44, s36
    s_waitcnt lgkmcnt(0)
    v_cmp_gt_u32 s[70:71], 2, v67
    s_cbranch_scc1 F_oa1
    v_cmp_gt_u32 vcc, 3, v66
    s_cbranch_vccz F_oa0

    ds_read_b32 v66, v2
FW_3:
    s_waitcnt lgkmcnt(0)
    v_cmp_gt_u32 vcc, 3, v66
    s_cbranch_vccz FO_4
    s_sleep 1
    ds_read_b32 v66, v2
    s_branch FW_3
FO_4:
F_oa0:
    ds_write_b128 v64, v[28:31] offset:0
    ds_write_b128 v64, v[32:35] offset:2048
    ds_write_b128 v64, v[36:39] offset:4096
    ds_write_b128 v64, v[40:43] offset:6144
F_oa1:
    s_cmp_lg_u64 s[70:71], 0
    s_cbranch_scc1 F_bp0
    ds_read_b64_tr_b16 v[40:41], v130 offset:24576
    ds_read_b64_tr_b16 v[42:43], v130 offset:28672
    ds_read_b64_tr_b16 v[44:45], v131 offset:24576
    ds_read_b64_tr_b16 v[46:47], v131 offset:28672
    ds_read_b64_tr_b16 v[64:65], v130 offset:32768
    ds_read_b64_tr_b16 v[66:67], v130 offset:36864
    ds_read_b64_tr_b16 v[68:69], v131 offset:32768
    ds_read_b64_tr_b16 v[70:71], v131 offset:36864
    ds_read_b64_tr_b16 v[88:89], v128 offset:0
    ds_read_b64_tr_b16 v[90:91], v128 offset:4096
    ds_read_b64_tr_b16 v[92:93], v129 offset:0
    s_waitcnt lgkmcnt(8)
    s_nop 0
    ds_read_b64_tr_b16 v[94:95], v129 offset:4096
    ds_read_b64_tr_b16 v[112:113], v128 offset:8192
    ds_read_b64_tr_b16 v[114:115], v128 offset:12288
    ds_read_b64_tr_b16 v[116:117], v129 offset:8192
    ds_read_b64_tr_b16 v[118:119], v129 offset:12288
F_bp0:
    s_waitcnt lgkmcnt(4)
    s_waitcnt vmcnt(0)
    s_atomic_add s76, s[68:69], 0
    s_atomic_add s76, s[68:69], 128
    s_atomic_add s76, s[68:69], 256
    s_atomic_add s76, s[68:69], 384
    s_mov_b64 exec, 1
    ds_write_b32 v3, v62
    s_mov_b64 exec, -1
    s_setprio 0
    v_lshlrev_b32 v140, 16, v152
    v_and_b32 v141, 0xffff0000, v152
    v_lshlrev_b32 v142, 16, v153
    v_and_b32 v143, 0xffff0000, v153
    v_lshlrev_b32 v144, 16, v154
    v_and_b32 v145, 0xffff0000, v154
    v_lshlrev_b32_e64 v146, 16, v155
    v_and_b32 v147, 0xffff0000, v155
    v_pk_add_f32 v[76:77], v[140:141], v[6:7]
    v_pk_add_f32 v[78:79], v[142:143], v[6:7]
    v_pk_add_f32 v[80:81], v[144:145], v[6:7]
    v_pk_add_f32 v[82:83], v[146:147], v[6:7]
    v_cvt_pk_bf16_f32 v72, v76, v77
    v_cvt_pk_bf16_f32 v73, v78, v79
    v_cvt_pk_bf16_f32 v74, v80, v81
    v_cvt_pk_bf16_f32 v75, v82, v83
    v_lshlrev_b32 v76, 16, v72
    v_and_b32 v77, 0xffff0000, v72
    v_lshlrev_b32 v78, 16, v73
    v_and_b32 v79, 0xffff0000, v73
    v_lshlrev_b32 v80, 16, v74
    v_and_b32 v81, 0xffff0000, v74
    v_lshlrev_b32 v82, 16, v75
    v_and_b32 v83, 0xffff0000, v75
    v_pk_mul_f32 v[76:77], v[76:77], v[14:15]
    v_pk_mul_f32 v[78:79], v[78:79], v[14:15]
    v_pk_mul_f32 v[80:81], v[80:81], v[14:15]
    v_pk_mul_f32 v[82:83], v[82:83], v[14:15]
    v_cvt_pk_bf16_f32 v72, v76, v77
    v_cvt_pk_bf16_f32 v73, v78, v79
    v_cvt_pk_bf16_f32 v74, v80, v81
    v_cvt_pk_bf16_f32 v75, v82, v83
    v_lshlrev_b32 v76, 16, v72
    v_and_b32 v77, 0xffff0000, v72
    v_lshlrev_b32 v78, 16, v73
    v_and_b32 v79, 0xffff0000, v73
    v_lshlrev_b32 v80, 16, v74
    v_and_b32 v81, 0xffff0000, v74
    v_lshlrev_b32 v82, 16, v75
    v_and_b32 v83, 0xffff0000, v75
    v_pk_add_f32 v[140:141], v[140:141], v[76:77]
    v_pk_add_f32 v[142:143], v[142:143], v[78:79]
    v_pk_add_f32 v[144:145], v[144:145], v[80:81]
    v_pk_add_f32 v[146:147], v[146:147], v[82:83]
    v_lshlrev_b32 v148, 16, v156
    v_and_b32 v149, 0xffff0000, v156
    v_lshlrev_b32 v150, 16, v157
    v_and_b32 v151, 0xffff0000, v157
    v_lshlrev_b32 v152, 16, v158
    v_and_b32 v153, 0xffff0000, v158
    v_lshlrev_b32 v154, 16, v159
    v_and_b32 v155, 0xffff0000, v159
    v_pk_add_f32 v[76:77], v[148:149], v[8:9]
    v_pk_add_f32 v[78:79], v[150:151], v[8:9]
    v_pk_add_f32 v[80:81], v[152:153], v[8:9]
    v_pk_add_f32 v[82:83], v[154:155], v[8:9]
    v_cvt_pk_bf16_f32 v72, v76, v77
    v_cvt_pk_bf16_f32 v73, v78, v79
    v_cvt_pk_bf16_f32 v74, v80, v81
    v_cvt_pk_bf16_f32 v75, v82, v83
    v_lshlrev_b32 v76, 16, v72
    v_and_b32 v77, 0xffff0000, v72
    v_lshlrev_b32 v78, 16, v73
    v_and_b32 v79, 0xffff0000, v73
    v_lshlrev_b32 v80, 16, v74
    v_and_b32 v81, 0xffff0000, v74
    v_lshlrev_b32 v82, 16, v75
    v_and_b32 v83, 0xffff0000, v75
    v_pk_mul_f32 v[76:77], v[76:77], v[16:17]
    v_pk_mul_f32 v[78:79], v[78:79], v[16:17]
    v_pk_mul_f32 v[80:81], v[80:81], v[16:17]
    v_pk_mul_f32 v[82:83], v[82:83], v[16:17]
    v_cvt_pk_bf16_f32 v72, v76, v77
    v_cvt_pk_bf16_f32 v73, v78, v79
    v_cvt_pk_bf16_f32 v74, v80, v81
    v_cvt_pk_bf16_f32 v75, v82, v83
    v_lshlrev_b32 v76, 16, v72
    v_and_b32 v77, 0xffff0000, v72
    v_lshlrev_b32 v78, 16, v73
    v_and_b32 v79, 0xffff0000, v73
    v_lshlrev_b32 v80, 16, v74
    v_and_b32 v81, 0xffff0000, v74
    v_lshlrev_b32 v82, 16, v75
    v_and_b32 v83, 0xffff0000, v75
    v_pk_add_f32 v[148:149], v[148:149], v[76:77]
    v_pk_add_f32 v[150:151], v[150:151], v[78:79]
    v_pk_add_f32 v[152:153], v[152:153], v[80:81]
    v_pk_add_f32 v[154:155], v[154:155], v[82:83]
    v_lshlrev_b32 v156, 16, v160
    v_and_b32 v157, 0xffff0000, v160
    v_lshlrev_b32 v158, 16, v161
    v_and_b32 v159, 0xffff0000, v161
    v_lshlrev_b32 v160, 16, v162
    v_and_b32 v161, 0xffff0000, v162
    v_lshlrev_b32 v162, 16, v163
    v_and_b32 v163, 0xffff0000, v163
    v_pk_add_f32 v[76:77], v[156:157], v[10:11]
    v_pk_add_f32 v[78:79], v[158:159], v[10:11]
    v_pk_add_f32 v[80:81], v[160:161], v[10:11]
    v_pk_add_f32 v[82:83], v[162:163], v[10:11]
    v_cvt_pk_bf16_f32 v72, v76, v77
    v_cvt_pk_bf16_f32 v73, v78, v79
    v_cvt_pk_bf16_f32 v74, v80, v81
    v_cvt_pk_bf16_f32 v75, v82, v83
    v_lshlrev_b32 v76, 16, v72
    v_and_b32 v77, 0xffff0000, v72
    v_lshlrev_b32 v78, 16, v73
    v_and_b32 v79, 0xffff0000, v73
    v_lshlrev_b32 v80, 16, v74
    v_and_b32 v81, 0xffff0000, v74
    v_lshlrev_b32 v82, 16, v75
    v_and_b32 v83, 0xffff0000, v75
    v_pk_mul_f32 v[76:77], v[76:77], v[18:19]
    v_pk_mul_f32 v[78:79], v[78:79], v[18:19]
    v_pk_mul_f32 v[80:81], v[80:81], v[18:19]
    v_pk_mul_f32 v[82:83], v[82:83], v[18:19]
    v_cvt_pk_bf16_f32 v72, v76, v77
    v_cvt_pk_bf16_f32 v73, v78, v79
    v_cvt_pk_bf16_f32 v74, v80, v81
    v_cvt_pk_bf16_f32 v75, v82, v83
    v_lshlrev_b32 v76, 16, v72
    v_and_b32 v77, 0xffff0000, v72
    v_lshlrev_b32 v78, 16, v73
    v_and_b32 v79, 0xffff0000, v73
    v_lshlrev_b32 v80, 16, v74
    v_and_b32 v81, 0xffff0000, v74
    v_lshlrev_b32 v82, 16, v75
    v_and_b32 v83, 0xffff0000, v75
    v_pk_add_f32 v[156:157], v[156:157], v[76:77]
    v_pk_add_f32 v[158:159], v[158:159], v[78:79]
    v_pk_add_f32 v[160:161], v[160:161], v[80:81]
    v_pk_add_f32 v[162:163], v[162:163], v[82:83]
    v_lshlrev_b32 v4, 4, v0
    v_add_u32 v5, 98304, v4
    v_add_u32 v4, 16384, v4
    v_subrev_u32 v8, 65536, v128
    v_subrev_u32 v9, 65536, v129
    v_and_b32 v1, 15, v0
    s_lshl_b32 s44, s3, 6
    s_add_u32 s44, s44, 0
    v_lshrrev_b32 v18, 4, v0
    v_lshl_add_u32 v18, v18, 3, s44
    v_mul_u32_u24 v19, 272, v1
    v_add_u32 v18, v18, v19
    v_add_u32 v19, 4352, v18
    v_add_u32 v20, 8704, v18
    v_add_u32 v21, 13056, v18

    s_setprio 2
    s_cmp_eq_u64 s[70:71], 0
    s_cbranch_scc1 F_bp1
    v_add_u32 v60, 32, v2
    ds_read_b32 v61, v60
FW_5:
    s_waitcnt lgkmcnt(0)
    v_cmp_gt_u32_e64 vcc, 2, v61
    s_cbranch_vccz FO_6
    s_sleep 1
    ds_read_b32 v61, v60
    s_branch FW_5
FO_6:
    ds_read_b64_tr_b16 v[40:41], v130 offset:24576
    ds_read_b64_tr_b16 v[42:43], v130 offset:28672
    ds_read_b64_tr_b16 v[44:45], v131 offset:24576
    ds_read_b64_tr_b16 v[46:47], v131 offset:28672
    ds_read_b64_tr_b16 v[64:65], v130 offset:32768
    ds_read_b64_tr_b16 v[66:67], v130 offset:36864
    ds_read_b64_tr_b16 v[68:69], v131 offset:32768
    ds_read_b64_tr_b16 v[70:71], v131 offset:36864
    ds_read_b64_tr_b16 v[88:89], v128 offset:0
    ds_read_b64_tr_b16 v[90:91], v128 offset:4096
    ds_read_b64_tr_b16 v[92:93], v129 offset:0
    ds_read_b64_tr_b16 v[94:95], v129 offset:4096
    ds_read_b64_tr_b16 v[112:113], v128 offset:8192
    ds_read_b64_tr_b16 v[114:115], v128 offset:12288
    ds_read_b64_tr_b16 v[116:117], v129 offset:8192
    s_waitcnt lgkmcnt(8)
    ds_read_b64_tr_b16 v[118:119], v129 offset:12288
F_bp1:
    ds_read_b32 v22, v2
FW_7:
    s_waitcnt lgkmcnt(0)
    v_cmp_gt_u32 vcc, 5, v22
    s_cbranch_vccz FO_8
    s_sleep 1
    ds_read_b32 v22, v2
    s_branch FW_7
FO_8:
    ds_read_b128 v[24:27], v5 offset:40960
    ds_read_b128 v[48:51], v5 offset:41984
    ds_read_b128 v[28:31], v5 offset:43008
    ds_read_b128 v[52:55], v5 offset:44032
    ds_read_b128 v[32:35], v5 offset:45056
W_3:
    s_cbranch_execz R_3
    s_nop 0
    ds_read_b128 v[56:59], v5 offset:46080
    ds_read_b128 v[36:39], v5 offset:47104
    ds_read_b128 v[60:63], v5 offset:48128
    v_mov_b32_e64 v22, 7
    s_mov_b64 exec, 1
    ds_write_b32 v3, v22 offset:0
    s_mov_b64 exec, -1
    s_waitcnt lgkmcnt(8)
    v_mfma_f32_16x16x32_bf16 v[132:135], v[40:43], v[24:27], v[132:135]
    s_waitcnt lgkmcnt(7)
    v_mfma_f32_16x16x32_bf16 v[132:135], v[64:67], v[48:51], v[132:135]
    v_mfma_f32_16x16x32_bf16 v[136:139], v[44:47], v[24:27], v[136:139]
    v_mfma_f32_16x16x32_bf16 v[136:139], v[68:71], v[48:51], v[136:139]
    s_waitcnt lgkmcnt(6)
    v_mfma_f32_16x16x32_bf16 v[140:143], v[40:43], v[28:31], v[140:143]
    s_waitcnt lgkmcnt(5)
    v_mfma_f32_16x16x32_bf16 v[140:143], v[64:67], v[52:55], v[140:143]
    v_mfma_f32_16x16x32_bf16 v[144:147], v[44:47], v[28:31], v[144:147]
    v_mfma_f32_16x16x32_bf16 v[144:147], v[68:71], v[52:55], v[144:147]
    s_waitcnt lgkmcnt(4)
    v_mfma_f32_16x16x32_bf16 v[148:151], v[40:43], v[32:35], v[148:151]
    s_waitcnt lgkmcnt(3)
    v_mfma_f32_16x16x32_bf16 v[148:151], v[64:67], v[56:59], v[148:151]
    v_mfma_f32_16x16x32_bf16 v[152:155], v[44:47], v[32:35], v[152:155]
    v_mfma_f32_16x16x32_bf16 v[152:155], v[68:71], v[56:59], v[152:155]
    s_waitcnt lgkmcnt(2)
    v_mfma_f32_16x16x32_bf16 v[156:159], v[40:43], v[36:39], v[156:159]
    s_waitcnt lgkmcnt(1)
    v_mfma_f32_16x16x32_bf16 v[156:159], v[64:67], v[60:63], v[156:159]
    v_mfma_f32_16x16x32_bf16 v[160:163], v[44:47], v[36:39], v[160:163]
    v_mfma_f32_16x16x32_bf16 v[160:163], v[68:71], v[60:63], v[160:163]
    ds_read_b64_tr_b16 v[40:41], v8 offset:0
    ds_read_b64_tr_b16 v[42:43], v8 offset:4096
    ds_read_b64_tr_b16 v[44:45], v9 offset:0
    ds_read_b64_tr_b16 v[46:47], v9 offset:4096
    ds_read_b64_tr_b16 v[64:65], v8 offset:8192
    ds_read_b64_tr_b16 v[66:67], v8 offset:12288
    ds_read_b64_tr_b16 v[68:69], v9 offset:8192
    ds_read_b64_tr_b16 v[70:71], v9 offset:12288
    s_waitcnt lgkmcnt(0)
    s_barrier
    ds_read_b128 v[72:75], v4 offset:0
    ds_read_b128 v[96:99], v4 offset:1024
    ds_read_b128 v[76:79], v4 offset:2048
    ds_read_b128 v[100:103], v4 offset:3072
    ds_read_b128 v[80:83], v4 offset:4096
    ds_read_b128 v[104:107], v4 offset:5120
    ds_read_b128 v[84:87], v4 offset:6144
    ds_read_b128 v[108:111], v4 offset:7168
    s_waitcnt lgkmcnt(7)
    v_mfma_f32_16x16x32_bf16 v[132:135], v[88:91], v[72:75], v[132:135]
    s_waitcnt lgkmcnt(6)
    v_mfma_f32_16x16x32_bf16 v[132:135], v[112:115], v[96:99], v[132:135]
    v_mfma_f32_16x16x32_bf16 v[136:139], v[92:95], v[72:75], v[136:139]
    v_mfma_f32_16x16x32_bf16 v[136:139], v[116:119], v[96:99], v[136:139]
    s_waitcnt lgkmcnt(5)
    v_mfma_f32_16x16x32_bf16 v[140:143], v[88:91], v[76:79], v[140:143]
    s_waitcnt lgkmcnt(4)
    v_mfma_f32_16x16x32_bf16 v[140:143], v[112:115], v[100:103], v[140:143]
    s_waitcnt lgkmcnt(0)
    s_barrier
    ds_read_b128 v[24:27], v5 offset:0
    ds_read_b128 v[48:51], v5 offset:1024
    v_mfma_f32_16x16x32_bf16 v[144:147], v[92:95], v[76:79], v[144:147]
    ds_read_b128 v[28:31], v5 offset:2048
    ds_read_b128 v[52:55], v5 offset:3072
    v_mfma_f32_16x16x32_bf16 v[144:147], v[116:119], v[100:103], v[144:147]
    ds_read_b128 v[32:35], v5 offset:4096
    ds_read_b128 v[56:59], v5 offset:5120
    v_mfma_f32_16x16x32_bf16 v[148:151], v[88:91], v[80:83], v[148:151]
    ds_read_b128 v[36:39], v5 offset:6144
    ds_read_b128 v[60:63], v5 offset:7168
    v_mfma_f32_16x16x32_bf16 v[148:151], v[112:115], v[104:107], v[148:151]
    v_mfma_f32_16x16x32_bf16 v[152:155], v[92:95], v[80:83], v[152:155]
    v_mfma_f32_16x16x32_bf16 v[152:155], v[116:119], v[104:107], v[152:155]
    v_mfma_f32_16x16x32_bf16 v[156:159], v[88:91], v[84:87], v[156:159]
    v_mfma_f32_16x16x32_bf16 v[156:159], v[112:115], v[108:111], v[156:159]
    v_mfma_f32_16x16x32_bf16 v[160:163], v[92:95], v[84:87], v[160:163]
    v_mfma_f32_16x16x32_bf16 v[160:163], v[116:119], v[108:111], v[160:163]
    s_waitcnt lgkmcnt(4)
    v_mfma_f32_16x16x32_bf16 v[132:135], v[40:43], v[24:27], v[132:135]
    v_mfma_f32_16x16x32_bf16 v[132:135], v[64:67], v[48:51], v[132:135]
    s_waitcnt lgkmcnt(0)
    s_barrier
    ds_read_b64_tr_b16 v[88:89], v8 offset:40960
    ds_read_b64_tr_b16 v[90:91], v8 offset:45056
    v_mfma_f32_16x16x32_bf16 v[136:139], v[44:47], v[24:27], v[136:139]
    ds_read_b128 v[72:75], v5 offset:40960
    ds_read_b64_tr_b16 v[112:113], v8 offset:49152
    v_mfma_f32_16x16x32_bf16 v[136:139], v[68:71], v[48:51], v[136:139]
    ds_read_b64_tr_b16 v[114:115], v8 offset:53248
    v_mfma_f32_16x16x32_bf16 v[140:143], v[40:43], v[28:31], v[140:143]
    ds_read_b128 v[96:99], v5 offset:41984
    v_mfma_f32_16x16x32_bf16 v[140:143], v[64:67], v[52:55], v[140:143]
    ds_read_b64_tr_b16 v[92:93], v9 offset:40960
    v_mfma_f32_16x16x32_bf16 v[144:147], v[44:47], v[28:31], v[144:147]
    ds_read_b64_tr_b16 v[94:95], v9 offset:45056
    v_mfma_f32_16x16x32_bf16 v[144:147], v[68:71], v[52:55], v[144:147]
    ds_read_b64_tr_b16 v[116:117], v9 offset:49152
    v_mfma_f32_16x16x32_bf16 v[148:151], v[40:43], v[32:35], v[148:151]
    ds_read_b64_tr_b16 v[118:119], v9 offset:53248
    v_mfma_f32_16x16x32_bf16 v[148:151], v[64:67], v[56:59], v[148:151]
    ds_read_b128 v[76:79], v5 offset:43008
    v_mfma_f32_16x16x32_bf16 v[152:155], v[44:47], v[32:35], v[152:155]
    ds_read_b128 v[100:103], v5 offset:44032
    v_mfma_f32_16x16x32_bf16 v[152:155], v[68:71], v[56:59], v[152:155]
    ds_read_b128 v[80:83], v5 offset:45056
    v_mfma_f32_16x16x32_bf16 v[156:159], v[40:43], v[36:39], v[156:159]
    ds_read_b128 v[104:107], v5 offset:46080
    v_mfma_f32_16x16x32_bf16 v[156:159], v[64:67], v[60:63], v[156:159]
    s_waitcnt lgkmcnt(8)
    ds_read_b128 v[84:87], v5 offset:47104
    v_mfma_f32_16x16x32_bf16 v[160:163], v[44:47], v[36:39], v[160:163]
    ds_read_b128 v[108:111], v5 offset:48128
    v_mfma_f32_16x16x32_bf16 v[160:163], v[68:71], v[60:63], v[160:163]
    s_waitcnt lgkmcnt(4)
    v_mfma_f32_16x16x32_bf16 v[132:135], v[88:91], v[72:75], v[132:135]
    v_mfma_f32_16x16x32_bf16 v[132:135], v[112:115], v[96:99], v[132:135]
    s_waitcnt lgkmcnt(0)
    s_barrier
    ds_read_b64_tr_b16 v[40:41], v128 offset:16384
    ds_read_b64_tr_b16 v[42:43], v128 offset:20480
    v_mfma_f32_16x16x32_bf16 v[136:139], v[92:95], v[72:75], v[136:139]
    ds_read_b128 v[24:27], v4 offset:40960
    ds_read_b64_tr_b16 v[64:65], v128 offset:24576
    v_mfma_f32_16x16x32_bf16 v[136:139], v[116:119], v[96:99], v[136:139]
    ds_read_b64_tr_b16 v[66:67], v128 offset:28672
    v_mfma_f32_16x16x32_bf16 v[140:143], v[88:91], v[76:79], v[140:143]
    ds_read_b128 v[48:51], v4 offset:41984
    v_mfma_f32_16x16x32_bf16 v[140:143], v[112:115], v[100:103], v[140:143]
    ds_read_b64_tr_b16 v[44:45], v129 offset:16384
    v_mfma_f32_16x16x32_bf16 v[144:147], v[92:95], v[76:79], v[144:147]
    ds_read_b64_tr_b16 v[46:47], v129 offset:20480
    v_mfma_f32_16x16x32_bf16 v[144:147], v[116:119], v[100:103], v[144:147]
    ds_read_b64_tr_b16 v[68:69], v129 offset:24576
    v_mfma_f32_16x16x32_bf16 v[148:151], v[88:91], v[80:83], v[148:151]
    ds_read_b64_tr_b16 v[70:71], v129 offset:28672
    v_mfma_f32_16x16x32_bf16 v[148:151], v[112:115], v[104:107], v[148:151]
    ds_read_b128 v[28:31], v4 offset:43008
    v_mfma_f32_16x16x32_bf16 v[152:155], v[92:95], v[80:83], v[152:155]
    ds_read_b128 v[52:55], v4 offset:44032
    v_mfma_f32_16x16x32_bf16 v[152:155], v[116:119], v[104:107], v[152:155]
    ds_read_b128 v[32:35], v4 offset:45056
    v_mfma_f32_16x16x32_bf16 v[156:159], v[88:91], v[84:87], v[156:159]
    ds_read_b128 v[56:59], v4 offset:46080
    v_mfma_f32_16x16x32_bf16 v[156:159], v[112:115], v[108:111], v[156:159]
    s_waitcnt lgkmcnt(8)
    ds_read_b128 v[36:39], v4 offset:47104
    v_mfma_f32_16x16x32_bf16 v[160:163], v[92:95], v[84:87], v[160:163]
    ds_read_b128 v[60:63], v4 offset:48128
    v_mfma_f32_16x16x32_bf16 v[160:163], v[116:119], v[108:111], v[160:163]
    s_waitcnt lgkmcnt(4)
    v_mfma_f32_16x16x32_bf16 v[132:135], v[40:43], v[24:27], v[132:135]
    v_mfma_f32_16x16x32_bf16 v[132:135], v[64:67], v[48:51], v[132:135]
    s_waitcnt lgkmcnt(0)
    s_barrier
    ds_read_b64_tr_b16 v[88:89], v130 offset:0
    ds_read_b64_tr_b16 v[90:91], v130 offset:4096
    v_mfma_f32_16x16x32_bf16 v[136:139], v[44:47], v[24:27], v[136:139]
    ds_read_b128 v[72:75], v4 offset:0
    ds_read_b64_tr_b16 v[112:113], v130 offset:8192
    v_mfma_f32_16x16x32_bf16 v[136:139], v[68:71], v[48:51], v[136:139]
    ds_read_b64_tr_b16 v[114:115], v130 offset:12288
    v_mfma_f32_16x16x32_bf16 v[140:143], v[40:43], v[28:31], v[140:143]
    ds_read_b128 v[96:99], v4 offset:1024
    v_mfma_f32_16x16x32_bf16 v[140:143], v[64:67], v[52:55], v[140:143]
    ds_read_b64_tr_b16 v[92:93], v131 offset:0
    v_mfma_f32_16x16x32_bf16 v[144:147], v[44:47], v[28:31], v[144:147]
    ds_read_b64_tr_b16 v[94:95], v131 offset:4096
    v_mfma_f32_16x16x32_bf16 v[144:147], v[68:71], v[52:55], v[144:147]
    ds_read_b64_tr_b16 v[116:117], v131 offset:8192
    v_mfma_f32_16x16x32_bf16 v[148:151], v[40:43], v[32:35], v[148:151]
    ds_read_b64_tr_b16 v[118:119], v131 offset:12288
    v_mfma_f32_16x16x32_bf16 v[148:151], v[64:67], v[56:59], v[148:151]
    ds_read_b128 v[76:79], v4 offset:2048
    v_mfma_f32_16x16x32_bf16 v[152:155], v[44:47], v[32:35], v[152:155]
    ds_read_b128 v[100:103], v4 offset:3072
    v_mfma_f32_16x16x32_bf16 v[152:155], v[68:71], v[56:59], v[152:155]
    ds_read_b128 v[80:83], v4 offset:4096
    v_mfma_f32_16x16x32_bf16 v[156:159], v[40:43], v[36:39], v[156:159]
    ds_read_b128 v[104:107], v4 offset:5120
    v_mfma_f32_16x16x32_bf16 v[156:159], v[64:67], v[60:63], v[156:159]
    s_waitcnt lgkmcnt(8)
    ds_read_b128 v[84:87], v4 offset:6144
    v_mfma_f32_16x16x32_bf16 v[160:163], v[44:47], v[36:39], v[160:163]
    ds_read_b128 v[108:111], v4 offset:7168
    v_mfma_f32_16x16x32_bf16 v[160:163], v[68:71], v[60:63], v[160:163]
    s_waitcnt lgkmcnt(4)
    v_mfma_f32_16x16x32_bf16 v[132:135], v[88:91], v[72:75], v[132:135]
    v_mfma_f32_16x16x32_bf16 v[132:135], v[112:115], v[96:99], v[132:135]
    s_waitcnt lgkmcnt(0)
    s_barrier
    ds_read_b64_tr_b16 v[40:41], v128 offset:40960
    ds_read_b64_tr_b16 v[42:43], v128 offset:45056
    v_mfma_f32_16x16x32_bf16 v[136:139], v[92:95], v[72:75], v[136:139]
    ds_read_b128 v[24:27], v5 offset:0
    ds_read_b64_tr_b16 v[64:65], v128 offset:49152
    v_mfma_f32_16x16x32_bf16 v[136:139], v[116:119], v[96:99], v[136:139]
    ds_read_b64_tr_b16 v[66:67], v128 offset:53248
    v_mfma_f32_16x16x32_bf16 v[140:143], v[88:91], v[76:79], v[140:143]
    ds_read_b128 v[48:51], v5 offset:1024
    v_mfma_f32_16x16x32_bf16 v[140:143], v[112:115], v[100:103], v[140:143]
    ds_read_b64_tr_b16 v[44:45], v129 offset:40960
    v_mfma_f32_16x16x32_bf16 v[144:147], v[92:95], v[76:79], v[144:147]
    ds_read_b64_tr_b16 v[46:47], v129 offset:45056
    v_mfma_f32_16x16x32_bf16 v[144:147], v[116:119], v[100:103], v[144:147]
    ds_read_b64_tr_b16 v[68:69], v129 offset:49152
    v_mfma_f32_16x16x32_bf16 v[148:151], v[88:91], v[80:83], v[148:151]
    ds_read_b64_tr_b16 v[70:71], v129 offset:53248
    v_mfma_f32_16x16x32_bf16 v[148:151], v[112:115], v[104:107], v[148:151]
    ds_read_b128 v[28:31], v5 offset:2048
    v_mfma_f32_16x16x32_bf16 v[152:155], v[92:95], v[80:83], v[152:155]
    ds_read_b128 v[52:55], v5 offset:3072
    v_mfma_f32_16x16x32_bf16 v[152:155], v[116:119], v[104:107], v[152:155]
    ds_read_b128 v[32:35], v5 offset:4096
    v_mfma_f32_16x16x32_bf16 v[156:159], v[88:91], v[84:87], v[156:159]
    ds_read_b128 v[56:59], v5 offset:5120
    v_mfma_f32_16x16x32_bf16 v[156:159], v[112:115], v[108:111], v[156:159]
    s_waitcnt lgkmcnt(8)
    ds_read_b128 v[36:39], v5 offset:6144
    v_mfma_f32_16x16x32_bf16 v[160:163], v[92:95], v[84:87], v[160:163]
    ds_read_b128 v[60:63], v5 offset:7168
    v_mfma_f32_16x16x32_bf16 v[160:163], v[116:119], v[108:111], v[160:163]
    s_waitcnt lgkmcnt(4)
    v_mfma_f32_16x16x32_bf16 v[132:135], v[40:43], v[24:27], v[132:135]
    v_mfma_f32_16x16x32_bf16 v[132:135], v[64:67], v[48:51], v[132:135]
    s_waitcnt lgkmcnt(0)
    s_barrier
    ds_read_b64_tr_b16 v[88:89], v130 offset:24576
    ds_read_b64_tr_b16 v[90:91], v130 offset:28672
    v_mfma_f32_16x16x32_bf16 v[136:139], v[44:47], v[24:27], v[136:139]
    ds_read_b128 v[72:75], v5 offset:40960
    ds_read_b64_tr_b16 v[112:113], v130 offset:32768
    v_mfma_f32_16x16x32_bf16 v[136:139], v[68:71], v[48:51], v[136:139]
    ds_read_b64_tr_b16 v[114:115], v130 offset:36864
    v_mfma_f32_16x16x32_bf16 v[140:143], v[40:43], v[28:31], v[140:143]
    ds_read_b128 v[96:99], v5 offset:41984
    v_mfma_f32_16x16x32_bf16 v[140:143], v[64:67], v[52:55], v[140:143]
    ds_read_b64_tr_b16 v[92:93], v131 offset:24576
    v_mfma_f32_16x16x32_bf16 v[144:147], v[44:47], v[28:31], v[144:147]
    ds_read_b64_tr_b16 v[94:95], v131 offset:28672
    v_mfma_f32_16x16x32_bf16 v[144:147], v[68:71], v[52:55], v[144:147]
    ds_read_b64_tr_b16 v[116:117], v131 offset:32768
    v_mfma_f32_16x16x32_bf16 v[148:151], v[40:43], v[32:35], v[148:151]
    ds_read_b64_tr_b16 v[118:119], v131 offset:36864
    v_mfma_f32_16x16x32_bf16 v[148:151], v[64:67], v[56:59], v[148:151]
    ds_read_b128 v[76:79], v5 offset:43008
    v_mfma_f32_16x16x32_bf16 v[152:155], v[44:47], v[32:35], v[152:155]
    ds_read_b128 v[100:103], v5 offset:44032
    v_mfma_f32_16x16x32_bf16 v[152:155], v[68:71], v[56:59], v[152:155]
    ds_read_b128 v[80:83], v5 offset:45056
    v_mfma_f32_16x16x32_bf16 v[156:159], v[40:43], v[36:39], v[156:159]
    ds_read_b128 v[104:107], v5 offset:46080
    v_mfma_f32_16x16x32_bf16 v[156:159], v[64:67], v[60:63], v[156:159]
    s_waitcnt lgkmcnt(8)
    ds_read_b128 v[84:87], v5 offset:47104
    v_mfma_f32_16x16x32_bf16 v[160:163], v[44:47], v[36:39], v[160:163]
    ds_read_b128 v[108:111], v5 offset:48128
    v_mfma_f32_16x16x32_bf16 v[160:163], v[68:71], v[60:63], v[160:163]
    s_waitcnt lgkmcnt(4)
    v_mfma_f32_16x16x32_bf16 v[132:135], v[88:91], v[72:75], v[132:135]
    v_mfma_f32_16x16x32_bf16 v[132:135], v[112:115], v[96:99], v[132:135]
    s_waitcnt lgkmcnt(0)
    s_barrier
    ds_read_b64_tr_b16 v[40:41], v128 offset:0
    ds_read_b64_tr_b16 v[42:43], v128 offset:4096
    v_mfma_f32_16x16x32_bf16 v[136:139], v[92:95], v[72:75], v[136:139]
    ds_read_b128 v[24:27], v4 offset:40960
    ds_read_b64_tr_b16 v[64:65], v128 offset:8192
    v_mfma_f32_16x16x32_bf16 v[136:139], v[116:119], v[96:99], v[136:139]
    ds_read_b64_tr_b16 v[66:67], v128 offset:12288
    v_mfma_f32_16x16x32_bf16 v[140:143], v[88:91], v[76:79], v[140:143]
    ds_read_b128 v[48:51], v4 offset:41984
    v_mfma_f32_16x16x32_bf16 v[140:143], v[112:115], v[100:103], v[140:143]
    ds_read_b64_tr_b16 v[44:45], v129 offset:0
    v_mfma_f32_16x16x32_bf16 v[144:147], v[92:95], v[76:79], v[144:147]
    ds_read_b64_tr_b16 v[46:47], v129 offset:4096
    v_mfma_f32_16x16x32_bf16 v[144:147], v[116:119], v[100:103], v[144:147]
    ds_read_b64_tr_b16 v[68:69], v129 offset:8192
    v_mfma_f32_16x16x32_bf16 v[148:151], v[88:91], v[80:83], v[148:151]
    ds_read_b64_tr_b16 v[70:71], v129 offset:12288
    v_mfma_f32_16x16x32_bf16 v[148:151], v[112:115], v[104:107], v[148:151]
    ds_read_b128 v[28:31], v4 offset:43008
    v_mfma_f32_16x16x32_bf16 v[152:155], v[92:95], v[80:83], v[152:155]
    ds_read_b128 v[52:55], v4 offset:44032
    v_mfma_f32_16x16x32_bf16 v[152:155], v[116:119], v[104:107], v[152:155]
    ds_read_b128 v[32:35], v4 offset:45056
    v_mfma_f32_16x16x32_bf16 v[156:159], v[88:91], v[84:87], v[156:159]
    ds_read_b128 v[56:59], v4 offset:46080
    v_mfma_f32_16x16x32_bf16 v[156:159], v[112:115], v[108:111], v[156:159]
    s_waitcnt lgkmcnt(8)
    ds_read_b128 v[36:39], v4 offset:47104
    v_mfma_f32_16x16x32_bf16 v[160:163], v[92:95], v[84:87], v[160:163]
    ds_read_b128 v[60:63], v4 offset:48128
    v_mfma_f32_16x16x32_bf16 v[160:163], v[116:119], v[108:111], v[160:163]
    s_waitcnt lgkmcnt(4)
    v_mfma_f32_16x16x32_bf16 v[132:135], v[40:43], v[24:27], v[132:135]
    v_mfma_f32_16x16x32_bf16 v[132:135], v[64:67], v[48:51], v[132:135]
    s_waitcnt lgkmcnt(0)
    s_barrier
    ds_read_b64_tr_b16 v[88:89], v8 offset:0
    ds_read_b64_tr_b16 v[90:91], v8 offset:4096
    v_mfma_f32_16x16x32_bf16 v[136:139], v[44:47], v[24:27], v[136:139]
    ds_read_b128 v[72:75], v4 offset:0
    ds_read_b64_tr_b16 v[112:113], v8 offset:8192
    v_mfma_f32_16x16x32_bf16 v[136:139], v[68:71], v[48:51], v[136:139]
    ds_read_b64_tr_b16 v[114:115], v8 offset:12288
    v_mfma_f32_16x16x32_bf16 v[140:143], v[40:43], v[28:31], v[140:143]
    ds_read_b128 v[96:99], v4 offset:1024
    v_mfma_f32_16x16x32_bf16 v[140:143], v[64:67], v[52:55], v[140:143]
    ds_read_b64_tr_b16 v[92:93], v9 offset:0
    v_mfma_f32_16x16x32_bf16 v[144:147], v[44:47], v[28:31], v[144:147]
    ds_read_b64_tr_b16 v[94:95], v9 offset:4096
    v_mfma_f32_16x16x32_bf16 v[144:147], v[68:71], v[52:55], v[144:147]
    ds_read_b64_tr_b16 v[116:117], v9 offset:8192
    v_mfma_f32_16x16x32_bf16 v[148:151], v[40:43], v[32:35], v[148:151]
    ds_read_b64_tr_b16 v[118:119], v9 offset:12288
    v_mfma_f32_16x16x32_bf16 v[148:151], v[64:67], v[56:59], v[148:151]
    ds_read_b128 v[76:79], v4 offset:2048
    v_mfma_f32_16x16x32_bf16 v[152:155], v[44:47], v[32:35], v[152:155]
    ds_read_b128 v[100:103], v4 offset:3072
    v_mfma_f32_16x16x32_bf16 v[152:155], v[68:71], v[56:59], v[152:155]
    ds_read_b128 v[80:83], v4 offset:4096
    v_mfma_f32_16x16x32_bf16 v[156:159], v[40:43], v[36:39], v[156:159]
    ds_read_b128 v[104:107], v4 offset:5120
    v_mfma_f32_16x16x32_bf16 v[156:159], v[64:67], v[60:63], v[156:159]
    s_waitcnt lgkmcnt(8)
    ds_read_b128 v[84:87], v4 offset:6144
    v_mfma_f32_16x16x32_bf16 v[160:163], v[44:47], v[36:39], v[160:163]
    ds_read_b128 v[108:111], v4 offset:7168
    v_mfma_f32_16x16x32_bf16 v[160:163], v[68:71], v[60:63], v[160:163]
    s_waitcnt lgkmcnt(4)
    v_mfma_f32_16x16x32_bf16 v[132:135], v[88:91], v[72:75], v[132:135]
    v_mfma_f32_16x16x32_bf16 v[132:135], v[112:115], v[96:99], v[132:135]
    s_waitcnt lgkmcnt(0)
    s_barrier
    ds_read_b64_tr_b16 v[40:41], v8 offset:40960
    ds_read_b64_tr_b16 v[42:43], v8 offset:45056
    v_mfma_f32_16x16x32_bf16 v[136:139], v[92:95], v[72:75], v[136:139]
    ds_read_b128 v[24:27], v5 offset:0
    ds_read_b64_tr_b16 v[64:65], v8 offset:49152
    v_mfma_f32_16x16x32_bf16 v[136:139], v[116:119], v[96:99], v[136:139]
    ds_read_b64_tr_b16 v[66:67], v8 offset:53248
    v_mfma_f32_16x16x32_bf16 v[140:143], v[88:91], v[76:79], v[140:143]
    ds_read_b128 v[48:51], v5 offset:1024
    v_mfma_f32_16x16x32_bf16 v[140:143], v[112:115], v[100:103], v[140:143]
    ds_read_b64_tr_b16 v[44:45], v9 offset:40960
    v_mfma_f32_16x16x32_bf16 v[144:147], v[92:95], v[76:79], v[144:147]
    ds_read_b64_tr_b16 v[46:47], v9 offset:45056
    v_mfma_f32_16x16x32_bf16 v[144:147], v[116:119], v[100:103], v[144:147]
    ds_read_b64_tr_b16 v[68:69], v9 offset:49152
    v_mfma_f32_16x16x32_bf16 v[148:151], v[88:91], v[80:83], v[148:151]
    ds_read_b64_tr_b16 v[70:71], v9 offset:53248
    v_mfma_f32_16x16x32_bf16 v[148:151], v[112:115], v[104:107], v[148:151]
    ds_read_b128 v[28:31], v5 offset:2048
    v_mfma_f32_16x16x32_bf16 v[152:155], v[92:95], v[80:83], v[152:155]
    ds_read_b128 v[52:55], v5 offset:3072
    v_mfma_f32_16x16x32_bf16 v[152:155], v[116:119], v[104:107], v[152:155]
    ds_read_b128 v[32:35], v5 offset:4096
    v_mfma_f32_16x16x32_bf16 v[156:159], v[88:91], v[84:87], v[156:159]
    ds_read_b128 v[56:59], v5 offset:5120
    v_mfma_f32_16x16x32_bf16 v[156:159], v[112:115], v[108:111], v[156:159]
    s_waitcnt lgkmcnt(8)
    ds_read_b128 v[36:39], v5 offset:6144
    v_mfma_f32_16x16x32_bf16 v[160:163], v[92:95], v[84:87], v[160:163]
    ds_read_b128 v[60:63], v5 offset:7168
    v_mfma_f32_16x16x32_bf16 v[160:163], v[116:119], v[108:111], v[160:163]
    s_waitcnt lgkmcnt(4)
    v_mfma_f32_16x16x32_bf16 v[132:135], v[40:43], v[24:27], v[132:135]
    v_mfma_f32_16x16x32_bf16 v[132:135], v[64:67], v[48:51], v[132:135]
    s_waitcnt lgkmcnt(0)
    s_barrier
    ds_read_b64_tr_b16 v[88:89], v128 offset:16384
    ds_read_b64_tr_b16 v[90:91], v128 offset:20480
    v_mfma_f32_16x16x32_bf16 v[136:139], v[44:47], v[24:27], v[136:139]
    ds_read_b128 v[72:75], v5 offset:40960
    ds_read_b64_tr_b16 v[112:113], v128 offset:24576
    v_mfma_f32_16x16x32_bf16 v[136:139], v[68:71], v[48:51], v[136:139]
    ds_read_b64_tr_b16 v[114:115], v128 offset:28672
    v_mfma_f32_16x16x32_bf16 v[140:143], v[40:43], v[28:31], v[140:143]
    ds_read_b128 v[96:99], v5 offset:41984
    v_mfma_f32_16x16x32_bf16 v[140:143], v[64:67], v[52:55], v[140:143]
    ds_read_b64_tr_b16 v[92:93], v129 offset:16384
    v_mfma_f32_16x16x32_bf16 v[144:147], v[44:47], v[28:31], v[144:147]
    ds_read_b64_tr_b16 v[94:95], v129 offset:20480
    v_mfma_f32_16x16x32_bf16 v[144:147], v[68:71], v[52:55], v[144:147]
    ds_read_b64_tr_b16 v[116:117], v129 offset:24576
    v_mfma_f32_16x16x32_bf16 v[148:151], v[40:43], v[32:35], v[148:151]
    ds_read_b64_tr_b16 v[118:119], v129 offset:28672
    v_mfma_f32_16x16x32_bf16 v[148:151], v[64:67], v[56:59], v[148:151]
    ds_read_b128 v[76:79], v5 offset:43008
    v_mfma_f32_16x16x32_bf16 v[152:155], v[44:47], v[32:35], v[152:155]
    ds_read_b128 v[100:103], v5 offset:44032
    v_mfma_f32_16x16x32_bf16 v[152:155], v[68:71], v[56:59], v[152:155]
    ds_read_b128 v[80:83], v5 offset:45056
    v_mfma_f32_16x16x32_bf16 v[156:159], v[40:43], v[36:39], v[156:159]
    ds_read_b128 v[104:107], v5 offset:46080
    v_mfma_f32_16x16x32_bf16 v[156:159], v[64:67], v[60:63], v[156:159]
    s_waitcnt lgkmcnt(8)
    ds_read_b128 v[84:87], v5 offset:47104
    v_mfma_f32_16x16x32_bf16 v[160:163], v[44:47], v[36:39], v[160:163]
    ds_read_b128 v[108:111], v5 offset:48128
    v_mfma_f32_16x16x32_bf16 v[160:163], v[68:71], v[60:63], v[160:163]
    s_waitcnt lgkmcnt(4)
    v_mfma_f32_16x16x32_bf16 v[132:135], v[88:91], v[72:75], v[132:135]
    v_mfma_f32_16x16x32_bf16 v[132:135], v[112:115], v[96:99], v[132:135]
    s_waitcnt lgkmcnt(0)
    s_barrier
    ds_read_b64_tr_b16 v[40:41], v130 offset:0
    ds_read_b64_tr_b16 v[42:43], v130 offset:4096
    v_mfma_f32_16x16x32_bf16 v[136:139], v[92:95], v[72:75], v[136:139]
    ds_read_b128 v[24:27], v4 offset:40960
    ds_read_b64_tr_b16 v[64:65], v130 offset:8192
    v_mfma_f32_16x16x32_bf16 v[136:139], v[116:119], v[96:99], v[136:139]
    ds_read_b64_tr_b16 v[66:67], v130 offset:12288
    v_mfma_f32_16x16x32_bf16 v[140:143], v[88:91], v[76:79], v[140:143]
    ds_read_b128 v[48:51], v4 offset:41984
    v_mfma_f32_16x16x32_bf16 v[140:143], v[112:115], v[100:103], v[140:143]
    ds_read_b64_tr_b16 v[44:45], v131 offset:0
    v_mfma_f32_16x16x32_bf16 v[144:147], v[92:95], v[76:79], v[144:147]
    ds_read_b64_tr_b16 v[46:47], v131 offset:4096
    v_mfma_f32_16x16x32_bf16 v[144:147], v[116:119], v[100:103], v[144:147]
    ds_read_b64_tr_b16 v[68:69], v131 offset:8192
    v_mfma_f32_16x16x32_bf16 v[148:151], v[88:91], v[80:83], v[148:151]
    ds_read_b64_tr_b16 v[70:71], v131 offset:12288
    v_mfma_f32_16x16x32_bf16 v[148:151], v[112:115], v[104:107], v[148:151]
    ds_read_b128 v[28:31], v4 offset:43008
    v_mfma_f32_16x16x32_bf16 v[152:155], v[92:95], v[80:83], v[152:155]
    ds_read_b128 v[52:55], v4 offset:44032
    v_mfma_f32_16x16x32_bf16 v[152:155], v[116:119], v[104:107], v[152:155]
    ds_read_b128 v[32:35], v4 offset:45056
    v_mfma_f32_16x16x32_bf16 v[156:159], v[88:91], v[84:87], v[156:159]
    ds_read_b128 v[56:59], v4 offset:46080
    v_mfma_f32_16x16x32_bf16 v[156:159], v[112:115], v[108:111], v[156:159]
    s_waitcnt lgkmcnt(8)
    ds_read_b128 v[36:39], v4 offset:47104
    v_mfma_f32_16x16x32_bf16 v[160:163], v[92:95], v[84:87], v[160:163]
    ds_read_b128 v[60:63], v4 offset:48128
    v_mfma_f32_16x16x32_bf16 v[160:163], v[116:119], v[108:111], v[160:163]
    s_waitcnt lgkmcnt(4)
    v_mfma_f32_16x16x32_bf16 v[132:135], v[40:43], v[24:27], v[132:135]
    v_mfma_f32_16x16x32_bf16 v[132:135], v[64:67], v[48:51], v[132:135]
    s_waitcnt lgkmcnt(0)
    s_barrier
    ds_read_b64_tr_b16 v[88:89], v128 offset:40960
    ds_read_b64_tr_b16 v[90:91], v128 offset:45056
    v_mfma_f32_16x16x32_bf16 v[136:139], v[44:47], v[24:27], v[136:139]
    ds_read_b128 v[72:75], v4 offset:0
    ds_read_b64_tr_b16 v[112:113], v128 offset:49152
    v_mfma_f32_16x16x32_bf16 v[136:139], v[68:71], v[48:51], v[136:139]
    ds_read_b64_tr_b16 v[114:115], v128 offset:53248
    v_mfma_f32_16x16x32_bf16 v[140:143], v[40:43], v[28:31], v[140:143]
    ds_read_b128 v[96:99], v4 offset:1024
    v_mfma_f32_16x16x32_bf16 v[140:143], v[64:67], v[52:55], v[140:143]
    ds_read_b64_tr_b16 v[92:93], v129 offset:40960
    v_mfma_f32_16x16x32_bf16 v[144:147], v[44:47], v[28:31], v[144:147]
    ds_read_b64_tr_b16 v[94:95], v129 offset:45056
    v_mfma_f32_16x16x32_bf16 v[144:147], v[68:71], v[52:55], v[144:147]
    ds_read_b64_tr_b16 v[116:117], v129 offset:49152
    v_mfma_f32_16x16x32_bf16 v[148:151], v[40:43], v[32:35], v[148:151]
    ds_read_b64_tr_b16 v[118:119], v129 offset:53248
    v_mfma_f32_16x16x32_bf16 v[148:151], v[64:67], v[56:59], v[148:151]
    ds_read_b128 v[76:79], v4 offset:2048
    v_mfma_f32_16x16x32_bf16 v[152:155], v[44:47], v[32:35], v[152:155]
    ds_read_b128 v[100:103], v4 offset:3072
    v_mfma_f32_16x16x32_bf16 v[152:155], v[68:71], v[56:59], v[152:155]
    ds_read_b128 v[80:83], v4 offset:4096
    v_mfma_f32_16x16x32_bf16 v[156:159], v[40:43], v[36:39], v[156:159]
    ds_read_b128 v[104:107], v4 offset:5120
    v_mfma_f32_16x16x32_bf16 v[156:159], v[64:67], v[60:63], v[156:159]
    s_waitcnt lgkmcnt(8)
    ds_read_b128 v[84:87], v4 offset:6144
    v_mfma_f32_16x16x32_bf16 v[160:163], v[44:47], v[36:39], v[160:163]
    ds_read_b128 v[108:111], v4 offset:7168
    v_mfma_f32_16x16x32_bf16 v[160:163], v[68:71], v[60:63], v[160:163]
    s_waitcnt lgkmcnt(4)
    v_mfma_f32_16x16x32_bf16 v[132:135], v[88:91], v[72:75], v[132:135]
    v_mfma_f32_16x16x32_bf16 v[132:135], v[112:115], v[96:99], v[132:135]
    s_waitcnt lgkmcnt(0)
    s_barrier
    ds_read_b64_tr_b16 v[40:41], v130 offset:24576
    ds_read_b64_tr_b16 v[42:43], v130 offset:28672
    v_mfma_f32_16x16x32_bf16 v[136:139], v[92:95], v[72:75], v[136:139]
    ds_read_b128 v[24:27], v5 offset:0
    ds_read_b64_tr_b16 v[64:65], v130 offset:32768
    v_mfma_f32_16x16x32_bf16 v[136:139], v[116:119], v[96:99], v[136:139]
    ds_read_b64_tr_b16 v[66:67], v130 offset:36864
    v_mfma_f32_16x16x32_bf16 v[140:143], v[88:91], v[76:79], v[140:143]
    ds_read_b128 v[48:51], v5 offset:1024
    v_mfma_f32_16x16x32_bf16 v[140:143], v[112:115], v[100:103], v[140:143]
    ds_read_b64_tr_b16 v[44:45], v131 offset:24576
    v_mfma_f32_16x16x32_bf16 v[144:147], v[92:95], v[76:79], v[144:147]
    ds_read_b64_tr_b16 v[46:47], v131 offset:28672
    v_mfma_f32_16x16x32_bf16 v[144:147], v[116:119], v[100:103], v[144:147]
    ds_read_b64_tr_b16 v[68:69], v131 offset:32768
    v_mfma_f32_16x16x32_bf16 v[148:151], v[88:91], v[80:83], v[148:151]
    ds_read_b64_tr_b16 v[70:71], v131 offset:36864
    v_mfma_f32_16x16x32_bf16 v[148:151], v[112:115], v[104:107], v[148:151]
    ds_read_b128 v[28:31], v5 offset:2048
    v_mfma_f32_16x16x32_bf16 v[152:155], v[92:95], v[80:83], v[152:155]
    ds_read_b128 v[52:55], v5 offset:3072
    v_mfma_f32_16x16x32_bf16 v[152:155], v[116:119], v[104:107], v[152:155]
    ds_read_b128 v[32:35], v5 offset:4096
    v_mfma_f32_16x16x32_bf16 v[156:159], v[88:91], v[84:87], v[156:159]
    ds_read_b128 v[56:59], v5 offset:5120
    v_mfma_f32_16x16x32_bf16 v[156:159], v[112:115], v[108:111], v[156:159]
    s_waitcnt lgkmcnt(8)
    ds_read_b128 v[36:39], v5 offset:6144
    v_mfma_f32_16x16x32_bf16 v[160:163], v[92:95], v[84:87], v[160:163]
    ds_read_b128 v[60:63], v5 offset:7168
    v_mfma_f32_16x16x32_bf16 v[160:163], v[116:119], v[108:111], v[160:163]
    s_waitcnt lgkmcnt(4)
    v_mfma_f32_16x16x32_bf16 v[132:135], v[40:43], v[24:27], v[132:135]
    v_mfma_f32_16x16x32_bf16 v[132:135], v[64:67], v[48:51], v[132:135]
    s_waitcnt lgkmcnt(0)
    s_barrier
    ds_read_b64_tr_b16 v[88:89], v128 offset:0
    ds_read_b64_tr_b16 v[90:91], v128 offset:4096
    v_mfma_f32_16x16x32_bf16 v[136:139], v[44:47], v[24:27], v[136:139]
    ds_read_b128 v[72:75], v5 offset:40960
    ds_read_b64_tr_b16 v[112:113], v128 offset:8192
    v_mfma_f32_16x16x32_bf16 v[136:139], v[68:71], v[48:51], v[136:139]
    ds_read_b64_tr_b16 v[114:115], v128 offset:12288
    ds_read_b128 v[96:99], v5 offset:41984
    v_mfma_f32_16x16x32_bf16 v[140:143], v[40:43], v[28:31], v[140:143]
    ds_read_b64_tr_b16 v[92:93], v129 offset:0
    ds_read_b64_tr_b16 v[94:95], v129 offset:4096
    v_mfma_f32_16x16x32_bf16 v[140:143], v[64:67], v[52:55], v[140:143]
    ds_read_b64_tr_b16 v[116:117], v129 offset:8192
    ds_read_b64_tr_b16 v[118:119], v129 offset:12288
    v_mfma_f32_16x16x32_bf16 v[144:147], v[44:47], v[28:31], v[144:147]
    ds_read_b128 v[76:79], v5 offset:43008
    v_mfma_f32_16x16x32_bf16 v[144:147], v[68:71], v[52:55], v[144:147]
    ds_read_b128 v[100:103], v5 offset:44032
    s_waitcnt lgkmcnt(9)
    v_mfma_f32_16x16x32_bf16 v[132:135], v[88:91], v[72:75], v[132:135]
    ds_read_b128 v[80:83], v5 offset:45056
    s_waitcnt lgkmcnt(7)
    v_mfma_f32_16x16x32_bf16 v[132:135], v[112:115], v[96:99], v[132:135]
    ds_read_b128 v[104:107], v5 offset:46080
    s_waitcnt lgkmcnt(6)
    v_mfma_f32_16x16x32_bf16 v[136:139], v[92:95], v[72:75], v[136:139]
    ds_read_b128 v[84:87], v5 offset:47104
    s_waitcnt lgkmcnt(5)
    v_mfma_f32_16x16x32_bf16 v[136:139], v[116:119], v[96:99], v[136:139]
    ds_read_b128 v[108:111], v5 offset:48128
    v_mfma_f32_16x16x32_bf16 v[148:151], v[40:43], v[32:35], v[148:151]
    v_mfma_f32_16x16x32_bf16 v[148:151], v[64:67], v[56:59], v[148:151]
W_4:
    s_cbranch_execz R_4
    s_nop 0
    v_mfma_f32_16x16x32_bf16 v[152:155], v[44:47], v[32:35], v[152:155]
    v_cvt_pk_bf16_f32 v132, v132, v133
    v_cvt_pk_bf16_f32 v133, v134, v135
    v_mfma_f32_16x16x32_bf16 v[152:155], v[68:71], v[56:59], v[152:155]
    s_nop 0
    v_cvt_pk_bf16_f32 v134, v136, v137
    v_cvt_pk_bf16_f32 v135, v138, v139
    s_waitcnt lgkmcnt(5)
    v_mfma_f32_16x16x32_bf16 v[140:143], v[88:91], v[76:79], v[140:143]
    ds_write2_b64 v18, v[132:133], v[134:135] offset0:0 offset1:4
    s_waitcnt lgkmcnt(5)
    v_mfma_f32_16x16x32_bf16 v[140:143], v[112:115], v[100:103], v[140:143]
    v_mfma_f32_16x16x32_bf16 v[144:147], v[92:95], v[76:79], v[144:147]
    v_mfma_f32_16x16x32_bf16 v[144:147], v[116:119], v[100:103], v[144:147]
    v_mfma_f32_16x16x32_bf16 v[156:159], v[40:43], v[36:39], v[156:159]
    v_mfma_f32_16x16x32_bf16 v[156:159], v[64:67], v[60:63], v[156:159]
    v_mfma_f32_16x16x32_bf16 v[160:163], v[44:47], v[36:39], v[160:163]
    s_waitcnt lgkmcnt(0)
    s_barrier
    s_nop 0
    v_cvt_pk_bf16_f32 v140, v140, v141
    v_mfma_f32_16x16x32_bf16 v[160:163], v[68:71], v[60:63], v[160:163]
    v_cvt_pk_bf16_f32 v141, v142, v143
    v_cvt_pk_bf16_f32 v142, v144, v145
    v_mfma_f32_16x16x32_bf16 v[148:151], v[88:91], v[80:83], v[148:151]
    v_cvt_pk_bf16_f32 v143, v146, v147
    ds_write2_b64 v19, v[140:141], v[142:143] offset0:0 offset1:4
    v_mfma_f32_16x16x32_bf16 v[148:151], v[112:115], v[104:107], v[148:151]
    v_mfma_f32_16x16x32_bf16 v[152:155], v[92:95], v[80:83], v[152:155]
    v_mfma_f32_16x16x32_bf16 v[152:155], v[116:119], v[104:107], v[152:155]
    v_mfma_f32_16x16x32_bf16 v[156:159], v[88:91], v[84:87], v[156:159]
    v_mfma_f32_16x16x32_bf16 v[156:159], v[112:115], v[108:111], v[156:159]
    v_mfma_f32_16x16x32_bf16 v[160:163], v[92:95], v[84:87], v[160:163]
    s_waitcnt lgkmcnt(0)
    s_barrier
    s_nop 0
    v_cvt_pk_bf16_f32 v148, v148, v149
    v_cvt_pk_bf16_f32 v149, v150, v151
    v_mfma_f32_16x16x32_bf16 v[160:163], v[116:119], v[108:111], v[160:163]
    v_cvt_pk_bf16_f32 v150, v152, v153
    v_cvt_pk_bf16_f32 v151, v154, v155
    ds_write2_b64 v20, v[148:149], v[150:151] offset0:0 offset1:4
    v_cvt_pk_bf16_f32 v156, v156, v157
    v_cvt_pk_bf16_f32 v157, v158, v159
    s_nop 2
    v_cvt_pk_bf16_f32 v158, v160, v161
    v_cvt_pk_bf16_f32 v159, v162, v163
    ds_write2_b64 v21, v[156:157], v[158:159] offset0:0 offset1:4
    s_waitcnt lgkmcnt(0)
    s_barrier
F_end:
    s_endpgm
F_loader:
    s_mov_b32 s48, 0x76542130
    s_mov_b32 s49, 0xfedca9b8
    s_cmp_eq_u32 s35, 1
    s_cselect_b32 s48, 0x75463021, s48
    s_cselect_b32 s49, 0xfdceba98, s49
    s_cmp_eq_u32 s35, 2
    s_cselect_b32 s48, 0x96543102, s48
    s_cselect_b32 s49, 0xfedcba87, s49
    s_cmp_eq_u32 s35, 3
    s_cselect_b32 s48, 0x76532410, s48
    s_cselect_b32 s49, 0xfedbac98, s49
    s_cmp_eq_u32 s35, 4
    s_cselect_b32 s48, 0x65743021, s48
    s_cselect_b32 s49, 0xedfcba98, s49
    s_cmp_eq_u32 s35, 5
    s_cselect_b32 s48, 0x76543102, s48
    s_cselect_b32 s49, 0xfedcb98a, s49
    s_cmp_eq_u32 s35, 6
    s_cselect_b32 s48, 0x76435210, s48
    s_cselect_b32 s49, 0xfecbda98, s49
    s_cmp_eq_u32 s35, 7
    s_cselect_b32 s48, 0x68543021, s48
    s_cselect_b32 s49, 0xfedcba97, s49
    s_setprio 0
    s_sub_u32 s3, s3, 8
    v_lshrrev_b32 v2, 3, v0
    v_and_b32 v3, 7, v0
    v_lshrrev_b32 v4, 1, v2
    v_xor_b32 v5, v3, v4
    v_xor_b32 v6, 4, v5
    v_lshlrev_b32 v5, 4, v5
    v_lshlrev_b32 v6, 4, v6
    v_lshlrev_b32 v7, 11, v2
    v_add_u32 v12, v5, v7
    v_add_u32 v13, v6, v7
    v_and_b32 v4, 1, v4
    v_lshlrev_b32 v4, 1, v4
    v_xor_b32 v8, v3, v4
    v_xor_b32 v9, 4, v8
    v_lshlrev_b32 v8, 4, v8
    v_lshlrev_b32 v9, 4, v9
    v_mul_u32_u24 v7, 6144, v2
    v_add_u32 v14, v8, v7
    v_add_u32_e64 v15, v9, v7
    s_lshl_b32 s36, s32, 18
    s_lshl_b32 s37, s3, 16
    s_add_u32 s36, s36, s37
    s_lshl_b32 s38, s33, 7
    s_mul_i32 s37, s3, 98304
    s_add_u32 s38, s38, s37
    s_sub_u32 s47, s10, s33
    s_lshl_b32 s47, s47, 7
    s_and_b32 s42, s39, 8
    s_and_b32 s43, s30, 6
    s_or_b32 s42, s42, s43
    s_and_b32 s43, s34, 0
    s_lshl_b32 s43, s43, 0
    s_xor_b32 s42, s42, s43
    s_lshl_b32 s44, s3, 12
    s_lshl_b32 s45, s3, 11
    s_waitcnt lgkmcnt(0)
    s_mov_b32 s12, s4
    s_mov_b32 s13, s5
    s_mov_b32 s14, 0x400000
    s_mov_b32 s15, 0x00020000
    s_mov_b32 s16, s6
    s_mov_b32 s17, s7
    s_mov_b32 s18, 0x600000
    s_mov_b32 s19, 0x00020000
    s_bfe_u32 s40, s48, 0x40000
    s_bitcmp1_b32 s40, 3
    s_cselect_b32 s41, s39, s42
    s_xor_b32 s40, s40, s41
    s_mul_i32 s41, s40, 393216
    s_add_u32 s41, s41, s38
    s_lshl_b32 s40, s40, 7
    s_add_u32 s40, s40, s36
    s_add_u32 m0, s44, 0
    s_add_u32 s46, s40, 0
    buffer_load_dwordx4 v12, s[12:15], s46 offen lds
    s_add_u32 m0, s45, 24576
    s_add_u32 s46, s41, 2048
    buffer_load_dwordx4 v14, s[16:19], s46 offen lds
    s_add_u32 m0, s45, 25600
    s_add_u32 s46, s41, 51200
    buffer_load_dwordx4 v15, s[16:19], s46 offen lds
    s_add_u32 m0, s45, 16384
    s_add_u32 s46, s41, 0
    s_add_u32 s46, s46, s47
    buffer_load_dwordx4 v14, s[16:19], s46 offen lds
    s_add_u32 m0, s45, 17408
    s_add_u32 s46, s41, 49152
    s_add_u32 s46, s46, s47
    s_nop 0
    buffer_load_dwordx4 v15, s[16:19], s46 offen lds
    s_add_u32 m0, s45, 32768
    s_add_u32 s46, s41, 4096
    buffer_load_dwordx4 v14, s[16:19], s46 offen lds
    s_add_u32 m0, s45, 33792
    s_add_u32 s46, s41, 53248
    buffer_load_dwordx4 v15, s[16:19], s46 offen lds
    s_add_u32 m0, s44, 1024
    s_add_u32 s46, s40, 16384
    buffer_load_dwordx4 v13, s[12:15], s46 offen lds
    s_add_u32 m0, s44, 2048
    s_add_u32 s46, s40, 32768
    buffer_load_dwordx4 v12, s[12:15], s46 offen lds
    s_add_u32 m0, s44, 3072
    s_add_u32 s46, s40, 49152
    buffer_load_dwordx4 v13, s[12:15], s46 offen lds
    s_bfe_u32 s40, s48, 0x40004
    s_bitcmp1_b32 s40, 3
    s_cselect_b32 s41, s39, s42
    s_xor_b32 s40, s40, s41
    s_mul_i32 s41, s40, 393216
    s_add_u32 s41, s41, s38
    s_lshl_b32 s40, s40, 7
    s_add_u32 s40, s40, s36
    s_add_u32 m0, s44, 40960
    s_add_u32 s46, s40, 0
    s_nop 0
    buffer_load_dwordx4 v12, s[12:15], s46 offen lds
    s_add_u32 m0, s45, 65536
    s_add_u32 s46, s41, 2048
    buffer_load_dwordx4 v14, s[16:19], s46 offen lds
    s_add_u32 m0, s45, 66560
    s_add_u32 s46, s41, 51200
    buffer_load_dwordx4 v15, s[16:19], s46 offen lds
    s_add_u32 m0, s45, 57344
    s_add_u32 s46, s41, 0
    s_add_u32 s46, s46, s47
    buffer_load_dwordx4 v14, s[16:19], s46 offen lds
    s_add_u32 m0, s45, 58368
    s_add_u32 s46, s41, 49152
    s_add_u32 s46, s46, s47
    s_nop 0
    buffer_load_dwordx4 v15, s[16:19], s46 offen lds
    s_add_u32 m0, s45, 73728
    s_add_u32 s46, s41, 4096
    buffer_load_dwordx4 v14, s[16:19], s46 offen lds
    s_add_u32 m0, s45, 74752
    s_add_u32 s46, s41, 53248
    buffer_load_dwordx4 v15, s[16:19], s46 offen lds
    s_add_u32 m0, s44, 41984
    s_add_u32 s46, s40, 16384
    buffer_load_dwordx4 v13, s[12:15], s46 offen lds
    s_waitcnt vmcnt(8)
    s_barrier
    s_add_u32 m0, s44, 43008
    s_add_u32 s46, s40, 32768
    buffer_load_dwordx4 v12, s[12:15], s46 offen lds
    s_add_u32 m0, s44, 44032
    s_add_u32 s46, s40, 49152
    buffer_load_dwordx4 v13, s[12:15], s46 offen lds
    s_bfe_u32 s40, s48, 0x40008
    s_bitcmp1_b32 s40, 3
    s_cselect_b32 s41, s39, s42
    s_xor_b32 s40, s40, s41
    s_mul_i32 s41, s40, 393216
    s_add_u32 s41, s41, s38
    s_lshl_b32 s40, s40, 7
    s_add_u32 s40, s40, s36
    s_add_u32 m0, s44, 81920
    s_add_u32 s46, s40, 0
    s_nop 0
    buffer_load_dwordx4 v12, s[12:15], s46 offen lds
    s_add_u32 m0, s45, 106496
    s_add_u32 s46, s41, 2048
    buffer_load_dwordx4 v14, s[16:19], s46 offen lds
    s_add_u32 m0, s45, 107520
    s_add_u32 s46, s41, 51200
    buffer_load_dwordx4 v15, s[16:19], s46 offen lds
    s_add_u32 m0, s45, 98304
    s_add_u32 s46, s41, 0
    s_add_u32 s46, s46, s47
    buffer_load_dwordx4 v14, s[16:19], s46 offen lds
    s_add_u32 m0, s45, 99328
    s_add_u32 s46, s41, 49152
    s_add_u32 s46, s46, s47
    s_nop 0
    buffer_load_dwordx4 v15, s[16:19], s46 offen lds
    s_add_u32 m0, s45, 114688
    s_add_u32 s46, s41, 4096
    buffer_load_dwordx4 v14, s[16:19], s46 offen lds
    s_add_u32 m0, s45, 115712
    s_add_u32 s46, s41, 53248
    buffer_load_dwordx4 v15, s[16:19], s46 offen lds
    s_add_u32 m0, s44, 82944
    s_add_u32 s46, s40, 16384
    buffer_load_dwordx4 v13, s[12:15], s46 offen lds
    s_add_u32 m0, s44, 83968
    s_add_u32 s46, s40, 32768
    buffer_load_dwordx4 v12, s[12:15], s46 offen lds
    s_add_u32 m0, s44, 84992
    s_add_u32 s46, s40, 49152
    buffer_load_dwordx4 v13, s[12:15], s46 offen lds
    s_waitcnt vmcnt(10)
    s_barrier
    s_bfe_u32 s40, s48, 0x4000c
    s_bitcmp1_b32 s40, 3
    s_cselect_b32 s41, s39, s42
    s_xor_b32 s40, s40, s41
    s_mul_i32 s41, s40, 393216
    s_add_u32 s41, s41, s38
    s_lshl_b32 s40, s40, 7
    s_add_u32 s40, s40, s36
    s_add_u32 m0, s44, 122880
    s_add_u32 s46, s40, 0
    s_nop 0
    buffer_load_dwordx4 v12, s[12:15], s46 offen lds
    s_add_u32 m0, s45, 147456
    s_add_u32 s46, s41, 2048
    buffer_load_dwordx4 v14, s[16:19], s46 offen lds
    s_add_u32 m0, s45, 148480
    s_add_u32 s46, s41, 51200
    buffer_load_dwordx4 v15, s[16:19], s46 offen lds
    s_add_u32 m0, s45, 139264
    s_add_u32 s46, s41, 0
    s_add_u32 s46, s46, s47
    buffer_load_dwordx4 v14, s[16:19], s46 offen lds
    s_add_u32 m0, s45, 140288
    s_add_u32 s46, s41, 49152
    s_add_u32 s46, s46, s47
    s_nop 0
    buffer_load_dwordx4 v15, s[16:19], s46 offen lds
    s_add_u32 m0, s45, 155648
    s_add_u32 s46, s41, 4096
    buffer_load_dwordx4 v14, s[16:19], s46 offen lds
    s_add_u32 m0, s45, 156672
    s_add_u32 s46, s41, 53248
    buffer_load_dwordx4 v15, s[16:19], s46 offen lds
    s_add_u32 m0, s44, 123904
    s_add_u32 s46, s40, 16384
    buffer_load_dwordx4 v13, s[12:15], s46 offen lds
    s_add_u32 m0, s44, 124928
    s_add_u32 s46, s40, 32768
    buffer_load_dwordx4 v12, s[12:15], s46 offen lds
    s_add_u32 m0, s44, 125952
    s_add_u32 s46, s40, 49152
    buffer_load_dwordx4 v13, s[12:15], s46 offen lds
    s_bfe_u32 s40, s48, 0x40010
    s_bitcmp1_b32 s40, 3
    s_cselect_b32 s41, s39, s42
    s_xor_b32 s40, s40, s41
    s_mul_i32 s41, s40, 393216
    s_add_u32 s41, s41, s38
    s_lshl_b32 s40, s40, 7
    s_add_u32 s40, s40, s36
    s_add_u32 m0, s44, 0
    s_add_u32 s46, s40, 0
    buffer_load_dwordx4 v12, s[12:15], s46 offen lds
    s_add_u32 m0, s45, 24576
    s_add_u32 s46, s41, 2048
    buffer_load_dwordx4 v14, s[16:19], s46 offen lds
    s_waitcnt vmcnt(12)
    s_barrier
    s_add_u32 m0, s45, 25600
    s_add_u32 s46, s41, 51200
    buffer_load_dwordx4 v15, s[16:19], s46 offen lds
    s_add_u32 m0, s45, 16384
    s_add_u32 s46, s41, 0
    s_add_u32 s46, s46, s47
    buffer_load_dwordx4 v14, s[16:19], s46 offen lds
    s_add_u32 m0, s45, 17408
    s_add_u32 s46, s41, 49152
    s_add_u32 s46, s46, s47
    s_nop 0
    buffer_load_dwordx4 v15, s[16:19], s46 offen lds
    s_add_u32 m0, s45, 32768
    s_add_u32 s46, s41, 4096
    buffer_load_dwordx4 v14, s[16:19], s46 offen lds
    s_add_u32 m0, s45, 33792
    s_add_u32 s46, s41, 53248
    buffer_load_dwordx4 v15, s[16:19], s46 offen lds
    s_add_u32 m0, s44, 1024
    s_add_u32 s46, s40, 16384
    buffer_load_dwordx4 v13, s[12:15], s46 offen lds
    s_add_u32 m0, s44, 2048
    s_add_u32 s46, s40, 32768
    buffer_load_dwordx4 v12, s[12:15], s46 offen lds
    s_add_u32 m0, s44, 3072
    s_add_u32 s46, s40, 49152
    buffer_load_dwordx4 v13, s[12:15], s46 offen lds
    s_bfe_u32 s40, s48, 0x40014
    s_bitcmp1_b32 s40, 3
    s_cselect_b32 s41, s39, s42
    s_xor_b32 s40, s40, s41
    s_mul_i32 s41, s40, 393216
    s_add_u32 s41, s41, s38
    s_lshl_b32 s40, s40, 7
    s_add_u32 s40, s40, s36
    s_add_u32 m0, s44, 40960
    s_add_u32 s46, s40, 0
    s_nop 0
    buffer_load_dwordx4 v12, s[12:15], s46 offen lds
    s_add_u32 m0, s45, 65536
    s_add_u32 s46, s41, 2048
    buffer_load_dwordx4 v14, s[16:19], s46 offen lds
    s_add_u32 m0, s45, 66560
    s_add_u32 s46, s41, 51200
    buffer_load_dwordx4 v15, s[16:19], s46 offen lds
    s_add_u32 m0, s45, 57344
    s_add_u32 s46, s41, 0
    s_add_u32 s46, s46, s47
    buffer_load_dwordx4 v14, s[16:19], s46 offen lds
    s_waitcnt vmcnt(14)
    s_barrier
    s_add_u32 m0, s45, 58368
    s_add_u32 s46, s41, 49152
    s_add_u32 s46, s46, s47
    s_nop 0
    buffer_load_dwordx4 v15, s[16:19], s46 offen lds
    s_add_u32 m0, s45, 73728
    s_add_u32 s46, s41, 4096
    buffer_load_dwordx4 v14, s[16:19], s46 offen lds
    s_add_u32 m0, s45, 74752
    s_add_u32 s46, s41, 53248
    buffer_load_dwordx4 v15, s[16:19], s46 offen lds
    s_add_u32 m0, s44, 41984
    s_add_u32 s46, s40, 16384
    buffer_load_dwordx4 v13, s[12:15], s46 offen lds
    s_add_u32 m0, s44, 43008
    s_add_u32 s46, s40, 32768
    buffer_load_dwordx4 v12, s[12:15], s46 offen lds
    s_add_u32 m0, s44, 44032
    s_add_u32 s46, s40, 49152
    buffer_load_dwordx4 v13, s[12:15], s46 offen lds
    s_bfe_u32 s40, s48, 0x40018
    s_bitcmp1_b32 s40, 3
    s_cselect_b32 s41, s39, s42
    s_xor_b32 s40, s40, s41
    s_mul_i32 s41, s40, 393216
    s_add_u32 s41, s41, s38
    s_lshl_b32 s40, s40, 7
    s_add_u32 s40, s40, s36
    s_add_u32 m0, s44, 81920
    s_add_u32 s46, s40, 0
    s_nop 0
    buffer_load_dwordx4 v12, s[12:15], s46 offen lds
    s_add_u32 m0, s45, 106496
    s_add_u32 s46, s41, 2048
    buffer_load_dwordx4 v14, s[16:19], s46 offen lds
    s_add_u32 m0, s45, 107520
    s_add_u32 s46, s41, 51200
    buffer_load_dwordx4 v15, s[16:19], s46 offen lds
    s_add_u32 m0, s45, 98304
    s_add_u32 s46, s41, 0
    s_add_u32 s46, s46, s47
    buffer_load_dwordx4 v14, s[16:19], s46 offen lds
    s_add_u32 m0, s45, 99328
    s_add_u32 s46, s41, 49152
    s_add_u32 s46, s46, s47
    buffer_load_dwordx4 v15, s[16:19], s46 offen lds
    s_add_u32 m0, s45, 114688
    s_add_u32 s46, s41, 4096
    buffer_load_dwordx4 v14, s[16:19], s46 offen lds
    s_waitcnt vmcnt(16)
    s_barrier
    s_nop 0
    s_add_u32 m0, s45, 115712
    s_add_u32 s46, s41, 53248
    buffer_load_dwordx4 v15, s[16:19], s46 offen lds
    s_add_u32 m0, s44, 82944
    s_add_u32 s46, s40, 16384
    buffer_load_dwordx4 v13, s[12:15], s46 offen lds
    s_add_u32 m0, s44, 83968
    s_add_u32 s46, s40, 32768
    buffer_load_dwordx4 v12, s[12:15], s46 offen lds
    s_add_u32 m0, s44, 84992
    s_add_u32 s46, s40, 49152
    buffer_load_dwordx4 v13, s[12:15], s46 offen lds
    s_bfe_u32 s40, s48, 0x4001c
    s_bitcmp1_b32 s40, 3
    s_cselect_b32 s41, s39, s42
    s_xor_b32 s40, s40, s41
    s_mul_i32 s41, s40, 393216
    s_add_u32 s41, s41, s38
    s_lshl_b32 s40, s40, 7
    s_add_u32 s40, s40, s36
    s_add_u32 m0, s44, 122880
    s_add_u32 s46, s40, 0
    s_nop 0
    buffer_load_dwordx4 v12, s[12:15], s46 offen lds
    s_add_u32 m0, s45, 147456
    s_add_u32 s46, s41, 2048
    buffer_load_dwordx4 v14, s[16:19], s46 offen lds
    s_add_u32 m0, s45, 148480
    s_add_u32 s46, s41, 51200
    buffer_load_dwordx4 v15, s[16:19], s46 offen lds
    s_add_u32 m0, s45, 139264
    s_add_u32 s46, s41, 0
    s_add_u32 s46, s46, s47
    buffer_load_dwordx4 v14, s[16:19], s46 offen lds
    s_add_u32 m0, s45, 140288
    s_add_u32 s46, s41, 49152
    s_add_u32 s46, s46, s47
    s_nop 0
    buffer_load_dwordx4 v15, s[16:19], s46 offen lds
    s_add_u32 m0, s45, 155648
    s_add_u32 s46, s41, 4096
    buffer_load_dwordx4 v14, s[16:19], s46 offen lds
    s_add_u32 m0, s45, 156672
    s_add_u32 s46, s41, 53248
    buffer_load_dwordx4 v15, s[16:19], s46 offen lds
    s_add_u32 m0, s44, 123904
    s_add_u32 s46, s40, 16384
    buffer_load_dwordx4 v13, s[12:15], s46 offen lds
    s_waitcnt vmcnt(18)
    s_barrier
    s_add_u32 m0, s44, 124928
    s_add_u32 s46, s40, 32768
    buffer_load_dwordx4 v12, s[12:15], s46 offen lds
    s_add_u32 m0, s44, 125952
    s_add_u32 s46, s40, 49152
    buffer_load_dwordx4 v13, s[12:15], s46 offen lds
    s_bfe_u32 s40, s49, 0x40000
    s_bitcmp1_b32 s40, 3
    s_cselect_b32 s41, s39, s42
    s_xor_b32 s40, s40, s41
    s_mul_i32 s41, s40, 393216
    s_add_u32 s41, s41, s38
    s_lshl_b32 s40, s40, 7
    s_add_u32 s40, s40, s36
    s_add_u32 m0, s44, 0
    s_add_u32 s46, s40, 0
    buffer_load_dwordx4 v12, s[12:15], s46 offen lds
    s_add_u32 m0, s45, 24576
    s_add_u32 s46, s41, 2048
    buffer_load_dwordx4 v14, s[16:19], s46 offen lds
    s_add_u32 m0, s45, 25600
    s_add_u32 s46, s41, 51200
    buffer_load_dwordx4 v15, s[16:19], s46 offen lds
    s_add_u32 m0, s45, 16384
    s_add_u32 s46, s41, 0
    s_add_u32 s46, s46, s47
    buffer_load_dwordx4 v14, s[16:19], s46 offen lds
    s_add_u32 m0, s45, 17408
    s_add_u32 s46, s41, 49152
    s_add_u32 s46, s46, s47
    s_nop 0
    buffer_load_dwordx4 v15, s[16:19], s46 offen lds
    s_add_u32 m0, s45, 32768
    s_add_u32 s46, s41, 4096
    buffer_load_dwordx4 v14, s[16:19], s46 offen lds
    s_add_u32 m0, s45, 33792
    s_add_u32 s46, s41, 53248
    buffer_load_dwordx4 v15, s[16:19], s46 offen lds
    s_add_u32 m0, s44, 1024
    s_add_u32 s46, s40, 16384
    buffer_load_dwordx4 v13, s[12:15], s46 offen lds
    s_add_u32 m0, s44, 2048
    s_add_u32 s46, s40, 32768
    buffer_load_dwordx4 v12, s[12:15], s46 offen lds
    s_add_u32 m0, s44, 3072
    s_add_u32 s46, s40, 49152
    buffer_load_dwordx4 v13, s[12:15], s46 offen lds
    s_waitcnt vmcnt(20)
    s_barrier
    s_bfe_u32 s40, s49, 0x40004
    s_bitcmp1_b32 s40, 3
    s_cselect_b32 s41, s39, s42
    s_xor_b32 s40, s40, s41
    s_mul_i32 s41, s40, 393216
    s_add_u32 s41, s41, s38
    s_lshl_b32 s40, s40, 7
    s_add_u32 s40, s40, s36
    s_add_u32 m0, s44, 40960
    s_add_u32 s46, s40, 0
    s_nop 0
    buffer_load_dwordx4 v12, s[12:15], s46 offen lds
    s_add_u32 m0, s45, 65536
    s_add_u32 s46, s41, 2048
    buffer_load_dwordx4 v14, s[16:19], s46 offen lds
    s_add_u32 m0, s45, 66560
    s_add_u32 s46, s41, 51200
    buffer_load_dwordx4 v15, s[16:19], s46 offen lds
    s_add_u32 m0, s45, 57344
    s_add_u32 s46, s41, 0
    s_add_u32 s46, s46, s47
    buffer_load_dwordx4 v14, s[16:19], s46 offen lds
    s_add_u32 m0, s45, 58368
    s_add_u32 s46, s41, 49152
    s_add_u32 s46, s46, s47
    s_nop 0
    buffer_load_dwordx4 v15, s[16:19], s46 offen lds
    s_add_u32 m0, s45, 73728
    s_add_u32 s46, s41, 4096
    buffer_load_dwordx4 v14, s[16:19], s46 offen lds
    s_add_u32 m0, s45, 74752
    s_add_u32 s46, s41, 53248
    buffer_load_dwordx4 v15, s[16:19], s46 offen lds
    s_add_u32 m0, s44, 41984
    s_add_u32 s46, s40, 16384
    buffer_load_dwordx4 v13, s[12:15], s46 offen lds
    s_add_u32 m0, s44, 43008
    s_add_u32 s46, s40, 32768
    buffer_load_dwordx4 v12, s[12:15], s46 offen lds
    s_add_u32 m0, s44, 44032
    s_add_u32 s46, s40, 49152
    buffer_load_dwordx4 v13, s[12:15], s46 offen lds
    s_mov_b32 s20, s8
    s_mov_b32 s21, s9
    s_mov_b32 s22, 0x200000
    s_mov_b32 s23, 0x00020000
    s_lshl_b32 s50, s2, 13
    s_lshl_b32 s51, s3, 11
    s_add_u32 s50, s50, s51
    v_lshlrev_b32 v104, 7, v0
    s_mov_b64 exec, 0xffff
    buffer_load_dword v160, v104, s[20:23], s50 offen
    s_mov_b64 exec, -1

    s_waitcnt vmcnt(21)
    s_barrier
    s_bfe_u32 s40, s49, 0x40008
    s_bitcmp1_b32 s40, 3
    s_cselect_b32 s41, s39, s42
    s_xor_b32 s40, s40, s41
    s_mul_i32 s41, s40, 393216
    s_add_u32 s41, s41, s38
    s_lshl_b32 s40, s40, 7
    s_add_u32 s40, s40, s36
    s_add_u32 m0, s44, 81920
    s_add_u32 s46, s40, 0
    buffer_load_dwordx4 v12, s[12:15], s46 offen lds
    s_add_u32 m0, s45, 106496
    s_add_u32 s46, s41, 2048
    buffer_load_dwordx4 v14, s[16:19], s46 offen lds
    s_add_u32 m0, s45, 107520
    s_add_u32 s46, s41, 51200
    buffer_load_dwordx4 v15, s[16:19], s46 offen lds
    s_add_u32 m0, s45, 98304
    s_add_u32 s46, s41, 0
    s_add_u32 s46, s46, s47
    buffer_load_dwordx4 v14, s[16:19], s46 offen lds
    s_add_u32 m0, s45, 99328
    s_add_u32 s46, s41, 49152
    s_add_u32 s46, s46, s47
    s_nop 0
    buffer_load_dwordx4 v15, s[16:19], s46 offen lds
    s_add_u32 m0, s45, 114688
    s_add_u32 s46, s41, 4096
    buffer_load_dwordx4 v14, s[16:19], s46 offen lds
    s_add_u32 m0, s45, 115712
    s_add_u32 s46, s41, 53248
    buffer_load_dwordx4 v15, s[16:19], s46 offen lds
    s_add_u32 m0, s44, 82944
    s_add_u32 s46, s40, 16384
    buffer_load_dwordx4 v13, s[12:15], s46 offen lds
    s_add_u32 m0, s44, 83968
    s_add_u32 s46, s40, 32768
    buffer_load_dwordx4 v12, s[12:15], s46 offen lds
    s_add_u32 m0, s44, 84992
    s_add_u32 s46, s40, 49152
    buffer_load_dwordx4 v13, s[12:15], s46 offen lds
    s_waitcnt vmcnt(21)
    s_barrier
    s_bfe_u32 s40, s49, 0x4000c
    s_bitcmp1_b32 s40, 3
    s_cselect_b32 s41, s39, s42
    s_xor_b32 s40, s40, s41
    s_mul_i32 s41, s40, 393216
    s_add_u32 s41, s41, s38
    s_lshl_b32 s40, s40, 7
    s_add_u32 s40, s40, s36
    s_add_u32 m0, s44, 122880
    s_add_u32 s46, s40, 0
    s_nop 0
    buffer_load_dwordx4 v12, s[12:15], s46 offen lds
    s_add_u32 m0, s45, 147456
    s_add_u32 s46, s41, 2048
    buffer_load_dwordx4 v14, s[16:19], s46 offen lds
W_5:
    s_cbranch_execz R_5
    s_nop 0
    s_add_u32 m0, s45, 148480
    s_add_u32 s46, s41, 51200
    buffer_load_dwordx4 v15, s[16:19], s46 offen lds
    s_add_u32 m0, s45, 139264
    s_add_u32 s46, s41, 0
    s_add_u32 s46, s46, s47
    buffer_load_dwordx4 v14, s[16:19], s46 offen lds
    s_add_u32 m0, s45, 140288
    s_add_u32 s46, s41, 49152
    s_add_u32 s46, s46, s47
    s_nop 0
    buffer_load_dwordx4 v15, s[16:19], s46 offen lds
    s_add_u32 m0, s45, 155648
    s_add_u32 s46, s41, 4096
    buffer_load_dwordx4 v14, s[16:19], s46 offen lds
    s_add_u32 m0, s45, 156672
    s_add_u32 s46, s41, 53248
    buffer_load_dwordx4 v15, s[16:19], s46 offen lds
    s_add_u32 m0, s44, 123904
    s_add_u32 s46, s40, 16384
    buffer_load_dwordx4 v13, s[12:15], s46 offen lds
    s_add_u32 m0, s44, 124928
    s_add_u32 s46, s40, 32768
    buffer_load_dwordx4 v12, s[12:15], s46 offen lds
    s_add_u32 m0, s44, 125952
    s_add_u32 s46, s40, 49152
    buffer_load_dwordx4 v13, s[12:15], s46 offen lds
    s_waitcnt vmcnt(21)
    s_barrier
    s_bfe_u32 s40, s49, 0x40010
    s_bitcmp1_b32 s40, 3
    s_cselect_b32 s41, s39, s42
    s_xor_b32 s40, s40, s41
    s_mul_i32 s41, s40, 393216
    s_add_u32 s41, s41, s38
    s_lshl_b32 s40, s40, 7
    s_add_u32 s40, s40, s36
    s_add_u32 m0, s44, 0
    s_add_u32 s46, s40, 0
    buffer_load_dwordx4 v12, s[12:15], s46 offen lds
    s_add_u32 m0, s45, 24576
    s_add_u32 s46, s41, 2048
    buffer_load_dwordx4 v14, s[16:19], s46 offen lds
    s_add_u32 m0, s45, 25600
    s_add_u32 s46, s41, 51200
    buffer_load_dwordx4 v15, s[16:19], s46 offen lds
    s_add_u32 m0, s45, 16384
    s_add_u32 s46, s41, 0
    s_add_u32 s46, s46, s47
    buffer_load_dwordx4 v14, s[16:19], s46 offen lds
    s_add_u32 m0, s45, 17408
    s_add_u32 s46, s41, 49152
    s_add_u32 s46, s46, s47
    s_nop 0
    buffer_load_dwordx4 v15, s[16:19], s46 offen lds
    s_add_u32 m0, s45, 32768
    s_add_u32 s46, s41, 4096
    buffer_load_dwordx4 v14, s[16:19], s46 offen lds
    s_add_u32 m0, s45, 33792
    s_add_u32 s46, s41, 53248
    buffer_load_dwordx4 v15, s[16:19], s46 offen lds
    s_add_u32 m0, s44, 1024
    s_add_u32 s46, s40, 16384
    buffer_load_dwordx4 v13, s[12:15], s46 offen lds
    s_add_u32 m0, s44, 2048
    s_add_u32 s46, s40, 32768
    buffer_load_dwordx4 v12, s[12:15], s46 offen lds
    s_add_u32 m0, s44, 3072
    s_add_u32 s46, s40, 49152
    buffer_load_dwordx4 v13, s[12:15], s46 offen lds
    s_waitcnt vmcnt(20)
    s_barrier
    s_bfe_u32 s40, s49, 0x40014
    s_bitcmp1_b32 s40, 3
    s_cselect_b32 s41, s39, s42
    s_xor_b32 s40, s40, s41
    s_mul_i32 s41, s40, 393216
    s_add_u32 s41, s41, s38
    s_lshl_b32 s40, s40, 7
    s_add_u32 s40, s40, s36
    s_add_u32 m0, s44, 40960
    s_add_u32 s46, s40, 0
    s_nop 0
    buffer_load_dwordx4 v12, s[12:15], s46 offen lds
    s_add_u32 m0, s45, 65536
    s_add_u32 s46, s41, 2048
    buffer_load_dwordx4 v14, s[16:19], s46 offen lds
    s_add_u32 m0, s45, 66560
    s_add_u32 s46, s41, 51200
    buffer_load_dwordx4 v15, s[16:19], s46 offen lds
    s_add_u32 m0, s45, 57344
    s_add_u32 s46, s41, 0
    s_add_u32 s46, s46, s47
    buffer_load_dwordx4 v14, s[16:19], s46 offen lds
    s_add_u32 m0, s45, 58368
    s_add_u32 s46, s41, 49152
    s_add_u32 s46, s46, s47
    s_nop 0
    buffer_load_dwordx4 v15, s[16:19], s46 offen lds
    s_add_u32 m0, s45, 73728
    s_add_u32 s46, s41, 4096
    buffer_load_dwordx4 v14, s[16:19], s46 offen lds
    s_add_u32 m0, s45, 74752
    s_add_u32 s46, s41, 53248
    buffer_load_dwordx4 v15, s[16:19], s46 offen lds
    s_add_u32 m0, s44, 41984
    s_add_u32 s46, s40, 16384
    buffer_load_dwordx4 v13, s[12:15], s46 offen lds
    s_add_u32 m0, s44, 43008
    s_add_u32 s46, s40, 32768
    buffer_load_dwordx4 v12, s[12:15], s46 offen lds
    s_add_u32 m0, s44, 44032
    s_add_u32 s46, s40, 49152
    buffer_load_dwordx4 v13, s[12:15], s46 offen lds
    v_lshlrev_b32_e64 v10, 4, v0
    s_add_u32 s68, s72, 0x900000
    s_addc_u32 s69, s73, 0
    s_mov_b32 s70, 0x18000
    s_mov_b32 s71, 0x00020000
    s_lshl_b32 s52, s32, 11
    s_add_u32 s52, s52, 65536
    s_lshl_b32 s76, s3, 2
    s_add_u32 s52, s52, s76
    s_lshl_b32 s76, s3, 9
    s_add_u32 s58, s76, 24832

    s_waitcnt vmcnt(20)
    s_barrier
    s_bfe_u32 s40, s49, 0x40018
    s_bitcmp1_b32 s40, 3
    s_cselect_b32 s41, s39, s42
    s_xor_b32 s40, s40, s41
    s_mul_i32 s41, s40, 393216
    s_add_u32 s41, s41, s38
    s_lshl_b32 s40, s40, 7
    s_add_u32 s40, s40, s36
    s_add_u32 m0, s44, 81920
    s_add_u32 s46, s40, 0
    buffer_load_dwordx4 v12, s[12:15], s46 offen lds
    s_add_u32 m0, s45, 106496
    s_add_u32 s46, s41, 2048
    buffer_load_dwordx4 v14, s[16:19], s46 offen lds
    s_add_u32 m0, s45, 107520
    s_add_u32 s46, s41, 51200
    buffer_load_dwordx4 v15, s[16:19], s46 offen lds
    s_add_u32 m0, s45, 98304
    s_add_u32 s46, s41, 0
    s_add_u32 s46, s46, s47
    buffer_load_dwordx4 v14, s[16:19], s46 offen lds
    s_add_u32 m0, s45, 99328
    s_add_u32 s46, s41, 49152
    s_add_u32 s46, s46, s47
    s_nop 0
    buffer_load_dwordx4 v15, s[16:19], s46 offen lds
    s_add_u32 m0, s45, 114688
    s_add_u32 s46, s41, 4096
    buffer_load_dwordx4 v14, s[16:19], s46 offen lds
    s_add_u32 m0, s45, 115712
    s_add_u32 s46, s41, 53248
    buffer_load_dwordx4 v15, s[16:19], s46 offen lds
    s_add_u32 m0, s44, 82944
    s_add_u32 s46, s40, 16384
    buffer_load_dwordx4 v13, s[12:15], s46 offen lds
    s_add_u32 m0, s44, 83968
    s_add_u32 s46, s40, 32768
    buffer_load_dwordx4 v12, s[12:15], s46 offen lds
    s_add_u32 m0, s44, 84992
    s_add_u32 s46, s40, 49152
    buffer_load_dwordx4 v13, s[12:15], s46 offen lds
    s_add_u32 s84, s72, 0xb00000
    s_addc_u32 s85, s73, 0
    s_mov_b32 s86, 0x30000
    s_mov_b32 s87, 0x00020000
    v_bfe_u32 v113, v0, 2, 2
    v_min_u32 v113, 2, v113
    v_lshlrev_b32 v114, 8, v113
    v_lshlrev_b32 v113, 12, v113
    v_and_b32 v112, 3, v0
    v_lshl_add_u32 v113, v112, 4, v113
    v_lshl_add_u32 v114, v112, 4, v114
    v_lshrrev_b32 v112, 4, v0
    v_mul_u32_u24 v112, 12288, v112
    v_add_u32 v113, v113, v112
    s_lshl_b32 s76, s3, 6
    s_lshl_b32 s53, s33, 8
    s_add_u32 s53, s53, s76
    s_add_u32 s76, s76, 26368
    v_add_u32 v114, s76, v114

    s_waitcnt vmcnt(20)
    s_barrier
    s_bfe_u32 s40, s49, 0x4001c
    s_bitcmp1_b32 s40, 3
    s_cselect_b32 s41, s39, s42
    s_xor_b32 s40, s40, s41
    s_mul_i32 s41, s40, 393216
    s_add_u32 s41, s41, s38
    s_lshl_b32 s40, s40, 7
    s_add_u32 s40, s40, s36
    s_add_u32 m0, s44, 122880
    s_add_u32 s46, s40, 0
    buffer_load_dwordx4 v12, s[12:15], s46 offen lds
    s_add_u32 m0, s45, 147456
    s_add_u32 s46, s41, 2048
    buffer_load_dwordx4 v14, s[16:19], s46 offen lds
    s_add_u32 m0, s45, 148480
    s_add_u32 s46, s41, 51200
    buffer_load_dwordx4 v15, s[16:19], s46 offen lds
    s_add_u32 m0, s45, 139264
    s_add_u32 s46, s41, 0
    s_add_u32 s46, s46, s47
    buffer_load_dwordx4 v14, s[16:19], s46 offen lds
    s_add_u32 m0, s45, 140288
    s_add_u32 s46, s41, 49152
    s_add_u32 s46, s46, s47
    s_nop 0
    buffer_load_dwordx4 v15, s[16:19], s46 offen lds
    s_add_u32 m0, s45, 155648
    s_add_u32 s46, s41, 4096
    buffer_load_dwordx4 v14, s[16:19], s46 offen lds
    s_add_u32 m0, s45, 156672
    s_add_u32 s46, s41, 53248
    buffer_load_dwordx4 v15, s[16:19], s46 offen lds
    s_add_u32 m0, s44, 123904
    s_add_u32 s46, s40, 16384
    buffer_load_dwordx4 v13, s[12:15], s46 offen lds
    s_add_u32 m0, s44, 124928
    s_add_u32 s46, s40, 32768
    buffer_load_dwordx4 v12, s[12:15], s46 offen lds
    s_add_u32 m0, s44, 125952
    s_add_u32 s46, s40, 49152
    buffer_load_dwordx4 v13, s[12:15], s46 offen lds
    s_add_u32 s76, s53, 0
    s_nop 0
    buffer_load_dwordx4 v[72:75], v113, s[84:87], s76 offen sc0 sc1
    s_add_u32 s76, s53, 49152
    buffer_load_dwordx4 v[76:79], v113, s[84:87], s76 offen sc0 sc1
    s_add_u32 s76, s53, 98304
    buffer_load_dwordx4 v[80:83], v113, s[84:87], s76 offen sc0 sc1
    s_add_u32 s76, s53, 147456
    buffer_load_dwordx4 v[84:87], v113, s[84:87], s76 offen sc0 sc1
    s_mov_b32 m0, s58
    s_setprio 3
    s_waitcnt vmcnt(24)
    s_barrier
    s_cmp_eq_u32 s3, 3
    s_cbranch_scc1 F_d0
    buffer_load_dword v10, s[68:71], s52 offen sc0 sc1 lds
    s_add_u32 m0, m0, 256
    s_add_u32 s52, s52, 1024
    buffer_load_dword v10, s[68:71], s52 offen sc0 sc1 lds
    s_branch F_d1
F_d0:
    s_nop 0
    s_mov_b32 m0, 24576
    s_mov_b32 s52, 0x7ff00000
    s_mov_b64 exec, 0xfff
    buffer_load_dwordx4 v10, s[84:87], s52 offen lds
    buffer_load_dwordx4 v10, s[84:87], s52 offen lds
    s_mov_b64 exec, -1
F_d1:

    s_setprio 0
    s_waitcnt vmcnt(16)
    s_barrier
    s_waitcnt vmcnt(2)
F_cs0:
    v_min3_u32 v96, v72, v76, v80
    v_min_u32 v96, v96, v84
    v_cmp_eq_u32 vcc, 0, v96
    s_cbranch_vccz F_cs1
    s_sleep 8

    s_add_u32 s76, s53, 0
    buffer_load_dwordx4 v[72:75], v113, s[84:87], s76 offen sc0 sc1
    s_add_u32 s76, s53, 49152
    buffer_load_dwordx4 v[76:79], v113, s[84:87], s76 offen sc0 sc1
    s_add_u32 s76, s53, 98304
    buffer_load_dwordx4 v[80:83], v113, s[84:87], s76 offen sc0 sc1
    s_add_u32 s76, s53, 147456
    buffer_load_dwordx4 v[84:87], v113, s[84:87], s76 offen sc0 sc1
    s_waitcnt vmcnt(0)
    s_branch F_cs0
F_cs1:
    v_add_f32 v72, v72, v76
    v_add_f32 v80, v80, v84
    v_add_f32 v73, v73, v77
    v_add_f32 v81, v81, v85
    v_add_f32 v74, v74, v78
    v_add_f32 v82, v82, v86
    v_add_f32 v75, v75, v79
    v_add_f32 v83, v83, v87
    v_add_f32 v72, v72, v80
    v_add_f32 v73, v73, v81
    v_add_f32 v74, v74, v82
    v_add_f32 v75, v75, v83
    v_mov_b32 v76, v72
    v_mov_b32 v77, v73
    v_mov_b32 v78, v74
    v_mov_b32 v79, v75
    v_permlane32_swap_b32 v72, v76
    v_permlane32_swap_b32 v73, v77
    v_permlane32_swap_b32 v74, v78
    v_permlane32_swap_b32 v75, v79
    v_add_f32 v72, v72, v76
    v_add_f32 v73, v73, v77
    v_add_f32 v74, v74, v78
    v_add_f32 v75, v75, v79
    v_mov_b32 v76, v72
    v_mov_b32 v77, v73
    v_mov_b32 v78, v74
    v_mov_b32 v79, v75
    v_permlane16_swap_b32 v72, v76
    v_permlane16_swap_b32 v73, v77
    v_permlane16_swap_b32 v74, v78
    v_permlane16_swap_b32 v75, v79
    v_add_f32 v72, v72, v76
    v_add_f32 v73, v73, v77
    v_add_f32 v74, v74, v78
    v_add_f32 v75, v75, v79
    s_mov_b64 exec, 0xfff
    ds_write_b128 v114, v[72:75]
    s_mov_b64 exec, -1
    s_waitcnt lgkmcnt(0)

    s_waitcnt vmcnt(0)
    s_barrier
    s_add_u32 s24, s72, 0x800000
    s_addc_u32 s25, s73, 0
    s_mov_b32 s26, 0x100000
    s_mov_b32 s27, 0x00020000
    s_add_u32 s12, s72, 0x400000
    s_addc_u32 s13, s73, 0
    s_mov_b32 s14, 0x400000
    s_mov_b32 s15, 0x00020000
    s_mov_b32 s16, s8
    s_mov_b32 s17, s9
    s_mov_b32 s18, 0x200000
    s_mov_b32 s19, 0x00020000
    v_lshrrev_b32 v4, 4, v0
    v_and_b32 v3, 15, v0
    v_lshlrev_b32 v6, 1, v4
    v_xor_b32 v8, v3, v6
    v_xor_b32 v9, 8, v8
    v_lshlrev_b32 v8, 4, v8
    v_lshlrev_b32_e64 v9, 4, v9
    v_lshl_add_u32 v8, v4, 11, v8
    v_lshl_add_u32 v9, v4, 11, v9
    s_lshl_b32 s38, s29, 8
    s_lshl_b32 s45, s3, 15
    s_add_u32 s38, s38, s45
    s_lshl_b32 s45, s3, 12

    s_mov_b32 s48, 0x76543210
    s_mov_b32 s49, 0xfedcba98
    s_bitcmp1_b32 0x92, s35
    s_cselect_b32 s48, 0xba983210, s48
    s_cselect_b32 s49, 0x7654fedc, s49
    s_bitcmp1_b32 0x24, s35
    s_cselect_b32 s48, 0xfedc3210, s48
    s_cselect_b32 s49, 0xba987654, s49
    s_lshr_b32 s36, s3, 1
    s_and_b32 s37, s3, 1
    s_lshl_b32 s43, s36, 6
    s_lshl_b32 s42, s33, 1
    s_add_u32 s42, s42, s37
    s_mul_i32 s82, s42, 4224
    s_add_u32 s83, s82, 4096
    s_add_u32 s83, s83, s43
    s_lshl_b32 s44, s36, 11
    s_add_u32 s82, s82, s44
    s_mul_i32 s51, s42, 16*64
    s_add_u32 s51, s51, 192512
    s_lshl_b32 s42, s10, 1
    s_add_u32 s42, s42, s37
    s_lshl_b32 s50, s42, 4
    s_add_u32 s50, s50, s32
    s_lshl_b32 s50, s50, 6
    v_lshlrev_b32 v10, 4, v0
    v_lshlrev_b32 v11, 2, v0
    s_lshl_b32 s42, s3, 2
    s_add_u32 s42, s42, 24640
    v_mov_b32 v1, s42
    v_and_b32 v2, 3, v0
    v_lshlrev_b32 v2, 2, v2
    v_add_u32 v2, 24640, v2
    v_and_b32 v105, 1, v0
    v_lshlrev_b32 v105, 3, v105
    s_lshl_b32 s42, s37, 2
    s_add_u32 s42, s42, 24640
    v_add_u32 v105, s42, v105
    s_lshl_b32 s42, s37, 12
    s_add_u32 s42, s42, s44
    s_add_u32 s42, s42, 65536
    v_add_u32 v106, s42, v11
    s_lshl_b32 s42, s37, 7
    s_add_u32 s42, s42, s43
    s_add_u32 s42, s42, 27136
    v_add_u32 v107, s42, v11
    v_mul_u32_u24 v108, 64*16/4, v0
    v_mov_b32 v109, 1
    s_mov_b32 s60, 0
    s_mov_b32 s62, 0xa001024
    s_mov_b32 s63, 0x1a1e14
    s_lshl_b32 s36, s28, 2
    s_add_u32 s36, s36, s3
    s_lshl_b32 s36, s36, 15
    s_lshl_b32 s44, s3, 11
    s_lshl_b32 s50, s28, 3
    s_and_b32 s76, s29, 4-1
    s_mul_i32 s76, s76, 8/4
    s_add_u32 s50, s50, s76
    s_mul_i32 s50, s50, 64
    s_add_u32 s78, s50, 0x837000
    s_add_u32 s78, s72, s78
    s_addc_u32 s79, s73, 0
    s_setprio 3
    s_sleep 10
    s_lshr_b32 s56, s3, 1
    s_add_u32 s56, s56, 1
    ds_read_b32 v114, v105
FW_9:
    s_waitcnt lgkmcnt(0)
    v_cmp_gt_u32 vcc, s56, v114
    s_cbranch_vccz FO_10
    s_sleep 1
    ds_read_b32 v114, v105
    s_branch FW_9
FO_10:
    ds_read2st64_b32 v[12:13], v106 offset0:0 offset1:1
    ds_read2st64_b32 v[20:21], v106 offset0:32 offset1:33
    ds_read2st64_b32 v[14:15], v106 offset0:2 offset1:3
    ds_read2st64_b32 v[22:23], v106 offset0:34 offset1:35
    ds_read2st64_b32 v[16:17], v106 offset0:4 offset1:5
    ds_read2st64_b32 v[24:25], v106 offset0:36 offset1:37
    ds_read2st64_b32 v[18:19], v106 offset0:6 offset1:7
    ds_read2st64_b32 v[26:27], v106 offset0:38 offset1:39
    ds_read2st64_b32 v[28:29], v107 offset0:0 offset1:1
    s_waitcnt lgkmcnt(7)
    v_add_f32 v12, v12, v20
    buffer_atomic_add_f32 v12, v11, s[24:27], s82 offen offset:0
    v_add_f32 v13, v13, v21
    buffer_atomic_add_f32 v13, v11, s[24:27], s82 offen offset:256
    s_waitcnt lgkmcnt(5)
    v_add_f32 v14, v14, v22
    buffer_atomic_add_f32 v14, v11, s[24:27], s82 offen offset:512
    v_add_f32 v15, v15, v23
    buffer_atomic_add_f32 v15, v11, s[24:27], s82 offen offset:768
    s_waitcnt lgkmcnt(3)
    v_add_f32 v16, v16, v24
    buffer_atomic_add_f32 v16, v11, s[24:27], s82 offen offset:1024
    v_add_f32 v17, v17, v25
    buffer_atomic_add_f32 v17, v11, s[24:27], s82 offen offset:1280
    s_waitcnt lgkmcnt(1)
    v_add_f32 v18, v18, v26
    buffer_atomic_add_f32 v18, v11, s[24:27], s82 offen offset:1536
    v_add_f32 v19, v19, v27
    buffer_atomic_add_f32 v19, v11, s[24:27], s82 offen offset:1792
    s_waitcnt lgkmcnt(0)
    v_add_f32 v28, v28, v29
    s_mov_b64 exec, 0xffff
    buffer_atomic_add_f32 v28, v11, s[24:27], s83 offen
    s_mov_b64 exec, -1
    v_mov_b32 v113, 1
    s_mov_b64 exec, 1
    ds_write_b32 v1, v113 offset:32
    s_mov_b64 exec, -1
    s_add_u32 s54, s51, 0x800000
    s_add_u32 s54, s72, s54
    s_addc_u32 s55, s73, 0
    s_mov_b32 s57, 1
    s_waitcnt vmcnt(4)
    ds_read2_b32 v[102:103], v2 offset0:0 offset1:8
    ds_read_b32 v104, v2 offset:16
    s_waitcnt lgkmcnt(0)
    v_cmp_ne_u32 vcc, 3, v102
    v_cmp_eq_u32 s[42:43], 0, v103
    s_nop 0
    s_or_b64 vcc, vcc, s[42:43]
    v_cmp_gt_u32 s[42:43], 2, v104
    s_nop 0
    s_or_b64 vcc, vcc, s[42:43]
    s_waitcnt vmcnt(0)
    s_atomic_add s57, s[54:55], 0
    s_atomic_add s57, s[54:55], 256
    s_atomic_add s57, s[54:55], 512
    s_atomic_add s57, s[54:55], 768
    s_cbranch_vccnz F_pe
    s_bfe_u32 s41, s48, 0x40000
    s_xor_b32 s41, s41, s10
    s_lshl_b32 s41, s41, 17
    s_add_u32 s41, s41, s38
    s_add_u32 m0, s45, 147456
    s_add_u32 s76, s41, 0
    buffer_load_dwordx4 v8, s[16:19], s76 offen lds
    s_add_u32 m0, s45, 148480
    s_add_u32 s76, s41, 8192
    buffer_load_dwordx4 v9, s[16:19], s76 offen lds
    s_add_u32 m0, s45, 149504
    s_add_u32 s76, s41, 16384
    buffer_load_dwordx4 v8, s[16:19], s76 offen lds
    s_add_u32 m0, s45, 150528
    s_add_u32 s76, s41, 24576
    buffer_load_dwordx4 v9, s[16:19], s76 offen lds
    s_bfe_u32 s41, s48, 0x40004
    s_xor_b32 s41, s41, s10
    s_lshl_b32 s41, s41, 17
    s_add_u32 s41, s41, s38
    s_add_u32 m0, s45, 65536
    s_add_u32 s76, s41, 0
    buffer_load_dwordx4 v8, s[16:19], s76 offen lds
    s_add_u32 m0, s45, 66560
    s_add_u32 s76, s41, 8192
    buffer_load_dwordx4 v9, s[16:19], s76 offen lds
    s_add_u32 m0, s45, 67584
    s_add_u32 s76, s41, 16384
    buffer_load_dwordx4 v8, s[16:19], s76 offen lds
    s_add_u32 m0, s45, 68608
    s_add_u32 s76, s41, 24576
    buffer_load_dwordx4 v9, s[16:19], s76 offen lds
    s_mov_b32 s60, 2
F_pe:
    s_setprio 1
F_pr0:
    s_waitcnt vmcnt(8)
    ds_read2_b32 v[102:103], v2 offset0:0 offset1:8
    s_cmp_lt_u32 s60, 2
    s_cselect_b32 s61, 1, 3
    s_waitcnt lgkmcnt(0)
    v_cmp_le_u32 vcc, 4, v102
    s_cbranch_vccz F_pr3
    s_mov_b32 s61, 5
F_pr3:
    v_cmp_gt_u32 vcc, s61, v102
    v_cmp_gt_u32 s[42:43], 1, v103
    s_nop 0
    s_or_b64 vcc, vcc, s[42:43]
    s_cbranch_vccz F_pr2
    s_sleep 2
    s_branch F_pr0
F_pr2:
    s_cmp_lt_u32 s60, 6
    s_cbranch_scc1 F_pr4
    ds_read_b32 v102, v2 offset:16
    s_waitcnt lgkmcnt(0)
    v_cmp_gt_u32 vcc, 2, v102
    s_cbranch_vccz F_pr4
    s_sleep 2
    s_branch F_pr0
F_pr4:
    s_cmp_lg_u32 s60, 4
    s_cbranch_scc1 F_pr6
    s_waitcnt vmcnt(4)
    v_mov_b32_e64 v113, 2
    s_mov_b64 exec, 1
    ds_write_b32 v1, v113 offset:32
    s_mov_b64 exec, -1
F_pr6:
    s_lshl_b32 s41, s60, 2
    s_lshr_b32 s41, s48, s41
    s_and_b32 s41, s41, 15
    s_xor_b32 s41, s41, s10
    s_lshl_b32 s41, s41, 17
    s_add_u32 s41, s41, s38
    s_lshl_b32 s76, s60, 3
    s_lshr_b64 s[42:43], s[62:63], s76
    s_and_b32 s42, s42, 0xff
    s_lshl_b32 s42, s42, 12
    s_add_u32 m0, s42, s45
    s_add_u32 s60, s60, 1
    buffer_load_dwordx4 v8, s[16:19], s41 offen lds
    s_add_u32 m0, m0, 1024
    s_add_u32 s41, s41, 8192
    buffer_load_dwordx4 v9, s[16:19], s41 offen lds
    s_add_u32 m0, m0, 1024
    s_add_u32 s41, s41, 8192
    buffer_load_dwordx4 v8, s[16:19], s41 offen lds
    s_add_u32 m0, m0, 1024
    s_add_u32 s41, s41, 8192
    buffer_load_dwordx4 v9, s[16:19], s41 offen lds
    s_cmp_ge_u32 s60, 7
    s_cbranch_scc1 F_pr1
    s_cmp_eq_u32 s61, 5
    s_cbranch_scc1 F_pr2
    s_branch F_pr0
F_pr1:
    s_cmp_lg_u32 s3, 0
    s_cbranch_scc1 F_l4
SP_11:
    s_load_dword s58, s[78:79], 0 glc
    s_waitcnt lgkmcnt(0)
    s_cmp_ge_u32 s58, 32
    s_cbranch_scc1 SD_12
    s_sleep 1
    s_branch SP_11
SD_12:
F_l6:
    v_mov_b32 v113, 3
    s_mov_b64 exec, 1
    ds_write_b32 v1, v113 offset:112
    s_mov_b64 exec, -1
    s_branch F_l5
F_l4:
    v_mov_b32 v4, 24752
    ds_read_b32 v13, v4
FW_13:
    s_waitcnt lgkmcnt(0)
    v_cmp_gt_u32 vcc, 3, v13
    s_cbranch_vccz FO_14
    s_sleep 1
    ds_read_b32 v13, v4
    s_branch FW_13
FO_14:
F_l5:
    s_bfe_u32 s40, s48, 0x40004
    s_xor_b32 s40, s40, s10
    s_lshl_b32 s40, s40, 11
    s_add_u32 s40, s40, s36
    s_add_u32 m0, s44, 16384
    s_nop 0
    buffer_load_dwordx4 v10, s[12:15], s40 offen offset:0 sc1 lds
    s_add_u32 m0, s44, 16384
    s_nop 0
    buffer_load_dwordx4 v10, s[12:15], s40 offen offset:1024 sc1 lds
    s_bfe_u32 s40, s48, 0x40008
    s_xor_b32 s40, s40, s10
    s_lshl_b32 s40, s40, 11
    s_add_u32 s40, s40, s36
    s_add_u32 m0, s44, 98304
    s_nop 0
    buffer_load_dwordx4 v10, s[12:15], s40 offen offset:0 sc1 lds
    s_add_u32 m0, s44, 98304
    s_nop 0
    buffer_load_dwordx4 v10, s[12:15], s40 offen offset:1024 sc1 lds
    ds_read_b32 v102, v2
FW_15:
    s_waitcnt lgkmcnt(0)
    v_cmp_gt_u32_e64 vcc, 7, v102
    s_cbranch_vccz FO_16
    s_sleep 1
    ds_read_b32 v102, v2
    s_branch FW_15
FO_16:
    s_bfe_u32 s40, s48, 0x4000c
    s_xor_b32 s40, s40, s10
    s_lshl_b32 s40, s40, 11
    s_add_u32 s40, s40, s36
    s_add_u32 m0, s44, 139264
    s_nop 0
    buffer_load_dwordx4 v10, s[12:15], s40 offen offset:0 sc1 lds
    s_add_u32 m0, s44, 139264
    s_nop 0
    buffer_load_dwordx4 v10, s[12:15], s40 offen offset:1024 sc1 lds
    s_bfe_u32 s41, s48, 0x4001c
    s_xor_b32 s41, s41, s10
    s_lshl_b32 s41, s41, 17
    s_add_u32 s41, s41, s38
    s_add_u32 m0, s45, 147456
    s_add_u32 s76, s41, 0
    buffer_load_dwordx4 v8, s[16:19], s76 offen lds
    s_add_u32 m0, s45, 148480
    s_add_u32 s76, s41, 8192
    buffer_load_dwordx4 v9, s[16:19], s76 offen lds
    s_add_u32 m0, s45, 149504
    s_add_u32 s76, s41, 16384
    buffer_load_dwordx4 v8, s[16:19], s76 offen lds
    s_add_u32 m0, s45, 150528
    s_add_u32 s76, s41, 24576
    buffer_load_dwordx4 v9, s[16:19], s76 offen lds
    s_waitcnt vmcnt(8)
    s_barrier
    s_bfe_u32 s40, s48, 0x40010
    s_xor_b32 s40, s40, s10
    s_lshl_b32 s40, s40, 11
    s_add_u32 s40, s40, s36
    s_add_u32 m0, s44, 57344
    s_nop 0
    buffer_load_dwordx4 v10, s[12:15], s40 offen offset:0 sc1 lds
    s_add_u32 m0, s44, 57344
    s_nop 0
    buffer_load_dwordx4 v10, s[12:15], s40 offen offset:1024 sc1 lds
    s_bfe_u32 s41, s49, 0x40000
    s_xor_b32 s41, s41, s10
    s_lshl_b32 s41, s41, 17
    s_add_u32 s41, s41, s38
    s_add_u32 m0, s45, 65536
    s_add_u32 s76, s41, 0
    buffer_load_dwordx4 v8, s[16:19], s76 offen lds
    s_add_u32 m0, s45, 66560
    s_add_u32 s76, s41, 8192
    buffer_load_dwordx4 v9, s[16:19], s76 offen lds
    s_setprio 0
    s_waitcnt vmcnt(10)
    s_barrier
    s_bfe_u32 s40, s48, 0x40014
    s_xor_b32 s40, s40, s10
    s_lshl_b32 s40, s40, 11
    s_add_u32 s40, s40, s36
    s_add_u32 m0, s44, 16384
    s_nop 0
    buffer_load_dwordx4 v10, s[12:15], s40 offen offset:0 sc1 lds
    s_add_u32 m0, s44, 16384
    s_nop 0
    s_nop 0
    buffer_load_dwordx4 v10, s[12:15], s40 offen offset:1024 sc1 lds
    s_add_u32 m0, s45, 67584
    s_add_u32 s76, s41, 16384
    buffer_load_dwordx4 v8, s[16:19], s76 offen lds
    s_add_u32 m0, s45, 68608
    s_add_u32 s76, s41, 24576
W_6:
    s_cbranch_execz R_6
    s_nop 0
    buffer_load_dwordx4 v9, s[16:19], s76 offen lds
    s_bfe_u32 s41, s49, 0x40004
    s_xor_b32 s41, s41, s10
    s_lshl_b32 s41, s41, 17
    s_add_u32 s41, s41, s38
    s_add_u32 m0, s45, 0
    s_add_u32 s76, s41, 0
    buffer_load_dwordx4 v8, s[16:19], s76 offen lds
    s_waitcnt vmcnt(13)
    s_barrier
    s_bfe_u32 s40, s48, 0x40018
    s_xor_b32 s40, s40, s10
    s_lshl_b32 s40, s40, 11
    s_add_u32 s40, s40, s36
    s_add_u32 m0, s44, 98304
    s_nop 0
    buffer_load_dwordx4 v10, s[12:15], s40 offen offset:0 sc1 lds
    s_add_u32 m0, s44, 98304
    s_nop 0
    buffer_load_dwordx4 v10, s[12:15], s40 offen offset:1024 sc1 lds
    s_add_u32 m0, s45, 1024
    s_add_u32 s76, s41, 8192
    buffer_load_dwordx4 v9, s[16:19], s76 offen lds
    s_add_u32 m0, s45, 2048
    s_add_u32 s76, s41, 16384
    buffer_load_dwordx4 v8, s[16:19], s76 offen lds
    s_add_u32 m0, s45, 3072
    s_add_u32 s76, s41, 24576
    buffer_load_dwordx4 v9, s[16:19], s76 offen lds
    s_waitcnt vmcnt(12)
    s_barrier
    s_bfe_u32 s40, s48, 0x4001c
    s_xor_b32 s40, s40, s10
    s_lshl_b32 s40, s40, 11
    s_add_u32 s40, s40, s36
    s_add_u32 m0, s44, 139264
    s_nop 0
    buffer_load_dwordx4 v10, s[12:15], s40 offen offset:0 sc1 lds
    s_add_u32 m0, s44, 139264
    s_nop 0
    buffer_load_dwordx4 v10, s[12:15], s40 offen offset:1024 sc1 lds
    s_bfe_u32 s41, s49, 0x40008
    s_xor_b32 s41, s41, s10
    s_lshl_b32 s41, s41, 17
    s_add_u32 s41, s41, s38
    s_add_u32 m0, s45, 40960
    s_add_u32 s76, s41, 0
    s_nop 0
    buffer_load_dwordx4 v8, s[16:19], s76 offen lds
    s_add_u32 m0, s45, 41984
    s_add_u32 s76, s41, 8192
    buffer_load_dwordx4 v9, s[16:19], s76 offen lds
    s_add_u32 m0, s45, 43008
    s_add_u32 s76, s41, 16384
    buffer_load_dwordx4 v8, s[16:19], s76 offen lds
    s_waitcnt vmcnt(13)
    s_barrier
    s_bfe_u32 s40, s49, 0x40000
    s_xor_b32 s40, s40, s10
    s_lshl_b32 s40, s40, 11
    s_add_u32 s40, s40, s36
    s_add_u32 m0, s44, 57344
    s_nop 0
    buffer_load_dwordx4 v10, s[12:15], s40 offen offset:0 sc1 lds
    s_add_u32 m0, s44, 57344
    s_nop 0
    s_nop 0
    buffer_load_dwordx4 v10, s[12:15], s40 offen offset:1024 sc1 lds
    s_add_u32 m0, s45, 44032
    s_add_u32 s76, s41, 24576
    buffer_load_dwordx4 v9, s[16:19], s76 offen lds
    s_bfe_u32 s41, s49, 0x4000c
    s_xor_b32 s41, s41, s10
    s_lshl_b32 s41, s41, 17
    s_add_u32 s41, s41, s38
    s_add_u32 m0, s45, 81920
    s_add_u32 s76, s41, 0
    buffer_load_dwordx4 v8, s[16:19], s76 offen lds
    s_add_u32 m0, s45, 82944
    s_add_u32 s76, s41, 8192
    buffer_load_dwordx4 v9, s[16:19], s76 offen lds
    s_waitcnt vmcnt(13)
    s_barrier
    s_bfe_u32 s40, s49, 0x40004
    s_xor_b32 s40, s40, s10
    s_lshl_b32 s40, s40, 11
    s_add_u32 s40, s40, s36
    s_add_u32 m0, s44, 16384
    s_nop 0
    buffer_load_dwordx4 v10, s[12:15], s40 offen offset:0 sc1 lds
    s_add_u32 m0, s44, 16384
    s_nop 0
    s_nop 0
    buffer_load_dwordx4 v10, s[12:15], s40 offen offset:1024 sc1 lds
    s_add_u32 m0, s45, 83968
    s_add_u32 s76, s41, 16384
    buffer_load_dwordx4 v8, s[16:19], s76 offen lds
    s_add_u32 m0, s45, 84992
    s_add_u32 s76, s41, 24576
    buffer_load_dwordx4 v9, s[16:19], s76 offen lds
    s_bfe_u32 s41, s49, 0x40010
    s_xor_b32 s41, s41, s10
    s_lshl_b32 s41, s41, 17
    s_add_u32 s41, s41, s38
    s_add_u32 m0, s45, 122880
    s_add_u32 s76, s41, 0
    buffer_load_dwordx4 v8, s[16:19], s76 offen lds
    s_waitcnt vmcnt(13)
    s_barrier
    s_bfe_u32 s40, s49, 0x40008
    s_xor_b32 s40, s40, s10
    s_lshl_b32 s40, s40, 11
    s_add_u32 s40, s40, s36
    s_add_u32 m0, s44, 98304
    s_nop 0
    buffer_load_dwordx4 v10, s[12:15], s40 offen offset:0 sc1 lds
    s_add_u32 m0, s44, 98304
    s_nop 0
    s_nop 0
    buffer_load_dwordx4 v10, s[12:15], s40 offen offset:1024 sc1 lds
    s_add_u32 m0, s45, 123904
    s_add_u32 s76, s41, 8192
    buffer_load_dwordx4 v9, s[16:19], s76 offen lds
    s_add_u32 m0, s45, 124928
    s_add_u32 s76, s41, 16384
    buffer_load_dwordx4 v8, s[16:19], s76 offen lds
    s_add_u32 m0, s45, 125952
    s_add_u32 s76, s41, 24576
    buffer_load_dwordx4 v9, s[16:19], s76 offen lds
    s_waitcnt vmcnt(13)
    s_barrier
    s_bfe_u32 s40, s49, 0x4000c
    s_xor_b32 s40, s40, s10
    s_lshl_b32 s40, s40, 11
    s_add_u32 s40, s40, s36
    s_add_u32 m0, s44, 139264
    s_nop 0
    buffer_load_dwordx4 v10, s[12:15], s40 offen offset:0 sc1 lds
    s_add_u32 m0, s44, 139264
    s_nop 0
    buffer_load_dwordx4 v10, s[12:15], s40 offen offset:1024 sc1 lds
    s_bfe_u32 s41, s49, 0x40014
    s_xor_b32 s41, s41, s10
    s_lshl_b32 s41, s41, 17
    s_add_u32 s41, s41, s38
    s_add_u32 m0, s45, 106496
    s_add_u32 s76, s41, 0
    s_nop 0
    buffer_load_dwordx4 v8, s[16:19], s76 offen lds
    s_add_u32 m0, s45, 107520
    s_add_u32 s76, s41, 8192
    buffer_load_dwordx4 v9, s[16:19], s76 offen lds
    s_add_u32 m0, s45, 108544
    s_add_u32 s76, s41, 16384
    buffer_load_dwordx4 v8, s[16:19], s76 offen lds
    s_waitcnt vmcnt(13)
    s_barrier
    s_bfe_u32 s40, s49, 0x40010
    s_xor_b32 s40, s40, s10
    s_lshl_b32 s40, s40, 11
    s_add_u32 s40, s40, s36
    s_add_u32 m0, s44, 57344
    s_nop 0
    buffer_load_dwordx4 v10, s[12:15], s40 offen offset:0 sc1 lds
    s_add_u32 m0, s44, 57344
    s_nop 0
    s_nop 0
    buffer_load_dwordx4 v10, s[12:15], s40 offen offset:1024 sc1 lds
    s_add_u32 m0, s45, 109568
    s_add_u32 s76, s41, 24576
    buffer_load_dwordx4 v9, s[16:19], s76 offen lds
    s_bfe_u32 s41, s49, 0x40018
    s_xor_b32 s41, s41, s10
    s_lshl_b32 s41, s41, 17
    s_add_u32 s41, s41, s38
    s_add_u32 m0, s45, 147456
    s_add_u32 s76, s41, 0
    buffer_load_dwordx4 v8, s[16:19], s76 offen lds
    s_add_u32 m0, s45, 148480
    s_add_u32 s76, s41, 8192
    buffer_load_dwordx4 v9, s[16:19], s76 offen lds
    s_waitcnt vmcnt(13)
    s_barrier
    s_bfe_u32 s40, s49, 0x40014
    s_xor_b32 s40, s40, s10
    s_lshl_b32 s40, s40, 11
    s_add_u32 s40, s40, s36
    s_add_u32 m0, s44, 16384
    s_nop 0
    buffer_load_dwordx4 v10, s[12:15], s40 offen offset:0 sc1 lds
    s_add_u32 m0, s44, 16384
    s_nop 0
    s_nop 0
    buffer_load_dwordx4 v10, s[12:15], s40 offen offset:1024 sc1 lds
    s_add_u32 m0, s45, 149504
    s_add_u32 s76, s41, 16384
    buffer_load_dwordx4 v8, s[16:19], s76 offen lds
    s_add_u32 m0, s45, 150528
    s_add_u32 s76, s41, 24576
    buffer_load_dwordx4 v9, s[16:19], s76 offen lds
    s_bfe_u32 s41, s49, 0x4001c
    s_xor_b32 s41, s41, s10
    s_lshl_b32 s41, s41, 17
    s_add_u32 s41, s41, s38
    s_add_u32 m0, s45, 65536
    s_add_u32 s76, s41, 0
    buffer_load_dwordx4 v8, s[16:19], s76 offen lds
    s_waitcnt vmcnt(13)
    s_barrier
    s_bfe_u32 s40, s49, 0x40018
    s_xor_b32 s40, s40, s10
    s_lshl_b32 s40, s40, 11
    s_add_u32 s40, s40, s36
    s_add_u32 m0, s44, 98304
    s_nop 0
    buffer_load_dwordx4 v10, s[12:15], s40 offen offset:0 sc1 lds
    s_add_u32 m0, s44, 98304
    s_nop 0
    s_nop 0
    buffer_load_dwordx4 v10, s[12:15], s40 offen offset:1024 sc1 lds
    s_add_u32 m0, s45, 66560
    s_add_u32 s76, s41, 8192
    buffer_load_dwordx4 v9, s[16:19], s76 offen lds
    s_add_u32 m0, s45, 67584
    s_add_u32 s76, s41, 16384
    buffer_load_dwordx4 v8, s[16:19], s76 offen lds
    s_add_u32 m0, s45, 68608
    s_add_u32 s76, s41, 24576
    buffer_load_dwordx4 v9, s[16:19], s76 offen lds
    s_waitcnt vmcnt(13)
    s_barrier
    s_bfe_u32 s40, s49, 0x4001c
    s_xor_b32 s40, s40, s10
    s_lshl_b32 s40, s40, 11
    s_add_u32 s40, s40, s36
    s_add_u32 m0, s44, 139264
    s_nop 0
    buffer_load_dwordx4 v10, s[12:15], s40 offen offset:0 sc1 lds
    s_add_u32 m0, s44, 139264
    s_nop 0
    buffer_load_dwordx4 v10, s[12:15], s40 offen offset:1024 sc1 lds
    s_waitcnt vmcnt(10)
    s_barrier
    s_waitcnt vmcnt(5)
    s_barrier
    s_waitcnt vmcnt(0)
    s_barrier
    s_endpgm
F_aux:
    s_barrier
    s_setprio 0
    s_sub_u32 s3, s3, 4
    s_add_u32 s11, s33, 4
    s_lshr_b32 s11, s11, 3
    s_sub_u32 s11, s33, s11
    s_lshl_b32 s11, s11, 4
    s_add_u32 s11, s11, s32
    s_and_b32 s36, s33, 7
    s_cmp_eq_u32 s36, 3
    s_cselect_b32 s11, 255, s11
    s_and_b32 s36, s11, 3
    s_bfe_u32 s37, s11, 0x10002
    s_lshr_b32 s38, s11, 3
    v_lshlrev_b32 v3, 2, v0
    s_lshl_b32 s77, s36, 1
    s_add_u32 s77, s77, s37
    s_mul_i32 s77, s77, 114688
    s_lshl_b32 s46, s38, 12
    s_add_u32 s77, s77, s46
    s_lshl_b32 s46, s3, 10
    s_add_u32 s77, s77, s46
    s_cmp_ge_u32 s11, 224
    s_cselect_b32 s77, 0x7ff00000, s77
    v_mov_b32 v140, 0
    v_mov_b32 v141, 0
    v_mov_b32 v142, 0
    v_mov_b32 v143, 0
    s_add_u32 s12, s72, 0xa00000
    s_addc_u32 s13, s73, 0
    s_mov_b32 s14, 0xe0000
    s_mov_b32 s15, 0x00020000
    buffer_store_dwordx4 v[140:143], v2, s[12:15], s77 offen sc0 sc1
    s_add_u32 s12, s72, 0xb00000
    s_addc_u32 s13, s73, 0
    s_mov_b32 s14, 0x30000
    s_mov_b32 s15, 0x00020000
    s_lshl_b32 s47, s32, 8
    s_add_u32 s56, s47, 0x908000
    s_add_u32 s56, s72, s56
    s_addc_u32 s57, s73, 0
    s_cmp_eq_u32 s37, 0
    s_cselect_b32 s16, s62, s64
    s_cselect_b32 s17, s63, s65
    s_mov_b32 s18, 7340032
    s_mov_b32 s19, 0x00020000
    s_lshl_b32 s44, s3, 2
    s_add_u32 s44, s44, 24640
    v_mov_b32 v10, s44
    v_lshrrev_b32 v5, 4, v0
    v_mul_u32_u24 v6, 57344, v5
    v_and_b32 v7, 15, v0
    v_lshl_add_u32 v6, v7, 4, v6
    s_lshl_b32 s44, s36, 2
    s_add_u32 s44, s44, s3
    s_mul_i32 s54, s44, 458752
    s_lshl_b32 s45, s38, 8
    s_add_u32 s54, s54, s45
    s_cmp_ge_u32 s11, 224
    s_cselect_b32 s54, 0x70000000, s54
    s_lshl_b32 s55, s44, 7
    v_mov_b32 v8, 0
    s_mov_b32 s80, s66
    s_mov_b32 s81, s67
    s_mov_b32 s82, 0x700000
    s_mov_b32 s83, 0x00020000
    v_bfe_u32 v21, v0, 2, 2
    v_lshl_add_u32 v22, v5, 3, v21
    v_lshrrev_b32 v21, 1, v21
    v_and_b32 v20, 1, v5
    v_lshl_add_u32 v21, v20, 1, v21
    v_xor_b32 v21, s3, v21
    v_lshlrev_b32 v21, 5, v21
    v_lshl_add_u32 v21, v22, 7, v21
    v_and_b32 v20, 3, v0
    v_lshl_add_u32 v21, v20, 3, v21
    s_mov_b32 s44, 0x23453342
    s_lshl_b32 s89, s35, 2
    s_lshr_b32 s89, s44, s89
    s_and_b32 s89, s89, 15
    s_and_b32 s44, s89, 3
    s_mul_i32 s44, s44, 40960
    s_add_u32 s44, s44, 16384
    v_add_u32 v112, s44, v21
    v_lshlrev_b32 v113, 2, v7
    v_lshl_add_u32 v113, v5, 12, v113
    s_lshl_b32 s91, s33, 8
    s_lshl_b32 s45, s3, 6
    s_add_u32 s91, s91, s45
    s_mul_i32 s88, s32, 12288
    s_add_u32 s88, s88, s91
    s_mov_b32 exec_hi, 0xffff
    buffer_store_dword v8, v113, s[12:15], s88 offen sc0 sc1
    s_mov_b64 exec, -1
    s_getpc_b64 s[64:65]
F_cp:
    s_add_u32 s64, s64, F_co-F_cp
    s_addc_u32 s65, s65, 0
    s_branch F_cx
F_co:
    ds_read_b64_tr_b16 v[72:73], v112 offset:0
    ds_read_b64_tr_b16 v[74:75], v112 offset:512
    ds_read_b64_tr_b16 v[76:77], v112 offset:4096
    ds_read_b64_tr_b16 v[78:79], v112 offset:4608
    ds_read_b64_tr_b16 v[80:81], v112 offset:8192
    ds_read_b64_tr_b16 v[82:83], v112 offset:8704
    ds_read_b64_tr_b16 v[84:85], v112 offset:12288
    ds_read_b64_tr_b16 v[86:87], v112 offset:12800
    ds_read_b64_tr_b16 v[88:89], v112 offset:16384
    ds_read_b64_tr_b16 v[90:91], v112 offset:16896
    ds_read_b64_tr_b16 v[92:93], v112 offset:20480
    ds_read_b64_tr_b16 v[94:95], v112 offset:20992
    v_mov_b32 v108, 0x3f803f80
    v_mov_b32 v109, 0x3f803f80
    v_mov_b32 v110, 0x3f803f80
    v_mov_b32 v111, 0x3f803f80
    s_waitcnt lgkmcnt(0)
    s_swappc_b64 s[64:65], s[66:67]
    s_setprio 3
    v_mfma_f32_16x16x32_bf16 v[96:99], v[108:111], v[72:75], 0
    v_mfma_f32_16x16x32_bf16 v[100:103], v[108:111], v[80:83], 0
    v_mfma_f32_16x16x32_bf16 v[104:107], v[108:111], v[88:91], 0
    v_mfma_f32_16x16x32_bf16 v[96:99], v[108:111], v[76:79], v[96:99]
    v_mfma_f32_16x16x32_bf16 v[100:103], v[108:111], v[84:87], v[100:103]
    v_mfma_f32_16x16x32_bf16 v[104:107], v[108:111], v[92:95], v[104:107]
    s_setprio 0
    v_cmp_eq_u32 vcc, 1, v5
    s_nop 4
    v_cndmask_b32 v96, v96, v100, vcc
    v_cmp_eq_u32 vcc, 2, v5
    s_nop 1
    v_cndmask_b32 v96, v96, v104, vcc
    v_max_u32 v96, 1, v96
    s_sleep 4
    s_mov_b32 exec_hi, 0xffff
    buffer_store_dword v96, v113, s[12:15], s88 offen sc0 sc1
    s_mov_b64 exec, -1
    s_setpc_b64 s[66:67]
F_cx:
    s_cmp_eq_u32 s3, 0
    s_cbranch_scc1 F_ax0
    s_cmp_eq_u32 s3, 2
    s_cbranch_scc1 F_ax2
    s_barrier
    s_waitcnt vmcnt(0)
    s_barrier
    s_sub_u32 s45, 2, s89
    s_cmp_gt_u32 s45, 1
    s_cbranch_scc1 CB_17
    s_swappc_b64 s[66:67], s[64:65]
CB_17:
    s_barrier
    s_sub_u32 s45, 3, s89
    s_cmp_gt_u32 s45, 1
    s_cbranch_scc1 CB_18
    s_swappc_b64 s[66:67], s[64:65]
CB_18:
    s_barrier
    s_sub_u32 s45, 4, s89
    s_cmp_gt_u32 s45, 1
    s_cbranch_scc1 CB_19
    s_swappc_b64 s[66:67], s[64:65]
CB_19:
    s_barrier
    s_sub_u32 s45, 5, s89
    s_cmp_gt_u32 s45, 1
    s_cbranch_scc1 CB_20
    s_swappc_b64 s[66:67], s[64:65]
CB_20:
    s_barrier
    s_sub_u32 s45, 6, s89
    s_cmp_gt_u32 s45, 1
    s_cbranch_scc1 CB_21
    s_swappc_b64 s[66:67], s[64:65]
CB_21:
    s_cmp_eq_u32 s3, 3
    s_cbranch_scc1 IW_22
    s_mov_b64 exec, 0
    s_branch W_1
R_1:
    s_branch W_2
R_2:
    s_mov_b64 exec, -1
    s_branch IW_22e
IW_22:
    s_mov_b64 exec, 0
    s_branch W_3
R_3:
    s_branch W_4
R_4:
    s_mov_b64 exec, -1
IW_22e:
    s_barrier
    s_cmp_eq_u32 s3, 3
    s_cbranch_scc1 IW_23
    s_mov_b64 exec, 0
    s_branch W_5
R_5:
    s_branch W_6
R_6:
    s_mov_b64 exec, -1
    s_branch IW_23e
IW_23:
    s_mov_b64 exec, 0
    s_branch W_7
R_7:
    s_branch W_8
R_8:
    s_mov_b64 exec, -1
IW_23e:
    s_barrier
    s_cmp_eq_u32 s3, 3
    s_cbranch_scc1 IW_24
    s_mov_b64 exec, 0
    s_nop 0
R_9:
    s_nop 0
R_10:
    s_mov_b64 exec, -1
    s_branch IW_24e
IW_24:
    s_mov_b64 exec, 0
    s_nop 0
R_11:
    s_nop 0
R_12:
    s_mov_b64 exec, -1
IW_24e:
    s_barrier
    s_barrier
    s_barrier
    s_branch F_aj
F_ax0:
    s_lshl_b32 s44, s32, 2
    buffer_load_dword v9, v8, s[48:51], s44 offen sc0 sc1
    s_barrier
    s_waitcnt vmcnt(0)
    v_cmp_eq_u32 vcc, 0, v9
    s_cbranch_vccz F_ax0r
PL_25:
    buffer_load_dword v9, v8, s[48:51], s44 offen sc0 sc1
    s_waitcnt vmcnt(0)
    v_cmp_gt_u32 vcc, 1, v9
    s_cbranch_vccz PD_26
    s_sleep 1
    s_branch PL_25
PD_26:
F_ax0r:
    s_barrier
    s_mov_b32 s76, 1
    s_atomic_add s76, s[56:57], 0 glc
    s_sub_u32 s45, 2, s89
    s_cmp_gt_u32 s45, 1
    s_cbranch_scc1 CB_27
    s_swappc_b64 s[66:67], s[64:65]
CB_27:
    s_barrier
    s_mov_b32 s75, 0
    s_waitcnt lgkmcnt(0)
    s_cmp_lg_u32 s76, 15
    s_cbranch_scc1 F_ax0c
    s_mov_b32 s75, 1
    s_atomic_add s75, s[70:71], 64 glc
F_ax0c:
    s_sub_u32 s45, 3, s89
    s_cmp_gt_u32 s45, 1
    s_cbranch_scc1 CB_28
    s_swappc_b64 s[66:67], s[64:65]
CB_28:
    s_barrier
    s_sub_u32 s45, 4, s89
    s_cmp_gt_u32 s45, 1
    s_cbranch_scc1 CB_29
    s_swappc_b64 s[66:67], s[64:65]
CB_29:
    s_waitcnt lgkmcnt(0)
    s_cmp_lg_u32 s75, 15
    s_cbranch_scc1 F_ax0d
    v_lshlrev_b32 v9, 8, v0
    v_mov_b32 v11, 1000
    s_mov_b32 s44, 32768
    s_mov_b64 exec, 0xffff
    buffer_store_dword v11, v9, s[40:43], s44 offen sc0 sc1
    s_mov_b64 exec, -1
F_ax0d:
    s_barrier
    s_sub_u32 s45, 5, s89
    s_cmp_gt_u32 s45, 1
    s_cbranch_scc1 CB_30
    s_swappc_b64 s[66:67], s[64:65]
CB_30:
    s_barrier
    s_sub_u32 s45, 6, s89
    s_cmp_gt_u32 s45, 1
    s_cbranch_scc1 CB_31
    s_swappc_b64 s[66:67], s[64:65]
CB_31:
    s_barrier
    s_barrier
    s_barrier
    s_barrier
    s_barrier
    s_branch F_aj
F_ax2:
    s_lshl_b32 s44, s2, 10
    buffer_store_dwordx4 v[140:143], v2, s[24:27], s44 offen sc0 sc1
    s_mov_b64 exec, -1
    s_barrier
    s_waitcnt vmcnt(0)
    s_cmp_lg_u32 s2, 16
    s_cbranch_scc1 F_ax2n
    s_barrier
    s_sub_u32 s45, 2, s89
    s_cmp_gt_u32 s45, 1
    s_cbranch_scc1 CB_32
    s_swappc_b64 s[66:67], s[64:65]
CB_32:
    s_barrier
    s_sub_u32 s45, 3, s89
    s_cmp_gt_u32 s45, 1
    s_cbranch_scc1 CB_33
    s_swappc_b64 s[66:67], s[64:65]
CB_33:
    s_barrier
    s_sub_u32 s45, 4, s89
    s_cmp_gt_u32 s45, 1
    s_cbranch_scc1 CB_34
    s_swappc_b64 s[66:67], s[64:65]
CB_34:
    s_barrier
    s_sub_u32 s45, 5, s89
    s_cmp_gt_u32 s45, 1
    s_cbranch_scc1 CB_35
    s_swappc_b64 s[66:67], s[64:65]
CB_35:
    s_barrier
    s_sub_u32 s45, 6, s89
    s_cmp_gt_u32 s45, 1
    s_cbranch_scc1 CB_36
    s_swappc_b64 s[66:67], s[64:65]
CB_36:
    s_load_dword s76, s[56:57], 0 glc
    s_barrier
    s_waitcnt lgkmcnt(0)
    s_cmp_ge_u32 s76, 1000
    s_cbranch_scc1 F_ax2g
SP_37:
    s_load_dword s76, s[56:57], 0 glc
    s_waitcnt lgkmcnt(0)
    s_cmp_ge_u32 s76, 1000
    s_cbranch_scc1 SD_38
    s_sleep 2
    s_branch SP_37
SD_38:
F_ax2g:
    s_movk_i32 s44, 0
    buffer_load_dwordx4 v[16:19], v2, s[40:43], s44 offen sc0 sc1
    s_movk_i32 s44, 1024
    buffer_load_dwordx4 v[20:23], v2, s[40:43], s44 offen sc0 sc1
    s_movk_i32 s44, 2048
    buffer_load_dwordx4 v[24:27], v2, s[40:43], s44 offen sc0 sc1
    s_movk_i32 s44, 3072
    buffer_load_dwordx4 v[28:31], v2, s[40:43], s44 offen sc0 sc1
    s_movk_i32 s44, 4096
    buffer_load_dwordx4 v[32:35], v2, s[40:43], s44 offen sc0 sc1
    s_movk_i32 s44, 5120
    buffer_load_dwordx4 v[36:39], v2, s[40:43], s44 offen sc0 sc1
    s_movk_i32 s44, 6144
    buffer_load_dwordx4 v[40:43], v2, s[40:43], s44 offen sc0 sc1
    s_movk_i32 s44, 7168
    buffer_load_dwordx4 v[44:47], v2, s[40:43], s44 offen sc0 sc1
    s_mov_b32 s53, 0
    v_and_b32 v13, 7, v0
    v_lshlrev_b32 v13, 2, v13
    v_lshrrev_b32_e64 v9, 3, v0
    v_lshl_add_u32 v13, v9, 7, v13
    s_barrier
    s_waitcnt vmcnt(0)
    s_mov_b32 s58, 0x01010101
    s_mov_b32 s59, s58
    v_max3_u32 v48, v16, v17, v18
    v_med3_u32 v49, v16, v17, v18
    v_min3_u32 v50, v16, v17, v18
    v_med3_u32 v50, v49, v50, v19
    v_med3_u32 v49, v48, v49, v19
    v_max_u32 v48, v48, v19
    v_med3_u32 v50, v49, v50, v20
    v_med3_u32 v49, v48, v49, v20
    v_max_u32 v48, v48, v20
    v_med3_u32 v50, v49, v50, v21
    v_med3_u32 v49, v48, v49, v21
    v_max_u32 v48, v48, v21
    v_med3_u32 v50, v49, v50, v22
    v_med3_u32 v49, v48, v49, v22
    v_max_u32 v48, v48, v22
    v_med3_u32 v50, v49, v50, v23
    v_med3_u32 v49, v48, v49, v23
    v_max_u32 v48, v48, v23
    v_med3_u32 v50, v49, v50, v24
    v_med3_u32 v49, v48, v49, v24
    v_max_u32 v48, v48, v24
    v_med3_u32 v50, v49, v50, v25
    v_med3_u32 v49, v48, v49, v25
    v_max_u32 v48, v48, v25
    v_med3_u32 v50, v49, v50, v26
    v_med3_u32 v49, v48, v49, v26
    v_max_u32 v48, v48, v26
    v_med3_u32 v50, v49, v50, v27
    v_med3_u32 v49, v48, v49, v27
    v_max_u32 v48, v48, v27
    v_med3_u32 v50, v49, v50, v28
    v_med3_u32 v49, v48, v49, v28
    v_max_u32 v48, v48, v28
    v_med3_u32 v50, v49, v50, v29
    v_med3_u32 v49, v48, v49, v29
    v_max_u32 v48, v48, v29
    v_med3_u32 v50, v49, v50, v30
    v_med3_u32 v49, v48, v49, v30
    v_max_u32 v48, v48, v30
    v_med3_u32 v50, v49, v50, v31
    v_med3_u32 v49, v48, v49, v31
    v_max_u32 v48, v48, v31
    v_med3_u32 v50, v49, v50, v32
    v_med3_u32 v49, v48, v49, v32
    v_max_u32 v48, v48, v32
    s_barrier
    v_med3_u32 v50, v49, v50, v33
    v_med3_u32 v49, v48, v49, v33
    v_max_u32 v48, v48, v33
    v_med3_u32 v50, v49, v50, v34
    v_med3_u32 v49, v48, v49, v34
    v_max_u32 v48, v48, v34
    v_med3_u32 v50, v49, v50, v35
    v_med3_u32 v49, v48, v49, v35
    v_max_u32 v48, v48, v35
    v_med3_u32 v50, v49, v50, v36
    v_med3_u32 v49, v48, v49, v36
    v_max_u32 v48, v48, v36
    v_med3_u32 v50, v49, v50, v37
    v_med3_u32 v49, v48, v49, v37
    v_max_u32 v48, v48, v37
    v_med3_u32 v50, v49, v50, v38
    v_med3_u32 v49, v48, v49, v38
    v_max_u32 v48, v48, v38
    v_med3_u32 v50, v49, v50, v39
    v_med3_u32 v49, v48, v49, v39
    v_max_u32 v48, v48, v39
    v_med3_u32 v50, v49, v50, v40
    v_med3_u32 v49, v48, v49, v40
    v_max_u32 v48, v48, v40
    v_med3_u32 v50, v49, v50, v41
    v_med3_u32 v49, v48, v49, v41
    v_max_u32 v48, v48, v41
    v_med3_u32 v50, v49, v50, v42
    v_med3_u32 v49, v48, v49, v42
    v_max_u32 v48, v48, v42
    v_med3_u32 v50, v49, v50, v43
    v_med3_u32 v49, v48, v49, v43
    v_max_u32 v48, v48, v43
    v_med3_u32 v50, v49, v50, v44
    v_med3_u32 v49, v48, v49, v44
    v_max_u32 v48, v48, v44
    v_med3_u32 v50, v49, v50, v45
    v_med3_u32 v49, v48, v49, v45
    v_max_u32 v48, v48, v45
    v_med3_u32 v50, v49, v50, v46
    v_med3_u32 v49, v48, v49, v46
    v_max_u32 v48, v48, v46
    v_med3_u32 v50, v49, v50, v47
    v_med3_u32 v49, v48, v49, v47
    v_max_u32 v48, v48, v47
    v_mov_b32 v4, v48
    s_nop 1
    v_max_u32_dpp v4, v4, v4 row_shr:1 row_mask:0xf bank_mask:0xf bound_ctrl:0
    s_nop 1
    v_max_u32_dpp v4, v4, v4 row_shr:2 row_mask:0xf bank_mask:0xf bound_ctrl:0
    s_nop 1
    v_max_u32_dpp v4, v4, v4 row_shr:4 row_mask:0xf bank_mask:0xf bound_ctrl:0
    s_nop 1
    v_max_u32_dpp v4, v4, v4 row_shr:8 row_mask:0xf bank_mask:0xf bound_ctrl:0
    s_nop 1
    v_max_u32_dpp v4, v4, v4 row_bcast:15 row_mask:0xa bank_mask:0xf
    s_nop 1
    v_max_u32_dpp v4, v4, v4 row_bcast:31 row_mask:0xc bank_mask:0xf
    s_nop 0
    v_readlane_b32 s52, v4, 63
    s_lshl_b64 exec, s[58:59], 0
    s_nop 0
    v_mov_b32 v12, s52
    s_mov_b64 exec, -1
    v_cmp_eq_u32 vcc, s52, v48
    s_nop 1
    v_cndmask_b32 v48, v48, v49, vcc
    v_cndmask_b32 v49, v49, v50, vcc
    v_cndmask_b32 v50, v50, 0, vcc
    s_barrier
    v_mov_b32 v4, v48
    s_nop 1
    v_max_u32_dpp v4, v4, v4 row_shr:1 row_mask:0xf bank_mask:0xf bound_ctrl:0
    s_nop 1
    v_max_u32_dpp v4, v4, v4 row_shr:2 row_mask:0xf bank_mask:0xf bound_ctrl:0
    s_nop 1
    v_max_u32_dpp v4, v4, v4 row_shr:4 row_mask:0xf bank_mask:0xf bound_ctrl:0
    s_nop 1
    v_max_u32_dpp v4, v4, v4 row_shr:8 row_mask:0xf bank_mask:0xf bound_ctrl:0
    s_nop 1
    v_max_u32_dpp v4, v4, v4 row_bcast:15 row_mask:0xa bank_mask:0xf
    s_nop 1
    v_max_u32_dpp v4, v4, v4 row_bcast:31 row_mask:0xc bank_mask:0xf
    s_nop 0
    v_readlane_b32 s52, v4, 63
    s_lshl_b64 exec, s[58:59], 1
    s_nop 0
    v_mov_b32 v12, s52
    s_mov_b64 exec, -1
    v_cmp_eq_u32 vcc, s52, v48
    s_nop 1
    v_cndmask_b32 v48, v48, v49, vcc
    v_cndmask_b32 v49, v49, v50, vcc
    v_cndmask_b32 v50, v50, 0, vcc
    v_mov_b32 v4, v48
    s_nop 1
    v_max_u32_dpp v4, v4, v4 row_shr:1 row_mask:0xf bank_mask:0xf bound_ctrl:0
    s_nop 1
W_7:
    s_cbranch_execz R_7
    s_nop 0
    v_max_u32_dpp v4, v4, v4 row_shr:2 row_mask:0xf bank_mask:0xf bound_ctrl:0
    s_nop 1
    v_max_u32_dpp v4, v4, v4 row_shr:4 row_mask:0xf bank_mask:0xf bound_ctrl:0
    s_nop 1
    v_max_u32_dpp v4, v4, v4 row_shr:8 row_mask:0xf bank_mask:0xf bound_ctrl:0
    s_nop 1
    v_max_u32_dpp v4, v4, v4 row_bcast:15 row_mask:0xa bank_mask:0xf
    s_nop 1
    v_max_u32_dpp v4, v4, v4 row_bcast:31 row_mask:0xc bank_mask:0xf
    s_nop 0
    v_readlane_b32 s52, v4, 63
    s_lshl_b64 exec, s[58:59], 2
    s_nop 0
    v_mov_b32 v12, s52
    s_mov_b64 exec, -1
    v_cmp_eq_u32 vcc, s52, v48
    s_nop 1
    v_cndmask_b32 v48, v48, v49, vcc
    v_cndmask_b32 v49, v49, v50, vcc
    v_cndmask_b32 v50, v50, 0, vcc
    v_mov_b32 v4, v48
    s_nop 1
    v_max_u32_dpp v4, v4, v4 row_shr:1 row_mask:0xf bank_mask:0xf bound_ctrl:0
    s_nop 1
    v_max_u32_dpp v4, v4, v4 row_shr:2 row_mask:0xf bank_mask:0xf bound_ctrl:0
    s_nop 1
    v_max_u32_dpp v4, v4, v4 row_shr:4 row_mask:0xf bank_mask:0xf bound_ctrl:0
    s_nop 1
    v_max_u32_dpp v4, v4, v4 row_shr:8 row_mask:0xf bank_mask:0xf bound_ctrl:0
    s_nop 1
    v_max_u32_dpp v4, v4, v4 row_bcast:15 row_mask:0xa bank_mask:0xf
    s_nop 1
    v_max_u32_dpp v4, v4, v4 row_bcast:31 row_mask:0xc bank_mask:0xf
    s_nop 0
    v_readlane_b32 s52, v4, 63
    s_lshl_b64 exec, s[58:59], 3
    s_nop 0
    v_mov_b32 v12, s52
    s_mov_b64 exec, -1
    v_cmp_eq_u32 vcc, s52, v48
    s_nop 1
    v_cndmask_b32 v48, v48, v49, vcc
    v_cndmask_b32 v49, v49, v50, vcc
    v_cndmask_b32 v50, v50, 0, vcc
    v_mov_b32 v4, v48
    s_nop 1
    v_max_u32_dpp v4, v4, v4 row_shr:1 row_mask:0xf bank_mask:0xf bound_ctrl:0
    s_nop 1
    v_max_u32_dpp v4, v4, v4 row_shr:2 row_mask:0xf bank_mask:0xf bound_ctrl:0
    s_nop 1
    v_max_u32_dpp v4, v4, v4 row_shr:4 row_mask:0xf bank_mask:0xf bound_ctrl:0
    s_nop 1
    v_max_u32_dpp v4, v4, v4 row_shr:8 row_mask:0xf bank_mask:0xf bound_ctrl:0
    s_nop 1
    v_max_u32_dpp v4, v4, v4 row_bcast:15 row_mask:0xa bank_mask:0xf
    s_nop 1
    v_max_u32_dpp v4, v4, v4 row_bcast:31 row_mask:0xc bank_mask:0xf
    s_nop 0
    v_readlane_b32 s52, v4, 63
    s_lshl_b64 exec, s[58:59], 4
    s_nop 0
    v_mov_b32 v12, s52
    s_mov_b64 exec, -1
    v_cmp_eq_u32 vcc, s52, v48
    s_nop 1
    v_cndmask_b32 v48, v48, v49, vcc
    v_cndmask_b32 v49, v49, v50, vcc
    v_cndmask_b32 v50, v50, 0, vcc
    s_barrier
    v_mov_b32 v4, v48
    s_nop 1
    v_max_u32_dpp v4, v4, v4 row_shr:1 row_mask:0xf bank_mask:0xf bound_ctrl:0
    s_nop 1
    v_max_u32_dpp v4, v4, v4 row_shr:2 row_mask:0xf bank_mask:0xf bound_ctrl:0
    s_nop 1
    v_max_u32_dpp v4, v4, v4 row_shr:4 row_mask:0xf bank_mask:0xf bound_ctrl:0
    s_nop 1
    v_max_u32_dpp v4, v4, v4 row_shr:8 row_mask:0xf bank_mask:0xf bound_ctrl:0
    s_nop 1
    v_max_u32_dpp v4, v4, v4 row_bcast:15 row_mask:0xa bank_mask:0xf
    s_nop 1
    v_max_u32_dpp v4, v4, v4 row_bcast:31 row_mask:0xc bank_mask:0xf
    s_nop 0
    v_readlane_b32 s52, v4, 63
    s_lshl_b64 exec, s[58:59], 5
    s_nop 0
    v_mov_b32 v12, s52
    s_mov_b64 exec, -1
    v_cmp_eq_u32 vcc, s52, v48
    s_nop 1
    v_cndmask_b32 v48, v48, v49, vcc
    v_cndmask_b32 v49, v49, v50, vcc
    v_cndmask_b32 v50, v50, 0, vcc
    v_mov_b32 v4, v48
    s_nop 1
    v_max_u32_dpp v4, v4, v4 row_shr:1 row_mask:0xf bank_mask:0xf bound_ctrl:0
    s_nop 1
    v_max_u32_dpp v4, v4, v4 row_shr:2 row_mask:0xf bank_mask:0xf bound_ctrl:0
    s_nop 1
    v_max_u32_dpp v4, v4, v4 row_shr:4 row_mask:0xf bank_mask:0xf bound_ctrl:0
    s_nop 1
    v_max_u32_dpp v4, v4, v4 row_shr:8 row_mask:0xf bank_mask:0xf bound_ctrl:0
    s_nop 1
    v_max_u32_dpp v4, v4, v4 row_bcast:15 row_mask:0xa bank_mask:0xf
    s_nop 1
    v_max_u32_dpp v4, v4, v4 row_bcast:31 row_mask:0xc bank_mask:0xf
    s_nop 0
    v_readlane_b32 s52, v4, 63
    s_lshl_b64 exec, s[58:59], 6
    s_nop 0
    v_mov_b32 v12, s52
    s_mov_b64 exec, -1
    v_cmp_eq_u32 vcc, s52, v48
    s_nop 1
    v_cndmask_b32 v48, v48, v49, vcc
    v_cndmask_b32 v49, v49, v50, vcc
    v_cndmask_b32 v50, v50, 0, vcc
    v_mov_b32 v4, v48
    s_nop 1
    v_max_u32_dpp v4, v4, v4 row_shr:1 row_mask:0xf bank_mask:0xf bound_ctrl:0
    s_nop 1
    v_max_u32_dpp v4, v4, v4 row_shr:2 row_mask:0xf bank_mask:0xf bound_ctrl:0
    s_nop 1
    v_max_u32_dpp v4, v4, v4 row_shr:4 row_mask:0xf bank_mask:0xf bound_ctrl:0
    s_nop 1
    v_max_u32_dpp v4, v4, v4 row_shr:8 row_mask:0xf bank_mask:0xf bound_ctrl:0
    s_nop 1
    v_max_u32_dpp v4, v4, v4 row_bcast:15 row_mask:0xa bank_mask:0xf
    s_nop 1
    v_max_u32_dpp v4, v4, v4 row_bcast:31 row_mask:0xc bank_mask:0xf
    s_nop 0
    v_readlane_b32 s52, v4, 63
    s_lshl_b64 exec, s[58:59], 7
    s_nop 0
    v_mov_b32 v12, s52
    s_mov_b64 exec, -1
    v_cmp_eq_u32 vcc, 0, v48
    s_cbranch_vccz F_tk2
    s_mov_b32 s52, 0
    s_mov_b32 s45, 0
F_tk1:
    v_subrev_u32 v16, s52, v16
    v_subrev_u32 v17, s52, v17
    v_subrev_u32 v18, s52, v18
    v_subrev_u32 v19, s52, v19
    v_subrev_u32 v20, s52, v20
    v_subrev_u32 v21, s52, v21
    v_subrev_u32 v22, s52, v22
    v_subrev_u32 v23, s52, v23
    v_subrev_u32 v24, s52, v24
    v_subrev_u32 v25, s52, v25
    v_subrev_u32 v26, s52, v26
    v_subrev_u32 v27, s52, v27
    v_subrev_u32 v28, s52, v28
    v_subrev_u32 v29, s52, v29
    v_subrev_u32 v30, s52, v30
    v_subrev_u32 v31, s52, v31
    v_subrev_u32 v32, s52, v32
    v_subrev_u32 v33, s52, v33
    v_subrev_u32 v34, s52, v34
    v_subrev_u32 v35, s52, v35
    v_subrev_u32 v36, s52, v36
    v_subrev_u32 v37, s52, v37
    v_subrev_u32 v38, s52, v38
    v_subrev_u32 v39, s52, v39
    v_subrev_u32 v40, s52, v40
    v_subrev_u32 v41, s52, v41
    v_subrev_u32 v42, s52, v42
    v_subrev_u32 v43, s52, v43
    v_subrev_u32 v44, s52, v44
    v_subrev_u32 v45, s52, v45
    v_subrev_u32 v46, s52, v46
    v_subrev_u32 v47, s52, v47
    v_max3_u32 v4, v16, v17, v18
    v_max3_u32 v4, v4, v19, v20
    v_max3_u32 v4, v4, v21, v22
    v_max3_u32 v4, v4, v23, v24
    v_max3_u32 v4, v4, v25, v26
    v_max3_u32 v4, v4, v27, v28
    v_max3_u32 v4, v4, v29, v30
    v_max3_u32 v4, v4, v31, v32
    v_max3_u32 v4, v4, v33, v34
    v_max3_u32 v4, v4, v35, v36
    v_max3_u32 v4, v4, v37, v38
    v_max3_u32 v4, v4, v39, v40
    v_max3_u32 v4, v4, v41, v42
    v_max3_u32 v4, v4, v43, v44
    v_max3_u32 v4, v4, v45, v46
    v_max_u32 v4, v4, v47
    s_nop 1
    v_max_u32_dpp v4, v4, v4 row_shr:1 row_mask:0xf bank_mask:0xf bound_ctrl:0
    s_nop 1
    v_max_u32_dpp v4, v4, v4 row_shr:2 row_mask:0xf bank_mask:0xf bound_ctrl:0
    s_nop 1
    v_max_u32_dpp v4, v4, v4 row_shr:4 row_mask:0xf bank_mask:0xf bound_ctrl:0
    s_nop 1
    v_max_u32_dpp v4, v4, v4 row_shr:8 row_mask:0xf bank_mask:0xf bound_ctrl:0
    s_nop 1
    v_max_u32_dpp v4, v4, v4 row_bcast:15 row_mask:0xa bank_mask:0xf
    s_nop 1
    v_max_u32_dpp v4, v4, v4 row_bcast:31 row_mask:0xc bank_mask:0xf
    s_nop 0
    v_readlane_b32 s52, v4, 63
    s_nop 0
    s_add_u32 s53, s53, s52
    s_lshl_b64 exec, s[58:59], s45
    v_mov_b32 v12, s53
    s_mov_b64 exec, -1
    s_add_u32 s45, s45, 1
    s_cmp_lt_u32 s45, 8
    s_cbranch_scc1 F_tk1
F_tk2:
    v_or_b32 v12, 0x8000, v12
    s_mov_b32 s44, 184320
    buffer_store_dword v12, v13, s[24:27], s44 offen offset:0 sc0 sc1
    buffer_store_dword v12, v13, s[24:27], s44 offen offset:1024 sc0 sc1
    buffer_store_dword v12, v13, s[24:27], s44 offen offset:2048 sc0 sc1
    buffer_store_dword v12, v13, s[24:27], s44 offen offset:3072 sc0 sc1
    s_mov_b32 s44, 188416
    buffer_store_dword v12, v13, s[24:27], s44 offen offset:0 sc0 sc1
    buffer_store_dword v12, v13, s[24:27], s44 offen offset:1024 sc0 sc1
    buffer_store_dword v12, v13, s[24:27], s44 offen offset:2048 sc0 sc1
    buffer_store_dword v12, v13, s[24:27], s44 offen offset:3072 sc0 sc1
    s_branch F_aj
F_ax2n:
    s_barrier
    s_sub_u32 s45, 2, s89
    s_cmp_gt_u32 s45, 1
    s_cbranch_scc1 CB_39
    s_swappc_b64 s[66:67], s[64:65]
CB_39:
    s_barrier
    s_sub_u32 s45, 3, s89
    s_cmp_gt_u32 s45, 1
    s_cbranch_scc1 CB_40
    s_swappc_b64 s[66:67], s[64:65]
CB_40:
    s_barrier
    s_sub_u32 s45, 4, s89
    s_cmp_gt_u32 s45, 1
    s_cbranch_scc1 CB_41
    s_swappc_b64 s[66:67], s[64:65]
CB_41:
    s_barrier
    s_sub_u32 s45, 5, s89
    s_cmp_gt_u32 s45, 1
    s_cbranch_scc1 CB_42
    s_swappc_b64 s[66:67], s[64:65]
CB_42:
    s_barrier
    s_sub_u32 s45, 6, s89
    s_cmp_gt_u32 s45, 1
    s_cbranch_scc1 CB_43
    s_swappc_b64 s[66:67], s[64:65]
CB_43:
    s_barrier
    s_load_dword s76, s[56:57], 0 glc
    s_barrier
    s_waitcnt lgkmcnt(0)
    s_cmp_ge_u32 s76, 1000
    s_cbranch_scc1 F_ax2h
SP_44:
    s_load_dword s76, s[56:57], 0 glc
    s_waitcnt lgkmcnt(0)
    s_cmp_ge_u32 s76, 1000
    s_cbranch_scc1 SD_45
    s_sleep 8
    s_branch SP_44
SD_45:
F_ax2h:
    s_barrier
    s_barrier
    s_barrier
F_aj:
    s_add_u32 s12, s72, 0xa00000
    s_addc_u32 s13, s73, 0
    s_mov_b32 s14, 0xe0000
    s_mov_b32 s15, 0x00020000
    s_and_b32 s46, s2, 63
    s_lshl_b32 s46, s46, 7
    s_add_u32 s56, s46, 0x82d000
    s_add_u32 s56, s72, s56
    s_addc_u32 s57, s73, 0
    s_mov_b32 s58, 0x01010101
    s_mov_b32 s59, s58
    s_mov_b32 s52, 0x05040100
    s_mov_b32 s53, 0x07060302
    v_and_b32 v13, 3, v0
    v_lshlrev_b32 v13, 2, v13
    v_add_u32 v13, 24656, v13
    s_lshl_b32 s86, s38, 2
    s_add_u32 s86, s86, s3
    s_and_b32 s87, s11, 7
    s_lshl_b32 s78, s86, 16
    s_lshl_b32 s79, s87, 8
    s_add_u32 s78, s78, s79

    v_lshlrev_b32 v160, 11, v5
    v_lshl_add_u32 v160, v7, 4, v160
    v_subrev_u32 v163, 16, v13
    v_add_u32 v162, 16, v13
    v_and_b32 v11, 7, v0
    v_lshlrev_b32 v11, 4, v11
    v_lshrrev_b32 v164, 3, v0
    v_lshl_add_u32 v164, v164, 9, v11
    s_lshl_b32 s45, s3, 12
    s_add_u32 s45, s45, 106496
    v_add_u32 v164, s45, v164
    s_lshl_b32 s45, s3, 10
    s_add_u32 s44, s45, 106496
    v_add_u32 v165, s44, v2
    s_add_u32 s44, s45, 32768
    v_add_u32 v167, s44, v2
    s_and_b32 s44, s3, 1
    s_lshl_b32 s44, s44, 12
    s_lshr_b32 s45, s3, 1
    s_mul_i32 s45, s45, 24576
    s_add_u32 s44, s44, s45
    s_add_u32 s44, s44, 32768
    v_add_u32 v161, s44, v2
    v_lshl_add_u32 v11, v5, 7, v11
    v_bfe_u32 v12, v0, 3, 1
    v_mul_u32_u24 v12, 114688, v12
    v_add_u32 v11, v11, v12
    v_mov_b32 v48, 0
    v_mov_b32 v49, 0
    v_mov_b32 v50, 0
    v_mov_b32 v51, 0
    v_mov_b32 v52, 0
    v_mov_b32 v53, 0
    v_mov_b32 v54, 0
    v_mov_b32 v55, 0
    v_mov_b32 v56, 0
    v_mov_b32 v57, 0
    v_mov_b32 v58, 0
    v_mov_b32 v59, 0
    v_mov_b32 v60, 0
    v_mov_b32 v61, 0
    v_mov_b32 v62, 0
    v_mov_b32 v63, 0
    s_barrier
    s_barrier
    s_sleep 2
    s_add_u32 s45, s54, 0
    buffer_load_dwordx4 v[72:75], v6, s[16:19], s45 offen nt
    s_add_u32 s45, s54, 7168
    buffer_load_dwordx4 v[76:79], v6, s[16:19], s45 offen nt
    s_add_u32 s45, s54, 14336
    buffer_load_dwordx4 v[80:83], v6, s[16:19], s45 offen nt
    s_add_u32 s45, s54, 21504
    buffer_load_dwordx4 v[84:87], v6, s[16:19], s45 offen nt
    s_add_u32 s45, s54, 28672
    buffer_load_dwordx4 v[88:91], v6, s[16:19], s45 offen nt
    s_barrier
    s_nop 0
    s_load_dwordx8 s[60:67], s[56:57], 0 glc
    s_add_u32 s45, s54, 35840
    buffer_load_dwordx4 v[92:95], v6, s[16:19], s45 offen nt
    s_add_u32 s45, s54, 43008
    buffer_load_dwordx4 v[96:99], v6, s[16:19], s45 offen nt
    s_add_u32 s45, s54, 50176
    buffer_load_dwordx4 v[100:103], v6, s[16:19], s45 offen nt
    s_add_u32 s45, s54, 229376
    buffer_load_dwordx4 v[104:107], v6, s[16:19], s45 offen nt
    s_add_u32 s45, s54, 236544
    buffer_load_dwordx4 v[108:111], v6, s[16:19], s45 offen nt
    s_barrier
    s_setprio 1
F_sc:
    s_waitcnt lgkmcnt(0)
    s_and_b64 s[74:75], s[60:61], s[62:63]
    s_and_b64 s[74:75], s[74:75], s[64:65]
    s_and_b64 s[74:75], s[74:75], s[66:67]
    s_and_b32 s74, s74, s75
    s_bitcmp1_b32 s74, 15
    s_cbranch_scc1 F_sd
    s_sleep 4
    s_load_dwordx8 s[60:67], s[56:57], 0 glc
    s_branch F_sc
F_sd:

    s_lshl_b64 exec, s[58:59], 0
    v_mov_b32 v4, s60
    s_lshl_b64 exec, s[58:59], 1
    v_mov_b32 v4, s61
    s_lshl_b64 exec, s[58:59], 2
    v_mov_b32 v4, s62
    s_lshl_b64 exec, s[58:59], 3
    v_mov_b32 v4, s63
    s_lshl_b64 exec, s[58:59], 4
    v_mov_b32 v4, s64
    s_lshl_b64 exec, s[58:59], 5
    v_mov_b32 v4, s65
    s_lshl_b64 exec, s[58:59], 6
    v_mov_b32 v4, s66
    s_lshl_b64 exec, s[58:59], 7
    v_mov_b32 v4, s67
    s_mov_b64 exec, -1
    s_mov_b32 s46, 65536
    v_and_b32 v4, 0x7ff, v4
    v_sub_u32 v4, 2047, v4
    v_lshlrev_b32 v9, 4, v4
    v_lshlrev_b32 v4, 11, v4
    v_lshl_add_u32 v4, v5, 4, v4
    v_and_b32_e64 v12, 8, v0
    v_lshl_add_u32 v4, v12, 3, v4

    buffer_load_dwordx4 v[64:67], v4, s[20:23], s55 offen
    buffer_load_dwordx2 v[14:15], v9, s[40:43], s46 offen sc0 sc1
    s_mov_b32 s48, 0xbfb8aa3b
    s_cmp_lt_u32 s11, 224
    s_cbranch_scc1 F_ag
    v_mov_b32 v4, 2
    s_mov_b64 exec, 1
    ds_write_b32 v10, v4 offset:16
    s_mov_b64 exec, -1
    s_sleep 64
    s_branch F_out
F_ag:
    s_add_u32 s45, s54, 243712
    buffer_load_dwordx4 v[112:115], v6, s[16:19], s45 offen nt
    s_add_u32 s45, s54, 250880
    buffer_load_dwordx4 v[116:119], v6, s[16:19], s45 offen nt
    s_add_u32 s45, s54, 258048
    buffer_load_dwordx4 v[120:123], v6, s[16:19], s45 offen nt
    s_add_u32 s45, s54, 265216
    buffer_load_dwordx4 v[124:127], v6, s[16:19], s45 offen nt
    s_add_u32 s45, s54, 272384
    buffer_load_dwordx4 v[128:131], v6, s[16:19], s45 offen nt
    s_add_u32 s45, s54, 279552
    buffer_load_dwordx4 v[132:135], v6, s[16:19], s45 offen nt
    s_waitcnt vmcnt(6)
    v_lshlrev_b32 v32, 16, v64
    v_and_b32 v33, 0xffff0000, v64
    v_lshlrev_b32 v34, 16, v65
    v_and_b32 v35, 0xffff0000, v65
    v_lshlrev_b32 v36, 16, v66
    v_and_b32 v37, 0xffff0000, v66
    v_lshlrev_b32 v38, 16, v67
    v_and_b32 v39, 0xffff0000, v67
    v_add_f32 v32, v32, v14
    v_add_f32 v33, v33, v14
    v_add_f32 v34, v34, v14
    v_add_f32 v35, v35, v14
    v_add_f32 v36, v36, v14
    v_add_f32 v37, v37, v14
    v_add_f32 v38, v38, v14
    v_add_f32 v39, v39, v14
    v_cvt_pk_bf16_f32 v64, v32, v33
    v_cvt_pk_bf16_f32 v65, v34, v35
    v_cvt_pk_bf16_f32 v66, v36, v37
    v_cvt_pk_bf16_f32 v67, v38, v39
    v_lshlrev_b32 v32, 16, v64
    v_and_b32 v33, 0xffff0000, v64
    v_lshlrev_b32 v34, 16, v65
    v_and_b32 v35, 0xffff0000, v65
    v_lshlrev_b32 v36, 16, v66
    v_and_b32 v37, 0xffff0000, v66
    v_lshlrev_b32 v38, 16, v67
    v_and_b32 v39, 0xffff0000, v67
    v_mul_f32 v32, v32, v15
    v_mul_f32 v33, v33, v15
    v_mul_f32 v34, v34, v15
    v_mul_f32 v35, v35, v15
    v_mul_f32 v36, v36, v15
    v_mul_f32 v37, v37, v15
    v_mul_f32 v38, v38, v15
    v_mul_f32_e64 v39, v39, v15
    v_cvt_pk_bf16_f32 v64, v32, v33
    v_cvt_pk_bf16_f32 v65, v34, v35
    v_cvt_pk_bf16_f32 v66, v36, v37
    v_cvt_pk_bf16_f32 v67, v38, v39
    v_mov_b32_dpp v48, v64 quad_perm:[0,1,2,3] row_mask:0xf bank_mask:0x3
    v_mov_b32_dpp v49, v65 quad_perm:[0,1,2,3] row_mask:0xf bank_mask:0x3
    v_mov_b32_dpp v50, v66 quad_perm:[0,1,2,3] row_mask:0xf bank_mask:0x3
    v_mov_b32_dpp v51, v67 quad_perm:[0,1,2,3] row_mask:0xf bank_mask:0x3
    v_mov_b32_dpp v52, v64 row_ror:8 row_mask:0xf bank_mask:0xc
    v_mov_b32_dpp v53, v65 row_ror:8 row_mask:0xf bank_mask:0xc
    v_mov_b32_dpp v54, v66 row_ror:8 row_mask:0xf bank_mask:0xc
    v_mov_b32_dpp v55, v67 row_ror:8 row_mask:0xf bank_mask:0xc
    v_mov_b32_dpp v56, v64 row_ror:8 row_mask:0xf bank_mask:0x3
    v_mov_b32_dpp v57, v65 row_ror:8 row_mask:0xf bank_mask:0x3
    v_mov_b32_dpp v58, v66 row_ror:8 row_mask:0xf bank_mask:0x3
    v_mov_b32_dpp v59, v67 row_ror:8 row_mask:0xf bank_mask:0x3
    v_mov_b32_dpp v60, v64 quad_perm:[0,1,2,3] row_mask:0xf bank_mask:0xc
    v_mov_b32_dpp v61, v65 quad_perm:[0,1,2,3] row_mask:0xf bank_mask:0xc
    v_mov_b32_dpp v62, v66 quad_perm:[0,1,2,3] row_mask:0xf bank_mask:0xc
    v_mov_b32_dpp v63, v67 quad_perm:[0,1,2,3] row_mask:0xf bank_mask:0xc
    v_perm_b32 v136, v76, v72, s52
    v_perm_b32 v137, v84, v80, s52
    v_perm_b32 v138, v92, v88, s52
    v_perm_b32 v139, v100, v96, s52
    s_nop 1
    v_mfma_f32_16x16x32_bf16 v[32:35], v[136:139], v[48:51], 0
    v_perm_b32 v140, v78, v74, s52
    v_perm_b32 v141, v86, v82, s52
    v_perm_b32 v142, v94, v90, s52
    v_perm_b32 v143, v102, v98, s52
    s_nop 1
    v_mfma_f32_16x16x32_bf16 v[32:35], v[140:143], v[52:55], v[32:35]
    v_perm_b32 v136, v76, v72, s53
    v_perm_b32 v137, v84, v80, s53
    v_perm_b32 v138, v92, v88, s53
    v_perm_b32 v139, v100, v96, s53
    s_nop 1
    v_mfma_f32_16x16x32_bf16 v[36:39], v[136:139], v[48:51], 0
    v_perm_b32 v140, v78, v74, s53
    v_perm_b32 v141, v86, v82, s53
    v_perm_b32 v142, v94, v90, s53
    v_perm_b32 v143, v102, v98, s53
    s_nop 1
    v_mfma_f32_16x16x32_bf16 v[36:39], v[140:143], v[52:55], v[36:39]
    v_perm_b32 v136, v77, v73, s52
    v_perm_b32 v137, v85, v81, s52
    v_perm_b32 v138, v93, v89, s52
    v_perm_b32 v139, v101, v97, s52
    s_nop 1
    v_mfma_f32_16x16x32_bf16 v[40:43], v[136:139], v[48:51], 0
    v_perm_b32 v140, v79, v75, s52
    v_perm_b32 v141, v87, v83, s52
    v_perm_b32 v142, v95, v91, s52
    v_perm_b32 v143, v103, v99, s52
    s_nop 1
    v_mfma_f32_16x16x32_bf16 v[40:43], v[140:143], v[52:55], v[40:43]
    v_perm_b32 v136, v77, v73, s53
    v_perm_b32 v137, v85, v81, s53
    v_perm_b32 v138, v93, v89, s53
    v_perm_b32 v139, v101, v97, s53
    s_nop 1
    v_mfma_f32_16x16x32_bf16 v[44:47], v[136:139], v[48:51], 0
    v_perm_b32 v140, v79, v75, s53
    v_perm_b32 v141, v87, v83, s53
    v_perm_b32 v142, v95, v91, s53
    v_perm_b32 v143, v103, v99, s53
    s_nop 1
    v_mfma_f32_16x16x32_bf16 v[44:47], v[140:143], v[52:55], v[44:47]
    s_waitcnt vmcnt(6)
    s_nop 0
    v_perm_b32 v72, v108, v104, s52
    v_perm_b32 v88, v110, v106, s52
    v_perm_b32 v76, v108, v104, s53
    v_perm_b32 v92, v110, v106, s53
    v_perm_b32 v80, v109, v105, s52
    v_perm_b32 v96, v111, v107, s52
    v_perm_b32 v84, v109, v105, s53
    v_perm_b32 v100, v111, v107, s53
    s_waitcnt vmcnt(4)
    s_nop 0
    v_perm_b32 v73, v116, v112, s52
    v_perm_b32 v89, v118, v114, s52
    v_perm_b32 v77, v116, v112, s53
    v_perm_b32 v93, v118, v114, s53
    v_perm_b32 v81, v117, v113, s52
    v_perm_b32 v97, v119, v115, s52
    v_perm_b32 v85, v117, v113, s53
    v_perm_b32 v101, v119, v115, s53
    s_waitcnt vmcnt(2)
    s_nop 0
    v_perm_b32 v74, v124, v120, s52
    v_perm_b32 v90, v126, v122, s52
    v_perm_b32 v78, v124, v120, s53
    v_perm_b32 v94, v126, v122, s53
    v_perm_b32 v82, v125, v121, s52
    v_perm_b32 v98, v127, v123, s52
    v_perm_b32 v86, v125, v121, s53
    v_perm_b32 v102, v127, v123, s53
    s_waitcnt vmcnt(0)
    s_add_u32 s79, s78, 0
    buffer_load_dwordx4 v[16:19], v160, s[80:83], s79 offen nt
    s_add_u32 s79, s78, 16384
    buffer_load_dwordx4 v[20:23], v160, s[80:83], s79 offen nt
    s_add_u32 s79, s78, 32768
    buffer_load_dwordx4 v[24:27], v160, s[80:83], s79 offen nt
    s_add_u32 s79, s78, 49152
    buffer_load_dwordx4 v[28:31], v160, s[80:83], s79 offen nt
    s_add_u32 s79, s78, 8192
    buffer_load_dwordx4 v[144:147], v160, s[80:83], s79 offen nt
    s_add_u32 s79, s78, 24576
    buffer_load_dwordx4 v[148:151], v160, s[80:83], s79 offen nt
    s_add_u32 s79, s78, 40960
    buffer_load_dwordx4 v[152:155], v160, s[80:83], s79 offen nt
    s_add_u32 s79, s78, 57344
    buffer_load_dwordx4 v[156:159], v160, s[80:83], s79 offen nt
    v_perm_b32 v75, v132, v128, s52
    v_perm_b32 v91, v134, v130, s52
    v_perm_b32 v79, v132, v128, s53
    v_perm_b32 v95, v134, v130, s53
    v_perm_b32 v83, v133, v129, s52
    v_perm_b32 v99, v135, v131, s52
    v_perm_b32 v87, v133, v129, s53
    v_perm_b32 v103, v135, v131, s53
    v_mfma_f32_16x16x32_bf16 v[32:35], v[72:75], v[56:59], v[32:35]
    v_mfma_f32_16x16x32_bf16 v[32:35], v[88:91], v[60:63], v[32:35]
    v_mfma_f32_16x16x32_bf16 v[36:39], v[76:79], v[56:59], v[36:39]
    v_mfma_f32_16x16x32_bf16 v[36:39], v[92:95], v[60:63], v[36:39]
    v_mfma_f32_16x16x32_bf16 v[40:43], v[80:83], v[56:59], v[40:43]
    v_mfma_f32_16x16x32_bf16 v[40:43], v[96:99], v[60:63], v[40:43]
    v_mfma_f32_16x16x32_bf16 v[44:47], v[84:87], v[56:59], v[44:47]
    v_mfma_f32_16x16x32_bf16 v[44:47], v[100:103], v[60:63], v[44:47]
    s_nop 1
    ds_write_b128 v164, v[32:35] offset:0
    s_nop 0
    ds_write_b128 v164, v[36:39] offset:128
    s_nop 0
    ds_write_b128 v164, v[40:43] offset:256
    s_nop 0
    ds_write_b128 v164, v[44:47] offset:384
    v_mov_b32 v4, 1
    s_mov_b64 exec, 1
    ds_write_b32 v10, v4 offset:16
    s_mov_b64 exec, -1
    s_mul_i32 s44, s86, 64
    s_add_u32 s44, s44, 241664
    ds_read_b32 v12, v13
FW_46:
    s_waitcnt lgkmcnt(0)
    v_cmp_gt_u32 vcc, 1, v12
    s_cbranch_vccz FO_47
    s_sleep 1
    ds_read_b32 v12, v13
    s_branch FW_46
FO_47:
    ds_read_b128 v[72:75], v165 offset:0
    ds_read_b128 v[76:79], v165 offset:4096
    ds_read_b128 v[80:83], v165 offset:8192
    ds_read_b128 v[84:87], v165 offset:12288
    s_waitcnt lgkmcnt(2)
    v_add_f32 v72, v72, v76
    v_add_f32 v73, v73, v77
    v_add_f32 v74, v74, v78
    v_add_f32 v75, v75, v79
    s_waitcnt lgkmcnt(0)
    v_add_f32 v80, v80, v84
    v_add_f32 v81, v81, v85
    v_add_f32 v82, v82, v86
    v_add_f32 v83, v83, v87
    v_add_f32 v72, v72, v80
    v_add_f32 v73, v73, v81
    v_add_f32 v74, v74, v82
    v_add_f32 v75, v75, v83
    v_max_u32 v72, 1, v72
    v_max_u32 v74, 1, v74
    buffer_store_dwordx4 v[72:75], v2, s[12:15], s77 offen sc0 sc1
    s_mov_b64 exec, 1
    buffer_atomic_add v4, v8, s[24:27], s44 offen
    s_mov_b64 exec, -1
    v_mov_b32 v12, 2
    s_mov_b64 exec, 1
    ds_write_b32 v10, v12 offset:16
    s_mov_b64 exec, -1
    s_add_u32 s56, s44, 0x800000
    s_add_u32 s56, s72, s56
    s_addc_u32 s57, s73, 0
    s_lshl_b32 s38, s86, 10
    v_add_u32 v13, 48, v13
    v_mov_b32 v64, 0
    v_mov_b32 v65, 0
    v_mov_b32 v66, 0
    v_mov_b32 v67, 0
    v_mov_b32 v68, 0
    v_mov_b32 v69, 0
    v_mov_b32 v70, 0
    v_mov_b32 v71, 0
F_out:
    s_mov_b32 s80, s68
    s_mov_b32 s81, s69
    s_mov_b32 s82, 0x400000
    s_mov_b32 s83, 0x00020000
    s_lshl_b32 s46, s3, 2
    v_add_u32 v32, s46, v5
    v_lshlrev_b32 v14, 4, v7
    v_mul_u32_u24 v33, 272, v32
    v_add3_u32 v15, v14, v33, 0
    v_lshl_add_u32 v14, v32, 11, v14
    s_lshl_b32 s78, s28, 17
    s_lshl_b32 s79, s29, 8
    s_add_u32 s78, s78, s79
    s_lshl_b32 s47, s28, 6
    s_add_u32 s47, s47, s46
    s_sub_u32 s47, 2047, s47
    s_mov_b32 s77, 0
    v_mov_b32 v136, 0
    v_mov_b32 v137, 0
    v_mov_b32 v138, 0
    v_mov_b32 v139, 0
    s_and_b32 s46, s60, 0x7ff
    s_sub_u32 s46, s47, s46
    s_and_b32 s45, s46, 0xffffffcc
    s_cbranch_scc1 SD_48
    s_mov_b32 s77, 1
    s_or_b32 s45, s60, 0x0
    v_mov_b32 v33, s45
    v_cmp_eq_u32 vcc, s46, v5
    s_sub_u32 s46, s46, 16
    s_nop 0
    v_cndmask_b32 v136, v136, v33, vcc
    v_cmp_eq_u32 vcc, s46, v5
    s_sub_u32 s46, s46, 16
    s_nop 0
    v_cndmask_b32 v137, v137, v33, vcc
    v_cmp_eq_u32 vcc, s46, v5
    s_sub_u32 s46, s46, 16
    s_nop 0
    v_cndmask_b32 v138, v138, v33, vcc
    v_cmp_eq_u32 vcc, s46, v5
    s_sub_u32 s46, s46, 16
    s_nop 0
    v_cndmask_b32 v139, v139, v33, vcc
SD_48:
    s_and_b32 s46, s61, 0x7ff
    s_sub_u32 s46, s47, s46
    s_and_b32 s45, s46, 0xffffffcc
    s_cbranch_scc1 SD_49
    s_mov_b32 s77, 1
    s_or_b32 s45, s61, 0x2000
    v_mov_b32 v33, s45
    v_cmp_eq_u32 vcc, s46, v5
    s_sub_u32 s46, s46, 16
    s_nop 0
    v_cndmask_b32 v136, v136, v33, vcc
    v_cmp_eq_u32 vcc, s46, v5
    s_sub_u32 s46, s46, 16
    s_nop 0
    v_cndmask_b32 v137, v137, v33, vcc
    v_cmp_eq_u32 vcc, s46, v5
    s_sub_u32 s46, s46, 16
    s_nop 0
    v_cndmask_b32 v138, v138, v33, vcc
    v_cmp_eq_u32 vcc, s46, v5
    s_sub_u32 s46, s46, 16
    s_nop 0
    v_cndmask_b32 v139, v139, v33, vcc
SD_49:
    s_and_b32 s46, s62, 0x7ff
    s_sub_u32 s46, s47, s46
    s_and_b32 s45, s46, 0xffffffcc
    s_cbranch_scc1 SD_50
    s_mov_b32 s77, 1
    s_or_b32 s45, s62, 0x4000
    v_mov_b32 v33, s45
    v_cmp_eq_u32 vcc, s46, v5
    s_sub_u32 s46, s46, 16
W_8:
    s_cbranch_execz R_8
    s_nop 0
    s_nop 0
    v_cndmask_b32 v136, v136, v33, vcc
    v_cmp_eq_u32 vcc, s46, v5
    s_sub_u32 s46, s46, 16
    s_nop 0
    v_cndmask_b32 v137, v137, v33, vcc
    v_cmp_eq_u32 vcc, s46, v5
    s_sub_u32 s46, s46, 16
    s_nop 0
    v_cndmask_b32 v138, v138, v33, vcc
    v_cmp_eq_u32 vcc, s46, v5
    s_sub_u32 s46, s46, 16
    s_nop 0
    v_cndmask_b32 v139, v139, v33, vcc
SD_50:
    s_and_b32 s46, s63, 0x7ff
    s_sub_u32 s46, s47, s46
    s_and_b32 s45, s46, 0xffffffcc
    s_cbranch_scc1 SD_51
    s_mov_b32 s77, 1
    s_or_b32 s45, s63, 0x6000
    v_mov_b32 v33, s45
    v_cmp_eq_u32 vcc, s46, v5
    s_sub_u32 s46, s46, 16
    s_nop 0
    v_cndmask_b32 v136, v136, v33, vcc
    v_cmp_eq_u32 vcc, s46, v5
    s_sub_u32 s46, s46, 16
    s_nop 0
    v_cndmask_b32 v137, v137, v33, vcc
    v_cmp_eq_u32 vcc, s46, v5
    s_sub_u32 s46, s46, 16
    s_nop 0
    v_cndmask_b32 v138, v138, v33, vcc
    v_cmp_eq_u32 vcc, s46, v5
    s_sub_u32 s46, s46, 16
    s_nop 0
    v_cndmask_b32 v139, v139, v33, vcc
SD_51:
    s_and_b32 s46, s64, 0x7ff
    s_sub_u32 s46, s47, s46
    s_and_b32 s45, s46, 0xffffffcc
    s_cbranch_scc1 SD_52
    s_mov_b32 s77, 1
    s_or_b32 s45, s64, 0x800
    v_mov_b32 v33, s45
    v_cmp_eq_u32 vcc, s46, v5
    s_sub_u32 s46, s46, 16
    s_nop 0
    v_cndmask_b32 v136, v136, v33, vcc
    v_cmp_eq_u32 vcc, s46, v5
    s_sub_u32 s46, s46, 16
    s_nop 0
    v_cndmask_b32 v137, v137, v33, vcc
    v_cmp_eq_u32 vcc, s46, v5
    s_sub_u32 s46, s46, 16
    s_nop 0
    v_cndmask_b32 v138, v138, v33, vcc
    v_cmp_eq_u32 vcc, s46, v5
    s_sub_u32 s46, s46, 16
    s_nop 0
    v_cndmask_b32 v139, v139, v33, vcc
SD_52:
    s_and_b32 s46, s65, 0x7ff
    s_sub_u32 s46, s47, s46
    s_and_b32 s45, s46, 0xffffffcc
    s_cbranch_scc1 SD_53
    s_mov_b32 s77, 1
    s_or_b32 s45, s65, 0x2800
    v_mov_b32 v33, s45
    v_cmp_eq_u32 vcc, s46, v5
    s_sub_u32 s46, s46, 16
    s_nop 0
    v_cndmask_b32 v136, v136, v33, vcc
    v_cmp_eq_u32 vcc, s46, v5
    s_sub_u32 s46, s46, 16
    s_nop 0
    v_cndmask_b32 v137, v137, v33, vcc
    v_cmp_eq_u32 vcc, s46, v5
    s_sub_u32 s46, s46, 16
    s_nop 0
    v_cndmask_b32 v138, v138, v33, vcc
    v_cmp_eq_u32 vcc, s46, v5
    s_sub_u32 s46, s46, 16
    s_nop 0
    v_cndmask_b32 v139, v139, v33, vcc
SD_53:
    s_and_b32 s46, s66, 0x7ff
    s_sub_u32 s46, s47, s46
    s_and_b32 s45, s46, 0xffffffcc
    s_cbranch_scc1 SD_54
    s_mov_b32 s77, 1
    s_or_b32 s45, s66, 0x4800
    v_mov_b32 v33, s45
    v_cmp_eq_u32 vcc, s46, v5
    s_sub_u32 s46, s46, 16
    s_nop 0
    v_cndmask_b32 v136, v136, v33, vcc
    v_cmp_eq_u32 vcc, s46, v5
    s_sub_u32 s46, s46, 16
    s_nop 0
    v_cndmask_b32 v137, v137, v33, vcc
    v_cmp_eq_u32 vcc, s46, v5
    s_sub_u32 s46, s46, 16
    s_nop 0
    v_cndmask_b32 v138, v138, v33, vcc
    v_cmp_eq_u32 vcc, s46, v5
    s_sub_u32 s46, s46, 16
    s_nop 0
    v_cndmask_b32 v139, v139, v33, vcc
SD_54:
    s_and_b32 s46, s67, 0x7ff
    s_sub_u32 s46, s47, s46
    s_and_b32 s45, s46, 0xffffffcc
    s_cbranch_scc1 SD_55
    s_mov_b32 s77, 1
    s_or_b32 s45, s67, 0x6800
    v_mov_b32 v33, s45
    v_cmp_eq_u32 vcc, s46, v5
    s_sub_u32 s46, s46, 16
    s_nop 0
    v_cndmask_b32 v136, v136, v33, vcc
    v_cmp_eq_u32 vcc, s46, v5
    s_sub_u32 s46, s46, 16
    s_nop 0
    v_cndmask_b32 v137, v137, v33, vcc
    v_cmp_eq_u32 vcc, s46, v5
    s_sub_u32 s46, s46, 16
    s_nop 0
    v_cndmask_b32 v138, v138, v33, vcc
    v_cmp_eq_u32 vcc, s46, v5
    s_sub_u32 s46, s46, 16
    s_nop 0
    v_cndmask_b32 v139, v139, v33, vcc
SD_55:
    s_cmp_eq_u32 s77, 0
    s_cbranch_scc1 F_ys1
    v_lshlrev_b32 v34, 2, v7
    v_cmp_ne_u32 s[60:61], 0, v136
    v_and_b32 v140, 0xffff0000, v136
    v_ashrrev_i32 v33, 31, v140
    v_not_b32 v33, v33
    v_or_b32 v33, 0x80000000, v33
    v_xor_b32 v140, v140, v33
    v_and_b32 v140, 0xffff0000, v140
    v_mul_f32 v140, s48, v140
    v_exp_f32 v140, v140
    s_nop 0
    v_add_f32 v140, 1.0, v140
    v_rcp_f32 v140, v140
    s_nop 0
    v_cvt_pk_bf16_f32 v140, v140, v140
    v_lshlrev_b32 v140, 16, v140
    v_bfe_u32 v136, v136, 11, 4
    v_lshl_add_u32 v136, v136, 6, v34
    v_cmp_ne_u32 s[62:63], 0, v137
    v_and_b32 v141, 0xffff0000, v137
    v_ashrrev_i32 v33, 31, v141
    v_not_b32 v33, v33
    v_or_b32 v33, 0x80000000, v33
    v_xor_b32 v141, v141, v33
    v_and_b32 v141, 0xffff0000, v141
    v_mul_f32 v141, s48, v141
    v_exp_f32 v141, v141
    s_nop 0
    v_add_f32 v141, 1.0, v141
    v_rcp_f32 v141, v141
    s_nop 0
    v_cvt_pk_bf16_f32 v141, v141, v141
    v_lshlrev_b32 v141, 16, v141
    v_bfe_u32 v137, v137, 11, 4
    v_lshl_add_u32 v137, v137, 6, v34
    v_cmp_ne_u32 s[64:65], 0, v138
    v_and_b32 v142, 0xffff0000, v138
    v_ashrrev_i32 v33, 31, v142
    v_not_b32 v33, v33
    v_or_b32 v33, 0x80000000, v33
    v_xor_b32 v142, v142, v33
    v_and_b32 v142, 0xffff0000, v142
    v_mul_f32 v142, s48, v142
    v_exp_f32 v142, v142
    s_nop 0
    v_add_f32 v142, 1.0, v142
    v_rcp_f32 v142, v142
    s_nop 0
    v_cvt_pk_bf16_f32 v142, v142, v142
    v_lshlrev_b32 v142, 16, v142
    v_bfe_u32 v138, v138, 11, 4
    v_lshl_add_u32 v138, v138, 6, v34
    v_cmp_ne_u32 s[66:67], 0, v139
    v_and_b32 v143, 0xffff0000, v139
    v_ashrrev_i32 v33, 31, v143
    v_not_b32 v33, v33
    v_or_b32 v33, 0x80000000, v33
    v_xor_b32 v143, v143, v33
    v_and_b32 v143, 0xffff0000, v143
    v_mul_f32 v143, s48, v143
    v_exp_f32 v143, v143
    s_nop 0
    v_add_f32 v143, 1.0, v143
    v_rcp_f32 v143, v143
    s_nop 0
    v_cvt_pk_bf16_f32 v143, v143, v143
    v_lshlrev_b32 v143, 16, v143
    v_bfe_u32 v139, v139, 11, 4
    v_lshl_add_u32 v139, v139, 6, v34
F_ys1:
    s_lshl_b32 s45, s29, 7
    s_add_u32 s84, s45, 0x82a000
    s_add_u32 s84, s72, s84
    s_addc_u32 s85, s73, 0
    s_lshl_b32 s50, s29, 12
    s_add_u32 s50, s50, 135168
    s_cmp_ge_u32 s11, 224
    s_cbranch_scc1 F_ynd
    ds_read_b32 v12, v163
FW_56:
    s_waitcnt lgkmcnt(0)
    v_cmp_gt_u32_e64 vcc, 3, v12
    s_cbranch_vccz FO_57
    s_sleep 2
    ds_read_b32 v12, v163
    s_branch FW_56
FO_57:
SP_58:
    s_load_dword s74, s[56:57], 0 glc
    s_waitcnt lgkmcnt(0)
    s_cmp_ge_u32 s74, 8
    s_cbranch_scc1 SD_59
    s_sleep 8
    s_branch SP_58
SD_59:
    s_add_u32 s45, s38, 0
    buffer_load_dwordx4 v[32:35], v11, s[12:15], s45 offen offset:0 sc0 sc1
    buffer_load_dwordx4 v[36:39], v11, s[12:15], s45 offen offset:512 sc0 sc1
    s_add_u32 s45, s38, 229376
    buffer_load_dwordx4 v[40:43], v11, s[12:15], s45 offen offset:0 sc0 sc1
    buffer_load_dwordx4 v[44:47], v11, s[12:15], s45 offen offset:512 sc0 sc1
    s_add_u32 s45, s38, 458752
    buffer_load_dwordx4 v[48:51], v11, s[12:15], s45 offen offset:0 sc0 sc1
    buffer_load_dwordx4 v[52:55], v11, s[12:15], s45 offen offset:512 sc0 sc1
    s_add_u32 s45, s38, 688128
    buffer_load_dwordx4 v[56:59], v11, s[12:15], s45 offen offset:0 sc0 sc1
    buffer_load_dwordx4 v[60:63], v11, s[12:15], s45 offen offset:512 sc0 sc1
    s_lshl_b32 s45, s87, 7
    s_add_u32 s58, s45, 0x82a000
    s_add_u32 s58, s72, s58
    s_addc_u32 s59, s73, 0
    s_lshl_b32 s44, s87, 2
    s_add_u32 s44, s44, s3
    s_lshl_b32 s44, s44, 10
    s_add_u32 s44, s44, 135168
    s_waitcnt vmcnt(10)
    s_nop 0
    v_perm_b32 v104, v20, v16, s52
    v_perm_b32 v105, v28, v24, s52
    v_perm_b32 v106, v148, v144, s52
    v_perm_b32 v107, v156, v152, s52
    v_perm_b32 v108, v20, v16, s53
    v_perm_b32 v109, v28, v24, s53
    v_perm_b32 v110, v148, v144, s53
    v_perm_b32 v111, v156, v152, s53
    v_perm_b32 v112, v21, v17, s52
    v_perm_b32 v113, v29, v25, s52
    v_perm_b32 v114, v149, v145, s52
    v_perm_b32 v115, v157, v153, s52
    v_perm_b32 v116, v21, v17, s53
    v_perm_b32 v117, v29, v25, s53
    v_perm_b32 v118, v149, v145, s53
    v_perm_b32 v119, v157, v153, s53
    v_perm_b32 v120, v22, v18, s52
    v_perm_b32 v121, v30, v26, s52
    v_perm_b32 v122, v150, v146, s52
    v_perm_b32 v123, v158, v154, s52
    v_perm_b32 v124, v22, v18, s53
    v_perm_b32 v125, v30, v26, s53
    v_perm_b32 v126, v150, v146, s53
    v_perm_b32 v127, v158, v154, s53
    v_perm_b32 v128, v23, v19, s52
    v_perm_b32 v129, v31, v27, s52
    v_perm_b32 v130, v151, v147, s52
    v_perm_b32 v131, v159, v155, s52
    v_perm_b32 v132, v23, v19, s53
    v_perm_b32 v133, v31, v27, s53
    v_perm_b32 v134, v151, v147, s53
    v_perm_b32 v135, v159, v155, s53
F_dl:
    s_waitcnt vmcnt(4)
    v_min3_u32 v12, v32, v34, v36
    v_min3_u32 v12, v12, v38, v40
    v_min3_u32 v12, v12, v42, v44
    v_min_u32 v12, v12, v46
    v_add_f32 v32, v32, v40
    v_add_f32 v33, v33, v41
    v_add_f32 v34, v34, v42
    v_add_f32 v35, v35, v43
    v_add_f32 v36, v36, v44
    v_add_f32 v37, v37, v45
    v_add_f32 v38, v38, v46
    v_add_f32 v39, v39, v47
    s_waitcnt vmcnt(0)
    v_min3_u32 v12, v12, v48, v50
    v_min3_u32 v12, v12, v52, v54
    v_min3_u32 v12, v12, v56, v58
    v_min3_u32 v12, v12, v60, v62
    v_cmp_eq_u32 vcc, 0, v12
    v_add_f32 v48, v48, v56
    v_add_f32 v49, v49, v57
    v_add_f32 v50, v50, v58
    v_add_f32 v51, v51, v59
    v_add_f32 v52, v52, v60
    v_add_f32 v53, v53, v61
    v_add_f32 v54, v54, v62
    v_add_f32_e64 v55, v55, v63
    s_cbranch_vccz F_dm
    s_sleep 6
    s_add_u32 s45, s38, 0
    buffer_load_dwordx4 v[32:35], v11, s[12:15], s45 offen offset:0 sc0 sc1
    buffer_load_dwordx4 v[36:39], v11, s[12:15], s45 offen offset:512 sc0 sc1
    s_add_u32 s45, s38, 229376
    buffer_load_dwordx4 v[40:43], v11, s[12:15], s45 offen offset:0 sc0 sc1
    buffer_load_dwordx4 v[44:47], v11, s[12:15], s45 offen offset:512 sc0 sc1
    s_add_u32 s45, s38, 458752
    buffer_load_dwordx4 v[48:51], v11, s[12:15], s45 offen offset:0 sc0 sc1
    buffer_load_dwordx4 v[52:55], v11, s[12:15], s45 offen offset:512 sc0 sc1
    s_add_u32 s45, s38, 688128
    buffer_load_dwordx4 v[56:59], v11, s[12:15], s45 offen offset:0 sc0 sc1
    buffer_load_dwordx4 v[60:63], v11, s[12:15], s45 offen offset:512 sc0 sc1
    s_branch F_dl
F_dm:
    v_add_f32 v32, v32, v48
    v_add_f32 v33, v33, v49
    v_add_f32 v34, v34, v50
    v_add_f32 v35, v35, v51
    v_add_f32 v36, v36, v52
    v_add_f32 v37, v37, v53
    v_add_f32 v38, v38, v54
    v_add_f32_e64 v39, v39, v55
    v_cvt_pk_bf16_f32 v40, v32, v33
    v_cvt_pk_bf16_f32 v41, v34, v35
    v_cvt_pk_bf16_f32 v42, v36, v37
    v_cvt_pk_bf16_f32 v43, v38, v39
    v_cvt_pk_bf16_f32 v44, v32, v33
    v_cvt_pk_bf16_f32 v45, v34, v35
    v_mov_b32_dpp v40, v42 row_ror:8 row_mask:0xf bank_mask:0xc
    v_mov_b32_dpp v41, v43 row_ror:8 row_mask:0xf bank_mask:0xc
    v_mov_b32_dpp v42, v44 row_ror:8 row_mask:0xf bank_mask:0x3
    v_mov_b32_dpp v43, v45 row_ror:8 row_mask:0xf bank_mask:0x3
    v_lshlrev_b32 v48, 16, v40
    v_and_b32 v49, 0xffff0000, v40
    v_lshlrev_b32 v50, 16, v41
    v_and_b32 v51, 0xffff0000, v41
    v_lshlrev_b32 v52, 16, v42
    v_and_b32 v53, 0xffff0000, v42
    v_lshlrev_b32 v54, 16, v43
    v_and_b32 v55, 0xffff0000, v43
    v_mul_f32 v56, s48, v48
    v_mul_f32 v57, s48, v49
    v_mul_f32 v58, s48, v50
    v_mul_f32 v59, s48, v51
    v_exp_f32 v56, v56
    v_exp_f32 v57, v57
    v_exp_f32 v58, v58
    v_exp_f32 v59, v59
    v_add_f32 v56, 1.0, v56
    v_add_f32 v57, 1.0, v57
    v_add_f32 v58, 1.0, v58
    v_add_f32 v59, 1.0, v59
    v_rcp_f32 v56, v56
    v_rcp_f32 v57, v57
    v_rcp_f32 v58, v58
    v_rcp_f32 v59, v59
    v_mul_f32 v48, v48, v56
    v_mul_f32 v49, v49, v57
    v_mul_f32 v50, v50, v58
    v_mul_f32 v51, v51, v59
    v_cvt_pk_bf16_f32 v56, v48, v49
    v_cvt_pk_bf16_f32 v57, v50, v51
    v_lshlrev_b32 v48, 16, v56
    v_and_b32 v49, 0xffff0000, v56
    v_lshlrev_b32 v50, 16, v57
    v_and_b32 v51, 0xffff0000, v57
    v_mul_f32 v48, v48, v52
    v_mul_f32 v49, v49, v53
    v_mul_f32 v50, v50, v54
    v_mul_f32_e64 v51, v51, v55
    v_cvt_pk_bf16_f32 v56, v48, v49
    v_cvt_pk_bf16_f32 v57, v50, v51
    s_nop 0
    v_mov_b32_dpp v64, v56 quad_perm:[0,1,2,3] row_mask:0xf bank_mask:0x3
    v_mov_b32_dpp v65, v57 quad_perm:[0,1,2,3] row_mask:0xf bank_mask:0x3
    v_mov_b32_dpp v66, v56 row_ror:8 row_mask:0xf bank_mask:0x3
    v_mov_b32_dpp v67, v57 row_ror:8 row_mask:0xf bank_mask:0x3
    v_mov_b32_dpp v68, v56 row_ror:8 row_mask:0xf bank_mask:0xc
    v_mov_b32_dpp v69, v57 row_ror:8 row_mask:0xf bank_mask:0xc
    v_mov_b32_dpp v70, v56 quad_perm:[0,1,2,3] row_mask:0xf bank_mask:0xc
    v_mov_b32_dpp v71, v57 quad_perm:[0,1,2,3] row_mask:0xf bank_mask:0xc
    v_mfma_f32_16x16x32_bf16 v[72:75], v[64:67], v[104:107], 0
    s_nop 0
    v_mfma_f32_16x16x32_bf16 v[72:75], v[68:71], v[120:123], v[72:75]
    v_mfma_f32_16x16x32_bf16 v[76:79], v[64:67], v[108:111], 0
    v_mfma_f32_16x16x32_bf16 v[76:79], v[68:71], v[124:127], v[76:79]
    v_mfma_f32_16x16x32_bf16 v[80:83], v[64:67], v[112:115], 0
    v_mfma_f32_16x16x32_bf16 v[80:83], v[68:71], v[128:131], v[80:83]
    v_mfma_f32_16x16x32_bf16 v[84:87], v[64:67], v[116:119], 0
    v_mfma_f32_16x16x32_bf16 v[84:87], v[68:71], v[132:135], v[84:87]
    s_nop 1
    ds_write_b128 v161, v[72:75] offset:0
    s_nop 0
    ds_write_b128 v161, v[76:79] offset:1024
    s_nop 0
    ds_write_b128 v161, v[80:83] offset:2048
    s_nop 0
    ds_write_b128 v161, v[84:87] offset:3072
    v_mov_b32 v4, 1
    s_mov_b64 exec, 1
    ds_write_b32 v10, v4 offset:64
    s_mov_b64 exec, -1
    ds_read_b32 v12, v13
FW_60:
    s_waitcnt lgkmcnt(0)
    v_cmp_gt_u32 vcc, 1, v12
    s_cbranch_vccz FO_61
    s_sleep 1
    ds_read_b32 v12, v13
    s_branch FW_60
FO_61:
    ds_read_b128 v[48:51], v167 offset:0
    ds_read_b128 v[52:55], v167 offset:4096
    ds_read_b128 v[56:59], v167 offset:24576
    ds_read_b128 v[60:63], v167 offset:28672
    s_waitcnt lgkmcnt(2)
    v_add_f32 v48, v48, v52
    v_add_f32 v49, v49, v53
    v_add_f32 v50, v50, v54
    v_add_f32 v51, v51, v55
    s_waitcnt lgkmcnt(0)
    v_add_f32 v56, v56, v60
    v_add_f32 v48, v48, v56
    buffer_atomic_add_f32 v48, v3, s[24:27], s44 offen offset:0
    v_add_f32 v57, v57, v61
    v_add_f32 v49, v49, v57
    buffer_atomic_add_f32 v49, v3, s[24:27], s44 offen offset:256
    v_add_f32 v58, v58, v62
    v_add_f32 v50, v50, v58
    buffer_atomic_add_f32 v50, v3, s[24:27], s44 offen offset:512
    v_add_f32 v59, v59, v63
    v_add_f32 v51, v51, v59
    buffer_atomic_add_f32 v51, v3, s[24:27], s44 offen offset:768
F_ynd:
    s_barrier
    s_barrier
    s_barrier
    s_barrier
    s_waitcnt vmcnt(0)
    s_barrier
    s_cmp_lg_u32 s3, 0
    s_cbranch_scc1 F_y0
    s_cmp_ge_u32 s11, 224
    s_cbranch_scc1 F_y0
    s_mov_b32 s76, 1
    s_atomic_add s76, s[58:59], 0
F_y0:
    s_barrier
    s_barrier
    s_barrier
    s_barrier
    s_cmp_lg_u32 s77, 0
    s_cbranch_scc1 F_y1
    s_barrier
    s_barrier
    s_barrier
    s_barrier
    s_barrier
    s_barrier
F_y3:
    s_waitcnt lgkmcnt(0)
    s_setprio 3
    s_barrier
    ds_read_b128 v[16:19], v15 offset:0
    s_cmp_lg_u32 s77, 0
    s_waitcnt lgkmcnt(0)
    s_cbranch_scc1 F_ya0
F_yb0:
    buffer_store_dwordx4 v[16:19], v14, s[80:83], s78 offen sc1
    s_add_u32 s78, s78, 32768
    s_barrier
    ds_read_b128 v[20:23], v15 offset:4352
    s_cmp_lg_u32 s77, 0
    s_waitcnt lgkmcnt(0)
    s_cbranch_scc1 F_ya1
F_yb1:
    buffer_store_dwordx4 v[20:23], v14, s[80:83], s78 offen sc1
    s_add_u32 s78, s78, 32768
    s_barrier
    ds_read_b128 v[24:27], v15 offset:8704
    ds_read_b128 v[28:31], v15 offset:13056
    s_cmp_lg_u32 s77, 0
    s_waitcnt lgkmcnt(1)
    s_cbranch_scc1 F_ya2
F_yb2:
    buffer_store_dwordx4 v[24:27], v14, s[80:83], s78 offen sc1
    s_add_u32 s78, s78, 32768
    s_cmp_lg_u32 s77, 0
    s_waitcnt lgkmcnt(0)
    s_cbranch_scc1 F_ya3
F_yb3:
    buffer_store_dwordx4 v[28:31], v14, s[80:83], s78 offen sc1
    s_add_u32 s78, s78, 32768
    s_endpgm
F_y1:
    s_load_dword s74, s[84:85], 0 glc
    s_barrier
    s_barrier
    s_waitcnt lgkmcnt(0)
    s_cmp_lt_u32 s74, 28
    s_cbranch_scc1 F_y2
    s_mov_b64 exec, s[60:61]
    s_cbranch_execz YL_62
    buffer_load_dword v72, v136, s[24:27], s50 offen offset:0 sc0 sc1
    buffer_load_dword v73, v136, s[24:27], s50 offen offset:1024 sc0 sc1
    buffer_load_dword v74, v136, s[24:27], s50 offen offset:2048 sc0 sc1
    buffer_load_dword v75, v136, s[24:27], s50 offen offset:3072 sc0 sc1
    buffer_load_dword v76, v136, s[24:27], s50 offen offset:128 sc0 sc1
    buffer_load_dword v77, v136, s[24:27], s50 offen offset:1152 sc0 sc1
    buffer_load_dword v78, v136, s[24:27], s50 offen offset:2176 sc0 sc1
    buffer_load_dword v79, v136, s[24:27], s50 offen offset:3200 sc0 sc1
YL_62:
    s_mov_b64 exec, s[62:63]
    s_cbranch_execz YL_63
    buffer_load_dword v80, v137, s[24:27], s50 offen offset:0 sc0 sc1
    buffer_load_dword v81, v137, s[24:27], s50 offen offset:1024 sc0 sc1
    buffer_load_dword v82, v137, s[24:27], s50 offen offset:2048 sc0 sc1
    buffer_load_dword v83, v137, s[24:27], s50 offen offset:3072 sc0 sc1
    buffer_load_dword v84, v137, s[24:27], s50 offen offset:128 sc0 sc1
    buffer_load_dword v85, v137, s[24:27], s50 offen offset:1152 sc0 sc1
    buffer_load_dword v86, v137, s[24:27], s50 offen offset:2176 sc0 sc1
    buffer_load_dword v87, v137, s[24:27], s50 offen offset:3200 sc0 sc1
YL_63:
    s_mov_b64 exec, s[64:65]
    s_cbranch_execz YL_64
    buffer_load_dword v88, v138, s[24:27], s50 offen offset:0 sc0 sc1
    buffer_load_dword v89, v138, s[24:27], s50 offen offset:1024 sc0 sc1
    buffer_load_dword v90, v138, s[24:27], s50 offen offset:2048 sc0 sc1
    buffer_load_dword v91, v138, s[24:27], s50 offen offset:3072 sc0 sc1
    buffer_load_dword v92, v138, s[24:27], s50 offen offset:128 sc0 sc1
    buffer_load_dword v93, v138, s[24:27], s50 offen offset:1152 sc0 sc1
    buffer_load_dword v94, v138, s[24:27], s50 offen offset:2176 sc0 sc1
    buffer_load_dword v95, v138, s[24:27], s50 offen offset:3200 sc0 sc1
YL_64:
    s_mov_b64 exec, s[66:67]
    s_cbranch_execz YL_65
    buffer_load_dword v96, v139, s[24:27], s50 offen offset:0 sc0 sc1
    buffer_load_dword v97, v139, s[24:27], s50 offen offset:1024 sc0 sc1
    buffer_load_dword v98, v139, s[24:27], s50 offen offset:2048 sc0 sc1
    buffer_load_dword v99, v139, s[24:27], s50 offen offset:3072 sc0 sc1
    buffer_load_dword v100, v139, s[24:27], s50 offen offset:128 sc0 sc1
    buffer_load_dword v101, v139, s[24:27], s50 offen offset:1152 sc0 sc1
    buffer_load_dword v102, v139, s[24:27], s50 offen offset:2176 sc0 sc1
    buffer_load_dword v103, v139, s[24:27], s50 offen offset:3200 sc0 sc1
YL_65:
    s_mov_b64 exec, -1
    s_barrier
    s_barrier
    s_barrier
    s_barrier
    s_branch F_y3
F_y2:
    s_barrier
    s_barrier
    s_barrier
    s_barrier
SP_66:
    s_load_dword s74, s[84:85], 0 glc
    s_waitcnt lgkmcnt(0)
    s_cmp_ge_u32 s74, 28
    s_cbranch_scc1 SD_67
    s_sleep 2
    s_branch SP_66
SD_67:
    s_mov_b64 exec, s[60:61]
    s_cbranch_execz YL_68
    s_nop 0
    buffer_load_dword v72, v136, s[24:27], s50 offen offset:0 sc0 sc1
    buffer_load_dword v73, v136, s[24:27], s50 offen offset:1024 sc0 sc1
    buffer_load_dword v74, v136, s[24:27], s50 offen offset:2048 sc0 sc1
    buffer_load_dword v75, v136, s[24:27], s50 offen offset:3072 sc0 sc1
    buffer_load_dword v76, v136, s[24:27], s50 offen offset:128 sc0 sc1
    buffer_load_dword v77, v136, s[24:27], s50 offen offset:1152 sc0 sc1
    buffer_load_dword v78, v136, s[24:27], s50 offen offset:2176 sc0 sc1
    buffer_load_dword v79, v136, s[24:27], s50 offen offset:3200 sc0 sc1
YL_68:
    s_mov_b64 exec, s[62:63]
    s_cbranch_execz YL_69
    buffer_load_dword v80, v137, s[24:27], s50 offen offset:0 sc0 sc1
    buffer_load_dword v81, v137, s[24:27], s50 offen offset:1024 sc0 sc1
    buffer_load_dword v82, v137, s[24:27], s50 offen offset:2048 sc0 sc1
    buffer_load_dword v83, v137, s[24:27], s50 offen offset:3072 sc0 sc1
    buffer_load_dword v84, v137, s[24:27], s50 offen offset:128 sc0 sc1
    buffer_load_dword v85, v137, s[24:27], s50 offen offset:1152 sc0 sc1
    buffer_load_dword v86, v137, s[24:27], s50 offen offset:2176 sc0 sc1
    buffer_load_dword v87, v137, s[24:27], s50 offen offset:3200 sc0 sc1
YL_69:
    s_mov_b64 exec, s[64:65]
    s_cbranch_execz YL_70
    buffer_load_dword v88, v138, s[24:27], s50 offen offset:0 sc0 sc1
    buffer_load_dword v89, v138, s[24:27], s50 offen offset:1024 sc0 sc1
    buffer_load_dword v90, v138, s[24:27], s50 offen offset:2048 sc0 sc1
    buffer_load_dword v91, v138, s[24:27], s50 offen offset:3072 sc0 sc1
    buffer_load_dword v92, v138, s[24:27], s50 offen offset:128 sc0 sc1
    buffer_load_dword v93, v138, s[24:27], s50 offen offset:1152 sc0 sc1
    buffer_load_dword v94, v138, s[24:27], s50 offen offset:2176 sc0 sc1
    buffer_load_dword v95, v138, s[24:27], s50 offen offset:3200 sc0 sc1
YL_70:
    s_mov_b64 exec, s[66:67]
    s_cbranch_execz YL_71
    buffer_load_dword v96, v139, s[24:27], s50 offen offset:0 sc0 sc1
    buffer_load_dword v97, v139, s[24:27], s50 offen offset:1024 sc0 sc1
    buffer_load_dword v98, v139, s[24:27], s50 offen offset:2048 sc0 sc1
    buffer_load_dword v99, v139, s[24:27], s50 offen offset:3072 sc0 sc1
    buffer_load_dword v100, v139, s[24:27], s50 offen offset:128 sc0 sc1
    buffer_load_dword v101, v139, s[24:27], s50 offen offset:1152 sc0 sc1
    buffer_load_dword v102, v139, s[24:27], s50 offen offset:2176 sc0 sc1
    buffer_load_dword v103, v139, s[24:27], s50 offen offset:3200 sc0 sc1
YL_71:
    s_mov_b64 exec, -1
    s_branch F_y3
F_ya0:
    s_cmp_eq_u64 s[60:61], 0
    s_cbranch_scc1 F_yb0
    s_mov_b64 exec, s[60:61]
    v_lshlrev_b32 v32, 16, v16
    v_and_b32 v33, 0xffff0000, v16
    v_lshlrev_b32 v34, 16, v17
    v_and_b32 v35, 0xffff0000, v17
    v_lshlrev_b32 v36, 16, v18
    v_and_b32 v37, 0xffff0000, v18
    v_lshlrev_b32 v38, 16, v19
    v_and_b32 v39, 0xffff0000, v19
    s_waitcnt vmcnt(0)
    v_fmac_f32 v32, v72, v140
    v_fmac_f32 v33, v73, v140
    v_fmac_f32 v34, v74, v140
    v_fmac_f32 v35, v75, v140
    v_fmac_f32 v36, v76, v140
    v_fmac_f32 v37, v77, v140
    v_fmac_f32 v38, v78, v140
    v_fmac_f32 v39, v79, v140
    v_cvt_pk_bf16_f32 v16, v32, v33
    v_cvt_pk_bf16_f32 v17, v34, v35
    v_cvt_pk_bf16_f32 v18, v36, v37
    v_cvt_pk_bf16_f32 v19, v38, v39
    s_mov_b64 exec, -1
    s_branch F_yb0
F_ya1:
    s_cmp_eq_u64 s[62:63], 0
    s_cbranch_scc1 F_yb1
    s_mov_b64 exec, s[62:63]
    v_lshlrev_b32 v32, 16, v20
    v_and_b32 v33, 0xffff0000, v20
    v_lshlrev_b32 v34, 16, v21
    v_and_b32 v35, 0xffff0000, v21
    v_lshlrev_b32 v36, 16, v22
    v_and_b32 v37, 0xffff0000, v22
    v_lshlrev_b32 v38, 16, v23
    v_and_b32 v39, 0xffff0000, v23
    s_waitcnt vmcnt(1)
    v_fmac_f32 v32, v80, v141
    v_fmac_f32 v33, v81, v141
    v_fmac_f32 v34, v82, v141
    v_fmac_f32 v35, v83, v141
    v_fmac_f32 v36, v84, v141
    v_fmac_f32 v37, v85, v141
    v_fmac_f32 v38, v86, v141
    v_fmac_f32 v39, v87, v141
    v_cvt_pk_bf16_f32 v20, v32, v33
    v_cvt_pk_bf16_f32 v21, v34, v35
    v_cvt_pk_bf16_f32 v22, v36, v37
    v_cvt_pk_bf16_f32 v23, v38, v39
    s_mov_b64 exec, -1
    s_branch F_yb1
F_ya2:
    s_cmp_eq_u64 s[64:65], 0
    s_cbranch_scc1 F_yb2
    s_mov_b64 exec, s[64:65]
    v_lshlrev_b32 v32, 16, v24
    v_and_b32 v33, 0xffff0000, v24
    v_lshlrev_b32 v34, 16, v25
    v_and_b32 v35, 0xffff0000, v25
    v_lshlrev_b32 v36, 16, v26
    v_and_b32 v37, 0xffff0000, v26
    v_lshlrev_b32 v38, 16, v27
    v_and_b32 v39, 0xffff0000, v27
    s_waitcnt vmcnt(2)
    v_fmac_f32 v32, v88, v142
    v_fmac_f32 v33, v89, v142
    v_fmac_f32 v34, v90, v142
    v_fmac_f32 v35, v91, v142
    v_fmac_f32 v36, v92, v142
    v_fmac_f32 v37, v93, v142
    v_fmac_f32 v38, v94, v142
    v_fmac_f32 v39, v95, v142
    v_cvt_pk_bf16_f32 v24, v32, v33
    v_cvt_pk_bf16_f32 v25, v34, v35
    v_cvt_pk_bf16_f32 v26, v36, v37
    v_cvt_pk_bf16_f32 v27, v38, v39
    s_mov_b64 exec, -1
    s_branch F_yb2
F_ya3:
    s_cmp_eq_u64 s[66:67], 0
    s_cbranch_scc1 F_yb3
    s_mov_b64 exec, s[66:67]
    v_lshlrev_b32 v32, 16, v28
    v_and_b32 v33, 0xffff0000, v28
    v_lshlrev_b32 v34, 16, v29
    v_and_b32 v35, 0xffff0000, v29
    v_lshlrev_b32 v36, 16, v30
    v_and_b32 v37, 0xffff0000, v30
    v_lshlrev_b32 v38, 16, v31
    v_and_b32 v39, 0xffff0000, v31
    s_waitcnt vmcnt(3)
    v_fmac_f32 v32, v96, v143
    v_fmac_f32 v33, v97, v143
    v_fmac_f32 v34, v98, v143
    v_fmac_f32 v35, v99, v143
    v_fmac_f32 v36, v100, v143
    v_fmac_f32 v37, v101, v143
    v_fmac_f32 v38, v102, v143
    v_fmac_f32 v39, v103, v143
    v_cvt_pk_bf16_f32 v28, v32, v33
    v_cvt_pk_bf16_f32 v29, v34, v35
    v_cvt_pk_bf16_f32 v30, v36, v37
    v_cvt_pk_bf16_f32 v31, v38, v39
    s_mov_b64 exec, -1
    s_branch F_yb3
F_codeend:
.section .rodata,"a"
.p2align 6
.amdhsa_kernel parallel_sum__linear_attn_block__moe_arch_mod__prompt_kernel
  .amdhsa_next_free_vgpr 168
  .amdhsa_next_free_sgpr 96
  .amdhsa_accum_offset 168
  .amdhsa_group_segment_fixed_size 0
  .amdhsa_kernarg_size 88
  .amdhsa_user_sgpr_count 2
  .amdhsa_user_sgpr_kernarg_segment_ptr 1
  .amdhsa_system_sgpr_workgroup_id_x 1
  .amdhsa_float_denorm_mode_32 3
  .amdhsa_float_denorm_mode_16_64 3
.end_amdhsa_kernel
```

```asm
; @launch grid=(256,1,1) block=(768,1,1) lds=163840
.amdgcn_target "amdgcn-amd-amdhsa--gfx950"
.text
.globl parallel_sum__linear_attn_block__moe_arch_mod__prompt_kernel
.p2align 8
.type parallel_sum__linear_attn_block__moe_arch_mod__prompt_kernel,@function
parallel_sum__linear_attn_block__moe_arch_mod__prompt_kernel:
    s_load_dwordx4 s[4:7], s[0:1], 0
    s_load_dwordx8 s[60:67], s[0:1], 32
    s_load_dwordx2 s[72:73], s[0:1], 80
    s_load_dwordx4 s[68:71], s[0:1], 64
    s_load_dwordx2 s[8:9], s[0:1], 16
    s_cmp_ge_u32 s2, 256
    s_cbranch_scc1 F_end
    v_lshrrev_b32 v1, 6, v0
    v_and_b32 v0, 63, v0
    s_and_b32 s30, s2, 7
    v_readfirstlane_b32 s3, v1
    s_lshr_b32 s31, s2, 3
    s_and_b32 s32, s30, 1
    s_lshl_b32 s32, s32, 3
    s_and_b32 s35, s31, 7
    s_add_u32 s32, s32, s35
    s_lshr_b32 s33, s30, 1
    s_lshl_b32 s33, s33, 2
    s_lshr_b32 s34, s31, 3
    s_xor_b32 s34, s34, 0
    s_add_u32 s33, s33, s34
    s_lshl_b32 s28, s32, 1
    s_bfe_u32 s29, s30, 0x10001
    s_add_u32 s28, s28, s29
    s_lshl_b32 s29, s30, 2
    s_xor_b32 s29, s29, s30
    s_and_b32 s29, s29, 4
    s_add_u32 s29, s29, s34
    s_lshl_b32 s39, s29, 1
    s_xor_b32 s39, s39, 14
    s_add_u32 s10, s33, 4
    s_and_b32 s10, s10, 15
    v_lshlrev_b32 v2, 4, v0
    s_cmp_ge_u32 s3, 8
    s_cbranch_scc1 F_loader
    s_lshl_b32 s77, s32, 4
    s_add_u32 s77, s77, s33
    s_lshl_b32 s77, s77, 3
    s_add_u32 s77, s77, s3
    s_cmp_lg_u32 s3, 7
    s_cbranch_scc1 F_nt
    s_getpc_b64 s[46:47]
F_pc:
    s_sub_u32 s46, s46, F_pc-parallel_sum__linear_attn_block__moe_arch_mod__prompt_kernel
    s_subb_u32 s47, s47, 0
    s_and_b32 s44, s31, 7
    s_lshl_b32 s44, s44, 13
    v_min_u32 v60, 63, v0
    v_lshlrev_b32 v60, 7, v60
    v_add_u32_e64 v60, s44, v60
    v_min_u32 v60, F_codeend-parallel_sum__linear_attn_block__moe_arch_mod__prompt_kernel-4, v60
    global_load_dword v161, v60, s[46:47]
F_nt:
    s_lshl_b32 s44, s77, 11
    s_waitcnt lgkmcnt(0)

    s_mov_b32 s20, s4
    s_mov_b32 s21, s5
    s_mov_b32 s22, 0x400000
    s_mov_b32 s23, 0x00020000
    buffer_load_dwordx4 v[4:7], v2, s[20:23], s44 offen
    buffer_load_dwordx4 v[8:11], v2, s[20:23], s44 offen offset:1024
    s_mov_b32 s16, s60
    s_mov_b32 s17, s61
    s_mov_b32 s18, 0x800
    s_mov_b32 s19, 0x00020000
    buffer_load_dwordx4 v[12:15], v2, s[16:19], 0 offen
    buffer_load_dwordx4 v[16:19], v2, s[16:19], 0 offen offset:1024
    s_add_u32 s24, s72, 0x800000
    s_addc_u32 s25, s73, 0
    s_mov_b32 s26, 0x100000
    s_mov_b32 s27, 0x00020000
    s_add_u32 s40, s72, 0x900000
    s_addc_u32 s41, s73, 0
    s_mov_b32 s42, 0x18000
    s_mov_b32 s43, 0x00020000
    s_mov_b32 s48, s70
    s_mov_b32 s49, s71
    s_mov_b32 s50, 0x100
    s_mov_b32 s51, 0x00020000
    v_mov_b32 v20, 0
    v_mov_b32 v21, 0
    v_mov_b32 v22, 0
    v_mov_b32 v23, 0
    s_cmp_lg_u32 s3, 5
    s_cbranch_scc1 F_a0
    s_cmp_lg_u32 s33, 0
    s_cbranch_scc1 F_a0
    s_lshl_b32 s44, s32, 8
    s_add_u32 s44, s44, 32768
    s_lshl_b32 s45, s32, 2
    s_mov_b64 exec, 0xffff
    buffer_store_dwordx4 v[20:23], v2, s[40:43], s44 offen sc0 sc1
    s_mov_b64 exec, 1
    s_waitcnt vmcnt(0)
    v_mov_b32 v24, 1
    buffer_store_dword v24, v20, s[48:51], s45 offen sc0 sc1
    s_mov_b64 exec, -1
    s_branch F_a1
F_a0:

    s_cmp_ge_u32 s3, 4
    s_cbranch_scc1 F_z1
    v_mov_b64 v[68:69], 0
    v_mov_b64 v[70:71], 0
    v_mov_b64 v[72:73], 0
    v_mov_b64 v[74:75], 0
    v_mov_b64 v[76:77], 0
    v_mov_b64 v[78:79], 0
    v_mov_b64 v[80:81], 0
    v_mov_b64 v[82:83], 0
    v_mov_b64 v[84:85], 0
    v_mov_b64 v[86:87], 0
    v_mov_b64 v[88:89], 0
    v_mov_b64 v[90:91], 0
    v_mov_b64 v[92:93], 0
    v_mov_b64 v[94:95], 0
    v_mov_b64 v[96:97], 0
    v_mov_b64 v[98:99], 0
    v_mov_b64 v[100:101], 0
    v_mov_b64 v[102:103], 0
    v_mov_b64 v[104:105], 0
    v_mov_b64 v[106:107], 0
    v_mov_b64 v[108:109], 0
    v_mov_b64 v[110:111], 0
    v_mov_b64 v[112:113], 0
    v_mov_b64 v[114:115], 0
    v_mov_b64 v[116:117], 0
    v_mov_b64 v[118:119], 0
    v_mov_b64 v[120:121], 0
    v_mov_b64 v[122:123], 0
    v_mov_b64 v[124:125], 0
    v_mov_b64 v[126:127], 0
    v_mov_b64 v[128:129], 0
    v_mov_b64 v[130:131], 0
    v_mov_b64 v[132:133], 0
    v_mov_b64 v[134:135], 0
    v_mov_b64 v[136:137], 0
    v_mov_b64 v[138:139], 0
    v_mov_b64 v[140:141], 0
    v_mov_b64 v[142:143], 0
    v_mov_b64 v[144:145], 0
    v_mov_b64 v[146:147], 0
    v_mov_b64 v[148:149], 0
    v_mov_b64 v[150:151], 0
    v_mov_b64 v[152:153], 0
    v_mov_b64 v[154:155], 0
    v_mov_b64 v[156:157], 0
    v_mov_b64 v[158:159], 0
    v_mov_b64 v[160:161], 0
    v_mov_b64 v[162:163], 0
F_z1:
    s_waitcnt vmcnt(0)
F_a1:

    v_lshlrev_b32 v24, 16, v4
    v_and_b32 v25, 0xffff0000, v4
    v_lshlrev_b32 v26, 16, v5
    v_and_b32 v27, 0xffff0000, v5
    v_lshlrev_b32 v28, 16, v6
    v_and_b32 v29, 0xffff0000, v6
    v_lshlrev_b32 v30, 16, v7
    v_and_b32 v31, 0xffff0000, v7
    v_lshlrev_b32 v32, 16, v8
    v_and_b32 v33, 0xffff0000, v8
    v_lshlrev_b32 v34, 16, v9
    v_and_b32 v35, 0xffff0000, v9
    v_lshlrev_b32 v36, 16, v10
    v_and_b32 v37, 0xffff0000, v10
    v_lshlrev_b32 v38, 16, v11
    v_and_b32 v39, 0xffff0000, v11
    v_add_f32 v40, v24, v25
    v_add_f32 v41, v26, v27
    v_add_f32 v42, v28, v29
    v_add_f32 v43, v30, v31
    v_add_f32 v44, v32, v33
    v_add_f32 v45, v34, v35
    v_add_f32 v46, v36, v37
    v_add_f32 v47, v38, v39
    v_add_f32 v40, v40, v44
    v_add_f32 v41, v41, v45
    v_add_f32 v42, v42, v46
    v_add_f32 v43, v43, v47
    v_add_f32 v40, v40, v42
    v_add_f32 v41, v41, v43
    v_add_f32 v40, v40, v41
    s_nop 1
    v_add_f32_dpp v40, v40, v40 row_shr:1 row_mask:0xf bank_mask:0xf bound_ctrl:0
    s_nop 1
    v_add_f32_dpp v40, v40, v40 row_shr:2 row_mask:0xf bank_mask:0xf bound_ctrl:0
    s_nop 1
    v_add_f32_dpp v40, v40, v40 row_shr:4 row_mask:0xf bank_mask:0xf bound_ctrl:0
    s_nop 1
    v_add_f32_dpp v40, v40, v40 row_shr:8 row_mask:0xf bank_mask:0xf bound_ctrl:0
    s_nop 1
    v_add_f32_dpp v40, v40, v40 row_bcast:15 row_mask:0xa bank_mask:0xf
    s_nop 1
    v_add_f32_dpp v40, v40, v40 row_bcast:31 row_mask:0xc bank_mask:0xf
    s_nop 0
    v_readlane_b32 s52, v40, 63
    v_mov_b32 v41, 0x3a800000
    s_nop 0
    v_mul_f32 v41, s52, v41
    v_sub_f32 v44, v24, v41
    v_sub_f32 v45, v25, v41
    v_sub_f32 v46, v26, v41
    v_sub_f32 v47, v27, v41
    v_sub_f32 v48, v28, v41
    v_sub_f32 v49, v29, v41
    v_sub_f32 v50, v30, v41
    v_sub_f32 v51, v31, v41
    v_sub_f32 v52, v32, v41
    v_sub_f32 v53, v33, v41
    v_sub_f32 v54, v34, v41
    v_sub_f32 v55, v35, v41
    v_sub_f32 v56, v36, v41
    v_sub_f32 v57, v37, v41
    v_sub_f32 v58, v38, v41
    v_sub_f32 v59, v39, v41
    v_mul_f32 v40, v44, v44
    v_mul_f32 v42, v45, v45
    v_fmac_f32 v40, v46, v46
    v_fmac_f32 v42, v47, v47
    v_fmac_f32 v40, v48, v48
    v_fmac_f32 v42, v49, v49
    v_fmac_f32 v40, v50, v50
    v_fmac_f32 v42, v51, v51
    v_fmac_f32 v40, v52, v52
    v_fmac_f32 v42, v53, v53
    v_fmac_f32 v40, v54, v54
    v_fmac_f32 v42, v55, v55
    v_fmac_f32 v40, v56, v56
    v_fmac_f32 v42, v57, v57
    v_fmac_f32 v40, v58, v58
    v_fmac_f32 v42, v59, v59
    v_add_f32 v40, v40, v42
    s_nop 1
    v_add_f32_dpp v40, v40, v40 row_shr:1 row_mask:0xf bank_mask:0xf bound_ctrl:0
    s_nop 1
    v_add_f32_dpp v40, v40, v40 row_shr:2 row_mask:0xf bank_mask:0xf bound_ctrl:0
    s_nop 1
    v_add_f32_dpp v40, v40, v40 row_shr:4 row_mask:0xf bank_mask:0xf bound_ctrl:0
    s_nop 1
    v_add_f32_dpp v40, v40, v40 row_shr:8 row_mask:0xf bank_mask:0xf bound_ctrl:0
    s_nop 1
    v_add_f32_dpp v40, v40, v40 row_bcast:15 row_mask:0xa bank_mask:0xf
    s_nop 1
    v_add_f32_dpp v40, v40, v40 row_bcast:31 row_mask:0xc bank_mask:0xf
    s_nop 0
    v_readlane_b32 s52, v40, 63
    v_mov_b32 v42, 0x3a800000
    s_nop 0
    v_mul_f32 v42, s52, v42
    v_cvt_pk_bf16_f32 v43, v41, v42
    v_lshlrev_b32 v41, 16, v43
    v_and_b32 v42, 0xffff0000, v43
    v_add_f32 v42, 0x3727c5ac, v42
    v_cvt_pk_bf16_f32 v42, v42, v42
    v_lshlrev_b32 v42, 16, v42
    v_sqrt_f32 v42, v42
    s_nop 0
    v_cvt_pk_bf16_f32 v42, v42, v42
    v_lshlrev_b32 v42, 16, v42
    v_rcp_f32 v42, v42
    v_sub_f32 v24, v24, v41
    v_sub_f32 v25, v25, v41
    v_sub_f32 v26, v26, v41
    v_sub_f32 v27, v27, v41
    v_sub_f32 v28, v28, v41
    v_sub_f32 v29, v29, v41
    v_sub_f32 v30, v30, v41
    v_sub_f32 v31, v31, v41
    v_sub_f32 v32, v32, v41
    v_sub_f32 v33, v33, v41
    v_sub_f32 v34, v34, v41
    v_sub_f32 v35, v35, v41
    v_sub_f32 v36, v36, v41
    v_sub_f32 v37, v37, v41
    v_sub_f32 v38, v38, v41
    v_sub_f32 v39, v39, v41
    v_cvt_pk_bf16_f32 v4, v24, v25
    v_cvt_pk_bf16_f32 v5, v26, v27
    v_cvt_pk_bf16_f32 v6, v28, v29
    v_cvt_pk_bf16_f32 v7, v30, v31
    v_cvt_pk_bf16_f32 v8, v32, v33
    v_cvt_pk_bf16_f32 v9, v34, v35
    v_cvt_pk_bf16_f32 v10, v36, v37
    v_cvt_pk_bf16_f32 v11, v38, v39
    v_lshlrev_b32 v24, 16, v4
    v_and_b32 v25, 0xffff0000, v4
    v_lshlrev_b32 v26, 16, v5
    v_and_b32 v27, 0xffff0000, v5
    v_lshlrev_b32 v28, 16, v6
    v_and_b32 v29, 0xffff0000, v6
    v_lshlrev_b32 v30, 16, v7
    v_and_b32 v31, 0xffff0000, v7
    v_lshlrev_b32 v32, 16, v8
    v_and_b32 v33, 0xffff0000, v8
    v_lshlrev_b32 v34, 16, v9
    v_and_b32 v35, 0xffff0000, v9
    v_lshlrev_b32 v36, 16, v10
    v_and_b32 v37, 0xffff0000, v10
    v_lshlrev_b32 v38, 16, v11
    v_and_b32 v39, 0xffff0000, v11
    v_mul_f32 v24, v24, v42
    v_mul_f32 v25, v25, v42
    v_mul_f32 v26, v26, v42
    v_mul_f32 v27, v27, v42
    v_mul_f32 v28, v28, v42
    v_mul_f32 v29, v29, v42
    v_mul_f32 v30, v30, v42
    v_mul_f32 v31, v31, v42
    v_mul_f32 v32, v32, v42
    v_mul_f32 v33, v33, v42
    v_mul_f32 v34, v34, v42
    v_mul_f32 v35, v35, v42
    v_mul_f32 v36, v36, v42
    v_mul_f32 v37, v37, v42
    v_mul_f32 v38, v38, v42
    v_mul_f32 v39, v39, v42
    v_cvt_pk_bf16_f32 v4, v24, v25
    v_cvt_pk_bf16_f32 v5, v26, v27
    v_cvt_pk_bf16_f32 v6, v28, v29
    v_cvt_pk_bf16_f32 v7, v30, v31
    v_cvt_pk_bf16_f32 v8, v32, v33
    v_cvt_pk_bf16_f32 v9, v34, v35
    v_cvt_pk_bf16_f32 v10, v36, v37
    v_cvt_pk_bf16_f32 v11, v38, v39
    v_mov_b32 v40, 0
    v_mov_b32 v43, 0
    v_dot2_f32_bf16 v40, v4, v12, v40
    v_dot2_f32_bf16 v43, v5, v13, v43
    v_dot2_f32_bf16 v40, v6, v14, v40
    v_dot2_f32_bf16 v43, v7, v15, v43
    v_dot2_f32_bf16 v40, v8, v16, v40
    v_dot2_f32_bf16 v43, v9, v17, v43
    v_dot2_f32_bf16 v40, v10, v18, v40
    v_dot2_f32_bf16 v43, v11, v19, v43
    s_nop 2
    v_add_f32 v40, v40, v43
    s_nop 1
    v_add_f32_dpp v40, v40, v40 row_shr:1 row_mask:0xf bank_mask:0xf bound_ctrl:0
    s_nop 1
    v_add_f32_dpp v40, v40, v40 row_shr:2 row_mask:0xf bank_mask:0xf bound_ctrl:0
    s_nop 1
    v_add_f32_dpp v40, v40, v40 row_shr:4 row_mask:0xf bank_mask:0xf bound_ctrl:0
    s_nop 1
    v_add_f32_dpp v40, v40, v40 row_shr:8 row_mask:0xf bank_mask:0xf bound_ctrl:0
    s_nop 1
    v_add_f32_dpp v40, v40, v40 row_bcast:15 row_mask:0xa bank_mask:0xf
    s_nop 1
    v_add_f32_dpp v40, v40, v40 row_bcast:31 row_mask:0xc bank_mask:0xf
    s_nop 0
    v_readlane_b32 s52, v40, 63
    s_nop 1
    v_mov_b32 v44, s52
    v_cvt_pk_bf16_f32 v44, v44, v44
    v_and_b32 v44, 0xffff0000, v44
    v_ashrrev_i32 v45, 31, v44
    v_or_b32 v45, 0x80000000, v45
    v_xor_b32 v44, v44, v45
    v_and_b32 v44, 0xffff0000, v44
    s_sub_u32 s44, 2047, s77
    v_or_b32 v44, s44, v44
    v_xor_b32 v46, 0x80000000, v41
    v_mov_b32 v47, v42
    v_mul_f32 v48, 0x3fb8aa3b, v42
    s_lshl_b32 s44, s77, 2
    s_lshl_b32 s45, s77, 4
    s_add_u32 s45, s45, 65536
    v_mov_b32 v45, 0
    s_mov_b64 exec, 1
    buffer_store_dword v44, v45, s[40:43], s44 offen sc0 sc1
    buffer_store_dwordx3 v[46:48], v45, s[40:43], s45 offen sc0 sc1
    s_mov_b64 exec, -1

    s_cmp_ge_u32 s3, 4
    s_cbranch_scc1 F_aux
    s_branch F_k
.p2align 12
F_k:
    s_setprio 2
    s_lshr_b32 s36, s3, 1
    s_and_b32 s37, s3, 1
    s_lshl_b32 s38, s36, 13
    s_lshl_b32 s42, s37, 1

    v_and_b32 v1, 15, v0
    v_lshrrev_b32 v2, 4, v0
    v_lshrrev_b32 v3, 1, v1
    v_xor_b32 v3, v3, v2
    v_lshlrev_b32 v3, 4, v3
    v_lshlrev_b32 v1, 7, v1
    v_add3_u32 v4, v1, v3, s38
    v_xor_b32 v5, 64, v4
    v_add_u32 v6, 81920, v4
    v_add_u32 v7, 81920, v5
    v_bfe_u32 v1, v0, 2, 2
    v_lshl_add_u32 v3, v2, 3, v1
    v_lshrrev_b32 v1, 1, v1
    v_and_b32 v2, 1, v2
    v_lshl_add_u32 v1, v2, 1, v1
    v_xor_b32 v1, s42, v1
    v_lshlrev_b32 v1, 5, v1
    v_lshl_add_u32 v1, v3, 7, v1
    v_and_b32 v2, 3, v0
    v_lshl_add_u32 v1, v2, 3, v1

    v_add_u32 v8, 16384, v1
    v_xor_b32 v9, 32, v8
    v_add_u32 v10, 81920, v8
    v_add_u32 v11, 81920, v9
    s_mov_b32 s40, 0x3f800008
    s_mov_b32 s41, s40
    s_mov_b32 s74, 0x358637bd
    s_mov_b32 s75, s74
    s_lshl_b32 s42, s36, 8
    s_add_u32 s42, s42, 24832
    v_and_or_b32 v164, v0, 48, s42
    v_and_b32 v165, 15, v0
    s_lshl_b32 s42, s37, 7
    s_add_u32 s42, s42, 26368
    v_lshl_add_u32 v165, v165, 2, s42
    s_lshl_b32 s42, s3, 12
    s_add_u32 s42, s42, 65536
    v_lshl_add_u32 v1, v0, 4, s42
    s_lshl_b32 s42, s3, 7
    s_add_u32 s42, s42, 27136
    v_and_or_b32 v2, v0, 48, s42
    s_lshl_b32 s42, s3, 2
    s_add_u32 s42, s42, 24640
    v_mov_b32_e64 v3, s42
    s_lshl_b32 s46, s28, 6
    s_lshl_b32 s78, s10, 1
    s_add_u32 s78, s78, s37
    s_lshl_b32 s79, s32, 18
    s_lshl_b32 s80, s36, 17
    s_add_u32 s79, s79, s80
    s_lshl_b32 s80, s78, 10
    s_add_u32 s79, s79, s80
    s_lshl_b32 s45, s32, 1
    s_add_u32 s45, s45, s36
    s_mul_i32 s45, s45, 8*64
    s_add_u32 s45, s45, 225280
    s_mul_i32 s82, s78, 4224
    s_add_u32 s83, s82, 4096
    s_lshl_b32 s50, s78, 4
    s_and_b32 s44, s32, 4-1
    s_mul_i32 s44, s44, 16/4
    s_add_u32 s50, s50, s44
    s_mul_i32 s50, s50, 64

    s_add_u32 s56, s50, 0x82f000
    s_add_u32 s56, s72, s56
    s_addc_u32 s57, s73, 0
    s_add_u32 s16, s72, 0x400000
    s_addc_u32 s17, s73, 0
    s_mov_b32 s18, 0x400000
    s_mov_b32 s19, 0x00020000
    s_add_u32 s68, s45, 0x800000
    s_add_u32 s68, s72, s68
    s_addc_u32 s69, s73, 0
    s_mov_b32 s76, 1
    s_barrier
    ds_read_b64_tr_b16 v[44:45], v8 offset:8192
    ds_read_b64_tr_b16 v[46:47], v8 offset:8704
    ds_read_b64_tr_b16 v[48:49], v8 offset:12288
    ds_read_b64_tr_b16 v[50:51], v8 offset:12800
    ds_read_b128 v[12:15], v4 offset:0
    ds_read_b128 v[28:31], v5 offset:0
    ds_read_b128 v[16:19], v4 offset:2048
    ds_read_b128 v[32:35], v5 offset:2048
    ds_read_b128 v[20:23], v4 offset:4096
    ds_read_b128 v[36:39], v5 offset:4096
    ds_read_b64_tr_b16 v[52:53], v9 offset:8192
    ds_read_b64_tr_b16 v[54:55], v9 offset:8704
    ds_read_b128 v[24:27], v4 offset:6144
    ds_read_b128 v[40:43], v5 offset:6144
    s_waitcnt lgkmcnt(14)
    s_mov_b32 s81, 3
F_p1:
    s_waitcnt lgkmcnt(7)
    v_mfma_f32_16x16x32_bf16 v[100:103], v[12:15], v[44:47], v[100:103]
    ds_read_b64_tr_b16 v[56:57], v9 offset:12288
    v_mfma_f32_16x16x32_bf16 v[100:103], v[28:31], v[48:51], v[100:103]
    ds_read_b64_tr_b16 v[58:59], v9 offset:12800
    v_mfma_f32_16x16x32_bf16 v[104:107], v[16:19], v[44:47], v[104:107]
    ds_read_b64_tr_b16 v[60:61], v8 offset:16384
    s_waitcnt lgkmcnt(9)
    v_mfma_f32_16x16x32_bf16 v[104:107], v[32:35], v[48:51], v[104:107]
    ds_read_b64_tr_b16 v[62:63], v8 offset:16896
    s_waitcnt lgkmcnt(9)
    v_mfma_f32_16x16x32_bf16 v[108:111], v[20:23], v[44:47], v[108:111]
    ds_read_b64_tr_b16 v[64:65], v8 offset:20480
    s_waitcnt lgkmcnt(9)
    v_mfma_f32_16x16x32_bf16 v[108:111], v[36:39], v[48:51], v[108:111]
    ds_read_b64_tr_b16 v[66:67], v8 offset:20992
    s_waitcnt lgkmcnt(7)
    v_mfma_f32_16x16x32_bf16 v[112:115], v[24:27], v[44:47], v[112:115]
    ds_read_b64_tr_b16 v[44:45], v9 offset:16384
    s_waitcnt lgkmcnt(7)
    v_mfma_f32_16x16x32_bf16 v[112:115], v[40:43], v[48:51], v[112:115]
    ds_read_b64_tr_b16 v[46:47], v9 offset:16896
    v_mfma_f32_16x16x32_bf16 v[116:119], v[12:15], v[52:55], v[116:119]
    ds_read_b64_tr_b16 v[48:49], v9 offset:20480
    s_waitcnt lgkmcnt(7)
    v_mfma_f32_16x16x32_bf16 v[116:119], v[28:31], v[56:59], v[116:119]
    ds_read_b64_tr_b16 v[50:51], v9 offset:20992
    v_mfma_f32_16x16x32_bf16 v[120:123], v[16:19], v[52:55], v[120:123]
    v_mfma_f32_16x16x32_bf16 v[120:123], v[32:35], v[56:59], v[120:123]
    v_mfma_f32_16x16x32_bf16 v[124:127], v[20:23], v[52:55], v[124:127]
    v_mfma_f32_16x16x32_bf16 v[124:127], v[36:39], v[56:59], v[124:127]
    v_mfma_f32_16x16x32_bf16 v[128:131], v[24:27], v[52:55], v[128:131]
    ds_read_b64_tr_b16 v[52:53], v8 offset:0
    v_mfma_f32_16x16x32_bf16 v[128:131], v[40:43], v[56:59], v[128:131]
    ds_read_b64_tr_b16 v[54:55], v8 offset:512
    s_waitcnt lgkmcnt(5)
    v_mfma_f32_16x16x32_bf16 v[132:135], v[12:15], v[60:63], v[132:135]
    ds_read_b64_tr_b16 v[56:57], v8 offset:4096
    v_mfma_f32_16x16x32_bf16 v[132:135], v[28:31], v[64:67], v[132:135]
    ds_read_b64_tr_b16 v[58:59], v8 offset:4608
    v_mfma_f32_16x16x32_bf16 v[136:139], v[16:19], v[60:63], v[136:139]
    v_mfma_f32_16x16x32_bf16 v[136:139], v[32:35], v[64:67], v[136:139]
    v_mfma_f32_16x16x32_bf16 v[140:143], v[20:23], v[60:63], v[140:143]
    v_mfma_f32_16x16x32_bf16 v[140:143], v[36:39], v[64:67], v[140:143]
    v_mfma_f32_16x16x32_bf16 v[144:147], v[24:27], v[60:63], v[144:147]
    ds_read_b64_tr_b16 v[60:61], v9 offset:0
    v_mfma_f32_16x16x32_bf16 v[144:147], v[40:43], v[64:67], v[144:147]
    ds_read_b64_tr_b16 v[62:63], v9 offset:512
    s_waitcnt lgkmcnt(5)
    v_mfma_f32_16x16x32_bf16 v[148:151], v[12:15], v[44:47], v[148:151]
    ds_read_b64_tr_b16 v[64:65], v9 offset:4096
    v_mfma_f32_16x16x32_bf16 v[148:151], v[28:31], v[48:51], v[148:151]
    ds_read_b64_tr_b16 v[66:67], v9 offset:4608
    v_mfma_f32_16x16x32_bf16 v[152:155], v[16:19], v[44:47], v[152:155]
    v_mfma_f32_16x16x32_bf16 v[152:155], v[32:35], v[48:51], v[152:155]
    v_mfma_f32_16x16x32_bf16 v[156:159], v[20:23], v[44:47], v[156:159]
    v_mfma_f32_16x16x32_bf16 v[156:159], v[36:39], v[48:51], v[156:159]
    s_waitcnt lgkmcnt(0)
    s_barrier
    v_mfma_f32_16x16x32_bf16 v[160:163], v[24:27], v[44:47], v[160:163]
    ds_read_b64_tr_b16 v[44:45], v8 offset:49152
    v_mfma_f32_16x16x32_bf16 v[160:163], v[40:43], v[48:51], v[160:163]
    ds_read_b64_tr_b16 v[46:47], v8 offset:49664
    v_mfma_f32_16x16x32_bf16 v[68:71], v[52:55], v[12:15], v[68:71]
    ds_read_b64_tr_b16 v[48:49], v8 offset:53248
    v_mfma_f32_16x16x32_bf16 v[68:71], v[56:59], v[28:31], v[68:71]
    ds_read_b64_tr_b16 v[50:51], v8 offset:53760
    v_mfma_f32_16x16x32_bf16 v[84:87], v[60:63], v[12:15], v[84:87]
    ds_read_b128 v[12:15], v4 offset:40960
    v_mfma_f32_16x16x32_bf16 v[84:87], v[64:67], v[28:31], v[84:87]
    ds_read_b128 v[28:31], v5 offset:40960
    v_mfma_f32_16x16x32_bf16 v[72:75], v[52:55], v[16:19], v[72:75]
    v_mfma_f32_16x16x32_bf16 v[72:75], v[56:59], v[32:35], v[72:75]
    v_mfma_f32_16x16x32_bf16 v[88:91], v[60:63], v[16:19], v[88:91]
    ds_read_b128 v[16:19], v4 offset:43008
    v_mfma_f32_16x16x32_bf16 v[88:91], v[64:67], v[32:35], v[88:91]
    ds_read_b128 v[32:35], v5 offset:43008
    v_mfma_f32_16x16x32_bf16 v[76:79], v[52:55], v[20:23], v[76:79]
    v_mfma_f32_16x16x32_bf16 v[76:79], v[56:59], v[36:39], v[76:79]
    v_mfma_f32_16x16x32_bf16 v[92:95], v[60:63], v[20:23], v[92:95]
    ds_read_b128 v[20:23], v4 offset:45056
    v_mfma_f32_16x16x32_bf16 v[92:95], v[64:67], v[36:39], v[92:95]
    ds_read_b128 v[36:39], v5 offset:45056
    v_mfma_f32_16x16x32_bf16 v[80:83], v[52:55], v[24:27], v[80:83]
    ds_read_b64_tr_b16 v[52:53], v9 offset:49152
    v_mfma_f32_16x16x32_bf16 v[80:83], v[56:59], v[40:43], v[80:83]
    ds_read_b64_tr_b16 v[54:55], v9 offset:49664
    v_mfma_f32_16x16x32_bf16 v[96:99], v[60:63], v[24:27], v[96:99]
    ds_read_b128 v[24:27], v4 offset:47104
    v_mfma_f32_16x16x32_bf16 v[96:99], v[64:67], v[40:43], v[96:99]
    ds_read_b128 v[40:43], v5 offset:47104
    s_waitcnt lgkmcnt(7)
    v_mfma_f32_16x16x32_bf16 v[100:103], v[12:15], v[44:47], v[100:103]
    ds_read_b64_tr_b16 v[56:57], v9 offset:53248
    v_mfma_f32_16x16x32_bf16 v[100:103], v[28:31], v[48:51], v[100:103]
    ds_read_b64_tr_b16 v[58:59], v9 offset:53760
    v_mfma_f32_16x16x32_bf16 v[104:107], v[16:19], v[44:47], v[104:107]
    ds_read_b64_tr_b16 v[60:61], v8 offset:57344
    s_waitcnt lgkmcnt(9)
    v_mfma_f32_16x16x32_bf16 v[104:107], v[32:35], v[48:51], v[104:107]
    ds_read_b64_tr_b16 v[62:63], v8 offset:57856
    s_waitcnt lgkmcnt(9)
    v_mfma_f32_16x16x32_bf16 v[108:111], v[20:23], v[44:47], v[108:111]
    ds_read_b64_tr_b16 v[64:65], v8 offset:61440
    s_waitcnt lgkmcnt(9)
    v_mfma_f32_16x16x32_bf16 v[108:111], v[36:39], v[48:51], v[108:111]
    ds_read_b64_tr_b16 v[66:67], v8 offset:61952
    s_waitcnt lgkmcnt(7)
    v_mfma_f32_16x16x32_bf16 v[112:115], v[24:27], v[44:47], v[112:115]
    ds_read_b64_tr_b16 v[44:45], v9 offset:57344
    s_waitcnt lgkmcnt(7)
    v_mfma_f32_16x16x32_bf16 v[112:115], v[40:43], v[48:51], v[112:115]
    ds_read_b64_tr_b16 v[46:47], v9 offset:57856
    v_mfma_f32_16x16x32_bf16 v[116:119], v[12:15], v[52:55], v[116:119]
    ds_read_b64_tr_b16 v[48:49], v9 offset:61440
    s_waitcnt lgkmcnt(7)
    v_mfma_f32_16x16x32_bf16 v[116:119], v[28:31], v[56:59], v[116:119]
    ds_read_b64_tr_b16 v[50:51], v9 offset:61952
    v_mfma_f32_16x16x32_bf16 v[120:123], v[16:19], v[52:55], v[120:123]
    v_mfma_f32_16x16x32_bf16 v[120:123], v[32:35], v[56:59], v[120:123]
    v_mfma_f32_16x16x32_bf16 v[124:127], v[20:23], v[52:55], v[124:127]
    v_mfma_f32_16x16x32_bf16 v[124:127], v[36:39], v[56:59], v[124:127]
    v_mfma_f32_16x16x32_bf16 v[128:131], v[24:27], v[52:55], v[128:131]
    ds_read_b64_tr_b16 v[52:53], v8 offset:40960
    v_mfma_f32_16x16x32_bf16 v[128:131], v[40:43], v[56:59], v[128:131]
    ds_read_b64_tr_b16 v[54:55], v8 offset:41472
    s_waitcnt lgkmcnt(5)
    v_mfma_f32_16x16x32_bf16 v[132:135], v[12:15], v[60:63], v[132:135]
    ds_read_b64_tr_b16 v[56:57], v8 offset:45056
    v_mfma_f32_16x16x32_bf16 v[132:135], v[28:31], v[64:67], v[132:135]
    ds_read_b64_tr_b16 v[58:59], v8 offset:45568
    v_mfma_f32_16x16x32_bf16 v[136:139], v[16:19], v[60:63], v[136:139]
    v_mfma_f32_16x16x32_bf16 v[136:139], v[32:35], v[64:67], v[136:139]
    v_mfma_f32_16x16x32_bf16 v[140:143], v[20:23], v[60:63], v[140:143]
    v_mfma_f32_16x16x32_bf16 v[140:143], v[36:39], v[64:67], v[140:143]
    v_mfma_f32_16x16x32_bf16 v[144:147], v[24:27], v[60:63], v[144:147]
    ds_read_b64_tr_b16 v[60:61], v9 offset:40960
    v_mfma_f32_16x16x32_bf16 v[144:147], v[40:43], v[64:67], v[144:147]
    ds_read_b64_tr_b16 v[62:63], v9 offset:41472
    s_waitcnt lgkmcnt(5)
    v_mfma_f32_16x16x32_bf16 v[148:151], v[12:15], v[44:47], v[148:151]
    ds_read_b64_tr_b16 v[64:65], v9 offset:45056
    v_mfma_f32_16x16x32_bf16 v[148:151], v[28:31], v[48:51], v[148:151]
    ds_read_b64_tr_b16 v[66:67], v9 offset:45568
    v_mfma_f32_16x16x32_bf16 v[152:155], v[16:19], v[44:47], v[152:155]
    v_mfma_f32_16x16x32_bf16 v[152:155], v[32:35], v[48:51], v[152:155]
    v_mfma_f32_16x16x32_bf16 v[156:159], v[20:23], v[44:47], v[156:159]
    v_mfma_f32_16x16x32_bf16 v[156:159], v[36:39], v[48:51], v[156:159]
    s_waitcnt lgkmcnt(0)
    s_waitcnt vmcnt(0)
    s_barrier
    v_mfma_f32_16x16x32_bf16 v[160:163], v[24:27], v[44:47], v[160:163]
    ds_read_b64_tr_b16 v[44:45], v10 offset:8192
    v_mfma_f32_16x16x32_bf16 v[160:163], v[40:43], v[48:51], v[160:163]
    ds_read_b64_tr_b16 v[46:47], v10 offset:8704
    v_mfma_f32_16x16x32_bf16 v[68:71], v[52:55], v[12:15], v[68:71]
    ds_read_b64_tr_b16 v[48:49], v10 offset:12288
    v_mfma_f32_16x16x32_bf16 v[68:71], v[56:59], v[28:31], v[68:71]
    ds_read_b64_tr_b16 v[50:51], v10 offset:12800
    v_mfma_f32_16x16x32_bf16 v[84:87], v[60:63], v[12:15], v[84:87]
    ds_read_b128 v[12:15], v6 offset:0
    v_mfma_f32_16x16x32_bf16 v[84:87], v[64:67], v[28:31], v[84:87]
    ds_read_b128 v[28:31], v7 offset:0
    v_mfma_f32_16x16x32_bf16 v[72:75], v[52:55], v[16:19], v[72:75]
    v_mfma_f32_16x16x32_bf16 v[72:75], v[56:59], v[32:35], v[72:75]
    v_mfma_f32_16x16x32_bf16 v[88:91], v[60:63], v[16:19], v[88:91]
    ds_read_b128 v[16:19], v6 offset:2048
    v_mfma_f32_16x16x32_bf16 v[88:91], v[64:67], v[32:35], v[88:91]
    ds_read_b128 v[32:35], v7 offset:2048
    v_mfma_f32_16x16x32_bf16 v[76:79], v[52:55], v[20:23], v[76:79]
    v_mfma_f32_16x16x32_bf16 v[76:79], v[56:59], v[36:39], v[76:79]
    v_mfma_f32_16x16x32_bf16 v[92:95], v[60:63], v[20:23], v[92:95]
    ds_read_b128 v[20:23], v6 offset:4096
    v_mfma_f32_16x16x32_bf16 v[92:95], v[64:67], v[36:39], v[92:95]
    ds_read_b128 v[36:39], v7 offset:4096
    v_mfma_f32_16x16x32_bf16 v[80:83], v[52:55], v[24:27], v[80:83]
    ds_read_b64_tr_b16 v[52:53], v11 offset:8192
    v_mfma_f32_16x16x32_bf16 v[80:83], v[56:59], v[40:43], v[80:83]
    ds_read_b64_tr_b16 v[54:55], v11 offset:8704
    v_mfma_f32_16x16x32_bf16 v[96:99], v[60:63], v[24:27], v[96:99]
    ds_read_b128 v[24:27], v6 offset:6144
    v_mfma_f32_16x16x32_bf16 v[96:99], v[64:67], v[40:43], v[96:99]
    ds_read_b128 v[40:43], v7 offset:6144
    s_waitcnt lgkmcnt(7)
    v_mfma_f32_16x16x32_bf16 v[100:103], v[12:15], v[44:47], v[100:103]
    ds_read_b64_tr_b16 v[56:57], v11 offset:12288
    v_mfma_f32_16x16x32_bf16 v[100:103], v[28:31], v[48:51], v[100:103]
    ds_read_b64_tr_b16 v[58:59], v11 offset:12800
    v_mfma_f32_16x16x32_bf16 v[104:107], v[16:19], v[44:47], v[104:107]
    ds_read_b64_tr_b16 v[60:61], v10 offset:16384
    s_waitcnt lgkmcnt(9)
    v_mfma_f32_16x16x32_bf16 v[104:107], v[32:35], v[48:51], v[104:107]
    ds_read_b64_tr_b16 v[62:63], v10 offset:16896
    s_waitcnt lgkmcnt(9)
    v_mfma_f32_16x16x32_bf16 v[108:111], v[20:23], v[44:47], v[108:111]
    ds_read_b64_tr_b16 v[64:65], v10 offset:20480
    s_waitcnt lgkmcnt(9)
    v_mfma_f32_16x16x32_bf16 v[108:111], v[36:39], v[48:51], v[108:111]
    ds_read_b64_tr_b16 v[66:67], v10 offset:20992
    s_waitcnt lgkmcnt(7)
    v_mfma_f32_16x16x32_bf16 v[112:115], v[24:27], v[44:47], v[112:115]
    ds_read_b64_tr_b16 v[44:45], v11 offset:16384
    s_waitcnt lgkmcnt(7)
    v_mfma_f32_16x16x32_bf16 v[112:115], v[40:43], v[48:51], v[112:115]
    ds_read_b64_tr_b16 v[46:47], v11 offset:16896
    v_mfma_f32_16x16x32_bf16 v[116:119], v[12:15], v[52:55], v[116:119]
    ds_read_b64_tr_b16 v[48:49], v11 offset:20480
    s_waitcnt lgkmcnt(7)
    v_mfma_f32_16x16x32_bf16 v[116:119], v[28:31], v[56:59], v[116:119]
    ds_read_b64_tr_b16 v[50:51], v11 offset:20992
    v_mfma_f32_16x16x32_bf16 v[120:123], v[16:19], v[52:55], v[120:123]
    v_mfma_f32_16x16x32_bf16 v[120:123], v[32:35], v[56:59], v[120:123]
    v_mfma_f32_16x16x32_bf16 v[124:127], v[20:23], v[52:55], v[124:127]
    v_mfma_f32_16x16x32_bf16 v[124:127], v[36:39], v[56:59], v[124:127]
    v_mfma_f32_16x16x32_bf16 v[128:131], v[24:27], v[52:55], v[128:131]
    ds_read_b64_tr_b16 v[52:53], v10 offset:0
    v_mfma_f32_16x16x32_bf16 v[128:131], v[40:43], v[56:59], v[128:131]
    ds_read_b64_tr_b16 v[54:55], v10 offset:512
    s_waitcnt lgkmcnt(5)
    v_mfma_f32_16x16x32_bf16 v[132:135], v[12:15], v[60:63], v[132:135]
    ds_read_b64_tr_b16 v[56:57], v10 offset:4096
    v_mfma_f32_16x16x32_bf16 v[132:135], v[28:31], v[64:67], v[132:135]
    ds_read_b64_tr_b16 v[58:59], v10 offset:4608
    v_mfma_f32_16x16x32_bf16 v[136:139], v[16:19], v[60:63], v[136:139]
    v_mfma_f32_16x16x32_bf16 v[136:139], v[32:35], v[64:67], v[136:139]
    v_mfma_f32_16x16x32_bf16 v[140:143], v[20:23], v[60:63], v[140:143]
    v_mfma_f32_16x16x32_bf16 v[140:143], v[36:39], v[64:67], v[140:143]
    v_mfma_f32_16x16x32_bf16 v[144:147], v[24:27], v[60:63], v[144:147]
    ds_read_b64_tr_b16 v[60:61], v11 offset:0
    v_mfma_f32_16x16x32_bf16 v[144:147], v[40:43], v[64:67], v[144:147]
    ds_read_b64_tr_b16 v[62:63], v11 offset:512
    s_waitcnt lgkmcnt(5)
    v_mfma_f32_16x16x32_bf16 v[148:151], v[12:15], v[44:47], v[148:151]
    ds_read_b64_tr_b16 v[64:65], v11 offset:4096
    v_mfma_f32_16x16x32_bf16 v[148:151], v[28:31], v[48:51], v[148:151]
    ds_read_b64_tr_b16 v[66:67], v11 offset:4608
    v_mfma_f32_16x16x32_bf16 v[152:155], v[16:19], v[44:47], v[152:155]
    v_mfma_f32_16x16x32_bf16 v[152:155], v[32:35], v[48:51], v[152:155]
    v_mfma_f32_16x16x32_bf16 v[156:159], v[20:23], v[44:47], v[156:159]
    v_mfma_f32_16x16x32_bf16 v[156:159], v[36:39], v[48:51], v[156:159]
    s_waitcnt lgkmcnt(0)
    s_barrier
    v_mfma_f32_16x16x32_bf16 v[160:163], v[24:27], v[44:47], v[160:163]
    ds_read_b64_tr_b16 v[44:45], v10 offset:49152
    v_mfma_f32_16x16x32_bf16 v[160:163], v[40:43], v[48:51], v[160:163]
    ds_read_b64_tr_b16 v[46:47], v10 offset:49664
    v_mfma_f32_16x16x32_bf16 v[68:71], v[52:55], v[12:15], v[68:71]
    ds_read_b64_tr_b16 v[48:49], v10 offset:53248
    v_mfma_f32_16x16x32_bf16 v[68:71], v[56:59], v[28:31], v[68:71]
    ds_read_b64_tr_b16 v[50:51], v10 offset:53760
    v_mfma_f32_16x16x32_bf16 v[84:87], v[60:63], v[12:15], v[84:87]
    ds_read_b128 v[12:15], v6 offset:40960
    v_mfma_f32_16x16x32_bf16 v[84:87], v[64:67], v[28:31], v[84:87]
    ds_read_b128 v[28:31], v7 offset:40960
    v_mfma_f32_16x16x32_bf16 v[72:75], v[52:55], v[16:19], v[72:75]
    v_mfma_f32_16x16x32_bf16 v[72:75], v[56:59], v[32:35], v[72:75]
    v_mfma_f32_16x16x32_bf16 v[88:91], v[60:63], v[16:19], v[88:91]
    ds_read_b128 v[16:19], v6 offset:43008
    v_mfma_f32_16x16x32_bf16 v[88:91], v[64:67], v[32:35], v[88:91]
    ds_read_b128 v[32:35], v7 offset:43008
    v_mfma_f32_16x16x32_bf16 v[76:79], v[52:55], v[20:23], v[76:79]
    v_mfma_f32_16x16x32_bf16 v[76:79], v[56:59], v[36:39], v[76:79]
    v_mfma_f32_16x16x32_bf16 v[92:95], v[60:63], v[20:23], v[92:95]
    ds_read_b128 v[20:23], v6 offset:45056
    v_mfma_f32_16x16x32_bf16 v[92:95], v[64:67], v[36:39], v[92:95]
    ds_read_b128 v[36:39], v7 offset:45056
    v_mfma_f32_16x16x32_bf16 v[80:83], v[52:55], v[24:27], v[80:83]
    ds_read_b64_tr_b16 v[52:53], v11 offset:49152
    v_mfma_f32_16x16x32_bf16 v[80:83], v[56:59], v[40:43], v[80:83]
    ds_read_b64_tr_b16 v[54:55], v11 offset:49664
    v_mfma_f32_16x16x32_bf16 v[96:99], v[60:63], v[24:27], v[96:99]
    ds_read_b128 v[24:27], v6 offset:47104
    v_mfma_f32_16x16x32_bf16 v[96:99], v[64:67], v[40:43], v[96:99]
    ds_read_b128 v[40:43], v7 offset:47104
    s_waitcnt lgkmcnt(7)
    v_mfma_f32_16x16x32_bf16 v[100:103], v[12:15], v[44:47], v[100:103]
    ds_read_b64_tr_b16 v[56:57], v11 offset:53248
    v_mfma_f32_16x16x32_bf16 v[100:103], v[28:31], v[48:51], v[100:103]
    ds_read_b64_tr_b16 v[58:59], v11 offset:53760
    v_mfma_f32_16x16x32_bf16 v[104:107], v[16:19], v[44:47], v[104:107]
    ds_read_b64_tr_b16 v[60:61], v10 offset:57344
    s_waitcnt lgkmcnt(9)
    v_mfma_f32_16x16x32_bf16 v[104:107], v[32:35], v[48:51], v[104:107]
    ds_read_b64_tr_b16 v[62:63], v10 offset:57856
    s_waitcnt lgkmcnt(9)
    v_mfma_f32_16x16x32_bf16 v[108:111], v[20:23], v[44:47], v[108:111]
    ds_read_b64_tr_b16 v[64:65], v10 offset:61440
    s_waitcnt lgkmcnt(9)
    v_mfma_f32_16x16x32_bf16 v[108:111], v[36:39], v[48:51], v[108:111]
    ds_read_b64_tr_b16 v[66:67], v10 offset:61952
    s_waitcnt lgkmcnt(7)
    v_mfma_f32_16x16x32_bf16 v[112:115], v[24:27], v[44:47], v[112:115]
    ds_read_b64_tr_b16 v[44:45], v11 offset:57344
    s_waitcnt lgkmcnt(7)
    v_mfma_f32_16x16x32_bf16 v[112:115], v[40:43], v[48:51], v[112:115]
    ds_read_b64_tr_b16 v[46:47], v11 offset:57856
    v_mfma_f32_16x16x32_bf16 v[116:119], v[12:15], v[52:55], v[116:119]
    ds_read_b64_tr_b16 v[48:49], v11 offset:61440
    s_waitcnt lgkmcnt(7)
    v_mfma_f32_16x16x32_bf16 v[116:119], v[28:31], v[56:59], v[116:119]
    ds_read_b64_tr_b16 v[50:51], v11 offset:61952
    v_mfma_f32_16x16x32_bf16 v[120:123], v[16:19], v[52:55], v[120:123]
    v_mfma_f32_16x16x32_bf16 v[120:123], v[32:35], v[56:59], v[120:123]
    v_mfma_f32_16x16x32_bf16 v[124:127], v[20:23], v[52:55], v[124:127]
    v_mfma_f32_16x16x32_bf16 v[124:127], v[36:39], v[56:59], v[124:127]
    v_mfma_f32_16x16x32_bf16 v[128:131], v[24:27], v[52:55], v[128:131]
    ds_read_b64_tr_b16 v[52:53], v10 offset:40960
    v_mfma_f32_16x16x32_bf16 v[128:131], v[40:43], v[56:59], v[128:131]
    ds_read_b64_tr_b16 v[54:55], v10 offset:41472
    s_waitcnt lgkmcnt(5)
    v_mfma_f32_16x16x32_bf16 v[132:135], v[12:15], v[60:63], v[132:135]
    ds_read_b64_tr_b16 v[56:57], v10 offset:45056
    v_mfma_f32_16x16x32_bf16 v[132:135], v[28:31], v[64:67], v[132:135]
    ds_read_b64_tr_b16 v[58:59], v10 offset:45568
    v_mfma_f32_16x16x32_bf16 v[136:139], v[16:19], v[60:63], v[136:139]
    v_mfma_f32_16x16x32_bf16 v[136:139], v[32:35], v[64:67], v[136:139]
    v_mfma_f32_16x16x32_bf16 v[140:143], v[20:23], v[60:63], v[140:143]
    v_mfma_f32_16x16x32_bf16 v[140:143], v[36:39], v[64:67], v[140:143]
    v_mfma_f32_16x16x32_bf16 v[144:147], v[24:27], v[60:63], v[144:147]
    ds_read_b64_tr_b16 v[60:61], v11 offset:40960
    v_mfma_f32_16x16x32_bf16 v[144:147], v[40:43], v[64:67], v[144:147]
    ds_read_b64_tr_b16 v[62:63], v11 offset:41472
    s_waitcnt lgkmcnt(5)
    v_mfma_f32_16x16x32_bf16 v[148:151], v[12:15], v[44:47], v[148:151]
    ds_read_b64_tr_b16 v[64:65], v11 offset:45056
    v_mfma_f32_16x16x32_bf16 v[148:151], v[28:31], v[48:51], v[148:151]
    ds_read_b64_tr_b16 v[66:67], v11 offset:45568
    v_mfma_f32_16x16x32_bf16 v[152:155], v[16:19], v[44:47], v[152:155]
    v_mfma_f32_16x16x32_bf16 v[152:155], v[32:35], v[48:51], v[152:155]
    v_mfma_f32_16x16x32_bf16 v[156:159], v[20:23], v[44:47], v[156:159]
    v_mfma_f32_16x16x32_bf16 v[156:159], v[36:39], v[48:51], v[156:159]
    s_waitcnt lgkmcnt(0)
    s_barrier
    v_mfma_f32_16x16x32_bf16 v[160:163], v[24:27], v[44:47], v[160:163]
    ds_read_b64_tr_b16 v[44:45], v8 offset:8192
    v_mfma_f32_16x16x32_bf16 v[160:163], v[40:43], v[48:51], v[160:163]
    ds_read_b64_tr_b16 v[46:47], v8 offset:8704
    v_mfma_f32_16x16x32_bf16 v[68:71], v[52:55], v[12:15], v[68:71]
    ds_read_b64_tr_b16 v[48:49], v8 offset:12288
    v_mfma_f32_16x16x32_bf16 v[68:71], v[56:59], v[28:31], v[68:71]
    ds_read_b64_tr_b16 v[50:51], v8 offset:12800
    v_mfma_f32_16x16x32_bf16 v[84:87], v[60:63], v[12:15], v[84:87]
    ds_read_b128 v[12:15], v4 offset:0
    v_mfma_f32_16x16x32_bf16 v[84:87], v[64:67], v[28:31], v[84:87]
    ds_read_b128 v[28:31], v5 offset:0
    v_mfma_f32_16x16x32_bf16 v[72:75], v[52:55], v[16:19], v[72:75]
    v_mfma_f32_16x16x32_bf16 v[72:75], v[56:59], v[32:35], v[72:75]
    v_mfma_f32_16x16x32_bf16 v[88:91], v[60:63], v[16:19], v[88:91]
    ds_read_b128 v[16:19], v4 offset:2048
    v_mfma_f32_16x16x32_bf16 v[88:91], v[64:67], v[32:35], v[88:91]
    ds_read_b128 v[32:35], v5 offset:2048
    v_mfma_f32_16x16x32_bf16 v[76:79], v[52:55], v[20:23], v[76:79]
    v_mfma_f32_16x16x32_bf16 v[76:79], v[56:59], v[36:39], v[76:79]
    s_sub_u32 s81, s81, 1
    s_cmp_lg_u32 s81, 0
    v_mfma_f32_16x16x32_bf16 v[92:95], v[60:63], v[20:23], v[92:95]
    ds_read_b128 v[20:23], v4 offset:4096
    v_mfma_f32_16x16x32_bf16 v[92:95], v[64:67], v[36:39], v[92:95]
    ds_read_b128 v[36:39], v5 offset:4096
    v_mfma_f32_16x16x32_bf16 v[80:83], v[52:55], v[24:27], v[80:83]
    ds_read_b64_tr_b16 v[52:53], v9 offset:8192
    v_mfma_f32_16x16x32_bf16 v[80:83], v[56:59], v[40:43], v[80:83]
    ds_read_b64_tr_b16 v[54:55], v9 offset:8704
    v_mfma_f32_16x16x32_bf16 v[96:99], v[60:63], v[24:27], v[96:99]
    ds_read_b128 v[24:27], v4 offset:6144
    v_mfma_f32_16x16x32_bf16 v[96:99], v[64:67], v[40:43], v[96:99]
    ds_read_b128 v[40:43], v5 offset:6144
    s_cbranch_scc1 F_p1
    s_waitcnt lgkmcnt(7)
    v_mfma_f32_16x16x32_bf16 v[100:103], v[12:15], v[44:47], v[100:103]
    ds_read_b64_tr_b16 v[56:57], v9 offset:12288
    v_mfma_f32_16x16x32_bf16 v[100:103], v[28:31], v[48:51], v[100:103]
    ds_read_b64_tr_b16 v[58:59], v9 offset:12800
    v_mfma_f32_16x16x32_bf16 v[104:107], v[16:19], v[44:47], v[104:107]
    ds_read_b64_tr_b16 v[60:61], v8 offset:16384
    s_waitcnt lgkmcnt(9)
    v_mfma_f32_16x16x32_bf16 v[104:107], v[32:35], v[48:51], v[104:107]
    ds_read_b64_tr_b16 v[62:63], v8 offset:16896
    s_waitcnt lgkmcnt(9)
    v_mfma_f32_16x16x32_bf16 v[108:111], v[20:23], v[44:47], v[108:111]
    ds_read_b64_tr_b16 v[64:65], v8 offset:20480
    s_waitcnt lgkmcnt(9)
    v_mfma_f32_16x16x32_bf16 v[108:111], v[36:39], v[48:51], v[108:111]
    ds_read_b64_tr_b16 v[66:67], v8 offset:20992
    s_waitcnt lgkmcnt(7)
    v_mfma_f32_16x16x32_bf16 v[112:115], v[24:27], v[44:47], v[112:115]
    ds_read_b64_tr_b16 v[44:45], v9 offset:16384
    s_waitcnt lgkmcnt(7)
    v_mfma_f32_16x16x32_bf16 v[112:115], v[40:43], v[48:51], v[112:115]
    ds_read_b64_tr_b16 v[46:47], v9 offset:16896
    v_mfma_f32_16x16x32_bf16 v[116:119], v[12:15], v[52:55], v[116:119]
    ds_read_b64_tr_b16 v[48:49], v9 offset:20480
    s_waitcnt lgkmcnt(7)
    v_mfma_f32_16x16x32_bf16 v[116:119], v[28:31], v[56:59], v[116:119]
    ds_read_b64_tr_b16 v[50:51], v9 offset:20992
    v_mfma_f32_16x16x32_bf16 v[120:123], v[16:19], v[52:55], v[120:123]
    v_mfma_f32_16x16x32_bf16 v[120:123], v[32:35], v[56:59], v[120:123]
    v_mfma_f32_16x16x32_bf16 v[124:127], v[20:23], v[52:55], v[124:127]
    v_mfma_f32_16x16x32_bf16 v[124:127], v[36:39], v[56:59], v[124:127]
    s_waitcnt lgkmcnt(0)
    s_barrier
    v_mfma_f32_16x16x32_bf16 v[128:131], v[24:27], v[52:55], v[128:131]
    ds_read_b64_tr_b16 v[52:53], v8 offset:49152
    v_mfma_f32_16x16x32_bf16 v[128:131], v[40:43], v[56:59], v[128:131]
    ds_read_b64_tr_b16 v[54:55], v8 offset:49664
    v_mfma_f32_16x16x32_bf16 v[132:135], v[12:15], v[60:63], v[132:135]
    ds_read_b64_tr_b16 v[56:57], v8 offset:53248
    v_mfma_f32_16x16x32_bf16 v[132:135], v[28:31], v[64:67], v[132:135]
    ds_read_b64_tr_b16 v[58:59], v8 offset:53760
    v_mfma_f32_16x16x32_bf16 v[148:151], v[12:15], v[44:47], v[148:151]
    ds_read_b128 v[12:15], v4 offset:40960
    v_mfma_f32_16x16x32_bf16 v[148:151], v[28:31], v[48:51], v[148:151]
    ds_read_b128 v[28:31], v5 offset:40960
    v_mfma_f32_16x16x32_bf16 v[136:139], v[16:19], v[60:63], v[136:139]
    v_mfma_f32_16x16x32_bf16 v[136:139], v[32:35], v[64:67], v[136:139]
    v_mfma_f32_16x16x32_bf16 v[152:155], v[16:19], v[44:47], v[152:155]
    ds_read_b128 v[16:19], v4 offset:43008
    v_mfma_f32_16x16x32_bf16 v[152:155], v[32:35], v[48:51], v[152:155]
    ds_read_b128 v[32:35], v5 offset:43008
    v_mfma_f32_16x16x32_bf16 v[140:143], v[20:23], v[60:63], v[140:143]
    v_mfma_f32_16x16x32_bf16 v[140:143], v[36:39], v[64:67], v[140:143]
    v_mfma_f32_16x16x32_bf16 v[156:159], v[20:23], v[44:47], v[156:159]
    ds_read_b128 v[20:23], v4 offset:45056
    v_mfma_f32_16x16x32_bf16 v[156:159], v[36:39], v[48:51], v[156:159]
    ds_read_b128 v[36:39], v5 offset:45056
    v_mfma_f32_16x16x32_bf16 v[144:147], v[24:27], v[60:63], v[144:147]
    ds_read_b64_tr_b16 v[60:61], v9 offset:49152
    v_mfma_f32_16x16x32_bf16 v[144:147], v[40:43], v[64:67], v[144:147]
    ds_read_b64_tr_b16 v[62:63], v9 offset:49664
    v_mfma_f32_16x16x32_bf16 v[160:163], v[24:27], v[44:47], v[160:163]
    ds_read_b128 v[24:27], v4 offset:47104
    v_mfma_f32_16x16x32_bf16 v[160:163], v[40:43], v[48:51], v[160:163]
    ds_read_b128 v[40:43], v5 offset:47104
    s_waitcnt lgkmcnt(7)
    v_mfma_f32_16x16x32_bf16 v[100:103], v[12:15], v[52:55], v[100:103]
    ds_read_b64_tr_b16 v[64:65], v9 offset:53248
    v_mfma_f32_16x16x32_bf16 v[100:103], v[28:31], v[56:59], v[100:103]
    ds_read_b64_tr_b16 v[66:67], v9 offset:53760
    v_mfma_f32_16x16x32_bf16 v[104:107], v[16:19], v[52:55], v[104:107]
    ds_read_b64_tr_b16 v[44:45], v8 offset:57344
    s_waitcnt lgkmcnt(9)
    v_mfma_f32_16x16x32_bf16 v[104:107], v[32:35], v[56:59], v[104:107]
    ds_read_b64_tr_b16 v[46:47], v8 offset:57856
    s_waitcnt lgkmcnt(9)
    v_mfma_f32_16x16x32_bf16 v[108:111], v[20:23], v[52:55], v[108:111]
    ds_read_b64_tr_b16 v[48:49], v8 offset:61440
    s_waitcnt lgkmcnt(9)
    v_mfma_f32_16x16x32_bf16 v[108:111], v[36:39], v[56:59], v[108:111]
    ds_read_b64_tr_b16 v[50:51], v8 offset:61952
    s_waitcnt lgkmcnt(7)
    v_mfma_f32_16x16x32_bf16 v[112:115], v[24:27], v[52:55], v[112:115]
    ds_read_b64_tr_b16 v[52:53], v9 offset:57344
    s_waitcnt lgkmcnt(7)
    v_mfma_f32_16x16x32_bf16 v[112:115], v[40:43], v[56:59], v[112:115]
    ds_read_b64_tr_b16 v[54:55], v9 offset:57856
    v_mfma_f32_16x16x32_bf16 v[116:119], v[12:15], v[60:63], v[116:119]
    ds_read_b64_tr_b16 v[56:57], v9 offset:61440
    s_waitcnt lgkmcnt(7)
    v_mfma_f32_16x16x32_bf16 v[116:119], v[28:31], v[64:67], v[116:119]
    ds_read_b64_tr_b16 v[58:59], v9 offset:61952
    v_mfma_f32_16x16x32_bf16 v[120:123], v[16:19], v[60:63], v[120:123]
    v_mfma_f32_16x16x32_bf16 v[120:123], v[32:35], v[64:67], v[120:123]
    v_mfma_f32_16x16x32_bf16 v[124:127], v[20:23], v[60:63], v[124:127]
    v_mfma_f32_16x16x32_bf16 v[124:127], v[36:39], v[64:67], v[124:127]
    s_waitcnt lgkmcnt(0)
    s_barrier
    v_mfma_f32_16x16x32_bf16 v[128:131], v[24:27], v[60:63], v[128:131]
    ds_read_b64_tr_b16 v[60:61], v10 offset:8192
    v_mfma_f32_16x16x32_bf16 v[128:131], v[40:43], v[64:67], v[128:131]
    ds_read_b64_tr_b16 v[62:63], v10 offset:8704
    v_mfma_f32_16x16x32_bf16 v[132:135], v[12:15], v[44:47], v[132:135]
    ds_read_b64_tr_b16 v[64:65], v10 offset:12288
    v_mfma_f32_16x16x32_bf16 v[132:135], v[28:31], v[48:51], v[132:135]
    ds_read_b64_tr_b16 v[66:67], v10 offset:12800
W_1:
    s_cbranch_execz R_1
    s_nop 0
    v_mfma_f32_16x16x32_bf16 v[148:151], v[12:15], v[52:55], v[148:151]
    ds_read_b128 v[12:15], v6 offset:0
    v_mfma_f32_16x16x32_bf16 v[148:151], v[28:31], v[56:59], v[148:151]
    ds_read_b128 v[28:31], v7 offset:0
    v_mfma_f32_16x16x32_bf16 v[136:139], v[16:19], v[44:47], v[136:139]
    v_mfma_f32_16x16x32_bf16 v[136:139], v[32:35], v[48:51], v[136:139]
    v_mfma_f32_16x16x32_bf16 v[152:155], v[16:19], v[52:55], v[152:155]
    ds_read_b128 v[16:19], v6 offset:2048
    v_mfma_f32_16x16x32_bf16 v[152:155], v[32:35], v[56:59], v[152:155]
    ds_read_b128 v[32:35], v7 offset:2048
    v_mfma_f32_16x16x32_bf16 v[140:143], v[20:23], v[44:47], v[140:143]
    v_mfma_f32_16x16x32_bf16 v[140:143], v[36:39], v[48:51], v[140:143]
    v_mfma_f32_16x16x32_bf16 v[156:159], v[20:23], v[52:55], v[156:159]
    ds_read_b128 v[20:23], v6 offset:4096
    v_mfma_f32_16x16x32_bf16 v[156:159], v[36:39], v[56:59], v[156:159]
    ds_read_b128 v[36:39], v7 offset:4096
    v_mfma_f32_16x16x32_bf16 v[144:147], v[24:27], v[44:47], v[144:147]
    ds_read_b64_tr_b16 v[44:45], v11 offset:8192
    v_mfma_f32_16x16x32_bf16 v[144:147], v[40:43], v[48:51], v[144:147]
    ds_read_b64_tr_b16 v[46:47], v11 offset:8704
    v_mfma_f32_16x16x32_bf16 v[160:163], v[24:27], v[52:55], v[160:163]
    ds_read_b128 v[24:27], v6 offset:6144
    v_mfma_f32_16x16x32_bf16 v[160:163], v[40:43], v[56:59], v[160:163]
    ds_read_b128 v[40:43], v7 offset:6144
    s_waitcnt lgkmcnt(7)
    v_mfma_f32_16x16x32_bf16 v[100:103], v[12:15], v[60:63], v[100:103]
    ds_read_b64_tr_b16 v[48:49], v11 offset:12288
    v_mfma_f32_16x16x32_bf16 v[100:103], v[28:31], v[64:67], v[100:103]
    ds_read_b64_tr_b16 v[50:51], v11 offset:12800
    v_mfma_f32_16x16x32_bf16 v[104:107], v[16:19], v[60:63], v[104:107]
    ds_read_b64_tr_b16 v[52:53], v10 offset:16384
    s_waitcnt lgkmcnt(9)
    v_mfma_f32_16x16x32_bf16 v[104:107], v[32:35], v[64:67], v[104:107]
    ds_read_b64_tr_b16 v[54:55], v10 offset:16896
    s_waitcnt lgkmcnt(9)
    v_mfma_f32_16x16x32_bf16 v[108:111], v[20:23], v[60:63], v[108:111]
    ds_read_b64_tr_b16 v[56:57], v10 offset:20480
    s_waitcnt lgkmcnt(9)
    v_mfma_f32_16x16x32_bf16 v[108:111], v[36:39], v[64:67], v[108:111]
    ds_read_b64_tr_b16 v[58:59], v10 offset:20992
    s_waitcnt lgkmcnt(7)
    v_mfma_f32_16x16x32_bf16 v[112:115], v[24:27], v[60:63], v[112:115]
    ds_read_b64_tr_b16 v[60:61], v11 offset:16384
    s_waitcnt lgkmcnt(7)
    v_mfma_f32_16x16x32_bf16 v[112:115], v[40:43], v[64:67], v[112:115]
    ds_read_b64_tr_b16 v[62:63], v11 offset:16896
    v_mfma_f32_16x16x32_bf16 v[116:119], v[12:15], v[44:47], v[116:119]
    ds_read_b64_tr_b16 v[64:65], v11 offset:20480
    s_waitcnt lgkmcnt(7)
    v_mfma_f32_16x16x32_bf16 v[116:119], v[28:31], v[48:51], v[116:119]
    ds_read_b64_tr_b16 v[66:67], v11 offset:20992
    v_mfma_f32_16x16x32_bf16 v[120:123], v[16:19], v[44:47], v[120:123]
    v_mfma_f32_16x16x32_bf16 v[120:123], v[32:35], v[48:51], v[120:123]
    v_mfma_f32_16x16x32_bf16 v[124:127], v[20:23], v[44:47], v[124:127]
    v_mfma_f32_16x16x32_bf16 v[124:127], v[36:39], v[48:51], v[124:127]
    s_waitcnt lgkmcnt(0)
    s_barrier
    v_mfma_f32_16x16x32_bf16 v[128:131], v[24:27], v[44:47], v[128:131]
    ds_read_b64_tr_b16 v[44:45], v10 offset:49152
    v_mfma_f32_16x16x32_bf16 v[128:131], v[40:43], v[48:51], v[128:131]
    ds_read_b64_tr_b16 v[46:47], v10 offset:49664
    v_mfma_f32_16x16x32_bf16 v[132:135], v[12:15], v[52:55], v[132:135]
    ds_read_b64_tr_b16 v[48:49], v10 offset:53248
    v_mfma_f32_16x16x32_bf16 v[132:135], v[28:31], v[56:59], v[132:135]
    ds_read_b64_tr_b16 v[50:51], v10 offset:53760
    v_mfma_f32_16x16x32_bf16 v[148:151], v[12:15], v[60:63], v[148:151]
    ds_read_b128 v[12:15], v6 offset:40960
    v_mfma_f32_16x16x32_bf16 v[148:151], v[28:31], v[64:67], v[148:151]
    ds_read_b128 v[28:31], v7 offset:40960
    v_mfma_f32_16x16x32_bf16 v[136:139], v[16:19], v[52:55], v[136:139]
    v_mfma_f32_16x16x32_bf16 v[136:139], v[32:35], v[56:59], v[136:139]
    v_mfma_f32_16x16x32_bf16 v[152:155], v[16:19], v[60:63], v[152:155]
    ds_read_b128 v[16:19], v6 offset:43008
    v_mfma_f32_16x16x32_bf16 v[152:155], v[32:35], v[64:67], v[152:155]
    ds_read_b128 v[32:35], v7 offset:43008
    v_mfma_f32_16x16x32_bf16 v[140:143], v[20:23], v[52:55], v[140:143]
    v_mfma_f32_16x16x32_bf16 v[140:143], v[36:39], v[56:59], v[140:143]
    v_mfma_f32_16x16x32_bf16 v[156:159], v[20:23], v[60:63], v[156:159]
    ds_read_b128 v[20:23], v6 offset:45056
    v_mfma_f32_16x16x32_bf16 v[156:159], v[36:39], v[64:67], v[156:159]
    ds_read_b128 v[36:39], v7 offset:45056
    v_mfma_f32_16x16x32_bf16 v[144:147], v[24:27], v[52:55], v[144:147]
    ds_read_b64_tr_b16 v[52:53], v11 offset:49152
    v_mfma_f32_16x16x32_bf16 v[144:147], v[40:43], v[56:59], v[144:147]
    ds_read_b64_tr_b16 v[54:55], v11 offset:49664
    v_mfma_f32_16x16x32_bf16 v[160:163], v[24:27], v[60:63], v[160:163]
    ds_read_b128 v[24:27], v6 offset:47104
    v_mfma_f32_16x16x32_bf16 v[160:163], v[40:43], v[64:67], v[160:163]
    ds_read_b128 v[40:43], v7 offset:47104
    s_waitcnt lgkmcnt(7)
    v_mfma_f32_16x16x32_bf16 v[100:103], v[12:15], v[44:47], v[100:103]
    ds_read_b64_tr_b16 v[56:57], v11 offset:53248
    v_mfma_f32_16x16x32_bf16 v[100:103], v[28:31], v[48:51], v[100:103]
    ds_read_b64_tr_b16 v[58:59], v11 offset:53760
    v_mfma_f32_16x16x32_bf16 v[104:107], v[16:19], v[44:47], v[104:107]
    ds_read_b64_tr_b16 v[60:61], v10 offset:57344
    s_waitcnt lgkmcnt(9)
    v_mfma_f32_16x16x32_bf16 v[104:107], v[32:35], v[48:51], v[104:107]
    ds_read_b64_tr_b16 v[62:63], v10 offset:57856
    s_waitcnt lgkmcnt(9)
    v_mfma_f32_16x16x32_bf16 v[108:111], v[20:23], v[44:47], v[108:111]
    ds_read_b64_tr_b16 v[64:65], v10 offset:61440
    s_waitcnt lgkmcnt(9)
    v_mfma_f32_16x16x32_bf16 v[108:111], v[36:39], v[48:51], v[108:111]
    ds_read_b64_tr_b16 v[66:67], v10 offset:61952
    s_waitcnt lgkmcnt(7)
    v_mfma_f32_16x16x32_bf16 v[112:115], v[24:27], v[44:47], v[112:115]
    ds_read_b64_tr_b16 v[44:45], v11 offset:57344
    s_waitcnt lgkmcnt(7)
    v_mfma_f32_16x16x32_bf16 v[112:115], v[40:43], v[48:51], v[112:115]
    ds_read_b64_tr_b16 v[46:47], v11 offset:57856
    v_mfma_f32_16x16x32_bf16 v[116:119], v[12:15], v[52:55], v[116:119]
    ds_read_b64_tr_b16 v[48:49], v11 offset:61440
    s_waitcnt lgkmcnt(7)
    v_mfma_f32_16x16x32_bf16 v[116:119], v[28:31], v[56:59], v[116:119]
    ds_read_b64_tr_b16 v[50:51], v11 offset:61952
    v_mfma_f32_16x16x32_bf16 v[120:123], v[16:19], v[52:55], v[120:123]
    v_mfma_f32_16x16x32_bf16 v[120:123], v[32:35], v[56:59], v[120:123]
    v_mfma_f32_16x16x32_bf16 v[124:127], v[20:23], v[52:55], v[124:127]
    v_mfma_f32_16x16x32_bf16 v[124:127], v[36:39], v[56:59], v[124:127]
    v_mfma_f32_16x16x32_bf16 v[128:131], v[24:27], v[52:55], v[128:131]
    ds_read2_b32 v[52:53], v165 offset0:64 offset1:64
    v_mfma_f32_16x16x32_bf16 v[128:131], v[40:43], v[56:59], v[128:131]
    ds_read2_b32 v[54:55], v165 offset0:80 offset1:80
    s_waitcnt lgkmcnt(5)
    v_mfma_f32_16x16x32_bf16 v[132:135], v[12:15], v[60:63], v[132:135]
    ds_read2_b32 v[56:57], v165 offset0:128 offset1:128
    v_mfma_f32_16x16x32_bf16 v[132:135], v[28:31], v[64:67], v[132:135]
    ds_read2_b32 v[58:59], v165 offset0:144 offset1:144
    s_waitcnt lgkmcnt(5)
    v_mfma_f32_16x16x32_bf16 v[148:151], v[12:15], v[44:47], v[148:151]
    ds_read_b128 v[12:15], v164 offset:0
    s_waitcnt lgkmcnt(5)
    v_mfma_f32_16x16x32_bf16 v[148:151], v[28:31], v[48:51], v[148:151]
    ds_read_b128 v[28:31], v164 offset:512
    v_mfma_f32_16x16x32_bf16 v[136:139], v[16:19], v[60:63], v[136:139]
    v_mfma_f32_16x16x32_bf16 v[136:139], v[32:35], v[64:67], v[136:139]
    v_mfma_f32_16x16x32_bf16 v[152:155], v[16:19], v[44:47], v[152:155]
    ds_read_b128 v[16:19], v164 offset:64
    v_mfma_f32_16x16x32_bf16 v[152:155], v[32:35], v[48:51], v[152:155]
    ds_read_b128 v[32:35], v164 offset:576
    v_mfma_f32_16x16x32_bf16 v[140:143], v[20:23], v[60:63], v[140:143]
    v_mfma_f32_16x16x32_bf16 v[140:143], v[36:39], v[64:67], v[140:143]
    v_mfma_f32_16x16x32_bf16 v[156:159], v[20:23], v[44:47], v[156:159]
    v_mfma_f32_16x16x32_bf16 v[156:159], v[36:39], v[48:51], v[156:159]
    v_mfma_f32_16x16x32_bf16 v[144:147], v[24:27], v[60:63], v[144:147]
    ds_read_b128 v[60:63], v164 offset:1024
    v_mfma_f32_16x16x32_bf16 v[144:147], v[40:43], v[64:67], v[144:147]
    ds_read_b128 v[64:67], v164 offset:1088
    v_mfma_f32_16x16x32_bf16 v[160:163], v[24:27], v[44:47], v[160:163]
    v_mfma_f32_16x16x32_bf16 v[160:163], v[40:43], v[48:51], v[160:163]
    s_mov_b32 s50, 0x10001
    s_mov_b32 s51, s50
    ds_read_b128 v[36:39], v164 offset:128
    ds_read_b128 v[40:43], v164 offset:192
    ds_read_b128 v[44:47], v164 offset:640
    ds_read_b128 v[48:51], v164 offset:704
    s_waitcnt lgkmcnt(9)
    v_pk_fma_f32 v[100:101], v[12:13], v[52:53], v[100:101]
    v_pk_fma_f32 v[102:103], v[14:15], v[52:53], v[102:103]
    s_waitcnt lgkmcnt(7)
    v_pk_fma_f32 v[104:105], v[16:17], v[52:53], v[104:105]
    v_pk_fma_f32 v[106:107], v[18:19], v[52:53], v[106:107]
    s_waitcnt lgkmcnt(5)
    v_pk_mul_f32 v[20:21], v[100:101], v[60:61]
    v_pk_mul_f32 v[22:23], v[102:103], v[62:63]
    s_waitcnt lgkmcnt(4)
    v_pk_mul_f32 v[24:25], v[104:105], v[64:65]
    v_pk_mul_f32 v[26:27], v[106:107], v[66:67]
    v_pk_fma_f32 v[100:101], v[100:101], v[28:29], s[40:41]
    v_pk_fma_f32 v[102:103], v[102:103], v[30:31], s[40:41]
    v_pk_fma_f32 v[104:105], v[104:105], v[32:33], s[40:41]
    v_pk_fma_f32 v[106:107], v[106:107], v[34:35], s[40:41]
    v_exp_f32 v20, v20 clamp
    v_exp_f32 v21, v21 clamp
    v_exp_f32 v22, v22 clamp
    v_exp_f32 v23, v23 clamp
    v_exp_f32 v24, v24 clamp
    v_exp_f32 v25, v25 clamp
    v_exp_f32 v26, v26 clamp
    v_exp_f32 v27, v27 clamp
    v_pk_add_f32 v[20:21], v[20:21], s[74:75]
    v_pk_add_f32 v[22:23], v[22:23], s[74:75]
    v_pk_add_f32 v[24:25], v[24:25], s[74:75]
    v_pk_add_f32 v[26:27], v[26:27], s[74:75]
    v_max_f32 v100, v100, v20
    v_max_f32 v101, v101, v21
    v_max_f32 v102, v102, v22
    v_max_f32 v103, v103, v23
    v_max_f32 v104, v104, v24
    v_max_f32 v105, v105, v25
    v_max_f32 v106, v106, v26
    v_max_f32 v107, v107, v27
    v_cvt_pk_bf16_f32 v100, v100, v101
    v_cvt_pk_bf16_f32 v101, v102, v103
    v_cvt_pk_bf16_f32 v102, v104, v105
    v_cvt_pk_bf16_f32 v103, v106, v107
    s_waitcnt lgkmcnt(3)
    v_pk_fma_f32 v[140:141], v[36:37], v[56:57], v[140:141]
    v_pk_fma_f32 v[142:143], v[38:39], v[56:57], v[142:143]
    s_waitcnt lgkmcnt(2)
    v_pk_fma_f32 v[144:145], v[40:41], v[56:57], v[144:145]
    v_pk_fma_f32 v[146:147], v[42:43], v[56:57], v[146:147]
    s_waitcnt lgkmcnt(1)
    v_pk_mul_f32 v[140:141], v[140:141], v[44:45]
    v_pk_mul_f32 v[142:143], v[142:143], v[46:47]
    s_waitcnt lgkmcnt(0)
    v_pk_mul_f32 v[144:145], v[144:145], v[48:49]
    v_pk_mul_f32 v[146:147], v[146:147], v[50:51]
    v_cvt_pk_bf16_f32 v140, v140, v141
    v_cvt_pk_bf16_f32 v141, v142, v143
    v_cvt_pk_bf16_f32 v142, v144, v145
    v_cvt_pk_bf16_f32 v143, v146, v147
    v_pk_fma_f32 v[156:157], v[36:37], v[58:59], v[156:157]
    v_pk_fma_f32 v[158:159], v[38:39], v[58:59], v[158:159]
    v_pk_fma_f32 v[160:161], v[40:41], v[58:59], v[160:161]
    v_pk_fma_f32 v[162:163], v[42:43], v[58:59], v[162:163]
    v_pk_mul_f32 v[156:157], v[156:157], v[44:45]
    v_pk_mul_f32 v[158:159], v[158:159], v[46:47]
    v_pk_mul_f32 v[160:161], v[160:161], v[48:49]
    v_pk_mul_f32 v[162:163], v[162:163], v[50:51]
    v_cvt_pk_bf16_f32 v156, v156, v157
    v_cvt_pk_bf16_f32 v157, v158, v159
    v_cvt_pk_bf16_f32 v158, v160, v161
    v_cvt_pk_bf16_f32 v159, v162, v163
    ds_read_b128 v[144:147], v164 offset:1152
    ds_read_b128 v[160:163], v164 offset:1216
    v_pk_fma_f32 v[132:133], v[12:13], v[56:57], v[132:133]
    v_pk_fma_f32 v[134:135], v[14:15], v[56:57], v[134:135]
    v_pk_fma_f32 v[136:137], v[16:17], v[56:57], v[136:137]
    v_pk_fma_f32 v[138:139], v[18:19], v[56:57], v[138:139]
    v_pk_mul_f32 v[132:133], v[132:133], v[28:29]
    v_pk_mul_f32 v[134:135], v[134:135], v[30:31]
    v_pk_mul_f32 v[136:137], v[136:137], v[32:33]
    v_pk_mul_f32 v[138:139], v[138:139], v[34:35]
    v_cvt_pk_bf16_f32 v132, v132, v133
    v_cvt_pk_bf16_f32 v133, v134, v135
    v_cvt_pk_bf16_f32 v134, v136, v137
    v_cvt_pk_bf16_f32 v135, v138, v139
    v_pk_fma_f32 v[148:149], v[12:13], v[58:59], v[148:149]
    v_pk_fma_f32 v[150:151], v[14:15], v[58:59], v[150:151]
    v_pk_fma_f32 v[152:153], v[16:17], v[58:59], v[152:153]
    v_pk_fma_f32 v[154:155], v[18:19], v[58:59], v[154:155]
    v_pk_mul_f32 v[148:149], v[148:149], v[28:29]
    v_pk_mul_f32 v[150:151], v[150:151], v[30:31]
    v_pk_mul_f32 v[152:153], v[152:153], v[32:33]
    v_pk_mul_f32 v[154:155], v[154:155], v[34:35]
    v_cvt_pk_bf16_f32 v148, v148, v149
    v_cvt_pk_bf16_f32 v149, v150, v151
    v_cvt_pk_bf16_f32 v150, v152, v153
    v_cvt_pk_bf16_f32 v151, v154, v155
    v_mov_b32 v56, 0x3f803f80
    v_mov_b32 v57, 0x3f803f80
    v_mov_b32 v58, 0x3f803f80
    v_mov_b32 v59, 0x3f803f80
    v_mov_b32 v164, 1
    v_mov_b32 v165, 2
    v_pk_fma_f32 v[108:109], v[36:37], v[52:53], v[108:109]
    v_pk_fma_f32 v[110:111], v[38:39], v[52:53], v[110:111]
    v_pk_fma_f32 v[112:113], v[40:41], v[52:53], v[112:113]
    v_pk_fma_f32 v[114:115], v[42:43], v[52:53], v[114:115]
    s_waitcnt lgkmcnt(1)
    v_pk_mul_f32 v[20:21], v[108:109], v[144:145]
    v_pk_mul_f32 v[22:23], v[110:111], v[146:147]
    s_waitcnt lgkmcnt(0)
    v_pk_mul_f32 v[24:25], v[112:113], v[160:161]
    v_pk_mul_f32 v[26:27], v[114:115], v[162:163]
    v_pk_fma_f32 v[108:109], v[108:109], v[44:45], s[40:41]
    v_pk_fma_f32 v[110:111], v[110:111], v[46:47], s[40:41]
    v_pk_fma_f32 v[112:113], v[112:113], v[48:49], s[40:41]
    v_pk_fma_f32 v[114:115], v[114:115], v[50:51], s[40:41]
    v_mfma_f32_16x16x32_bf16 v[136:139], v[100:103], v[132:135], 0
    v_exp_f32 v20, v20 clamp
    v_mfma_f32_16x16x32_bf16 v[152:155], v[100:103], v[148:151], 0
    v_exp_f32 v21, v21 clamp
    v_mfma_f32_16x16x32_bf16 v[104:107], v[100:103], v[56:59], 0
    v_exp_f32 v22, v22 clamp
    v_exp_f32 v23, v23 clamp
    v_exp_f32 v24, v24 clamp
    v_exp_f32 v25, v25 clamp
    v_exp_f32 v26, v26 clamp
    v_exp_f32 v27, v27 clamp
    v_pk_add_f32 v[20:21], v[20:21], s[74:75]
    v_pk_add_f32 v[22:23], v[22:23], s[74:75]
    v_pk_add_f32 v[24:25], v[24:25], s[74:75]
    v_pk_add_f32 v[26:27], v[26:27], s[74:75]
    v_max_f32 v108, v108, v20
    v_max_f32 v109, v109, v21
    v_max_f32 v110, v110, v22
    v_max_f32 v111, v111, v23
    v_max_f32 v112, v112, v24
    v_max_f32 v113, v113, v25
    v_max_f32 v114, v114, v26
    v_max_f32 v115, v115, v27
    v_cvt_pk_bf16_f32 v108, v108, v109
    v_cvt_pk_bf16_f32 v109, v110, v111
    v_cvt_pk_bf16_f32 v110, v112, v113
    v_cvt_pk_bf16_f32 v111, v114, v115
    v_pk_fma_f32 v[116:117], v[12:13], v[54:55], v[116:117]
    v_pk_fma_f32 v[118:119], v[14:15], v[54:55], v[118:119]
    v_pk_fma_f32 v[120:121], v[16:17], v[54:55], v[120:121]
    v_pk_fma_f32 v[122:123], v[18:19], v[54:55], v[122:123]
    v_pk_mul_f32 v[20:21], v[116:117], v[60:61]
    v_pk_mul_f32 v[22:23], v[118:119], v[62:63]
    v_pk_mul_f32 v[24:25], v[120:121], v[64:65]
    v_pk_mul_f32 v[26:27], v[122:123], v[66:67]
    v_pk_fma_f32 v[116:117], v[116:117], v[28:29], s[40:41]
    v_pk_fma_f32 v[118:119], v[118:119], v[30:31], s[40:41]
    v_pk_fma_f32 v[120:121], v[120:121], v[32:33], s[40:41]
    v_pk_fma_f32 v[122:123], v[122:123], v[34:35], s[40:41]
    v_mfma_f32_16x16x32_bf16 v[136:139], v[108:111], v[140:143], v[136:139]
    v_exp_f32 v20, v20 clamp
    v_mfma_f32_16x16x32_bf16 v[152:155], v[108:111], v[156:159], v[152:155]
    v_exp_f32 v21, v21 clamp
    v_mfma_f32_16x16x32_bf16 v[104:107], v[108:111], v[56:59], v[104:107]
    v_exp_f32 v22, v22 clamp
    v_exp_f32 v23, v23 clamp
    v_exp_f32 v24, v24 clamp
    v_exp_f32 v25, v25 clamp
    v_exp_f32 v26, v26 clamp
    v_exp_f32 v27, v27 clamp
    v_pk_add_f32 v[20:21], v[20:21], s[74:75]
    v_pk_add_f32 v[22:23], v[22:23], s[74:75]
    v_pk_add_f32 v[24:25], v[24:25], s[74:75]
    v_pk_add_f32 v[26:27], v[26:27], s[74:75]
    ds_write_b128 v1, v[136:139] offset:0
    ds_write_b128 v1, v[152:155] offset:1024
    s_mov_b64 exec, s[50:51]
    ds_write_b128 v2, v[104:107] offset:0
    s_mov_b64 exec, 1
    ds_write_b32 v3, v164
    s_mov_b64 exec, -1
    v_max_f32 v116, v116, v20
    v_max_f32 v117, v117, v21
    v_max_f32 v118, v118, v22
    v_max_f32 v119, v119, v23
    v_max_f32 v120, v120, v24
    v_max_f32 v121, v121, v25
    v_max_f32 v122, v122, v26
    v_max_f32_e64 v123, v123, v27
    v_cvt_pk_bf16_f32 v116, v116, v117
    v_cvt_pk_bf16_f32 v117, v118, v119
    v_cvt_pk_bf16_f32 v118, v120, v121
    v_cvt_pk_bf16_f32 v119, v122, v123
    v_pk_fma_f32 v[124:125], v[36:37], v[54:55], v[124:125]
    v_pk_fma_f32 v[126:127], v[38:39], v[54:55], v[126:127]
    v_pk_fma_f32 v[128:129], v[40:41], v[54:55], v[128:129]
    v_pk_fma_f32 v[130:131], v[42:43], v[54:55], v[130:131]
    v_pk_mul_f32 v[20:21], v[124:125], v[144:145]
    v_pk_mul_f32 v[22:23], v[126:127], v[146:147]
    v_pk_mul_f32 v[24:25], v[128:129], v[160:161]
    v_pk_mul_f32 v[26:27], v[130:131], v[162:163]
    v_pk_fma_f32 v[124:125], v[124:125], v[44:45], s[40:41]
    v_pk_fma_f32 v[126:127], v[126:127], v[46:47], s[40:41]
    v_pk_fma_f32 v[128:129], v[128:129], v[48:49], s[40:41]
    v_pk_fma_f32 v[130:131], v[130:131], v[50:51], s[40:41]
    v_mfma_f32_16x16x32_bf16 v[112:115], v[116:119], v[132:135], 0
    v_exp_f32 v20, v20 clamp
    v_mfma_f32_16x16x32_bf16 v[120:123], v[116:119], v[148:151], 0
    v_exp_f32 v21, v21 clamp
    v_mfma_f32_16x16x32_bf16 v[100:103], v[116:119], v[56:59], 0
    v_exp_f32 v22, v22 clamp
    v_exp_f32 v23, v23 clamp
    v_exp_f32 v24, v24 clamp
    v_exp_f32 v25, v25 clamp
    v_exp_f32 v26, v26 clamp
    v_exp_f32 v27, v27 clamp
    v_pk_add_f32 v[20:21], v[20:21], s[74:75]
    v_pk_add_f32 v[22:23], v[22:23], s[74:75]
    v_pk_add_f32 v[24:25], v[24:25], s[74:75]
    v_pk_add_f32 v[26:27], v[26:27], s[74:75]
    v_max_f32 v124, v124, v20
    v_max_f32 v125, v125, v21
    v_max_f32 v126, v126, v22
    v_max_f32 v127, v127, v23
    v_max_f32 v128, v128, v24
    v_max_f32 v129, v129, v25
    v_max_f32 v130, v130, v26
    v_max_f32 v131, v131, v27
    v_cvt_pk_bf16_f32 v124, v124, v125
    v_cvt_pk_bf16_f32 v125, v126, v127
    v_cvt_pk_bf16_f32 v126, v128, v129
    v_cvt_pk_bf16_f32 v127, v130, v131
    s_nop 1
    v_mfma_f32_16x16x32_bf16 v[112:115], v[124:127], v[140:143], v[112:115]
    v_mfma_f32_16x16x32_bf16 v[120:123], v[124:127], v[156:159], v[120:123]
    v_mfma_f32_16x16x32_bf16 v[100:103], v[124:127], v[56:59], v[100:103]
    ds_read_b64_tr_b16 v[44:45], v8 offset:0
    ds_read_b64_tr_b16 v[46:47], v8 offset:512
    ds_read_b128 v[12:15], v4 offset:0
    ds_read_b64_tr_b16 v[52:53], v8 offset:4096
    ds_read_b64_tr_b16 v[54:55], v8 offset:4608
    ds_read_b128 v[28:31], v5 offset:0
    ds_write_b128 v1, v[112:115] offset:2048
    ds_write_b128 v1, v[120:123] offset:3072
    s_mov_b64 exec, s[50:51]
    ds_write_b128 v2, v[100:103] offset:64
    s_mov_b64 exec, 1
    ds_write_b32 v3, v165
    s_mov_b64 exec, -1
    ds_read_b64_tr_b16 v[48:49], v9 offset:0
    s_waitcnt lgkmcnt(8)
    ds_read_b64_tr_b16 v[50:51], v9 offset:512
    ds_read_b64_tr_b16 v[56:57], v9 offset:4096
    ds_read_b64_tr_b16 v[58:59], v9 offset:4608
    ds_read_b128 v[16:19], v4 offset:2048
    s_setprio 0
    v_and_b32 v60, 15, v0
    s_lshl_b32 s44, s36, 8
    s_add_u32 s44, s44, 24832
    v_lshl_add_u32 v60, v60, 2, s44
    v_add_u32 v61, 1024, v60
    s_lshl_b32 s44, s37, 7
    s_add_u32 s44, s44, 26368
    v_and_or_b32 v62, v0, 48, s44
    s_lshl_b32 s44, s35, 2
    s_and_b32 s47, s3, 2
    s_add_u32 s44, s44, s47
    s_lshr_b32 s44, 0xeee7eece, s44
    s_and_b32 s44, s44, 3
    s_mul_i32 s44, s44, 40960
    s_and_b32 s47, s28, 1
    s_lshl_b32 s47, s47, 13
    s_add_u32 s44, s44, s47
    s_lshl_b32 s47, s37, 6
    v_lshrrev_b32 v63, 4, v0
    v_lshlrev_b32 v63, 3, v63
    v_xor_b32 v63, s47, v63
    v_and_b32 v64, 14, v0
    v_lshlrev_b32 v64, 3, v64
    v_xor_b32 v63, v63, v64
    v_and_b32 v64, 15, v0
    v_lshlrev_b32 v64, 7, v64
    v_add3_u32 v63, v63, v64, s44
    v_xor_b32 v64, 32, v63

    s_waitcnt lgkmcnt(0)
    v_mfma_f32_16x16x32_bf16 v[68:71], v[44:47], v[12:15], v[68:71]
    ds_read_b128 v[32:35], v5 offset:2048
    ds_read_b128 v[20:23], v4 offset:4096
    v_mfma_f32_16x16x32_bf16 v[68:71], v[52:55], v[28:31], v[68:71]
    ds_read_b128 v[36:39], v5 offset:4096
    v_mfma_f32_16x16x32_bf16 v[84:87], v[48:51], v[12:15], v[84:87]
    ds_read_b128 v[24:27], v4 offset:6144
    ds_read_b128 v[40:43], v5 offset:6144
    v_mfma_f32_16x16x32_bf16 v[84:87], v[56:59], v[28:31], v[84:87]
    ds_read_b64_tr_b16 v[132:133], v8 offset:40960
    v_mfma_f32_16x16x32_bf16 v[72:75], v[44:47], v[16:19], v[72:75]
    ds_read_b64_tr_b16 v[134:135], v8 offset:41472
    ds_read_b128 v[100:103], v4 offset:40960
    s_waitcnt lgkmcnt(7)
    v_mfma_f32_16x16x32_bf16 v[72:75], v[52:55], v[32:35], v[72:75]
    ds_read_b64_tr_b16 v[140:141], v8 offset:45056
    v_mfma_f32_16x16x32_bf16 v[88:91], v[48:51], v[16:19], v[88:91]
    ds_read_b64_tr_b16 v[142:143], v8 offset:45568
    ds_read_b128 v[116:119], v5 offset:40960
    v_mfma_f32_16x16x32_bf16 v[88:91], v[56:59], v[32:35], v[88:91]
    ds_read_b64_tr_b16 v[136:137], v9 offset:40960
    s_waitcnt lgkmcnt(7)
    v_mfma_f32_16x16x32_bf16 v[76:79], v[44:47], v[20:23], v[76:79]
    ds_read_b64_tr_b16 v[138:139], v9 offset:41472
    ds_read_b64_tr_b16 v[144:145], v9 offset:45056
    v_mfma_f32_16x16x32_bf16 v[76:79], v[52:55], v[36:39], v[76:79]
    ds_read_b64_tr_b16 v[146:147], v9 offset:45568
    v_mfma_f32_16x16x32_bf16 v[92:95], v[48:51], v[20:23], v[92:95]
    ds_read_b128 v[104:107], v4 offset:43008
    ds_read_b128 v[120:123], v5 offset:43008
    v_mfma_f32_16x16x32_bf16 v[92:95], v[56:59], v[36:39], v[92:95]
    ds_read_b128 v[108:111], v4 offset:45056
    v_mfma_f32_16x16x32_bf16 v[80:83], v[44:47], v[24:27], v[80:83]
    ds_read_b128 v[124:127], v5 offset:45056
    ds_read_b128 v[112:115], v4 offset:47104
    s_waitcnt lgkmcnt(8)
    v_mfma_f32_16x16x32_bf16 v[80:83], v[52:55], v[40:43], v[80:83]
    ds_read_b128 v[128:131], v5 offset:47104
    v_mfma_f32_16x16x32_bf16 v[96:99], v[48:51], v[24:27], v[96:99]
    ds_read_b64_tr_b16 v[44:45], v10 offset:0
    ds_read_b64_tr_b16 v[46:47], v10 offset:512
    v_mfma_f32_16x16x32_bf16 v[96:99], v[56:59], v[40:43], v[96:99]
    ds_read_b128 v[12:15], v6 offset:0
    v_mfma_f32_16x16x32_bf16 v[68:71], v[132:135], v[100:103], v[68:71]
    ds_read_b64_tr_b16 v[52:53], v10 offset:4096
    ds_read_b64_tr_b16 v[54:55], v10 offset:4608
    s_waitcnt lgkmcnt(8)
    v_mfma_f32_16x16x32_bf16 v[68:71], v[140:143], v[116:119], v[68:71]
    ds_read_b128 v[28:31], v7 offset:0
    v_mfma_f32_16x16x32_bf16 v[84:87], v[136:139], v[100:103], v[84:87]
    ds_read_b64_tr_b16 v[48:49], v11 offset:0
    ds_read_b64_tr_b16 v[50:51], v11 offset:512
    v_mfma_f32_16x16x32_bf16 v[84:87], v[144:147], v[116:119], v[84:87]
    ds_read_b64_tr_b16 v[56:57], v11 offset:4096
    v_mfma_f32_16x16x32_bf16 v[72:75], v[132:135], v[104:107], v[72:75]
    ds_read_b64_tr_b16 v[58:59], v11 offset:4608
    ds_read_b128 v[16:19], v6 offset:2048
    s_waitcnt lgkmcnt(8)
    v_mfma_f32_16x16x32_bf16 v[72:75], v[140:143], v[120:123], v[72:75]
    ds_read_b128 v[32:35], v7 offset:2048
    v_mfma_f32_16x16x32_bf16 v[88:91], v[136:139], v[104:107], v[88:91]
    ds_read_b128 v[100:103], v6 offset:40960
    ds_read_b128 v[116:119], v7 offset:40960
    v_mfma_f32_16x16x32_bf16 v[88:91], v[144:147], v[120:123], v[88:91]
    ds_read_b128 v[104:107], v6 offset:43008
    v_mfma_f32_16x16x32_bf16 v[76:79], v[132:135], v[108:111], v[76:79]
    ds_read_b128 v[120:123], v7 offset:43008
    ds_read_b128 v[20:23], v6 offset:4096
    s_waitcnt lgkmcnt(8)
    v_mfma_f32_16x16x32_bf16 v[76:79], v[140:143], v[124:127], v[76:79]
    ds_read2_b32 v[66:67], v61 offset0:0 offset1:0
    v_mfma_f32_16x16x32_bf16 v[92:95], v[136:139], v[108:111], v[92:95]
    ds_read2_b32 v[164:165], v61 offset0:16 offset1:16
    ds_read_b128 v[36:39], v7 offset:4096
    v_mfma_f32_16x16x32_bf16 v[92:95], v[144:147], v[124:127], v[92:95]
    ds_read_b128 v[24:27], v6 offset:6144
    v_mfma_f32_16x16x32_bf16 v[80:83], v[132:135], v[112:115], v[80:83]
    ds_read_b64_tr_b16 v[132:133], v10 offset:40960
    ds_read_b64_tr_b16 v[134:135], v10 offset:41472
    s_waitcnt lgkmcnt(8)
    v_mfma_f32_16x16x32_bf16 v[80:83], v[140:143], v[128:131], v[80:83]
    ds_read_b64_tr_b16 v[140:141], v10 offset:45056
    v_mfma_f32_16x16x32_bf16 v[96:99], v[136:139], v[112:115], v[96:99]
    ds_read_b64_tr_b16 v[142:143], v10 offset:45568
    ds_read_b64_tr_b16 v[136:137], v11 offset:40960
    v_mfma_f32_16x16x32_bf16 v[96:99], v[144:147], v[128:131], v[96:99]
    ds_read_b64_tr_b16 v[138:139], v11 offset:41472
    v_mfma_f32_16x16x32_bf16 v[68:71], v[44:47], v[12:15], v[68:71]
    ds_read_b64_tr_b16 v[144:145], v11 offset:45056
    ds_read_b64_tr_b16 v[146:147], v11 offset:45568
    s_waitcnt lgkmcnt(8)
    v_mfma_f32_16x16x32_bf16 v[68:71], v[52:55], v[28:31], v[68:71]
    ds_read_b128 v[40:43], v7 offset:6144
    v_mfma_f32_16x16x32_bf16 v[84:87], v[48:51], v[12:15], v[84:87]
    ds_read_b128 v[12:15], v62 offset:0
    ds_read_b128 v[108:111], v6 offset:45056
    v_mfma_f32_16x16x32_bf16 v[84:87], v[56:59], v[28:31], v[84:87]
    ds_read2_b32 v[28:29], v60 offset0:0 offset1:0
    v_mfma_f32_16x16x32_bf16 v[72:75], v[44:47], v[16:19], v[72:75]
    ds_read2_b32 v[30:31], v60 offset0:16 offset1:16
    ds_read_b128 v[124:127], v7 offset:45056
    s_waitcnt lgkmcnt(8)
    v_mfma_f32_16x16x32_bf16 v[72:75], v[52:55], v[32:35], v[72:75]
    ds_read_b128 v[112:115], v6 offset:47104
    v_mfma_f32_16x16x32_bf16 v[88:91], v[48:51], v[16:19], v[88:91]
    ds_read_b128 v[16:19], v62 offset:64
    ds_read_b128 v[128:131], v7 offset:47104
    v_mfma_f32_16x16x32_bf16 v[88:91], v[56:59], v[32:35], v[88:91]
    ds_read2_b32 v[32:33], v60 offset0:128 offset1:128
    ds_read2_b32 v[34:35], v60 offset0:144 offset1:144
    v_mfma_f32_16x16x32_bf16 v[68:71], v[132:135], v[100:103], v[68:71]
    ds_read_b64 v[148:149], v63 offset:0
    ds_read_b64 v[150:151], v64 offset:0
    s_waitcnt lgkmcnt(9)
    v_mfma_f32_16x16x32_bf16 v[68:71], v[140:143], v[116:119], v[68:71]
    ds_read_b64 v[152:153], v63 offset:2048
    v_mfma_f32_16x16x32_bf16 v[84:87], v[136:139], v[100:103], v[84:87]
    ds_read_b64 v[154:155], v64 offset:2048
    ds_read_b64 v[156:157], v63 offset:4096
    v_mfma_f32_16x16x32_bf16 v[84:87], v[144:147], v[116:119], v[84:87]
    ds_read_b64 v[158:159], v64 offset:4096
    v_mfma_f32_16x16x32_bf16 v[72:75], v[132:135], v[104:107], v[72:75]
    ds_read_b64 v[160:161], v63 offset:6144
    ds_read_b64 v[162:163], v64 offset:6144
    v_mov_b32_e64 v65, 3
    s_mov_b64 exec, 1
    s_waitcnt lgkmcnt(8)
    ds_write_b32 v3, v65 offset:0
W_2:
    s_cbranch_execz R_2
    s_nop 0
    s_mov_b64 exec, -1
    s_waitcnt lgkmcnt(9)
    v_mfma_f32_16x16x32_bf16 v[72:75], v[140:143], v[120:123], v[72:75]
    v_mfma_f32_16x16x32_bf16 v[88:91], v[136:139], v[104:107], v[88:91]
    v_mfma_f32_16x16x32_bf16 v[88:91], v[144:147], v[120:123], v[88:91]
    v_pk_fma_f32 v[68:69], v[12:13], v[28:29], v[68:69]
    v_pk_fma_f32 v[70:71], v[14:15], v[28:29], v[70:71]
    v_pk_fma_f32 v[84:85], v[16:17], v[28:29], v[84:85]
    v_pk_fma_f32 v[86:87], v[18:19], v[28:29], v[86:87]
    s_nop 1
    v_pk_fma_f32 v[72:73], v[12:13], v[30:31], v[72:73]
    v_pk_fma_f32 v[74:75], v[14:15], v[30:31], v[74:75]
    v_pk_fma_f32 v[88:89], v[16:17], v[30:31], v[88:89]
    v_pk_fma_f32 v[90:91], v[18:19], v[30:31], v[90:91]
    v_pk_mul_f32 v[100:101], v[68:69], v[66:67]
    v_pk_mul_f32 v[102:103], v[70:71], v[66:67]
    v_pk_mul_f32 v[104:105], v[84:85], v[66:67]
    v_pk_mul_f32 v[106:107], v[86:87], v[66:67]
    v_pk_mul_f32 v[116:117], v[72:73], v[164:165]
    v_pk_mul_f32 v[118:119], v[74:75], v[164:165]
    v_pk_mul_f32 v[120:121], v[88:89], v[164:165]
    v_pk_mul_f32 v[122:123], v[90:91], v[164:165]
    v_pk_fma_f32 v[68:69], v[68:69], v[32:33], s[40:41]
    v_pk_fma_f32 v[70:71], v[70:71], v[32:33], s[40:41]
    v_pk_fma_f32 v[84:85], v[84:85], v[32:33], s[40:41]
    v_pk_fma_f32 v[86:87], v[86:87], v[32:33], s[40:41]
    v_pk_fma_f32 v[72:73], v[72:73], v[34:35], s[40:41]
    v_pk_fma_f32 v[74:75], v[74:75], v[34:35], s[40:41]
    v_pk_fma_f32 v[88:89], v[88:89], v[34:35], s[40:41]
    v_pk_fma_f32 v[90:91], v[90:91], v[34:35], s[40:41]
    v_mfma_f32_16x16x32_bf16 v[76:79], v[44:47], v[20:23], v[76:79]
    v_exp_f32 v100, v100 clamp
    ds_read2_b32 v[28:29], v60 offset0:32 offset1:32
    v_mfma_f32_16x16x32_bf16 v[76:79], v[52:55], v[36:39], v[76:79]
    v_exp_f32 v101, v101 clamp
    ds_read2_b32 v[30:31], v60 offset0:48 offset1:48
    v_mfma_f32_16x16x32_bf16 v[92:95], v[48:51], v[20:23], v[92:95]
    v_exp_f32 v102, v102 clamp
    ds_read2_b32 v[66:67], v61 offset0:32 offset1:32
    v_mfma_f32_16x16x32_bf16 v[92:95], v[56:59], v[36:39], v[92:95]
    v_exp_f32 v103, v103 clamp
    ds_read2_b32 v[164:165], v61 offset0:48 offset1:48
    v_mfma_f32_16x16x32_bf16 v[80:83], v[44:47], v[24:27], v[80:83]
    v_exp_f32 v104, v104 clamp
    ds_read2_b32 v[32:33], v60 offset0:160 offset1:160
    s_waitcnt lgkmcnt(5)
    v_mfma_f32_16x16x32_bf16 v[80:83], v[52:55], v[40:43], v[80:83]
    v_exp_f32 v105, v105 clamp
    ds_read2_b32 v[34:35], v60 offset0:176 offset1:176
    v_mfma_f32_16x16x32_bf16 v[96:99], v[48:51], v[24:27], v[96:99]
    v_exp_f32 v106, v106 clamp
    v_mfma_f32_16x16x32_bf16 v[96:99], v[56:59], v[40:43], v[96:99]
    v_exp_f32 v107, v107 clamp
    v_mfma_f32_16x16x32_bf16 v[76:79], v[132:135], v[108:111], v[76:79]
    v_exp_f32 v116, v116 clamp
    v_mfma_f32_16x16x32_bf16 v[76:79], v[140:143], v[124:127], v[76:79]
    v_exp_f32 v117, v117 clamp
    v_mfma_f32_16x16x32_bf16 v[92:95], v[136:139], v[108:111], v[92:95]
    v_exp_f32 v118, v118 clamp
    v_mfma_f32_16x16x32_bf16 v[92:95], v[144:147], v[124:127], v[92:95]
    v_exp_f32 v119, v119 clamp
    v_mfma_f32_16x16x32_bf16 v[80:83], v[132:135], v[112:115], v[80:83]
    v_exp_f32 v120, v120 clamp
    v_mfma_f32_16x16x32_bf16 v[80:83], v[140:143], v[128:131], v[80:83]
    v_exp_f32 v121, v121 clamp
    v_mfma_f32_16x16x32_bf16 v[96:99], v[136:139], v[112:115], v[96:99]
    v_exp_f32 v122, v122 clamp
    v_mfma_f32_16x16x32_bf16 v[96:99], v[144:147], v[128:131], v[96:99]
    v_exp_f32 v123, v123 clamp
    v_pk_add_f32 v[100:101], v[100:101], s[74:75]
    v_pk_add_f32 v[102:103], v[102:103], s[74:75]
    v_pk_add_f32 v[104:105], v[104:105], s[74:75]
    v_pk_add_f32 v[106:107], v[106:107], s[74:75]
    v_pk_add_f32 v[116:117], v[116:117], s[74:75]
    v_pk_add_f32 v[118:119], v[118:119], s[74:75]
    v_pk_add_f32 v[120:121], v[120:121], s[74:75]
    v_pk_add_f32 v[122:123], v[122:123], s[74:75]
    v_max_f32 v68, v68, v100
    v_max_f32 v69, v69, v101
    v_max_f32 v70, v70, v102
    v_max_f32 v71, v71, v103
    v_max_f32 v84, v84, v104
    v_max_f32 v85, v85, v105
    v_max_f32 v86, v86, v106
    v_max_f32 v87, v87, v107
    v_max_f32 v72, v72, v116
    v_max_f32 v73, v73, v117
    v_max_f32 v74, v74, v118
    v_max_f32 v75, v75, v119
    v_max_f32 v88, v88, v120
    v_max_f32 v89, v89, v121
    v_max_f32 v90, v90, v122
    v_max_f32_e64 v91, v91, v123
    v_cvt_pk_bf16_f32 v44, v68, v69
    v_cvt_pk_bf16_f32 v45, v70, v71
    v_cvt_pk_bf16_f32 v46, v84, v85
    v_cvt_pk_bf16_f32 v47, v86, v87
    v_cvt_pk_bf16_f32 v48, v72, v73
    v_cvt_pk_bf16_f32 v49, v74, v75
    v_cvt_pk_bf16_f32 v50, v88, v89
    v_cvt_pk_bf16_f32 v51, v90, v91
    s_waitcnt lgkmcnt(5)
    v_pk_fma_f32 v[76:77], v[12:13], v[28:29], v[76:77]
    v_pk_fma_f32 v[78:79], v[14:15], v[28:29], v[78:79]
    v_pk_fma_f32 v[92:93], v[16:17], v[28:29], v[92:93]
    v_pk_fma_f32 v[94:95], v[18:19], v[28:29], v[94:95]
    s_waitcnt lgkmcnt(4)
    v_pk_fma_f32 v[80:81], v[12:13], v[30:31], v[80:81]
    v_pk_fma_f32 v[82:83], v[14:15], v[30:31], v[82:83]
    v_pk_fma_f32 v[96:97], v[16:17], v[30:31], v[96:97]
    v_pk_fma_f32 v[98:99], v[18:19], v[30:31], v[98:99]
    s_waitcnt lgkmcnt(3)
    v_pk_mul_f32 v[108:109], v[76:77], v[66:67]
    v_pk_mul_f32 v[110:111], v[78:79], v[66:67]
    v_pk_mul_f32 v[112:113], v[92:93], v[66:67]
    v_pk_mul_f32 v[114:115], v[94:95], v[66:67]
    s_waitcnt lgkmcnt(2)
    v_pk_mul_f32 v[124:125], v[80:81], v[164:165]
    v_pk_mul_f32 v[126:127], v[82:83], v[164:165]
    v_pk_mul_f32 v[128:129], v[96:97], v[164:165]
    v_pk_mul_f32 v[130:131], v[98:99], v[164:165]
    s_waitcnt lgkmcnt(1)
    v_pk_fma_f32 v[76:77], v[76:77], v[32:33], s[40:41]
    v_pk_fma_f32 v[78:79], v[78:79], v[32:33], s[40:41]
    v_pk_fma_f32 v[92:93], v[92:93], v[32:33], s[40:41]
    v_pk_fma_f32 v[94:95], v[94:95], v[32:33], s[40:41]
    s_waitcnt lgkmcnt(0)
    v_pk_fma_f32 v[80:81], v[80:81], v[34:35], s[40:41]
    v_pk_fma_f32 v[82:83], v[82:83], v[34:35], s[40:41]
    v_pk_fma_f32 v[96:97], v[96:97], v[34:35], s[40:41]
    v_pk_fma_f32 v[98:99], v[98:99], v[34:35], s[40:41]
    v_exp_f32 v108, v108 clamp
    v_exp_f32 v109, v109 clamp
    v_exp_f32 v110, v110 clamp
    v_exp_f32 v111, v111 clamp
    v_exp_f32 v112, v112 clamp
    v_exp_f32 v113, v113 clamp
    v_exp_f32 v114, v114 clamp
    v_exp_f32 v115, v115 clamp
    v_exp_f32 v124, v124 clamp
    v_exp_f32 v125, v125 clamp
    v_exp_f32 v126, v126 clamp
    v_exp_f32 v127, v127 clamp
    v_exp_f32 v128, v128 clamp
    v_exp_f32 v129, v129 clamp
    v_exp_f32 v130, v130 clamp
    v_exp_f32 v131, v131 clamp
    v_pk_add_f32 v[108:109], v[108:109], s[74:75]
    v_pk_add_f32 v[110:111], v[110:111], s[74:75]
    v_pk_add_f32 v[112:113], v[112:113], s[74:75]
    v_pk_add_f32 v[114:115], v[114:115], s[74:75]
    v_pk_add_f32 v[124:125], v[124:125], s[74:75]
    v_pk_add_f32 v[126:127], v[126:127], s[74:75]
    v_pk_add_f32 v[128:129], v[128:129], s[74:75]
    v_pk_add_f32 v[130:131], v[130:131], s[74:75]
    v_max_f32 v76, v76, v108
    v_max_f32 v77, v77, v109
    v_max_f32 v78, v78, v110
    v_max_f32 v79, v79, v111
    v_max_f32 v92, v92, v112
    v_max_f32 v93, v93, v113
    v_max_f32 v94, v94, v114
    v_max_f32 v95, v95, v115
    v_max_f32 v80, v80, v124
    v_max_f32 v81, v81, v125
    v_max_f32 v82, v82, v126
    v_max_f32 v83, v83, v127
    v_max_f32 v96, v96, v128
    v_max_f32 v97, v97, v129
    v_max_f32 v98, v98, v130
    v_max_f32 v99, v99, v131
    v_cvt_pk_bf16_f32 v52, v76, v77
    v_cvt_pk_bf16_f32 v53, v78, v79
    v_cvt_pk_bf16_f32 v54, v92, v93
    v_cvt_pk_bf16_f32 v55, v94, v95
    v_cvt_pk_bf16_f32 v56, v80, v81
    v_cvt_pk_bf16_f32 v57, v82, v83
    v_cvt_pk_bf16_f32 v58, v96, v97
    v_cvt_pk_bf16_f32 v59, v98, v99
    s_and_b32 s44, s46, 127
    s_lshl_b32 s44, s44, 2
    s_add_u32 s44, s44, 24832
    v_and_b32 v1, 15, v0
    v_lshl_add_u32 v63, v1, 2, s44

    v_lshrrev_b32 v2, 4, v0
    v_bfe_u32 v1, v0, 2, 2
    v_lshl_add_u32 v1, v2, 2, v1
    v_and_b32 v2, 7, v1
    s_lshl_b32 s44, s3, 1
    v_xor_b32 v2, s44, v2
    v_lshlrev_b32 v2, 5, v2
    v_lshl_add_u32 v2, v1, 8, v2
    v_and_b32 v1, 3, v0
    v_lshl_add_u32 v2, v1, 3, v2
    v_add_u32 v128, 65536, v2
    v_xor_b32 v129, 32, v128
    v_add_u32 v130, 122880, v2
    v_xor_b32 v131, 32, v130
    v_lshlrev_b32 v2, 2, v1
    v_add_u32 v2, 24640, v2
    s_lshl_b32 s44, s37, 10
    s_add_u32 s44, s44, 139264
    v_lshl_add_u32 v64, v0, 4, s44

    ds_read2_b32 v[4:5], v63 offset0:0 offset1:0
    ds_read2_b32 v[6:7], v63 offset0:16 offset1:16
    ds_read2_b32 v[8:9], v63 offset0:32 offset1:32
    ds_read2_b32 v[10:11], v63 offset0:48 offset1:48
    ds_read2_b32 v[12:13], v63 offset0:128 offset1:128
    ds_read2_b32 v[14:15], v63 offset0:144 offset1:144
    ds_read2_b32 v[16:17], v63 offset0:160 offset1:160
    ds_read2_b32 v[18:19], v63 offset0:176 offset1:176
    v_lshlrev_b32 v60, 4, v0
    v_and_b32 v61, 48, v0
    s_setprio 2
SP_1:
    s_load_dword s58, s[56:57], 0 glc
    s_waitcnt lgkmcnt(0)
    s_cmp_ge_u32 s58, 32
    s_cbranch_scc1 SD_2
    s_sleep 2
    s_branch SP_1
SD_2:
F_kp:
    buffer_load_dwordx4 v[36:39], v61, s[24:27], s83 offen offset:0 sc0 sc1
    buffer_load_dwordx4 v[40:43], v61, s[24:27], s83 offen offset:64 sc0 sc1
    buffer_load_dwordx4 v[20:23], v60, s[24:27], s82 offen offset:0 sc0 sc1
    buffer_load_dwordx4 v[24:27], v60, s[24:27], s82 offen offset:2048 sc0 sc1
    buffer_load_dwordx4 v[28:31], v60, s[24:27], s82 offen offset:1024 sc0 sc1
    buffer_load_dwordx4 v[32:35], v60, s[24:27], s82 offen offset:3072 sc0 sc1
    v_mov_b32 v62, 4
    s_mov_b64 exec, 1
    ds_write_b32 v3, v62 offset:0
    s_mov_b64 exec, -1
    s_waitcnt vmcnt(4)
    v_cvt_pk_bf16_f32 v124, v36, v37
    v_cvt_pk_bf16_f32 v125, v38, v39
    v_cvt_pk_bf16_f32 v126, v40, v41
    v_cvt_pk_bf16_f32 v127, v42, v43
    s_nop 1
    v_mfma_f32_16x16x32_bf16 v[76:79], v[124:127], v[44:47], 0
    v_mfma_f32_16x16x32_bf16 v[88:91], v[124:127], v[48:51], 0
    v_mfma_f32_16x16x32_bf16 v[100:103], v[124:127], v[52:55], 0
    v_mfma_f32_16x16x32_bf16 v[112:115], v[124:127], v[56:59], 0
    s_waitcnt vmcnt(2)
    v_cvt_pk_bf16_f32 v116, v20, v21
    v_cvt_pk_bf16_f32 v117, v22, v23
    v_cvt_pk_bf16_f32 v118, v24, v25
    v_cvt_pk_bf16_f32 v119, v26, v27
    s_nop 1
    v_mfma_f32_16x16x32_bf16 v[68:71], v[116:119], v[44:47], 0
    v_mfma_f32_16x16x32_bf16 v[80:83], v[116:119], v[48:51], 0
    v_mfma_f32_16x16x32_bf16 v[92:95], v[116:119], v[52:55], 0
    v_mfma_f32_16x16x32_bf16 v[104:107], v[116:119], v[56:59], 0
    v_add_f32 v76, s74, v76
    v_rcp_f32 v76, v76
    s_nop 0
    v_mov_b32 v77, v76
    v_add_f32 v88, s74, v88
    v_rcp_f32 v88, v88
    s_nop 0
    v_mov_b32 v89, v88
    v_add_f32 v100, s74, v100
    v_rcp_f32 v100, v100
    s_nop 0
    v_mov_b32 v101, v100
    v_add_f32 v112, s74, v112
    v_rcp_f32 v112, v112
    s_nop 0
    v_mov_b32_e64 v113, v112
    s_waitcnt vmcnt(0)
    v_cvt_pk_bf16_f32 v120, v28, v29
    v_cvt_pk_bf16_f32 v121, v30, v31
    v_cvt_pk_bf16_f32 v122, v32, v33
    v_cvt_pk_bf16_f32 v123, v34, v35
    s_nop 1
    v_mfma_f32_16x16x32_bf16 v[72:75], v[120:123], v[44:47], 0
    v_mfma_f32_16x16x32_bf16 v[84:87], v[120:123], v[48:51], 0
    v_mfma_f32_16x16x32_bf16 v[96:99], v[120:123], v[52:55], 0
    v_mfma_f32_16x16x32_bf16 v[108:111], v[120:123], v[56:59], 0
    s_add_u32 s80, s79, 0
    v_pk_mul_f32 v[68:69], v[68:69], v[76:77]
    v_pk_mul_f32 v[70:71], v[70:71], v[76:77]
    s_nop 1
    v_pk_mul_f32 v[72:73], v[72:73], v[76:77]
    v_pk_mul_f32 v[74:75], v[74:75], v[76:77]
    v_cvt_pk_bf16_f32 v28, v68, v69
    v_cvt_pk_bf16_f32 v29, v70, v71
    v_cvt_pk_bf16_f32 v30, v72, v73
    v_cvt_pk_bf16_f32 v31, v74, v75
    buffer_store_dwordx4 v[28:31], v60, s[16:19], s80 offen sc0 sc1
    s_add_u32 s80, s79, 32768
    v_pk_mul_f32 v[80:81], v[80:81], v[88:89]
    v_pk_mul_f32 v[82:83], v[82:83], v[88:89]
    v_pk_mul_f32 v[84:85], v[84:85], v[88:89]
    v_pk_mul_f32 v[86:87], v[86:87], v[88:89]
    v_cvt_pk_bf16_f32 v32, v80, v81
    v_cvt_pk_bf16_f32 v33, v82, v83
    v_cvt_pk_bf16_f32 v34, v84, v85
    v_cvt_pk_bf16_f32 v35, v86, v87
    buffer_store_dwordx4 v[32:35], v60, s[16:19], s80 offen sc0 sc1
    s_add_u32 s80, s79, 65536
    v_pk_mul_f32 v[92:93], v[92:93], v[100:101]
    v_pk_mul_f32 v[94:95], v[94:95], v[100:101]
    v_pk_mul_f32 v[96:97], v[96:97], v[100:101]
    v_pk_mul_f32 v[98:99], v[98:99], v[100:101]
    v_cvt_pk_bf16_f32 v36, v92, v93
    v_cvt_pk_bf16_f32 v37, v94, v95
    v_cvt_pk_bf16_f32 v38, v96, v97
    v_cvt_pk_bf16_f32 v39, v98, v99
    buffer_store_dwordx4 v[36:39], v60, s[16:19], s80 offen sc0 sc1
    s_add_u32 s80, s79, 98304
    v_pk_mul_f32 v[104:105], v[104:105], v[112:113]
    v_pk_mul_f32 v[106:107], v[106:107], v[112:113]
    v_pk_mul_f32 v[108:109], v[108:109], v[112:113]
    v_pk_mul_f32 v[110:111], v[110:111], v[112:113]
    v_cvt_pk_bf16_f32 v40, v104, v105
    v_cvt_pk_bf16_f32 v41, v106, v107
    v_cvt_pk_bf16_f32 v42, v108, v109
    v_cvt_pk_bf16_f32 v43, v110, v111
    buffer_store_dwordx4 v[40:43], v60, s[16:19], s80 offen sc0 sc1
    ds_read2_b32 v[66:67], v2 offset0:0 offset1:8
    v_lshlrev_b32 v132, 16, v148
    v_and_b32 v133, 0xffff0000, v148
    v_lshlrev_b32 v134, 16, v149
    v_and_b32 v135, 0xffff0000, v149
    v_lshlrev_b32 v136, 16, v150
    v_and_b32 v137, 0xffff0000, v150
    v_lshlrev_b32 v138, 16, v151
    v_and_b32 v139, 0xffff0000, v151
    v_pk_add_f32 v[76:77], v[132:133], v[4:5]
    v_pk_add_f32 v[78:79], v[134:135], v[4:5]
    v_pk_add_f32 v[80:81], v[136:137], v[4:5]
    v_pk_add_f32 v[82:83], v[138:139], v[4:5]
    v_cvt_pk_bf16_f32 v72, v76, v77
    v_cvt_pk_bf16_f32 v73, v78, v79
    v_cvt_pk_bf16_f32 v74, v80, v81
    v_cvt_pk_bf16_f32 v75, v82, v83
    v_lshlrev_b32 v76, 16, v72
    v_and_b32 v77, 0xffff0000, v72
    v_lshlrev_b32 v78, 16, v73
    v_and_b32 v79, 0xffff0000, v73
    v_lshlrev_b32 v80, 16, v74
    v_and_b32 v81, 0xffff0000, v74
    v_lshlrev_b32 v82, 16, v75
    v_and_b32 v83, 0xffff0000, v75
    v_pk_mul_f32 v[76:77], v[76:77], v[12:13]
    v_pk_mul_f32 v[78:79], v[78:79], v[12:13]
    v_pk_mul_f32 v[80:81], v[80:81], v[12:13]
    v_pk_mul_f32 v[82:83], v[82:83], v[12:13]
    v_cvt_pk_bf16_f32 v72, v76, v77
    v_cvt_pk_bf16_f32 v73, v78, v79
    v_cvt_pk_bf16_f32 v74, v80, v81
    v_cvt_pk_bf16_f32 v75, v82, v83
    v_lshlrev_b32 v76, 16, v72
    v_and_b32 v77, 0xffff0000, v72
    v_lshlrev_b32 v78, 16, v73
    v_and_b32 v79, 0xffff0000, v73
    v_lshlrev_b32 v80, 16, v74
    v_and_b32 v81, 0xffff0000, v74
    v_lshlrev_b32 v82, 16, v75
    v_and_b32 v83, 0xffff0000, v75
    v_pk_add_f32 v[132:133], v[132:133], v[76:77]
    v_pk_add_f32 v[134:135], v[134:135], v[78:79]
    v_pk_add_f32 v[136:137], v[136:137], v[80:81]
    v_pk_add_f32 v[138:139], v[138:139], v[82:83]
    v_mov_b32 v62, 5
    s_and_b32 s44, s28, 1
    s_cmp_lg_u32 s44, s36
    s_waitcnt lgkmcnt(0)
    v_cmp_gt_u32 s[70:71], 2, v67
    s_cbranch_scc1 F_oa1
    v_cmp_gt_u32 vcc, 3, v66
    s_cbranch_vccz F_oa0

    ds_read_b32 v66, v2
FW_3:
    s_waitcnt lgkmcnt(0)
    v_cmp_gt_u32 vcc, 3, v66
    s_cbranch_vccz FO_4
    s_sleep 1
    ds_read_b32 v66, v2
    s_branch FW_3
FO_4:
F_oa0:
    ds_write_b128 v64, v[28:31] offset:0
    ds_write_b128 v64, v[32:35] offset:2048
    ds_write_b128 v64, v[36:39] offset:4096
    ds_write_b128 v64, v[40:43] offset:6144
F_oa1:
    s_cmp_lg_u64 s[70:71], 0
    s_cbranch_scc1 F_bp0
    ds_read_b64_tr_b16 v[40:41], v130 offset:24576
    ds_read_b64_tr_b16 v[42:43], v130 offset:28672
    ds_read_b64_tr_b16 v[44:45], v131 offset:24576
    ds_read_b64_tr_b16 v[46:47], v131 offset:28672
    ds_read_b64_tr_b16 v[64:65], v130 offset:32768
    ds_read_b64_tr_b16 v[66:67], v130 offset:36864
    ds_read_b64_tr_b16 v[68:69], v131 offset:32768
    ds_read_b64_tr_b16 v[70:71], v131 offset:36864
    ds_read_b64_tr_b16 v[88:89], v128 offset:0
    ds_read_b64_tr_b16 v[90:91], v128 offset:4096
    ds_read_b64_tr_b16 v[92:93], v129 offset:0
    s_waitcnt lgkmcnt(8)
    s_nop 0
    ds_read_b64_tr_b16 v[94:95], v129 offset:4096
    ds_read_b64_tr_b16 v[112:113], v128 offset:8192
    ds_read_b64_tr_b16 v[114:115], v128 offset:12288
    ds_read_b64_tr_b16 v[116:117], v129 offset:8192
    ds_read_b64_tr_b16 v[118:119], v129 offset:12288
F_bp0:
    s_waitcnt lgkmcnt(4)
    s_waitcnt vmcnt(0)
    s_atomic_add s76, s[68:69], 0
    s_atomic_add s76, s[68:69], 128
    s_atomic_add s76, s[68:69], 256
    s_atomic_add s76, s[68:69], 384
    s_mov_b64 exec, 1
    ds_write_b32 v3, v62
    s_mov_b64 exec, -1
    s_setprio 0
    v_lshlrev_b32 v140, 16, v152
    v_and_b32 v141, 0xffff0000, v152
    v_lshlrev_b32 v142, 16, v153
    v_and_b32 v143, 0xffff0000, v153
    v_lshlrev_b32 v144, 16, v154
    v_and_b32 v145, 0xffff0000, v154
    v_lshlrev_b32_e64 v146, 16, v155
    v_and_b32 v147, 0xffff0000, v155
    v_pk_add_f32 v[76:77], v[140:141], v[6:7]
    v_pk_add_f32 v[78:79], v[142:143], v[6:7]
    v_pk_add_f32 v[80:81], v[144:145], v[6:7]
    v_pk_add_f32 v[82:83], v[146:147], v[6:7]
    v_cvt_pk_bf16_f32 v72, v76, v77
    v_cvt_pk_bf16_f32 v73, v78, v79
    v_cvt_pk_bf16_f32 v74, v80, v81
    v_cvt_pk_bf16_f32 v75, v82, v83
    v_lshlrev_b32 v76, 16, v72
    v_and_b32 v77, 0xffff0000, v72
    v_lshlrev_b32 v78, 16, v73
    v_and_b32 v79, 0xffff0000, v73
    v_lshlrev_b32 v80, 16, v74
    v_and_b32 v81, 0xffff0000, v74
    v_lshlrev_b32 v82, 16, v75
    v_and_b32 v83, 0xffff0000, v75
    v_pk_mul_f32 v[76:77], v[76:77], v[14:15]
    v_pk_mul_f32 v[78:79], v[78:79], v[14:15]
    v_pk_mul_f32 v[80:81], v[80:81], v[14:15]
    v_pk_mul_f32 v[82:83], v[82:83], v[14:15]
    v_cvt_pk_bf16_f32 v72, v76, v77
    v_cvt_pk_bf16_f32 v73, v78, v79
    v_cvt_pk_bf16_f32 v74, v80, v81
    v_cvt_pk_bf16_f32 v75, v82, v83
    v_lshlrev_b32 v76, 16, v72
    v_and_b32 v77, 0xffff0000, v72
    v_lshlrev_b32 v78, 16, v73
    v_and_b32 v79, 0xffff0000, v73
    v_lshlrev_b32 v80, 16, v74
    v_and_b32 v81, 0xffff0000, v74
    v_lshlrev_b32 v82, 16, v75
    v_and_b32 v83, 0xffff0000, v75
    v_pk_add_f32 v[140:141], v[140:141], v[76:77]
    v_pk_add_f32 v[142:143], v[142:143], v[78:79]
    v_pk_add_f32 v[144:145], v[144:145], v[80:81]
    v_pk_add_f32 v[146:147], v[146:147], v[82:83]
    v_lshlrev_b32 v148, 16, v156
    v_and_b32 v149, 0xffff0000, v156
    v_lshlrev_b32 v150, 16, v157
    v_and_b32 v151, 0xffff0000, v157
    v_lshlrev_b32 v152, 16, v158
    v_and_b32 v153, 0xffff0000, v158
    v_lshlrev_b32 v154, 16, v159
    v_and_b32 v155, 0xffff0000, v159
    v_pk_add_f32 v[76:77], v[148:149], v[8:9]
    v_pk_add_f32 v[78:79], v[150:151], v[8:9]
    v_pk_add_f32 v[80:81], v[152:153], v[8:9]
    v_pk_add_f32 v[82:83], v[154:155], v[8:9]
    v_cvt_pk_bf16_f32 v72, v76, v77
    v_cvt_pk_bf16_f32 v73, v78, v79
    v_cvt_pk_bf16_f32 v74, v80, v81
    v_cvt_pk_bf16_f32 v75, v82, v83
    v_lshlrev_b32 v76, 16, v72
    v_and_b32 v77, 0xffff0000, v72
    v_lshlrev_b32 v78, 16, v73
    v_and_b32 v79, 0xffff0000, v73
    v_lshlrev_b32 v80, 16, v74
    v_and_b32 v81, 0xffff0000, v74
    v_lshlrev_b32 v82, 16, v75
    v_and_b32 v83, 0xffff0000, v75
    v_pk_mul_f32 v[76:77], v[76:77], v[16:17]
    v_pk_mul_f32 v[78:79], v[78:79], v[16:17]
    v_pk_mul_f32 v[80:81], v[80:81], v[16:17]
    v_pk_mul_f32 v[82:83], v[82:83], v[16:17]
    v_cvt_pk_bf16_f32 v72, v76, v77
    v_cvt_pk_bf16_f32 v73, v78, v79
    v_cvt_pk_bf16_f32 v74, v80, v81
    v_cvt_pk_bf16_f32 v75, v82, v83
    v_lshlrev_b32 v76, 16, v72
    v_and_b32 v77, 0xffff0000, v72
    v_lshlrev_b32 v78, 16, v73
    v_and_b32 v79, 0xffff0000, v73
    v_lshlrev_b32 v80, 16, v74
    v_and_b32 v81, 0xffff0000, v74
    v_lshlrev_b32 v82, 16, v75
    v_and_b32 v83, 0xffff0000, v75
    v_pk_add_f32 v[148:149], v[148:149], v[76:77]
    v_pk_add_f32 v[150:151], v[150:151], v[78:79]
    v_pk_add_f32 v[152:153], v[152:153], v[80:81]
    v_pk_add_f32 v[154:155], v[154:155], v[82:83]
    v_lshlrev_b32 v156, 16, v160
    v_and_b32 v157, 0xffff0000, v160
    v_lshlrev_b32 v158, 16, v161
    v_and_b32 v159, 0xffff0000, v161
    v_lshlrev_b32 v160, 16, v162
    v_and_b32 v161, 0xffff0000, v162
    v_lshlrev_b32 v162, 16, v163
    v_and_b32 v163, 0xffff0000, v163
    v_pk_add_f32 v[76:77], v[156:157], v[10:11]
    v_pk_add_f32 v[78:79], v[158:159], v[10:11]
    v_pk_add_f32 v[80:81], v[160:161], v[10:11]
    v_pk_add_f32 v[82:83], v[162:163], v[10:11]
    v_cvt_pk_bf16_f32 v72, v76, v77
    v_cvt_pk_bf16_f32 v73, v78, v79
    v_cvt_pk_bf16_f32 v74, v80, v81
    v_cvt_pk_bf16_f32 v75, v82, v83
    v_lshlrev_b32 v76, 16, v72
    v_and_b32 v77, 0xffff0000, v72
    v_lshlrev_b32 v78, 16, v73
    v_and_b32 v79, 0xffff0000, v73
    v_lshlrev_b32 v80, 16, v74
    v_and_b32 v81, 0xffff0000, v74
    v_lshlrev_b32 v82, 16, v75
    v_and_b32 v83, 0xffff0000, v75
    v_pk_mul_f32 v[76:77], v[76:77], v[18:19]
    v_pk_mul_f32 v[78:79], v[78:79], v[18:19]
    v_pk_mul_f32 v[80:81], v[80:81], v[18:19]
    v_pk_mul_f32 v[82:83], v[82:83], v[18:19]
    v_cvt_pk_bf16_f32 v72, v76, v77
    v_cvt_pk_bf16_f32 v73, v78, v79
    v_cvt_pk_bf16_f32 v74, v80, v81
    v_cvt_pk_bf16_f32 v75, v82, v83
    v_lshlrev_b32 v76, 16, v72
    v_and_b32 v77, 0xffff0000, v72
    v_lshlrev_b32 v78, 16, v73
    v_and_b32 v79, 0xffff0000, v73
    v_lshlrev_b32 v80, 16, v74
    v_and_b32 v81, 0xffff0000, v74
    v_lshlrev_b32 v82, 16, v75
    v_and_b32 v83, 0xffff0000, v75
    v_pk_add_f32 v[156:157], v[156:157], v[76:77]
    v_pk_add_f32 v[158:159], v[158:159], v[78:79]
    v_pk_add_f32 v[160:161], v[160:161], v[80:81]
    v_pk_add_f32 v[162:163], v[162:163], v[82:83]
    v_lshlrev_b32 v4, 4, v0
    v_add_u32 v5, 98304, v4
    v_add_u32 v4, 16384, v4
    v_subrev_u32 v8, 65536, v128
    v_subrev_u32 v9, 65536, v129
    v_and_b32 v1, 15, v0
    s_lshl_b32 s44, s3, 6
    s_add_u32 s44, s44, 0
    v_lshrrev_b32 v18, 4, v0
    v_lshl_add_u32 v18, v18, 3, s44
    v_mul_u32_u24 v19, 272, v1
    v_add_u32 v18, v18, v19
    v_add_u32 v19, 4352, v18
    v_add_u32 v20, 8704, v18
    v_add_u32 v21, 13056, v18

    s_setprio 2
    s_cmp_eq_u64 s[70:71], 0
    s_cbranch_scc1 F_bp1
    v_add_u32 v60, 32, v2
    ds_read_b32 v61, v60
FW_5:
    s_waitcnt lgkmcnt(0)
    v_cmp_gt_u32_e64 vcc, 2, v61
    s_cbranch_vccz FO_6
    s_sleep 1
    ds_read_b32 v61, v60
    s_branch FW_5
FO_6:
    ds_read_b64_tr_b16 v[40:41], v130 offset:24576
    ds_read_b64_tr_b16 v[42:43], v130 offset:28672
    ds_read_b64_tr_b16 v[44:45], v131 offset:24576
    ds_read_b64_tr_b16 v[46:47], v131 offset:28672
    ds_read_b64_tr_b16 v[64:65], v130 offset:32768
    ds_read_b64_tr_b16 v[66:67], v130 offset:36864
    ds_read_b64_tr_b16 v[68:69], v131 offset:32768
    ds_read_b64_tr_b16 v[70:71], v131 offset:36864
    ds_read_b64_tr_b16 v[88:89], v128 offset:0
    ds_read_b64_tr_b16 v[90:91], v128 offset:4096
    ds_read_b64_tr_b16 v[92:93], v129 offset:0
    ds_read_b64_tr_b16 v[94:95], v129 offset:4096
    ds_read_b64_tr_b16 v[112:113], v128 offset:8192
    ds_read_b64_tr_b16 v[114:115], v128 offset:12288
    ds_read_b64_tr_b16 v[116:117], v129 offset:8192
    s_waitcnt lgkmcnt(8)
    ds_read_b64_tr_b16 v[118:119], v129 offset:12288
F_bp1:
    ds_read_b32 v22, v2
FW_7:
    s_waitcnt lgkmcnt(0)
    v_cmp_gt_u32 vcc, 5, v22
    s_cbranch_vccz FO_8
    s_sleep 1
    ds_read_b32 v22, v2
    s_branch FW_7
FO_8:
    ds_read_b128 v[24:27], v5 offset:40960
    ds_read_b128 v[48:51], v5 offset:41984
    ds_read_b128 v[28:31], v5 offset:43008
    ds_read_b128 v[52:55], v5 offset:44032
    ds_read_b128 v[32:35], v5 offset:45056
W_3:
    s_cbranch_execz R_3
    s_nop 0
    ds_read_b128 v[56:59], v5 offset:46080
    ds_read_b128 v[36:39], v5 offset:47104
    ds_read_b128 v[60:63], v5 offset:48128
    v_mov_b32_e64 v22, 7
    s_mov_b64 exec, 1
    ds_write_b32 v3, v22 offset:0
    s_mov_b64 exec, -1
    s_waitcnt lgkmcnt(8)
    v_mfma_f32_16x16x32_bf16 v[132:135], v[40:43], v[24:27], v[132:135]
    s_waitcnt lgkmcnt(7)
    v_mfma_f32_16x16x32_bf16 v[132:135], v[64:67], v[48:51], v[132:135]
    v_mfma_f32_16x16x32_bf16 v[136:139], v[44:47], v[24:27], v[136:139]
    v_mfma_f32_16x16x32_bf16 v[136:139], v[68:71], v[48:51], v[136:139]
    s_waitcnt lgkmcnt(6)
    v_mfma_f32_16x16x32_bf16 v[140:143], v[40:43], v[28:31], v[140:143]
    s_waitcnt lgkmcnt(5)
    v_mfma_f32_16x16x32_bf16 v[140:143], v[64:67], v[52:55], v[140:143]
    v_mfma_f32_16x16x32_bf16 v[144:147], v[44:47], v[28:31], v[144:147]
    v_mfma_f32_16x16x32_bf16 v[144:147], v[68:71], v[52:55], v[144:147]
    s_waitcnt lgkmcnt(4)
    v_mfma_f32_16x16x32_bf16 v[148:151], v[40:43], v[32:35], v[148:151]
    s_waitcnt lgkmcnt(3)
    v_mfma_f32_16x16x32_bf16 v[148:151], v[64:67], v[56:59], v[148:151]
    v_mfma_f32_16x16x32_bf16 v[152:155], v[44:47], v[32:35], v[152:155]
    v_mfma_f32_16x16x32_bf16 v[152:155], v[68:71], v[56:59], v[152:155]
    s_waitcnt lgkmcnt(2)
    v_mfma_f32_16x16x32_bf16 v[156:159], v[40:43], v[36:39], v[156:159]
    s_waitcnt lgkmcnt(1)
    v_mfma_f32_16x16x32_bf16 v[156:159], v[64:67], v[60:63], v[156:159]
    v_mfma_f32_16x16x32_bf16 v[160:163], v[44:47], v[36:39], v[160:163]
    v_mfma_f32_16x16x32_bf16 v[160:163], v[68:71], v[60:63], v[160:163]
    ds_read_b64_tr_b16 v[40:41], v8 offset:0
    ds_read_b64_tr_b16 v[42:43], v8 offset:4096
    ds_read_b64_tr_b16 v[44:45], v9 offset:0
    ds_read_b64_tr_b16 v[46:47], v9 offset:4096
    ds_read_b64_tr_b16 v[64:65], v8 offset:8192
    ds_read_b64_tr_b16 v[66:67], v8 offset:12288
    ds_read_b64_tr_b16 v[68:69], v9 offset:8192
    ds_read_b64_tr_b16 v[70:71], v9 offset:12288
    s_waitcnt lgkmcnt(0)
    s_barrier
    ds_read_b128 v[72:75], v4 offset:0
    ds_read_b128 v[96:99], v4 offset:1024
    ds_read_b128 v[76:79], v4 offset:2048
    ds_read_b128 v[100:103], v4 offset:3072
    ds_read_b128 v[80:83], v4 offset:4096
    ds_read_b128 v[104:107], v4 offset:5120
    ds_read_b128 v[84:87], v4 offset:6144
    ds_read_b128 v[108:111], v4 offset:7168
    s_waitcnt lgkmcnt(7)
    v_mfma_f32_16x16x32_bf16 v[132:135], v[88:91], v[72:75], v[132:135]
    s_waitcnt lgkmcnt(6)
    v_mfma_f32_16x16x32_bf16 v[132:135], v[112:115], v[96:99], v[132:135]
    v_mfma_f32_16x16x32_bf16 v[136:139], v[92:95], v[72:75], v[136:139]
    v_mfma_f32_16x16x32_bf16 v[136:139], v[116:119], v[96:99], v[136:139]
    s_waitcnt lgkmcnt(5)
    v_mfma_f32_16x16x32_bf16 v[140:143], v[88:91], v[76:79], v[140:143]
    s_waitcnt lgkmcnt(4)
    v_mfma_f32_16x16x32_bf16 v[140:143], v[112:115], v[100:103], v[140:143]
    s_waitcnt lgkmcnt(0)
    s_barrier
    ds_read_b128 v[24:27], v5 offset:0
    ds_read_b128 v[48:51], v5 offset:1024
    v_mfma_f32_16x16x32_bf16 v[144:147], v[92:95], v[76:79], v[144:147]
    ds_read_b128 v[28:31], v5 offset:2048
    ds_read_b128 v[52:55], v5 offset:3072
    v_mfma_f32_16x16x32_bf16 v[144:147], v[116:119], v[100:103], v[144:147]
    ds_read_b128 v[32:35], v5 offset:4096
    ds_read_b128 v[56:59], v5 offset:5120
    v_mfma_f32_16x16x32_bf16 v[148:151], v[88:91], v[80:83], v[148:151]
    ds_read_b128 v[36:39], v5 offset:6144
    ds_read_b128 v[60:63], v5 offset:7168
    v_mfma_f32_16x16x32_bf16 v[148:151], v[112:115], v[104:107], v[148:151]
    v_mfma_f32_16x16x32_bf16 v[152:155], v[92:95], v[80:83], v[152:155]
    v_mfma_f32_16x16x32_bf16 v[152:155], v[116:119], v[104:107], v[152:155]
    v_mfma_f32_16x16x32_bf16 v[156:159], v[88:91], v[84:87], v[156:159]
    v_mfma_f32_16x16x32_bf16 v[156:159], v[112:115], v[108:111], v[156:159]
    v_mfma_f32_16x16x32_bf16 v[160:163], v[92:95], v[84:87], v[160:163]
    v_mfma_f32_16x16x32_bf16 v[160:163], v[116:119], v[108:111], v[160:163]
    s_waitcnt lgkmcnt(4)
    v_mfma_f32_16x16x32_bf16 v[132:135], v[40:43], v[24:27], v[132:135]
    v_mfma_f32_16x16x32_bf16 v[132:135], v[64:67], v[48:51], v[132:135]
    s_waitcnt lgkmcnt(0)
    s_barrier
    ds_read_b64_tr_b16 v[88:89], v8 offset:40960
    ds_read_b64_tr_b16 v[90:91], v8 offset:45056
    v_mfma_f32_16x16x32_bf16 v[136:139], v[44:47], v[24:27], v[136:139]
    ds_read_b128 v[72:75], v5 offset:40960
    ds_read_b64_tr_b16 v[112:113], v8 offset:49152
    v_mfma_f32_16x16x32_bf16 v[136:139], v[68:71], v[48:51], v[136:139]
    ds_read_b64_tr_b16 v[114:115], v8 offset:53248
    v_mfma_f32_16x16x32_bf16 v[140:143], v[40:43], v[28:31], v[140:143]
    ds_read_b128 v[96:99], v5 offset:41984
    v_mfma_f32_16x16x32_bf16 v[140:143], v[64:67], v[52:55], v[140:143]
    ds_read_b64_tr_b16 v[92:93], v9 offset:40960
    v_mfma_f32_16x16x32_bf16 v[144:147], v[44:47], v[28:31], v[144:147]
    ds_read_b64_tr_b16 v[94:95], v9 offset:45056
    v_mfma_f32_16x16x32_bf16 v[144:147], v[68:71], v[52:55], v[144:147]
    ds_read_b64_tr_b16 v[116:117], v9 offset:49152
    v_mfma_f32_16x16x32_bf16 v[148:151], v[40:43], v[32:35], v[148:151]
    ds_read_b64_tr_b16 v[118:119], v9 offset:53248
    v_mfma_f32_16x16x32_bf16 v[148:151], v[64:67], v[56:59], v[148:151]
    ds_read_b128 v[76:79], v5 offset:43008
    v_mfma_f32_16x16x32_bf16 v[152:155], v[44:47], v[32:35], v[152:155]
    ds_read_b128 v[100:103], v5 offset:44032
    v_mfma_f32_16x16x32_bf16 v[152:155], v[68:71], v[56:59], v[152:155]
    ds_read_b128 v[80:83], v5 offset:45056
    v_mfma_f32_16x16x32_bf16 v[156:159], v[40:43], v[36:39], v[156:159]
    ds_read_b128 v[104:107], v5 offset:46080
    v_mfma_f32_16x16x32_bf16 v[156:159], v[64:67], v[60:63], v[156:159]
    s_waitcnt lgkmcnt(8)
    ds_read_b128 v[84:87], v5 offset:47104
    v_mfma_f32_16x16x32_bf16 v[160:163], v[44:47], v[36:39], v[160:163]
    ds_read_b128 v[108:111], v5 offset:48128
    v_mfma_f32_16x16x32_bf16 v[160:163], v[68:71], v[60:63], v[160:163]
    s_waitcnt lgkmcnt(4)
    v_mfma_f32_16x16x32_bf16 v[132:135], v[88:91], v[72:75], v[132:135]
    v_mfma_f32_16x16x32_bf16 v[132:135], v[112:115], v[96:99], v[132:135]
    s_waitcnt lgkmcnt(0)
    s_barrier
    ds_read_b64_tr_b16 v[40:41], v128 offset:16384
    ds_read_b64_tr_b16 v[42:43], v128 offset:20480
    v_mfma_f32_16x16x32_bf16 v[136:139], v[92:95], v[72:75], v[136:139]
    ds_read_b128 v[24:27], v4 offset:40960
    ds_read_b64_tr_b16 v[64:65], v128 offset:24576
    v_mfma_f32_16x16x32_bf16 v[136:139], v[116:119], v[96:99], v[136:139]
    ds_read_b64_tr_b16 v[66:67], v128 offset:28672
    v_mfma_f32_16x16x32_bf16 v[140:143], v[88:91], v[76:79], v[140:143]
    ds_read_b128 v[48:51], v4 offset:41984
    v_mfma_f32_16x16x32_bf16 v[140:143], v[112:115], v[100:103], v[140:143]
    ds_read_b64_tr_b16 v[44:45], v129 offset:16384
    v_mfma_f32_16x16x32_bf16 v[144:147], v[92:95], v[76:79], v[144:147]
    ds_read_b64_tr_b16 v[46:47], v129 offset:20480
    v_mfma_f32_16x16x32_bf16 v[144:147], v[116:119], v[100:103], v[144:147]
    ds_read_b64_tr_b16 v[68:69], v129 offset:24576
    v_mfma_f32_16x16x32_bf16 v[148:151], v[88:91], v[80:83], v[148:151]
    ds_read_b64_tr_b16 v[70:71], v129 offset:28672
    v_mfma_f32_16x16x32_bf16 v[148:151], v[112:115], v[104:107], v[148:151]
    ds_read_b128 v[28:31], v4 offset:43008
    v_mfma_f32_16x16x32_bf16 v[152:155], v[92:95], v[80:83], v[152:155]
    ds_read_b128 v[52:55], v4 offset:44032
    v_mfma_f32_16x16x32_bf16 v[152:155], v[116:119], v[104:107], v[152:155]
    ds_read_b128 v[32:35], v4 offset:45056
    v_mfma_f32_16x16x32_bf16 v[156:159], v[88:91], v[84:87], v[156:159]
    ds_read_b128 v[56:59], v4 offset:46080
    v_mfma_f32_16x16x32_bf16 v[156:159], v[112:115], v[108:111], v[156:159]
    s_waitcnt lgkmcnt(8)
    ds_read_b128 v[36:39], v4 offset:47104
    v_mfma_f32_16x16x32_bf16 v[160:163], v[92:95], v[84:87], v[160:163]
    ds_read_b128 v[60:63], v4 offset:48128
    v_mfma_f32_16x16x32_bf16 v[160:163], v[116:119], v[108:111], v[160:163]
    s_waitcnt lgkmcnt(4)
    v_mfma_f32_16x16x32_bf16 v[132:135], v[40:43], v[24:27], v[132:135]
    v_mfma_f32_16x16x32_bf16 v[132:135], v[64:67], v[48:51], v[132:135]
    s_waitcnt lgkmcnt(0)
    s_barrier
    ds_read_b64_tr_b16 v[88:89], v130 offset:0
    ds_read_b64_tr_b16 v[90:91], v130 offset:4096
    v_mfma_f32_16x16x32_bf16 v[136:139], v[44:47], v[24:27], v[136:139]
    ds_read_b128 v[72:75], v4 offset:0
    ds_read_b64_tr_b16 v[112:113], v130 offset:8192
    v_mfma_f32_16x16x32_bf16 v[136:139], v[68:71], v[48:51], v[136:139]
    ds_read_b64_tr_b16 v[114:115], v130 offset:12288
    v_mfma_f32_16x16x32_bf16 v[140:143], v[40:43], v[28:31], v[140:143]
    ds_read_b128 v[96:99], v4 offset:1024
    v_mfma_f32_16x16x32_bf16 v[140:143], v[64:67], v[52:55], v[140:143]
    ds_read_b64_tr_b16 v[92:93], v131 offset:0
    v_mfma_f32_16x16x32_bf16 v[144:147], v[44:47], v[28:31], v[144:147]
    ds_read_b64_tr_b16 v[94:95], v131 offset:4096
    v_mfma_f32_16x16x32_bf16 v[144:147], v[68:71], v[52:55], v[144:147]
    ds_read_b64_tr_b16 v[116:117], v131 offset:8192
    v_mfma_f32_16x16x32_bf16 v[148:151], v[40:43], v[32:35], v[148:151]
    ds_read_b64_tr_b16 v[118:119], v131 offset:12288
    v_mfma_f32_16x16x32_bf16 v[148:151], v[64:67], v[56:59], v[148:151]
    ds_read_b128 v[76:79], v4 offset:2048
    v_mfma_f32_16x16x32_bf16 v[152:155], v[44:47], v[32:35], v[152:155]
    ds_read_b128 v[100:103], v4 offset:3072
    v_mfma_f32_16x16x32_bf16 v[152:155], v[68:71], v[56:59], v[152:155]
    ds_read_b128 v[80:83], v4 offset:4096
    v_mfma_f32_16x16x32_bf16 v[156:159], v[40:43], v[36:39], v[156:159]
    ds_read_b128 v[104:107], v4 offset:5120
    v_mfma_f32_16x16x32_bf16 v[156:159], v[64:67], v[60:63], v[156:159]
    s_waitcnt lgkmcnt(8)
    ds_read_b128 v[84:87], v4 offset:6144
    v_mfma_f32_16x16x32_bf16 v[160:163], v[44:47], v[36:39], v[160:163]
    ds_read_b128 v[108:111], v4 offset:7168
    v_mfma_f32_16x16x32_bf16 v[160:163], v[68:71], v[60:63], v[160:163]
    s_waitcnt lgkmcnt(4)
    v_mfma_f32_16x16x32_bf16 v[132:135], v[88:91], v[72:75], v[132:135]
    v_mfma_f32_16x16x32_bf16 v[132:135], v[112:115], v[96:99], v[132:135]
    s_waitcnt lgkmcnt(0)
    s_barrier
    ds_read_b64_tr_b16 v[40:41], v128 offset:40960
    ds_read_b64_tr_b16 v[42:43], v128 offset:45056
    v_mfma_f32_16x16x32_bf16 v[136:139], v[92:95], v[72:75], v[136:139]
    ds_read_b128 v[24:27], v5 offset:0
    ds_read_b64_tr_b16 v[64:65], v128 offset:49152
    v_mfma_f32_16x16x32_bf16 v[136:139], v[116:119], v[96:99], v[136:139]
    ds_read_b64_tr_b16 v[66:67], v128 offset:53248
    v_mfma_f32_16x16x32_bf16 v[140:143], v[88:91], v[76:79], v[140:143]
    ds_read_b128 v[48:51], v5 offset:1024
    v_mfma_f32_16x16x32_bf16 v[140:143], v[112:115], v[100:103], v[140:143]
    ds_read_b64_tr_b16 v[44:45], v129 offset:40960
    v_mfma_f32_16x16x32_bf16 v[144:147], v[92:95], v[76:79], v[144:147]
    ds_read_b64_tr_b16 v[46:47], v129 offset:45056
    v_mfma_f32_16x16x32_bf16 v[144:147], v[116:119], v[100:103], v[144:147]
    ds_read_b64_tr_b16 v[68:69], v129 offset:49152
    v_mfma_f32_16x16x32_bf16 v[148:151], v[88:91], v[80:83], v[148:151]
    ds_read_b64_tr_b16 v[70:71], v129 offset:53248
    v_mfma_f32_16x16x32_bf16 v[148:151], v[112:115], v[104:107], v[148:151]
    ds_read_b128 v[28:31], v5 offset:2048
    v_mfma_f32_16x16x32_bf16 v[152:155], v[92:95], v[80:83], v[152:155]
    ds_read_b128 v[52:55], v5 offset:3072
    v_mfma_f32_16x16x32_bf16 v[152:155], v[116:119], v[104:107], v[152:155]
    ds_read_b128 v[32:35], v5 offset:4096
    v_mfma_f32_16x16x32_bf16 v[156:159], v[88:91], v[84:87], v[156:159]
    ds_read_b128 v[56:59], v5 offset:5120
    v_mfma_f32_16x16x32_bf16 v[156:159], v[112:115], v[108:111], v[156:159]
    s_waitcnt lgkmcnt(8)
    ds_read_b128 v[36:39], v5 offset:6144
    v_mfma_f32_16x16x32_bf16 v[160:163], v[92:95], v[84:87], v[160:163]
    ds_read_b128 v[60:63], v5 offset:7168
    v_mfma_f32_16x16x32_bf16 v[160:163], v[116:119], v[108:111], v[160:163]
    s_waitcnt lgkmcnt(4)
    v_mfma_f32_16x16x32_bf16 v[132:135], v[40:43], v[24:27], v[132:135]
    v_mfma_f32_16x16x32_bf16 v[132:135], v[64:67], v[48:51], v[132:135]
    s_waitcnt lgkmcnt(0)
    s_barrier
    ds_read_b64_tr_b16 v[88:89], v130 offset:24576
    ds_read_b64_tr_b16 v[90:91], v130 offset:28672
    v_mfma_f32_16x16x32_bf16 v[136:139], v[44:47], v[24:27], v[136:139]
    ds_read_b128 v[72:75], v5 offset:40960
    ds_read_b64_tr_b16 v[112:113], v130 offset:32768
    v_mfma_f32_16x16x32_bf16 v[136:139], v[68:71], v[48:51], v[136:139]
    ds_read_b64_tr_b16 v[114:115], v130 offset:36864
    v_mfma_f32_16x16x32_bf16 v[140:143], v[40:43], v[28:31], v[140:143]
    ds_read_b128 v[96:99], v5 offset:41984
    v_mfma_f32_16x16x32_bf16 v[140:143], v[64:67], v[52:55], v[140:143]
    ds_read_b64_tr_b16 v[92:93], v131 offset:24576
    v_mfma_f32_16x16x32_bf16 v[144:147], v[44:47], v[28:31], v[144:147]
    ds_read_b64_tr_b16 v[94:95], v131 offset:28672
    v_mfma_f32_16x16x32_bf16 v[144:147], v[68:71], v[52:55], v[144:147]
    ds_read_b64_tr_b16 v[116:117], v131 offset:32768
    v_mfma_f32_16x16x32_bf16 v[148:151], v[40:43], v[32:35], v[148:151]
    ds_read_b64_tr_b16 v[118:119], v131 offset:36864
    v_mfma_f32_16x16x32_bf16 v[148:151], v[64:67], v[56:59], v[148:151]
    ds_read_b128 v[76:79], v5 offset:43008
    v_mfma_f32_16x16x32_bf16 v[152:155], v[44:47], v[32:35], v[152:155]
    ds_read_b128 v[100:103], v5 offset:44032
    v_mfma_f32_16x16x32_bf16 v[152:155], v[68:71], v[56:59], v[152:155]
    ds_read_b128 v[80:83], v5 offset:45056
    v_mfma_f32_16x16x32_bf16 v[156:159], v[40:43], v[36:39], v[156:159]
    ds_read_b128 v[104:107], v5 offset:46080
    v_mfma_f32_16x16x32_bf16 v[156:159], v[64:67], v[60:63], v[156:159]
    s_waitcnt lgkmcnt(8)
    ds_read_b128 v[84:87], v5 offset:47104
    v_mfma_f32_16x16x32_bf16 v[160:163], v[44:47], v[36:39], v[160:163]
    ds_read_b128 v[108:111], v5 offset:48128
    v_mfma_f32_16x16x32_bf16 v[160:163], v[68:71], v[60:63], v[160:163]
    s_waitcnt lgkmcnt(4)
    v_mfma_f32_16x16x32_bf16 v[132:135], v[88:91], v[72:75], v[132:135]
    v_mfma_f32_16x16x32_bf16 v[132:135], v[112:115], v[96:99], v[132:135]
    s_waitcnt lgkmcnt(0)
    s_barrier
    ds_read_b64_tr_b16 v[40:41], v128 offset:0
    ds_read_b64_tr_b16 v[42:43], v128 offset:4096
    v_mfma_f32_16x16x32_bf16 v[136:139], v[92:95], v[72:75], v[136:139]
    ds_read_b128 v[24:27], v4 offset:40960
    ds_read_b64_tr_b16 v[64:65], v128 offset:8192
    v_mfma_f32_16x16x32_bf16 v[136:139], v[116:119], v[96:99], v[136:139]
    ds_read_b64_tr_b16 v[66:67], v128 offset:12288
    v_mfma_f32_16x16x32_bf16 v[140:143], v[88:91], v[76:79], v[140:143]
    ds_read_b128 v[48:51], v4 offset:41984
    v_mfma_f32_16x16x32_bf16 v[140:143], v[112:115], v[100:103], v[140:143]
    ds_read_b64_tr_b16 v[44:45], v129 offset:0
    v_mfma_f32_16x16x32_bf16 v[144:147], v[92:95], v[76:79], v[144:147]
    ds_read_b64_tr_b16 v[46:47], v129 offset:4096
    v_mfma_f32_16x16x32_bf16 v[144:147], v[116:119], v[100:103], v[144:147]
    ds_read_b64_tr_b16 v[68:69], v129 offset:8192
    v_mfma_f32_16x16x32_bf16 v[148:151], v[88:91], v[80:83], v[148:151]
    ds_read_b64_tr_b16 v[70:71], v129 offset:12288
    v_mfma_f32_16x16x32_bf16 v[148:151], v[112:115], v[104:107], v[148:151]
    ds_read_b128 v[28:31], v4 offset:43008
    v_mfma_f32_16x16x32_bf16 v[152:155], v[92:95], v[80:83], v[152:155]
    ds_read_b128 v[52:55], v4 offset:44032
    v_mfma_f32_16x16x32_bf16 v[152:155], v[116:119], v[104:107], v[152:155]
    ds_read_b128 v[32:35], v4 offset:45056
    v_mfma_f32_16x16x32_bf16 v[156:159], v[88:91], v[84:87], v[156:159]
    ds_read_b128 v[56:59], v4 offset:46080
    v_mfma_f32_16x16x32_bf16 v[156:159], v[112:115], v[108:111], v[156:159]
    s_waitcnt lgkmcnt(8)
    ds_read_b128 v[36:39], v4 offset:47104
    v_mfma_f32_16x16x32_bf16 v[160:163], v[92:95], v[84:87], v[160:163]
    ds_read_b128 v[60:63], v4 offset:48128
    v_mfma_f32_16x16x32_bf16 v[160:163], v[116:119], v[108:111], v[160:163]
    s_waitcnt lgkmcnt(4)
    v_mfma_f32_16x16x32_bf16 v[132:135], v[40:43], v[24:27], v[132:135]
    v_mfma_f32_16x16x32_bf16 v[132:135], v[64:67], v[48:51], v[132:135]
    s_waitcnt lgkmcnt(0)
    s_barrier
    ds_read_b64_tr_b16 v[88:89], v8 offset:0
    ds_read_b64_tr_b16 v[90:91], v8 offset:4096
    v_mfma_f32_16x16x32_bf16 v[136:139], v[44:47], v[24:27], v[136:139]
    ds_read_b128 v[72:75], v4 offset:0
    ds_read_b64_tr_b16 v[112:113], v8 offset:8192
    v_mfma_f32_16x16x32_bf16 v[136:139], v[68:71], v[48:51], v[136:139]
    ds_read_b64_tr_b16 v[114:115], v8 offset:12288
    v_mfma_f32_16x16x32_bf16 v[140:143], v[40:43], v[28:31], v[140:143]
    ds_read_b128 v[96:99], v4 offset:1024
    v_mfma_f32_16x16x32_bf16 v[140:143], v[64:67], v[52:55], v[140:143]
    ds_read_b64_tr_b16 v[92:93], v9 offset:0
    v_mfma_f32_16x16x32_bf16 v[144:147], v[44:47], v[28:31], v[144:147]
    ds_read_b64_tr_b16 v[94:95], v9 offset:4096
    v_mfma_f32_16x16x32_bf16 v[144:147], v[68:71], v[52:55], v[144:147]
    ds_read_b64_tr_b16 v[116:117], v9 offset:8192
    v_mfma_f32_16x16x32_bf16 v[148:151], v[40:43], v[32:35], v[148:151]
    ds_read_b64_tr_b16 v[118:119], v9 offset:12288
    v_mfma_f32_16x16x32_bf16 v[148:151], v[64:67], v[56:59], v[148:151]
    ds_read_b128 v[76:79], v4 offset:2048
    v_mfma_f32_16x16x32_bf16 v[152:155], v[44:47], v[32:35], v[152:155]
    ds_read_b128 v[100:103], v4 offset:3072
    v_mfma_f32_16x16x32_bf16 v[152:155], v[68:71], v[56:59], v[152:155]
    ds_read_b128 v[80:83], v4 offset:4096
    v_mfma_f32_16x16x32_bf16 v[156:159], v[40:43], v[36:39], v[156:159]
    ds_read_b128 v[104:107], v4 offset:5120
    v_mfma_f32_16x16x32_bf16 v[156:159], v[64:67], v[60:63], v[156:159]
    s_waitcnt lgkmcnt(8)
    ds_read_b128 v[84:87], v4 offset:6144
    v_mfma_f32_16x16x32_bf16 v[160:163], v[44:47], v[36:39], v[160:163]
    ds_read_b128 v[108:111], v4 offset:7168
    v_mfma_f32_16x16x32_bf16 v[160:163], v[68:71], v[60:63], v[160:163]
    s_waitcnt lgkmcnt(4)
    v_mfma_f32_16x16x32_bf16 v[132:135], v[88:91], v[72:75], v[132:135]
    v_mfma_f32_16x16x32_bf16 v[132:135], v[112:115], v[96:99], v[132:135]
    s_waitcnt lgkmcnt(0)
    s_barrier
    ds_read_b64_tr_b16 v[40:41], v8 offset:40960
    ds_read_b64_tr_b16 v[42:43], v8 offset:45056
    v_mfma_f32_16x16x32_bf16 v[136:139], v[92:95], v[72:75], v[136:139]
    ds_read_b128 v[24:27], v5 offset:0
    ds_read_b64_tr_b16 v[64:65], v8 offset:49152
    v_mfma_f32_16x16x32_bf16 v[136:139], v[116:119], v[96:99], v[136:139]
    ds_read_b64_tr_b16 v[66:67], v8 offset:53248
    v_mfma_f32_16x16x32_bf16 v[140:143], v[88:91], v[76:79], v[140:143]
    ds_read_b128 v[48:51], v5 offset:1024
    v_mfma_f32_16x16x32_bf16 v[140:143], v[112:115], v[100:103], v[140:143]
    ds_read_b64_tr_b16 v[44:45], v9 offset:40960
    v_mfma_f32_16x16x32_bf16 v[144:147], v[92:95], v[76:79], v[144:147]
    ds_read_b64_tr_b16 v[46:47], v9 offset:45056
    v_mfma_f32_16x16x32_bf16 v[144:147], v[116:119], v[100:103], v[144:147]
    ds_read_b64_tr_b16 v[68:69], v9 offset:49152
    v_mfma_f32_16x16x32_bf16 v[148:151], v[88:91], v[80:83], v[148:151]
    ds_read_b64_tr_b16 v[70:71], v9 offset:53248
    v_mfma_f32_16x16x32_bf16 v[148:151], v[112:115], v[104:107], v[148:151]
    ds_read_b128 v[28:31], v5 offset:2048
    v_mfma_f32_16x16x32_bf16 v[152:155], v[92:95], v[80:83], v[152:155]
    ds_read_b128 v[52:55], v5 offset:3072
    v_mfma_f32_16x16x32_bf16 v[152:155], v[116:119], v[104:107], v[152:155]
    ds_read_b128 v[32:35], v5 offset:4096
    v_mfma_f32_16x16x32_bf16 v[156:159], v[88:91], v[84:87], v[156:159]
    ds_read_b128 v[56:59], v5 offset:5120
    v_mfma_f32_16x16x32_bf16 v[156:159], v[112:115], v[108:111], v[156:159]
    s_waitcnt lgkmcnt(8)
    ds_read_b128 v[36:39], v5 offset:6144
    v_mfma_f32_16x16x32_bf16 v[160:163], v[92:95], v[84:87], v[160:163]
    ds_read_b128 v[60:63], v5 offset:7168
    v_mfma_f32_16x16x32_bf16 v[160:163], v[116:119], v[108:111], v[160:163]
    s_waitcnt lgkmcnt(4)
    v_mfma_f32_16x16x32_bf16 v[132:135], v[40:43], v[24:27], v[132:135]
    v_mfma_f32_16x16x32_bf16 v[132:135], v[64:67], v[48:51], v[132:135]
    s_waitcnt lgkmcnt(0)
    s_barrier
    ds_read_b64_tr_b16 v[88:89], v128 offset:16384
    ds_read_b64_tr_b16 v[90:91], v128 offset:20480
    v_mfma_f32_16x16x32_bf16 v[136:139], v[44:47], v[24:27], v[136:139]
    ds_read_b128 v[72:75], v5 offset:40960
    ds_read_b64_tr_b16 v[112:113], v128 offset:24576
    v_mfma_f32_16x16x32_bf16 v[136:139], v[68:71], v[48:51], v[136:139]
    ds_read_b64_tr_b16 v[114:115], v128 offset:28672
    v_mfma_f32_16x16x32_bf16 v[140:143], v[40:43], v[28:31], v[140:143]
    ds_read_b128 v[96:99], v5 offset:41984
    v_mfma_f32_16x16x32_bf16 v[140:143], v[64:67], v[52:55], v[140:143]
    ds_read_b64_tr_b16 v[92:93], v129 offset:16384
    v_mfma_f32_16x16x32_bf16 v[144:147], v[44:47], v[28:31], v[144:147]
    ds_read_b64_tr_b16 v[94:95], v129 offset:20480
    v_mfma_f32_16x16x32_bf16 v[144:147], v[68:71], v[52:55], v[144:147]
    ds_read_b64_tr_b16 v[116:117], v129 offset:24576
    v_mfma_f32_16x16x32_bf16 v[148:151], v[40:43], v[32:35], v[148:151]
    ds_read_b64_tr_b16 v[118:119], v129 offset:28672
    v_mfma_f32_16x16x32_bf16 v[148:151], v[64:67], v[56:59], v[148:151]
    ds_read_b128 v[76:79], v5 offset:43008
    v_mfma_f32_16x16x32_bf16 v[152:155], v[44:47], v[32:35], v[152:155]
    ds_read_b128 v[100:103], v5 offset:44032
    v_mfma_f32_16x16x32_bf16 v[152:155], v[68:71], v[56:59], v[152:155]
    ds_read_b128 v[80:83], v5 offset:45056
    v_mfma_f32_16x16x32_bf16 v[156:159], v[40:43], v[36:39], v[156:159]
    ds_read_b128 v[104:107], v5 offset:46080
    v_mfma_f32_16x16x32_bf16 v[156:159], v[64:67], v[60:63], v[156:159]
    s_waitcnt lgkmcnt(8)
    ds_read_b128 v[84:87], v5 offset:47104
    v_mfma_f32_16x16x32_bf16 v[160:163], v[44:47], v[36:39], v[160:163]
    ds_read_b128 v[108:111], v5 offset:48128
    v_mfma_f32_16x16x32_bf16 v[160:163], v[68:71], v[60:63], v[160:163]
    s_waitcnt lgkmcnt(4)
    v_mfma_f32_16x16x32_bf16 v[132:135], v[88:91], v[72:75], v[132:135]
    v_mfma_f32_16x16x32_bf16 v[132:135], v[112:115], v[96:99], v[132:135]
    s_waitcnt lgkmcnt(0)
    s_barrier
    ds_read_b64_tr_b16 v[40:41], v130 offset:0
    ds_read_b64_tr_b16 v[42:43], v130 offset:4096
    v_mfma_f32_16x16x32_bf16 v[136:139], v[92:95], v[72:75], v[136:139]
    ds_read_b128 v[24:27], v4 offset:40960
    ds_read_b64_tr_b16 v[64:65], v130 offset:8192
    v_mfma_f32_16x16x32_bf16 v[136:139], v[116:119], v[96:99], v[136:139]
    ds_read_b64_tr_b16 v[66:67], v130 offset:12288
    v_mfma_f32_16x16x32_bf16 v[140:143], v[88:91], v[76:79], v[140:143]
    ds_read_b128 v[48:51], v4 offset:41984
    v_mfma_f32_16x16x32_bf16 v[140:143], v[112:115], v[100:103], v[140:143]
    ds_read_b64_tr_b16 v[44:45], v131 offset:0
    v_mfma_f32_16x16x32_bf16 v[144:147], v[92:95], v[76:79], v[144:147]
    ds_read_b64_tr_b16 v[46:47], v131 offset:4096
    v_mfma_f32_16x16x32_bf16 v[144:147], v[116:119], v[100:103], v[144:147]
    ds_read_b64_tr_b16 v[68:69], v131 offset:8192
    v_mfma_f32_16x16x32_bf16 v[148:151], v[88:91], v[80:83], v[148:151]
    ds_read_b64_tr_b16 v[70:71], v131 offset:12288
    v_mfma_f32_16x16x32_bf16 v[148:151], v[112:115], v[104:107], v[148:151]
    ds_read_b128 v[28:31], v4 offset:43008
    v_mfma_f32_16x16x32_bf16 v[152:155], v[92:95], v[80:83], v[152:155]
    ds_read_b128 v[52:55], v4 offset:44032
    v_mfma_f32_16x16x32_bf16 v[152:155], v[116:119], v[104:107], v[152:155]
    ds_read_b128 v[32:35], v4 offset:45056
    v_mfma_f32_16x16x32_bf16 v[156:159], v[88:91], v[84:87], v[156:159]
    ds_read_b128 v[56:59], v4 offset:46080
    v_mfma_f32_16x16x32_bf16 v[156:159], v[112:115], v[108:111], v[156:159]
    s_waitcnt lgkmcnt(8)
    ds_read_b128 v[36:39], v4 offset:47104
    v_mfma_f32_16x16x32_bf16 v[160:163], v[92:95], v[84:87], v[160:163]
    ds_read_b128 v[60:63], v4 offset:48128
    v_mfma_f32_16x16x32_bf16 v[160:163], v[116:119], v[108:111], v[160:163]
    s_waitcnt lgkmcnt(4)
    v_mfma_f32_16x16x32_bf16 v[132:135], v[40:43], v[24:27], v[132:135]
    v_mfma_f32_16x16x32_bf16 v[132:135], v[64:67], v[48:51], v[132:135]
    s_waitcnt lgkmcnt(0)
    s_barrier
    ds_read_b64_tr_b16 v[88:89], v128 offset:40960
    ds_read_b64_tr_b16 v[90:91], v128 offset:45056
    v_mfma_f32_16x16x32_bf16 v[136:139], v[44:47], v[24:27], v[136:139]
    ds_read_b128 v[72:75], v4 offset:0
    ds_read_b64_tr_b16 v[112:113], v128 offset:49152
    v_mfma_f32_16x16x32_bf16 v[136:139], v[68:71], v[48:51], v[136:139]
    ds_read_b64_tr_b16 v[114:115], v128 offset:53248
    v_mfma_f32_16x16x32_bf16 v[140:143], v[40:43], v[28:31], v[140:143]
    ds_read_b128 v[96:99], v4 offset:1024
    v_mfma_f32_16x16x32_bf16 v[140:143], v[64:67], v[52:55], v[140:143]
    ds_read_b64_tr_b16 v[92:93], v129 offset:40960
    v_mfma_f32_16x16x32_bf16 v[144:147], v[44:47], v[28:31], v[144:147]
    ds_read_b64_tr_b16 v[94:95], v129 offset:45056
    v_mfma_f32_16x16x32_bf16 v[144:147], v[68:71], v[52:55], v[144:147]
    ds_read_b64_tr_b16 v[116:117], v129 offset:49152
    v_mfma_f32_16x16x32_bf16 v[148:151], v[40:43], v[32:35], v[148:151]
    ds_read_b64_tr_b16 v[118:119], v129 offset:53248
    v_mfma_f32_16x16x32_bf16 v[148:151], v[64:67], v[56:59], v[148:151]
    ds_read_b128 v[76:79], v4 offset:2048
    v_mfma_f32_16x16x32_bf16 v[152:155], v[44:47], v[32:35], v[152:155]
    ds_read_b128 v[100:103], v4 offset:3072
    v_mfma_f32_16x16x32_bf16 v[152:155], v[68:71], v[56:59], v[152:155]
    ds_read_b128 v[80:83], v4 offset:4096
    v_mfma_f32_16x16x32_bf16 v[156:159], v[40:43], v[36:39], v[156:159]
    ds_read_b128 v[104:107], v4 offset:5120
    v_mfma_f32_16x16x32_bf16 v[156:159], v[64:67], v[60:63], v[156:159]
    s_waitcnt lgkmcnt(8)
    ds_read_b128 v[84:87], v4 offset:6144
    v_mfma_f32_16x16x32_bf16 v[160:163], v[44:47], v[36:39], v[160:163]
    ds_read_b128 v[108:111], v4 offset:7168
    v_mfma_f32_16x16x32_bf16 v[160:163], v[68:71], v[60:63], v[160:163]
    s_waitcnt lgkmcnt(4)
    v_mfma_f32_16x16x32_bf16 v[132:135], v[88:91], v[72:75], v[132:135]
    v_mfma_f32_16x16x32_bf16 v[132:135], v[112:115], v[96:99], v[132:135]
    s_waitcnt lgkmcnt(0)
    s_barrier
    ds_read_b64_tr_b16 v[40:41], v130 offset:24576
    ds_read_b64_tr_b16 v[42:43], v130 offset:28672
    v_mfma_f32_16x16x32_bf16 v[136:139], v[92:95], v[72:75], v[136:139]
    ds_read_b128 v[24:27], v5 offset:0
    ds_read_b64_tr_b16 v[64:65], v130 offset:32768
    v_mfma_f32_16x16x32_bf16 v[136:139], v[116:119], v[96:99], v[136:139]
    ds_read_b64_tr_b16 v[66:67], v130 offset:36864
    v_mfma_f32_16x16x32_bf16 v[140:143], v[88:91], v[76:79], v[140:143]
    ds_read_b128 v[48:51], v5 offset:1024
    v_mfma_f32_16x16x32_bf16 v[140:143], v[112:115], v[100:103], v[140:143]
    ds_read_b64_tr_b16 v[44:45], v131 offset:24576
    v_mfma_f32_16x16x32_bf16 v[144:147], v[92:95], v[76:79], v[144:147]
    ds_read_b64_tr_b16 v[46:47], v131 offset:28672
    v_mfma_f32_16x16x32_bf16 v[144:147], v[116:119], v[100:103], v[144:147]
    ds_read_b64_tr_b16 v[68:69], v131 offset:32768
    v_mfma_f32_16x16x32_bf16 v[148:151], v[88:91], v[80:83], v[148:151]
    ds_read_b64_tr_b16 v[70:71], v131 offset:36864
    v_mfma_f32_16x16x32_bf16 v[148:151], v[112:115], v[104:107], v[148:151]
    ds_read_b128 v[28:31], v5 offset:2048
    v_mfma_f32_16x16x32_bf16 v[152:155], v[92:95], v[80:83], v[152:155]
    ds_read_b128 v[52:55], v5 offset:3072
    v_mfma_f32_16x16x32_bf16 v[152:155], v[116:119], v[104:107], v[152:155]
    ds_read_b128 v[32:35], v5 offset:4096
    v_mfma_f32_16x16x32_bf16 v[156:159], v[88:91], v[84:87], v[156:159]
    ds_read_b128 v[56:59], v5 offset:5120
    v_mfma_f32_16x16x32_bf16 v[156:159], v[112:115], v[108:111], v[156:159]
    s_waitcnt lgkmcnt(8)
    ds_read_b128 v[36:39], v5 offset:6144
    v_mfma_f32_16x16x32_bf16 v[160:163], v[92:95], v[84:87], v[160:163]
    ds_read_b128 v[60:63], v5 offset:7168
    v_mfma_f32_16x16x32_bf16 v[160:163], v[116:119], v[108:111], v[160:163]
    s_waitcnt lgkmcnt(4)
    v_mfma_f32_16x16x32_bf16 v[132:135], v[40:43], v[24:27], v[132:135]
    v_mfma_f32_16x16x32_bf16 v[132:135], v[64:67], v[48:51], v[132:135]
    s_waitcnt lgkmcnt(0)
    s_barrier
    ds_read_b64_tr_b16 v[88:89], v128 offset:0
    ds_read_b64_tr_b16 v[90:91], v128 offset:4096
    v_mfma_f32_16x16x32_bf16 v[136:139], v[44:47], v[24:27], v[136:139]
    ds_read_b128 v[72:75], v5 offset:40960
    ds_read_b64_tr_b16 v[112:113], v128 offset:8192
    v_mfma_f32_16x16x32_bf16 v[136:139], v[68:71], v[48:51], v[136:139]
    ds_read_b64_tr_b16 v[114:115], v128 offset:12288
    ds_read_b128 v[96:99], v5 offset:41984
    v_mfma_f32_16x16x32_bf16 v[140:143], v[40:43], v[28:31], v[140:143]
    ds_read_b64_tr_b16 v[92:93], v129 offset:0
    ds_read_b64_tr_b16 v[94:95], v129 offset:4096
    v_mfma_f32_16x16x32_bf16 v[140:143], v[64:67], v[52:55], v[140:143]
    ds_read_b64_tr_b16 v[116:117], v129 offset:8192
    ds_read_b64_tr_b16 v[118:119], v129 offset:12288
    v_mfma_f32_16x16x32_bf16 v[144:147], v[44:47], v[28:31], v[144:147]
    ds_read_b128 v[76:79], v5 offset:43008
    v_mfma_f32_16x16x32_bf16 v[144:147], v[68:71], v[52:55], v[144:147]
    ds_read_b128 v[100:103], v5 offset:44032
    s_waitcnt lgkmcnt(9)
    v_mfma_f32_16x16x32_bf16 v[132:135], v[88:91], v[72:75], v[132:135]
    ds_read_b128 v[80:83], v5 offset:45056
    s_waitcnt lgkmcnt(7)
    v_mfma_f32_16x16x32_bf16 v[132:135], v[112:115], v[96:99], v[132:135]
    ds_read_b128 v[104:107], v5 offset:46080
    s_waitcnt lgkmcnt(6)
    v_mfma_f32_16x16x32_bf16 v[136:139], v[92:95], v[72:75], v[136:139]
    ds_read_b128 v[84:87], v5 offset:47104
    s_waitcnt lgkmcnt(5)
    v_mfma_f32_16x16x32_bf16 v[136:139], v[116:119], v[96:99], v[136:139]
    ds_read_b128 v[108:111], v5 offset:48128
    v_mfma_f32_16x16x32_bf16 v[148:151], v[40:43], v[32:35], v[148:151]
    v_mfma_f32_16x16x32_bf16 v[148:151], v[64:67], v[56:59], v[148:151]
W_4:
    s_cbranch_execz R_4
    s_nop 0
    v_mfma_f32_16x16x32_bf16 v[152:155], v[44:47], v[32:35], v[152:155]
    v_cvt_pk_bf16_f32 v132, v132, v133
    v_cvt_pk_bf16_f32 v133, v134, v135
    v_mfma_f32_16x16x32_bf16 v[152:155], v[68:71], v[56:59], v[152:155]
    s_nop 0
    v_cvt_pk_bf16_f32 v134, v136, v137
    v_cvt_pk_bf16_f32 v135, v138, v139
    s_waitcnt lgkmcnt(5)
    v_mfma_f32_16x16x32_bf16 v[140:143], v[88:91], v[76:79], v[140:143]
    ds_write2_b64 v18, v[132:133], v[134:135] offset0:0 offset1:4
    s_waitcnt lgkmcnt(5)
    v_mfma_f32_16x16x32_bf16 v[140:143], v[112:115], v[100:103], v[140:143]
    v_mfma_f32_16x16x32_bf16 v[144:147], v[92:95], v[76:79], v[144:147]
    v_mfma_f32_16x16x32_bf16 v[144:147], v[116:119], v[100:103], v[144:147]
    v_mfma_f32_16x16x32_bf16 v[156:159], v[40:43], v[36:39], v[156:159]
    v_mfma_f32_16x16x32_bf16 v[156:159], v[64:67], v[60:63], v[156:159]
    v_mfma_f32_16x16x32_bf16 v[160:163], v[44:47], v[36:39], v[160:163]
    s_waitcnt lgkmcnt(0)
    s_barrier
    s_nop 0
    v_cvt_pk_bf16_f32 v140, v140, v141
    v_mfma_f32_16x16x32_bf16 v[160:163], v[68:71], v[60:63], v[160:163]
    v_cvt_pk_bf16_f32 v141, v142, v143
    v_cvt_pk_bf16_f32 v142, v144, v145
    v_mfma_f32_16x16x32_bf16 v[148:151], v[88:91], v[80:83], v[148:151]
    v_cvt_pk_bf16_f32 v143, v146, v147
    ds_write2_b64 v19, v[140:141], v[142:143] offset0:0 offset1:4
    v_mfma_f32_16x16x32_bf16 v[148:151], v[112:115], v[104:107], v[148:151]
    v_mfma_f32_16x16x32_bf16 v[152:155], v[92:95], v[80:83], v[152:155]
    v_mfma_f32_16x16x32_bf16 v[152:155], v[116:119], v[104:107], v[152:155]
    v_mfma_f32_16x16x32_bf16 v[156:159], v[88:91], v[84:87], v[156:159]
    v_mfma_f32_16x16x32_bf16 v[156:159], v[112:115], v[108:111], v[156:159]
    v_mfma_f32_16x16x32_bf16 v[160:163], v[92:95], v[84:87], v[160:163]
    s_waitcnt lgkmcnt(0)
    s_barrier
    s_nop 0
    v_cvt_pk_bf16_f32 v148, v148, v149
    v_cvt_pk_bf16_f32 v149, v150, v151
    v_mfma_f32_16x16x32_bf16 v[160:163], v[116:119], v[108:111], v[160:163]
    v_cvt_pk_bf16_f32 v150, v152, v153
    v_cvt_pk_bf16_f32 v151, v154, v155
    ds_write2_b64 v20, v[148:149], v[150:151] offset0:0 offset1:4
    v_cvt_pk_bf16_f32 v156, v156, v157
    v_cvt_pk_bf16_f32 v157, v158, v159
    s_nop 2
    v_cvt_pk_bf16_f32 v158, v160, v161
    v_cvt_pk_bf16_f32 v159, v162, v163
    ds_write2_b64 v21, v[156:157], v[158:159] offset0:0 offset1:4
    s_waitcnt lgkmcnt(0)
    s_barrier
F_end:
    s_endpgm
F_loader:
    s_mov_b32 s48, 0x76542130
    s_mov_b32 s49, 0xfedca9b8
    s_cmp_eq_u32 s35, 1
    s_cselect_b32 s48, 0x75463021, s48
    s_cselect_b32 s49, 0xfdceba98, s49
    s_cmp_eq_u32 s35, 2
    s_cselect_b32 s48, 0x96543102, s48
    s_cselect_b32 s49, 0xfedcba87, s49
    s_cmp_eq_u32 s35, 3
    s_cselect_b32 s48, 0x76532410, s48
    s_cselect_b32 s49, 0xfedbac98, s49
    s_cmp_eq_u32 s35, 4
    s_cselect_b32 s48, 0x65743021, s48
    s_cselect_b32 s49, 0xedfcba98, s49
    s_cmp_eq_u32 s35, 5
    s_cselect_b32 s48, 0x76543102, s48
    s_cselect_b32 s49, 0xfedcb98a, s49
    s_cmp_eq_u32 s35, 6
    s_cselect_b32 s48, 0x76435210, s48
    s_cselect_b32 s49, 0xfecbda98, s49
    s_cmp_eq_u32 s35, 7
    s_cselect_b32 s48, 0x68543021, s48
    s_cselect_b32 s49, 0xfedcba97, s49
    s_setprio 0
    s_sub_u32 s3, s3, 8
    v_lshrrev_b32 v2, 3, v0
    v_and_b32 v3, 7, v0
    v_lshrrev_b32 v4, 1, v2
    v_xor_b32 v5, v3, v4
    v_xor_b32 v6, 4, v5
    v_lshlrev_b32 v5, 4, v5
    v_lshlrev_b32 v6, 4, v6
    v_lshlrev_b32 v7, 11, v2
    v_add_u32 v12, v5, v7
    v_add_u32 v13, v6, v7
    v_and_b32 v4, 1, v4
    v_lshlrev_b32 v4, 1, v4
    v_xor_b32 v8, v3, v4
    v_xor_b32 v9, 4, v8
    v_lshlrev_b32 v8, 4, v8
    v_lshlrev_b32 v9, 4, v9
    v_mul_u32_u24 v7, 6144, v2
    v_add_u32 v14, v8, v7
    v_add_u32_e64 v15, v9, v7
    s_lshl_b32 s36, s32, 18
    s_lshl_b32 s37, s3, 16
    s_add_u32 s36, s36, s37
    s_lshl_b32 s38, s33, 7
    s_mul_i32 s37, s3, 98304
    s_add_u32 s38, s38, s37
    s_sub_u32 s47, s10, s33
    s_lshl_b32 s47, s47, 7
    s_and_b32 s42, s39, 8
    s_and_b32 s43, s30, 6
    s_or_b32 s42, s42, s43
    s_and_b32 s43, s34, 0
    s_lshl_b32 s43, s43, 0
    s_xor_b32 s42, s42, s43
    s_lshl_b32 s44, s3, 12
    s_lshl_b32 s45, s3, 11
    s_waitcnt lgkmcnt(0)
    s_mov_b32 s12, s4
    s_mov_b32 s13, s5
    s_mov_b32 s14, 0x400000
    s_mov_b32 s15, 0x00020000
    s_mov_b32 s16, s6
    s_mov_b32 s17, s7
    s_mov_b32 s18, 0x600000
    s_mov_b32 s19, 0x00020000
    s_bfe_u32 s40, s48, 0x40000
    s_bitcmp1_b32 s40, 3
    s_cselect_b32 s41, s39, s42
    s_xor_b32 s40, s40, s41
    s_mul_i32 s41, s40, 393216
    s_add_u32 s41, s41, s38
    s_lshl_b32 s40, s40, 7
    s_add_u32 s40, s40, s36
    s_add_u32 m0, s44, 0
    s_add_u32 s46, s40, 0
    buffer_load_dwordx4 v12, s[12:15], s46 offen lds
    s_add_u32 m0, s45, 24576
    s_add_u32 s46, s41, 2048
    buffer_load_dwordx4 v14, s[16:19], s46 offen lds
    s_add_u32 m0, s45, 25600
    s_add_u32 s46, s41, 51200
    buffer_load_dwordx4 v15, s[16:19], s46 offen lds
    s_add_u32 m0, s45, 16384
    s_add_u32 s46, s41, 0
    s_add_u32 s46, s46, s47
    buffer_load_dwordx4 v14, s[16:19], s46 offen lds
    s_add_u32 m0, s45, 17408
    s_add_u32 s46, s41, 49152
    s_add_u32 s46, s46, s47
    s_nop 0
    buffer_load_dwordx4 v15, s[16:19], s46 offen lds
    s_add_u32 m0, s45, 32768
    s_add_u32 s46, s41, 4096
    buffer_load_dwordx4 v14, s[16:19], s46 offen lds
    s_add_u32 m0, s45, 33792
    s_add_u32 s46, s41, 53248
    buffer_load_dwordx4 v15, s[16:19], s46 offen lds
    s_add_u32 m0, s44, 1024
    s_add_u32 s46, s40, 16384
    buffer_load_dwordx4 v13, s[12:15], s46 offen lds
    s_add_u32 m0, s44, 2048
    s_add_u32 s46, s40, 32768
    buffer_load_dwordx4 v12, s[12:15], s46 offen lds
    s_add_u32 m0, s44, 3072
    s_add_u32 s46, s40, 49152
    buffer_load_dwordx4 v13, s[12:15], s46 offen lds
    s_bfe_u32 s40, s48, 0x40004
    s_bitcmp1_b32 s40, 3
    s_cselect_b32 s41, s39, s42
    s_xor_b32 s40, s40, s41
    s_mul_i32 s41, s40, 393216
    s_add_u32 s41, s41, s38
    s_lshl_b32 s40, s40, 7
    s_add_u32 s40, s40, s36
    s_add_u32 m0, s44, 40960
    s_add_u32 s46, s40, 0
    s_nop 0
    buffer_load_dwordx4 v12, s[12:15], s46 offen lds
    s_add_u32 m0, s45, 65536
    s_add_u32 s46, s41, 2048
    buffer_load_dwordx4 v14, s[16:19], s46 offen lds
    s_add_u32 m0, s45, 66560
    s_add_u32 s46, s41, 51200
    buffer_load_dwordx4 v15, s[16:19], s46 offen lds
    s_add_u32 m0, s45, 57344
    s_add_u32 s46, s41, 0
    s_add_u32 s46, s46, s47
    buffer_load_dwordx4 v14, s[16:19], s46 offen lds
    s_add_u32 m0, s45, 58368
    s_add_u32 s46, s41, 49152
    s_add_u32 s46, s46, s47
    s_nop 0
    buffer_load_dwordx4 v15, s[16:19], s46 offen lds
    s_add_u32 m0, s45, 73728
    s_add_u32 s46, s41, 4096
    buffer_load_dwordx4 v14, s[16:19], s46 offen lds
    s_add_u32 m0, s45, 74752
    s_add_u32 s46, s41, 53248
    buffer_load_dwordx4 v15, s[16:19], s46 offen lds
    s_add_u32 m0, s44, 41984
    s_add_u32 s46, s40, 16384
    buffer_load_dwordx4 v13, s[12:15], s46 offen lds
    s_waitcnt vmcnt(8)
    s_barrier
    s_add_u32 m0, s44, 43008
    s_add_u32 s46, s40, 32768
    buffer_load_dwordx4 v12, s[12:15], s46 offen lds
    s_add_u32 m0, s44, 44032
    s_add_u32 s46, s40, 49152
    buffer_load_dwordx4 v13, s[12:15], s46 offen lds
    s_bfe_u32 s40, s48, 0x40008
    s_bitcmp1_b32 s40, 3
    s_cselect_b32 s41, s39, s42
    s_xor_b32 s40, s40, s41
    s_mul_i32 s41, s40, 393216
    s_add_u32 s41, s41, s38
    s_lshl_b32 s40, s40, 7
    s_add_u32 s40, s40, s36
    s_add_u32 m0, s44, 81920
    s_add_u32 s46, s40, 0
    s_nop 0
    buffer_load_dwordx4 v12, s[12:15], s46 offen lds
    s_add_u32 m0, s45, 106496
    s_add_u32 s46, s41, 2048
    buffer_load_dwordx4 v14, s[16:19], s46 offen lds
    s_add_u32 m0, s45, 107520
    s_add_u32 s46, s41, 51200
    buffer_load_dwordx4 v15, s[16:19], s46 offen lds
    s_add_u32 m0, s45, 98304
    s_add_u32 s46, s41, 0
    s_add_u32 s46, s46, s47
    buffer_load_dwordx4 v14, s[16:19], s46 offen lds
    s_add_u32 m0, s45, 99328
    s_add_u32 s46, s41, 49152
    s_add_u32 s46, s46, s47
    s_nop 0
    buffer_load_dwordx4 v15, s[16:19], s46 offen lds
    s_add_u32 m0, s45, 114688
    s_add_u32 s46, s41, 4096
    buffer_load_dwordx4 v14, s[16:19], s46 offen lds
    s_add_u32 m0, s45, 115712
    s_add_u32 s46, s41, 53248
    buffer_load_dwordx4 v15, s[16:19], s46 offen lds
    s_add_u32 m0, s44, 82944
    s_add_u32 s46, s40, 16384
    buffer_load_dwordx4 v13, s[12:15], s46 offen lds
    s_add_u32 m0, s44, 83968
    s_add_u32 s46, s40, 32768
    buffer_load_dwordx4 v12, s[12:15], s46 offen lds
    s_add_u32 m0, s44, 84992
    s_add_u32 s46, s40, 49152
    buffer_load_dwordx4 v13, s[12:15], s46 offen lds
    s_waitcnt vmcnt(10)
    s_barrier
    s_bfe_u32 s40, s48, 0x4000c
    s_bitcmp1_b32 s40, 3
    s_cselect_b32 s41, s39, s42
    s_xor_b32 s40, s40, s41
    s_mul_i32 s41, s40, 393216
    s_add_u32 s41, s41, s38
    s_lshl_b32 s40, s40, 7
    s_add_u32 s40, s40, s36
    s_add_u32 m0, s44, 122880
    s_add_u32 s46, s40, 0
    s_nop 0
    buffer_load_dwordx4 v12, s[12:15], s46 offen lds
    s_add_u32 m0, s45, 147456
    s_add_u32 s46, s41, 2048
    buffer_load_dwordx4 v14, s[16:19], s46 offen lds
    s_add_u32 m0, s45, 148480
    s_add_u32 s46, s41, 51200
    buffer_load_dwordx4 v15, s[16:19], s46 offen lds
    s_add_u32 m0, s45, 139264
    s_add_u32 s46, s41, 0
    s_add_u32 s46, s46, s47
    buffer_load_dwordx4 v14, s[16:19], s46 offen lds
    s_add_u32 m0, s45, 140288
    s_add_u32 s46, s41, 49152
    s_add_u32 s46, s46, s47
    s_nop 0
    buffer_load_dwordx4 v15, s[16:19], s46 offen lds
    s_add_u32 m0, s45, 155648
    s_add_u32 s46, s41, 4096
    buffer_load_dwordx4 v14, s[16:19], s46 offen lds
    s_add_u32 m0, s45, 156672
    s_add_u32 s46, s41, 53248
    buffer_load_dwordx4 v15, s[16:19], s46 offen lds
    s_add_u32 m0, s44, 123904
    s_add_u32 s46, s40, 16384
    buffer_load_dwordx4 v13, s[12:15], s46 offen lds
    s_add_u32 m0, s44, 124928
    s_add_u32 s46, s40, 32768
    buffer_load_dwordx4 v12, s[12:15], s46 offen lds
    s_add_u32 m0, s44, 125952
    s_add_u32 s46, s40, 49152
    buffer_load_dwordx4 v13, s[12:15], s46 offen lds
    s_bfe_u32 s40, s48, 0x40010
    s_bitcmp1_b32 s40, 3
    s_cselect_b32 s41, s39, s42
    s_xor_b32 s40, s40, s41
    s_mul_i32 s41, s40, 393216
    s_add_u32 s41, s41, s38
    s_lshl_b32 s40, s40, 7
    s_add_u32 s40, s40, s36
    s_add_u32 m0, s44, 0
    s_add_u32 s46, s40, 0
    buffer_load_dwordx4 v12, s[12:15], s46 offen lds
    s_add_u32 m0, s45, 24576
    s_add_u32 s46, s41, 2048
    buffer_load_dwordx4 v14, s[16:19], s46 offen lds
    s_waitcnt vmcnt(12)
    s_barrier
    s_add_u32 m0, s45, 25600
    s_add_u32 s46, s41, 51200
    buffer_load_dwordx4 v15, s[16:19], s46 offen lds
    s_add_u32 m0, s45, 16384
    s_add_u32 s46, s41, 0
    s_add_u32 s46, s46, s47
    buffer_load_dwordx4 v14, s[16:19], s46 offen lds
    s_add_u32 m0, s45, 17408
    s_add_u32 s46, s41, 49152
    s_add_u32 s46, s46, s47
    s_nop 0
    buffer_load_dwordx4 v15, s[16:19], s46 offen lds
    s_add_u32 m0, s45, 32768
    s_add_u32 s46, s41, 4096
    buffer_load_dwordx4 v14, s[16:19], s46 offen lds
    s_add_u32 m0, s45, 33792
    s_add_u32 s46, s41, 53248
    buffer_load_dwordx4 v15, s[16:19], s46 offen lds
    s_add_u32 m0, s44, 1024
    s_add_u32 s46, s40, 16384
    buffer_load_dwordx4 v13, s[12:15], s46 offen lds
    s_add_u32 m0, s44, 2048
    s_add_u32 s46, s40, 32768
    buffer_load_dwordx4 v12, s[12:15], s46 offen lds
    s_add_u32 m0, s44, 3072
    s_add_u32 s46, s40, 49152
    buffer_load_dwordx4 v13, s[12:15], s46 offen lds
    s_bfe_u32 s40, s48, 0x40014
    s_bitcmp1_b32 s40, 3
    s_cselect_b32 s41, s39, s42
    s_xor_b32 s40, s40, s41
    s_mul_i32 s41, s40, 393216
    s_add_u32 s41, s41, s38
    s_lshl_b32 s40, s40, 7
    s_add_u32 s40, s40, s36
    s_add_u32 m0, s44, 40960
    s_add_u32 s46, s40, 0
    s_nop 0
    buffer_load_dwordx4 v12, s[12:15], s46 offen lds
    s_add_u32 m0, s45, 65536
    s_add_u32 s46, s41, 2048
    buffer_load_dwordx4 v14, s[16:19], s46 offen lds
    s_add_u32 m0, s45, 66560
    s_add_u32 s46, s41, 51200
    buffer_load_dwordx4 v15, s[16:19], s46 offen lds
    s_add_u32 m0, s45, 57344
    s_add_u32 s46, s41, 0
    s_add_u32 s46, s46, s47
    buffer_load_dwordx4 v14, s[16:19], s46 offen lds
    s_waitcnt vmcnt(14)
    s_barrier
    s_add_u32 m0, s45, 58368
    s_add_u32 s46, s41, 49152
    s_add_u32 s46, s46, s47
    s_nop 0
    buffer_load_dwordx4 v15, s[16:19], s46 offen lds
    s_add_u32 m0, s45, 73728
    s_add_u32 s46, s41, 4096
    buffer_load_dwordx4 v14, s[16:19], s46 offen lds
    s_add_u32 m0, s45, 74752
    s_add_u32 s46, s41, 53248
    buffer_load_dwordx4 v15, s[16:19], s46 offen lds
    s_add_u32 m0, s44, 41984
    s_add_u32 s46, s40, 16384
    buffer_load_dwordx4 v13, s[12:15], s46 offen lds
    s_add_u32 m0, s44, 43008
    s_add_u32 s46, s40, 32768
    buffer_load_dwordx4 v12, s[12:15], s46 offen lds
    s_add_u32 m0, s44, 44032
    s_add_u32 s46, s40, 49152
    buffer_load_dwordx4 v13, s[12:15], s46 offen lds
    s_bfe_u32 s40, s48, 0x40018
    s_bitcmp1_b32 s40, 3
    s_cselect_b32 s41, s39, s42
    s_xor_b32 s40, s40, s41
    s_mul_i32 s41, s40, 393216
    s_add_u32 s41, s41, s38
    s_lshl_b32 s40, s40, 7
    s_add_u32 s40, s40, s36
    s_add_u32 m0, s44, 81920
    s_add_u32 s46, s40, 0
    s_nop 0
    buffer_load_dwordx4 v12, s[12:15], s46 offen lds
    s_add_u32 m0, s45, 106496
    s_add_u32 s46, s41, 2048
    buffer_load_dwordx4 v14, s[16:19], s46 offen lds
    s_add_u32 m0, s45, 107520
    s_add_u32 s46, s41, 51200
    buffer_load_dwordx4 v15, s[16:19], s46 offen lds
    s_add_u32 m0, s45, 98304
    s_add_u32 s46, s41, 0
    s_add_u32 s46, s46, s47
    buffer_load_dwordx4 v14, s[16:19], s46 offen lds
    s_add_u32 m0, s45, 99328
    s_add_u32 s46, s41, 49152
    s_add_u32 s46, s46, s47
    buffer_load_dwordx4 v15, s[16:19], s46 offen lds
    s_add_u32 m0, s45, 114688
    s_add_u32 s46, s41, 4096
    buffer_load_dwordx4 v14, s[16:19], s46 offen lds
    s_waitcnt vmcnt(16)
    s_barrier
    s_nop 0
    s_add_u32 m0, s45, 115712
    s_add_u32 s46, s41, 53248
    buffer_load_dwordx4 v15, s[16:19], s46 offen lds
    s_add_u32 m0, s44, 82944
    s_add_u32 s46, s40, 16384
    buffer_load_dwordx4 v13, s[12:15], s46 offen lds
    s_add_u32 m0, s44, 83968
    s_add_u32 s46, s40, 32768
    buffer_load_dwordx4 v12, s[12:15], s46 offen lds
    s_add_u32 m0, s44, 84992
    s_add_u32 s46, s40, 49152
    buffer_load_dwordx4 v13, s[12:15], s46 offen lds
    s_bfe_u32 s40, s48, 0x4001c
    s_bitcmp1_b32 s40, 3
    s_cselect_b32 s41, s39, s42
    s_xor_b32 s40, s40, s41
    s_mul_i32 s41, s40, 393216
    s_add_u32 s41, s41, s38
    s_lshl_b32 s40, s40, 7
    s_add_u32 s40, s40, s36
    s_add_u32 m0, s44, 122880
    s_add_u32 s46, s40, 0
    s_nop 0
    buffer_load_dwordx4 v12, s[12:15], s46 offen lds
    s_add_u32 m0, s45, 147456
    s_add_u32 s46, s41, 2048
    buffer_load_dwordx4 v14, s[16:19], s46 offen lds
    s_add_u32 m0, s45, 148480
    s_add_u32 s46, s41, 51200
    buffer_load_dwordx4 v15, s[16:19], s46 offen lds
    s_add_u32 m0, s45, 139264
    s_add_u32 s46, s41, 0
    s_add_u32 s46, s46, s47
    buffer_load_dwordx4 v14, s[16:19], s46 offen lds
    s_add_u32 m0, s45, 140288
    s_add_u32 s46, s41, 49152
    s_add_u32 s46, s46, s47
    s_nop 0
    buffer_load_dwordx4 v15, s[16:19], s46 offen lds
    s_add_u32 m0, s45, 155648
    s_add_u32 s46, s41, 4096
    buffer_load_dwordx4 v14, s[16:19], s46 offen lds
    s_add_u32 m0, s45, 156672
    s_add_u32 s46, s41, 53248
    buffer_load_dwordx4 v15, s[16:19], s46 offen lds
    s_add_u32 m0, s44, 123904
    s_add_u32 s46, s40, 16384
    buffer_load_dwordx4 v13, s[12:15], s46 offen lds
    s_waitcnt vmcnt(18)
    s_barrier
    s_add_u32 m0, s44, 124928
    s_add_u32 s46, s40, 32768
    buffer_load_dwordx4 v12, s[12:15], s46 offen lds
    s_add_u32 m0, s44, 125952
    s_add_u32 s46, s40, 49152
    buffer_load_dwordx4 v13, s[12:15], s46 offen lds
    s_bfe_u32 s40, s49, 0x40000
    s_bitcmp1_b32 s40, 3
    s_cselect_b32 s41, s39, s42
    s_xor_b32 s40, s40, s41
    s_mul_i32 s41, s40, 393216
    s_add_u32 s41, s41, s38
    s_lshl_b32 s40, s40, 7
    s_add_u32 s40, s40, s36
    s_add_u32 m0, s44, 0
    s_add_u32 s46, s40, 0
    buffer_load_dwordx4 v12, s[12:15], s46 offen lds
    s_add_u32 m0, s45, 24576
    s_add_u32 s46, s41, 2048
    buffer_load_dwordx4 v14, s[16:19], s46 offen lds
    s_add_u32 m0, s45, 25600
    s_add_u32 s46, s41, 51200
    buffer_load_dwordx4 v15, s[16:19], s46 offen lds
    s_add_u32 m0, s45, 16384
    s_add_u32 s46, s41, 0
    s_add_u32 s46, s46, s47
    buffer_load_dwordx4 v14, s[16:19], s46 offen lds
    s_add_u32 m0, s45, 17408
    s_add_u32 s46, s41, 49152
    s_add_u32 s46, s46, s47
    s_nop 0
    buffer_load_dwordx4 v15, s[16:19], s46 offen lds
    s_add_u32 m0, s45, 32768
    s_add_u32 s46, s41, 4096
    buffer_load_dwordx4 v14, s[16:19], s46 offen lds
    s_add_u32 m0, s45, 33792
    s_add_u32 s46, s41, 53248
    buffer_load_dwordx4 v15, s[16:19], s46 offen lds
    s_add_u32 m0, s44, 1024
    s_add_u32 s46, s40, 16384
    buffer_load_dwordx4 v13, s[12:15], s46 offen lds
    s_add_u32 m0, s44, 2048
    s_add_u32 s46, s40, 32768
    buffer_load_dwordx4 v12, s[12:15], s46 offen lds
    s_add_u32 m0, s44, 3072
    s_add_u32 s46, s40, 49152
    buffer_load_dwordx4 v13, s[12:15], s46 offen lds
    s_waitcnt vmcnt(20)
    s_barrier
    s_bfe_u32 s40, s49, 0x40004
    s_bitcmp1_b32 s40, 3
    s_cselect_b32 s41, s39, s42
    s_xor_b32 s40, s40, s41
    s_mul_i32 s41, s40, 393216
    s_add_u32 s41, s41, s38
    s_lshl_b32 s40, s40, 7
    s_add_u32 s40, s40, s36
    s_add_u32 m0, s44, 40960
    s_add_u32 s46, s40, 0
    s_nop 0
    buffer_load_dwordx4 v12, s[12:15], s46 offen lds
    s_add_u32 m0, s45, 65536
    s_add_u32 s46, s41, 2048
    buffer_load_dwordx4 v14, s[16:19], s46 offen lds
    s_add_u32 m0, s45, 66560
    s_add_u32 s46, s41, 51200
    buffer_load_dwordx4 v15, s[16:19], s46 offen lds
    s_add_u32 m0, s45, 57344
    s_add_u32 s46, s41, 0
    s_add_u32 s46, s46, s47
    buffer_load_dwordx4 v14, s[16:19], s46 offen lds
    s_add_u32 m0, s45, 58368
    s_add_u32 s46, s41, 49152
    s_add_u32 s46, s46, s47
    s_nop 0
    buffer_load_dwordx4 v15, s[16:19], s46 offen lds
    s_add_u32 m0, s45, 73728
    s_add_u32 s46, s41, 4096
    buffer_load_dwordx4 v14, s[16:19], s46 offen lds
    s_add_u32 m0, s45, 74752
    s_add_u32 s46, s41, 53248
    buffer_load_dwordx4 v15, s[16:19], s46 offen lds
    s_add_u32 m0, s44, 41984
    s_add_u32 s46, s40, 16384
    buffer_load_dwordx4 v13, s[12:15], s46 offen lds
    s_add_u32 m0, s44, 43008
    s_add_u32 s46, s40, 32768
    buffer_load_dwordx4 v12, s[12:15], s46 offen lds
    s_add_u32 m0, s44, 44032
    s_add_u32 s46, s40, 49152
    buffer_load_dwordx4 v13, s[12:15], s46 offen lds
    s_mov_b32 s20, s8
    s_mov_b32 s21, s9
    s_mov_b32 s22, 0x200000
    s_mov_b32 s23, 0x00020000
    s_lshl_b32 s50, s2, 13
    s_lshl_b32 s51, s3, 11
    s_add_u32 s50, s50, s51
    v_lshlrev_b32 v104, 7, v0
    s_mov_b64 exec, 0xffff
    buffer_load_dword v160, v104, s[20:23], s50 offen
    s_mov_b64 exec, -1

    s_waitcnt vmcnt(21)
    s_barrier
    s_bfe_u32 s40, s49, 0x40008
    s_bitcmp1_b32 s40, 3
    s_cselect_b32 s41, s39, s42
    s_xor_b32 s40, s40, s41
    s_mul_i32 s41, s40, 393216
    s_add_u32 s41, s41, s38
    s_lshl_b32 s40, s40, 7
    s_add_u32 s40, s40, s36
    s_add_u32 m0, s44, 81920
    s_add_u32 s46, s40, 0
    buffer_load_dwordx4 v12, s[12:15], s46 offen lds
    s_add_u32 m0, s45, 106496
    s_add_u32 s46, s41, 2048
    buffer_load_dwordx4 v14, s[16:19], s46 offen lds
    s_add_u32 m0, s45, 107520
    s_add_u32 s46, s41, 51200
    buffer_load_dwordx4 v15, s[16:19], s46 offen lds
    s_add_u32 m0, s45, 98304
    s_add_u32 s46, s41, 0
    s_add_u32 s46, s46, s47
    buffer_load_dwordx4 v14, s[16:19], s46 offen lds
    s_add_u32 m0, s45, 99328
    s_add_u32 s46, s41, 49152
    s_add_u32 s46, s46, s47
    s_nop 0
    buffer_load_dwordx4 v15, s[16:19], s46 offen lds
    s_add_u32 m0, s45, 114688
    s_add_u32 s46, s41, 4096
    buffer_load_dwordx4 v14, s[16:19], s46 offen lds
    s_add_u32 m0, s45, 115712
    s_add_u32 s46, s41, 53248
    buffer_load_dwordx4 v15, s[16:19], s46 offen lds
    s_add_u32 m0, s44, 82944
    s_add_u32 s46, s40, 16384
    buffer_load_dwordx4 v13, s[12:15], s46 offen lds
    s_add_u32 m0, s44, 83968
    s_add_u32 s46, s40, 32768
    buffer_load_dwordx4 v12, s[12:15], s46 offen lds
    s_add_u32 m0, s44, 84992
    s_add_u32 s46, s40, 49152
    buffer_load_dwordx4 v13, s[12:15], s46 offen lds
    s_waitcnt vmcnt(21)
    s_barrier
    s_bfe_u32 s40, s49, 0x4000c
    s_bitcmp1_b32 s40, 3
    s_cselect_b32 s41, s39, s42
    s_xor_b32 s40, s40, s41
    s_mul_i32 s41, s40, 393216
    s_add_u32 s41, s41, s38
    s_lshl_b32 s40, s40, 7
    s_add_u32 s40, s40, s36
    s_add_u32 m0, s44, 122880
    s_add_u32 s46, s40, 0
    s_nop 0
    buffer_load_dwordx4 v12, s[12:15], s46 offen lds
    s_add_u32 m0, s45, 147456
    s_add_u32 s46, s41, 2048
    buffer_load_dwordx4 v14, s[16:19], s46 offen lds
W_5:
    s_cbranch_execz R_5
    s_nop 0
    s_add_u32 m0, s45, 148480
    s_add_u32 s46, s41, 51200
    buffer_load_dwordx4 v15, s[16:19], s46 offen lds
    s_add_u32 m0, s45, 139264
    s_add_u32 s46, s41, 0
    s_add_u32 s46, s46, s47
    buffer_load_dwordx4 v14, s[16:19], s46 offen lds
    s_add_u32 m0, s45, 140288
    s_add_u32 s46, s41, 49152
    s_add_u32 s46, s46, s47
    s_nop 0
    buffer_load_dwordx4 v15, s[16:19], s46 offen lds
    s_add_u32 m0, s45, 155648
    s_add_u32 s46, s41, 4096
    buffer_load_dwordx4 v14, s[16:19], s46 offen lds
    s_add_u32 m0, s45, 156672
    s_add_u32 s46, s41, 53248
    buffer_load_dwordx4 v15, s[16:19], s46 offen lds
    s_add_u32 m0, s44, 123904
    s_add_u32 s46, s40, 16384
    buffer_load_dwordx4 v13, s[12:15], s46 offen lds
    s_add_u32 m0, s44, 124928
    s_add_u32 s46, s40, 32768
    buffer_load_dwordx4 v12, s[12:15], s46 offen lds
    s_add_u32 m0, s44, 125952
    s_add_u32 s46, s40, 49152
    buffer_load_dwordx4 v13, s[12:15], s46 offen lds
    s_waitcnt vmcnt(21)
    s_barrier
    s_bfe_u32 s40, s49, 0x40010
    s_bitcmp1_b32 s40, 3
    s_cselect_b32 s41, s39, s42
    s_xor_b32 s40, s40, s41
    s_mul_i32 s41, s40, 393216
    s_add_u32 s41, s41, s38
    s_lshl_b32 s40, s40, 7
    s_add_u32 s40, s40, s36
    s_add_u32 m0, s44, 0
    s_add_u32 s46, s40, 0
    buffer_load_dwordx4 v12, s[12:15], s46 offen lds
    s_add_u32 m0, s45, 24576
    s_add_u32 s46, s41, 2048
    buffer_load_dwordx4 v14, s[16:19], s46 offen lds
    s_add_u32 m0, s45, 25600
    s_add_u32 s46, s41, 51200
    buffer_load_dwordx4 v15, s[16:19], s46 offen lds
    s_add_u32 m0, s45, 16384
    s_add_u32 s46, s41, 0
    s_add_u32 s46, s46, s47
    buffer_load_dwordx4 v14, s[16:19], s46 offen lds
    s_add_u32 m0, s45, 17408
    s_add_u32 s46, s41, 49152
    s_add_u32 s46, s46, s47
    s_nop 0
    buffer_load_dwordx4 v15, s[16:19], s46 offen lds
    s_add_u32 m0, s45, 32768
    s_add_u32 s46, s41, 4096
    buffer_load_dwordx4 v14, s[16:19], s46 offen lds
    s_add_u32 m0, s45, 33792
    s_add_u32 s46, s41, 53248
    buffer_load_dwordx4 v15, s[16:19], s46 offen lds
    s_add_u32 m0, s44, 1024
    s_add_u32 s46, s40, 16384
    buffer_load_dwordx4 v13, s[12:15], s46 offen lds
    s_add_u32 m0, s44, 2048
    s_add_u32 s46, s40, 32768
    buffer_load_dwordx4 v12, s[12:15], s46 offen lds
    s_add_u32 m0, s44, 3072
    s_add_u32 s46, s40, 49152
    buffer_load_dwordx4 v13, s[12:15], s46 offen lds
    s_waitcnt vmcnt(20)
    s_barrier
    s_bfe_u32 s40, s49, 0x40014
    s_bitcmp1_b32 s40, 3
    s_cselect_b32 s41, s39, s42
    s_xor_b32 s40, s40, s41
    s_mul_i32 s41, s40, 393216
    s_add_u32 s41, s41, s38
    s_lshl_b32 s40, s40, 7
    s_add_u32 s40, s40, s36
    s_add_u32 m0, s44, 40960
    s_add_u32 s46, s40, 0
    s_nop 0
    buffer_load_dwordx4 v12, s[12:15], s46 offen lds
    s_add_u32 m0, s45, 65536
    s_add_u32 s46, s41, 2048
    buffer_load_dwordx4 v14, s[16:19], s46 offen lds
    s_add_u32 m0, s45, 66560
    s_add_u32 s46, s41, 51200
    buffer_load_dwordx4 v15, s[16:19], s46 offen lds
    s_add_u32 m0, s45, 57344
    s_add_u32 s46, s41, 0
    s_add_u32 s46, s46, s47
    buffer_load_dwordx4 v14, s[16:19], s46 offen lds
    s_add_u32 m0, s45, 58368
    s_add_u32 s46, s41, 49152
    s_add_u32 s46, s46, s47
    s_nop 0
    buffer_load_dwordx4 v15, s[16:19], s46 offen lds
    s_add_u32 m0, s45, 73728
    s_add_u32 s46, s41, 4096
    buffer_load_dwordx4 v14, s[16:19], s46 offen lds
    s_add_u32 m0, s45, 74752
    s_add_u32 s46, s41, 53248
    buffer_load_dwordx4 v15, s[16:19], s46 offen lds
    s_add_u32 m0, s44, 41984
    s_add_u32 s46, s40, 16384
    buffer_load_dwordx4 v13, s[12:15], s46 offen lds
    s_add_u32 m0, s44, 43008
    s_add_u32 s46, s40, 32768
    buffer_load_dwordx4 v12, s[12:15], s46 offen lds
    s_add_u32 m0, s44, 44032
    s_add_u32 s46, s40, 49152
    buffer_load_dwordx4 v13, s[12:15], s46 offen lds
    v_lshlrev_b32_e64 v10, 4, v0
    s_add_u32 s68, s72, 0x900000
    s_addc_u32 s69, s73, 0
    s_mov_b32 s70, 0x18000
    s_mov_b32 s71, 0x00020000
    s_lshl_b32 s52, s32, 11
    s_add_u32 s52, s52, 65536
    s_lshl_b32 s76, s3, 2
    s_add_u32 s52, s52, s76
    s_lshl_b32 s76, s3, 9
    s_add_u32 s58, s76, 24832

    s_waitcnt vmcnt(20)
    s_barrier
    s_bfe_u32 s40, s49, 0x40018
    s_bitcmp1_b32 s40, 3
    s_cselect_b32 s41, s39, s42
    s_xor_b32 s40, s40, s41
    s_mul_i32 s41, s40, 393216
    s_add_u32 s41, s41, s38
    s_lshl_b32 s40, s40, 7
    s_add_u32 s40, s40, s36
    s_add_u32 m0, s44, 81920
    s_add_u32 s46, s40, 0
    buffer_load_dwordx4 v12, s[12:15], s46 offen lds
    s_add_u32 m0, s45, 106496
    s_add_u32 s46, s41, 2048
    buffer_load_dwordx4 v14, s[16:19], s46 offen lds
    s_add_u32 m0, s45, 107520
    s_add_u32 s46, s41, 51200
    buffer_load_dwordx4 v15, s[16:19], s46 offen lds
    s_add_u32 m0, s45, 98304
    s_add_u32 s46, s41, 0
    s_add_u32 s46, s46, s47
    buffer_load_dwordx4 v14, s[16:19], s46 offen lds
    s_add_u32 m0, s45, 99328
    s_add_u32 s46, s41, 49152
    s_add_u32 s46, s46, s47
    s_nop 0
    buffer_load_dwordx4 v15, s[16:19], s46 offen lds
    s_add_u32 m0, s45, 114688
    s_add_u32 s46, s41, 4096
    buffer_load_dwordx4 v14, s[16:19], s46 offen lds
    s_add_u32 m0, s45, 115712
    s_add_u32 s46, s41, 53248
    buffer_load_dwordx4 v15, s[16:19], s46 offen lds
    s_add_u32 m0, s44, 82944
    s_add_u32 s46, s40, 16384
    buffer_load_dwordx4 v13, s[12:15], s46 offen lds
    s_add_u32 m0, s44, 83968
    s_add_u32 s46, s40, 32768
    buffer_load_dwordx4 v12, s[12:15], s46 offen lds
    s_add_u32 m0, s44, 84992
    s_add_u32 s46, s40, 49152
    buffer_load_dwordx4 v13, s[12:15], s46 offen lds
    s_add_u32 s84, s72, 0xb00000
    s_addc_u32 s85, s73, 0
    s_mov_b32 s86, 0x30000
    s_mov_b32 s87, 0x00020000
    v_bfe_u32 v113, v0, 2, 2
    v_min_u32 v113, 2, v113
    v_lshlrev_b32 v114, 8, v113
    v_lshlrev_b32 v113, 12, v113
    v_and_b32 v112, 3, v0
    v_lshl_add_u32 v113, v112, 4, v113
    v_lshl_add_u32 v114, v112, 4, v114
    v_lshrrev_b32 v112, 4, v0
    v_mul_u32_u24 v112, 12288, v112
    v_add_u32 v113, v113, v112
    s_lshl_b32 s76, s3, 6
    s_lshl_b32 s53, s33, 8
    s_add_u32 s53, s53, s76
    s_add_u32 s76, s76, 26368
    v_add_u32 v114, s76, v114

    s_waitcnt vmcnt(20)
    s_barrier
    s_bfe_u32 s40, s49, 0x4001c
    s_bitcmp1_b32 s40, 3
    s_cselect_b32 s41, s39, s42
    s_xor_b32 s40, s40, s41
    s_mul_i32 s41, s40, 393216
    s_add_u32 s41, s41, s38
    s_lshl_b32 s40, s40, 7
    s_add_u32 s40, s40, s36
    s_add_u32 m0, s44, 122880
    s_add_u32 s46, s40, 0
    buffer_load_dwordx4 v12, s[12:15], s46 offen lds
    s_add_u32 m0, s45, 147456
    s_add_u32 s46, s41, 2048
    buffer_load_dwordx4 v14, s[16:19], s46 offen lds
    s_add_u32 m0, s45, 148480
    s_add_u32 s46, s41, 51200
    buffer_load_dwordx4 v15, s[16:19], s46 offen lds
    s_add_u32 m0, s45, 139264
    s_add_u32 s46, s41, 0
    s_add_u32 s46, s46, s47
    buffer_load_dwordx4 v14, s[16:19], s46 offen lds
    s_add_u32 m0, s45, 140288
    s_add_u32 s46, s41, 49152
    s_add_u32 s46, s46, s47
    s_nop 0
    buffer_load_dwordx4 v15, s[16:19], s46 offen lds
    s_add_u32 m0, s45, 155648
    s_add_u32 s46, s41, 4096
    buffer_load_dwordx4 v14, s[16:19], s46 offen lds
    s_add_u32 m0, s45, 156672
    s_add_u32 s46, s41, 53248
    buffer_load_dwordx4 v15, s[16:19], s46 offen lds
    s_add_u32 m0, s44, 123904
    s_add_u32 s46, s40, 16384
    buffer_load_dwordx4 v13, s[12:15], s46 offen lds
    s_add_u32 m0, s44, 124928
    s_add_u32 s46, s40, 32768
    buffer_load_dwordx4 v12, s[12:15], s46 offen lds
    s_add_u32 m0, s44, 125952
    s_add_u32 s46, s40, 49152
    buffer_load_dwordx4 v13, s[12:15], s46 offen lds
    s_add_u32 s76, s53, 0
    s_nop 0
    buffer_load_dwordx4 v[72:75], v113, s[84:87], s76 offen sc0 sc1
    s_add_u32 s76, s53, 49152
    buffer_load_dwordx4 v[76:79], v113, s[84:87], s76 offen sc0 sc1
    s_add_u32 s76, s53, 98304
    buffer_load_dwordx4 v[80:83], v113, s[84:87], s76 offen sc0 sc1
    s_add_u32 s76, s53, 147456
    buffer_load_dwordx4 v[84:87], v113, s[84:87], s76 offen sc0 sc1
    s_mov_b32 m0, s58
    s_setprio 3
    s_waitcnt vmcnt(24)
    s_barrier
    s_cmp_eq_u32 s3, 3
    s_cbranch_scc1 F_d0
    buffer_load_dword v10, s[68:71], s52 offen sc0 sc1 lds
    s_add_u32 m0, m0, 256
    s_add_u32 s52, s52, 1024
    buffer_load_dword v10, s[68:71], s52 offen sc0 sc1 lds
    s_branch F_d1
F_d0:
    s_nop 0
    s_mov_b32 m0, 24576
    s_mov_b32 s52, 0x7ff00000
    s_mov_b64 exec, 0xfff
    buffer_load_dwordx4 v10, s[84:87], s52 offen lds
    buffer_load_dwordx4 v10, s[84:87], s52 offen lds
    s_mov_b64 exec, -1
F_d1:

    s_setprio 0
    s_waitcnt vmcnt(16)
    s_barrier
    s_waitcnt vmcnt(2)
F_cs0:
    v_min3_u32 v96, v72, v76, v80
    v_min_u32 v96, v96, v84
    v_cmp_eq_u32 vcc, 0, v96
    s_cbranch_vccz F_cs1
    s_sleep 8

    s_add_u32 s76, s53, 0
    buffer_load_dwordx4 v[72:75], v113, s[84:87], s76 offen sc0 sc1
    s_add_u32 s76, s53, 49152
    buffer_load_dwordx4 v[76:79], v113, s[84:87], s76 offen sc0 sc1
    s_add_u32 s76, s53, 98304
    buffer_load_dwordx4 v[80:83], v113, s[84:87], s76 offen sc0 sc1
    s_add_u32 s76, s53, 147456
    buffer_load_dwordx4 v[84:87], v113, s[84:87], s76 offen sc0 sc1
    s_waitcnt vmcnt(0)
    s_branch F_cs0
F_cs1:
    v_add_f32 v72, v72, v76
    v_add_f32 v80, v80, v84
    v_add_f32 v73, v73, v77
    v_add_f32 v81, v81, v85
    v_add_f32 v74, v74, v78
    v_add_f32 v82, v82, v86
    v_add_f32 v75, v75, v79
    v_add_f32 v83, v83, v87
    v_add_f32 v72, v72, v80
    v_add_f32 v73, v73, v81
    v_add_f32 v74, v74, v82
    v_add_f32 v75, v75, v83
    v_mov_b32 v76, v72
    v_mov_b32 v77, v73
    v_mov_b32 v78, v74
    v_mov_b32 v79, v75
    v_permlane32_swap_b32 v72, v76
    v_permlane32_swap_b32 v73, v77
    v_permlane32_swap_b32 v74, v78
    v_permlane32_swap_b32 v75, v79
    v_add_f32 v72, v72, v76
    v_add_f32 v73, v73, v77
    v_add_f32 v74, v74, v78
    v_add_f32 v75, v75, v79
    v_mov_b32 v76, v72
    v_mov_b32 v77, v73
    v_mov_b32 v78, v74
    v_mov_b32 v79, v75
    v_permlane16_swap_b32 v72, v76
    v_permlane16_swap_b32 v73, v77
    v_permlane16_swap_b32 v74, v78
    v_permlane16_swap_b32 v75, v79
    v_add_f32 v72, v72, v76
    v_add_f32 v73, v73, v77
    v_add_f32 v74, v74, v78
    v_add_f32 v75, v75, v79
    s_mov_b64 exec, 0xfff
    ds_write_b128 v114, v[72:75]
    s_mov_b64 exec, -1
    s_waitcnt lgkmcnt(0)

    s_waitcnt vmcnt(0)
    s_barrier
    s_add_u32 s24, s72, 0x800000
    s_addc_u32 s25, s73, 0
    s_mov_b32 s26, 0x100000
    s_mov_b32 s27, 0x00020000
    s_add_u32 s12, s72, 0x400000
    s_addc_u32 s13, s73, 0
    s_mov_b32 s14, 0x400000
    s_mov_b32 s15, 0x00020000
    s_mov_b32 s16, s8
    s_mov_b32 s17, s9
    s_mov_b32 s18, 0x200000
    s_mov_b32 s19, 0x00020000
    v_lshrrev_b32 v4, 4, v0
    v_and_b32 v3, 15, v0
    v_lshlrev_b32 v6, 1, v4
    v_xor_b32 v8, v3, v6
    v_xor_b32 v9, 8, v8
    v_lshlrev_b32 v8, 4, v8
    v_lshlrev_b32_e64 v9, 4, v9
    v_lshl_add_u32 v8, v4, 11, v8
    v_lshl_add_u32 v9, v4, 11, v9
    s_lshl_b32 s38, s29, 8
    s_lshl_b32 s45, s3, 15
    s_add_u32 s38, s38, s45
    s_lshl_b32 s45, s3, 12

    s_mov_b32 s48, 0x76543210
    s_mov_b32 s49, 0xfedcba98
    s_bitcmp1_b32 0x92, s35
    s_cselect_b32 s48, 0xba983210, s48
    s_cselect_b32 s49, 0x7654fedc, s49
    s_bitcmp1_b32 0x24, s35
    s_cselect_b32 s48, 0xfedc3210, s48
    s_cselect_b32 s49, 0xba987654, s49
    s_lshr_b32 s36, s3, 1
    s_and_b32 s37, s3, 1
    s_lshl_b32 s43, s36, 6
    s_lshl_b32 s42, s33, 1
    s_add_u32 s42, s42, s37
    s_mul_i32 s82, s42, 4224
    s_add_u32 s83, s82, 4096
    s_add_u32 s83, s83, s43
    s_lshl_b32 s44, s36, 11
    s_add_u32 s82, s82, s44
    s_mul_i32 s51, s42, 16*64
    s_add_u32 s51, s51, 192512
    s_lshl_b32 s42, s10, 1
    s_add_u32 s42, s42, s37
    s_lshl_b32 s50, s42, 4
    s_add_u32 s50, s50, s32
    s_lshl_b32 s50, s50, 6
    v_lshlrev_b32 v10, 4, v0
    v_lshlrev_b32 v11, 2, v0
    s_lshl_b32 s42, s3, 2
    s_add_u32 s42, s42, 24640
    v_mov_b32 v1, s42
    v_and_b32 v2, 3, v0
    v_lshlrev_b32 v2, 2, v2
    v_add_u32 v2, 24640, v2
    v_and_b32 v105, 1, v0
    v_lshlrev_b32 v105, 3, v105
    s_lshl_b32 s42, s37, 2
    s_add_u32 s42, s42, 24640
    v_add_u32 v105, s42, v105
    s_lshl_b32 s42, s37, 12
    s_add_u32 s42, s42, s44
    s_add_u32 s42, s42, 65536
    v_add_u32 v106, s42, v11
    s_lshl_b32 s42, s37, 7
    s_add_u32 s42, s42, s43
    s_add_u32 s42, s42, 27136
    v_add_u32 v107, s42, v11
    v_mul_u32_u24 v108, 64*16/4, v0
    v_mov_b32 v109, 1
    s_mov_b32 s60, 0
    s_mov_b32 s62, 0xa001024
    s_mov_b32 s63, 0x1a1e14
    s_lshl_b32 s36, s28, 2
    s_add_u32 s36, s36, s3
    s_lshl_b32 s36, s36, 15
    s_lshl_b32 s44, s3, 11
    s_lshl_b32 s50, s28, 3
    s_and_b32 s76, s29, 4-1
    s_mul_i32 s76, s76, 8/4
    s_add_u32 s50, s50, s76
    s_mul_i32 s50, s50, 64
    s_add_u32 s78, s50, 0x837000
    s_add_u32 s78, s72, s78
    s_addc_u32 s79, s73, 0
    s_setprio 3
    s_sleep 10
    s_lshr_b32 s56, s3, 1
    s_add_u32 s56, s56, 1
    ds_read_b32 v114, v105
FW_9:
    s_waitcnt lgkmcnt(0)
    v_cmp_gt_u32 vcc, s56, v114
    s_cbranch_vccz FO_10
    s_sleep 1
    ds_read_b32 v114, v105
    s_branch FW_9
FO_10:
    ds_read2st64_b32 v[12:13], v106 offset0:0 offset1:1
    ds_read2st64_b32 v[20:21], v106 offset0:32 offset1:33
    ds_read2st64_b32 v[14:15], v106 offset0:2 offset1:3
    ds_read2st64_b32 v[22:23], v106 offset0:34 offset1:35
    ds_read2st64_b32 v[16:17], v106 offset0:4 offset1:5
    ds_read2st64_b32 v[24:25], v106 offset0:36 offset1:37
    ds_read2st64_b32 v[18:19], v106 offset0:6 offset1:7
    ds_read2st64_b32 v[26:27], v106 offset0:38 offset1:39
    ds_read2st64_b32 v[28:29], v107 offset0:0 offset1:1
    s_waitcnt lgkmcnt(7)
    v_add_f32 v12, v12, v20
    buffer_atomic_add_f32 v12, v11, s[24:27], s82 offen offset:0
    v_add_f32 v13, v13, v21
    buffer_atomic_add_f32 v13, v11, s[24:27], s82 offen offset:256
    s_waitcnt lgkmcnt(5)
    v_add_f32 v14, v14, v22
    buffer_atomic_add_f32 v14, v11, s[24:27], s82 offen offset:512
    v_add_f32 v15, v15, v23
    buffer_atomic_add_f32 v15, v11, s[24:27], s82 offen offset:768
    s_waitcnt lgkmcnt(3)
    v_add_f32 v16, v16, v24
    buffer_atomic_add_f32 v16, v11, s[24:27], s82 offen offset:1024
    v_add_f32 v17, v17, v25
    buffer_atomic_add_f32 v17, v11, s[24:27], s82 offen offset:1280
    s_waitcnt lgkmcnt(1)
    v_add_f32 v18, v18, v26
    buffer_atomic_add_f32 v18, v11, s[24:27], s82 offen offset:1536
    v_add_f32 v19, v19, v27
    buffer_atomic_add_f32 v19, v11, s[24:27], s82 offen offset:1792
    s_waitcnt lgkmcnt(0)
    v_add_f32 v28, v28, v29
    s_mov_b64 exec, 0xffff
    buffer_atomic_add_f32 v28, v11, s[24:27], s83 offen
    s_mov_b64 exec, -1
    v_mov_b32 v113, 1
    s_mov_b64 exec, 1
    ds_write_b32 v1, v113 offset:32
    s_mov_b64 exec, -1
    s_add_u32 s54, s51, 0x800000
    s_add_u32 s54, s72, s54
    s_addc_u32 s55, s73, 0
    s_mov_b32 s57, 1
    s_waitcnt vmcnt(4)
    ds_read2_b32 v[102:103], v2 offset0:0 offset1:8
    ds_read_b32 v104, v2 offset:16
    s_waitcnt lgkmcnt(0)
    v_cmp_ne_u32 vcc, 3, v102
    v_cmp_eq_u32 s[42:43], 0, v103
    s_nop 0
    s_or_b64 vcc, vcc, s[42:43]
    v_cmp_gt_u32 s[42:43], 2, v104
    s_nop 0
    s_or_b64 vcc, vcc, s[42:43]
    s_waitcnt vmcnt(0)
    s_atomic_add s57, s[54:55], 0
    s_atomic_add s57, s[54:55], 256
    s_atomic_add s57, s[54:55], 512
    s_atomic_add s57, s[54:55], 768
    s_cbranch_vccnz F_pe
    s_bfe_u32 s41, s48, 0x40000
    s_xor_b32 s41, s41, s10
    s_lshl_b32 s41, s41, 17
    s_add_u32 s41, s41, s38
    s_add_u32 m0, s45, 147456
    s_add_u32 s76, s41, 0
    buffer_load_dwordx4 v8, s[16:19], s76 offen lds
    s_add_u32 m0, s45, 148480
    s_add_u32 s76, s41, 8192
    buffer_load_dwordx4 v9, s[16:19], s76 offen lds
    s_add_u32 m0, s45, 149504
    s_add_u32 s76, s41, 16384
    buffer_load_dwordx4 v8, s[16:19], s76 offen lds
    s_add_u32 m0, s45, 150528
    s_add_u32 s76, s41, 24576
    buffer_load_dwordx4 v9, s[16:19], s76 offen lds
    s_bfe_u32 s41, s48, 0x40004
    s_xor_b32 s41, s41, s10
    s_lshl_b32 s41, s41, 17
    s_add_u32 s41, s41, s38
    s_add_u32 m0, s45, 65536
    s_add_u32 s76, s41, 0
    buffer_load_dwordx4 v8, s[16:19], s76 offen lds
    s_add_u32 m0, s45, 66560
    s_add_u32 s76, s41, 8192
    buffer_load_dwordx4 v9, s[16:19], s76 offen lds
    s_add_u32 m0, s45, 67584
    s_add_u32 s76, s41, 16384
    buffer_load_dwordx4 v8, s[16:19], s76 offen lds
    s_add_u32 m0, s45, 68608
    s_add_u32 s76, s41, 24576
    buffer_load_dwordx4 v9, s[16:19], s76 offen lds
    s_mov_b32 s60, 2
F_pe:
    s_setprio 1
F_pr0:
    s_waitcnt vmcnt(8)
    ds_read2_b32 v[102:103], v2 offset0:0 offset1:8
    s_cmp_lt_u32 s60, 2
    s_cselect_b32 s61, 1, 3
    s_waitcnt lgkmcnt(0)
    v_cmp_le_u32 vcc, 4, v102
    s_cbranch_vccz F_pr3
    s_mov_b32 s61, 5
F_pr3:
    v_cmp_gt_u32 vcc, s61, v102
    v_cmp_gt_u32 s[42:43], 1, v103
    s_nop 0
    s_or_b64 vcc, vcc, s[42:43]
    s_cbranch_vccz F_pr2
    s_sleep 2
    s_branch F_pr0
F_pr2:
    s_cmp_lt_u32 s60, 6
    s_cbranch_scc1 F_pr4
    ds_read_b32 v102, v2 offset:16
    s_waitcnt lgkmcnt(0)
    v_cmp_gt_u32 vcc, 2, v102
    s_cbranch_vccz F_pr4
    s_sleep 2
    s_branch F_pr0
F_pr4:
    s_cmp_lg_u32 s60, 4
    s_cbranch_scc1 F_pr6
    s_waitcnt vmcnt(4)
    v_mov_b32_e64 v113, 2
    s_mov_b64 exec, 1
    ds_write_b32 v1, v113 offset:32
    s_mov_b64 exec, -1
F_pr6:
    s_lshl_b32 s41, s60, 2
    s_lshr_b32 s41, s48, s41
    s_and_b32 s41, s41, 15
    s_xor_b32 s41, s41, s10
    s_lshl_b32 s41, s41, 17
    s_add_u32 s41, s41, s38
    s_lshl_b32 s76, s60, 3
    s_lshr_b64 s[42:43], s[62:63], s76
    s_and_b32 s42, s42, 0xff
    s_lshl_b32 s42, s42, 12
    s_add_u32 m0, s42, s45
    s_add_u32 s60, s60, 1
    buffer_load_dwordx4 v8, s[16:19], s41 offen lds
    s_add_u32 m0, m0, 1024
    s_add_u32 s41, s41, 8192
    buffer_load_dwordx4 v9, s[16:19], s41 offen lds
    s_add_u32 m0, m0, 1024
    s_add_u32 s41, s41, 8192
    buffer_load_dwordx4 v8, s[16:19], s41 offen lds
    s_add_u32 m0, m0, 1024
    s_add_u32 s41, s41, 8192
    buffer_load_dwordx4 v9, s[16:19], s41 offen lds
    s_cmp_ge_u32 s60, 7
    s_cbranch_scc1 F_pr1
    s_cmp_eq_u32 s61, 5
    s_cbranch_scc1 F_pr2
    s_branch F_pr0
F_pr1:
    s_cmp_lg_u32 s3, 0
    s_cbranch_scc1 F_l4
SP_11:
    s_load_dword s58, s[78:79], 0 glc
    s_waitcnt lgkmcnt(0)
    s_cmp_ge_u32 s58, 32
    s_cbranch_scc1 SD_12
    s_sleep 1
    s_branch SP_11
SD_12:
F_l6:
    v_mov_b32 v113, 3
    s_mov_b64 exec, 1
    ds_write_b32 v1, v113 offset:112
    s_mov_b64 exec, -1
    s_branch F_l5
F_l4:
    v_mov_b32 v4, 24752
    ds_read_b32 v13, v4
FW_13:
    s_waitcnt lgkmcnt(0)
    v_cmp_gt_u32 vcc, 3, v13
    s_cbranch_vccz FO_14
    s_sleep 1
    ds_read_b32 v13, v4
    s_branch FW_13
FO_14:
F_l5:
    s_bfe_u32 s40, s48, 0x40004
    s_xor_b32 s40, s40, s10
    s_lshl_b32 s40, s40, 11
    s_add_u32 s40, s40, s36
    s_add_u32 m0, s44, 16384
    s_nop 0
    buffer_load_dwordx4 v10, s[12:15], s40 offen offset:0 sc1 lds
    s_add_u32 m0, s44, 16384
    s_nop 0
    buffer_load_dwordx4 v10, s[12:15], s40 offen offset:1024 sc1 lds
    s_bfe_u32 s40, s48, 0x40008
    s_xor_b32 s40, s40, s10
    s_lshl_b32 s40, s40, 11
    s_add_u32 s40, s40, s36
    s_add_u32 m0, s44, 98304
    s_nop 0
    buffer_load_dwordx4 v10, s[12:15], s40 offen offset:0 sc1 lds
    s_add_u32 m0, s44, 98304
    s_nop 0
    buffer_load_dwordx4 v10, s[12:15], s40 offen offset:1024 sc1 lds
    ds_read_b32 v102, v2
FW_15:
    s_waitcnt lgkmcnt(0)
    v_cmp_gt_u32_e64 vcc, 7, v102
    s_cbranch_vccz FO_16
    s_sleep 1
    ds_read_b32 v102, v2
    s_branch FW_15
FO_16:
    s_bfe_u32 s40, s48, 0x4000c
    s_xor_b32 s40, s40, s10
    s_lshl_b32 s40, s40, 11
    s_add_u32 s40, s40, s36
    s_add_u32 m0, s44, 139264
    s_nop 0
    buffer_load_dwordx4 v10, s[12:15], s40 offen offset:0 sc1 lds
    s_add_u32 m0, s44, 139264
    s_nop 0
    buffer_load_dwordx4 v10, s[12:15], s40 offen offset:1024 sc1 lds
    s_bfe_u32 s41, s48, 0x4001c
    s_xor_b32 s41, s41, s10
    s_lshl_b32 s41, s41, 17
    s_add_u32 s41, s41, s38
    s_add_u32 m0, s45, 147456
    s_add_u32 s76, s41, 0
    buffer_load_dwordx4 v8, s[16:19], s76 offen lds
    s_add_u32 m0, s45, 148480
    s_add_u32 s76, s41, 8192
    buffer_load_dwordx4 v9, s[16:19], s76 offen lds
    s_add_u32 m0, s45, 149504
    s_add_u32 s76, s41, 16384
    buffer_load_dwordx4 v8, s[16:19], s76 offen lds
    s_add_u32 m0, s45, 150528
    s_add_u32 s76, s41, 24576
    buffer_load_dwordx4 v9, s[16:19], s76 offen lds
    s_waitcnt vmcnt(8)
    s_barrier
    s_bfe_u32 s40, s48, 0x40010
    s_xor_b32 s40, s40, s10
    s_lshl_b32 s40, s40, 11
    s_add_u32 s40, s40, s36
    s_add_u32 m0, s44, 57344
    s_nop 0
    buffer_load_dwordx4 v10, s[12:15], s40 offen offset:0 sc1 lds
    s_add_u32 m0, s44, 57344
    s_nop 0
    buffer_load_dwordx4 v10, s[12:15], s40 offen offset:1024 sc1 lds
    s_bfe_u32 s41, s49, 0x40000
    s_xor_b32 s41, s41, s10
    s_lshl_b32 s41, s41, 17
    s_add_u32 s41, s41, s38
    s_add_u32 m0, s45, 65536
    s_add_u32 s76, s41, 0
    buffer_load_dwordx4 v8, s[16:19], s76 offen lds
    s_add_u32 m0, s45, 66560
    s_add_u32 s76, s41, 8192
    buffer_load_dwordx4 v9, s[16:19], s76 offen lds
    s_setprio 0
    s_waitcnt vmcnt(10)
    s_barrier
    s_bfe_u32 s40, s48, 0x40014
    s_xor_b32 s40, s40, s10
    s_lshl_b32 s40, s40, 11
    s_add_u32 s40, s40, s36
    s_add_u32 m0, s44, 16384
    s_nop 0
    buffer_load_dwordx4 v10, s[12:15], s40 offen offset:0 sc1 lds
    s_add_u32 m0, s44, 16384
    s_nop 0
    s_nop 0
    buffer_load_dwordx4 v10, s[12:15], s40 offen offset:1024 sc1 lds
    s_add_u32 m0, s45, 67584
    s_add_u32 s76, s41, 16384
    buffer_load_dwordx4 v8, s[16:19], s76 offen lds
    s_add_u32 m0, s45, 68608
    s_add_u32 s76, s41, 24576
W_6:
    s_cbranch_execz R_6
    s_nop 0
    buffer_load_dwordx4 v9, s[16:19], s76 offen lds
    s_bfe_u32 s41, s49, 0x40004
    s_xor_b32 s41, s41, s10
    s_lshl_b32 s41, s41, 17
    s_add_u32 s41, s41, s38
    s_add_u32 m0, s45, 0
    s_add_u32 s76, s41, 0
    buffer_load_dwordx4 v8, s[16:19], s76 offen lds
    s_waitcnt vmcnt(13)
    s_barrier
    s_bfe_u32 s40, s48, 0x40018
    s_xor_b32 s40, s40, s10
    s_lshl_b32 s40, s40, 11
    s_add_u32 s40, s40, s36
    s_add_u32 m0, s44, 98304
    s_nop 0
    buffer_load_dwordx4 v10, s[12:15], s40 offen offset:0 sc1 lds
    s_add_u32 m0, s44, 98304
    s_nop 0
    buffer_load_dwordx4 v10, s[12:15], s40 offen offset:1024 sc1 lds
    s_add_u32 m0, s45, 1024
    s_add_u32 s76, s41, 8192
    buffer_load_dwordx4 v9, s[16:19], s76 offen lds
    s_add_u32 m0, s45, 2048
    s_add_u32 s76, s41, 16384
    buffer_load_dwordx4 v8, s[16:19], s76 offen lds
    s_add_u32 m0, s45, 3072
    s_add_u32 s76, s41, 24576
    buffer_load_dwordx4 v9, s[16:19], s76 offen lds
    s_waitcnt vmcnt(12)
    s_barrier
    s_bfe_u32 s40, s48, 0x4001c
    s_xor_b32 s40, s40, s10
    s_lshl_b32 s40, s40, 11
    s_add_u32 s40, s40, s36
    s_add_u32 m0, s44, 139264
    s_nop 0
    buffer_load_dwordx4 v10, s[12:15], s40 offen offset:0 sc1 lds
    s_add_u32 m0, s44, 139264
    s_nop 0
    buffer_load_dwordx4 v10, s[12:15], s40 offen offset:1024 sc1 lds
    s_bfe_u32 s41, s49, 0x40008
    s_xor_b32 s41, s41, s10
    s_lshl_b32 s41, s41, 17
    s_add_u32 s41, s41, s38
    s_add_u32 m0, s45, 40960
    s_add_u32 s76, s41, 0
    s_nop 0
    buffer_load_dwordx4 v8, s[16:19], s76 offen lds
    s_add_u32 m0, s45, 41984
    s_add_u32 s76, s41, 8192
    buffer_load_dwordx4 v9, s[16:19], s76 offen lds
    s_add_u32 m0, s45, 43008
    s_add_u32 s76, s41, 16384
    buffer_load_dwordx4 v8, s[16:19], s76 offen lds
    s_waitcnt vmcnt(13)
    s_barrier
    s_bfe_u32 s40, s49, 0x40000
    s_xor_b32 s40, s40, s10
    s_lshl_b32 s40, s40, 11
    s_add_u32 s40, s40, s36
    s_add_u32 m0, s44, 57344
    s_nop 0
    buffer_load_dwordx4 v10, s[12:15], s40 offen offset:0 sc1 lds
    s_add_u32 m0, s44, 57344
    s_nop 0
    s_nop 0
    buffer_load_dwordx4 v10, s[12:15], s40 offen offset:1024 sc1 lds
    s_add_u32 m0, s45, 44032
    s_add_u32 s76, s41, 24576
    buffer_load_dwordx4 v9, s[16:19], s76 offen lds
    s_bfe_u32 s41, s49, 0x4000c
    s_xor_b32 s41, s41, s10
    s_lshl_b32 s41, s41, 17
    s_add_u32 s41, s41, s38
    s_add_u32 m0, s45, 81920
    s_add_u32 s76, s41, 0
    buffer_load_dwordx4 v8, s[16:19], s76 offen lds
    s_add_u32 m0, s45, 82944
    s_add_u32 s76, s41, 8192
    buffer_load_dwordx4 v9, s[16:19], s76 offen lds
    s_waitcnt vmcnt(13)
    s_barrier
    s_bfe_u32 s40, s49, 0x40004
    s_xor_b32 s40, s40, s10
    s_lshl_b32 s40, s40, 11
    s_add_u32 s40, s40, s36
    s_add_u32 m0, s44, 16384
    s_nop 0
    buffer_load_dwordx4 v10, s[12:15], s40 offen offset:0 sc1 lds
    s_add_u32 m0, s44, 16384
    s_nop 0
    s_nop 0
    buffer_load_dwordx4 v10, s[12:15], s40 offen offset:1024 sc1 lds
    s_add_u32 m0, s45, 83968
    s_add_u32 s76, s41, 16384
    buffer_load_dwordx4 v8, s[16:19], s76 offen lds
    s_add_u32 m0, s45, 84992
    s_add_u32 s76, s41, 24576
    buffer_load_dwordx4 v9, s[16:19], s76 offen lds
    s_bfe_u32 s41, s49, 0x40010
    s_xor_b32 s41, s41, s10
    s_lshl_b32 s41, s41, 17
    s_add_u32 s41, s41, s38
    s_add_u32 m0, s45, 122880
    s_add_u32 s76, s41, 0
    buffer_load_dwordx4 v8, s[16:19], s76 offen lds
    s_waitcnt vmcnt(13)
    s_barrier
    s_bfe_u32 s40, s49, 0x40008
    s_xor_b32 s40, s40, s10
    s_lshl_b32 s40, s40, 11
    s_add_u32 s40, s40, s36
    s_add_u32 m0, s44, 98304
    s_nop 0
    buffer_load_dwordx4 v10, s[12:15], s40 offen offset:0 sc1 lds
    s_add_u32 m0, s44, 98304
    s_nop 0
    s_nop 0
    buffer_load_dwordx4 v10, s[12:15], s40 offen offset:1024 sc1 lds
    s_add_u32 m0, s45, 123904
    s_add_u32 s76, s41, 8192
    buffer_load_dwordx4 v9, s[16:19], s76 offen lds
    s_add_u32 m0, s45, 124928
    s_add_u32 s76, s41, 16384
    buffer_load_dwordx4 v8, s[16:19], s76 offen lds
    s_add_u32 m0, s45, 125952
    s_add_u32 s76, s41, 24576
    buffer_load_dwordx4 v9, s[16:19], s76 offen lds
    s_waitcnt vmcnt(13)
    s_barrier
    s_bfe_u32 s40, s49, 0x4000c
    s_xor_b32 s40, s40, s10
    s_lshl_b32 s40, s40, 11
    s_add_u32 s40, s40, s36
    s_add_u32 m0, s44, 139264
    s_nop 0
    buffer_load_dwordx4 v10, s[12:15], s40 offen offset:0 sc1 lds
    s_add_u32 m0, s44, 139264
    s_nop 0
    buffer_load_dwordx4 v10, s[12:15], s40 offen offset:1024 sc1 lds
    s_bfe_u32 s41, s49, 0x40014
    s_xor_b32 s41, s41, s10
    s_lshl_b32 s41, s41, 17
    s_add_u32 s41, s41, s38
    s_add_u32 m0, s45, 106496
    s_add_u32 s76, s41, 0
    s_nop 0
    buffer_load_dwordx4 v8, s[16:19], s76 offen lds
    s_add_u32 m0, s45, 107520
    s_add_u32 s76, s41, 8192
    buffer_load_dwordx4 v9, s[16:19], s76 offen lds
    s_add_u32 m0, s45, 108544
    s_add_u32 s76, s41, 16384
    buffer_load_dwordx4 v8, s[16:19], s76 offen lds
    s_waitcnt vmcnt(13)
    s_barrier
    s_bfe_u32 s40, s49, 0x40010
    s_xor_b32 s40, s40, s10
    s_lshl_b32 s40, s40, 11
    s_add_u32 s40, s40, s36
    s_add_u32 m0, s44, 57344
    s_nop 0
    buffer_load_dwordx4 v10, s[12:15], s40 offen offset:0 sc1 lds
    s_add_u32 m0, s44, 57344
    s_nop 0
    s_nop 0
    buffer_load_dwordx4 v10, s[12:15], s40 offen offset:1024 sc1 lds
    s_add_u32 m0, s45, 109568
    s_add_u32 s76, s41, 24576
    buffer_load_dwordx4 v9, s[16:19], s76 offen lds
    s_bfe_u32 s41, s49, 0x40018
    s_xor_b32 s41, s41, s10
    s_lshl_b32 s41, s41, 17
    s_add_u32 s41, s41, s38
    s_add_u32 m0, s45, 147456
    s_add_u32 s76, s41, 0
    buffer_load_dwordx4 v8, s[16:19], s76 offen lds
    s_add_u32 m0, s45, 148480
    s_add_u32 s76, s41, 8192
    buffer_load_dwordx4 v9, s[16:19], s76 offen lds
    s_waitcnt vmcnt(13)
    s_barrier
    s_bfe_u32 s40, s49, 0x40014
    s_xor_b32 s40, s40, s10
    s_lshl_b32 s40, s40, 11
    s_add_u32 s40, s40, s36
    s_add_u32 m0, s44, 16384
    s_nop 0
    buffer_load_dwordx4 v10, s[12:15], s40 offen offset:0 sc1 lds
    s_add_u32 m0, s44, 16384
    s_nop 0
    s_nop 0
    buffer_load_dwordx4 v10, s[12:15], s40 offen offset:1024 sc1 lds
    s_add_u32 m0, s45, 149504
    s_add_u32 s76, s41, 16384
    buffer_load_dwordx4 v8, s[16:19], s76 offen lds
    s_add_u32 m0, s45, 150528
    s_add_u32 s76, s41, 24576
    buffer_load_dwordx4 v9, s[16:19], s76 offen lds
    s_bfe_u32 s41, s49, 0x4001c
    s_xor_b32 s41, s41, s10
    s_lshl_b32 s41, s41, 17
    s_add_u32 s41, s41, s38
    s_add_u32 m0, s45, 65536
    s_add_u32 s76, s41, 0
    buffer_load_dwordx4 v8, s[16:19], s76 offen lds
    s_waitcnt vmcnt(13)
    s_barrier
    s_bfe_u32 s40, s49, 0x40018
    s_xor_b32 s40, s40, s10
    s_lshl_b32 s40, s40, 11
    s_add_u32 s40, s40, s36
    s_add_u32 m0, s44, 98304
    s_nop 0
    buffer_load_dwordx4 v10, s[12:15], s40 offen offset:0 sc1 lds
    s_add_u32 m0, s44, 98304
    s_nop 0
    s_nop 0
    buffer_load_dwordx4 v10, s[12:15], s40 offen offset:1024 sc1 lds
    s_add_u32 m0, s45, 66560
    s_add_u32 s76, s41, 8192
    buffer_load_dwordx4 v9, s[16:19], s76 offen lds
    s_add_u32 m0, s45, 67584
    s_add_u32 s76, s41, 16384
    buffer_load_dwordx4 v8, s[16:19], s76 offen lds
    s_add_u32 m0, s45, 68608
    s_add_u32 s76, s41, 24576
    buffer_load_dwordx4 v9, s[16:19], s76 offen lds
    s_waitcnt vmcnt(13)
    s_barrier
    s_bfe_u32 s40, s49, 0x4001c
    s_xor_b32 s40, s40, s10
    s_lshl_b32 s40, s40, 11
    s_add_u32 s40, s40, s36
    s_add_u32 m0, s44, 139264
    s_nop 0
    buffer_load_dwordx4 v10, s[12:15], s40 offen offset:0 sc1 lds
    s_add_u32 m0, s44, 139264
    s_nop 0
    buffer_load_dwordx4 v10, s[12:15], s40 offen offset:1024 sc1 lds
    s_waitcnt vmcnt(10)
    s_barrier
    s_waitcnt vmcnt(5)
    s_barrier
    s_waitcnt vmcnt(0)
    s_barrier
    s_endpgm
F_aux:
    s_barrier
    s_setprio 0
    s_sub_u32 s3, s3, 4
    s_add_u32 s11, s33, 4
    s_lshr_b32 s11, s11, 3
    s_sub_u32 s11, s33, s11
    s_lshl_b32 s11, s11, 4
    s_add_u32 s11, s11, s32
    s_and_b32 s36, s33, 7
    s_cmp_eq_u32 s36, 3
    s_cselect_b32 s11, 255, s11
    s_and_b32 s36, s11, 3
    s_bfe_u32 s37, s11, 0x10002
    s_lshr_b32 s38, s11, 3
    v_lshlrev_b32 v3, 2, v0
    s_lshl_b32 s77, s36, 1
    s_add_u32 s77, s77, s37
    s_mul_i32 s77, s77, 114688
    s_lshl_b32 s46, s38, 12
    s_add_u32 s77, s77, s46
    s_lshl_b32 s46, s3, 10
    s_add_u32 s77, s77, s46
    s_cmp_ge_u32 s11, 224
    s_cselect_b32 s77, 0x7ff00000, s77
    v_mov_b32 v140, 0
    v_mov_b32 v141, 0
    v_mov_b32 v142, 0
    v_mov_b32 v143, 0
    s_add_u32 s12, s72, 0xa00000
    s_addc_u32 s13, s73, 0
    s_mov_b32 s14, 0xe0000
    s_mov_b32 s15, 0x00020000
    buffer_store_dwordx4 v[140:143], v2, s[12:15], s77 offen sc0 sc1
    s_add_u32 s12, s72, 0xb00000
    s_addc_u32 s13, s73, 0
    s_mov_b32 s14, 0x30000
    s_mov_b32 s15, 0x00020000
    s_lshl_b32 s47, s32, 8
    s_add_u32 s56, s47, 0x908000
    s_add_u32 s56, s72, s56
    s_addc_u32 s57, s73, 0
    s_cmp_eq_u32 s37, 0
    s_cselect_b32 s16, s62, s64
    s_cselect_b32 s17, s63, s65
    s_mov_b32 s18, 7340032
    s_mov_b32 s19, 0x00020000
    s_lshl_b32 s44, s3, 2
    s_add_u32 s44, s44, 24640
    v_mov_b32 v10, s44
    v_lshrrev_b32 v5, 4, v0
    v_mul_u32_u24 v6, 57344, v5
    v_and_b32 v7, 15, v0
    v_lshl_add_u32 v6, v7, 4, v6
    s_lshl_b32 s44, s36, 2
    s_add_u32 s44, s44, s3
    s_mul_i32 s54, s44, 458752
    s_lshl_b32 s45, s38, 8
    s_add_u32 s54, s54, s45
    s_cmp_ge_u32 s11, 224
    s_cselect_b32 s54, 0x70000000, s54
    s_lshl_b32 s55, s44, 7
    v_mov_b32 v8, 0
    s_mov_b32 s80, s66
    s_mov_b32 s81, s67
    s_mov_b32 s82, 0x700000
    s_mov_b32 s83, 0x00020000
    v_bfe_u32 v21, v0, 2, 2
    v_lshl_add_u32 v22, v5, 3, v21
    v_lshrrev_b32 v21, 1, v21
    v_and_b32 v20, 1, v5
    v_lshl_add_u32 v21, v20, 1, v21
    v_xor_b32 v21, s3, v21
    v_lshlrev_b32 v21, 5, v21
    v_lshl_add_u32 v21, v22, 7, v21
    v_and_b32 v20, 3, v0
    v_lshl_add_u32 v21, v20, 3, v21
    s_mov_b32 s44, 0x23453342
    s_lshl_b32 s89, s35, 2
    s_lshr_b32 s89, s44, s89
    s_and_b32 s89, s89, 15
    s_and_b32 s44, s89, 3
    s_mul_i32 s44, s44, 40960
    s_add_u32 s44, s44, 16384
    v_add_u32 v112, s44, v21
    v_lshlrev_b32 v113, 2, v7
    v_lshl_add_u32 v113, v5, 12, v113
    s_lshl_b32 s91, s33, 8
    s_lshl_b32 s45, s3, 6
    s_add_u32 s91, s91, s45
    s_mul_i32 s88, s32, 12288
    s_add_u32 s88, s88, s91
    s_mov_b32 exec_hi, 0xffff
    buffer_store_dword v8, v113, s[12:15], s88 offen sc0 sc1
    s_mov_b64 exec, -1
    s_getpc_b64 s[64:65]
F_cp:
    s_add_u32 s64, s64, F_co-F_cp
    s_addc_u32 s65, s65, 0
    s_branch F_cx
F_co:
    ds_read_b64_tr_b16 v[72:73], v112 offset:0
    ds_read_b64_tr_b16 v[74:75], v112 offset:512
    ds_read_b64_tr_b16 v[76:77], v112 offset:4096
    ds_read_b64_tr_b16 v[78:79], v112 offset:4608
    ds_read_b64_tr_b16 v[80:81], v112 offset:8192
    ds_read_b64_tr_b16 v[82:83], v112 offset:8704
    ds_read_b64_tr_b16 v[84:85], v112 offset:12288
    ds_read_b64_tr_b16 v[86:87], v112 offset:12800
    ds_read_b64_tr_b16 v[88:89], v112 offset:16384
    ds_read_b64_tr_b16 v[90:91], v112 offset:16896
    ds_read_b64_tr_b16 v[92:93], v112 offset:20480
    ds_read_b64_tr_b16 v[94:95], v112 offset:20992
    v_mov_b32 v108, 0x3f803f80
    v_mov_b32 v109, 0x3f803f80
    v_mov_b32 v110, 0x3f803f80
    v_mov_b32 v111, 0x3f803f80
    s_waitcnt lgkmcnt(0)
    s_swappc_b64 s[64:65], s[66:67]
    s_setprio 3
    v_mfma_f32_16x16x32_bf16 v[96:99], v[108:111], v[72:75], 0
    v_mfma_f32_16x16x32_bf16 v[100:103], v[108:111], v[80:83], 0
    v_mfma_f32_16x16x32_bf16 v[104:107], v[108:111], v[88:91], 0
    v_mfma_f32_16x16x32_bf16 v[96:99], v[108:111], v[76:79], v[96:99]
    v_mfma_f32_16x16x32_bf16 v[100:103], v[108:111], v[84:87], v[100:103]
    v_mfma_f32_16x16x32_bf16 v[104:107], v[108:111], v[92:95], v[104:107]
    s_setprio 0
    v_cmp_eq_u32 vcc, 1, v5
    s_nop 4
    v_cndmask_b32 v96, v96, v100, vcc
    v_cmp_eq_u32 vcc, 2, v5
    s_nop 1
    v_cndmask_b32 v96, v96, v104, vcc
    v_max_u32 v96, 1, v96
    s_sleep 4
    s_mov_b32 exec_hi, 0xffff
    buffer_store_dword v96, v113, s[12:15], s88 offen sc0 sc1
    s_mov_b64 exec, -1
    s_setpc_b64 s[66:67]
F_cx:
    s_cmp_eq_u32 s3, 0
    s_cbranch_scc1 F_ax0
    s_cmp_eq_u32 s3, 2
    s_cbranch_scc1 F_ax2
    s_barrier
    s_waitcnt vmcnt(0)
    s_barrier
    s_sub_u32 s45, 2, s89
    s_cmp_gt_u32 s45, 1
    s_cbranch_scc1 CB_17
    s_swappc_b64 s[66:67], s[64:65]
CB_17:
    s_barrier
    s_sub_u32 s45, 3, s89
    s_cmp_gt_u32 s45, 1
    s_cbranch_scc1 CB_18
    s_swappc_b64 s[66:67], s[64:65]
CB_18:
    s_barrier
    s_sub_u32 s45, 4, s89
    s_cmp_gt_u32 s45, 1
    s_cbranch_scc1 CB_19
    s_swappc_b64 s[66:67], s[64:65]
CB_19:
    s_barrier
    s_sub_u32 s45, 5, s89
    s_cmp_gt_u32 s45, 1
    s_cbranch_scc1 CB_20
    s_swappc_b64 s[66:67], s[64:65]
CB_20:
    s_barrier
    s_sub_u32 s45, 6, s89
    s_cmp_gt_u32 s45, 1
    s_cbranch_scc1 CB_21
    s_swappc_b64 s[66:67], s[64:65]
CB_21:
    s_cmp_eq_u32 s3, 3
    s_cbranch_scc1 IW_22
    s_mov_b64 exec, 0
    s_branch W_1
R_1:
    s_branch W_2
R_2:
    s_mov_b64 exec, -1
    s_branch IW_22e
IW_22:
    s_mov_b64 exec, 0
    s_branch W_3
R_3:
    s_branch W_4
R_4:
    s_mov_b64 exec, -1
IW_22e:
    s_barrier
    s_cmp_eq_u32 s3, 3
    s_cbranch_scc1 IW_23
    s_mov_b64 exec, 0
    s_branch W_5
R_5:
    s_branch W_6
R_6:
    s_mov_b64 exec, -1
    s_branch IW_23e
IW_23:
    s_mov_b64 exec, 0
    s_branch W_7
R_7:
    s_branch W_8
R_8:
    s_mov_b64 exec, -1
IW_23e:
    s_barrier
    s_cmp_eq_u32 s3, 3
    s_cbranch_scc1 IW_24
    s_mov_b64 exec, 0
    s_nop 0
R_9:
    s_nop 0
R_10:
    s_mov_b64 exec, -1
    s_branch IW_24e
IW_24:
    s_mov_b64 exec, 0
    s_nop 0
R_11:
    s_nop 0
R_12:
    s_mov_b64 exec, -1
IW_24e:
    s_barrier
    s_barrier
    s_barrier
    s_branch F_aj
F_ax0:
    s_lshl_b32 s44, s32, 2
    buffer_load_dword v9, v8, s[48:51], s44 offen sc0 sc1
    s_barrier
    s_waitcnt vmcnt(0)
    v_cmp_eq_u32 vcc, 0, v9
    s_cbranch_vccz F_ax0r
PL_25:
    buffer_load_dword v9, v8, s[48:51], s44 offen sc0 sc1
    s_waitcnt vmcnt(0)
    v_cmp_gt_u32 vcc, 1, v9
    s_cbranch_vccz PD_26
    s_sleep 1
    s_branch PL_25
PD_26:
F_ax0r:
    s_barrier
    s_mov_b32 s76, 1
    s_atomic_add s76, s[56:57], 0 glc
    s_sub_u32 s45, 2, s89
    s_cmp_gt_u32 s45, 1
    s_cbranch_scc1 CB_27
    s_swappc_b64 s[66:67], s[64:65]
CB_27:
    s_barrier
    s_mov_b32 s75, 0
    s_waitcnt lgkmcnt(0)
    s_cmp_lg_u32 s76, 15
    s_cbranch_scc1 F_ax0c
    s_mov_b32 s75, 1
    s_atomic_add s75, s[70:71], 64 glc
F_ax0c:
    s_sub_u32 s45, 3, s89
    s_cmp_gt_u32 s45, 1
    s_cbranch_scc1 CB_28
    s_swappc_b64 s[66:67], s[64:65]
CB_28:
    s_barrier
    s_sub_u32 s45, 4, s89
    s_cmp_gt_u32 s45, 1
    s_cbranch_scc1 CB_29
    s_swappc_b64 s[66:67], s[64:65]
CB_29:
    s_waitcnt lgkmcnt(0)
    s_cmp_lg_u32 s75, 15
    s_cbranch_scc1 F_ax0d
    v_lshlrev_b32 v9, 8, v0
    v_mov_b32 v11, 1000
    s_mov_b32 s44, 32768
    s_mov_b64 exec, 0xffff
    buffer_store_dword v11, v9, s[40:43], s44 offen sc0 sc1
    s_mov_b64 exec, -1
F_ax0d:
    s_barrier
    s_sub_u32 s45, 5, s89
    s_cmp_gt_u32 s45, 1
    s_cbranch_scc1 CB_30
    s_swappc_b64 s[66:67], s[64:65]
CB_30:
    s_barrier
    s_sub_u32 s45, 6, s89
    s_cmp_gt_u32 s45, 1
    s_cbranch_scc1 CB_31
    s_swappc_b64 s[66:67], s[64:65]
CB_31:
    s_barrier
    s_barrier
    s_barrier
    s_barrier
    s_barrier
    s_branch F_aj
F_ax2:
    s_lshl_b32 s44, s2, 10
    buffer_store_dwordx4 v[140:143], v2, s[24:27], s44 offen sc0 sc1
    s_mov_b64 exec, -1
    s_barrier
    s_waitcnt vmcnt(0)
    s_cmp_lg_u32 s2, 16
    s_cbranch_scc1 F_ax2n
    s_barrier
    s_sub_u32 s45, 2, s89
    s_cmp_gt_u32 s45, 1
    s_cbranch_scc1 CB_32
    s_swappc_b64 s[66:67], s[64:65]
CB_32:
    s_barrier
    s_sub_u32 s45, 3, s89
    s_cmp_gt_u32 s45, 1
    s_cbranch_scc1 CB_33
    s_swappc_b64 s[66:67], s[64:65]
CB_33:
    s_barrier
    s_sub_u32 s45, 4, s89
    s_cmp_gt_u32 s45, 1
    s_cbranch_scc1 CB_34
    s_swappc_b64 s[66:67], s[64:65]
CB_34:
    s_barrier
    s_sub_u32 s45, 5, s89
    s_cmp_gt_u32 s45, 1
    s_cbranch_scc1 CB_35
    s_swappc_b64 s[66:67], s[64:65]
CB_35:
    s_barrier
    s_sub_u32 s45, 6, s89
    s_cmp_gt_u32 s45, 1
    s_cbranch_scc1 CB_36
    s_swappc_b64 s[66:67], s[64:65]
CB_36:
    s_load_dword s76, s[56:57], 0 glc
    s_barrier
    s_waitcnt lgkmcnt(0)
    s_cmp_ge_u32 s76, 1000
    s_cbranch_scc1 F_ax2g
SP_37:
    s_load_dword s76, s[56:57], 0 glc
    s_waitcnt lgkmcnt(0)
    s_cmp_ge_u32 s76, 1000
    s_cbranch_scc1 SD_38
    s_sleep 2
    s_branch SP_37
SD_38:
F_ax2g:
    s_movk_i32 s44, 0
    buffer_load_dwordx4 v[16:19], v2, s[40:43], s44 offen sc0 sc1
    s_movk_i32 s44, 1024
    buffer_load_dwordx4 v[20:23], v2, s[40:43], s44 offen sc0 sc1
    s_movk_i32 s44, 2048
    buffer_load_dwordx4 v[24:27], v2, s[40:43], s44 offen sc0 sc1
    s_movk_i32 s44, 3072
    buffer_load_dwordx4 v[28:31], v2, s[40:43], s44 offen sc0 sc1
    s_movk_i32 s44, 4096
    buffer_load_dwordx4 v[32:35], v2, s[40:43], s44 offen sc0 sc1
    s_movk_i32 s44, 5120
    buffer_load_dwordx4 v[36:39], v2, s[40:43], s44 offen sc0 sc1
    s_movk_i32 s44, 6144
    buffer_load_dwordx4 v[40:43], v2, s[40:43], s44 offen sc0 sc1
    s_movk_i32 s44, 7168
    buffer_load_dwordx4 v[44:47], v2, s[40:43], s44 offen sc0 sc1
    s_mov_b32 s53, 0
    v_and_b32 v13, 7, v0
    v_lshlrev_b32 v13, 2, v13
    v_lshrrev_b32_e64 v9, 3, v0
    v_lshl_add_u32 v13, v9, 7, v13
    s_barrier
    s_waitcnt vmcnt(0)
    s_mov_b32 s58, 0x01010101
    s_mov_b32 s59, s58
    v_max3_u32 v48, v16, v17, v18
    v_med3_u32 v49, v16, v17, v18
    v_min3_u32 v50, v16, v17, v18
    v_med3_u32 v50, v49, v50, v19
    v_med3_u32 v49, v48, v49, v19
    v_max_u32 v48, v48, v19
    v_med3_u32 v50, v49, v50, v20
    v_med3_u32 v49, v48, v49, v20
    v_max_u32 v48, v48, v20
    v_med3_u32 v50, v49, v50, v21
    v_med3_u32 v49, v48, v49, v21
    v_max_u32 v48, v48, v21
    v_med3_u32 v50, v49, v50, v22
    v_med3_u32 v49, v48, v49, v22
    v_max_u32 v48, v48, v22
    v_med3_u32 v50, v49, v50, v23
    v_med3_u32 v49, v48, v49, v23
    v_max_u32 v48, v48, v23
    v_med3_u32 v50, v49, v50, v24
    v_med3_u32 v49, v48, v49, v24
    v_max_u32 v48, v48, v24
    v_med3_u32 v50, v49, v50, v25
    v_med3_u32 v49, v48, v49, v25
    v_max_u32 v48, v48, v25
    v_med3_u32 v50, v49, v50, v26
    v_med3_u32 v49, v48, v49, v26
    v_max_u32 v48, v48, v26
    v_med3_u32 v50, v49, v50, v27
    v_med3_u32 v49, v48, v49, v27
    v_max_u32 v48, v48, v27
    v_med3_u32 v50, v49, v50, v28
    v_med3_u32 v49, v48, v49, v28
    v_max_u32 v48, v48, v28
    v_med3_u32 v50, v49, v50, v29
    v_med3_u32 v49, v48, v49, v29
    v_max_u32 v48, v48, v29
    v_med3_u32 v50, v49, v50, v30
    v_med3_u32 v49, v48, v49, v30
    v_max_u32 v48, v48, v30
    v_med3_u32 v50, v49, v50, v31
    v_med3_u32 v49, v48, v49, v31
    v_max_u32 v48, v48, v31
    v_med3_u32 v50, v49, v50, v32
    v_med3_u32 v49, v48, v49, v32
    v_max_u32 v48, v48, v32
    s_barrier
    v_med3_u32 v50, v49, v50, v33
    v_med3_u32 v49, v48, v49, v33
    v_max_u32 v48, v48, v33
    v_med3_u32 v50, v49, v50, v34
    v_med3_u32 v49, v48, v49, v34
    v_max_u32 v48, v48, v34
    v_med3_u32 v50, v49, v50, v35
    v_med3_u32 v49, v48, v49, v35
    v_max_u32 v48, v48, v35
    v_med3_u32 v50, v49, v50, v36
    v_med3_u32 v49, v48, v49, v36
    v_max_u32 v48, v48, v36
    v_med3_u32 v50, v49, v50, v37
    v_med3_u32 v49, v48, v49, v37
    v_max_u32 v48, v48, v37
    v_med3_u32 v50, v49, v50, v38
    v_med3_u32 v49, v48, v49, v38
    v_max_u32 v48, v48, v38
    v_med3_u32 v50, v49, v50, v39
    v_med3_u32 v49, v48, v49, v39
    v_max_u32 v48, v48, v39
    v_med3_u32 v50, v49, v50, v40
    v_med3_u32 v49, v48, v49, v40
    v_max_u32 v48, v48, v40
    v_med3_u32 v50, v49, v50, v41
    v_med3_u32 v49, v48, v49, v41
    v_max_u32 v48, v48, v41
    v_med3_u32 v50, v49, v50, v42
    v_med3_u32 v49, v48, v49, v42
    v_max_u32 v48, v48, v42
    v_med3_u32 v50, v49, v50, v43
    v_med3_u32 v49, v48, v49, v43
    v_max_u32 v48, v48, v43
    v_med3_u32 v50, v49, v50, v44
    v_med3_u32 v49, v48, v49, v44
    v_max_u32 v48, v48, v44
    v_med3_u32 v50, v49, v50, v45
    v_med3_u32 v49, v48, v49, v45
    v_max_u32 v48, v48, v45
    v_med3_u32 v50, v49, v50, v46
    v_med3_u32 v49, v48, v49, v46
    v_max_u32 v48, v48, v46
    v_med3_u32 v50, v49, v50, v47
    v_med3_u32 v49, v48, v49, v47
    v_max_u32 v48, v48, v47
    v_mov_b32 v4, v48
    s_nop 1
    v_max_u32_dpp v4, v4, v4 row_shr:1 row_mask:0xf bank_mask:0xf bound_ctrl:0
    s_nop 1
    v_max_u32_dpp v4, v4, v4 row_shr:2 row_mask:0xf bank_mask:0xf bound_ctrl:0
    s_nop 1
    v_max_u32_dpp v4, v4, v4 row_shr:4 row_mask:0xf bank_mask:0xf bound_ctrl:0
    s_nop 1
    v_max_u32_dpp v4, v4, v4 row_shr:8 row_mask:0xf bank_mask:0xf bound_ctrl:0
    s_nop 1
    v_max_u32_dpp v4, v4, v4 row_bcast:15 row_mask:0xa bank_mask:0xf
    s_nop 1
    v_max_u32_dpp v4, v4, v4 row_bcast:31 row_mask:0xc bank_mask:0xf
    s_nop 0
    v_readlane_b32 s52, v4, 63
    s_lshl_b64 exec, s[58:59], 0
    s_nop 0
    v_mov_b32 v12, s52
    s_mov_b64 exec, -1
    v_cmp_eq_u32 vcc, s52, v48
    s_nop 1
    v_cndmask_b32 v48, v48, v49, vcc
    v_cndmask_b32 v49, v49, v50, vcc
    v_cndmask_b32 v50, v50, 0, vcc
    s_barrier
    v_mov_b32 v4, v48
    s_nop 1
    v_max_u32_dpp v4, v4, v4 row_shr:1 row_mask:0xf bank_mask:0xf bound_ctrl:0
    s_nop 1
    v_max_u32_dpp v4, v4, v4 row_shr:2 row_mask:0xf bank_mask:0xf bound_ctrl:0
    s_nop 1
    v_max_u32_dpp v4, v4, v4 row_shr:4 row_mask:0xf bank_mask:0xf bound_ctrl:0
    s_nop 1
    v_max_u32_dpp v4, v4, v4 row_shr:8 row_mask:0xf bank_mask:0xf bound_ctrl:0
    s_nop 1
    v_max_u32_dpp v4, v4, v4 row_bcast:15 row_mask:0xa bank_mask:0xf
    s_nop 1
    v_max_u32_dpp v4, v4, v4 row_bcast:31 row_mask:0xc bank_mask:0xf
    s_nop 0
    v_readlane_b32 s52, v4, 63
    s_lshl_b64 exec, s[58:59], 1
    s_nop 0
    v_mov_b32 v12, s52
    s_mov_b64 exec, -1
    v_cmp_eq_u32 vcc, s52, v48
    s_nop 1
    v_cndmask_b32 v48, v48, v49, vcc
    v_cndmask_b32 v49, v49, v50, vcc
    v_cndmask_b32 v50, v50, 0, vcc
    v_mov_b32 v4, v48
    s_nop 1
    v_max_u32_dpp v4, v4, v4 row_shr:1 row_mask:0xf bank_mask:0xf bound_ctrl:0
    s_nop 1
W_7:
    s_cbranch_execz R_7
    s_nop 0
    v_max_u32_dpp v4, v4, v4 row_shr:2 row_mask:0xf bank_mask:0xf bound_ctrl:0
    s_nop 1
    v_max_u32_dpp v4, v4, v4 row_shr:4 row_mask:0xf bank_mask:0xf bound_ctrl:0
    s_nop 1
    v_max_u32_dpp v4, v4, v4 row_shr:8 row_mask:0xf bank_mask:0xf bound_ctrl:0
    s_nop 1
    v_max_u32_dpp v4, v4, v4 row_bcast:15 row_mask:0xa bank_mask:0xf
    s_nop 1
    v_max_u32_dpp v4, v4, v4 row_bcast:31 row_mask:0xc bank_mask:0xf
    s_nop 0
    v_readlane_b32 s52, v4, 63
    s_lshl_b64 exec, s[58:59], 2
    s_nop 0
    v_mov_b32 v12, s52
    s_mov_b64 exec, -1
    v_cmp_eq_u32 vcc, s52, v48
    s_nop 1
    v_cndmask_b32 v48, v48, v49, vcc
    v_cndmask_b32 v49, v49, v50, vcc
    v_cndmask_b32 v50, v50, 0, vcc
    v_mov_b32 v4, v48
    s_nop 1
    v_max_u32_dpp v4, v4, v4 row_shr:1 row_mask:0xf bank_mask:0xf bound_ctrl:0
    s_nop 1
    v_max_u32_dpp v4, v4, v4 row_shr:2 row_mask:0xf bank_mask:0xf bound_ctrl:0
    s_nop 1
    v_max_u32_dpp v4, v4, v4 row_shr:4 row_mask:0xf bank_mask:0xf bound_ctrl:0
    s_nop 1
    v_max_u32_dpp v4, v4, v4 row_shr:8 row_mask:0xf bank_mask:0xf bound_ctrl:0
    s_nop 1
    v_max_u32_dpp v4, v4, v4 row_bcast:15 row_mask:0xa bank_mask:0xf
    s_nop 1
    v_max_u32_dpp v4, v4, v4 row_bcast:31 row_mask:0xc bank_mask:0xf
    s_nop 0
    v_readlane_b32 s52, v4, 63
    s_lshl_b64 exec, s[58:59], 3
    s_nop 0
    v_mov_b32 v12, s52
    s_mov_b64 exec, -1
    v_cmp_eq_u32 vcc, s52, v48
    s_nop 1
    v_cndmask_b32 v48, v48, v49, vcc
    v_cndmask_b32 v49, v49, v50, vcc
    v_cndmask_b32 v50, v50, 0, vcc
    v_mov_b32 v4, v48
    s_nop 1
    v_max_u32_dpp v4, v4, v4 row_shr:1 row_mask:0xf bank_mask:0xf bound_ctrl:0
    s_nop 1
    v_max_u32_dpp v4, v4, v4 row_shr:2 row_mask:0xf bank_mask:0xf bound_ctrl:0
    s_nop 1
    v_max_u32_dpp v4, v4, v4 row_shr:4 row_mask:0xf bank_mask:0xf bound_ctrl:0
    s_nop 1
    v_max_u32_dpp v4, v4, v4 row_shr:8 row_mask:0xf bank_mask:0xf bound_ctrl:0
    s_nop 1
    v_max_u32_dpp v4, v4, v4 row_bcast:15 row_mask:0xa bank_mask:0xf
    s_nop 1
    v_max_u32_dpp v4, v4, v4 row_bcast:31 row_mask:0xc bank_mask:0xf
    s_nop 0
    v_readlane_b32 s52, v4, 63
    s_lshl_b64 exec, s[58:59], 4
    s_nop 0
    v_mov_b32 v12, s52
    s_mov_b64 exec, -1
    v_cmp_eq_u32 vcc, s52, v48
    s_nop 1
    v_cndmask_b32 v48, v48, v49, vcc
    v_cndmask_b32 v49, v49, v50, vcc
    v_cndmask_b32 v50, v50, 0, vcc
    s_barrier
    v_mov_b32 v4, v48
    s_nop 1
    v_max_u32_dpp v4, v4, v4 row_shr:1 row_mask:0xf bank_mask:0xf bound_ctrl:0
    s_nop 1
    v_max_u32_dpp v4, v4, v4 row_shr:2 row_mask:0xf bank_mask:0xf bound_ctrl:0
    s_nop 1
    v_max_u32_dpp v4, v4, v4 row_shr:4 row_mask:0xf bank_mask:0xf bound_ctrl:0
    s_nop 1
    v_max_u32_dpp v4, v4, v4 row_shr:8 row_mask:0xf bank_mask:0xf bound_ctrl:0
    s_nop 1
    v_max_u32_dpp v4, v4, v4 row_bcast:15 row_mask:0xa bank_mask:0xf
    s_nop 1
    v_max_u32_dpp v4, v4, v4 row_bcast:31 row_mask:0xc bank_mask:0xf
    s_nop 0
    v_readlane_b32 s52, v4, 63
    s_lshl_b64 exec, s[58:59], 5
    s_nop 0
    v_mov_b32 v12, s52
    s_mov_b64 exec, -1
    v_cmp_eq_u32 vcc, s52, v48
    s_nop 1
    v_cndmask_b32 v48, v48, v49, vcc
    v_cndmask_b32 v49, v49, v50, vcc
    v_cndmask_b32 v50, v50, 0, vcc
    v_mov_b32 v4, v48
    s_nop 1
    v_max_u32_dpp v4, v4, v4 row_shr:1 row_mask:0xf bank_mask:0xf bound_ctrl:0
    s_nop 1
    v_max_u32_dpp v4, v4, v4 row_shr:2 row_mask:0xf bank_mask:0xf bound_ctrl:0
    s_nop 1
    v_max_u32_dpp v4, v4, v4 row_shr:4 row_mask:0xf bank_mask:0xf bound_ctrl:0
    s_nop 1
    v_max_u32_dpp v4, v4, v4 row_shr:8 row_mask:0xf bank_mask:0xf bound_ctrl:0
    s_nop 1
    v_max_u32_dpp v4, v4, v4 row_bcast:15 row_mask:0xa bank_mask:0xf
    s_nop 1
    v_max_u32_dpp v4, v4, v4 row_bcast:31 row_mask:0xc bank_mask:0xf
    s_nop 0
    v_readlane_b32 s52, v4, 63
    s_lshl_b64 exec, s[58:59], 6
    s_nop 0
    v_mov_b32 v12, s52
    s_mov_b64 exec, -1
    v_cmp_eq_u32 vcc, s52, v48
    s_nop 1
    v_cndmask_b32 v48, v48, v49, vcc
    v_cndmask_b32 v49, v49, v50, vcc
    v_cndmask_b32 v50, v50, 0, vcc
    v_mov_b32 v4, v48
    s_nop 1
    v_max_u32_dpp v4, v4, v4 row_shr:1 row_mask:0xf bank_mask:0xf bound_ctrl:0
    s_nop 1
    v_max_u32_dpp v4, v4, v4 row_shr:2 row_mask:0xf bank_mask:0xf bound_ctrl:0
    s_nop 1
    v_max_u32_dpp v4, v4, v4 row_shr:4 row_mask:0xf bank_mask:0xf bound_ctrl:0
    s_nop 1
    v_max_u32_dpp v4, v4, v4 row_shr:8 row_mask:0xf bank_mask:0xf bound_ctrl:0
    s_nop 1
    v_max_u32_dpp v4, v4, v4 row_bcast:15 row_mask:0xa bank_mask:0xf
    s_nop 1
    v_max_u32_dpp v4, v4, v4 row_bcast:31 row_mask:0xc bank_mask:0xf
    s_nop 0
    v_readlane_b32 s52, v4, 63
    s_lshl_b64 exec, s[58:59], 7
    s_nop 0
    v_mov_b32 v12, s52
    s_mov_b64 exec, -1
    v_cmp_eq_u32 vcc, 0, v48
    s_cbranch_vccz F_tk2
    s_mov_b32 s52, 0
    s_mov_b32 s45, 0
F_tk1:
    v_subrev_u32 v16, s52, v16
    v_subrev_u32 v17, s52, v17
    v_subrev_u32 v18, s52, v18
    v_subrev_u32 v19, s52, v19
    v_subrev_u32 v20, s52, v20
    v_subrev_u32 v21, s52, v21
    v_subrev_u32 v22, s52, v22
    v_subrev_u32 v23, s52, v23
    v_subrev_u32 v24, s52, v24
    v_subrev_u32 v25, s52, v25
    v_subrev_u32 v26, s52, v26
    v_subrev_u32 v27, s52, v27
    v_subrev_u32 v28, s52, v28
    v_subrev_u32 v29, s52, v29
    v_subrev_u32 v30, s52, v30
    v_subrev_u32 v31, s52, v31
    v_subrev_u32 v32, s52, v32
    v_subrev_u32 v33, s52, v33
    v_subrev_u32 v34, s52, v34
    v_subrev_u32 v35, s52, v35
    v_subrev_u32 v36, s52, v36
    v_subrev_u32 v37, s52, v37
    v_subrev_u32 v38, s52, v38
    v_subrev_u32 v39, s52, v39
    v_subrev_u32 v40, s52, v40
    v_subrev_u32 v41, s52, v41
    v_subrev_u32 v42, s52, v42
    v_subrev_u32 v43, s52, v43
    v_subrev_u32 v44, s52, v44
    v_subrev_u32 v45, s52, v45
    v_subrev_u32 v46, s52, v46
    v_subrev_u32 v47, s52, v47
    v_max3_u32 v4, v16, v17, v18
    v_max3_u32 v4, v4, v19, v20
    v_max3_u32 v4, v4, v21, v22
    v_max3_u32 v4, v4, v23, v24
    v_max3_u32 v4, v4, v25, v26
    v_max3_u32 v4, v4, v27, v28
    v_max3_u32 v4, v4, v29, v30
    v_max3_u32 v4, v4, v31, v32
    v_max3_u32 v4, v4, v33, v34
    v_max3_u32 v4, v4, v35, v36
    v_max3_u32 v4, v4, v37, v38
    v_max3_u32 v4, v4, v39, v40
    v_max3_u32 v4, v4, v41, v42
    v_max3_u32 v4, v4, v43, v44
    v_max3_u32 v4, v4, v45, v46
    v_max_u32 v4, v4, v47
    s_nop 1
    v_max_u32_dpp v4, v4, v4 row_shr:1 row_mask:0xf bank_mask:0xf bound_ctrl:0
    s_nop 1
    v_max_u32_dpp v4, v4, v4 row_shr:2 row_mask:0xf bank_mask:0xf bound_ctrl:0
    s_nop 1
    v_max_u32_dpp v4, v4, v4 row_shr:4 row_mask:0xf bank_mask:0xf bound_ctrl:0
    s_nop 1
    v_max_u32_dpp v4, v4, v4 row_shr:8 row_mask:0xf bank_mask:0xf bound_ctrl:0
    s_nop 1
    v_max_u32_dpp v4, v4, v4 row_bcast:15 row_mask:0xa bank_mask:0xf
    s_nop 1
    v_max_u32_dpp v4, v4, v4 row_bcast:31 row_mask:0xc bank_mask:0xf
    s_nop 0
    v_readlane_b32 s52, v4, 63
    s_nop 0
    s_add_u32 s53, s53, s52
    s_lshl_b64 exec, s[58:59], s45
    v_mov_b32 v12, s53
    s_mov_b64 exec, -1
    s_add_u32 s45, s45, 1
    s_cmp_lt_u32 s45, 8
    s_cbranch_scc1 F_tk1
F_tk2:
    v_or_b32 v12, 0x8000, v12
    s_mov_b32 s44, 184320
    buffer_store_dword v12, v13, s[24:27], s44 offen offset:0 sc0 sc1
    buffer_store_dword v12, v13, s[24:27], s44 offen offset:1024 sc0 sc1
    buffer_store_dword v12, v13, s[24:27], s44 offen offset:2048 sc0 sc1
    buffer_store_dword v12, v13, s[24:27], s44 offen offset:3072 sc0 sc1
    s_mov_b32 s44, 188416
    buffer_store_dword v12, v13, s[24:27], s44 offen offset:0 sc0 sc1
    buffer_store_dword v12, v13, s[24:27], s44 offen offset:1024 sc0 sc1
    buffer_store_dword v12, v13, s[24:27], s44 offen offset:2048 sc0 sc1
    buffer_store_dword v12, v13, s[24:27], s44 offen offset:3072 sc0 sc1
    s_branch F_aj
F_ax2n:
    s_barrier
    s_sub_u32 s45, 2, s89
    s_cmp_gt_u32 s45, 1
    s_cbranch_scc1 CB_39
    s_swappc_b64 s[66:67], s[64:65]
CB_39:
    s_barrier
    s_sub_u32 s45, 3, s89
    s_cmp_gt_u32 s45, 1
    s_cbranch_scc1 CB_40
    s_swappc_b64 s[66:67], s[64:65]
CB_40:
    s_barrier
    s_sub_u32 s45, 4, s89
    s_cmp_gt_u32 s45, 1
    s_cbranch_scc1 CB_41
    s_swappc_b64 s[66:67], s[64:65]
CB_41:
    s_barrier
    s_sub_u32 s45, 5, s89
    s_cmp_gt_u32 s45, 1
    s_cbranch_scc1 CB_42
    s_swappc_b64 s[66:67], s[64:65]
CB_42:
    s_barrier
    s_sub_u32 s45, 6, s89
    s_cmp_gt_u32 s45, 1
    s_cbranch_scc1 CB_43
    s_swappc_b64 s[66:67], s[64:65]
CB_43:
    s_barrier
    s_load_dword s76, s[56:57], 0 glc
    s_barrier
    s_waitcnt lgkmcnt(0)
    s_cmp_ge_u32 s76, 1000
    s_cbranch_scc1 F_ax2h
SP_44:
    s_load_dword s76, s[56:57], 0 glc
    s_waitcnt lgkmcnt(0)
    s_cmp_ge_u32 s76, 1000
    s_cbranch_scc1 SD_45
    s_sleep 8
    s_branch SP_44
SD_45:
F_ax2h:
    s_barrier
    s_barrier
    s_barrier
F_aj:
    s_add_u32 s12, s72, 0xa00000
    s_addc_u32 s13, s73, 0
    s_mov_b32 s14, 0xe0000
    s_mov_b32 s15, 0x00020000
    s_and_b32 s46, s2, 63
    s_lshl_b32 s46, s46, 7
    s_add_u32 s56, s46, 0x82d000
    s_add_u32 s56, s72, s56
    s_addc_u32 s57, s73, 0
    s_mov_b32 s58, 0x01010101
    s_mov_b32 s59, s58
    s_mov_b32 s52, 0x05040100
    s_mov_b32 s53, 0x07060302
    v_and_b32 v13, 3, v0
    v_lshlrev_b32 v13, 2, v13
    v_add_u32 v13, 24656, v13
    s_lshl_b32 s86, s38, 2
    s_add_u32 s86, s86, s3
    s_and_b32 s87, s11, 7
    s_lshl_b32 s78, s86, 16
    s_lshl_b32 s79, s87, 8
    s_add_u32 s78, s78, s79

    v_lshlrev_b32 v160, 11, v5
    v_lshl_add_u32 v160, v7, 4, v160
    v_subrev_u32 v163, 16, v13
    v_add_u32 v162, 16, v13
    v_and_b32 v11, 7, v0
    v_lshlrev_b32 v11, 4, v11
    v_lshrrev_b32 v164, 3, v0
    v_lshl_add_u32 v164, v164, 9, v11
    s_lshl_b32 s45, s3, 12
    s_add_u32 s45, s45, 106496
    v_add_u32 v164, s45, v164
    s_lshl_b32 s45, s3, 10
    s_add_u32 s44, s45, 106496
    v_add_u32 v165, s44, v2
    s_add_u32 s44, s45, 32768
    v_add_u32 v167, s44, v2
    s_and_b32 s44, s3, 1
    s_lshl_b32 s44, s44, 12
    s_lshr_b32 s45, s3, 1
    s_mul_i32 s45, s45, 24576
    s_add_u32 s44, s44, s45
    s_add_u32 s44, s44, 32768
    v_add_u32 v161, s44, v2
    v_lshl_add_u32 v11, v5, 7, v11
    v_bfe_u32 v12, v0, 3, 1
    v_mul_u32_u24 v12, 114688, v12
    v_add_u32 v11, v11, v12
    v_mov_b32 v48, 0
    v_mov_b32 v49, 0
    v_mov_b32 v50, 0
    v_mov_b32 v51, 0
    v_mov_b32 v52, 0
    v_mov_b32 v53, 0
    v_mov_b32 v54, 0
    v_mov_b32 v55, 0
    v_mov_b32 v56, 0
    v_mov_b32 v57, 0
    v_mov_b32 v58, 0
    v_mov_b32 v59, 0
    v_mov_b32 v60, 0
    v_mov_b32 v61, 0
    v_mov_b32 v62, 0
    v_mov_b32 v63, 0
    s_barrier
    s_barrier
    s_sleep 2
    s_add_u32 s45, s54, 0
    buffer_load_dwordx4 v[72:75], v6, s[16:19], s45 offen nt
    s_add_u32 s45, s54, 7168
    buffer_load_dwordx4 v[76:79], v6, s[16:19], s45 offen nt
    s_add_u32 s45, s54, 14336
    buffer_load_dwordx4 v[80:83], v6, s[16:19], s45 offen nt
    s_add_u32 s45, s54, 21504
    buffer_load_dwordx4 v[84:87], v6, s[16:19], s45 offen nt
    s_add_u32 s45, s54, 28672
    buffer_load_dwordx4 v[88:91], v6, s[16:19], s45 offen nt
    s_barrier
    s_nop 0
    s_load_dwordx8 s[60:67], s[56:57], 0 glc
    s_add_u32 s45, s54, 35840
    buffer_load_dwordx4 v[92:95], v6, s[16:19], s45 offen nt
    s_add_u32 s45, s54, 43008
    buffer_load_dwordx4 v[96:99], v6, s[16:19], s45 offen nt
    s_add_u32 s45, s54, 50176
    buffer_load_dwordx4 v[100:103], v6, s[16:19], s45 offen nt
    s_add_u32 s45, s54, 229376
    buffer_load_dwordx4 v[104:107], v6, s[16:19], s45 offen nt
    s_add_u32 s45, s54, 236544
    buffer_load_dwordx4 v[108:111], v6, s[16:19], s45 offen nt
    s_barrier
    s_setprio 1
F_sc:
    s_waitcnt lgkmcnt(0)
    s_and_b64 s[74:75], s[60:61], s[62:63]
    s_and_b64 s[74:75], s[74:75], s[64:65]
    s_and_b64 s[74:75], s[74:75], s[66:67]
    s_and_b32 s74, s74, s75
    s_bitcmp1_b32 s74, 15
    s_cbranch_scc1 F_sd
    s_sleep 4
    s_load_dwordx8 s[60:67], s[56:57], 0 glc
    s_branch F_sc
F_sd:

    s_lshl_b64 exec, s[58:59], 0
    v_mov_b32 v4, s60
    s_lshl_b64 exec, s[58:59], 1
    v_mov_b32 v4, s61
    s_lshl_b64 exec, s[58:59], 2
    v_mov_b32 v4, s62
    s_lshl_b64 exec, s[58:59], 3
    v_mov_b32 v4, s63
    s_lshl_b64 exec, s[58:59], 4
    v_mov_b32 v4, s64
    s_lshl_b64 exec, s[58:59], 5
    v_mov_b32 v4, s65
    s_lshl_b64 exec, s[58:59], 6
    v_mov_b32 v4, s66
    s_lshl_b64 exec, s[58:59], 7
    v_mov_b32 v4, s67
    s_mov_b64 exec, -1
    s_mov_b32 s46, 65536
    v_and_b32 v4, 0x7ff, v4
    v_sub_u32 v4, 2047, v4
    v_lshlrev_b32 v9, 4, v4
    v_lshlrev_b32 v4, 11, v4
    v_lshl_add_u32 v4, v5, 4, v4
    v_and_b32_e64 v12, 8, v0
    v_lshl_add_u32 v4, v12, 3, v4

    buffer_load_dwordx4 v[64:67], v4, s[20:23], s55 offen
    buffer_load_dwordx2 v[14:15], v9, s[40:43], s46 offen sc0 sc1
    s_mov_b32 s48, 0xbfb8aa3b
    s_cmp_lt_u32 s11, 224
    s_cbranch_scc1 F_ag
    v_mov_b32_e64 v4, 2
    s_mov_b64 exec, 1
    ds_write_b32 v10, v4 offset:16
    s_mov_b64 exec, -1
    s_sleep 64
    s_waitcnt vmcnt(0)
    s_branch F_out
F_ag:
    s_add_u32 s45, s54, 243712
    buffer_load_dwordx4 v[112:115], v6, s[16:19], s45 offen nt
    s_add_u32 s45, s54, 250880
    buffer_load_dwordx4 v[116:119], v6, s[16:19], s45 offen nt
    s_add_u32 s45, s54, 258048
    buffer_load_dwordx4 v[120:123], v6, s[16:19], s45 offen nt
    s_add_u32 s45, s54, 265216
    buffer_load_dwordx4 v[124:127], v6, s[16:19], s45 offen nt
    s_add_u32 s45, s54, 272384
    buffer_load_dwordx4 v[128:131], v6, s[16:19], s45 offen nt
    s_add_u32 s45, s54, 279552
    buffer_load_dwordx4 v[132:135], v6, s[16:19], s45 offen nt
    s_waitcnt vmcnt(6)
    v_lshlrev_b32 v32, 16, v64
    v_and_b32 v33, 0xffff0000, v64
    v_lshlrev_b32 v34, 16, v65
    v_and_b32 v35, 0xffff0000, v65
    v_lshlrev_b32 v36, 16, v66
    v_and_b32 v37, 0xffff0000, v66
    v_lshlrev_b32 v38, 16, v67
    v_and_b32 v39, 0xffff0000, v67
    v_add_f32 v32, v32, v14
    v_add_f32 v33, v33, v14
    v_add_f32 v34, v34, v14
    v_add_f32 v35, v35, v14
    v_add_f32 v36, v36, v14
    v_add_f32 v37, v37, v14
    v_add_f32 v38, v38, v14
    v_add_f32 v39, v39, v14
    v_cvt_pk_bf16_f32 v64, v32, v33
    v_cvt_pk_bf16_f32 v65, v34, v35
    v_cvt_pk_bf16_f32 v66, v36, v37
    v_cvt_pk_bf16_f32 v67, v38, v39
    v_lshlrev_b32 v32, 16, v64
    v_and_b32 v33, 0xffff0000, v64
    v_lshlrev_b32 v34, 16, v65
    v_and_b32 v35, 0xffff0000, v65
    v_lshlrev_b32 v36, 16, v66
    v_and_b32 v37, 0xffff0000, v66
    v_lshlrev_b32 v38, 16, v67
    v_and_b32 v39, 0xffff0000, v67
    v_mul_f32 v32, v32, v15
    v_mul_f32 v33, v33, v15
    v_mul_f32 v34, v34, v15
    v_mul_f32 v35, v35, v15
    v_mul_f32 v36, v36, v15
    v_mul_f32 v37, v37, v15
    v_mul_f32 v38, v38, v15
    v_mul_f32_e64 v39, v39, v15
    v_cvt_pk_bf16_f32 v64, v32, v33
    v_cvt_pk_bf16_f32 v65, v34, v35
    v_cvt_pk_bf16_f32 v66, v36, v37
    v_cvt_pk_bf16_f32 v67, v38, v39
    v_mov_b32_dpp v48, v64 quad_perm:[0,1,2,3] row_mask:0xf bank_mask:0x3
    v_mov_b32_dpp v49, v65 quad_perm:[0,1,2,3] row_mask:0xf bank_mask:0x3
    v_mov_b32_dpp v50, v66 quad_perm:[0,1,2,3] row_mask:0xf bank_mask:0x3
    v_mov_b32_dpp v51, v67 quad_perm:[0,1,2,3] row_mask:0xf bank_mask:0x3
    v_mov_b32_dpp v52, v64 row_ror:8 row_mask:0xf bank_mask:0xc
    v_mov_b32_dpp v53, v65 row_ror:8 row_mask:0xf bank_mask:0xc
    v_mov_b32_dpp v54, v66 row_ror:8 row_mask:0xf bank_mask:0xc
    v_mov_b32_dpp v55, v67 row_ror:8 row_mask:0xf bank_mask:0xc
    v_mov_b32_dpp v56, v64 row_ror:8 row_mask:0xf bank_mask:0x3
    v_mov_b32_dpp v57, v65 row_ror:8 row_mask:0xf bank_mask:0x3
    v_mov_b32_dpp v58, v66 row_ror:8 row_mask:0xf bank_mask:0x3
    v_mov_b32_dpp v59, v67 row_ror:8 row_mask:0xf bank_mask:0x3
    v_mov_b32_dpp v60, v64 quad_perm:[0,1,2,3] row_mask:0xf bank_mask:0xc
    v_mov_b32_dpp v61, v65 quad_perm:[0,1,2,3] row_mask:0xf bank_mask:0xc
    v_mov_b32_dpp v62, v66 quad_perm:[0,1,2,3] row_mask:0xf bank_mask:0xc
    v_mov_b32_dpp v63, v67 quad_perm:[0,1,2,3] row_mask:0xf bank_mask:0xc
    v_perm_b32 v136, v76, v72, s52
    v_perm_b32 v137, v84, v80, s52
    v_perm_b32 v138, v92, v88, s52
    v_perm_b32 v139, v100, v96, s52
    s_nop 1
    v_mfma_f32_16x16x32_bf16 v[32:35], v[136:139], v[48:51], 0
    v_perm_b32 v140, v78, v74, s52
    v_perm_b32 v141, v86, v82, s52
    v_perm_b32 v142, v94, v90, s52
    v_perm_b32 v143, v102, v98, s52
    s_nop 1
    v_mfma_f32_16x16x32_bf16 v[32:35], v[140:143], v[52:55], v[32:35]
    v_perm_b32 v136, v76, v72, s53
    v_perm_b32 v137, v84, v80, s53
    v_perm_b32 v138, v92, v88, s53
    v_perm_b32 v139, v100, v96, s53
    s_nop 1
    v_mfma_f32_16x16x32_bf16 v[36:39], v[136:139], v[48:51], 0
    v_perm_b32 v140, v78, v74, s53
    v_perm_b32 v141, v86, v82, s53
    v_perm_b32 v142, v94, v90, s53
    v_perm_b32 v143, v102, v98, s53
    s_nop 1
    v_mfma_f32_16x16x32_bf16 v[36:39], v[140:143], v[52:55], v[36:39]
    v_perm_b32 v136, v77, v73, s52
    v_perm_b32 v137, v85, v81, s52
    v_perm_b32 v138, v93, v89, s52
    v_perm_b32 v139, v101, v97, s52
    s_nop 1
    v_mfma_f32_16x16x32_bf16 v[40:43], v[136:139], v[48:51], 0
    v_perm_b32 v140, v79, v75, s52
    v_perm_b32 v141, v87, v83, s52
    v_perm_b32 v142, v95, v91, s52
    v_perm_b32 v143, v103, v99, s52
    s_nop 1
    v_mfma_f32_16x16x32_bf16 v[40:43], v[140:143], v[52:55], v[40:43]
    v_perm_b32 v136, v77, v73, s53
    v_perm_b32 v137, v85, v81, s53
    v_perm_b32 v138, v93, v89, s53
    v_perm_b32 v139, v101, v97, s53
    s_nop 1
    v_mfma_f32_16x16x32_bf16 v[44:47], v[136:139], v[48:51], 0
    v_perm_b32 v140, v79, v75, s53
    v_perm_b32 v141, v87, v83, s53
    v_perm_b32 v142, v95, v91, s53
    v_perm_b32 v143, v103, v99, s53
    s_nop 1
    v_mfma_f32_16x16x32_bf16 v[44:47], v[140:143], v[52:55], v[44:47]
    s_waitcnt vmcnt(6)
    s_nop 0
    v_perm_b32 v72, v108, v104, s52
    v_perm_b32 v88, v110, v106, s52
    v_perm_b32 v76, v108, v104, s53
    v_perm_b32 v92, v110, v106, s53
    v_perm_b32 v80, v109, v105, s52
    v_perm_b32 v96, v111, v107, s52
    v_perm_b32 v84, v109, v105, s53
    v_perm_b32 v100, v111, v107, s53
    s_waitcnt vmcnt(4)
    s_nop 0
    v_perm_b32 v73, v116, v112, s52
    v_perm_b32 v89, v118, v114, s52
    v_perm_b32 v77, v116, v112, s53
    v_perm_b32 v93, v118, v114, s53
    v_perm_b32 v81, v117, v113, s52
    v_perm_b32 v97, v119, v115, s52
    v_perm_b32 v85, v117, v113, s53
    v_perm_b32 v101, v119, v115, s53
    s_waitcnt vmcnt(2)
    s_nop 0
    v_perm_b32 v74, v124, v120, s52
    v_perm_b32 v90, v126, v122, s52
    v_perm_b32 v78, v124, v120, s53
    v_perm_b32 v94, v126, v122, s53
    v_perm_b32 v82, v125, v121, s52
    v_perm_b32 v98, v127, v123, s52
    v_perm_b32 v86, v125, v121, s53
    v_perm_b32 v102, v127, v123, s53
    s_waitcnt vmcnt(0)
    s_add_u32 s79, s78, 0
    buffer_load_dwordx4 v[16:19], v160, s[80:83], s79 offen nt
    s_add_u32 s79, s78, 16384
    buffer_load_dwordx4 v[20:23], v160, s[80:83], s79 offen nt
    s_add_u32 s79, s78, 32768
    buffer_load_dwordx4 v[24:27], v160, s[80:83], s79 offen nt
    s_add_u32 s79, s78, 49152
    buffer_load_dwordx4 v[28:31], v160, s[80:83], s79 offen nt
    s_add_u32 s79, s78, 8192
    buffer_load_dwordx4 v[144:147], v160, s[80:83], s79 offen nt
    s_add_u32 s79, s78, 24576
    buffer_load_dwordx4 v[148:151], v160, s[80:83], s79 offen nt
    s_add_u32 s79, s78, 40960
    buffer_load_dwordx4 v[152:155], v160, s[80:83], s79 offen nt
    s_add_u32 s79, s78, 57344
    buffer_load_dwordx4 v[156:159], v160, s[80:83], s79 offen nt
    v_perm_b32 v75, v132, v128, s52
    v_perm_b32 v91, v134, v130, s52
    v_perm_b32 v79, v132, v128, s53
    v_perm_b32 v95, v134, v130, s53
    v_perm_b32 v83, v133, v129, s52
    v_perm_b32 v99, v135, v131, s52
    v_perm_b32 v87, v133, v129, s53
    v_perm_b32 v103, v135, v131, s53
    v_mfma_f32_16x16x32_bf16 v[32:35], v[72:75], v[56:59], v[32:35]
    v_mfma_f32_16x16x32_bf16 v[32:35], v[88:91], v[60:63], v[32:35]
    v_mfma_f32_16x16x32_bf16 v[36:39], v[76:79], v[56:59], v[36:39]
    v_mfma_f32_16x16x32_bf16 v[36:39], v[92:95], v[60:63], v[36:39]
    v_mfma_f32_16x16x32_bf16 v[40:43], v[80:83], v[56:59], v[40:43]
    v_mfma_f32_16x16x32_bf16 v[40:43], v[96:99], v[60:63], v[40:43]
    v_mfma_f32_16x16x32_bf16 v[44:47], v[84:87], v[56:59], v[44:47]
    v_mfma_f32_16x16x32_bf16 v[44:47], v[100:103], v[60:63], v[44:47]
    s_nop 1
    ds_write_b128 v164, v[32:35] offset:0
    s_nop 0
    ds_write_b128 v164, v[36:39] offset:128
    s_nop 0
    ds_write_b128 v164, v[40:43] offset:256
    s_nop 0
    ds_write_b128 v164, v[44:47] offset:384
    v_mov_b32 v4, 1
    s_mov_b64 exec, 1
    ds_write_b32 v10, v4 offset:16
    s_mov_b64 exec, -1
    s_mul_i32 s44, s86, 64
    s_add_u32 s44, s44, 241664
    ds_read_b32 v12, v13
FW_46:
    s_waitcnt lgkmcnt(0)
    v_cmp_gt_u32 vcc, 1, v12
    s_cbranch_vccz FO_47
    s_sleep 1
    ds_read_b32 v12, v13
    s_branch FW_46
FO_47:
    ds_read_b128 v[72:75], v165 offset:0
    ds_read_b128 v[76:79], v165 offset:4096
    ds_read_b128 v[80:83], v165 offset:8192
    ds_read_b128 v[84:87], v165 offset:12288
    s_waitcnt lgkmcnt(2)
    v_add_f32 v72, v72, v76
    v_add_f32 v73, v73, v77
    v_add_f32 v74, v74, v78
    v_add_f32 v75, v75, v79
    s_waitcnt lgkmcnt(0)
    v_add_f32 v80, v80, v84
    v_add_f32 v81, v81, v85
    v_add_f32 v82, v82, v86
    v_add_f32 v83, v83, v87
    v_add_f32 v72, v72, v80
    v_add_f32 v73, v73, v81
    v_add_f32 v74, v74, v82
    v_add_f32 v75, v75, v83
    v_max_u32 v72, 1, v72
    v_max_u32 v74, 1, v74
    buffer_store_dwordx4 v[72:75], v2, s[12:15], s77 offen sc0 sc1
    s_mov_b64 exec, 1
    buffer_atomic_add v4, v8, s[24:27], s44 offen
    s_mov_b64 exec, -1
    v_mov_b32 v12, 2
    s_mov_b64 exec, 1
    ds_write_b32 v10, v12 offset:16
    s_mov_b64 exec, -1
    s_add_u32 s56, s44, 0x800000
    s_add_u32 s56, s72, s56
    s_addc_u32 s57, s73, 0
    s_lshl_b32 s38, s86, 10
    v_add_u32 v13, 48, v13
    v_mov_b32 v64, 0
    v_mov_b32 v65, 0
    v_mov_b32 v66, 0
    v_mov_b32 v67, 0
    v_mov_b32 v68, 0
    v_mov_b32 v69, 0
    v_mov_b32 v70, 0
    v_mov_b32 v71, 0
F_out:
    s_mov_b32 s80, s68
    s_mov_b32 s81, s69
    s_mov_b32 s82, 0x400000
    s_mov_b32 s83, 0x00020000
    s_lshl_b32 s46, s3, 2
    v_add_u32 v32, s46, v5
    v_lshlrev_b32 v14, 4, v7
    v_mul_u32_u24 v33, 272, v32
    v_add3_u32 v15, v14, v33, 0
    v_lshl_add_u32 v14, v32, 11, v14
    s_lshl_b32 s78, s28, 17
    s_lshl_b32 s79, s29, 8
    s_add_u32 s78, s78, s79
    s_lshl_b32 s47, s28, 6
    s_add_u32 s47, s47, s46
    s_sub_u32 s47, 2047, s47
    s_mov_b32 s77, 0
    v_mov_b32 v136, 0
    v_mov_b32 v137, 0
    v_mov_b32 v138, 0
    v_mov_b32 v139, 0
    s_and_b32 s46, s60, 0x7ff
    s_sub_u32 s46, s47, s46
    s_and_b32 s45, s46, 0xffffffcc
    s_cbranch_scc1 SD_48
    s_mov_b32 s77, 1
    s_or_b32 s45, s60, 0x0
    v_mov_b32 v33, s45
    v_cmp_eq_u32 vcc, s46, v5
    s_sub_u32 s46, s46, 16
    s_nop 0
    v_cndmask_b32 v136, v136, v33, vcc
    v_cmp_eq_u32 vcc, s46, v5
    s_sub_u32 s46, s46, 16
    s_nop 0
    v_cndmask_b32 v137, v137, v33, vcc
    v_cmp_eq_u32 vcc, s46, v5
    s_sub_u32 s46, s46, 16
    s_nop 0
    v_cndmask_b32 v138, v138, v33, vcc
    v_cmp_eq_u32 vcc, s46, v5
    s_sub_u32 s46, s46, 16
    s_nop 0
    v_cndmask_b32 v139, v139, v33, vcc
SD_48:
    s_and_b32 s46, s61, 0x7ff
    s_sub_u32 s46, s47, s46
    s_and_b32 s45, s46, 0xffffffcc
    s_cbranch_scc1 SD_49
    s_mov_b32 s77, 1
    s_or_b32 s45, s61, 0x2000
    v_mov_b32 v33, s45
    v_cmp_eq_u32 vcc, s46, v5
    s_sub_u32 s46, s46, 16
    s_nop 0
    v_cndmask_b32 v136, v136, v33, vcc
    v_cmp_eq_u32 vcc, s46, v5
    s_sub_u32 s46, s46, 16
    s_nop 0
    v_cndmask_b32 v137, v137, v33, vcc
    v_cmp_eq_u32 vcc, s46, v5
    s_sub_u32 s46, s46, 16
    s_nop 0
    v_cndmask_b32 v138, v138, v33, vcc
    v_cmp_eq_u32 vcc, s46, v5
    s_sub_u32 s46, s46, 16
    s_nop 0
    v_cndmask_b32 v139, v139, v33, vcc
SD_49:
    s_and_b32 s46, s62, 0x7ff
    s_sub_u32 s46, s47, s46
    s_and_b32 s45, s46, 0xffffffcc
    s_cbranch_scc1 SD_50
    s_mov_b32 s77, 1
    s_or_b32 s45, s62, 0x4000
    v_mov_b32 v33, s45
W_8:
    s_cbranch_execz R_8
    s_nop 0
    v_cmp_eq_u32 vcc, s46, v5
    s_sub_u32 s46, s46, 16
    s_nop 0
    v_cndmask_b32 v136, v136, v33, vcc
    v_cmp_eq_u32 vcc, s46, v5
    s_sub_u32 s46, s46, 16
    s_nop 0
    v_cndmask_b32 v137, v137, v33, vcc
    v_cmp_eq_u32 vcc, s46, v5
    s_sub_u32 s46, s46, 16
    s_nop 0
    v_cndmask_b32 v138, v138, v33, vcc
    v_cmp_eq_u32 vcc, s46, v5
    s_sub_u32 s46, s46, 16
    s_nop 0
    v_cndmask_b32 v139, v139, v33, vcc
SD_50:
    s_and_b32 s46, s63, 0x7ff
    s_sub_u32 s46, s47, s46
    s_and_b32 s45, s46, 0xffffffcc
    s_cbranch_scc1 SD_51
    s_mov_b32 s77, 1
    s_or_b32 s45, s63, 0x6000
    v_mov_b32 v33, s45
    v_cmp_eq_u32 vcc, s46, v5
    s_sub_u32 s46, s46, 16
    s_nop 0
    v_cndmask_b32 v136, v136, v33, vcc
    v_cmp_eq_u32 vcc, s46, v5
    s_sub_u32 s46, s46, 16
    s_nop 0
    v_cndmask_b32 v137, v137, v33, vcc
    v_cmp_eq_u32 vcc, s46, v5
    s_sub_u32 s46, s46, 16
    s_nop 0
    v_cndmask_b32 v138, v138, v33, vcc
    v_cmp_eq_u32 vcc, s46, v5
    s_sub_u32 s46, s46, 16
    s_nop 0
    v_cndmask_b32 v139, v139, v33, vcc
SD_51:
    s_and_b32 s46, s64, 0x7ff
    s_sub_u32 s46, s47, s46
    s_and_b32 s45, s46, 0xffffffcc
    s_cbranch_scc1 SD_52
    s_mov_b32 s77, 1
    s_or_b32 s45, s64, 0x800
    v_mov_b32 v33, s45
    v_cmp_eq_u32 vcc, s46, v5
    s_sub_u32 s46, s46, 16
    s_nop 0
    v_cndmask_b32 v136, v136, v33, vcc
    v_cmp_eq_u32 vcc, s46, v5
    s_sub_u32 s46, s46, 16
    s_nop 0
    v_cndmask_b32 v137, v137, v33, vcc
    v_cmp_eq_u32 vcc, s46, v5
    s_sub_u32 s46, s46, 16
    s_nop 0
    v_cndmask_b32 v138, v138, v33, vcc
    v_cmp_eq_u32 vcc, s46, v5
    s_sub_u32 s46, s46, 16
    s_nop 0
    v_cndmask_b32 v139, v139, v33, vcc
SD_52:
    s_and_b32 s46, s65, 0x7ff
    s_sub_u32 s46, s47, s46
    s_and_b32 s45, s46, 0xffffffcc
    s_cbranch_scc1 SD_53
    s_mov_b32 s77, 1
    s_or_b32 s45, s65, 0x2800
    v_mov_b32 v33, s45
    v_cmp_eq_u32 vcc, s46, v5
    s_sub_u32 s46, s46, 16
    s_nop 0
    v_cndmask_b32 v136, v136, v33, vcc
    v_cmp_eq_u32 vcc, s46, v5
    s_sub_u32 s46, s46, 16
    s_nop 0
    v_cndmask_b32 v137, v137, v33, vcc
    v_cmp_eq_u32 vcc, s46, v5
    s_sub_u32 s46, s46, 16
    s_nop 0
    v_cndmask_b32 v138, v138, v33, vcc
    v_cmp_eq_u32 vcc, s46, v5
    s_sub_u32 s46, s46, 16
    s_nop 0
    v_cndmask_b32 v139, v139, v33, vcc
SD_53:
    s_and_b32 s46, s66, 0x7ff
    s_sub_u32 s46, s47, s46
    s_and_b32 s45, s46, 0xffffffcc
    s_cbranch_scc1 SD_54
    s_mov_b32 s77, 1
    s_or_b32 s45, s66, 0x4800
    v_mov_b32 v33, s45
    v_cmp_eq_u32 vcc, s46, v5
    s_sub_u32 s46, s46, 16
    s_nop 0
    v_cndmask_b32 v136, v136, v33, vcc
    v_cmp_eq_u32 vcc, s46, v5
    s_sub_u32 s46, s46, 16
    s_nop 0
    v_cndmask_b32 v137, v137, v33, vcc
    v_cmp_eq_u32 vcc, s46, v5
    s_sub_u32 s46, s46, 16
    s_nop 0
    v_cndmask_b32 v138, v138, v33, vcc
    v_cmp_eq_u32 vcc, s46, v5
    s_sub_u32 s46, s46, 16
    s_nop 0
    v_cndmask_b32 v139, v139, v33, vcc
SD_54:
    s_and_b32 s46, s67, 0x7ff
    s_sub_u32 s46, s47, s46
    s_and_b32 s45, s46, 0xffffffcc
    s_cbranch_scc1 SD_55
    s_mov_b32 s77, 1
    s_or_b32 s45, s67, 0x6800
    v_mov_b32 v33, s45
    v_cmp_eq_u32 vcc, s46, v5
    s_sub_u32 s46, s46, 16
    s_nop 0
    v_cndmask_b32 v136, v136, v33, vcc
    v_cmp_eq_u32 vcc, s46, v5
    s_sub_u32 s46, s46, 16
    s_nop 0
    v_cndmask_b32 v137, v137, v33, vcc
    v_cmp_eq_u32 vcc, s46, v5
    s_sub_u32 s46, s46, 16
    s_nop 0
    v_cndmask_b32 v138, v138, v33, vcc
    v_cmp_eq_u32 vcc, s46, v5
    s_sub_u32 s46, s46, 16
    s_nop 0
    v_cndmask_b32 v139, v139, v33, vcc
SD_55:
    s_cmp_eq_u32 s77, 0
    s_cbranch_scc1 F_ys1
    v_lshlrev_b32 v34, 2, v7
    v_cmp_ne_u32 s[60:61], 0, v136
    v_and_b32 v140, 0xffff0000, v136
    v_ashrrev_i32 v33, 31, v140
    v_not_b32 v33, v33
    v_or_b32 v33, 0x80000000, v33
    v_xor_b32 v140, v140, v33
    v_and_b32 v140, 0xffff0000, v140
    v_mul_f32 v140, s48, v140
    v_exp_f32 v140, v140
    s_nop 0
    v_add_f32 v140, 1.0, v140
    v_rcp_f32 v140, v140
    s_nop 0
    v_cvt_pk_bf16_f32 v140, v140, v140
    v_lshlrev_b32 v140, 16, v140
    v_bfe_u32 v136, v136, 11, 4
    v_lshl_add_u32 v136, v136, 6, v34
    v_cmp_ne_u32 s[62:63], 0, v137
    v_and_b32 v141, 0xffff0000, v137
    v_ashrrev_i32 v33, 31, v141
    v_not_b32 v33, v33
    v_or_b32 v33, 0x80000000, v33
    v_xor_b32 v141, v141, v33
    v_and_b32 v141, 0xffff0000, v141
    v_mul_f32 v141, s48, v141
    v_exp_f32 v141, v141
    s_nop 0
    v_add_f32 v141, 1.0, v141
    v_rcp_f32 v141, v141
    s_nop 0
    v_cvt_pk_bf16_f32 v141, v141, v141
    v_lshlrev_b32 v141, 16, v141
    v_bfe_u32 v137, v137, 11, 4
    v_lshl_add_u32 v137, v137, 6, v34
    v_cmp_ne_u32 s[64:65], 0, v138
    v_and_b32 v142, 0xffff0000, v138
    v_ashrrev_i32 v33, 31, v142
    v_not_b32 v33, v33
    v_or_b32 v33, 0x80000000, v33
    v_xor_b32 v142, v142, v33
    v_and_b32 v142, 0xffff0000, v142
    v_mul_f32 v142, s48, v142
    v_exp_f32 v142, v142
    s_nop 0
    v_add_f32 v142, 1.0, v142
    v_rcp_f32 v142, v142
    s_nop 0
    v_cvt_pk_bf16_f32 v142, v142, v142
    v_lshlrev_b32 v142, 16, v142
    v_bfe_u32 v138, v138, 11, 4
    v_lshl_add_u32 v138, v138, 6, v34
    v_cmp_ne_u32 s[66:67], 0, v139
    v_and_b32 v143, 0xffff0000, v139
    v_ashrrev_i32 v33, 31, v143
    v_not_b32 v33, v33
    v_or_b32 v33, 0x80000000, v33
    v_xor_b32 v143, v143, v33
    v_and_b32 v143, 0xffff0000, v143
    v_mul_f32 v143, s48, v143
    v_exp_f32 v143, v143
    s_nop 0
    v_add_f32 v143, 1.0, v143
    v_rcp_f32 v143, v143
    s_nop 0
    v_cvt_pk_bf16_f32 v143, v143, v143
    v_lshlrev_b32 v143, 16, v143
    v_bfe_u32 v139, v139, 11, 4
    v_lshl_add_u32 v139, v139, 6, v34
F_ys1:
    s_lshl_b32 s45, s29, 7
    s_add_u32 s84, s45, 0x82a000
    s_add_u32 s84, s72, s84
    s_addc_u32 s85, s73, 0
    s_lshl_b32 s50, s29, 12
    s_add_u32 s50, s50, 135168
    s_cmp_ge_u32 s11, 224
    s_cbranch_scc1 F_ynd
    ds_read_b32 v12, v163
FW_56:
    s_waitcnt lgkmcnt(0)
    v_cmp_gt_u32_e64 vcc, 3, v12
    s_cbranch_vccz FO_57
    s_sleep 2
    ds_read_b32 v12, v163
    s_branch FW_56
FO_57:
SP_58:
    s_load_dword s74, s[56:57], 0 glc
    s_waitcnt lgkmcnt(0)
    s_cmp_ge_u32 s74, 8
    s_cbranch_scc1 SD_59
    s_sleep 8
    s_branch SP_58
SD_59:
    s_add_u32 s45, s38, 0
    buffer_load_dwordx4 v[32:35], v11, s[12:15], s45 offen offset:0 sc0 sc1
    buffer_load_dwordx4 v[36:39], v11, s[12:15], s45 offen offset:512 sc0 sc1
    s_add_u32 s45, s38, 229376
    buffer_load_dwordx4 v[40:43], v11, s[12:15], s45 offen offset:0 sc0 sc1
    buffer_load_dwordx4 v[44:47], v11, s[12:15], s45 offen offset:512 sc0 sc1
    s_add_u32 s45, s38, 458752
    buffer_load_dwordx4 v[48:51], v11, s[12:15], s45 offen offset:0 sc0 sc1
    buffer_load_dwordx4 v[52:55], v11, s[12:15], s45 offen offset:512 sc0 sc1
    s_add_u32 s45, s38, 688128
    buffer_load_dwordx4 v[56:59], v11, s[12:15], s45 offen offset:0 sc0 sc1
    buffer_load_dwordx4 v[60:63], v11, s[12:15], s45 offen offset:512 sc0 sc1
    s_lshl_b32 s45, s87, 7
    s_add_u32 s58, s45, 0x82a000
    s_add_u32 s58, s72, s58
    s_addc_u32 s59, s73, 0
    s_lshl_b32 s44, s87, 2
    s_add_u32 s44, s44, s3
    s_lshl_b32 s44, s44, 10
    s_add_u32 s44, s44, 135168
    s_waitcnt vmcnt(10)
    s_nop 0
    v_perm_b32 v104, v20, v16, s52
    v_perm_b32 v105, v28, v24, s52
    v_perm_b32 v106, v148, v144, s52
    v_perm_b32 v107, v156, v152, s52
    v_perm_b32 v108, v20, v16, s53
    v_perm_b32 v109, v28, v24, s53
    v_perm_b32 v110, v148, v144, s53
    v_perm_b32 v111, v156, v152, s53
    v_perm_b32 v112, v21, v17, s52
    v_perm_b32 v113, v29, v25, s52
    v_perm_b32 v114, v149, v145, s52
    v_perm_b32 v115, v157, v153, s52
    v_perm_b32 v116, v21, v17, s53
    v_perm_b32 v117, v29, v25, s53
    v_perm_b32 v118, v149, v145, s53
    v_perm_b32 v119, v157, v153, s53
    v_perm_b32 v120, v22, v18, s52
    v_perm_b32 v121, v30, v26, s52
    v_perm_b32 v122, v150, v146, s52
    v_perm_b32 v123, v158, v154, s52
    v_perm_b32 v124, v22, v18, s53
    v_perm_b32 v125, v30, v26, s53
    v_perm_b32 v126, v150, v146, s53
    v_perm_b32 v127, v158, v154, s53
    v_perm_b32 v128, v23, v19, s52
    v_perm_b32 v129, v31, v27, s52
    v_perm_b32 v130, v151, v147, s52
    v_perm_b32 v131, v159, v155, s52
    v_perm_b32 v132, v23, v19, s53
    v_perm_b32 v133, v31, v27, s53
    v_perm_b32 v134, v151, v147, s53
    v_perm_b32 v135, v159, v155, s53
F_dl:
    s_waitcnt vmcnt(4)
    v_min3_u32 v12, v32, v34, v36
    v_min3_u32 v12, v12, v38, v40
    v_min3_u32 v12, v12, v42, v44
    v_min_u32 v12, v12, v46
    v_add_f32 v32, v32, v40
    v_add_f32 v33, v33, v41
    v_add_f32 v34, v34, v42
    v_add_f32 v35, v35, v43
    v_add_f32 v36, v36, v44
    v_add_f32 v37, v37, v45
    v_add_f32 v38, v38, v46
    v_add_f32 v39, v39, v47
    s_waitcnt vmcnt(0)
    v_min3_u32 v12, v12, v48, v50
    v_min3_u32 v12, v12, v52, v54
    v_min3_u32 v12, v12, v56, v58
    v_min3_u32 v12, v12, v60, v62
    v_cmp_eq_u32 vcc, 0, v12
    v_add_f32 v48, v48, v56
    v_add_f32 v49, v49, v57
    v_add_f32 v50, v50, v58
    v_add_f32 v51, v51, v59
    v_add_f32 v52, v52, v60
    v_add_f32 v53, v53, v61
    v_add_f32 v54, v54, v62
    v_add_f32_e64 v55, v55, v63
    s_cbranch_vccz F_dm
    s_sleep 6
    s_add_u32 s45, s38, 0
    buffer_load_dwordx4 v[32:35], v11, s[12:15], s45 offen offset:0 sc0 sc1
    buffer_load_dwordx4 v[36:39], v11, s[12:15], s45 offen offset:512 sc0 sc1
    s_add_u32 s45, s38, 229376
    buffer_load_dwordx4 v[40:43], v11, s[12:15], s45 offen offset:0 sc0 sc1
    buffer_load_dwordx4 v[44:47], v11, s[12:15], s45 offen offset:512 sc0 sc1
    s_add_u32 s45, s38, 458752
    buffer_load_dwordx4 v[48:51], v11, s[12:15], s45 offen offset:0 sc0 sc1
    buffer_load_dwordx4 v[52:55], v11, s[12:15], s45 offen offset:512 sc0 sc1
    s_add_u32 s45, s38, 688128
    buffer_load_dwordx4 v[56:59], v11, s[12:15], s45 offen offset:0 sc0 sc1
    buffer_load_dwordx4 v[60:63], v11, s[12:15], s45 offen offset:512 sc0 sc1
    s_branch F_dl
F_dm:
    v_add_f32 v32, v32, v48
    v_add_f32 v33, v33, v49
    v_add_f32 v34, v34, v50
    v_add_f32 v35, v35, v51
    v_add_f32 v36, v36, v52
    v_add_f32 v37, v37, v53
    v_add_f32 v38, v38, v54
    v_add_f32_e64 v39, v39, v55
    v_cvt_pk_bf16_f32 v40, v32, v33
    v_cvt_pk_bf16_f32 v41, v34, v35
    v_cvt_pk_bf16_f32 v42, v36, v37
    v_cvt_pk_bf16_f32 v43, v38, v39
    v_cvt_pk_bf16_f32 v44, v32, v33
    v_cvt_pk_bf16_f32 v45, v34, v35
    v_mov_b32_dpp v40, v42 row_ror:8 row_mask:0xf bank_mask:0xc
    v_mov_b32_dpp v41, v43 row_ror:8 row_mask:0xf bank_mask:0xc
    v_mov_b32_dpp v42, v44 row_ror:8 row_mask:0xf bank_mask:0x3
    v_mov_b32_dpp v43, v45 row_ror:8 row_mask:0xf bank_mask:0x3
    v_lshlrev_b32 v48, 16, v40
    v_and_b32 v49, 0xffff0000, v40
    v_lshlrev_b32 v50, 16, v41
    v_and_b32 v51, 0xffff0000, v41
    v_lshlrev_b32 v52, 16, v42
    v_and_b32 v53, 0xffff0000, v42
    v_lshlrev_b32 v54, 16, v43
    v_and_b32 v55, 0xffff0000, v43
    v_mul_f32 v56, s48, v48
    v_mul_f32 v57, s48, v49
    v_mul_f32 v58, s48, v50
    v_mul_f32 v59, s48, v51
    v_exp_f32 v56, v56
    v_exp_f32 v57, v57
    v_exp_f32 v58, v58
    v_exp_f32 v59, v59
    v_add_f32 v56, 1.0, v56
    v_add_f32 v57, 1.0, v57
    v_add_f32 v58, 1.0, v58
    v_add_f32 v59, 1.0, v59
    v_rcp_f32 v56, v56
    v_rcp_f32 v57, v57
    v_rcp_f32 v58, v58
    v_rcp_f32 v59, v59
    v_mul_f32 v48, v48, v56
    v_mul_f32 v49, v49, v57
    v_mul_f32 v50, v50, v58
    v_mul_f32 v51, v51, v59
    v_cvt_pk_bf16_f32 v56, v48, v49
    v_cvt_pk_bf16_f32 v57, v50, v51
    v_lshlrev_b32 v48, 16, v56
    v_and_b32 v49, 0xffff0000, v56
    v_lshlrev_b32 v50, 16, v57
    v_and_b32 v51, 0xffff0000, v57
    v_mul_f32 v48, v48, v52
    v_mul_f32 v49, v49, v53
    v_mul_f32 v50, v50, v54
    v_mul_f32_e64 v51, v51, v55
    v_cvt_pk_bf16_f32 v56, v48, v49
    v_cvt_pk_bf16_f32 v57, v50, v51
    s_nop 0
    v_mov_b32_dpp v64, v56 quad_perm:[0,1,2,3] row_mask:0xf bank_mask:0x3
    v_mov_b32_dpp v65, v57 quad_perm:[0,1,2,3] row_mask:0xf bank_mask:0x3
    v_mov_b32_dpp v66, v56 row_ror:8 row_mask:0xf bank_mask:0x3
    v_mov_b32_dpp v67, v57 row_ror:8 row_mask:0xf bank_mask:0x3
    v_mov_b32_dpp v68, v56 row_ror:8 row_mask:0xf bank_mask:0xc
    v_mov_b32_dpp v69, v57 row_ror:8 row_mask:0xf bank_mask:0xc
    v_mov_b32_dpp v70, v56 quad_perm:[0,1,2,3] row_mask:0xf bank_mask:0xc
    v_mov_b32_dpp v71, v57 quad_perm:[0,1,2,3] row_mask:0xf bank_mask:0xc
    v_mfma_f32_16x16x32_bf16 v[72:75], v[64:67], v[104:107], 0
    s_nop 0
    v_mfma_f32_16x16x32_bf16 v[72:75], v[68:71], v[120:123], v[72:75]
    v_mfma_f32_16x16x32_bf16 v[76:79], v[64:67], v[108:111], 0
    v_mfma_f32_16x16x32_bf16 v[76:79], v[68:71], v[124:127], v[76:79]
    v_mfma_f32_16x16x32_bf16 v[80:83], v[64:67], v[112:115], 0
    v_mfma_f32_16x16x32_bf16 v[80:83], v[68:71], v[128:131], v[80:83]
    v_mfma_f32_16x16x32_bf16 v[84:87], v[64:67], v[116:119], 0
    v_mfma_f32_16x16x32_bf16 v[84:87], v[68:71], v[132:135], v[84:87]
    s_nop 1
    ds_write_b128 v161, v[72:75] offset:0
    s_nop 0
    ds_write_b128 v161, v[76:79] offset:1024
    s_nop 0
    ds_write_b128 v161, v[80:83] offset:2048
    s_nop 0
    ds_write_b128 v161, v[84:87] offset:3072
    v_mov_b32 v4, 1
    s_mov_b64 exec, 1
    ds_write_b32 v10, v4 offset:64
    s_mov_b64 exec, -1
    ds_read_b32 v12, v13
FW_60:
    s_waitcnt lgkmcnt(0)
    v_cmp_gt_u32 vcc, 1, v12
    s_cbranch_vccz FO_61
    s_sleep 1
    ds_read_b32 v12, v13
    s_branch FW_60
FO_61:
    ds_read_b128 v[48:51], v167 offset:0
    ds_read_b128 v[52:55], v167 offset:4096
    ds_read_b128 v[56:59], v167 offset:24576
    ds_read_b128 v[60:63], v167 offset:28672
    s_waitcnt lgkmcnt(2)
    v_add_f32 v48, v48, v52
    v_add_f32 v49, v49, v53
    v_add_f32 v50, v50, v54
    v_add_f32 v51, v51, v55
    s_waitcnt lgkmcnt(0)
    v_add_f32 v56, v56, v60
    v_add_f32 v48, v48, v56
    buffer_atomic_add_f32 v48, v3, s[24:27], s44 offen offset:0
    v_add_f32 v57, v57, v61
    v_add_f32 v49, v49, v57
    buffer_atomic_add_f32 v49, v3, s[24:27], s44 offen offset:256
    v_add_f32 v58, v58, v62
    v_add_f32 v50, v50, v58
    buffer_atomic_add_f32 v50, v3, s[24:27], s44 offen offset:512
    v_add_f32 v59, v59, v63
    v_add_f32 v51, v51, v59
    buffer_atomic_add_f32 v51, v3, s[24:27], s44 offen offset:768
F_ynd:
    s_barrier
    s_barrier
    s_barrier
    s_barrier
    s_waitcnt vmcnt(0)
    s_barrier
    s_cmp_lg_u32 s3, 0
    s_cbranch_scc1 F_y0
    s_cmp_ge_u32 s11, 224
    s_cbranch_scc1 F_y0
    s_mov_b32 s76, 1
    s_atomic_add s76, s[58:59], 0
F_y0:
    s_barrier
    s_barrier
    s_barrier
    s_barrier
    s_cmp_lg_u32 s77, 0
    s_cbranch_scc1 F_y1
    s_barrier
    s_barrier
    s_barrier
    s_barrier
    s_barrier
    s_barrier
F_y3:
    s_waitcnt lgkmcnt(0)
    s_setprio 3
    s_barrier
    ds_read_b128 v[16:19], v15 offset:0
    s_cmp_lg_u32 s77, 0
    s_waitcnt lgkmcnt(0)
    s_cbranch_scc1 F_ya0
F_yb0:
    buffer_store_dwordx4 v[16:19], v14, s[80:83], s78 offen sc1
    s_add_u32 s78, s78, 32768
    s_barrier
    ds_read_b128 v[20:23], v15 offset:4352
    s_cmp_lg_u32 s77, 0
    s_waitcnt lgkmcnt(0)
    s_cbranch_scc1 F_ya1
F_yb1:
    buffer_store_dwordx4 v[20:23], v14, s[80:83], s78 offen sc1
    s_add_u32 s78, s78, 32768
    s_barrier
    ds_read_b128 v[24:27], v15 offset:8704
    ds_read_b128 v[28:31], v15 offset:13056
    s_cmp_lg_u32 s77, 0
    s_waitcnt lgkmcnt(1)
    s_cbranch_scc1 F_ya2
F_yb2:
    buffer_store_dwordx4 v[24:27], v14, s[80:83], s78 offen sc1
    s_add_u32 s78, s78, 32768
    s_cmp_lg_u32 s77, 0
    s_waitcnt lgkmcnt(0)
    s_cbranch_scc1 F_ya3
F_yb3:
    buffer_store_dwordx4 v[28:31], v14, s[80:83], s78 offen sc1
    s_add_u32 s78, s78, 32768
    s_endpgm
F_y1:
    s_load_dword s74, s[84:85], 0 glc
    s_barrier
    s_barrier
    s_waitcnt lgkmcnt(0)
    s_cmp_lt_u32 s74, 28
    s_cbranch_scc1 F_y2
    s_mov_b64 exec, s[60:61]
    s_cbranch_execz YL_62
    buffer_load_dword v72, v136, s[24:27], s50 offen offset:0 sc0 sc1
    buffer_load_dword v73, v136, s[24:27], s50 offen offset:1024 sc0 sc1
    buffer_load_dword v74, v136, s[24:27], s50 offen offset:2048 sc0 sc1
    buffer_load_dword v75, v136, s[24:27], s50 offen offset:3072 sc0 sc1
    buffer_load_dword v76, v136, s[24:27], s50 offen offset:128 sc0 sc1
    buffer_load_dword v77, v136, s[24:27], s50 offen offset:1152 sc0 sc1
    buffer_load_dword v78, v136, s[24:27], s50 offen offset:2176 sc0 sc1
    buffer_load_dword v79, v136, s[24:27], s50 offen offset:3200 sc0 sc1
YL_62:
    s_mov_b64 exec, s[62:63]
    s_cbranch_execz YL_63
    buffer_load_dword v80, v137, s[24:27], s50 offen offset:0 sc0 sc1
    buffer_load_dword v81, v137, s[24:27], s50 offen offset:1024 sc0 sc1
    buffer_load_dword v82, v137, s[24:27], s50 offen offset:2048 sc0 sc1
    buffer_load_dword v83, v137, s[24:27], s50 offen offset:3072 sc0 sc1
    buffer_load_dword v84, v137, s[24:27], s50 offen offset:128 sc0 sc1
    buffer_load_dword v85, v137, s[24:27], s50 offen offset:1152 sc0 sc1
    buffer_load_dword v86, v137, s[24:27], s50 offen offset:2176 sc0 sc1
    buffer_load_dword v87, v137, s[24:27], s50 offen offset:3200 sc0 sc1
YL_63:
    s_mov_b64 exec, s[64:65]
    s_cbranch_execz YL_64
    buffer_load_dword v88, v138, s[24:27], s50 offen offset:0 sc0 sc1
    buffer_load_dword v89, v138, s[24:27], s50 offen offset:1024 sc0 sc1
    buffer_load_dword v90, v138, s[24:27], s50 offen offset:2048 sc0 sc1
    buffer_load_dword v91, v138, s[24:27], s50 offen offset:3072 sc0 sc1
    buffer_load_dword v92, v138, s[24:27], s50 offen offset:128 sc0 sc1
    buffer_load_dword v93, v138, s[24:27], s50 offen offset:1152 sc0 sc1
    buffer_load_dword v94, v138, s[24:27], s50 offen offset:2176 sc0 sc1
    buffer_load_dword v95, v138, s[24:27], s50 offen offset:3200 sc0 sc1
YL_64:
    s_mov_b64 exec, s[66:67]
    s_cbranch_execz YL_65
    buffer_load_dword v96, v139, s[24:27], s50 offen offset:0 sc0 sc1
    buffer_load_dword v97, v139, s[24:27], s50 offen offset:1024 sc0 sc1
    buffer_load_dword v98, v139, s[24:27], s50 offen offset:2048 sc0 sc1
    buffer_load_dword v99, v139, s[24:27], s50 offen offset:3072 sc0 sc1
    buffer_load_dword v100, v139, s[24:27], s50 offen offset:128 sc0 sc1
    buffer_load_dword v101, v139, s[24:27], s50 offen offset:1152 sc0 sc1
    buffer_load_dword v102, v139, s[24:27], s50 offen offset:2176 sc0 sc1
    buffer_load_dword v103, v139, s[24:27], s50 offen offset:3200 sc0 sc1
YL_65:
    s_mov_b64 exec, -1
    s_barrier
    s_barrier
    s_barrier
    s_barrier
    s_branch F_y3
F_y2:
    s_barrier
    s_barrier
    s_barrier
    s_barrier
SP_66:
    s_load_dword s74, s[84:85], 0 glc
    s_waitcnt lgkmcnt(0)
    s_cmp_ge_u32 s74, 28
    s_cbranch_scc1 SD_67
    s_sleep 2
    s_branch SP_66
SD_67:
    s_mov_b64 exec, s[60:61]
    s_cbranch_execz YL_68
    s_nop 0
    buffer_load_dword v72, v136, s[24:27], s50 offen offset:0 sc0 sc1
    buffer_load_dword v73, v136, s[24:27], s50 offen offset:1024 sc0 sc1
    buffer_load_dword v74, v136, s[24:27], s50 offen offset:2048 sc0 sc1
    buffer_load_dword v75, v136, s[24:27], s50 offen offset:3072 sc0 sc1
    buffer_load_dword v76, v136, s[24:27], s50 offen offset:128 sc0 sc1
    buffer_load_dword v77, v136, s[24:27], s50 offen offset:1152 sc0 sc1
    buffer_load_dword v78, v136, s[24:27], s50 offen offset:2176 sc0 sc1
    buffer_load_dword v79, v136, s[24:27], s50 offen offset:3200 sc0 sc1
YL_68:
    s_mov_b64 exec, s[62:63]
    s_cbranch_execz YL_69
    buffer_load_dword v80, v137, s[24:27], s50 offen offset:0 sc0 sc1
    buffer_load_dword v81, v137, s[24:27], s50 offen offset:1024 sc0 sc1
    buffer_load_dword v82, v137, s[24:27], s50 offen offset:2048 sc0 sc1
    buffer_load_dword v83, v137, s[24:27], s50 offen offset:3072 sc0 sc1
    buffer_load_dword v84, v137, s[24:27], s50 offen offset:128 sc0 sc1
    buffer_load_dword v85, v137, s[24:27], s50 offen offset:1152 sc0 sc1
    buffer_load_dword v86, v137, s[24:27], s50 offen offset:2176 sc0 sc1
    buffer_load_dword v87, v137, s[24:27], s50 offen offset:3200 sc0 sc1
YL_69:
    s_mov_b64 exec, s[64:65]
    s_cbranch_execz YL_70
    buffer_load_dword v88, v138, s[24:27], s50 offen offset:0 sc0 sc1
    buffer_load_dword v89, v138, s[24:27], s50 offen offset:1024 sc0 sc1
    buffer_load_dword v90, v138, s[24:27], s50 offen offset:2048 sc0 sc1
    buffer_load_dword v91, v138, s[24:27], s50 offen offset:3072 sc0 sc1
    buffer_load_dword v92, v138, s[24:27], s50 offen offset:128 sc0 sc1
    buffer_load_dword v93, v138, s[24:27], s50 offen offset:1152 sc0 sc1
    buffer_load_dword v94, v138, s[24:27], s50 offen offset:2176 sc0 sc1
    buffer_load_dword v95, v138, s[24:27], s50 offen offset:3200 sc0 sc1
YL_70:
    s_mov_b64 exec, s[66:67]
    s_cbranch_execz YL_71
    buffer_load_dword v96, v139, s[24:27], s50 offen offset:0 sc0 sc1
    buffer_load_dword v97, v139, s[24:27], s50 offen offset:1024 sc0 sc1
    buffer_load_dword v98, v139, s[24:27], s50 offen offset:2048 sc0 sc1
    buffer_load_dword v99, v139, s[24:27], s50 offen offset:3072 sc0 sc1
    buffer_load_dword v100, v139, s[24:27], s50 offen offset:128 sc0 sc1
    buffer_load_dword v101, v139, s[24:27], s50 offen offset:1152 sc0 sc1
    buffer_load_dword v102, v139, s[24:27], s50 offen offset:2176 sc0 sc1
    buffer_load_dword v103, v139, s[24:27], s50 offen offset:3200 sc0 sc1
YL_71:
    s_mov_b64 exec, -1
    s_branch F_y3
F_ya0:
    s_cmp_eq_u64 s[60:61], 0
    s_cbranch_scc1 F_yb0
    s_mov_b64 exec, s[60:61]
    v_lshlrev_b32 v32, 16, v16
    v_and_b32 v33, 0xffff0000, v16
    v_lshlrev_b32 v34, 16, v17
    v_and_b32 v35, 0xffff0000, v17
    v_lshlrev_b32 v36, 16, v18
    v_and_b32 v37, 0xffff0000, v18
    v_lshlrev_b32 v38, 16, v19
    v_and_b32 v39, 0xffff0000, v19
    s_waitcnt vmcnt(0)
    v_fmac_f32 v32, v72, v140
    v_fmac_f32 v33, v73, v140
    v_fmac_f32 v34, v74, v140
    v_fmac_f32 v35, v75, v140
    v_fmac_f32 v36, v76, v140
    v_fmac_f32 v37, v77, v140
    v_fmac_f32 v38, v78, v140
    v_fmac_f32 v39, v79, v140
    v_cvt_pk_bf16_f32 v16, v32, v33
    v_cvt_pk_bf16_f32 v17, v34, v35
    v_cvt_pk_bf16_f32 v18, v36, v37
    v_cvt_pk_bf16_f32 v19, v38, v39
    s_mov_b64 exec, -1
    s_branch F_yb0
F_ya1:
    s_cmp_eq_u64 s[62:63], 0
    s_cbranch_scc1 F_yb1
    s_mov_b64 exec, s[62:63]
    v_lshlrev_b32 v32, 16, v20
    v_and_b32 v33, 0xffff0000, v20
    v_lshlrev_b32 v34, 16, v21
    v_and_b32 v35, 0xffff0000, v21
    v_lshlrev_b32 v36, 16, v22
    v_and_b32 v37, 0xffff0000, v22
    v_lshlrev_b32 v38, 16, v23
    v_and_b32 v39, 0xffff0000, v23
    s_waitcnt vmcnt(1)
    v_fmac_f32 v32, v80, v141
    v_fmac_f32 v33, v81, v141
    v_fmac_f32 v34, v82, v141
    v_fmac_f32 v35, v83, v141
    v_fmac_f32 v36, v84, v141
    v_fmac_f32 v37, v85, v141
    v_fmac_f32 v38, v86, v141
    v_fmac_f32 v39, v87, v141
    v_cvt_pk_bf16_f32 v20, v32, v33
    v_cvt_pk_bf16_f32 v21, v34, v35
    v_cvt_pk_bf16_f32 v22, v36, v37
    v_cvt_pk_bf16_f32 v23, v38, v39
    s_mov_b64 exec, -1
    s_branch F_yb1
F_ya2:
    s_cmp_eq_u64 s[64:65], 0
    s_cbranch_scc1 F_yb2
    s_mov_b64 exec, s[64:65]
    v_lshlrev_b32 v32, 16, v24
    v_and_b32 v33, 0xffff0000, v24
    v_lshlrev_b32 v34, 16, v25
    v_and_b32 v35, 0xffff0000, v25
    v_lshlrev_b32 v36, 16, v26
    v_and_b32 v37, 0xffff0000, v26
    v_lshlrev_b32 v38, 16, v27
    v_and_b32 v39, 0xffff0000, v27
    s_waitcnt vmcnt(2)
    v_fmac_f32 v32, v88, v142
    v_fmac_f32 v33, v89, v142
    v_fmac_f32 v34, v90, v142
    v_fmac_f32 v35, v91, v142
    v_fmac_f32 v36, v92, v142
    v_fmac_f32 v37, v93, v142
    v_fmac_f32 v38, v94, v142
    v_fmac_f32 v39, v95, v142
    v_cvt_pk_bf16_f32 v24, v32, v33
    v_cvt_pk_bf16_f32 v25, v34, v35
    v_cvt_pk_bf16_f32 v26, v36, v37
    v_cvt_pk_bf16_f32 v27, v38, v39
    s_mov_b64 exec, -1
    s_branch F_yb2
F_ya3:
    s_cmp_eq_u64 s[66:67], 0
    s_cbranch_scc1 F_yb3
    s_mov_b64 exec, s[66:67]
    v_lshlrev_b32 v32, 16, v28
    v_and_b32 v33, 0xffff0000, v28
    v_lshlrev_b32 v34, 16, v29
    v_and_b32 v35, 0xffff0000, v29
    v_lshlrev_b32 v36, 16, v30
    v_and_b32 v37, 0xffff0000, v30
    v_lshlrev_b32 v38, 16, v31
    v_and_b32 v39, 0xffff0000, v31
    s_waitcnt vmcnt(3)
    v_fmac_f32 v32, v96, v143
    v_fmac_f32 v33, v97, v143
    v_fmac_f32 v34, v98, v143
    v_fmac_f32 v35, v99, v143
    v_fmac_f32 v36, v100, v143
    v_fmac_f32 v37, v101, v143
    v_fmac_f32 v38, v102, v143
    v_fmac_f32 v39, v103, v143
    v_cvt_pk_bf16_f32 v28, v32, v33
    v_cvt_pk_bf16_f32 v29, v34, v35
    v_cvt_pk_bf16_f32 v30, v36, v37
    v_cvt_pk_bf16_f32 v31, v38, v39
    s_mov_b64 exec, -1
    s_branch F_yb3
F_codeend:
.section .rodata,"a"
.p2align 6
.amdhsa_kernel parallel_sum__linear_attn_block__moe_arch_mod__prompt_kernel
  .amdhsa_next_free_vgpr 168
  .amdhsa_next_free_sgpr 96
  .amdhsa_accum_offset 168
  .amdhsa_group_segment_fixed_size 0
  .amdhsa_kernarg_size 88
  .amdhsa_user_sgpr_count 2
  .amdhsa_user_sgpr_kernarg_segment_ptr 1
  .amdhsa_system_sgpr_workgroup_id_x 1
  .amdhsa_float_denorm_mode_32 3
  .amdhsa_float_denorm_mode_16_64 3
.end_amdhsa_kernel
```
